```python
import torch

def _softmax(x, axis=-1):
    return torch.softmax(x, dim=axis)

def _gelu(x):
    return torch.nn.functional.gelu(x, approximate='tanh')

def _silu(x):
    return torch.nn.functional.silu(x)

def _sigmoid(x):
    return torch.sigmoid(x)

def _layernorm(x, axis=-1, eps=1e-05):
    m = x.mean(dim=axis, keepdim=True)
    v = x.var(dim=axis, keepdim=True, unbiased=False)
    return (x - m) / torch.sqrt(v + eps)

def _scatter_add(tgt, idx, src, axis=0):
    return tgt.clone().index_add_(axis, idx, src)

def _segment_sum(src, seg, n):
    out = torch.zeros((n,) + src.shape[1:], dtype=src.dtype)
    return out.index_add_(0, seg, src)

def _pad(x, pw):
    flat = tuple((v for pair in reversed(pw) for v in pair))
    return torch.nn.functional.pad(x, flat)
kernel_name = 'standalone__neighborhood_nat__vision'

def setup_inputs():

    _w = lambda a: (lambda t: t.to(torch.bfloat16) if t.is_floating_point() else t)(torch.as_tensor(a))
    H = W = 224
    C = 192
    return {'x': _w((lambda *s: torch.randn(*s, dtype=torch.bfloat16) * 0.2)(1, H, W, C)), 'wqkv': _w((lambda *s: torch.randn(*s, dtype=torch.bfloat16) * 0.2)(C, 3 * C)), 'wo': _w((lambda *s: torch.randn(*s, dtype=torch.bfloat16) * 0.05)(C, C))}

def reference(x, wqkv, wo):
    B, H, W, C = x.shape
    ks, dil = (7, 2)
    qkv = x @ wqkv
    q, k, v = (qkv[..., :C].clone(), qkv[..., C:2 * C].clone(), qkv[..., 2 * C:].clone())
    half = (ks - 1) // 2 * dil
    ir = torch.arange(H)
    ic = torch.arange(W)
    off = torch.arange(ks) * dil
    r0 = torch.clip(ir - half, 0, H - 1 - (ks - 1) * dil)
    c0 = torch.clip(ic - half, 0, W - 1 - (ks - 1) * dil)
    ri = r0[:, None] + off[None, :]
    ci = c0[:, None] + off[None, :]
    nidx = (ri[:, None, :, None] * W + ci[None, :, None, :]).reshape(1, H * W * ks * ks, 1)
    kf = k.reshape(B, H * W, C)
    vf = v.reshape(B, H * W, C)
    kn = (lambda x, i, axis: torch.take_along_dim(x, i, dim=axis))(kf, nidx, 1).reshape(B, H * W, ks * ks, C)
    vn = (lambda x, i, axis: torch.take_along_dim(x, i, dim=axis))(vf, nidx, 1).reshape(B, H * W, ks * ks, C)
    qf = q.reshape(B, H * W, C)
    scale = C ** (-0.5)
    logits = torch.einsum('bnc,bnkc->bnk', qf, kn) * scale
    p = _softmax(logits, axis=-1)
    o = torch.einsum('bnk,bnkc->bnc', p, vn) @ wo
    return o.reshape(B, H, W, C)
```

```asm
; @launch kernel=prep_kernel grid=(144,1,1) block=(64,1,1) lds=0
; @launch kernel=main_kernel grid=(256,1,1) block=(512,1,1) lds=163840
.amdgcn_target "amdgcn-amd-amdhsa--gfx950"
.text
.globl prep_kernel
.p2align 8
.type prep_kernel,@function
prep_kernel:
  s_cmp_ge_u32 s2, 144
  s_cbranch_scc1 PR_done
  s_load_dwordx4 s[4:7], s[0:1], 8
  s_load_dwordx2 s[8:9], s[0:1], 40
  s_cmp_ge_u32 s2, 72
  s_cselect_b32 s24, 1, 0
  s_mul_i32 s25, s24, 72
  s_sub_u32 s25, s2, s25
  s_mul_hi_u32 s26, s25, 0x15555556
  s_mul_i32 s27, s26, 12
  s_sub_u32 s27, s25, s27
  s_and_b32 s28, s27, 1
  s_lshr_b32 s27, s27, 1
  v_and_b32 v1, 15, v0
  v_lshrrev_b32 v2, 4, v0
  v_lshrrev_b32 v3, 2, v1
  v_and_b32 v4, 3, v1
  s_lshl_b32 s29, s26, 5
  s_lshl_b32 s30, s28, 2
  s_add_u32 s29, s29, s30
  v_lshl_add_u32 v5, v3, 3, v4
  v_add_u32 v5, s29, v5
  s_waitcnt lgkmcnt(0)
  s_mov_b32 s12, s4
  s_and_b32 s13, s5, 0xffff
  s_mov_b32 s14, 221184
  s_mov_b32 s15, 0x00020000
  s_mov_b32 s16, s6
  s_and_b32 s17, s7, 0xffff
  s_mov_b32 s18, 73728
  s_mov_b32 s19, 0x00020000
  s_mov_b32 s20, s8
  s_and_b32 s21, s9, 0xffff
  s_mov_b32 s22, 147456
  s_mov_b32 s23, 0x00020000
  s_cmp_eq_u32 s24, 1
  s_cbranch_scc1 PR_n
  s_lshl_b32 s29, s27, 5
  v_lshl_add_u32 v6, v3, 3, v4
  v_add_u32 v6, s29, v6
  v_mul_u32_u24 v6, 1152, v6
  v_lshl_add_u32 v6, v2, 4, v6
  v_add_u32 v7, 4608, v6
  v_mul_u32_u24 v8, 1152, v5
  v_lshl_add_u32 v8, v2, 4, v8
  buffer_load_dwordx4 v[64:67], v8, s[12:15], 0 offen offset:384
  buffer_load_dwordx4 v[68:71], v8, s[12:15], 0 offen offset:448
  buffer_load_dwordx4 v[72:75], v8, s[12:15], 0 offen offset:512
  buffer_load_dwordx4 v[76:79], v8, s[12:15], 0 offen offset:576
  buffer_load_dwordx4 v[80:83], v8, s[12:15], 0 offen offset:640
  buffer_load_dwordx4 v[84:87], v8, s[12:15], 0 offen offset:704
  s_mov_b32 s31, 1037384597
  s_sub_u32 s25, 71, s25
  s_lshl_b32 s25, s25, 10
  s_branch PR_go
PR_n:
  s_lshr_b32 s29, s27, 1
  s_lshl_b32 s29, s29, 3
  s_and_b32 s30, s27, 1
  s_lshl_b32 s30, s30, 1
  s_add_u32 s29, s29, s30
  s_lshl_b32 s29, s29, 3
  v_lshrrev_b32 v6, 1, v3
  v_lshlrev_b32 v6, 5, v6
  v_and_b32 v7, 1, v3
  v_lshl_add_u32 v6, v7, 2, v6
  v_add3_u32 v6, v6, v4, s29
  v_mul_u32_u24 v6, 1152, v6
  v_lshl_add_u32 v6, v2, 4, v6
  v_add_u32 v6, 768, v6
  v_add_u32 v7, 9216, v6
  v_mul_u32_u24 v8, 3072, v2
  v_lshl_add_u32 v8, v5, 1, v8
  s_mov_b32 s32, 0
  buffer_load_ushort v104, v8, s[16:19], s32 offen offset:0
  buffer_load_ushort v105, v8, s[16:19], s32 offen offset:384
  buffer_load_ushort v106, v8, s[16:19], s32 offen offset:768
  buffer_load_ushort v107, v8, s[16:19], s32 offen offset:1152
  buffer_load_ushort v108, v8, s[16:19], s32 offen offset:1536
  buffer_load_ushort v109, v8, s[16:19], s32 offen offset:1920
  buffer_load_ushort v110, v8, s[16:19], s32 offen offset:2304
  buffer_load_ushort v111, v8, s[16:19], s32 offen offset:2688
  s_mov_b32 s32, 12288
  buffer_load_ushort v112, v8, s[16:19], s32 offen offset:0
  buffer_load_ushort v113, v8, s[16:19], s32 offen offset:384
  buffer_load_ushort v114, v8, s[16:19], s32 offen offset:768
  buffer_load_ushort v115, v8, s[16:19], s32 offen offset:1152
  buffer_load_ushort v116, v8, s[16:19], s32 offen offset:1536
  buffer_load_ushort v117, v8, s[16:19], s32 offen offset:1920
  buffer_load_ushort v118, v8, s[16:19], s32 offen offset:2304
  buffer_load_ushort v119, v8, s[16:19], s32 offen offset:2688
  s_mov_b32 s32, 24576
  buffer_load_ushort v120, v8, s[16:19], s32 offen offset:0
  buffer_load_ushort v121, v8, s[16:19], s32 offen offset:384
  buffer_load_ushort v122, v8, s[16:19], s32 offen offset:768
  buffer_load_ushort v123, v8, s[16:19], s32 offen offset:1152
  buffer_load_ushort v124, v8, s[16:19], s32 offen offset:1536
  buffer_load_ushort v125, v8, s[16:19], s32 offen offset:1920
  buffer_load_ushort v126, v8, s[16:19], s32 offen offset:2304
  buffer_load_ushort v127, v8, s[16:19], s32 offen offset:2688
  s_mov_b32 s32, 36864
  buffer_load_ushort v128, v8, s[16:19], s32 offen offset:0
  buffer_load_ushort v129, v8, s[16:19], s32 offen offset:384
  buffer_load_ushort v130, v8, s[16:19], s32 offen offset:768
  buffer_load_ushort v131, v8, s[16:19], s32 offen offset:1152
  buffer_load_ushort v132, v8, s[16:19], s32 offen offset:1536
  buffer_load_ushort v133, v8, s[16:19], s32 offen offset:1920
  buffer_load_ushort v134, v8, s[16:19], s32 offen offset:2304
  buffer_load_ushort v135, v8, s[16:19], s32 offen offset:2688
  s_mov_b32 s32, 49152
  buffer_load_ushort v136, v8, s[16:19], s32 offen offset:0
  buffer_load_ushort v137, v8, s[16:19], s32 offen offset:384
  buffer_load_ushort v138, v8, s[16:19], s32 offen offset:768
  buffer_load_ushort v139, v8, s[16:19], s32 offen offset:1152
  buffer_load_ushort v140, v8, s[16:19], s32 offen offset:1536
  buffer_load_ushort v141, v8, s[16:19], s32 offen offset:1920
  buffer_load_ushort v142, v8, s[16:19], s32 offen offset:2304
  buffer_load_ushort v143, v8, s[16:19], s32 offen offset:2688
  s_mov_b32 s32, 61440
  buffer_load_ushort v144, v8, s[16:19], s32 offen offset:0
  buffer_load_ushort v145, v8, s[16:19], s32 offen offset:384
  buffer_load_ushort v146, v8, s[16:19], s32 offen offset:768
  buffer_load_ushort v147, v8, s[16:19], s32 offen offset:1152
  buffer_load_ushort v148, v8, s[16:19], s32 offen offset:1536
  buffer_load_ushort v149, v8, s[16:19], s32 offen offset:1920
  buffer_load_ushort v150, v8, s[16:19], s32 offen offset:2304
  buffer_load_ushort v151, v8, s[16:19], s32 offen offset:2688
  s_mov_b32 s31, 1.0
  s_lshl_b32 s25, s25, 10
  s_add_u32 s25, s25, 73728
PR_go:
  buffer_load_dwordx4 v[16:19], v6, s[12:15], 0 offen offset:0
  buffer_load_dwordx4 v[40:43], v7, s[12:15], 0 offen offset:0
  buffer_load_dwordx4 v[20:23], v6, s[12:15], 0 offen offset:64
  buffer_load_dwordx4 v[44:47], v7, s[12:15], 0 offen offset:64
  buffer_load_dwordx4 v[24:27], v6, s[12:15], 0 offen offset:128
  buffer_load_dwordx4 v[48:51], v7, s[12:15], 0 offen offset:128
  buffer_load_dwordx4 v[28:31], v6, s[12:15], 0 offen offset:192
  buffer_load_dwordx4 v[52:55], v7, s[12:15], 0 offen offset:192
  buffer_load_dwordx4 v[32:35], v6, s[12:15], 0 offen offset:256
  buffer_load_dwordx4 v[56:59], v7, s[12:15], 0 offen offset:256
  buffer_load_dwordx4 v[36:39], v6, s[12:15], 0 offen offset:320
  buffer_load_dwordx4 v[60:63], v7, s[12:15], 0 offen offset:320
  s_waitcnt vmcnt(0)
  s_cmp_eq_u32 s24, 0
  s_cbranch_scc1 PR_mm
  v_lshl_or_b32 v64, v105, 16, v104
  v_lshl_or_b32 v65, v107, 16, v106
  v_lshl_or_b32 v66, v109, 16, v108
  v_lshl_or_b32 v67, v111, 16, v110
  v_lshl_or_b32 v68, v113, 16, v112
  v_lshl_or_b32 v69, v115, 16, v114
  v_lshl_or_b32 v70, v117, 16, v116
  v_lshl_or_b32 v71, v119, 16, v118
  v_lshl_or_b32 v72, v121, 16, v120
  v_lshl_or_b32 v73, v123, 16, v122
  v_lshl_or_b32 v74, v125, 16, v124
  v_lshl_or_b32 v75, v127, 16, v126
  v_lshl_or_b32 v76, v129, 16, v128
  v_lshl_or_b32 v77, v131, 16, v130
  v_lshl_or_b32 v78, v133, 16, v132
  v_lshl_or_b32 v79, v135, 16, v134
  v_lshl_or_b32 v80, v137, 16, v136
  v_lshl_or_b32 v81, v139, 16, v138
  v_lshl_or_b32 v82, v141, 16, v140
  v_lshl_or_b32 v83, v143, 16, v142
  v_lshl_or_b32 v84, v145, 16, v144
  v_lshl_or_b32 v85, v147, 16, v146
  v_lshl_or_b32 v86, v149, 16, v148
  v_lshl_or_b32 v87, v151, 16, v150
  s_nop 1
PR_mm:
  v_mfma_f32_16x16x32_bf16 v[88:91], v[16:19], v[64:67], 0
  v_mfma_f32_16x16x32_bf16 v[92:95], v[40:43], v[64:67], 0
  v_mfma_f32_16x16x32_bf16 v[88:91], v[20:23], v[68:71], v[88:91]
  v_mfma_f32_16x16x32_bf16 v[92:95], v[44:47], v[68:71], v[92:95]
  v_mfma_f32_16x16x32_bf16 v[88:91], v[24:27], v[72:75], v[88:91]
  v_mfma_f32_16x16x32_bf16 v[92:95], v[48:51], v[72:75], v[92:95]
  v_mfma_f32_16x16x32_bf16 v[88:91], v[28:31], v[76:79], v[88:91]
  v_mfma_f32_16x16x32_bf16 v[92:95], v[52:55], v[76:79], v[92:95]
  v_mfma_f32_16x16x32_bf16 v[88:91], v[32:35], v[80:83], v[88:91]
  v_mfma_f32_16x16x32_bf16 v[92:95], v[56:59], v[80:83], v[92:95]
  v_mfma_f32_16x16x32_bf16 v[88:91], v[36:39], v[84:87], v[88:91]
  v_mfma_f32_16x16x32_bf16 v[92:95], v[60:63], v[84:87], v[92:95]
  s_nop 15
  v_mul_f32 v88, s31, v88
  v_mul_f32 v89, s31, v89
  v_mul_f32 v90, s31, v90
  v_mul_f32 v91, s31, v91
  v_mul_f32 v92, s31, v92
  v_mul_f32 v93, s31, v93
  v_mul_f32 v94, s31, v94
  v_mul_f32 v95, s31, v95
  v_cvt_pk_bf16_f32 v96, v88, v89
  v_cvt_pk_bf16_f32 v97, v90, v91
  v_cvt_pk_bf16_f32 v98, v92, v93
  v_cvt_pk_bf16_f32 v99, v94, v95
  v_lshlrev_b32 v9, 4, v0
  buffer_store_dwordx4 v[96:99], v9, s[20:23], s25 offen
PR_done:
  s_endpgm
.globl main_kernel
.p2align 8
.type main_kernel,@function
main_kernel:
  s_cmp_ge_u32 s2, 256
  s_cbranch_scc1 MK_done
  s_load_dwordx2 s[4:5], s[0:1], 0
  s_load_dwordx2 s[6:7], s[0:1], 24
  s_load_dwordx2 s[8:9], s[0:1], 40
  v_lshrrev_b32 v15, 6, v0
  v_and_b32 v0, 63, v0
  v_readfirstlane_b32 s24, v15
  v_lshlrev_b32 v1, 4, v0
  v_add_u32 v2, 36864, v1
  s_and_b32 s46, s2, 7
  s_lshr_b32 s47, s2, 3
  s_lshr_b32 s27, s46, 2
  s_bfe_u32 s28, s46, 0x10001
  s_and_b32 s29, s46, 1
  s_lshl_b32 s29, s29, 2
  s_lshr_b32 s48, s47, 3
  s_add_u32 s29, s29, s48
  s_and_b32 s30, s47, 7
  s_lshr_b32 s25, s24, 1
  s_and_b32 s26, s24, 1
  s_mul_i32 s42, s29, 14
  s_mul_i32 s48, s27, 6
  s_add_i32 s42, s42, s48
  s_add_i32 s42, s42, -6
  s_max_i32 s31, s42, 0
  s_min_i32 s31, s31, 92
  s_mul_i32 s43, s30, 14
  s_mul_i32 s48, s28, 6
  s_add_i32 s43, s43, s48
  s_add_i32 s43, s43, -6
  s_max_i32 s32, s43, 0
  s_min_i32 s32, s32, 92
  s_waitcnt lgkmcnt(0)
  s_mov_b32 s20, s8
  s_and_b32 s21, s9, 0xffff
  s_mov_b32 s22, 147456
  s_mov_b32 s23, 0x00020000
  s_lshl_b32 s49, s24, 10
  s_add_u32 m0, s49, 65536
  s_add_u32 s50, s49, 65536
  buffer_load_dwordx4 v1, s[20:23], s50 offen lds
  s_add_u32 m0, s49, 57344
  s_add_u32 s50, s49, 57344
  buffer_load_dwordx4 v1, s[20:23], s50 offen lds
  s_add_u32 m0, s49, 49152
  s_add_u32 s50, s49, 49152
  buffer_load_dwordx4 v1, s[20:23], s50 offen lds
  s_add_u32 m0, s49, 40960
  s_add_u32 s50, s49, 40960
  buffer_load_dwordx4 v1, s[20:23], s50 offen lds
  s_add_u32 m0, s49, 32768
  s_add_u32 s50, s49, 32768
  buffer_load_dwordx4 v1, s[20:23], s50 offen lds
  s_add_u32 m0, s49, 24576
  s_add_u32 s50, s49, 24576
  buffer_load_dwordx4 v1, s[20:23], s50 offen lds
  s_add_u32 m0, s49, 16384
  s_add_u32 s50, s49, 16384
  buffer_load_dwordx4 v1, s[20:23], s50 offen lds
  s_add_u32 m0, s49, 8192
  s_add_u32 s50, s49, 8192
  buffer_load_dwordx4 v1, s[20:23], s50 offen lds
  s_add_u32 m0, s49, 0
  s_add_u32 s50, s49, 0
  buffer_load_dwordx4 v1, s[20:23], s50 offen lds
  s_mov_b32 s12, s4
  s_and_b32 s13, s5, 0xffff
  s_mov_b32 s14, 19267584
  s_mov_b32 s15, 0x00020000
  v_and_b32 v15, 15, v0
  v_lshrrev_b32 v16, 4, v0
  v_lshrrev_b32 v17, 3, v15
  v_and_b32 v18, 7, v15
  s_mul_i32 s51, s26, 7
  s_add_i32 s51, s51, s43
  v_min_u32 v19, 6, v18
  v_add_u32 v19, s51, v19
  s_movk_i32 s52, 105
  v_med3_i32 v20, v19, 0, s52
  s_add_u32 s53, s28, 6
  v_add3_u32 v19, v19, v20, s53
  v_subrev_u32 v20, s32, v20
  v_mul_u32_u24 v19, 384, v19
  v_lshl_add_u32 v19, v16, 4, v19
  s_lshl_b32 s54, s25, 2
  s_add_u32 s53, s27, 6
  s_mov_b32 s55, 86016
  v_add_u32 v23, s54, v17
  v_min_u32 v3, 13, v23
  v_add_u32 v3, s42, v3
  v_med3_i32 v21, v3, 0, s52
  v_add3_u32 v3, v3, v21, s53
  v_subrev_u32 v21, s31, v21
  v_mad_u32_u24 v3, v3, s55, v19
  buffer_load_dwordx4 v[136:139], v3, s[12:15], 0 offen offset:0
  buffer_load_dwordx4 v[140:143], v3, s[12:15], 0 offen offset:64
  buffer_load_dwordx4 v[144:147], v3, s[12:15], 0 offen offset:128
  buffer_load_dwordx4 v[148:151], v3, s[12:15], 0 offen offset:192
  buffer_load_dwordx4 v[152:155], v3, s[12:15], 0 offen offset:256
  buffer_load_dwordx4 v[156:159], v3, s[12:15], 0 offen offset:320
  v_cmp_gt_u32 vcc, 14, v23
  v_cmp_gt_u32 s[56:57], 7, v18
  s_and_b64 vcc, vcc, s[56:57]
  v_mov_b32 v23, 0x80000000
  s_nop 0
  v_cndmask_b32 v5, v23, v3, vcc
  v_add_u32 v23, s54, v17
  v_add_u32 v23, 2, v23
  v_min_u32 v4, 13, v23
  v_add_u32 v4, s42, v4
  v_med3_i32 v22, v4, 0, s52
  v_add3_u32 v4, v4, v22, s53
  v_subrev_u32 v22, s31, v22
  v_mad_u32_u24 v4, v4, s55, v19
  buffer_load_dwordx4 v[160:163], v4, s[12:15], 0 offen offset:0
  buffer_load_dwordx4 v[164:167], v4, s[12:15], 0 offen offset:64
  buffer_load_dwordx4 v[168:171], v4, s[12:15], 0 offen offset:128
  buffer_load_dwordx4 v[172:175], v4, s[12:15], 0 offen offset:192
  buffer_load_dwordx4 v[176:179], v4, s[12:15], 0 offen offset:256
  buffer_load_dwordx4 v[180:183], v4, s[12:15], 0 offen offset:320
  v_cmp_gt_u32 vcc, 14, v23
  v_cmp_gt_u32 s[56:57], 7, v18
  s_and_b64 vcc, vcc, s[56:57]
  v_mov_b32 v23, 0x80000000
  s_nop 0
  v_cndmask_b32 v6, v23, v4, vcc
  s_lshl_b32 s51, s31, 1
  s_add_u32 s51, s51, s27
  s_mul_i32 s51, s51, 224
  s_lshl_b32 s53, s32, 1
  s_add_u32 s51, s51, s53
  s_add_u32 s51, s51, s28
  s_mul_i32 s33, s51, 384
  s_lshl_b32 s51, s24, 1
  s_add_u32 s53, s51, 1
  s_min_u32 s53, s53, 14
  s_lshl_b32 s44, s51, 10
  s_add_u32 s44, s44, 10240
  s_lshl_b32 s45, s53, 10
  s_add_u32 s45, s45, 10240
  s_lshl_b32 s54, s51, 6
  v_add_u32 v23, s54, v0
  v_mul_u32_u24 v13, 2731, v23
  v_lshrrev_b32 v13, 16, v13
  v_mul_u32_u24 v19, 24, v13
  v_sub_u32 v23, v23, v19
  v_cmp_le_u32 vcc, 20, v13
  v_subrev_u32 v19, 20, v13
  s_nop 0
  v_cndmask_b32 v13, v13, v19, vcc
  v_bfe_u32 v19, v13, 1, 3
  v_xor_b32 v23, v23, v19
  v_mul_u32_u24 v13, 768, v13
  v_lshl_add_u32 v13, v23, 4, v13
  v_add_u32 v19, 172032, v13
  v_cndmask_b32 v13, v13, v19, vcc
  s_lshl_b32 s54, s53, 6
  v_add_u32 v23, s54, v0
  v_mul_u32_u24 v14, 2731, v23
  v_lshrrev_b32 v14, 16, v14
  v_mul_u32_u24 v19, 24, v14
  v_sub_u32 v23, v23, v19
  v_cmp_le_u32 vcc, 20, v14
  v_subrev_u32 v19, 20, v14
  s_nop 0
  v_cndmask_b32 v14, v14, v19, vcc
  v_bfe_u32 v19, v14, 1, 3
  v_xor_b32 v23, v23, v19
  v_mul_u32_u24 v14, 768, v14
  v_lshl_add_u32 v14, v23, 4, v14
  v_add_u32 v19, 172032, v14
  v_cndmask_b32 v14, v14, v19, vcc
  s_add_u32 s50, s33, 3096576
  s_add_u32 m0, s44, 138240
  s_nop 0
  buffer_load_dwordx4 v13, s[12:15], s50 offen lds
  s_add_u32 m0, s45, 138240
  s_nop 0
  buffer_load_dwordx4 v14, s[12:15], s50 offen lds
  s_add_u32 s50, s33, 2752512
  s_add_u32 m0, s44, 122880
  s_nop 0
  buffer_load_dwordx4 v13, s[12:15], s50 offen lds
  s_add_u32 m0, s45, 122880
  s_nop 0
  buffer_load_dwordx4 v14, s[12:15], s50 offen lds
  s_add_u32 s50, s33, 2408448
  s_add_u32 m0, s44, 107520
  s_nop 0
  buffer_load_dwordx4 v13, s[12:15], s50 offen lds
  s_add_u32 m0, s45, 107520
  s_nop 0
  buffer_load_dwordx4 v14, s[12:15], s50 offen lds
  s_add_u32 s50, s33, 2064384
  s_add_u32 m0, s44, 92160
  s_nop 0
  buffer_load_dwordx4 v13, s[12:15], s50 offen lds
  s_add_u32 m0, s45, 92160
  s_nop 0
  buffer_load_dwordx4 v14, s[12:15], s50 offen lds
  s_add_u32 s50, s33, 1720320
  s_add_u32 m0, s44, 76800
  s_nop 0
  buffer_load_dwordx4 v13, s[12:15], s50 offen lds
  s_add_u32 m0, s45, 76800
  s_nop 0
  buffer_load_dwordx4 v14, s[12:15], s50 offen lds
  s_mov_b32 s16, s6
  s_and_b32 s17, s7, 0xffff
  s_mov_b32 s18, 19267584
  s_mov_b32 s19, 0x00020000
  s_lshl_b32 s51, s25, 2
  s_add_u32 s51, s51, 0
  s_min_u32 s51, s51, 13
  s_add_i32 s51, s51, s42
  s_max_i32 s51, s51, 0
  s_min_i32 s51, s51, 105
  s_sub_u32 s51, s51, s31
  s_lshl_b32 s34, s25, 2
  s_add_u32 s34, s34, 2
  s_min_u32 s34, s34, 13
  s_add_i32 s34, s34, s42
  s_max_i32 s34, s34, 0
  s_min_i32 s34, s34, 105
  s_sub_u32 s34, s34, s31
  s_sub_u32 s51, s34, s51
  s_cmp_eq_u32 s51, 2
  s_cselect_b32 s38, -2, 6
  s_cmp_ge_u32 s34, 1
  s_cselect_b32 s39, -1, 7
  s_cmp_le_u32 s34, 12
  s_cselect_b32 s40, 7, -1
  s_add_i32 s35, s34, s38
  s_mul_i32 s38, s38, 7680
  s_add_i32 s36, s34, s39
  s_mul_i32 s39, s39, 7680
  s_add_i32 s37, s34, s40
  s_mul_i32 s40, s40, 7680
  s_mul_i32 s51, s26, 7
  s_add_i32 s51, s51, s43
  s_max_i32 s51, s51, 0
  s_min_i32 s51, s51, 105
  s_sub_u32 s51, s51, s32
  s_cmp_ge_u32 s51, 4
  s_cselect_b32 s41, 4, 0
  s_mul_i32 s51, s34, 7680
  s_add_u32 s51, s51, 10240
  v_add_u32 v19, s41, v15
  v_bfe_u32 v23, v19, 1, 3
  v_xor_b32 v23, v23, v16
  v_mul_u32_u24 v19, 384, v19
  v_lshl_add_u32 v19, v23, 4, v19
  v_add_u32 v7, s51, v19
  v_xor_b32 v8, 64, v7
  v_lshrrev_b32 v19, 2, v15
  v_lshl_add_u32 v19, v16, 2, v19
  v_add_u32 v19, s41, v19
  v_bfe_u32 v23, v19, 1, 3
  v_and_b32 v10, 2, v15
  v_lshlrev_b32 v10, 1, v10
  v_xor_b32 v23, v23, v10
  v_mul_u32_u24 v19, 384, v19
  v_lshl_add_u32 v19, v23, 4, v19
  v_and_b32 v23, 1, v15
  v_lshl_add_u32 v19, v23, 3, v19
  v_add_u32 v9, s51, v19
  v_xor_b32 v10, 16, v9
  v_xor_b32 v11, 32, v9
  v_xor_b32 v12, 48, v9
  v_mov_b32 v220, 0xff800000
  v_lshl_add_u32 v19, v16, 2, s41
  v_sub_u32 v19, v19, v20
  v_add_u32 v23, 0, v19
  v_cmp_gt_u32 vcc, 7, v23
  s_nop 1
  v_cndmask_b32 v216, v220, 0, vcc
  v_add_u32 v23, 1, v19
  v_cmp_gt_u32 vcc, 7, v23
  s_nop 1
  v_cndmask_b32 v217, v220, 0, vcc
  v_add_u32 v23, 2, v19
  v_cmp_gt_u32 vcc, 7, v23
  s_nop 1
  v_cndmask_b32 v218, v220, 0, vcc
  v_add_u32 v23, 3, v19
  v_cmp_gt_u32 vcc, 7, v23
  s_nop 1
  v_cndmask_b32 v219, v220, 0, vcc
  v_sub_u32 v23, s35, v21
  v_cmp_gt_u32 vcc, 7, v23
  s_nop 1
  v_cndmask_b32 v24, v220, v216, vcc
  v_cndmask_b32 v25, v220, v217, vcc
  v_cndmask_b32 v26, v220, v218, vcc
  v_cndmask_b32 v27, v220, v219, vcc
  v_sub_u32 v23, s36, v21
  v_cmp_gt_u32 vcc, 7, v23
  s_nop 1
  v_cndmask_b32 v28, v220, v216, vcc
  v_cndmask_b32 v29, v220, v217, vcc
  v_cndmask_b32 v30, v220, v218, vcc
  v_cndmask_b32 v31, v220, v219, vcc
  v_sub_u32 v23, s34, v21
  v_cmp_gt_u32 vcc, 7, v23
  s_nop 1
  v_cndmask_b32 v32, v220, v216, vcc
  v_cndmask_b32 v33, v220, v217, vcc
  v_cndmask_b32 v34, v220, v218, vcc
  v_cndmask_b32 v35, v220, v219, vcc
  v_sub_u32 v23, s34, v21
  v_add_u32 v23, 1, v23
  v_cmp_gt_u32 vcc, 7, v23
  s_nop 1
  v_cndmask_b32 v36, v220, v216, vcc
  v_cndmask_b32 v37, v220, v217, vcc
  v_cndmask_b32 v38, v220, v218, vcc
  v_cndmask_b32 v39, v220, v219, vcc
  v_sub_u32 v23, s34, v21
  v_add_u32 v23, 2, v23
  v_cmp_gt_u32 vcc, 7, v23
  s_nop 1
  v_cndmask_b32 v40, v220, v216, vcc
  v_cndmask_b32 v41, v220, v217, vcc
  v_cndmask_b32 v42, v220, v218, vcc
  v_cndmask_b32 v43, v220, v219, vcc
  v_sub_u32 v23, s34, v21
  v_add_u32 v23, 3, v23
  v_cmp_gt_u32 vcc, 7, v23
  s_nop 1
  v_cndmask_b32 v44, v220, v216, vcc
  v_cndmask_b32 v45, v220, v217, vcc
  v_cndmask_b32 v46, v220, v218, vcc
  v_cndmask_b32 v47, v220, v219, vcc
  v_sub_u32 v23, s34, v21
  v_add_u32 v23, 4, v23
  v_cmp_gt_u32 vcc, 7, v23
  s_nop 1
  v_cndmask_b32 v48, v220, v216, vcc
  v_cndmask_b32 v49, v220, v217, vcc
  v_cndmask_b32 v50, v220, v218, vcc
  v_cndmask_b32 v51, v220, v219, vcc
  v_sub_u32 v23, s34, v21
  v_add_u32 v23, 5, v23
  v_cmp_gt_u32 vcc, 7, v23
  s_nop 1
  v_cndmask_b32 v52, v220, v216, vcc
  v_cndmask_b32 v53, v220, v217, vcc
  v_cndmask_b32 v54, v220, v218, vcc
  v_cndmask_b32 v55, v220, v219, vcc
  v_sub_u32 v23, s34, v22
  v_cmp_gt_u32 vcc, 7, v23
  s_nop 1
  v_cndmask_b32 v56, v220, v216, vcc
  v_cndmask_b32 v57, v220, v217, vcc
  v_cndmask_b32 v58, v220, v218, vcc
  v_cndmask_b32 v59, v220, v219, vcc
  v_sub_u32 v23, s34, v22
  v_add_u32 v23, 1, v23
  v_cmp_gt_u32 vcc, 7, v23
  s_nop 1
  v_cndmask_b32 v60, v220, v216, vcc
  v_cndmask_b32 v61, v220, v217, vcc
  v_cndmask_b32 v62, v220, v218, vcc
  v_cndmask_b32 v63, v220, v219, vcc
  v_sub_u32 v23, s34, v22
  v_add_u32 v23, 2, v23
  v_cmp_gt_u32 vcc, 7, v23
  s_nop 1
  v_cndmask_b32 v64, v220, v216, vcc
  v_cndmask_b32 v65, v220, v217, vcc
  v_cndmask_b32 v66, v220, v218, vcc
  v_cndmask_b32 v67, v220, v219, vcc
  v_sub_u32 v23, s34, v22
  v_add_u32 v23, 3, v23
  v_cmp_gt_u32 vcc, 7, v23
  s_nop 1
  v_cndmask_b32 v68, v220, v216, vcc
  v_cndmask_b32 v69, v220, v217, vcc
  v_cndmask_b32 v70, v220, v218, vcc
  v_cndmask_b32 v71, v220, v219, vcc
  v_sub_u32 v23, s34, v22
  v_add_u32 v23, 4, v23
  v_cmp_gt_u32 vcc, 7, v23
  s_nop 1
  v_cndmask_b32 v72, v220, v216, vcc
  v_cndmask_b32 v73, v220, v217, vcc
  v_cndmask_b32 v74, v220, v218, vcc
  v_cndmask_b32 v75, v220, v219, vcc
  v_sub_u32 v23, s34, v22
  v_add_u32 v23, 5, v23
  v_cmp_gt_u32 vcc, 7, v23
  s_nop 1
  v_cndmask_b32 v76, v220, v216, vcc
  v_cndmask_b32 v77, v220, v217, vcc
  v_cndmask_b32 v78, v220, v218, vcc
  v_cndmask_b32 v79, v220, v219, vcc
  v_sub_u32 v23, s34, v22
  v_add_u32 v23, 6, v23
  v_cmp_gt_u32 vcc, 7, v23
  s_nop 1
  v_cndmask_b32 v80, v220, v216, vcc
  v_cndmask_b32 v81, v220, v217, vcc
  v_cndmask_b32 v82, v220, v218, vcc
  v_cndmask_b32 v83, v220, v219, vcc
  v_sub_u32 v23, s37, v22
  v_cmp_gt_u32 vcc, 7, v23
  s_nop 1
  v_cndmask_b32 v84, v220, v216, vcc
  v_cndmask_b32 v85, v220, v217, vcc
  v_cndmask_b32 v86, v220, v218, vcc
  v_cndmask_b32 v87, v220, v219, vcc
  v_add_u32 v15, s40, v7
  v_add_u32 v16, s40, v8
  v_add_u32 v17, s39, v7
  v_add_u32 v18, s39, v8
  v_add_u32 v19, s38, v7
  v_add_u32 v20, s38, v8
  s_waitcnt vmcnt(10)
  s_barrier
  ds_read_b128 v[216:219], v2 offset:35840
  ds_read_b128 v[220:223], v2 offset:34816
  ds_read_b128 v[224:227], v2 offset:33792
  ds_read_b128 v[228:231], v2 offset:32768
  ds_read_b128 v[232:235], v2 offset:31744
  ds_read_b128 v[236:239], v2 offset:30720
  ds_read_b128 v[240:243], v2 offset:29696
  ds_read_b128 v[244:247], v2 offset:28672
  ds_read_b128 v[248:251], v2 offset:27648
  ds_read_b128 v[252:255], v2 offset:26624
  s_waitcnt lgkmcnt(8)
  v_mfma_f32_16x16x32_bf16 v[184:187], v[216:219], v[136:139], 0
  v_mfma_f32_16x16x32_bf16 v[192:195], v[216:219], v[160:163], 0
  ds_read_b128 v[216:219], v2 offset:25600
  v_mfma_f32_16x16x32_bf16 v[188:191], v[220:223], v[136:139], 0
  v_mfma_f32_16x16x32_bf16 v[196:199], v[220:223], v[160:163], 0
  ds_read_b128 v[220:223], v2 offset:24576
  s_waitcnt lgkmcnt(8)
  v_mfma_f32_16x16x32_bf16 v[184:187], v[224:227], v[140:143], v[184:187]
  v_mfma_f32_16x16x32_bf16 v[192:195], v[224:227], v[164:167], v[192:195]
  ds_read_b128 v[224:227], v2 offset:23552
  v_mfma_f32_16x16x32_bf16 v[188:191], v[228:231], v[140:143], v[188:191]
  v_mfma_f32_16x16x32_bf16 v[196:199], v[228:231], v[164:167], v[196:199]
  ds_read_b128 v[228:231], v2 offset:22528
  s_waitcnt lgkmcnt(8)
  v_mfma_f32_16x16x32_bf16 v[184:187], v[232:235], v[144:147], v[184:187]
  v_mfma_f32_16x16x32_bf16 v[192:195], v[232:235], v[168:171], v[192:195]
  ds_read_b128 v[232:235], v2 offset:21504
  v_mfma_f32_16x16x32_bf16 v[188:191], v[236:239], v[144:147], v[188:191]
  v_mfma_f32_16x16x32_bf16 v[196:199], v[236:239], v[168:171], v[196:199]
  ds_read_b128 v[236:239], v2 offset:20480
  s_waitcnt lgkmcnt(8)
  v_mfma_f32_16x16x32_bf16 v[184:187], v[240:243], v[148:151], v[184:187]
  v_mfma_f32_16x16x32_bf16 v[192:195], v[240:243], v[172:175], v[192:195]
  ds_read_b128 v[240:243], v2 offset:19456
  v_mfma_f32_16x16x32_bf16 v[188:191], v[244:247], v[148:151], v[188:191]
  v_mfma_f32_16x16x32_bf16 v[196:199], v[244:247], v[172:175], v[196:199]
  ds_read_b128 v[244:247], v2 offset:18432
  s_waitcnt lgkmcnt(8)
  v_mfma_f32_16x16x32_bf16 v[184:187], v[248:251], v[152:155], v[184:187]
  v_mfma_f32_16x16x32_bf16 v[192:195], v[248:251], v[176:179], v[192:195]
  ds_read_b128 v[248:251], v2 offset:17408
  v_mfma_f32_16x16x32_bf16 v[188:191], v[252:255], v[152:155], v[188:191]
  v_mfma_f32_16x16x32_bf16 v[196:199], v[252:255], v[176:179], v[196:199]
  ds_read_b128 v[252:255], v2 offset:16384
  s_waitcnt lgkmcnt(8)
  v_mfma_f32_16x16x32_bf16 v[184:187], v[216:219], v[156:159], v[184:187]
  v_mfma_f32_16x16x32_bf16 v[192:195], v[216:219], v[180:183], v[192:195]
  ds_read_b128 v[216:219], v2 offset:15360
  v_mfma_f32_16x16x32_bf16 v[188:191], v[220:223], v[156:159], v[188:191]
  v_mfma_f32_16x16x32_bf16 v[196:199], v[220:223], v[180:183], v[196:199]
  ds_read_b128 v[220:223], v2 offset:14336
  s_waitcnt lgkmcnt(8)
  v_mfma_f32_16x16x32_bf16 v[200:203], v[224:227], v[136:139], 0
  v_mfma_f32_16x16x32_bf16 v[208:211], v[224:227], v[160:163], 0
  ds_read_b128 v[224:227], v2 offset:13312
  v_mfma_f32_16x16x32_bf16 v[204:207], v[228:231], v[136:139], 0
  v_mfma_f32_16x16x32_bf16 v[212:215], v[228:231], v[160:163], 0
  ds_read_b128 v[228:231], v2 offset:12288
  s_waitcnt lgkmcnt(8)
  v_mfma_f32_16x16x32_bf16 v[200:203], v[232:235], v[140:143], v[200:203]
  v_mfma_f32_16x16x32_bf16 v[208:211], v[232:235], v[164:167], v[208:211]
  ds_read_b128 v[232:235], v2 offset:11264
  v_cvt_pk_bf16_f32 v88, v184, v185
  v_cvt_pk_bf16_f32 v89, v186, v187
  v_mfma_f32_16x16x32_bf16 v[204:207], v[236:239], v[140:143], v[204:207]
  v_mfma_f32_16x16x32_bf16 v[212:215], v[236:239], v[164:167], v[212:215]
  ds_read_b128 v[236:239], v2 offset:10240
  v_cvt_pk_bf16_f32 v90, v188, v189
  v_cvt_pk_bf16_f32 v91, v190, v191
  s_waitcnt lgkmcnt(8)
  v_mfma_f32_16x16x32_bf16 v[200:203], v[240:243], v[144:147], v[200:203]
  v_mfma_f32_16x16x32_bf16 v[208:211], v[240:243], v[168:171], v[208:211]
  ds_read_b128 v[240:243], v2 offset:9216
  v_cvt_pk_bf16_f32 v112, v192, v193
  v_cvt_pk_bf16_f32 v113, v194, v195
  s_barrier
  s_add_u32 s50, s33, 1376256
  s_add_u32 m0, s44, 61440
  s_nop 0
  buffer_load_dwordx4 v13, s[12:15], s50 offen lds
  s_add_u32 m0, s45, 61440
  s_nop 0
  buffer_load_dwordx4 v14, s[12:15], s50 offen lds
  s_add_u32 s50, s33, 1032192
  s_add_u32 m0, s44, 46080
  s_nop 0
  buffer_load_dwordx4 v13, s[12:15], s50 offen lds
  s_add_u32 m0, s45, 46080
  s_nop 0
  buffer_load_dwordx4 v14, s[12:15], s50 offen lds
  v_mfma_f32_16x16x32_bf16 v[204:207], v[244:247], v[144:147], v[204:207]
  v_mfma_f32_16x16x32_bf16 v[212:215], v[244:247], v[168:171], v[212:215]
  ds_read_b128 v[244:247], v2 offset:8192
  v_cvt_pk_bf16_f32 v114, v196, v197
  v_cvt_pk_bf16_f32 v115, v198, v199
  s_waitcnt lgkmcnt(8)
  v_mfma_f32_16x16x32_bf16 v[200:203], v[248:251], v[148:151], v[200:203]
  v_mfma_f32_16x16x32_bf16 v[208:211], v[248:251], v[172:175], v[208:211]
  ds_read_b128 v[248:251], v2 offset:7168
  v_mfma_f32_16x16x32_bf16 v[204:207], v[252:255], v[148:151], v[204:207]
  v_mfma_f32_16x16x32_bf16 v[212:215], v[252:255], v[172:175], v[212:215]
  ds_read_b128 v[252:255], v2 offset:6144
  s_waitcnt lgkmcnt(8)
  v_mfma_f32_16x16x32_bf16 v[200:203], v[216:219], v[152:155], v[200:203]
  v_mfma_f32_16x16x32_bf16 v[208:211], v[216:219], v[176:179], v[208:211]
  ds_read_b128 v[216:219], v2 offset:5120
  v_mfma_f32_16x16x32_bf16 v[204:207], v[220:223], v[152:155], v[204:207]
  v_mfma_f32_16x16x32_bf16 v[212:215], v[220:223], v[176:179], v[212:215]
  ds_read_b128 v[220:223], v2 offset:4096
  s_waitcnt lgkmcnt(8)
  v_mfma_f32_16x16x32_bf16 v[200:203], v[224:227], v[156:159], v[200:203]
  v_mfma_f32_16x16x32_bf16 v[208:211], v[224:227], v[180:183], v[208:211]
  ds_read_b128 v[224:227], v2 offset:3072
  v_mfma_f32_16x16x32_bf16 v[204:207], v[228:231], v[156:159], v[204:207]
  v_mfma_f32_16x16x32_bf16 v[212:215], v[228:231], v[180:183], v[212:215]
  ds_read_b128 v[228:231], v2 offset:2048
  s_waitcnt lgkmcnt(8)
  v_mfma_f32_16x16x32_bf16 v[184:187], v[232:235], v[136:139], 0
  v_mfma_f32_16x16x32_bf16 v[192:195], v[232:235], v[160:163], 0
  ds_read_b128 v[232:235], v2 offset:1024
  v_mfma_f32_16x16x32_bf16 v[188:191], v[236:239], v[136:139], 0
  v_mfma_f32_16x16x32_bf16 v[196:199], v[236:239], v[160:163], 0
  ds_read_b128 v[236:239], v2 offset:0
  s_waitcnt lgkmcnt(8)
  v_mfma_f32_16x16x32_bf16 v[184:187], v[240:243], v[140:143], v[184:187]
  v_mfma_f32_16x16x32_bf16 v[192:195], v[240:243], v[164:167], v[192:195]
  ds_read_b128 v[240:243], v1 offset:35840
  v_cvt_pk_bf16_f32 v92, v200, v201
  v_cvt_pk_bf16_f32 v93, v202, v203
  v_mfma_f32_16x16x32_bf16 v[188:191], v[244:247], v[140:143], v[188:191]
  v_mfma_f32_16x16x32_bf16 v[196:199], v[244:247], v[164:167], v[196:199]
  ds_read_b128 v[244:247], v1 offset:34816
  v_cvt_pk_bf16_f32 v94, v204, v205
  v_cvt_pk_bf16_f32 v95, v206, v207
  s_waitcnt lgkmcnt(8)
  v_mfma_f32_16x16x32_bf16 v[184:187], v[248:251], v[144:147], v[184:187]
  v_mfma_f32_16x16x32_bf16 v[192:195], v[248:251], v[168:171], v[192:195]
  ds_read_b128 v[248:251], v1 offset:33792
  v_cvt_pk_bf16_f32 v116, v208, v209
  v_cvt_pk_bf16_f32 v117, v210, v211
  v_mfma_f32_16x16x32_bf16 v[188:191], v[252:255], v[144:147], v[188:191]
  v_mfma_f32_16x16x32_bf16 v[196:199], v[252:255], v[168:171], v[196:199]
  ds_read_b128 v[252:255], v1 offset:32768
  v_cvt_pk_bf16_f32 v118, v212, v213
  v_cvt_pk_bf16_f32 v119, v214, v215
  s_waitcnt lgkmcnt(8)
  v_mfma_f32_16x16x32_bf16 v[184:187], v[216:219], v[148:151], v[184:187]
  v_mfma_f32_16x16x32_bf16 v[192:195], v[216:219], v[172:175], v[192:195]
  ds_read_b128 v[216:219], v1 offset:31744
  s_barrier
  s_add_u32 s50, s33, 688128
  s_add_u32 m0, s44, 30720
  s_nop 0
  buffer_load_dwordx4 v13, s[12:15], s50 offen lds
  s_add_u32 m0, s45, 30720
  s_nop 0
  buffer_load_dwordx4 v14, s[12:15], s50 offen lds
  v_mfma_f32_16x16x32_bf16 v[188:191], v[220:223], v[148:151], v[188:191]
  v_mfma_f32_16x16x32_bf16 v[196:199], v[220:223], v[172:175], v[196:199]
  ds_read_b128 v[220:223], v1 offset:30720
  s_waitcnt lgkmcnt(8)
  v_mfma_f32_16x16x32_bf16 v[184:187], v[224:227], v[152:155], v[184:187]
  v_mfma_f32_16x16x32_bf16 v[192:195], v[224:227], v[176:179], v[192:195]
  ds_read_b128 v[224:227], v1 offset:29696
  v_mfma_f32_16x16x32_bf16 v[188:191], v[228:231], v[152:155], v[188:191]
  v_mfma_f32_16x16x32_bf16 v[196:199], v[228:231], v[176:179], v[196:199]
  ds_read_b128 v[228:231], v1 offset:28672
  s_waitcnt lgkmcnt(8)
  v_mfma_f32_16x16x32_bf16 v[184:187], v[232:235], v[156:159], v[184:187]
  v_mfma_f32_16x16x32_bf16 v[192:195], v[232:235], v[180:183], v[192:195]
  ds_read_b128 v[232:235], v1 offset:27648
  v_mfma_f32_16x16x32_bf16 v[188:191], v[236:239], v[156:159], v[188:191]
  v_mfma_f32_16x16x32_bf16 v[196:199], v[236:239], v[180:183], v[196:199]
  ds_read_b128 v[236:239], v1 offset:26624
  s_waitcnt lgkmcnt(8)
  v_mfma_f32_16x16x32_bf16 v[200:203], v[240:243], v[136:139], 0
  v_mfma_f32_16x16x32_bf16 v[208:211], v[240:243], v[160:163], 0
  ds_read_b128 v[240:243], v1 offset:25600
  v_mfma_f32_16x16x32_bf16 v[204:207], v[244:247], v[136:139], 0
  v_mfma_f32_16x16x32_bf16 v[212:215], v[244:247], v[160:163], 0
  ds_read_b128 v[244:247], v1 offset:24576
  s_waitcnt lgkmcnt(8)
  v_mfma_f32_16x16x32_bf16 v[200:203], v[248:251], v[140:143], v[200:203]
  v_mfma_f32_16x16x32_bf16 v[208:211], v[248:251], v[164:167], v[208:211]
  ds_read_b128 v[248:251], v1 offset:23552
  v_cvt_pk_bf16_f32 v96, v184, v185
  v_cvt_pk_bf16_f32 v97, v186, v187
  v_mfma_f32_16x16x32_bf16 v[204:207], v[252:255], v[140:143], v[204:207]
  v_mfma_f32_16x16x32_bf16 v[212:215], v[252:255], v[164:167], v[212:215]
  ds_read_b128 v[252:255], v1 offset:22528
  v_cvt_pk_bf16_f32 v98, v188, v189
  v_cvt_pk_bf16_f32 v99, v190, v191
  s_waitcnt lgkmcnt(8)
  v_mfma_f32_16x16x32_bf16 v[200:203], v[216:219], v[144:147], v[200:203]
  v_mfma_f32_16x16x32_bf16 v[208:211], v[216:219], v[168:171], v[208:211]
  ds_read_b128 v[216:219], v1 offset:21504
  v_cvt_pk_bf16_f32 v120, v192, v193
  v_cvt_pk_bf16_f32 v121, v194, v195
  v_mfma_f32_16x16x32_bf16 v[204:207], v[220:223], v[144:147], v[204:207]
  v_mfma_f32_16x16x32_bf16 v[212:215], v[220:223], v[168:171], v[212:215]
  ds_read_b128 v[220:223], v1 offset:20480
  v_cvt_pk_bf16_f32 v122, v196, v197
  v_cvt_pk_bf16_f32 v123, v198, v199
  s_waitcnt lgkmcnt(8)
  v_mfma_f32_16x16x32_bf16 v[200:203], v[224:227], v[148:151], v[200:203]
  v_mfma_f32_16x16x32_bf16 v[208:211], v[224:227], v[172:175], v[208:211]
  ds_read_b128 v[224:227], v1 offset:19456
  v_mfma_f32_16x16x32_bf16 v[204:207], v[228:231], v[148:151], v[204:207]
  v_mfma_f32_16x16x32_bf16 v[212:215], v[228:231], v[172:175], v[212:215]
  ds_read_b128 v[228:231], v1 offset:18432
  s_waitcnt lgkmcnt(8)
  v_mfma_f32_16x16x32_bf16 v[200:203], v[232:235], v[152:155], v[200:203]
  v_mfma_f32_16x16x32_bf16 v[208:211], v[232:235], v[176:179], v[208:211]
  ds_read_b128 v[232:235], v1 offset:17408
  v_mfma_f32_16x16x32_bf16 v[204:207], v[236:239], v[152:155], v[204:207]
  v_mfma_f32_16x16x32_bf16 v[212:215], v[236:239], v[176:179], v[212:215]
  ds_read_b128 v[236:239], v1 offset:16384
  s_waitcnt lgkmcnt(8)
  v_mfma_f32_16x16x32_bf16 v[200:203], v[240:243], v[156:159], v[200:203]
  v_mfma_f32_16x16x32_bf16 v[208:211], v[240:243], v[180:183], v[208:211]
  ds_read_b128 v[240:243], v1 offset:15360
  s_barrier
  s_add_u32 s50, s33, 344064
  s_add_u32 m0, s44, 15360
  s_nop 0
  buffer_load_dwordx4 v13, s[12:15], s50 offen lds
  s_add_u32 m0, s45, 15360
  s_nop 0
  buffer_load_dwordx4 v14, s[12:15], s50 offen lds
  v_mfma_f32_16x16x32_bf16 v[204:207], v[244:247], v[156:159], v[204:207]
  v_mfma_f32_16x16x32_bf16 v[212:215], v[244:247], v[180:183], v[212:215]
  ds_read_b128 v[244:247], v1 offset:14336
  s_waitcnt lgkmcnt(8)
  v_mfma_f32_16x16x32_bf16 v[184:187], v[248:251], v[136:139], 0
  v_mfma_f32_16x16x32_bf16 v[192:195], v[248:251], v[160:163], 0
  ds_read_b128 v[248:251], v1 offset:13312
  v_mfma_f32_16x16x32_bf16 v[188:191], v[252:255], v[136:139], 0
  v_mfma_f32_16x16x32_bf16 v[196:199], v[252:255], v[160:163], 0
  ds_read_b128 v[252:255], v1 offset:12288
  s_waitcnt lgkmcnt(8)
  v_mfma_f32_16x16x32_bf16 v[184:187], v[216:219], v[140:143], v[184:187]
  v_mfma_f32_16x16x32_bf16 v[192:195], v[216:219], v[164:167], v[192:195]
  ds_read_b128 v[216:219], v1 offset:11264
  v_cvt_pk_bf16_f32 v100, v200, v201
  v_cvt_pk_bf16_f32 v101, v202, v203
  v_mfma_f32_16x16x32_bf16 v[188:191], v[220:223], v[140:143], v[188:191]
  v_mfma_f32_16x16x32_bf16 v[196:199], v[220:223], v[164:167], v[196:199]
  ds_read_b128 v[220:223], v1 offset:10240
  v_cvt_pk_bf16_f32 v102, v204, v205
  v_cvt_pk_bf16_f32 v103, v206, v207
  s_waitcnt lgkmcnt(8)
  v_mfma_f32_16x16x32_bf16 v[184:187], v[224:227], v[144:147], v[184:187]
  v_mfma_f32_16x16x32_bf16 v[192:195], v[224:227], v[168:171], v[192:195]
  ds_read_b128 v[224:227], v1 offset:9216
  v_cvt_pk_bf16_f32 v124, v208, v209
  v_cvt_pk_bf16_f32 v125, v210, v211
  v_mfma_f32_16x16x32_bf16 v[188:191], v[228:231], v[144:147], v[188:191]
  v_mfma_f32_16x16x32_bf16 v[196:199], v[228:231], v[168:171], v[196:199]
  ds_read_b128 v[228:231], v1 offset:8192
  v_cvt_pk_bf16_f32 v126, v212, v213
  v_cvt_pk_bf16_f32 v127, v214, v215
  s_waitcnt lgkmcnt(8)
  v_mfma_f32_16x16x32_bf16 v[184:187], v[232:235], v[148:151], v[184:187]
  v_mfma_f32_16x16x32_bf16 v[192:195], v[232:235], v[172:175], v[192:195]
  ds_read_b128 v[232:235], v1 offset:7168
  v_mfma_f32_16x16x32_bf16 v[188:191], v[236:239], v[148:151], v[188:191]
  v_mfma_f32_16x16x32_bf16 v[196:199], v[236:239], v[172:175], v[196:199]
  ds_read_b128 v[236:239], v1 offset:6144
  s_waitcnt lgkmcnt(8)
  v_mfma_f32_16x16x32_bf16 v[184:187], v[240:243], v[152:155], v[184:187]
  v_mfma_f32_16x16x32_bf16 v[192:195], v[240:243], v[176:179], v[192:195]
  ds_read_b128 v[240:243], v1 offset:5120
  v_mfma_f32_16x16x32_bf16 v[188:191], v[244:247], v[152:155], v[188:191]
  v_mfma_f32_16x16x32_bf16 v[196:199], v[244:247], v[176:179], v[196:199]
  ds_read_b128 v[244:247], v1 offset:4096
  s_waitcnt lgkmcnt(8)
  v_mfma_f32_16x16x32_bf16 v[184:187], v[248:251], v[156:159], v[184:187]
  v_mfma_f32_16x16x32_bf16 v[192:195], v[248:251], v[180:183], v[192:195]
  ds_read_b128 v[248:251], v1 offset:3072
  v_mfma_f32_16x16x32_bf16 v[188:191], v[252:255], v[156:159], v[188:191]
  v_mfma_f32_16x16x32_bf16 v[196:199], v[252:255], v[180:183], v[196:199]
  ds_read_b128 v[252:255], v1 offset:2048
  s_waitcnt lgkmcnt(8)
  v_mfma_f32_16x16x32_bf16 v[200:203], v[216:219], v[136:139], 0
  v_mfma_f32_16x16x32_bf16 v[208:211], v[216:219], v[160:163], 0
  ds_read_b128 v[216:219], v1 offset:1024
  s_barrier
  s_add_u32 s50, s33, 0
  s_add_u32 m0, s44, 0
  s_nop 0
  buffer_load_dwordx4 v13, s[12:15], s50 offen lds
  s_add_u32 m0, s45, 0
  s_nop 0
  buffer_load_dwordx4 v14, s[12:15], s50 offen lds
  v_mfma_f32_16x16x32_bf16 v[204:207], v[220:223], v[136:139], 0
  v_mfma_f32_16x16x32_bf16 v[212:215], v[220:223], v[160:163], 0
  ds_read_b128 v[220:223], v1 offset:0
  s_waitcnt lgkmcnt(8)
  v_mfma_f32_16x16x32_bf16 v[200:203], v[224:227], v[140:143], v[200:203]
  v_mfma_f32_16x16x32_bf16 v[208:211], v[224:227], v[164:167], v[208:211]
  v_cvt_pk_bf16_f32 v104, v184, v185
  v_cvt_pk_bf16_f32 v105, v186, v187
  v_mfma_f32_16x16x32_bf16 v[204:207], v[228:231], v[140:143], v[204:207]
  v_mfma_f32_16x16x32_bf16 v[212:215], v[228:231], v[164:167], v[212:215]
  v_cvt_pk_bf16_f32 v106, v188, v189
  v_cvt_pk_bf16_f32 v107, v190, v191
  s_waitcnt lgkmcnt(6)
  v_mfma_f32_16x16x32_bf16 v[200:203], v[232:235], v[144:147], v[200:203]
  v_mfma_f32_16x16x32_bf16 v[208:211], v[232:235], v[168:171], v[208:211]
  v_cvt_pk_bf16_f32 v128, v192, v193
  v_cvt_pk_bf16_f32 v129, v194, v195
  v_mfma_f32_16x16x32_bf16 v[204:207], v[236:239], v[144:147], v[204:207]
  v_mfma_f32_16x16x32_bf16 v[212:215], v[236:239], v[168:171], v[212:215]
  v_cvt_pk_bf16_f32 v130, v196, v197
  v_cvt_pk_bf16_f32 v131, v198, v199
  s_waitcnt lgkmcnt(4)
  v_mfma_f32_16x16x32_bf16 v[200:203], v[240:243], v[148:151], v[200:203]
  v_mfma_f32_16x16x32_bf16 v[208:211], v[240:243], v[172:175], v[208:211]
  v_mfma_f32_16x16x32_bf16 v[204:207], v[244:247], v[148:151], v[204:207]
  v_mfma_f32_16x16x32_bf16 v[212:215], v[244:247], v[172:175], v[212:215]
  s_waitcnt lgkmcnt(3)
  v_mfma_f32_16x16x32_bf16 v[200:203], v[248:251], v[152:155], v[200:203]
  v_mfma_f32_16x16x32_bf16 v[208:211], v[248:251], v[176:179], v[208:211]
  s_waitcnt lgkmcnt(2)
  v_mfma_f32_16x16x32_bf16 v[204:207], v[252:255], v[152:155], v[204:207]
  v_mfma_f32_16x16x32_bf16 v[212:215], v[252:255], v[176:179], v[212:215]
  s_waitcnt lgkmcnt(1)
  v_mfma_f32_16x16x32_bf16 v[200:203], v[216:219], v[156:159], v[200:203]
  v_mfma_f32_16x16x32_bf16 v[208:211], v[216:219], v[180:183], v[208:211]
  s_waitcnt lgkmcnt(0)
  v_mfma_f32_16x16x32_bf16 v[204:207], v[220:223], v[156:159], v[204:207]
  v_mfma_f32_16x16x32_bf16 v[212:215], v[220:223], v[180:183], v[212:215]
  s_nop 7
  v_cvt_pk_bf16_f32 v108, v200, v201
  v_cvt_pk_bf16_f32 v109, v202, v203
  v_cvt_pk_bf16_f32 v110, v204, v205
  v_cvt_pk_bf16_f32 v111, v206, v207
  v_cvt_pk_bf16_f32 v132, v208, v209
  v_cvt_pk_bf16_f32 v133, v210, v211
  v_cvt_pk_bf16_f32 v134, v212, v213
  v_cvt_pk_bf16_f32 v135, v214, v215
  s_waitcnt vmcnt(2)
  s_barrier
  ds_read_b128 v[224:227], v15 offset:0
  ds_read_b128 v[228:231], v16 offset:0
  ds_read_b128 v[232:235], v15 offset:128
  ds_read_b128 v[236:239], v16 offset:128
  ds_read_b128 v[240:243], v15 offset:256
  ds_read_b128 v[244:247], v16 offset:256
  ds_read_b128 v[248:251], v7 offset:46080
  ds_read_b128 v[252:255], v8 offset:46080
  ds_read_b128 v[216:219], v7 offset:46208
  ds_read_b128 v[220:223], v8 offset:46208
  s_add_u32 m0, s49, 0
  s_add_u32 s50, s49, 73728
  buffer_load_dwordx4 v1, s[20:23], s50 offen lds
  s_waitcnt lgkmcnt(8)
  v_mfma_f32_16x16x32_bf16 v[84:87], v[224:227], v[112:115], v[84:87]
  ds_read_b128 v[224:227], v7 offset:46336
  v_mfma_f32_16x16x32_bf16 v[84:87], v[228:231], v[116:119], v[84:87]
  ds_read_b128 v[228:231], v8 offset:46336
  s_waitcnt lgkmcnt(8)
  v_mfma_f32_16x16x32_bf16 v[84:87], v[232:235], v[120:123], v[84:87]
  ds_read_b128 v[232:235], v7 offset:38400
  v_mfma_f32_16x16x32_bf16 v[84:87], v[236:239], v[124:127], v[84:87]
  ds_read_b128 v[236:239], v8 offset:38400
  s_waitcnt lgkmcnt(8)
  v_mfma_f32_16x16x32_bf16 v[84:87], v[240:243], v[128:131], v[84:87]
  ds_read_b128 v[240:243], v7 offset:38528
  v_mfma_f32_16x16x32_bf16 v[84:87], v[244:247], v[132:135], v[84:87]
  ds_read_b128 v[244:247], v8 offset:38528
  s_waitcnt lgkmcnt(8)
  v_mfma_f32_16x16x32_bf16 v[80:83], v[248:251], v[112:115], v[80:83]
  ds_read_b128 v[248:251], v7 offset:38656
  v_mfma_f32_16x16x32_bf16 v[80:83], v[252:255], v[116:119], v[80:83]
  ds_read_b128 v[252:255], v8 offset:38656
  s_waitcnt lgkmcnt(8)
  v_mfma_f32_16x16x32_bf16 v[80:83], v[216:219], v[120:123], v[80:83]
  ds_read_b128 v[216:219], v7 offset:30720
  v_mfma_f32_16x16x32_bf16 v[80:83], v[220:223], v[124:127], v[80:83]
  ds_read_b128 v[220:223], v8 offset:30720
  s_waitcnt lgkmcnt(8)
  v_mfma_f32_16x16x32_bf16 v[80:83], v[224:227], v[128:131], v[80:83]
  ds_read_b128 v[224:227], v7 offset:30848
  v_mfma_f32_16x16x32_bf16 v[80:83], v[228:231], v[132:135], v[80:83]
  ds_read_b128 v[228:231], v8 offset:30848
  s_waitcnt lgkmcnt(8)
  v_mfma_f32_16x16x32_bf16 v[52:55], v[232:235], v[88:91], v[52:55]
  v_mfma_f32_16x16x32_bf16 v[76:79], v[232:235], v[112:115], v[76:79]
  ds_read_b128 v[232:235], v7 offset:30976
  v_mfma_f32_16x16x32_bf16 v[52:55], v[236:239], v[92:95], v[52:55]
  v_mfma_f32_16x16x32_bf16 v[76:79], v[236:239], v[116:119], v[76:79]
  ds_read_b128 v[236:239], v8 offset:30976
  s_waitcnt lgkmcnt(8)
  v_mfma_f32_16x16x32_bf16 v[52:55], v[240:243], v[96:99], v[52:55]
  v_mfma_f32_16x16x32_bf16 v[76:79], v[240:243], v[120:123], v[76:79]
  ds_read_b128 v[240:243], v7 offset:23040
  v_mfma_f32_16x16x32_bf16 v[52:55], v[244:247], v[100:103], v[52:55]
  v_mfma_f32_16x16x32_bf16 v[76:79], v[244:247], v[124:127], v[76:79]
  ds_read_b128 v[244:247], v8 offset:23040
  s_waitcnt lgkmcnt(8)
  v_mfma_f32_16x16x32_bf16 v[52:55], v[248:251], v[104:107], v[52:55]
  v_mfma_f32_16x16x32_bf16 v[76:79], v[248:251], v[128:131], v[76:79]
  ds_read_b128 v[248:251], v7 offset:23168
  v_mfma_f32_16x16x32_bf16 v[52:55], v[252:255], v[108:111], v[52:55]
  v_mfma_f32_16x16x32_bf16 v[76:79], v[252:255], v[132:135], v[76:79]
  ds_read_b128 v[252:255], v8 offset:23168
  s_waitcnt lgkmcnt(8)
  v_mfma_f32_16x16x32_bf16 v[48:51], v[216:219], v[88:91], v[48:51]
  v_mfma_f32_16x16x32_bf16 v[72:75], v[216:219], v[112:115], v[72:75]
  ds_read_b128 v[216:219], v7 offset:23296
  v_mfma_f32_16x16x32_bf16 v[48:51], v[220:223], v[92:95], v[48:51]
  v_mfma_f32_16x16x32_bf16 v[72:75], v[220:223], v[116:119], v[72:75]
  ds_read_b128 v[220:223], v8 offset:23296
  s_waitcnt lgkmcnt(8)
  v_mfma_f32_16x16x32_bf16 v[48:51], v[224:227], v[96:99], v[48:51]
  v_mfma_f32_16x16x32_bf16 v[72:75], v[224:227], v[120:123], v[72:75]
  ds_read_b128 v[224:227], v7 offset:15360
  v_mfma_f32_16x16x32_bf16 v[48:51], v[228:231], v[100:103], v[48:51]
  v_mfma_f32_16x16x32_bf16 v[72:75], v[228:231], v[124:127], v[72:75]
  ds_read_b128 v[228:231], v8 offset:15360
  s_waitcnt lgkmcnt(8)
  v_mfma_f32_16x16x32_bf16 v[48:51], v[232:235], v[104:107], v[48:51]
  v_mfma_f32_16x16x32_bf16 v[72:75], v[232:235], v[128:131], v[72:75]
  ds_read_b128 v[232:235], v7 offset:15488
  v_mfma_f32_16x16x32_bf16 v[48:51], v[236:239], v[108:111], v[48:51]
  v_mfma_f32_16x16x32_bf16 v[72:75], v[236:239], v[132:135], v[72:75]
  ds_read_b128 v[236:239], v8 offset:15488
  s_waitcnt lgkmcnt(8)
  v_mfma_f32_16x16x32_bf16 v[44:47], v[240:243], v[88:91], v[44:47]
  v_mfma_f32_16x16x32_bf16 v[68:71], v[240:243], v[112:115], v[68:71]
  ds_read_b128 v[240:243], v7 offset:15616
  v_mfma_f32_16x16x32_bf16 v[44:47], v[244:247], v[92:95], v[44:47]
  v_mfma_f32_16x16x32_bf16 v[68:71], v[244:247], v[116:119], v[68:71]
  ds_read_b128 v[244:247], v8 offset:15616
  s_waitcnt lgkmcnt(8)
  v_mfma_f32_16x16x32_bf16 v[44:47], v[248:251], v[96:99], v[44:47]
  v_mfma_f32_16x16x32_bf16 v[68:71], v[248:251], v[120:123], v[68:71]
  v_mfma_f32_16x16x32_bf16 v[44:47], v[252:255], v[100:103], v[44:47]
  v_mfma_f32_16x16x32_bf16 v[68:71], v[252:255], v[124:127], v[68:71]
  s_waitcnt lgkmcnt(6)
  v_mfma_f32_16x16x32_bf16 v[44:47], v[216:219], v[104:107], v[44:47]
  v_mfma_f32_16x16x32_bf16 v[68:71], v[216:219], v[128:131], v[68:71]
  v_mfma_f32_16x16x32_bf16 v[44:47], v[220:223], v[108:111], v[44:47]
  v_mfma_f32_16x16x32_bf16 v[68:71], v[220:223], v[132:135], v[68:71]
  s_waitcnt lgkmcnt(4)
  v_mfma_f32_16x16x32_bf16 v[40:43], v[224:227], v[88:91], v[40:43]
  v_mfma_f32_16x16x32_bf16 v[64:67], v[224:227], v[112:115], v[64:67]
  v_mfma_f32_16x16x32_bf16 v[40:43], v[228:231], v[92:95], v[40:43]
  v_mfma_f32_16x16x32_bf16 v[64:67], v[228:231], v[116:119], v[64:67]
  s_waitcnt lgkmcnt(3)
  v_mfma_f32_16x16x32_bf16 v[40:43], v[232:235], v[96:99], v[40:43]
  v_mfma_f32_16x16x32_bf16 v[64:67], v[232:235], v[120:123], v[64:67]
  s_waitcnt lgkmcnt(2)
  v_mfma_f32_16x16x32_bf16 v[40:43], v[236:239], v[100:103], v[40:43]
  v_mfma_f32_16x16x32_bf16 v[64:67], v[236:239], v[124:127], v[64:67]
  s_waitcnt lgkmcnt(1)
  v_mfma_f32_16x16x32_bf16 v[40:43], v[240:243], v[104:107], v[40:43]
  v_mfma_f32_16x16x32_bf16 v[64:67], v[240:243], v[128:131], v[64:67]
  s_waitcnt lgkmcnt(0)
  v_mfma_f32_16x16x32_bf16 v[40:43], v[244:247], v[108:111], v[40:43]
  v_mfma_f32_16x16x32_bf16 v[64:67], v[244:247], v[132:135], v[64:67]
  s_waitcnt vmcnt(1)
  s_barrier
  ds_read_b128 v[248:251], v7 offset:7680
  ds_read_b128 v[252:255], v8 offset:7680
  ds_read_b128 v[216:219], v7 offset:7808
  ds_read_b128 v[220:223], v8 offset:7808
  ds_read_b128 v[224:227], v7 offset:7936
  ds_read_b128 v[228:231], v8 offset:7936
  ds_read_b128 v[232:235], v7 offset:0
  ds_read_b128 v[236:239], v8 offset:0
  ds_read_b128 v[240:243], v7 offset:128
  ds_read_b128 v[244:247], v8 offset:128
  s_waitcnt lgkmcnt(8)
  v_mfma_f32_16x16x32_bf16 v[36:39], v[248:251], v[88:91], v[36:39]
  v_mfma_f32_16x16x32_bf16 v[60:63], v[248:251], v[112:115], v[60:63]
  ds_read_b128 v[248:251], v7 offset:256
  v_mfma_f32_16x16x32_bf16 v[36:39], v[252:255], v[92:95], v[36:39]
  v_mfma_f32_16x16x32_bf16 v[60:63], v[252:255], v[116:119], v[60:63]
  ds_read_b128 v[252:255], v8 offset:256
  s_waitcnt lgkmcnt(8)
  v_mfma_f32_16x16x32_bf16 v[36:39], v[216:219], v[96:99], v[36:39]
  v_mfma_f32_16x16x32_bf16 v[60:63], v[216:219], v[120:123], v[60:63]
  ds_read_b128 v[216:219], v17 offset:0
  v_mfma_f32_16x16x32_bf16 v[36:39], v[220:223], v[100:103], v[36:39]
  v_mfma_f32_16x16x32_bf16 v[60:63], v[220:223], v[124:127], v[60:63]
  ds_read_b128 v[220:223], v18 offset:0
  s_waitcnt lgkmcnt(8)
  v_mfma_f32_16x16x32_bf16 v[36:39], v[224:227], v[104:107], v[36:39]
  v_mfma_f32_16x16x32_bf16 v[60:63], v[224:227], v[128:131], v[60:63]
  ds_read_b128 v[224:227], v17 offset:128
  v_mfma_f32_16x16x32_bf16 v[36:39], v[228:231], v[108:111], v[36:39]
  v_mfma_f32_16x16x32_bf16 v[60:63], v[228:231], v[132:135], v[60:63]
  ds_read_b128 v[228:231], v18 offset:128
  s_waitcnt lgkmcnt(8)
  v_mfma_f32_16x16x32_bf16 v[32:35], v[232:235], v[88:91], v[32:35]
  v_mfma_f32_16x16x32_bf16 v[56:59], v[232:235], v[112:115], v[56:59]
  ds_read_b128 v[232:235], v17 offset:256
  v_mfma_f32_16x16x32_bf16 v[32:35], v[236:239], v[92:95], v[32:35]
  v_mfma_f32_16x16x32_bf16 v[56:59], v[236:239], v[116:119], v[56:59]
  ds_read_b128 v[236:239], v18 offset:256
  s_waitcnt lgkmcnt(8)
  v_mfma_f32_16x16x32_bf16 v[32:35], v[240:243], v[96:99], v[32:35]
  v_mfma_f32_16x16x32_bf16 v[56:59], v[240:243], v[120:123], v[56:59]
  ds_read_b128 v[240:243], v19 offset:0
  v_mfma_f32_16x16x32_bf16 v[32:35], v[244:247], v[100:103], v[32:35]
  v_mfma_f32_16x16x32_bf16 v[56:59], v[244:247], v[124:127], v[56:59]
  ds_read_b128 v[244:247], v20 offset:0
  s_waitcnt lgkmcnt(8)
  v_mfma_f32_16x16x32_bf16 v[32:35], v[248:251], v[104:107], v[32:35]
  v_mfma_f32_16x16x32_bf16 v[56:59], v[248:251], v[128:131], v[56:59]
  ds_read_b128 v[248:251], v19 offset:128
  v_mfma_f32_16x16x32_bf16 v[32:35], v[252:255], v[108:111], v[32:35]
  v_mfma_f32_16x16x32_bf16 v[56:59], v[252:255], v[132:135], v[56:59]
  ds_read_b128 v[252:255], v20 offset:128
  s_waitcnt lgkmcnt(8)
  v_mfma_f32_16x16x32_bf16 v[28:31], v[216:219], v[88:91], v[28:31]
  ds_read_b128 v[216:219], v19 offset:256
  v_mfma_f32_16x16x32_bf16 v[28:31], v[220:223], v[92:95], v[28:31]
  ds_read_b128 v[220:223], v20 offset:256
  s_waitcnt lgkmcnt(8)
  v_mfma_f32_16x16x32_bf16 v[28:31], v[224:227], v[96:99], v[28:31]
  v_mfma_f32_16x16x32_bf16 v[28:31], v[228:231], v[100:103], v[28:31]
  s_waitcnt lgkmcnt(6)
  v_mfma_f32_16x16x32_bf16 v[28:31], v[232:235], v[104:107], v[28:31]
  v_mfma_f32_16x16x32_bf16 v[28:31], v[236:239], v[108:111], v[28:31]
  s_waitcnt lgkmcnt(4)
  v_mfma_f32_16x16x32_bf16 v[24:27], v[240:243], v[88:91], v[24:27]
  v_mfma_f32_16x16x32_bf16 v[24:27], v[244:247], v[92:95], v[24:27]
  s_waitcnt lgkmcnt(3)
  v_mfma_f32_16x16x32_bf16 v[24:27], v[248:251], v[96:99], v[24:27]
  s_waitcnt lgkmcnt(2)
  v_mfma_f32_16x16x32_bf16 v[24:27], v[252:255], v[100:103], v[24:27]
  s_waitcnt lgkmcnt(1)
  v_mfma_f32_16x16x32_bf16 v[24:27], v[216:219], v[104:107], v[24:27]
  s_waitcnt lgkmcnt(0)
  v_mfma_f32_16x16x32_bf16 v[24:27], v[220:223], v[108:111], v[24:27]
  v_add_u32 v15, s38, v9
  v_add_u32 v19, s39, v9
  v_add_u32 v16, s38, v10
  v_add_u32 v20, s39, v10
  v_add_u32 v17, s38, v11
  v_add_u32 v21, s39, v11
  v_add_u32 v18, s38, v12
  v_add_u32 v22, s39, v12
  ds_read_b64_tr_b16 v[224:225], v15 offset:0
  ds_read_b64_tr_b16 v[226:227], v19 offset:0
  ds_read_b64_tr_b16 v[228:229], v16 offset:0
  ds_read_b64_tr_b16 v[230:231], v20 offset:0
  ds_read_b64_tr_b16 v[232:233], v17 offset:0
  ds_read_b64_tr_b16 v[234:235], v21 offset:0
  ds_read_b64_tr_b16 v[236:237], v18 offset:0
  ds_read_b64_tr_b16 v[238:239], v22 offset:0
  ds_read_b64_tr_b16 v[240:241], v15 offset:128
  ds_read_b64_tr_b16 v[242:243], v19 offset:128
  ds_read_b64_tr_b16 v[244:245], v16 offset:128
  ds_read_b64_tr_b16 v[246:247], v20 offset:128
  ds_read_b64_tr_b16 v[248:249], v17 offset:128
  ds_read_b64_tr_b16 v[250:251], v21 offset:128
  s_nop 7
  v_max3_f32 v196, v56, v57, v58
  v_max3_f32 v192, v24, v25, v26
  v_max3_f32 v198, v59, v60, v61
  v_max3_f32 v194, v27, v28, v29
  v_max3_f32 v196, v196, v62, v63
  v_max3_f32 v192, v192, v30, v31
  v_max3_f32 v198, v198, v64, v65
  v_max3_f32 v194, v194, v32, v33
  v_max3_f32 v196, v196, v66, v67
  v_max3_f32 v192, v192, v34, v35
  v_max3_f32 v198, v198, v68, v69
  v_max3_f32 v194, v194, v36, v37
  v_max3_f32 v196, v196, v70, v71
  v_max3_f32 v192, v192, v38, v39
  v_max3_f32 v198, v198, v72, v73
  v_max3_f32 v194, v194, v40, v41
  v_max3_f32 v196, v196, v74, v75
  v_max3_f32 v192, v192, v42, v43
  v_max3_f32 v198, v198, v76, v77
  v_max3_f32 v194, v194, v44, v45
  v_max3_f32 v196, v196, v78, v79
  v_max3_f32 v192, v192, v46, v47
  v_max3_f32 v198, v198, v80, v81
  v_max3_f32 v194, v194, v48, v49
  v_max3_f32 v196, v196, v82, v83
  v_max3_f32 v192, v192, v50, v51
  v_max3_f32 v198, v198, v84, v85
  v_max3_f32 v194, v194, v52, v53
  v_max3_f32 v196, v196, v86, v87
  v_max3_f32 v192, v192, v54, v55
  v_max_f32 v196, v196, v198
  v_max_f32 v192, v192, v194
  v_mov_b32 v193, v192
  v_mov_b32 v197, v196
  s_nop 1
  v_permlane32_swap_b32 v192, v193
  v_permlane32_swap_b32 v196, v197
  s_nop 1
  v_max_f32 v192, v192, v193
  v_max_f32 v196, v196, v197
  v_mov_b32 v193, v192
  v_mov_b32 v197, v196
  s_nop 1
  v_permlane16_swap_b32 v192, v193
  v_permlane16_swap_b32 v196, v197
  s_nop 1
  v_max_f32 v192, v192, v193
  v_max_f32 v196, v196, v197
  v_mov_b32 v188, 0x3f803f80
  v_mov_b32 v189, 0x3f803f80
  v_mov_b32 v190, 0x3f803f80
  v_mov_b32 v191, 0x3f803f80
  v_sub_f32 v24, v24, v192
  v_sub_f32 v25, v25, v192
  v_sub_f32 v26, v26, v192
  v_sub_f32 v27, v27, v192
  v_exp_f32 v24, v24
  v_exp_f32 v25, v25
  v_exp_f32 v26, v26
  v_exp_f32 v27, v27
  v_sub_f32 v28, v28, v192
  v_sub_f32 v29, v29, v192
  v_sub_f32 v30, v30, v192
  v_sub_f32 v31, v31, v192
  v_exp_f32 v28, v28
  v_exp_f32 v29, v29
  v_exp_f32 v30, v30
  v_exp_f32 v31, v31
  v_cvt_pk_bf16_f32 v88, v24, v25
  v_cvt_pk_bf16_f32 v89, v26, v27
  v_sub_f32 v32, v32, v192
  v_sub_f32 v33, v33, v192
  v_sub_f32 v34, v34, v192
  v_sub_f32 v35, v35, v192
  v_exp_f32 v32, v32
  v_exp_f32 v33, v33
  v_exp_f32 v34, v34
  v_exp_f32 v35, v35
  v_cvt_pk_bf16_f32 v90, v28, v29
  v_cvt_pk_bf16_f32 v91, v30, v31
  v_sub_f32 v36, v36, v192
  v_sub_f32 v37, v37, v192
  v_sub_f32 v38, v38, v192
  v_sub_f32 v39, v39, v192
  v_exp_f32 v36, v36
  v_exp_f32 v37, v37
  v_exp_f32 v38, v38
  v_exp_f32 v39, v39
  v_cvt_pk_bf16_f32 v92, v32, v33
  v_cvt_pk_bf16_f32 v93, v34, v35
  v_sub_f32 v40, v40, v192
  v_sub_f32 v41, v41, v192
  v_sub_f32 v42, v42, v192
  v_sub_f32 v43, v43, v192
  v_exp_f32 v40, v40
  v_exp_f32 v41, v41
  v_exp_f32 v42, v42
  v_exp_f32 v43, v43
  v_cvt_pk_bf16_f32 v94, v36, v37
  v_cvt_pk_bf16_f32 v95, v38, v39
  v_sub_f32 v44, v44, v192
  v_sub_f32 v45, v45, v192
  v_sub_f32 v46, v46, v192
  v_sub_f32 v47, v47, v192
  v_exp_f32 v44, v44
  v_exp_f32 v45, v45
  v_exp_f32 v46, v46
  v_exp_f32 v47, v47
  v_cvt_pk_bf16_f32 v96, v40, v41
  v_cvt_pk_bf16_f32 v97, v42, v43
  v_sub_f32 v48, v48, v192
  v_sub_f32 v49, v49, v192
  v_sub_f32 v50, v50, v192
  v_sub_f32 v51, v51, v192
  v_exp_f32 v48, v48
  v_exp_f32 v49, v49
  v_exp_f32 v50, v50
  v_exp_f32 v51, v51
  v_cvt_pk_bf16_f32 v98, v44, v45
  v_cvt_pk_bf16_f32 v99, v46, v47
  v_sub_f32 v52, v52, v192
  v_sub_f32 v53, v53, v192
  v_sub_f32 v54, v54, v192
  v_sub_f32 v55, v55, v192
  v_exp_f32 v52, v52
  v_exp_f32 v53, v53
  v_exp_f32 v54, v54
  v_exp_f32 v55, v55
  v_cvt_pk_bf16_f32 v100, v48, v49
  v_cvt_pk_bf16_f32 v101, v50, v51
  s_nop 0
  v_cvt_pk_bf16_f32 v102, v52, v53
  v_cvt_pk_bf16_f32 v103, v54, v55
  v_sub_f32 v56, v56, v196
  v_sub_f32 v57, v57, v196
  v_sub_f32 v58, v58, v196
  v_sub_f32 v59, v59, v196
  v_exp_f32 v56, v56
  v_exp_f32 v57, v57
  v_exp_f32 v58, v58
  v_exp_f32 v59, v59
  v_sub_f32 v60, v60, v196
  v_sub_f32 v61, v61, v196
  v_sub_f32 v62, v62, v196
  v_sub_f32 v63, v63, v196
  v_exp_f32 v60, v60
  v_exp_f32 v61, v61
  v_exp_f32 v62, v62
  v_exp_f32 v63, v63
  v_cvt_pk_bf16_f32 v104, v56, v57
  v_cvt_pk_bf16_f32 v105, v58, v59
  v_sub_f32 v64, v64, v196
  v_sub_f32 v65, v65, v196
  v_sub_f32 v66, v66, v196
  v_sub_f32 v67, v67, v196
  v_exp_f32 v64, v64
  v_exp_f32 v65, v65
  v_exp_f32 v66, v66
  v_exp_f32 v67, v67
  v_cvt_pk_bf16_f32 v106, v60, v61
  v_cvt_pk_bf16_f32 v107, v62, v63
  v_sub_f32 v68, v68, v196
  v_sub_f32 v69, v69, v196
  v_sub_f32 v70, v70, v196
  v_sub_f32 v71, v71, v196
  v_exp_f32 v68, v68
  v_exp_f32 v69, v69
  v_exp_f32 v70, v70
  v_exp_f32 v71, v71
  v_cvt_pk_bf16_f32 v108, v64, v65
  v_cvt_pk_bf16_f32 v109, v66, v67
  v_sub_f32 v72, v72, v196
  v_sub_f32 v73, v73, v196
  v_sub_f32 v74, v74, v196
  v_sub_f32 v75, v75, v196
  v_exp_f32 v72, v72
  v_exp_f32 v73, v73
  v_exp_f32 v74, v74
  v_exp_f32 v75, v75
  v_cvt_pk_bf16_f32 v110, v68, v69
  v_cvt_pk_bf16_f32 v111, v70, v71
  v_sub_f32 v76, v76, v196
  v_sub_f32 v77, v77, v196
  v_sub_f32 v78, v78, v196
  v_sub_f32 v79, v79, v196
  v_exp_f32 v76, v76
  v_exp_f32 v77, v77
  v_exp_f32 v78, v78
  v_exp_f32 v79, v79
  v_cvt_pk_bf16_f32 v112, v72, v73
  v_cvt_pk_bf16_f32 v113, v74, v75
  v_sub_f32 v80, v80, v196
  v_sub_f32 v81, v81, v196
  v_sub_f32 v82, v82, v196
  v_sub_f32 v83, v83, v196
  v_exp_f32 v80, v80
  v_exp_f32 v81, v81
  v_exp_f32 v82, v82
  v_exp_f32 v83, v83
  v_cvt_pk_bf16_f32 v114, v76, v77
  v_cvt_pk_bf16_f32 v115, v78, v79
  v_sub_f32 v84, v84, v196
  v_sub_f32 v85, v85, v196
  v_sub_f32 v86, v86, v196
  v_sub_f32 v87, v87, v196
  v_exp_f32 v84, v84
  v_exp_f32 v85, v85
  v_exp_f32 v86, v86
  v_exp_f32 v87, v87
  v_cvt_pk_bf16_f32 v116, v80, v81
  v_cvt_pk_bf16_f32 v117, v82, v83
  s_nop 0
  v_cvt_pk_bf16_f32 v118, v84, v85
  v_cvt_pk_bf16_f32 v119, v86, v87
  s_nop 1
  s_waitcnt lgkmcnt(10)
  v_mfma_f32_16x16x32_bf16 v[136:139], v[224:227], v[88:91], 0
  ds_read_b64_tr_b16 v[252:253], v18 offset:128
  ds_read_b64_tr_b16 v[254:255], v22 offset:128
  ds_read_b64_tr_b16 v[216:217], v15 offset:256
  ds_read_b64_tr_b16 v[218:219], v19 offset:256
  v_mfma_f32_16x16x32_bf16 v[140:143], v[228:231], v[88:91], 0
  s_waitcnt lgkmcnt(10)
  v_mfma_f32_16x16x32_bf16 v[144:147], v[232:235], v[88:91], 0
  ds_read_b64_tr_b16 v[220:221], v16 offset:256
  ds_read_b64_tr_b16 v[222:223], v20 offset:256
  ds_read_b64_tr_b16 v[224:225], v17 offset:256
  ds_read_b64_tr_b16 v[226:227], v21 offset:256
  v_mfma_f32_16x16x32_bf16 v[148:151], v[236:239], v[88:91], 0
  s_waitcnt lgkmcnt(10)
  v_mfma_f32_16x16x32_bf16 v[152:155], v[240:243], v[88:91], 0
  ds_read_b64_tr_b16 v[228:229], v18 offset:256
  ds_read_b64_tr_b16 v[230:231], v22 offset:256
  ds_read_b64_tr_b16 v[232:233], v9 offset:0
  ds_read_b64_tr_b16 v[234:235], v9 offset:7680
  v_mfma_f32_16x16x32_bf16 v[156:159], v[244:247], v[88:91], 0
  s_waitcnt lgkmcnt(10)
  v_mfma_f32_16x16x32_bf16 v[160:163], v[248:251], v[88:91], 0
  ds_read_b64_tr_b16 v[236:237], v10 offset:0
  ds_read_b64_tr_b16 v[238:239], v10 offset:7680
  ds_read_b64_tr_b16 v[240:241], v11 offset:0
  ds_read_b64_tr_b16 v[242:243], v11 offset:7680
  v_mfma_f32_16x16x32_bf16 v[164:167], v[252:255], v[88:91], 0
  s_waitcnt lgkmcnt(10)
  v_mfma_f32_16x16x32_bf16 v[168:171], v[216:219], v[88:91], 0
  ds_read_b64_tr_b16 v[244:245], v12 offset:0
  ds_read_b64_tr_b16 v[246:247], v12 offset:7680
  ds_read_b64_tr_b16 v[248:249], v9 offset:128
  ds_read_b64_tr_b16 v[250:251], v9 offset:7808
  v_mfma_f32_16x16x32_bf16 v[172:175], v[220:223], v[88:91], 0
  s_waitcnt lgkmcnt(10)
  v_mfma_f32_16x16x32_bf16 v[176:179], v[224:227], v[88:91], 0
  ds_read_b64_tr_b16 v[252:253], v10 offset:128
  ds_read_b64_tr_b16 v[254:255], v10 offset:7808
  ds_read_b64_tr_b16 v[216:217], v11 offset:128
  ds_read_b64_tr_b16 v[218:219], v11 offset:7808
  v_mfma_f32_16x16x32_bf16 v[180:183], v[228:231], v[88:91], 0
  v_mfma_f32_16x16x32_bf16 v[184:187], v[188:191], v[88:91], 0
  v_add_u32 v15, s40, v9
  v_add_u32 v16, s40, v10
  v_add_u32 v17, s40, v11
  v_add_u32 v18, s40, v12
  s_waitcnt lgkmcnt(10)
  v_mfma_f32_16x16x32_bf16 v[136:139], v[232:235], v[92:95], v[136:139]
  ds_read_b64_tr_b16 v[220:221], v12 offset:128
  ds_read_b64_tr_b16 v[222:223], v12 offset:7808
  ds_read_b64_tr_b16 v[224:225], v9 offset:256
  ds_read_b64_tr_b16 v[226:227], v9 offset:7936
  v_mfma_f32_16x16x32_bf16 v[24:27], v[232:235], v[104:107], 0
  v_mfma_f32_16x16x32_bf16 v[140:143], v[236:239], v[92:95], v[140:143]
  v_mfma_f32_16x16x32_bf16 v[28:31], v[236:239], v[104:107], 0
  s_waitcnt lgkmcnt(10)
  v_mfma_f32_16x16x32_bf16 v[144:147], v[240:243], v[92:95], v[144:147]
  ds_read_b64_tr_b16 v[228:229], v10 offset:256
  ds_read_b64_tr_b16 v[230:231], v10 offset:7936
  ds_read_b64_tr_b16 v[232:233], v11 offset:256
  ds_read_b64_tr_b16 v[234:235], v11 offset:7936
  v_mfma_f32_16x16x32_bf16 v[32:35], v[240:243], v[104:107], 0
  v_mfma_f32_16x16x32_bf16 v[148:151], v[244:247], v[92:95], v[148:151]
  v_mfma_f32_16x16x32_bf16 v[36:39], v[244:247], v[104:107], 0
  s_waitcnt lgkmcnt(10)
  v_mfma_f32_16x16x32_bf16 v[152:155], v[248:251], v[92:95], v[152:155]
  ds_read_b64_tr_b16 v[236:237], v12 offset:256
  ds_read_b64_tr_b16 v[238:239], v12 offset:7936
  ds_read_b64_tr_b16 v[240:241], v9 offset:15360
  ds_read_b64_tr_b16 v[242:243], v9 offset:23040
  v_mfma_f32_16x16x32_bf16 v[40:43], v[248:251], v[104:107], 0
  v_mfma_f32_16x16x32_bf16 v[156:159], v[252:255], v[92:95], v[156:159]
  v_mfma_f32_16x16x32_bf16 v[44:47], v[252:255], v[104:107], 0
  s_waitcnt lgkmcnt(10)
  v_mfma_f32_16x16x32_bf16 v[160:163], v[216:219], v[92:95], v[160:163]
  ds_read_b64_tr_b16 v[244:245], v10 offset:15360
  ds_read_b64_tr_b16 v[246:247], v10 offset:23040
  ds_read_b64_tr_b16 v[248:249], v11 offset:15360
  ds_read_b64_tr_b16 v[250:251], v11 offset:23040
  v_mfma_f32_16x16x32_bf16 v[48:51], v[216:219], v[104:107], 0
  v_mfma_f32_16x16x32_bf16 v[164:167], v[220:223], v[92:95], v[164:167]
  v_mfma_f32_16x16x32_bf16 v[52:55], v[220:223], v[104:107], 0
  s_waitcnt lgkmcnt(10)
  v_mfma_f32_16x16x32_bf16 v[168:171], v[224:227], v[92:95], v[168:171]
  ds_read_b64_tr_b16 v[252:253], v12 offset:15360
  ds_read_b64_tr_b16 v[254:255], v12 offset:23040
  ds_read_b64_tr_b16 v[216:217], v9 offset:15488
  ds_read_b64_tr_b16 v[218:219], v9 offset:23168
  v_mfma_f32_16x16x32_bf16 v[56:59], v[224:227], v[104:107], 0
  v_mfma_f32_16x16x32_bf16 v[172:175], v[228:231], v[92:95], v[172:175]
  v_mfma_f32_16x16x32_bf16 v[60:63], v[228:231], v[104:107], 0
  s_waitcnt lgkmcnt(10)
  v_mfma_f32_16x16x32_bf16 v[176:179], v[232:235], v[92:95], v[176:179]
  ds_read_b64_tr_b16 v[220:221], v10 offset:15488
  ds_read_b64_tr_b16 v[222:223], v10 offset:23168
  ds_read_b64_tr_b16 v[224:225], v11 offset:15488
  ds_read_b64_tr_b16 v[226:227], v11 offset:23168
  v_mfma_f32_16x16x32_bf16 v[64:67], v[232:235], v[104:107], 0
  v_mfma_f32_16x16x32_bf16 v[180:183], v[236:239], v[92:95], v[180:183]
  v_mfma_f32_16x16x32_bf16 v[68:71], v[236:239], v[104:107], 0
  v_mfma_f32_16x16x32_bf16 v[184:187], v[188:191], v[92:95], v[184:187]
  v_mfma_f32_16x16x32_bf16 v[72:75], v[188:191], v[104:107], 0
  s_waitcnt lgkmcnt(10)
  v_mfma_f32_16x16x32_bf16 v[136:139], v[240:243], v[96:99], v[136:139]
  ds_read_b64_tr_b16 v[228:229], v12 offset:15488
  ds_read_b64_tr_b16 v[230:231], v12 offset:23168
  ds_read_b64_tr_b16 v[232:233], v9 offset:15616
  ds_read_b64_tr_b16 v[234:235], v9 offset:23296
  v_mfma_f32_16x16x32_bf16 v[24:27], v[240:243], v[108:111], v[24:27]
  v_mfma_f32_16x16x32_bf16 v[140:143], v[244:247], v[96:99], v[140:143]
  v_mfma_f32_16x16x32_bf16 v[28:31], v[244:247], v[108:111], v[28:31]
  s_waitcnt lgkmcnt(10)
  v_mfma_f32_16x16x32_bf16 v[144:147], v[248:251], v[96:99], v[144:147]
  ds_read_b64_tr_b16 v[236:237], v10 offset:15616
  ds_read_b64_tr_b16 v[238:239], v10 offset:23296
  ds_read_b64_tr_b16 v[240:241], v11 offset:15616
  ds_read_b64_tr_b16 v[242:243], v11 offset:23296
  v_mfma_f32_16x16x32_bf16 v[32:35], v[248:251], v[108:111], v[32:35]
  v_mfma_f32_16x16x32_bf16 v[148:151], v[252:255], v[96:99], v[148:151]
  v_mfma_f32_16x16x32_bf16 v[36:39], v[252:255], v[108:111], v[36:39]
  s_waitcnt lgkmcnt(10)
  v_mfma_f32_16x16x32_bf16 v[152:155], v[216:219], v[96:99], v[152:155]
  ds_read_b64_tr_b16 v[244:245], v12 offset:15616
  ds_read_b64_tr_b16 v[246:247], v12 offset:23296
  ds_read_b64_tr_b16 v[248:249], v9 offset:30720
  ds_read_b64_tr_b16 v[250:251], v9 offset:38400
  v_mfma_f32_16x16x32_bf16 v[40:43], v[216:219], v[108:111], v[40:43]
  v_mfma_f32_16x16x32_bf16 v[156:159], v[220:223], v[96:99], v[156:159]
  v_mfma_f32_16x16x32_bf16 v[44:47], v[220:223], v[108:111], v[44:47]
  s_waitcnt lgkmcnt(10)
  v_mfma_f32_16x16x32_bf16 v[160:163], v[224:227], v[96:99], v[160:163]
  ds_read_b64_tr_b16 v[252:253], v10 offset:30720
  ds_read_b64_tr_b16 v[254:255], v10 offset:38400
  ds_read_b64_tr_b16 v[216:217], v11 offset:30720
  ds_read_b64_tr_b16 v[218:219], v11 offset:38400
  v_mfma_f32_16x16x32_bf16 v[48:51], v[224:227], v[108:111], v[48:51]
  v_mfma_f32_16x16x32_bf16 v[164:167], v[228:231], v[96:99], v[164:167]
  v_mfma_f32_16x16x32_bf16 v[52:55], v[228:231], v[108:111], v[52:55]
  s_waitcnt lgkmcnt(10)
  v_mfma_f32_16x16x32_bf16 v[168:171], v[232:235], v[96:99], v[168:171]
  ds_read_b64_tr_b16 v[220:221], v12 offset:30720
  ds_read_b64_tr_b16 v[222:223], v12 offset:38400
  ds_read_b64_tr_b16 v[224:225], v9 offset:30848
  ds_read_b64_tr_b16 v[226:227], v9 offset:38528
  v_mfma_f32_16x16x32_bf16 v[56:59], v[232:235], v[108:111], v[56:59]
  v_mfma_f32_16x16x32_bf16 v[172:175], v[236:239], v[96:99], v[172:175]
  v_mfma_f32_16x16x32_bf16 v[60:63], v[236:239], v[108:111], v[60:63]
  s_waitcnt lgkmcnt(10)
  v_mfma_f32_16x16x32_bf16 v[176:179], v[240:243], v[96:99], v[176:179]
  ds_read_b64_tr_b16 v[228:229], v10 offset:30848
  ds_read_b64_tr_b16 v[230:231], v10 offset:38528
  ds_read_b64_tr_b16 v[232:233], v11 offset:30848
  ds_read_b64_tr_b16 v[234:235], v11 offset:38528
  v_mfma_f32_16x16x32_bf16 v[64:67], v[240:243], v[108:111], v[64:67]
  v_mfma_f32_16x16x32_bf16 v[180:183], v[244:247], v[96:99], v[180:183]
  v_mfma_f32_16x16x32_bf16 v[68:71], v[244:247], v[108:111], v[68:71]
  v_mfma_f32_16x16x32_bf16 v[184:187], v[188:191], v[96:99], v[184:187]
  v_mfma_f32_16x16x32_bf16 v[72:75], v[188:191], v[108:111], v[72:75]
  s_waitcnt vmcnt(0)
  s_barrier
  s_add_u32 m0, s49, 8192
  s_add_u32 s50, s49, 81920
  buffer_load_dwordx4 v1, s[20:23], s50 offen lds
  s_add_u32 m0, s49, 16384
  s_add_u32 s50, s49, 90112
  buffer_load_dwordx4 v1, s[20:23], s50 offen lds
  s_add_u32 m0, s49, 24576
  s_add_u32 s50, s49, 98304
  buffer_load_dwordx4 v1, s[20:23], s50 offen lds
  s_add_u32 m0, s49, 32768
  s_add_u32 s50, s49, 106496
  buffer_load_dwordx4 v1, s[20:23], s50 offen lds
  s_waitcnt lgkmcnt(10)
  v_mfma_f32_16x16x32_bf16 v[136:139], v[248:251], v[100:103], v[136:139]
  ds_read_b64_tr_b16 v[236:237], v12 offset:30848
  ds_read_b64_tr_b16 v[238:239], v12 offset:38528
  ds_read_b64_tr_b16 v[240:241], v9 offset:30976
  ds_read_b64_tr_b16 v[242:243], v9 offset:38656
  v_mfma_f32_16x16x32_bf16 v[24:27], v[248:251], v[112:115], v[24:27]
  v_mfma_f32_16x16x32_bf16 v[140:143], v[252:255], v[100:103], v[140:143]
  v_mfma_f32_16x16x32_bf16 v[28:31], v[252:255], v[112:115], v[28:31]
  s_waitcnt lgkmcnt(10)
  v_mfma_f32_16x16x32_bf16 v[144:147], v[216:219], v[100:103], v[144:147]
  ds_read_b64_tr_b16 v[244:245], v10 offset:30976
  ds_read_b64_tr_b16 v[246:247], v10 offset:38656
  ds_read_b64_tr_b16 v[248:249], v11 offset:30976
  ds_read_b64_tr_b16 v[250:251], v11 offset:38656
  v_mfma_f32_16x16x32_bf16 v[32:35], v[216:219], v[112:115], v[32:35]
  v_mfma_f32_16x16x32_bf16 v[148:151], v[220:223], v[100:103], v[148:151]
  v_mfma_f32_16x16x32_bf16 v[36:39], v[220:223], v[112:115], v[36:39]
  s_waitcnt lgkmcnt(10)
  v_mfma_f32_16x16x32_bf16 v[152:155], v[224:227], v[100:103], v[152:155]
  ds_read_b64_tr_b16 v[252:253], v12 offset:30976
  ds_read_b64_tr_b16 v[254:255], v12 offset:38656
  ds_read_b64_tr_b16 v[216:217], v9 offset:46080
  ds_read_b64_tr_b16 v[218:219], v15 offset:0
  v_mfma_f32_16x16x32_bf16 v[40:43], v[224:227], v[112:115], v[40:43]
  v_mfma_f32_16x16x32_bf16 v[156:159], v[228:231], v[100:103], v[156:159]
  v_mfma_f32_16x16x32_bf16 v[44:47], v[228:231], v[112:115], v[44:47]
  s_waitcnt lgkmcnt(10)
  v_mfma_f32_16x16x32_bf16 v[160:163], v[232:235], v[100:103], v[160:163]
  ds_read_b64_tr_b16 v[220:221], v10 offset:46080
  ds_read_b64_tr_b16 v[222:223], v16 offset:0
  ds_read_b64_tr_b16 v[224:225], v11 offset:46080
  ds_read_b64_tr_b16 v[226:227], v17 offset:0
  v_mfma_f32_16x16x32_bf16 v[48:51], v[232:235], v[112:115], v[48:51]
  v_mfma_f32_16x16x32_bf16 v[164:167], v[236:239], v[100:103], v[164:167]
  v_mfma_f32_16x16x32_bf16 v[52:55], v[236:239], v[112:115], v[52:55]
  s_waitcnt lgkmcnt(10)
  v_mfma_f32_16x16x32_bf16 v[168:171], v[240:243], v[100:103], v[168:171]
  ds_read_b64_tr_b16 v[228:229], v12 offset:46080
  ds_read_b64_tr_b16 v[230:231], v18 offset:0
  ds_read_b64_tr_b16 v[232:233], v9 offset:46208
  ds_read_b64_tr_b16 v[234:235], v15 offset:128
  v_mfma_f32_16x16x32_bf16 v[56:59], v[240:243], v[112:115], v[56:59]
  v_mfma_f32_16x16x32_bf16 v[172:175], v[244:247], v[100:103], v[172:175]
  v_mfma_f32_16x16x32_bf16 v[60:63], v[244:247], v[112:115], v[60:63]
  s_waitcnt lgkmcnt(10)
  v_mfma_f32_16x16x32_bf16 v[176:179], v[248:251], v[100:103], v[176:179]
  ds_read_b64_tr_b16 v[236:237], v10 offset:46208
  ds_read_b64_tr_b16 v[238:239], v16 offset:128
  ds_read_b64_tr_b16 v[240:241], v11 offset:46208
  ds_read_b64_tr_b16 v[242:243], v17 offset:128
  v_mfma_f32_16x16x32_bf16 v[64:67], v[248:251], v[112:115], v[64:67]
  v_mfma_f32_16x16x32_bf16 v[180:183], v[252:255], v[100:103], v[180:183]
  v_mfma_f32_16x16x32_bf16 v[68:71], v[252:255], v[112:115], v[68:71]
  v_mfma_f32_16x16x32_bf16 v[184:187], v[188:191], v[100:103], v[184:187]
  v_mfma_f32_16x16x32_bf16 v[72:75], v[188:191], v[112:115], v[72:75]
  s_waitcnt lgkmcnt(10)
  v_mfma_f32_16x16x32_bf16 v[24:27], v[216:219], v[116:119], v[24:27]
  ds_read_b64_tr_b16 v[244:245], v12 offset:46208
  ds_read_b64_tr_b16 v[246:247], v18 offset:128
  ds_read_b64_tr_b16 v[248:249], v9 offset:46336
  ds_read_b64_tr_b16 v[250:251], v15 offset:256
  v_mfma_f32_16x16x32_bf16 v[28:31], v[220:223], v[116:119], v[28:31]
  s_waitcnt lgkmcnt(10)
  v_mfma_f32_16x16x32_bf16 v[32:35], v[224:227], v[116:119], v[32:35]
  ds_read_b64_tr_b16 v[252:253], v10 offset:46336
  ds_read_b64_tr_b16 v[254:255], v16 offset:256
  ds_read_b64_tr_b16 v[216:217], v11 offset:46336
  ds_read_b64_tr_b16 v[218:219], v17 offset:256
  v_mfma_f32_16x16x32_bf16 v[36:39], v[228:231], v[116:119], v[36:39]
  s_waitcnt lgkmcnt(10)
  v_mfma_f32_16x16x32_bf16 v[40:43], v[232:235], v[116:119], v[40:43]
  ds_read_b64_tr_b16 v[220:221], v12 offset:46336
  ds_read_b64_tr_b16 v[222:223], v18 offset:256
  ds_read_b128 v[224:227], v1 offset:0
  v_mfma_f32_16x16x32_bf16 v[44:47], v[236:239], v[116:119], v[44:47]
  ds_read_b128 v[228:231], v1 offset:1024
  ds_read_b128 v[232:235], v1 offset:2048
  s_waitcnt lgkmcnt(11)
  v_mfma_f32_16x16x32_bf16 v[48:51], v[240:243], v[116:119], v[48:51]
  ds_read_b128 v[236:239], v1 offset:3072
  ds_read_b128 v[240:243], v1 offset:4096
  v_mfma_f32_16x16x32_bf16 v[52:55], v[244:247], v[116:119], v[52:55]
  ds_read_b128 v[244:247], v1 offset:5120
  s_waitcnt lgkmcnt(10)
  v_mfma_f32_16x16x32_bf16 v[56:59], v[248:251], v[116:119], v[56:59]
  ds_read_b128 v[248:251], v1 offset:6144
  v_mfma_f32_16x16x32_bf16 v[60:63], v[252:255], v[116:119], v[60:63]
  ds_read_b128 v[252:255], v1 offset:7168
  s_waitcnt lgkmcnt(8)
  v_mfma_f32_16x16x32_bf16 v[64:67], v[216:219], v[116:119], v[64:67]
  v_mfma_f32_16x16x32_bf16 v[68:71], v[220:223], v[116:119], v[68:71]
  v_mfma_f32_16x16x32_bf16 v[72:75], v[188:191], v[116:119], v[72:75]
  s_waitcnt vmcnt(0)
  s_barrier
  ds_read_b128 v[216:219], v1 offset:8192
  ds_read_b128 v[220:223], v1 offset:9216
  s_add_u32 m0, s49, 40960
  s_add_u32 s50, s49, 114688
  buffer_load_dwordx4 v1, s[20:23], s50 offen lds
  s_add_u32 m0, s49, 49152
  s_add_u32 s50, s49, 122880
  buffer_load_dwordx4 v1, s[20:23], s50 offen lds
  s_add_u32 m0, s49, 57344
  s_add_u32 s50, s49, 131072
  buffer_load_dwordx4 v1, s[20:23], s50 offen lds
  s_add_u32 m0, s49, 65536
  s_add_u32 s50, s49, 139264
  buffer_load_dwordx4 v1, s[20:23], s50 offen lds
  s_nop 7
  v_rcp_f32 v22, v184
  v_rcp_f32 v23, v72
  v_cvt_pk_bf16_f32 v88, v136, v137
  v_cvt_pk_bf16_f32 v89, v138, v139
  v_cvt_pk_bf16_f32 v90, v140, v141
  v_cvt_pk_bf16_f32 v91, v142, v143
  v_cvt_pk_bf16_f32 v92, v144, v145
  v_cvt_pk_bf16_f32 v93, v146, v147
  v_cvt_pk_bf16_f32 v94, v148, v149
  v_cvt_pk_bf16_f32 v95, v150, v151
  v_cvt_pk_bf16_f32 v96, v152, v153
  v_cvt_pk_bf16_f32 v97, v154, v155
  v_cvt_pk_bf16_f32 v98, v156, v157
  v_cvt_pk_bf16_f32 v99, v158, v159
  v_cvt_pk_bf16_f32 v100, v160, v161
  v_cvt_pk_bf16_f32 v101, v162, v163
  v_cvt_pk_bf16_f32 v102, v164, v165
  v_cvt_pk_bf16_f32 v103, v166, v167
  v_cvt_pk_bf16_f32 v120, v168, v169
  v_cvt_pk_bf16_f32 v121, v170, v171
  v_cvt_pk_bf16_f32 v122, v172, v173
  v_cvt_pk_bf16_f32 v123, v174, v175
  v_cvt_pk_bf16_f32 v124, v176, v177
  v_cvt_pk_bf16_f32 v125, v178, v179
  v_cvt_pk_bf16_f32 v126, v180, v181
  v_cvt_pk_bf16_f32 v127, v182, v183
  v_cvt_pk_bf16_f32 v104, v24, v25
  v_cvt_pk_bf16_f32 v105, v26, v27
  v_cvt_pk_bf16_f32 v106, v28, v29
  v_cvt_pk_bf16_f32 v107, v30, v31
  v_cvt_pk_bf16_f32 v108, v32, v33
  v_cvt_pk_bf16_f32 v109, v34, v35
  v_cvt_pk_bf16_f32 v110, v36, v37
  v_cvt_pk_bf16_f32 v111, v38, v39
  v_cvt_pk_bf16_f32 v112, v40, v41
  v_cvt_pk_bf16_f32 v113, v42, v43
  v_cvt_pk_bf16_f32 v114, v44, v45
  v_cvt_pk_bf16_f32 v115, v46, v47
  v_cvt_pk_bf16_f32 v116, v48, v49
  v_cvt_pk_bf16_f32 v117, v50, v51
  v_cvt_pk_bf16_f32 v118, v52, v53
  v_cvt_pk_bf16_f32 v119, v54, v55
  v_cvt_pk_bf16_f32 v128, v56, v57
  v_cvt_pk_bf16_f32 v129, v58, v59
  v_cvt_pk_bf16_f32 v130, v60, v61
  v_cvt_pk_bf16_f32 v131, v62, v63
  v_cvt_pk_bf16_f32 v132, v64, v65
  v_cvt_pk_bf16_f32 v133, v66, v67
  v_cvt_pk_bf16_f32 v134, v68, v69
  v_cvt_pk_bf16_f32 v135, v70, v71
  s_nop 1
  s_waitcnt lgkmcnt(8)
  v_mfma_f32_16x16x32_bf16 v[184:187], v[224:227], v[88:91], 0
  v_mfma_f32_16x16x32_bf16 v[192:195], v[224:227], v[104:107], 0
  ds_read_b128 v[224:227], v1 offset:10240
  v_mfma_f32_16x16x32_bf16 v[188:191], v[228:231], v[88:91], 0
  v_mfma_f32_16x16x32_bf16 v[196:199], v[228:231], v[104:107], 0
  ds_read_b128 v[228:231], v1 offset:11264
  s_waitcnt lgkmcnt(8)
  v_mfma_f32_16x16x32_bf16 v[184:187], v[232:235], v[92:95], v[184:187]
  v_mfma_f32_16x16x32_bf16 v[192:195], v[232:235], v[108:111], v[192:195]
  ds_read_b128 v[232:235], v1 offset:12288
  v_mfma_f32_16x16x32_bf16 v[188:191], v[236:239], v[92:95], v[188:191]
  v_mfma_f32_16x16x32_bf16 v[196:199], v[236:239], v[108:111], v[196:199]
  ds_read_b128 v[236:239], v1 offset:13312
  s_waitcnt lgkmcnt(8)
  v_mfma_f32_16x16x32_bf16 v[184:187], v[240:243], v[96:99], v[184:187]
  v_mfma_f32_16x16x32_bf16 v[192:195], v[240:243], v[112:115], v[192:195]
  ds_read_b128 v[240:243], v1 offset:14336
  v_mfma_f32_16x16x32_bf16 v[188:191], v[244:247], v[96:99], v[188:191]
  v_mfma_f32_16x16x32_bf16 v[196:199], v[244:247], v[112:115], v[196:199]
  ds_read_b128 v[244:247], v1 offset:15360
  s_waitcnt lgkmcnt(8)
  v_mfma_f32_16x16x32_bf16 v[184:187], v[248:251], v[100:103], v[184:187]
  v_mfma_f32_16x16x32_bf16 v[192:195], v[248:251], v[116:119], v[192:195]
  ds_read_b128 v[248:251], v1 offset:16384
  v_mfma_f32_16x16x32_bf16 v[188:191], v[252:255], v[100:103], v[188:191]
  v_mfma_f32_16x16x32_bf16 v[196:199], v[252:255], v[116:119], v[196:199]
  ds_read_b128 v[252:255], v1 offset:17408
  s_waitcnt lgkmcnt(8)
  v_mfma_f32_16x16x32_bf16 v[184:187], v[216:219], v[120:123], v[184:187]
  v_mfma_f32_16x16x32_bf16 v[192:195], v[216:219], v[128:131], v[192:195]
  ds_read_b128 v[216:219], v1 offset:18432
  v_mfma_f32_16x16x32_bf16 v[188:191], v[220:223], v[120:123], v[188:191]
  v_mfma_f32_16x16x32_bf16 v[196:199], v[220:223], v[128:131], v[196:199]
  ds_read_b128 v[220:223], v1 offset:19456
  s_waitcnt lgkmcnt(8)
  v_mfma_f32_16x16x32_bf16 v[184:187], v[224:227], v[124:127], v[184:187]
  v_mfma_f32_16x16x32_bf16 v[192:195], v[224:227], v[132:135], v[192:195]
  ds_read_b128 v[224:227], v1 offset:20480
  v_mfma_f32_16x16x32_bf16 v[188:191], v[228:231], v[124:127], v[188:191]
  v_mfma_f32_16x16x32_bf16 v[196:199], v[228:231], v[132:135], v[196:199]
  ds_read_b128 v[228:231], v1 offset:21504
  s_waitcnt lgkmcnt(8)
  v_mfma_f32_16x16x32_bf16 v[200:203], v[232:235], v[88:91], 0
  v_mfma_f32_16x16x32_bf16 v[208:211], v[232:235], v[104:107], 0
  ds_read_b128 v[232:235], v1 offset:22528
  v_mfma_f32_16x16x32_bf16 v[204:207], v[236:239], v[88:91], 0
  v_mfma_f32_16x16x32_bf16 v[212:215], v[236:239], v[104:107], 0
  ds_read_b128 v[236:239], v1 offset:23552
  s_waitcnt lgkmcnt(8)
  v_mfma_f32_16x16x32_bf16 v[200:203], v[240:243], v[92:95], v[200:203]
  v_mfma_f32_16x16x32_bf16 v[208:211], v[240:243], v[108:111], v[208:211]
  ds_read_b128 v[240:243], v1 offset:24576
  v_mul_f32 v184, v184, v22
  v_mul_f32 v185, v185, v22
  v_mul_f32 v186, v186, v22
  v_mul_f32 v187, v187, v22
  v_mfma_f32_16x16x32_bf16 v[204:207], v[244:247], v[92:95], v[204:207]
  v_mfma_f32_16x16x32_bf16 v[212:215], v[244:247], v[108:111], v[212:215]
  ds_read_b128 v[244:247], v1 offset:25600
  v_mul_f32 v188, v188, v22
  v_mul_f32 v189, v189, v22
  v_mul_f32 v190, v190, v22
  v_mul_f32 v191, v191, v22
  s_waitcnt lgkmcnt(8)
  v_mfma_f32_16x16x32_bf16 v[200:203], v[248:251], v[96:99], v[200:203]
  v_mfma_f32_16x16x32_bf16 v[208:211], v[248:251], v[112:115], v[208:211]
  ds_read_b128 v[248:251], v1 offset:26624
  v_cvt_pk_bf16_f32 v24, v184, v185
  v_cvt_pk_bf16_f32 v25, v186, v187
  v_cvt_pk_bf16_f32 v26, v188, v189
  v_cvt_pk_bf16_f32 v27, v190, v191
  v_mfma_f32_16x16x32_bf16 v[204:207], v[252:255], v[96:99], v[204:207]
  v_mfma_f32_16x16x32_bf16 v[212:215], v[252:255], v[112:115], v[212:215]
  ds_read_b128 v[252:255], v1 offset:27648
  buffer_store_dwordx4 v[24:27], v5, s[16:19], 0 offen offset:0
  v_mul_f32 v192, v192, v23
  s_waitcnt lgkmcnt(8)
  v_mfma_f32_16x16x32_bf16 v[200:203], v[216:219], v[100:103], v[200:203]
  v_mfma_f32_16x16x32_bf16 v[208:211], v[216:219], v[116:119], v[208:211]
  ds_read_b128 v[216:219], v1 offset:28672
  v_mul_f32 v193, v193, v23
  v_mul_f32 v194, v194, v23
  v_mfma_f32_16x16x32_bf16 v[204:207], v[220:223], v[100:103], v[204:207]
  v_mfma_f32_16x16x32_bf16 v[212:215], v[220:223], v[116:119], v[212:215]
  ds_read_b128 v[220:223], v1 offset:29696
  v_mul_f32 v195, v195, v23
  v_mul_f32 v196, v196, v23
  s_waitcnt lgkmcnt(8)
  v_mfma_f32_16x16x32_bf16 v[200:203], v[224:227], v[120:123], v[200:203]
  v_mfma_f32_16x16x32_bf16 v[208:211], v[224:227], v[128:131], v[208:211]
  ds_read_b128 v[224:227], v1 offset:30720
  v_mul_f32 v197, v197, v23
  v_mul_f32 v198, v198, v23
  v_mfma_f32_16x16x32_bf16 v[204:207], v[228:231], v[120:123], v[204:207]
  v_mfma_f32_16x16x32_bf16 v[212:215], v[228:231], v[128:131], v[212:215]
  ds_read_b128 v[228:231], v1 offset:31744
  v_mul_f32 v199, v199, v23
  v_cvt_pk_bf16_f32 v28, v192, v193
  s_waitcnt lgkmcnt(8)
  v_mfma_f32_16x16x32_bf16 v[200:203], v[232:235], v[124:127], v[200:203]
  v_mfma_f32_16x16x32_bf16 v[208:211], v[232:235], v[132:135], v[208:211]
  ds_read_b128 v[232:235], v1 offset:32768
  v_cvt_pk_bf16_f32 v29, v194, v195
  v_cvt_pk_bf16_f32 v30, v196, v197
  v_mfma_f32_16x16x32_bf16 v[204:207], v[236:239], v[124:127], v[204:207]
  v_mfma_f32_16x16x32_bf16 v[212:215], v[236:239], v[132:135], v[212:215]
  ds_read_b128 v[236:239], v1 offset:33792
  v_cvt_pk_bf16_f32 v31, v198, v199
  buffer_store_dwordx4 v[28:31], v6, s[16:19], 0 offen offset:0
  s_waitcnt lgkmcnt(8)
  v_mfma_f32_16x16x32_bf16 v[184:187], v[240:243], v[88:91], 0
  v_mfma_f32_16x16x32_bf16 v[192:195], v[240:243], v[104:107], 0
  ds_read_b128 v[240:243], v1 offset:34816
  v_mfma_f32_16x16x32_bf16 v[188:191], v[244:247], v[88:91], 0
  v_mfma_f32_16x16x32_bf16 v[196:199], v[244:247], v[104:107], 0
  ds_read_b128 v[244:247], v1 offset:35840
  s_waitcnt lgkmcnt(8)
  v_mfma_f32_16x16x32_bf16 v[184:187], v[248:251], v[92:95], v[184:187]
  v_mfma_f32_16x16x32_bf16 v[192:195], v[248:251], v[108:111], v[192:195]
  ds_read_b128 v[248:251], v2 offset:0
  v_mul_f32 v200, v200, v22
  v_mul_f32 v201, v201, v22
  v_mul_f32 v202, v202, v22
  v_mul_f32 v203, v203, v22
  v_mfma_f32_16x16x32_bf16 v[188:191], v[252:255], v[92:95], v[188:191]
  v_mfma_f32_16x16x32_bf16 v[196:199], v[252:255], v[108:111], v[196:199]
  ds_read_b128 v[252:255], v2 offset:1024
  v_mul_f32 v204, v204, v22
  v_mul_f32 v205, v205, v22
  v_mul_f32 v206, v206, v22
  v_mul_f32 v207, v207, v22
  s_waitcnt lgkmcnt(8)
  v_mfma_f32_16x16x32_bf16 v[184:187], v[216:219], v[96:99], v[184:187]
  v_mfma_f32_16x16x32_bf16 v[192:195], v[216:219], v[112:115], v[192:195]
  ds_read_b128 v[216:219], v2 offset:2048
  v_cvt_pk_bf16_f32 v32, v200, v201
  v_cvt_pk_bf16_f32 v33, v202, v203
  v_cvt_pk_bf16_f32 v34, v204, v205
  v_cvt_pk_bf16_f32 v35, v206, v207
  v_mfma_f32_16x16x32_bf16 v[188:191], v[220:223], v[96:99], v[188:191]
  v_mfma_f32_16x16x32_bf16 v[196:199], v[220:223], v[112:115], v[196:199]
  ds_read_b128 v[220:223], v2 offset:3072
  buffer_store_dwordx4 v[32:35], v5, s[16:19], 0 offen offset:64
  v_mul_f32 v208, v208, v23
  s_waitcnt lgkmcnt(8)
  v_mfma_f32_16x16x32_bf16 v[184:187], v[224:227], v[100:103], v[184:187]
  v_mfma_f32_16x16x32_bf16 v[192:195], v[224:227], v[116:119], v[192:195]
  v_mul_f32 v209, v209, v23
  v_mul_f32 v210, v210, v23
  v_mfma_f32_16x16x32_bf16 v[188:191], v[228:231], v[100:103], v[188:191]
  v_mfma_f32_16x16x32_bf16 v[196:199], v[228:231], v[116:119], v[196:199]
  v_mul_f32 v211, v211, v23
  v_mul_f32 v212, v212, v23
  s_waitcnt lgkmcnt(6)
  v_mfma_f32_16x16x32_bf16 v[184:187], v[232:235], v[120:123], v[184:187]
  v_mfma_f32_16x16x32_bf16 v[192:195], v[232:235], v[128:131], v[192:195]
  v_mul_f32 v213, v213, v23
  v_mul_f32 v214, v214, v23
  v_mfma_f32_16x16x32_bf16 v[188:191], v[236:239], v[120:123], v[188:191]
  v_mfma_f32_16x16x32_bf16 v[196:199], v[236:239], v[128:131], v[196:199]
  v_mul_f32 v215, v215, v23
  v_cvt_pk_bf16_f32 v36, v208, v209
  s_waitcnt lgkmcnt(4)
  v_mfma_f32_16x16x32_bf16 v[184:187], v[240:243], v[124:127], v[184:187]
  v_mfma_f32_16x16x32_bf16 v[192:195], v[240:243], v[132:135], v[192:195]
  v_cvt_pk_bf16_f32 v37, v210, v211
  v_cvt_pk_bf16_f32 v38, v212, v213
  v_mfma_f32_16x16x32_bf16 v[188:191], v[244:247], v[124:127], v[188:191]
  v_mfma_f32_16x16x32_bf16 v[196:199], v[244:247], v[132:135], v[196:199]
  v_cvt_pk_bf16_f32 v39, v214, v215
  buffer_store_dwordx4 v[36:39], v6, s[16:19], 0 offen offset:64
  s_waitcnt vmcnt(4)
  s_barrier
  ds_read_b128 v[224:227], v2 offset:4096
  ds_read_b128 v[228:231], v2 offset:5120
  ds_read_b128 v[232:235], v2 offset:6144
  ds_read_b128 v[236:239], v2 offset:7168
  ds_read_b128 v[240:243], v2 offset:8192
  ds_read_b128 v[244:247], v2 offset:9216
  s_waitcnt lgkmcnt(8)
  v_mfma_f32_16x16x32_bf16 v[200:203], v[248:251], v[88:91], 0
  v_mfma_f32_16x16x32_bf16 v[208:211], v[248:251], v[104:107], 0
  ds_read_b128 v[248:251], v2 offset:10240
  v_mfma_f32_16x16x32_bf16 v[204:207], v[252:255], v[88:91], 0
  v_mfma_f32_16x16x32_bf16 v[212:215], v[252:255], v[104:107], 0
  ds_read_b128 v[252:255], v2 offset:11264
  s_waitcnt lgkmcnt(8)
  v_mfma_f32_16x16x32_bf16 v[200:203], v[216:219], v[92:95], v[200:203]
  v_mfma_f32_16x16x32_bf16 v[208:211], v[216:219], v[108:111], v[208:211]
  ds_read_b128 v[216:219], v2 offset:12288
  v_mul_f32 v184, v184, v22
  v_mul_f32 v185, v185, v22
  v_mul_f32 v186, v186, v22
  v_mul_f32 v187, v187, v22
  v_mfma_f32_16x16x32_bf16 v[204:207], v[220:223], v[92:95], v[204:207]
  v_mfma_f32_16x16x32_bf16 v[212:215], v[220:223], v[108:111], v[212:215]
  ds_read_b128 v[220:223], v2 offset:13312
  v_mul_f32 v188, v188, v22
  v_mul_f32 v189, v189, v22
  v_mul_f32 v190, v190, v22
  v_mul_f32 v191, v191, v22
  s_waitcnt lgkmcnt(8)
  v_mfma_f32_16x16x32_bf16 v[200:203], v[224:227], v[96:99], v[200:203]
  v_mfma_f32_16x16x32_bf16 v[208:211], v[224:227], v[112:115], v[208:211]
  ds_read_b128 v[224:227], v2 offset:14336
  v_cvt_pk_bf16_f32 v24, v184, v185
  v_cvt_pk_bf16_f32 v25, v186, v187
  v_cvt_pk_bf16_f32 v26, v188, v189
  v_cvt_pk_bf16_f32 v27, v190, v191
  v_mfma_f32_16x16x32_bf16 v[204:207], v[228:231], v[96:99], v[204:207]
  v_mfma_f32_16x16x32_bf16 v[212:215], v[228:231], v[112:115], v[212:215]
  ds_read_b128 v[228:231], v2 offset:15360
  buffer_store_dwordx4 v[24:27], v5, s[16:19], 0 offen offset:128
  v_mul_f32 v192, v192, v23
  s_waitcnt lgkmcnt(8)
  v_mfma_f32_16x16x32_bf16 v[200:203], v[232:235], v[100:103], v[200:203]
  v_mfma_f32_16x16x32_bf16 v[208:211], v[232:235], v[116:119], v[208:211]
  ds_read_b128 v[232:235], v2 offset:16384
  v_mul_f32 v193, v193, v23
  v_mul_f32 v194, v194, v23
  v_mfma_f32_16x16x32_bf16 v[204:207], v[236:239], v[100:103], v[204:207]
  v_mfma_f32_16x16x32_bf16 v[212:215], v[236:239], v[116:119], v[212:215]
  ds_read_b128 v[236:239], v2 offset:17408
  v_mul_f32 v195, v195, v23
  v_mul_f32 v196, v196, v23
  s_waitcnt lgkmcnt(8)
  v_mfma_f32_16x16x32_bf16 v[200:203], v[240:243], v[120:123], v[200:203]
  v_mfma_f32_16x16x32_bf16 v[208:211], v[240:243], v[128:131], v[208:211]
  ds_read_b128 v[240:243], v2 offset:18432
  v_mul_f32 v197, v197, v23
  v_mul_f32 v198, v198, v23
  v_mfma_f32_16x16x32_bf16 v[204:207], v[244:247], v[120:123], v[204:207]
  v_mfma_f32_16x16x32_bf16 v[212:215], v[244:247], v[128:131], v[212:215]
  ds_read_b128 v[244:247], v2 offset:19456
  v_mul_f32 v199, v199, v23
  v_cvt_pk_bf16_f32 v28, v192, v193
  s_waitcnt lgkmcnt(8)
  v_mfma_f32_16x16x32_bf16 v[200:203], v[248:251], v[124:127], v[200:203]
  v_mfma_f32_16x16x32_bf16 v[208:211], v[248:251], v[132:135], v[208:211]
  ds_read_b128 v[248:251], v2 offset:20480
  v_cvt_pk_bf16_f32 v29, v194, v195
  v_cvt_pk_bf16_f32 v30, v196, v197
  v_mfma_f32_16x16x32_bf16 v[204:207], v[252:255], v[124:127], v[204:207]
  v_mfma_f32_16x16x32_bf16 v[212:215], v[252:255], v[132:135], v[212:215]
  ds_read_b128 v[252:255], v2 offset:21504
  v_cvt_pk_bf16_f32 v31, v198, v199
  buffer_store_dwordx4 v[28:31], v6, s[16:19], 0 offen offset:128
  s_waitcnt lgkmcnt(8)
  v_mfma_f32_16x16x32_bf16 v[184:187], v[216:219], v[88:91], 0
  v_mfma_f32_16x16x32_bf16 v[192:195], v[216:219], v[104:107], 0
  ds_read_b128 v[216:219], v2 offset:22528
  v_mfma_f32_16x16x32_bf16 v[188:191], v[220:223], v[88:91], 0
  v_mfma_f32_16x16x32_bf16 v[196:199], v[220:223], v[104:107], 0
  ds_read_b128 v[220:223], v2 offset:23552
  s_waitcnt lgkmcnt(8)
  v_mfma_f32_16x16x32_bf16 v[184:187], v[224:227], v[92:95], v[184:187]
  v_mfma_f32_16x16x32_bf16 v[192:195], v[224:227], v[108:111], v[192:195]
  ds_read_b128 v[224:227], v2 offset:24576
  v_mul_f32 v200, v200, v22
  v_mul_f32 v201, v201, v22
  v_mul_f32 v202, v202, v22
  v_mul_f32 v203, v203, v22
  v_mfma_f32_16x16x32_bf16 v[188:191], v[228:231], v[92:95], v[188:191]
  v_mfma_f32_16x16x32_bf16 v[196:199], v[228:231], v[108:111], v[196:199]
  ds_read_b128 v[228:231], v2 offset:25600
  v_mul_f32 v204, v204, v22
  v_mul_f32 v205, v205, v22
  v_mul_f32 v206, v206, v22
  v_mul_f32 v207, v207, v22
  s_waitcnt lgkmcnt(8)
  v_mfma_f32_16x16x32_bf16 v[184:187], v[232:235], v[96:99], v[184:187]
  v_mfma_f32_16x16x32_bf16 v[192:195], v[232:235], v[112:115], v[192:195]
  ds_read_b128 v[232:235], v2 offset:26624
  v_cvt_pk_bf16_f32 v32, v200, v201
  v_cvt_pk_bf16_f32 v33, v202, v203
  v_cvt_pk_bf16_f32 v34, v204, v205
  v_cvt_pk_bf16_f32 v35, v206, v207
  v_mfma_f32_16x16x32_bf16 v[188:191], v[236:239], v[96:99], v[188:191]
  v_mfma_f32_16x16x32_bf16 v[196:199], v[236:239], v[112:115], v[196:199]
  ds_read_b128 v[236:239], v2 offset:27648
  buffer_store_dwordx4 v[32:35], v5, s[16:19], 0 offen offset:192
  v_mul_f32 v208, v208, v23
  s_waitcnt lgkmcnt(8)
  v_mfma_f32_16x16x32_bf16 v[184:187], v[240:243], v[100:103], v[184:187]
  v_mfma_f32_16x16x32_bf16 v[192:195], v[240:243], v[116:119], v[192:195]
  ds_read_b128 v[240:243], v2 offset:28672
  v_mul_f32 v209, v209, v23
  v_mul_f32 v210, v210, v23
  v_mfma_f32_16x16x32_bf16 v[188:191], v[244:247], v[100:103], v[188:191]
  v_mfma_f32_16x16x32_bf16 v[196:199], v[244:247], v[116:119], v[196:199]
  ds_read_b128 v[244:247], v2 offset:29696
  v_mul_f32 v211, v211, v23
  v_mul_f32 v212, v212, v23
  s_waitcnt lgkmcnt(8)
  v_mfma_f32_16x16x32_bf16 v[184:187], v[248:251], v[120:123], v[184:187]
  v_mfma_f32_16x16x32_bf16 v[192:195], v[248:251], v[128:131], v[192:195]
  ds_read_b128 v[248:251], v2 offset:30720
  v_mul_f32 v213, v213, v23
  v_mul_f32 v214, v214, v23
  v_mfma_f32_16x16x32_bf16 v[188:191], v[252:255], v[120:123], v[188:191]
  v_mfma_f32_16x16x32_bf16 v[196:199], v[252:255], v[128:131], v[196:199]
  ds_read_b128 v[252:255], v2 offset:31744
  v_mul_f32 v215, v215, v23
  v_cvt_pk_bf16_f32 v36, v208, v209
  s_waitcnt lgkmcnt(8)
  v_mfma_f32_16x16x32_bf16 v[184:187], v[216:219], v[124:127], v[184:187]
  v_mfma_f32_16x16x32_bf16 v[192:195], v[216:219], v[132:135], v[192:195]
  ds_read_b128 v[216:219], v2 offset:32768
  v_cvt_pk_bf16_f32 v37, v210, v211
  v_cvt_pk_bf16_f32 v38, v212, v213
  v_mfma_f32_16x16x32_bf16 v[188:191], v[220:223], v[124:127], v[188:191]
  v_mfma_f32_16x16x32_bf16 v[196:199], v[220:223], v[132:135], v[196:199]
  ds_read_b128 v[220:223], v2 offset:33792
  v_cvt_pk_bf16_f32 v39, v214, v215
  buffer_store_dwordx4 v[36:39], v6, s[16:19], 0 offen offset:192
  s_waitcnt lgkmcnt(8)
  v_mfma_f32_16x16x32_bf16 v[200:203], v[224:227], v[88:91], 0
  v_mfma_f32_16x16x32_bf16 v[208:211], v[224:227], v[104:107], 0
  ds_read_b128 v[224:227], v2 offset:34816
  v_mfma_f32_16x16x32_bf16 v[204:207], v[228:231], v[88:91], 0
  v_mfma_f32_16x16x32_bf16 v[212:215], v[228:231], v[104:107], 0
  ds_read_b128 v[228:231], v2 offset:35840
  s_waitcnt lgkmcnt(8)
  v_mfma_f32_16x16x32_bf16 v[200:203], v[232:235], v[92:95], v[200:203]
  v_mfma_f32_16x16x32_bf16 v[208:211], v[232:235], v[108:111], v[208:211]
  v_mul_f32 v184, v184, v22
  v_mul_f32 v185, v185, v22
  v_mul_f32 v186, v186, v22
  v_mul_f32 v187, v187, v22
  v_mfma_f32_16x16x32_bf16 v[204:207], v[236:239], v[92:95], v[204:207]
  v_mfma_f32_16x16x32_bf16 v[212:215], v[236:239], v[108:111], v[212:215]
  v_mul_f32 v188, v188, v22
  v_mul_f32 v189, v189, v22
  v_mul_f32 v190, v190, v22
  v_mul_f32 v191, v191, v22
  s_waitcnt lgkmcnt(6)
  v_mfma_f32_16x16x32_bf16 v[200:203], v[240:243], v[96:99], v[200:203]
  v_mfma_f32_16x16x32_bf16 v[208:211], v[240:243], v[112:115], v[208:211]
  v_cvt_pk_bf16_f32 v24, v184, v185
  v_cvt_pk_bf16_f32 v25, v186, v187
  v_cvt_pk_bf16_f32 v26, v188, v189
  v_cvt_pk_bf16_f32 v27, v190, v191
  v_mfma_f32_16x16x32_bf16 v[204:207], v[244:247], v[96:99], v[204:207]
  v_mfma_f32_16x16x32_bf16 v[212:215], v[244:247], v[112:115], v[212:215]
  buffer_store_dwordx4 v[24:27], v5, s[16:19], 0 offen offset:256
  v_mul_f32 v192, v192, v23
  s_waitcnt lgkmcnt(4)
  v_mfma_f32_16x16x32_bf16 v[200:203], v[248:251], v[100:103], v[200:203]
  v_mfma_f32_16x16x32_bf16 v[208:211], v[248:251], v[116:119], v[208:211]
  v_mul_f32 v193, v193, v23
  v_mul_f32 v194, v194, v23
  v_mfma_f32_16x16x32_bf16 v[204:207], v[252:255], v[100:103], v[204:207]
  v_mfma_f32_16x16x32_bf16 v[212:215], v[252:255], v[116:119], v[212:215]
  v_mul_f32 v195, v195, v23
  v_mul_f32 v196, v196, v23
  s_waitcnt lgkmcnt(3)
  v_mfma_f32_16x16x32_bf16 v[200:203], v[216:219], v[120:123], v[200:203]
  v_mfma_f32_16x16x32_bf16 v[208:211], v[216:219], v[128:131], v[208:211]
  v_mul_f32 v197, v197, v23
  v_mul_f32 v198, v198, v23
  s_waitcnt lgkmcnt(2)
  v_mfma_f32_16x16x32_bf16 v[204:207], v[220:223], v[120:123], v[204:207]
  v_mfma_f32_16x16x32_bf16 v[212:215], v[220:223], v[128:131], v[212:215]
  v_mul_f32 v199, v199, v23
  v_cvt_pk_bf16_f32 v28, v192, v193
  s_waitcnt lgkmcnt(1)
  v_mfma_f32_16x16x32_bf16 v[200:203], v[224:227], v[124:127], v[200:203]
  v_mfma_f32_16x16x32_bf16 v[208:211], v[224:227], v[132:135], v[208:211]
  v_cvt_pk_bf16_f32 v29, v194, v195
  v_cvt_pk_bf16_f32 v30, v196, v197
  s_waitcnt lgkmcnt(0)
  v_mfma_f32_16x16x32_bf16 v[204:207], v[228:231], v[124:127], v[204:207]
  v_mfma_f32_16x16x32_bf16 v[212:215], v[228:231], v[132:135], v[212:215]
  v_cvt_pk_bf16_f32 v31, v198, v199
  buffer_store_dwordx4 v[28:31], v6, s[16:19], 0 offen offset:256
  s_nop 7
  v_mul_f32 v200, v200, v22
  v_mul_f32 v201, v201, v22
  v_mul_f32 v202, v202, v22
  v_mul_f32 v203, v203, v22
  v_mul_f32 v204, v204, v22
  v_mul_f32 v205, v205, v22
  v_mul_f32 v206, v206, v22
  v_mul_f32 v207, v207, v22
  v_cvt_pk_bf16_f32 v32, v200, v201
  v_cvt_pk_bf16_f32 v33, v202, v203
  v_cvt_pk_bf16_f32 v34, v204, v205
  v_cvt_pk_bf16_f32 v35, v206, v207
  buffer_store_dwordx4 v[32:35], v5, s[16:19], 0 offen offset:320
  v_mul_f32 v208, v208, v23
  v_mul_f32 v209, v209, v23
  v_mul_f32 v210, v210, v23
  v_mul_f32 v211, v211, v23
  v_mul_f32 v212, v212, v23
  v_mul_f32 v213, v213, v23
  v_mul_f32 v214, v214, v23
  v_mul_f32 v215, v215, v23
  v_cvt_pk_bf16_f32 v36, v208, v209
  v_cvt_pk_bf16_f32 v37, v210, v211
  v_cvt_pk_bf16_f32 v38, v212, v213
  v_cvt_pk_bf16_f32 v39, v214, v215
  buffer_store_dwordx4 v[36:39], v6, s[16:19], 0 offen offset:320
MK_done:
  s_endpgm
.section .rodata,"a"
.p2align 6
.amdhsa_kernel prep_kernel
  .amdhsa_next_free_vgpr 152
  .amdhsa_next_free_sgpr 102
  .amdhsa_accum_offset 152
  .amdhsa_group_segment_fixed_size 0
  .amdhsa_kernarg_size 48
  .amdhsa_user_sgpr_count 2
  .amdhsa_user_sgpr_kernarg_segment_ptr 1
  .amdhsa_system_sgpr_workgroup_id_x 1
.end_amdhsa_kernel
.p2align 6
.amdhsa_kernel main_kernel
  .amdhsa_next_free_vgpr 256
  .amdhsa_next_free_sgpr 102
  .amdhsa_accum_offset 256
  .amdhsa_group_segment_fixed_size 0
  .amdhsa_kernarg_size 48
  .amdhsa_user_sgpr_count 2
  .amdhsa_user_sgpr_kernarg_segment_ptr 1
  .amdhsa_system_sgpr_workgroup_id_x 1
.end_amdhsa_kernel
```

```asm
; @launch kernel=prep_kernel grid=(144,1,1) block=(64,1,1) lds=0
; @launch kernel=main_kernel grid=(256,1,1) block=(512,1,1) lds=163840
.amdgcn_target "amdgcn-amd-amdhsa--gfx950"
.text
.globl prep_kernel
.p2align 8
.type prep_kernel,@function
prep_kernel:
  s_cmp_ge_u32 s2, 144
  s_cbranch_scc1 PR_done
  s_load_dwordx4 s[4:7], s[0:1], 8
  s_load_dwordx2 s[8:9], s[0:1], 40
  s_cmp_ge_u32 s2, 72
  s_cselect_b32 s24, 1, 0
  s_mul_i32 s25, s24, 72
  s_sub_u32 s25, s2, s25
  s_mul_hi_u32 s26, s25, 0x15555556
  s_mul_i32 s27, s26, 12
  s_sub_u32 s27, s25, s27
  s_and_b32 s28, s27, 1
  s_lshr_b32 s27, s27, 1
  v_and_b32 v1, 15, v0
  v_lshrrev_b32 v2, 4, v0
  v_lshrrev_b32 v3, 2, v1
  v_and_b32 v4, 3, v1
  s_lshl_b32 s29, s26, 5
  s_lshl_b32 s30, s28, 2
  s_add_u32 s29, s29, s30
  v_lshl_add_u32 v5, v3, 3, v4
  v_add_u32 v5, s29, v5
  s_waitcnt lgkmcnt(0)
  s_mov_b32 s12, s4
  s_and_b32 s13, s5, 0xffff
  s_mov_b32 s14, 221184
  s_mov_b32 s15, 0x00020000
  s_mov_b32 s16, s6
  s_and_b32 s17, s7, 0xffff
  s_mov_b32 s18, 73728
  s_mov_b32 s19, 0x00020000
  s_mov_b32 s20, s8
  s_and_b32 s21, s9, 0xffff
  s_mov_b32 s22, 147456
  s_mov_b32 s23, 0x00020000
  s_cmp_eq_u32 s24, 1
  s_cbranch_scc1 PR_n
  s_lshl_b32 s29, s27, 5
  v_lshl_add_u32 v6, v3, 3, v4
  v_add_u32 v6, s29, v6
  v_mul_u32_u24 v6, 1152, v6
  v_lshl_add_u32 v6, v2, 4, v6
  v_add_u32 v7, 4608, v6
  v_mul_u32_u24 v8, 1152, v5
  v_lshl_add_u32 v8, v2, 4, v8
  buffer_load_dwordx4 v[64:67], v8, s[12:15], 0 offen offset:384
  buffer_load_dwordx4 v[68:71], v8, s[12:15], 0 offen offset:448
  buffer_load_dwordx4 v[72:75], v8, s[12:15], 0 offen offset:512
  buffer_load_dwordx4 v[76:79], v8, s[12:15], 0 offen offset:576
  buffer_load_dwordx4 v[80:83], v8, s[12:15], 0 offen offset:640
  buffer_load_dwordx4 v[84:87], v8, s[12:15], 0 offen offset:704
  s_mov_b32 s31, 1037384597
  s_sub_u32 s25, 71, s25
  s_lshl_b32 s25, s25, 10
  s_branch PR_go
PR_n:
  s_lshr_b32 s29, s27, 1
  s_lshl_b32 s29, s29, 3
  s_and_b32 s30, s27, 1
  s_lshl_b32 s30, s30, 1
  s_add_u32 s29, s29, s30
  s_lshl_b32 s29, s29, 3
  v_lshrrev_b32 v6, 1, v3
  v_lshlrev_b32 v6, 5, v6
  v_and_b32 v7, 1, v3
  v_lshl_add_u32 v6, v7, 2, v6
  v_add3_u32 v6, v6, v4, s29
  v_mul_u32_u24 v6, 1152, v6
  v_lshl_add_u32 v6, v2, 4, v6
  v_add_u32 v6, 768, v6
  v_add_u32 v7, 9216, v6
  v_mul_u32_u24 v8, 3072, v2
  v_lshl_add_u32 v8, v5, 1, v8
  s_mov_b32 s32, 0
  buffer_load_ushort v104, v8, s[16:19], s32 offen offset:0
  buffer_load_ushort v105, v8, s[16:19], s32 offen offset:384
  buffer_load_ushort v106, v8, s[16:19], s32 offen offset:768
  buffer_load_ushort v107, v8, s[16:19], s32 offen offset:1152
  buffer_load_ushort v108, v8, s[16:19], s32 offen offset:1536
  buffer_load_ushort v109, v8, s[16:19], s32 offen offset:1920
  buffer_load_ushort v110, v8, s[16:19], s32 offen offset:2304
  buffer_load_ushort v111, v8, s[16:19], s32 offen offset:2688
  s_mov_b32 s32, 12288
  buffer_load_ushort v112, v8, s[16:19], s32 offen offset:0
  buffer_load_ushort v113, v8, s[16:19], s32 offen offset:384
  buffer_load_ushort v114, v8, s[16:19], s32 offen offset:768
  buffer_load_ushort v115, v8, s[16:19], s32 offen offset:1152
  buffer_load_ushort v116, v8, s[16:19], s32 offen offset:1536
  buffer_load_ushort v117, v8, s[16:19], s32 offen offset:1920
  buffer_load_ushort v118, v8, s[16:19], s32 offen offset:2304
  buffer_load_ushort v119, v8, s[16:19], s32 offen offset:2688
  s_mov_b32 s32, 24576
  buffer_load_ushort v120, v8, s[16:19], s32 offen offset:0
  buffer_load_ushort v121, v8, s[16:19], s32 offen offset:384
  buffer_load_ushort v122, v8, s[16:19], s32 offen offset:768
  buffer_load_ushort v123, v8, s[16:19], s32 offen offset:1152
  buffer_load_ushort v124, v8, s[16:19], s32 offen offset:1536
  buffer_load_ushort v125, v8, s[16:19], s32 offen offset:1920
  buffer_load_ushort v126, v8, s[16:19], s32 offen offset:2304
  buffer_load_ushort v127, v8, s[16:19], s32 offen offset:2688
  s_mov_b32 s32, 36864
  buffer_load_ushort v128, v8, s[16:19], s32 offen offset:0
  buffer_load_ushort v129, v8, s[16:19], s32 offen offset:384
  buffer_load_ushort v130, v8, s[16:19], s32 offen offset:768
  buffer_load_ushort v131, v8, s[16:19], s32 offen offset:1152
  buffer_load_ushort v132, v8, s[16:19], s32 offen offset:1536
  buffer_load_ushort v133, v8, s[16:19], s32 offen offset:1920
  buffer_load_ushort v134, v8, s[16:19], s32 offen offset:2304
  buffer_load_ushort v135, v8, s[16:19], s32 offen offset:2688
  s_mov_b32 s32, 49152
  buffer_load_ushort v136, v8, s[16:19], s32 offen offset:0
  buffer_load_ushort v137, v8, s[16:19], s32 offen offset:384
  buffer_load_ushort v138, v8, s[16:19], s32 offen offset:768
  buffer_load_ushort v139, v8, s[16:19], s32 offen offset:1152
  buffer_load_ushort v140, v8, s[16:19], s32 offen offset:1536
  buffer_load_ushort v141, v8, s[16:19], s32 offen offset:1920
  buffer_load_ushort v142, v8, s[16:19], s32 offen offset:2304
  buffer_load_ushort v143, v8, s[16:19], s32 offen offset:2688
  s_mov_b32 s32, 61440
  buffer_load_ushort v144, v8, s[16:19], s32 offen offset:0
  buffer_load_ushort v145, v8, s[16:19], s32 offen offset:384
  buffer_load_ushort v146, v8, s[16:19], s32 offen offset:768
  buffer_load_ushort v147, v8, s[16:19], s32 offen offset:1152
  buffer_load_ushort v148, v8, s[16:19], s32 offen offset:1536
  buffer_load_ushort v149, v8, s[16:19], s32 offen offset:1920
  buffer_load_ushort v150, v8, s[16:19], s32 offen offset:2304
  buffer_load_ushort v151, v8, s[16:19], s32 offen offset:2688
  s_mov_b32 s31, 1.0
  s_lshl_b32 s25, s25, 10
  s_add_u32 s25, s25, 73728
PR_go:
  buffer_load_dwordx4 v[16:19], v6, s[12:15], 0 offen offset:0
  buffer_load_dwordx4 v[40:43], v7, s[12:15], 0 offen offset:0
  buffer_load_dwordx4 v[20:23], v6, s[12:15], 0 offen offset:64
  buffer_load_dwordx4 v[44:47], v7, s[12:15], 0 offen offset:64
  buffer_load_dwordx4 v[24:27], v6, s[12:15], 0 offen offset:128
  buffer_load_dwordx4 v[48:51], v7, s[12:15], 0 offen offset:128
  buffer_load_dwordx4 v[28:31], v6, s[12:15], 0 offen offset:192
  buffer_load_dwordx4 v[52:55], v7, s[12:15], 0 offen offset:192
  buffer_load_dwordx4 v[32:35], v6, s[12:15], 0 offen offset:256
  buffer_load_dwordx4 v[56:59], v7, s[12:15], 0 offen offset:256
  buffer_load_dwordx4 v[36:39], v6, s[12:15], 0 offen offset:320
  buffer_load_dwordx4 v[60:63], v7, s[12:15], 0 offen offset:320
  s_waitcnt vmcnt(0)
  s_cmp_eq_u32 s24, 0
  s_cbranch_scc1 PR_mm
  v_lshl_or_b32 v64, v105, 16, v104
  v_lshl_or_b32 v65, v107, 16, v106
  v_lshl_or_b32 v66, v109, 16, v108
  v_lshl_or_b32 v67, v111, 16, v110
  v_lshl_or_b32 v68, v113, 16, v112
  v_lshl_or_b32 v69, v115, 16, v114
  v_lshl_or_b32 v70, v117, 16, v116
  v_lshl_or_b32 v71, v119, 16, v118
  v_lshl_or_b32 v72, v121, 16, v120
  v_lshl_or_b32 v73, v123, 16, v122
  v_lshl_or_b32 v74, v125, 16, v124
  v_lshl_or_b32 v75, v127, 16, v126
  v_lshl_or_b32 v76, v129, 16, v128
  v_lshl_or_b32 v77, v131, 16, v130
  v_lshl_or_b32 v78, v133, 16, v132
  v_lshl_or_b32 v79, v135, 16, v134
  v_lshl_or_b32 v80, v137, 16, v136
  v_lshl_or_b32 v81, v139, 16, v138
  v_lshl_or_b32 v82, v141, 16, v140
  v_lshl_or_b32 v83, v143, 16, v142
  v_lshl_or_b32 v84, v145, 16, v144
  v_lshl_or_b32 v85, v147, 16, v146
  v_lshl_or_b32 v86, v149, 16, v148
  v_lshl_or_b32 v87, v151, 16, v150
  s_nop 1
PR_mm:
  v_mfma_f32_16x16x32_bf16 v[88:91], v[16:19], v[64:67], 0
  v_mfma_f32_16x16x32_bf16 v[92:95], v[40:43], v[64:67], 0
  v_mfma_f32_16x16x32_bf16 v[88:91], v[20:23], v[68:71], v[88:91]
  v_mfma_f32_16x16x32_bf16 v[92:95], v[44:47], v[68:71], v[92:95]
  v_mfma_f32_16x16x32_bf16 v[88:91], v[24:27], v[72:75], v[88:91]
  v_mfma_f32_16x16x32_bf16 v[92:95], v[48:51], v[72:75], v[92:95]
  v_mfma_f32_16x16x32_bf16 v[88:91], v[28:31], v[76:79], v[88:91]
  v_mfma_f32_16x16x32_bf16 v[92:95], v[52:55], v[76:79], v[92:95]
  v_mfma_f32_16x16x32_bf16 v[88:91], v[32:35], v[80:83], v[88:91]
  v_mfma_f32_16x16x32_bf16 v[92:95], v[56:59], v[80:83], v[92:95]
  v_mfma_f32_16x16x32_bf16 v[88:91], v[36:39], v[84:87], v[88:91]
  v_mfma_f32_16x16x32_bf16 v[92:95], v[60:63], v[84:87], v[92:95]
  s_nop 15
  v_mul_f32 v88, s31, v88
  v_mul_f32 v89, s31, v89
  v_mul_f32 v90, s31, v90
  v_mul_f32 v91, s31, v91
  v_mul_f32 v92, s31, v92
  v_mul_f32 v93, s31, v93
  v_mul_f32 v94, s31, v94
  v_mul_f32 v95, s31, v95
  v_cvt_pk_bf16_f32 v96, v88, v89
  v_cvt_pk_bf16_f32 v97, v90, v91
  v_cvt_pk_bf16_f32 v98, v92, v93
  v_cvt_pk_bf16_f32 v99, v94, v95
  v_lshlrev_b32 v9, 4, v0
  buffer_store_dwordx4 v[96:99], v9, s[20:23], s25 offen
PR_done:
  s_endpgm
.globl main_kernel
.p2align 8
.type main_kernel,@function
main_kernel:
  s_cmp_ge_u32 s2, 256
  s_cbranch_scc1 MK_done
  s_load_dwordx2 s[4:5], s[0:1], 0
  s_load_dwordx2 s[6:7], s[0:1], 24
  s_load_dwordx2 s[8:9], s[0:1], 40
  v_lshrrev_b32 v15, 6, v0
  v_and_b32 v0, 63, v0
  v_readfirstlane_b32 s24, v15
  v_lshlrev_b32 v1, 4, v0
  v_add_u32 v2, 36864, v1
  s_bfe_u32 s27, s2, 0x10002
  s_bfe_u32 s28, s2, 0x10001
  s_and_b32 s29, s2, 1
  s_lshl_b32 s29, s29, 2
  s_lshr_b32 s46, s2, 6
  s_add_u32 s29, s29, s46
  s_bfe_u32 s30, s2, 0x30003
  s_mul_i32 s29, s29, 14
  s_add_i32 s29, s29, -6
  s_mul_i32 s30, s30, 14
  s_add_i32 s30, s30, -6
  s_lshr_b32 s25, s24, 1
  s_add_u32 s25, s25, 2
  s_and_b32 s25, s25, 3
  s_and_b32 s26, s24, 1
  s_and_b32 s41, s24, 3
  s_lshl_b32 s41, s41, 10
  v_and_b32 v15, 15, v0
  v_lshrrev_b32 v16, 4, v0
  v_lshrrev_b32 v17, 3, v15
  v_and_b32 v18, 7, v15
  s_sub_u32 s56, 0, s27
  s_mul_i32 s57, s27, 224
  s_sub_u32 s58, 0, s28
  s_mul_i32 s59, s28, 224
  s_mul_i32 s46, s26, 7
  s_add_i32 s46, s46, s30
  v_add_u32 v19, s46, v18
  v_max_i32 v20, 0, v19
  v_add3_u32 v19, v19, v20, 6
  v_xor_b32 v19, s58, v19
  v_add_u32 v19, s59, v19
  v_subrev_u32 v20, s30, v20
  v_mul_u32_u24 v19, 384, v19
  v_lshl_add_u32 v19, v16, 4, v19
  s_lshl_b32 s46, s25, 2
  s_mov_b32 s47, 86016
  v_cmp_gt_u32 s[48:49], 7, v18
  v_add_u32 v23, s46, v17
  v_add_u32 v5, s29, v23
  v_max_i32 v21, 0, v5
  v_add3_u32 v5, v5, v21, 6
  v_xor_b32 v5, s56, v5
  v_add_u32 v5, s57, v5
  v_subrev_u32 v21, s29, v21
  v_cmp_gt_u32 vcc, 14, v23
  v_mad_u32_u24 v5, v5, s47, v19
  s_and_b64 vcc, vcc, s[48:49]
  v_mov_b32 v23, 0x80000000
  s_nop 0
  v_cndmask_b32 v5, v23, v5, vcc
  v_cndmask_b32 v21, v23, v21, vcc
  v_add_u32 v23, s46, v17
  v_add_u32 v23, 2, v23
  v_add_u32 v6, s29, v23
  v_max_i32 v22, 0, v6
  v_add3_u32 v6, v6, v22, 6
  v_xor_b32 v6, s56, v6
  v_add_u32 v6, s57, v6
  v_subrev_u32 v22, s29, v22
  v_cmp_gt_u32 vcc, 14, v23
  v_mad_u32_u24 v6, v6, s47, v19
  s_and_b64 vcc, vcc, s[48:49]
  v_mov_b32 v23, 0x80000000
  s_nop 0
  v_cndmask_b32 v6, v23, v6, vcc
  v_cndmask_b32 v22, v23, v22, vcc
  v_cmp_gt_i32 s[42:43], 0, v5
  v_cmp_gt_i32 s[44:45], 0, v6
  v_mov_b32 v23, 70656
  v_mov_b32 v19, 0
  ds_write_b32 v23, v19
  s_waitcnt lgkmcnt(0)
  s_barrier
  s_mov_b32 s20, s8
  s_and_b32 s21, s9, 0xffff
  s_mov_b32 s22, 147456
  s_mov_b32 s23, 0x00020000
  s_mov_b32 s12, s4
  s_and_b32 s13, s5, 0xffff
  s_mov_b32 s14, 19267584
  s_mov_b32 s15, 0x00020000
  s_cmp_ge_u32 s24, 4
  s_cbranch_scc1 MK_noM
  s_mov_b32 s50, 69632
  s_mov_b32 m0, s50
  s_nop 0
  buffer_load_dwordx4 v1, s[20:23], s50 offen lds
  s_add_u32 s50, s41, 65536
  s_mov_b32 m0, s50
  s_nop 0
  buffer_load_dwordx4 v1, s[20:23], s50 offen lds
  s_add_u32 s50, s41, 61440
  s_mov_b32 m0, s50
  s_nop 0
  buffer_load_dwordx4 v1, s[20:23], s50 offen lds
  s_add_u32 s50, s41, 57344
  s_mov_b32 m0, s50
  s_nop 0
  buffer_load_dwordx4 v1, s[20:23], s50 offen lds
  s_add_u32 s50, s41, 53248
  s_mov_b32 m0, s50
  s_nop 0
  buffer_load_dwordx4 v1, s[20:23], s50 offen lds
  s_add_u32 s50, s41, 49152
  s_mov_b32 m0, s50
  s_nop 0
  buffer_load_dwordx4 v1, s[20:23], s50 offen lds
  s_add_u32 s50, s41, 45056
  s_mov_b32 m0, s50
  s_nop 0
  buffer_load_dwordx4 v1, s[20:23], s50 offen lds
  s_add_u32 s50, s41, 40960
  s_mov_b32 m0, s50
  s_nop 0
  buffer_load_dwordx4 v1, s[20:23], s50 offen lds
  s_add_u32 s50, s41, 36864
  s_mov_b32 m0, s50
  s_nop 0
  buffer_load_dwordx4 v1, s[20:23], s50 offen lds
  s_add_u32 s50, s41, 32768
  s_mov_b32 m0, s50
  s_nop 0
  buffer_load_dwordx4 v1, s[20:23], s50 offen lds
  s_add_u32 s50, s41, 28672
  s_mov_b32 m0, s50
  s_nop 0
  buffer_load_dwordx4 v1, s[20:23], s50 offen lds
  s_add_u32 s50, s41, 24576
  s_mov_b32 m0, s50
  s_nop 0
  buffer_load_dwordx4 v1, s[20:23], s50 offen lds
  s_add_u32 s50, s41, 20480
  s_mov_b32 m0, s50
  s_nop 0
  buffer_load_dwordx4 v1, s[20:23], s50 offen lds
  s_add_u32 s50, s41, 16384
  s_mov_b32 m0, s50
  s_nop 0
  buffer_load_dwordx4 v1, s[20:23], s50 offen lds
  s_add_u32 s50, s41, 12288
  s_mov_b32 m0, s50
  s_nop 0
  buffer_load_dwordx4 v1, s[20:23], s50 offen lds
  s_add_u32 s50, s41, 8192
  s_mov_b32 m0, s50
  s_nop 0
  buffer_load_dwordx4 v1, s[20:23], s50 offen lds
  s_add_u32 s50, s41, 4096
  s_mov_b32 m0, s50
  s_nop 0
  buffer_load_dwordx4 v1, s[20:23], s50 offen lds
  s_add_u32 s50, s41, 0
  s_mov_b32 m0, s50
  s_nop 0
  buffer_load_dwordx4 v1, s[20:23], s50 offen lds
MK_noM:
  s_mov_b32 s50, 70656
  buffer_load_dwordx4 v[216:219], v1, s[20:23], s50 offen offset:2048
  buffer_load_dwordx4 v[220:223], v1, s[20:23], s50 offen offset:1024
  buffer_load_dwordx4 v[224:227], v1, s[20:23], s50 offen
  buffer_load_dwordx4 v[136:139], v5, s[12:15], 0 offen offset:0
  buffer_load_dwordx4 v[160:163], v6, s[12:15], 0 offen offset:0
  buffer_load_dwordx4 v[140:143], v5, s[12:15], 0 offen offset:64
  buffer_load_dwordx4 v[164:167], v6, s[12:15], 0 offen offset:64
  buffer_load_dwordx4 v[144:147], v5, s[12:15], 0 offen offset:128
  buffer_load_dwordx4 v[168:171], v6, s[12:15], 0 offen offset:128
  buffer_load_dwordx4 v[148:151], v5, s[12:15], 0 offen offset:192
  buffer_load_dwordx4 v[172:175], v6, s[12:15], 0 offen offset:192
  buffer_load_dwordx4 v[152:155], v5, s[12:15], 0 offen offset:256
  buffer_load_dwordx4 v[176:179], v6, s[12:15], 0 offen offset:256
  buffer_load_dwordx4 v[156:159], v5, s[12:15], 0 offen offset:320
  buffer_load_dwordx4 v[180:183], v6, s[12:15], 0 offen offset:320
  s_lshl_b32 s46, s29, 1
  s_sub_i32 s47, 221, s46
  s_cmp_eq_u32 s27, 0
  s_cselect_b32 s31, s46, s47
  s_cselect_b32 s32, 1, -1
  s_mul_i32 s32, s32, 344064
  s_mul_i32 s31, s31, 86016
  s_cmp_lt_i32 s29, 0
  s_cselect_b32 s33, 3, 0
  s_lshl_b32 s39, s41, 2
  s_add_u32 s40, s39, 3072
  s_min_u32 s40, s40, 14336
  s_mul_i32 s48, s27, 172032
  s_sub_u32 s49, 172032, s48
  s_lshr_b32 s46, s39, 4
  s_add_u32 s46, s46, 0
  v_add_u32 v23, s46, v0
  v_mul_u32_u24 v13, 2731, v23
  v_lshrrev_b32 v13, 16, v13
  v_mul_u32_u24 v19, 24, v13
  v_sub_u32 v23, v23, v19
  v_cmp_le_u32 vcc, 20, v13
  v_subrev_u32 v19, 20, v13
  v_mov_b32 v232, s48
  v_cndmask_b32 v13, v13, v19, vcc
  v_mov_b32 v233, s49
  v_cndmask_b32 v232, v232, v233, vcc
  v_bfe_u32 v19, v13, 1, 3
  v_xor_b32 v23, v23, v19
  v_lshl_add_u32 v23, v23, 4, v232
  v_add_u32 v13, s30, v13
  v_max_i32 v13, 0, v13
  v_lshlrev_b32 v13, 1, v13
  v_xor_b32 v13, s58, v13
  v_add_u32 v13, s59, v13
  v_mul_u32_u24 v13, 384, v13
  v_add_u32 v13, v13, v23
  s_lshr_b32 s46, s39, 4
  s_add_u32 s46, s46, 64
  v_add_u32 v23, s46, v0
  v_mul_u32_u24 v14, 2731, v23
  v_lshrrev_b32 v14, 16, v14
  v_mul_u32_u24 v19, 24, v14
  v_sub_u32 v23, v23, v19
  v_cmp_le_u32 vcc, 20, v14
  v_subrev_u32 v19, 20, v14
  v_mov_b32 v232, s48
  v_cndmask_b32 v14, v14, v19, vcc
  v_mov_b32 v233, s49
  v_cndmask_b32 v232, v232, v233, vcc
  v_bfe_u32 v19, v14, 1, 3
  v_xor_b32 v23, v23, v19
  v_lshl_add_u32 v23, v23, 4, v232
  v_add_u32 v14, s30, v14
  v_max_i32 v14, 0, v14
  v_lshlrev_b32 v14, 1, v14
  v_xor_b32 v14, s58, v14
  v_add_u32 v14, s59, v14
  v_mul_u32_u24 v14, 384, v14
  v_add_u32 v14, v14, v23
  s_lshr_b32 s46, s39, 4
  s_add_u32 s46, s46, 128
  v_add_u32 v23, s46, v0
  v_mul_u32_u24 v3, 2731, v23
  v_lshrrev_b32 v3, 16, v3
  v_mul_u32_u24 v19, 24, v3
  v_sub_u32 v23, v23, v19
  v_cmp_le_u32 vcc, 20, v3
  v_subrev_u32 v19, 20, v3
  v_mov_b32 v232, s48
  v_cndmask_b32 v3, v3, v19, vcc
  v_mov_b32 v233, s49
  v_cndmask_b32 v232, v232, v233, vcc
  v_bfe_u32 v19, v3, 1, 3
  v_xor_b32 v23, v23, v19
  v_lshl_add_u32 v23, v23, 4, v232
  v_add_u32 v3, s30, v3
  v_max_i32 v3, 0, v3
  v_lshlrev_b32 v3, 1, v3
  v_xor_b32 v3, s58, v3
  v_add_u32 v3, s59, v3
  v_mul_u32_u24 v3, 384, v3
  v_add_u32 v3, v3, v23
  s_lshr_b32 s46, s40, 4
  v_add_u32 v23, s46, v0
  v_mul_u32_u24 v4, 2731, v23
  v_lshrrev_b32 v4, 16, v4
  v_mul_u32_u24 v19, 24, v4
  v_sub_u32 v23, v23, v19
  v_cmp_le_u32 vcc, 20, v4
  v_subrev_u32 v19, 20, v4
  v_mov_b32 v232, s48
  v_cndmask_b32 v4, v4, v19, vcc
  v_mov_b32 v233, s49
  v_cndmask_b32 v232, v232, v233, vcc
  v_bfe_u32 v19, v4, 1, 3
  v_xor_b32 v23, v23, v19
  v_lshl_add_u32 v23, v23, 4, v232
  v_add_u32 v4, s30, v4
  v_max_i32 v4, 0, v4
  v_lshlrev_b32 v4, 1, v4
  v_xor_b32 v4, s58, v4
  v_add_u32 v4, s59, v4
  v_mul_u32_u24 v4, 384, v4
  v_add_u32 v4, v4, v23
  s_add_u32 s39, s39, 10240
  s_add_u32 s40, s40, 10240
  s_mov_b32 s16, s6
  s_and_b32 s17, s7, 0xffff
  s_mov_b32 s18, 19267584
  s_mov_b32 s19, 0x00020000
  s_lshl_b32 s46, s25, 2
  s_add_u32 s46, s46, 0
  s_min_u32 s46, s46, 13
  s_add_i32 s46, s46, s29
  s_max_i32 s46, s46, 0
  s_sub_i32 s46, s46, s29
  s_lshl_b32 s34, s25, 2
  s_add_u32 s34, s34, 2
  s_min_u32 s34, s34, 13
  s_add_i32 s34, s34, s29
  s_max_i32 s34, s34, 0
  s_sub_i32 s34, s34, s29
  s_sub_u32 s46, s34, s46
  s_cmp_eq_u32 s46, 2
  s_cselect_b32 s37, -1, 7
  s_cmp_le_u32 s34, 12
  s_cselect_b32 s38, 8, 0
  s_sub_u32 s34, s34, 1
  s_add_i32 s35, s34, s37
  s_mul_i32 s37, s37, 7680
  s_add_i32 s36, s34, s38
  s_mul_i32 s38, s38, 7680
  s_lshl_b32 s47, s26, 2
  s_mul_i32 s46, s34, 7680
  s_add_u32 s46, s46, 10240
  v_add_u32 v19, s47, v15
  v_bfe_u32 v23, v19, 1, 3
  v_xor_b32 v23, v23, v16
  v_mul_u32_u24 v19, 384, v19
  v_lshl_add_u32 v19, v23, 4, v19
  v_add_u32 v7, s46, v19
  v_xor_b32 v8, 64, v7
  v_lshrrev_b32 v19, 2, v15
  v_lshl_add_u32 v19, v16, 2, v19
  v_add_u32 v19, s47, v19
  v_bfe_u32 v23, v19, 1, 3
  v_and_b32 v10, 2, v15
  v_lshlrev_b32 v10, 1, v10
  v_xor_b32 v23, v23, v10
  v_mul_u32_u24 v19, 384, v19
  v_lshl_add_u32 v19, v23, 4, v19
  v_and_b32 v23, 1, v15
  v_lshl_add_u32 v19, v23, 3, v19
  v_add_u32 v9, s46, v19
  v_xor_b32 v10, 16, v9
  v_xor_b32 v11, 32, v9
  v_xor_b32 v12, 48, v9
  v_mov_b32 v236, 0xff800000
  v_lshl_add_u32 v19, v16, 2, s47
  v_sub_u32 v19, v19, v20
  v_add_u32 v237, 0, v19
  v_add_u32 v238, 1, v19
  v_add_u32 v239, 2, v19
  v_add_u32 v240, 3, v19
  v_cmp_gt_u32 s[48:49], 7, v237
  v_cmp_gt_u32 s[50:51], 7, v238
  v_cmp_gt_u32 s[52:53], 7, v239
  v_cmp_gt_u32 s[54:55], 7, v240
  v_cndmask_b32 v232, v236, 0, s[48:49]
  v_cndmask_b32 v233, v236, 0, s[50:51]
  v_cndmask_b32 v234, v236, 0, s[52:53]
  v_cndmask_b32 v235, v236, 0, s[54:55]
  v_sub_u32 v237, s35, v21
  s_add_u32 s46, s34, 0
  v_sub_u32 v238, s46, v21
  s_add_u32 s46, s34, 1
  v_sub_u32 v239, s46, v21
  s_add_u32 s46, s34, 2
  v_sub_u32 v240, s46, v21
  v_cmp_gt_u32 s[48:49], 7, v237
  v_cmp_gt_u32 s[50:51], 7, v238
  v_cmp_gt_u32 s[52:53], 7, v239
  v_cmp_gt_u32 s[54:55], 7, v240
  v_cndmask_b32 v24, v236, v232, s[48:49]
  v_cndmask_b32 v25, v236, v233, s[48:49]
  v_cndmask_b32 v26, v236, v234, s[48:49]
  v_cndmask_b32 v27, v236, v235, s[48:49]
  v_cndmask_b32 v28, v236, v232, s[50:51]
  v_cndmask_b32 v29, v236, v233, s[50:51]
  v_cndmask_b32 v30, v236, v234, s[50:51]
  v_cndmask_b32 v31, v236, v235, s[50:51]
  v_cndmask_b32 v32, v236, v232, s[52:53]
  v_cndmask_b32 v33, v236, v233, s[52:53]
  v_cndmask_b32 v34, v236, v234, s[52:53]
  v_cndmask_b32 v35, v236, v235, s[52:53]
  v_cndmask_b32 v36, v236, v232, s[54:55]
  v_cndmask_b32 v37, v236, v233, s[54:55]
  v_cndmask_b32 v38, v236, v234, s[54:55]
  v_cndmask_b32 v39, v236, v235, s[54:55]
  s_add_u32 s46, s34, 3
  v_sub_u32 v237, s46, v21
  s_add_u32 s46, s34, 4
  v_sub_u32 v238, s46, v21
  s_add_u32 s46, s34, 5
  v_sub_u32 v239, s46, v21
  s_add_u32 s46, s34, 6
  v_sub_u32 v240, s46, v21
  v_cmp_gt_u32 s[48:49], 7, v237
  v_cmp_gt_u32 s[50:51], 7, v238
  v_cmp_gt_u32 s[52:53], 7, v239
  v_cmp_gt_u32 s[54:55], 7, v240
  v_cndmask_b32 v40, v236, v232, s[48:49]
  v_cndmask_b32 v41, v236, v233, s[48:49]
  v_cndmask_b32 v42, v236, v234, s[48:49]
  v_cndmask_b32 v43, v236, v235, s[48:49]
  v_cndmask_b32 v44, v236, v232, s[50:51]
  v_cndmask_b32 v45, v236, v233, s[50:51]
  v_cndmask_b32 v46, v236, v234, s[50:51]
  v_cndmask_b32 v47, v236, v235, s[50:51]
  v_cndmask_b32 v48, v236, v232, s[52:53]
  v_cndmask_b32 v49, v236, v233, s[52:53]
  v_cndmask_b32 v50, v236, v234, s[52:53]
  v_cndmask_b32 v51, v236, v235, s[52:53]
  v_cndmask_b32 v52, v236, v232, s[54:55]
  v_cndmask_b32 v53, v236, v233, s[54:55]
  v_cndmask_b32 v54, v236, v234, s[54:55]
  v_cndmask_b32 v55, v236, v235, s[54:55]
  s_add_u32 s46, s34, 1
  v_sub_u32 v237, s46, v22
  s_add_u32 s46, s34, 2
  v_sub_u32 v238, s46, v22
  s_add_u32 s46, s34, 3
  v_sub_u32 v239, s46, v22
  s_add_u32 s46, s34, 4
  v_sub_u32 v240, s46, v22
  v_cmp_gt_u32 s[48:49], 7, v237
  v_cmp_gt_u32 s[50:51], 7, v238
  v_cmp_gt_u32 s[52:53], 7, v239
  v_cmp_gt_u32 s[54:55], 7, v240
  v_cndmask_b32 v56, v236, v232, s[48:49]
  v_cndmask_b32 v57, v236, v233, s[48:49]
  v_cndmask_b32 v58, v236, v234, s[48:49]
  v_cndmask_b32 v59, v236, v235, s[48:49]
  v_cndmask_b32 v60, v236, v232, s[50:51]
  v_cndmask_b32 v61, v236, v233, s[50:51]
  v_cndmask_b32 v62, v236, v234, s[50:51]
  v_cndmask_b32 v63, v236, v235, s[50:51]
  v_cndmask_b32 v64, v236, v232, s[52:53]
  v_cndmask_b32 v65, v236, v233, s[52:53]
  v_cndmask_b32 v66, v236, v234, s[52:53]
  v_cndmask_b32 v67, v236, v235, s[52:53]
  v_cndmask_b32 v68, v236, v232, s[54:55]
  v_cndmask_b32 v69, v236, v233, s[54:55]
  v_cndmask_b32 v70, v236, v234, s[54:55]
  v_cndmask_b32 v71, v236, v235, s[54:55]
  s_add_u32 s46, s34, 5
  v_sub_u32 v237, s46, v22
  s_add_u32 s46, s34, 6
  v_sub_u32 v238, s46, v22
  s_add_u32 s46, s34, 7
  v_sub_u32 v239, s46, v22
  v_sub_u32 v240, s36, v22
  v_cmp_gt_u32 s[48:49], 7, v237
  v_cmp_gt_u32 s[50:51], 7, v238
  v_cmp_gt_u32 s[52:53], 7, v239
  v_cmp_gt_u32 s[54:55], 7, v240
  v_cndmask_b32 v72, v236, v232, s[48:49]
  v_cndmask_b32 v73, v236, v233, s[48:49]
  v_cndmask_b32 v74, v236, v234, s[48:49]
  v_cndmask_b32 v75, v236, v235, s[48:49]
  v_cndmask_b32 v76, v236, v232, s[50:51]
  v_cndmask_b32 v77, v236, v233, s[50:51]
  v_cndmask_b32 v78, v236, v234, s[50:51]
  v_cndmask_b32 v79, v236, v235, s[50:51]
  v_cndmask_b32 v80, v236, v232, s[52:53]
  v_cndmask_b32 v81, v236, v233, s[52:53]
  v_cndmask_b32 v82, v236, v234, s[52:53]
  v_cndmask_b32 v83, v236, v235, s[52:53]
  v_cndmask_b32 v84, v236, v232, s[54:55]
  v_cndmask_b32 v85, v236, v233, s[54:55]
  v_cndmask_b32 v86, v236, v234, s[54:55]
  v_cndmask_b32 v87, v236, v235, s[54:55]
  v_add_u32 v15, s38, v7
  v_add_u32 v16, s38, v8
  v_add_u32 v17, s37, v7
  v_add_u32 v18, s37, v8
  s_cmp_lt_u32 s24, 4
  s_cselect_b64 vcc, -1, 0
  v_mov_b32 v23, 70656
  s_cbranch_vccz MK_p0
  s_waitcnt vmcnt(15)
  v_mov_b32 v19, 1
  s_mov_b64 exec, 1
  ds_add_u32 v23, v19
  s_mov_b64 exec, -1
MK_p0:
  ds_read_b32 v19, v23
  s_waitcnt lgkmcnt(0)
  v_readfirstlane_b32 s46, v19
  s_cmp_lt_u32 s46, 4
  s_cbranch_scc1 MK_p0
  ds_read_b128 v[228:231], v2 offset:32768
  ds_read_b128 v[232:235], v2 offset:31744
  ds_read_b128 v[236:239], v2 offset:30720
  ds_read_b128 v[240:243], v2 offset:29696
  ds_read_b128 v[244:247], v2 offset:28672
  ds_read_b128 v[248:251], v2 offset:27648
  ds_read_b128 v[252:255], v2 offset:26624
  s_waitcnt vmcnt(10)
  v_mfma_f32_16x16x32_bf16 v[184:187], v[216:219], v[136:139], 0
  v_mfma_f32_16x16x32_bf16 v[192:195], v[216:219], v[160:163], 0
  ds_read_b128 v[216:219], v2 offset:25600
  v_mfma_f32_16x16x32_bf16 v[188:191], v[220:223], v[136:139], 0
  v_mfma_f32_16x16x32_bf16 v[196:199], v[220:223], v[160:163], 0
  ds_read_b128 v[220:223], v2 offset:24576
  s_waitcnt vmcnt(8)
  v_mfma_f32_16x16x32_bf16 v[184:187], v[224:227], v[140:143], v[184:187]
  v_mfma_f32_16x16x32_bf16 v[192:195], v[224:227], v[164:167], v[192:195]
  ds_read_b128 v[224:227], v2 offset:23552
  s_waitcnt lgkmcnt(8)
  v_mfma_f32_16x16x32_bf16 v[188:191], v[228:231], v[140:143], v[188:191]
  v_mfma_f32_16x16x32_bf16 v[196:199], v[228:231], v[164:167], v[196:199]
  ds_read_b128 v[228:231], v2 offset:22528
  s_waitcnt vmcnt(6)
  v_mfma_f32_16x16x32_bf16 v[184:187], v[232:235], v[144:147], v[184:187]
  v_mfma_f32_16x16x32_bf16 v[192:195], v[232:235], v[168:171], v[192:195]
  ds_read_b128 v[232:235], v2 offset:21504
  s_waitcnt lgkmcnt(8)
  v_mfma_f32_16x16x32_bf16 v[188:191], v[236:239], v[144:147], v[188:191]
  v_mfma_f32_16x16x32_bf16 v[196:199], v[236:239], v[168:171], v[196:199]
  ds_read_b128 v[236:239], v2 offset:20480
  s_waitcnt vmcnt(4)
  v_mfma_f32_16x16x32_bf16 v[184:187], v[240:243], v[148:151], v[184:187]
  v_mfma_f32_16x16x32_bf16 v[192:195], v[240:243], v[172:175], v[192:195]
  ds_read_b128 v[240:243], v2 offset:19456
  s_waitcnt lgkmcnt(8)
  v_mfma_f32_16x16x32_bf16 v[188:191], v[244:247], v[148:151], v[188:191]
  v_mfma_f32_16x16x32_bf16 v[196:199], v[244:247], v[172:175], v[196:199]
  ds_read_b128 v[244:247], v2 offset:18432
  s_waitcnt vmcnt(2)
  v_mfma_f32_16x16x32_bf16 v[184:187], v[248:251], v[152:155], v[184:187]
  v_mfma_f32_16x16x32_bf16 v[192:195], v[248:251], v[176:179], v[192:195]
  ds_read_b128 v[248:251], v2 offset:17408
  s_waitcnt lgkmcnt(8)
  v_mfma_f32_16x16x32_bf16 v[188:191], v[252:255], v[152:155], v[188:191]
  v_mfma_f32_16x16x32_bf16 v[196:199], v[252:255], v[176:179], v[196:199]
  ds_read_b128 v[252:255], v2 offset:16384
  s_waitcnt vmcnt(0)
  v_mfma_f32_16x16x32_bf16 v[184:187], v[216:219], v[156:159], v[184:187]
  v_mfma_f32_16x16x32_bf16 v[192:195], v[216:219], v[180:183], v[192:195]
  ds_read_b128 v[216:219], v2 offset:15360
  s_waitcnt lgkmcnt(8)
  v_mfma_f32_16x16x32_bf16 v[188:191], v[220:223], v[156:159], v[188:191]
  v_mfma_f32_16x16x32_bf16 v[196:199], v[220:223], v[180:183], v[196:199]
  ds_read_b128 v[220:223], v2 offset:14336
  v_mfma_f32_16x16x32_bf16 v[200:203], v[224:227], v[136:139], 0
  v_mfma_f32_16x16x32_bf16 v[208:211], v[224:227], v[160:163], 0
  ds_read_b128 v[224:227], v2 offset:13312
  s_waitcnt lgkmcnt(8)
  v_mfma_f32_16x16x32_bf16 v[204:207], v[228:231], v[136:139], 0
  v_cvt_pk_bf16_f32 v88, v184, v185
  v_cvt_pk_bf16_f32 v89, v186, v187
  v_mfma_f32_16x16x32_bf16 v[212:215], v[228:231], v[160:163], 0
  ds_read_b128 v[228:231], v2 offset:12288
  v_cvt_pk_bf16_f32 v90, v188, v189
  v_mfma_f32_16x16x32_bf16 v[200:203], v[232:235], v[140:143], v[200:203]
  v_cvt_pk_bf16_f32 v91, v190, v191
  v_cvt_pk_bf16_f32 v112, v192, v193
  v_mfma_f32_16x16x32_bf16 v[208:211], v[232:235], v[164:167], v[208:211]
  ds_read_b128 v[232:235], v2 offset:11264
  s_waitcnt lgkmcnt(8)
  v_mfma_f32_16x16x32_bf16 v[204:207], v[236:239], v[140:143], v[204:207]
  v_cvt_pk_bf16_f32 v113, v194, v195
  v_cvt_pk_bf16_f32 v114, v196, v197
  v_mfma_f32_16x16x32_bf16 v[212:215], v[236:239], v[164:167], v[212:215]
  ds_read_b128 v[236:239], v2 offset:10240
  v_cvt_pk_bf16_f32 v115, v198, v199
  v_mfma_f32_16x16x32_bf16 v[200:203], v[240:243], v[144:147], v[200:203]
  v_mfma_f32_16x16x32_bf16 v[208:211], v[240:243], v[168:171], v[208:211]
  ds_read_b128 v[240:243], v2 offset:9216
  s_waitcnt lgkmcnt(8)
  v_mfma_f32_16x16x32_bf16 v[204:207], v[244:247], v[144:147], v[204:207]
  v_mfma_f32_16x16x32_bf16 v[212:215], v[244:247], v[168:171], v[212:215]
  ds_read_b128 v[244:247], v2 offset:8192
  v_mfma_f32_16x16x32_bf16 v[200:203], v[248:251], v[148:151], v[200:203]
  v_mfma_f32_16x16x32_bf16 v[208:211], v[248:251], v[172:175], v[208:211]
  ds_read_b128 v[248:251], v2 offset:7168
  s_waitcnt lgkmcnt(8)
  v_mfma_f32_16x16x32_bf16 v[204:207], v[252:255], v[148:151], v[204:207]
  v_mfma_f32_16x16x32_bf16 v[212:215], v[252:255], v[172:175], v[212:215]
  ds_read_b128 v[252:255], v2 offset:6144
  v_mfma_f32_16x16x32_bf16 v[200:203], v[216:219], v[152:155], v[200:203]
  v_mfma_f32_16x16x32_bf16 v[208:211], v[216:219], v[176:179], v[208:211]
  ds_read_b128 v[216:219], v2 offset:5120
  s_waitcnt lgkmcnt(8)
  v_mfma_f32_16x16x32_bf16 v[204:207], v[220:223], v[152:155], v[204:207]
  v_mfma_f32_16x16x32_bf16 v[212:215], v[220:223], v[176:179], v[212:215]
  ds_read_b128 v[220:223], v2 offset:4096
  v_mfma_f32_16x16x32_bf16 v[200:203], v[224:227], v[156:159], v[200:203]
  v_mfma_f32_16x16x32_bf16 v[208:211], v[224:227], v[180:183], v[208:211]
  ds_read_b128 v[224:227], v2 offset:3072
  s_waitcnt lgkmcnt(8)
  v_mfma_f32_16x16x32_bf16 v[204:207], v[228:231], v[156:159], v[204:207]
  v_mfma_f32_16x16x32_bf16 v[212:215], v[228:231], v[180:183], v[212:215]
  ds_read_b128 v[228:231], v2 offset:2048
  v_mfma_f32_16x16x32_bf16 v[184:187], v[232:235], v[136:139], 0
  v_mfma_f32_16x16x32_bf16 v[192:195], v[232:235], v[160:163], 0
  ds_read_b128 v[232:235], v2 offset:1024
  s_waitcnt lgkmcnt(8)
  v_mfma_f32_16x16x32_bf16 v[188:191], v[236:239], v[136:139], 0
  v_cvt_pk_bf16_f32 v92, v200, v201
  v_cvt_pk_bf16_f32 v93, v202, v203
  v_mfma_f32_16x16x32_bf16 v[196:199], v[236:239], v[160:163], 0
  ds_read_b128 v[236:239], v2 offset:0
  v_cvt_pk_bf16_f32 v94, v204, v205
  v_mfma_f32_16x16x32_bf16 v[184:187], v[240:243], v[140:143], v[184:187]
  v_cvt_pk_bf16_f32 v95, v206, v207
  v_cvt_pk_bf16_f32 v116, v208, v209
  v_mfma_f32_16x16x32_bf16 v[192:195], v[240:243], v[164:167], v[192:195]
  ds_read_b128 v[240:243], v1 offset:35840
  s_waitcnt lgkmcnt(8)
  v_mfma_f32_16x16x32_bf16 v[188:191], v[244:247], v[140:143], v[188:191]
  v_cvt_pk_bf16_f32 v117, v210, v211
  v_cvt_pk_bf16_f32 v118, v212, v213
  v_mfma_f32_16x16x32_bf16 v[196:199], v[244:247], v[164:167], v[196:199]
  ds_read_b128 v[244:247], v1 offset:34816
  v_cvt_pk_bf16_f32 v119, v214, v215
  v_mfma_f32_16x16x32_bf16 v[184:187], v[248:251], v[144:147], v[184:187]
  v_mfma_f32_16x16x32_bf16 v[192:195], v[248:251], v[168:171], v[192:195]
  ds_read_b128 v[248:251], v1 offset:33792
  s_waitcnt lgkmcnt(8)
  v_mfma_f32_16x16x32_bf16 v[188:191], v[252:255], v[144:147], v[188:191]
  v_mfma_f32_16x16x32_bf16 v[196:199], v[252:255], v[168:171], v[196:199]
  ds_read_b128 v[252:255], v1 offset:32768
  v_mfma_f32_16x16x32_bf16 v[184:187], v[216:219], v[148:151], v[184:187]
  v_mfma_f32_16x16x32_bf16 v[192:195], v[216:219], v[172:175], v[192:195]
  ds_read_b128 v[216:219], v1 offset:31744
  s_waitcnt lgkmcnt(8)
  s_cbranch_vccnz RL1
  s_barrier
RL1:
  v_mfma_f32_16x16x32_bf16 v[188:191], v[220:223], v[148:151], v[188:191]
  v_mfma_f32_16x16x32_bf16 v[196:199], v[220:223], v[172:175], v[196:199]
  ds_read_b128 v[220:223], v1 offset:30720
  v_mfma_f32_16x16x32_bf16 v[184:187], v[224:227], v[152:155], v[184:187]
  v_mfma_f32_16x16x32_bf16 v[192:195], v[224:227], v[176:179], v[192:195]
  ds_read_b128 v[224:227], v1 offset:29696
  s_waitcnt lgkmcnt(8)
  v_mfma_f32_16x16x32_bf16 v[188:191], v[228:231], v[152:155], v[188:191]
  v_mfma_f32_16x16x32_bf16 v[196:199], v[228:231], v[176:179], v[196:199]
  ds_read_b128 v[228:231], v1 offset:28672
  v_mfma_f32_16x16x32_bf16 v[184:187], v[232:235], v[156:159], v[184:187]
  v_mfma_f32_16x16x32_bf16 v[192:195], v[232:235], v[180:183], v[192:195]
  ds_read_b128 v[232:235], v1 offset:27648
  s_waitcnt lgkmcnt(8)
  v_mfma_f32_16x16x32_bf16 v[188:191], v[236:239], v[156:159], v[188:191]
  v_mfma_f32_16x16x32_bf16 v[196:199], v[236:239], v[180:183], v[196:199]
  ds_read_b128 v[236:239], v1 offset:26624
  v_mfma_f32_16x16x32_bf16 v[200:203], v[240:243], v[136:139], 0
  v_mfma_f32_16x16x32_bf16 v[208:211], v[240:243], v[160:163], 0
  ds_read_b128 v[240:243], v1 offset:25600
  s_waitcnt lgkmcnt(8)
  v_mfma_f32_16x16x32_bf16 v[204:207], v[244:247], v[136:139], 0
  v_cvt_pk_bf16_f32 v96, v184, v185
  v_cvt_pk_bf16_f32 v97, v186, v187
  v_mfma_f32_16x16x32_bf16 v[212:215], v[244:247], v[160:163], 0
  ds_read_b128 v[244:247], v1 offset:24576
  v_cvt_pk_bf16_f32 v98, v188, v189
  v_mfma_f32_16x16x32_bf16 v[200:203], v[248:251], v[140:143], v[200:203]
  v_cvt_pk_bf16_f32 v99, v190, v191
  v_cvt_pk_bf16_f32 v120, v192, v193
  v_mfma_f32_16x16x32_bf16 v[208:211], v[248:251], v[164:167], v[208:211]
  ds_read_b128 v[248:251], v1 offset:23552
  s_waitcnt lgkmcnt(8)
  v_mfma_f32_16x16x32_bf16 v[204:207], v[252:255], v[140:143], v[204:207]
  v_cvt_pk_bf16_f32 v121, v194, v195
  v_cvt_pk_bf16_f32 v122, v196, v197
  v_mfma_f32_16x16x32_bf16 v[212:215], v[252:255], v[164:167], v[212:215]
  ds_read_b128 v[252:255], v1 offset:22528
  v_cvt_pk_bf16_f32 v123, v198, v199
  v_mfma_f32_16x16x32_bf16 v[200:203], v[216:219], v[144:147], v[200:203]
  v_mfma_f32_16x16x32_bf16 v[208:211], v[216:219], v[168:171], v[208:211]
  ds_read_b128 v[216:219], v1 offset:21504
  s_waitcnt lgkmcnt(8)
  v_mfma_f32_16x16x32_bf16 v[204:207], v[220:223], v[144:147], v[204:207]
  v_mfma_f32_16x16x32_bf16 v[212:215], v[220:223], v[168:171], v[212:215]
  ds_read_b128 v[220:223], v1 offset:20480
  v_mfma_f32_16x16x32_bf16 v[200:203], v[224:227], v[148:151], v[200:203]
  v_mfma_f32_16x16x32_bf16 v[208:211], v[224:227], v[172:175], v[208:211]
  ds_read_b128 v[224:227], v1 offset:19456
  s_waitcnt lgkmcnt(8)
  v_mfma_f32_16x16x32_bf16 v[204:207], v[228:231], v[148:151], v[204:207]
  v_mfma_f32_16x16x32_bf16 v[212:215], v[228:231], v[172:175], v[212:215]
  ds_read_b128 v[228:231], v1 offset:18432
  v_mfma_f32_16x16x32_bf16 v[200:203], v[232:235], v[152:155], v[200:203]
  v_mfma_f32_16x16x32_bf16 v[208:211], v[232:235], v[176:179], v[208:211]
  ds_read_b128 v[232:235], v1 offset:17408
  s_waitcnt lgkmcnt(8)
  v_mfma_f32_16x16x32_bf16 v[204:207], v[236:239], v[152:155], v[204:207]
  v_mfma_f32_16x16x32_bf16 v[212:215], v[236:239], v[176:179], v[212:215]
  ds_read_b128 v[236:239], v1 offset:16384
  v_mfma_f32_16x16x32_bf16 v[200:203], v[240:243], v[156:159], v[200:203]
  v_mfma_f32_16x16x32_bf16 v[208:211], v[240:243], v[180:183], v[208:211]
  ds_read_b128 v[240:243], v1 offset:15360
  s_waitcnt lgkmcnt(8)
  v_mfma_f32_16x16x32_bf16 v[204:207], v[244:247], v[156:159], v[204:207]
  v_mfma_f32_16x16x32_bf16 v[212:215], v[244:247], v[180:183], v[212:215]
  ds_read_b128 v[244:247], v1 offset:14336
  v_mfma_f32_16x16x32_bf16 v[184:187], v[248:251], v[136:139], 0
  v_mfma_f32_16x16x32_bf16 v[192:195], v[248:251], v[160:163], 0
  ds_read_b128 v[248:251], v1 offset:13312
  s_waitcnt lgkmcnt(8)
  v_mfma_f32_16x16x32_bf16 v[188:191], v[252:255], v[136:139], 0
  v_cvt_pk_bf16_f32 v100, v200, v201
  v_cvt_pk_bf16_f32 v101, v202, v203
  v_mfma_f32_16x16x32_bf16 v[196:199], v[252:255], v[160:163], 0
  ds_read_b128 v[252:255], v1 offset:12288
  v_cvt_pk_bf16_f32 v102, v204, v205
  v_mfma_f32_16x16x32_bf16 v[184:187], v[216:219], v[140:143], v[184:187]
  v_cvt_pk_bf16_f32 v103, v206, v207
  v_cvt_pk_bf16_f32 v124, v208, v209
  v_mfma_f32_16x16x32_bf16 v[192:195], v[216:219], v[164:167], v[192:195]
  ds_read_b128 v[216:219], v1 offset:11264
  s_waitcnt lgkmcnt(8)
  v_mfma_f32_16x16x32_bf16 v[188:191], v[220:223], v[140:143], v[188:191]
  v_cvt_pk_bf16_f32 v125, v210, v211
  v_cvt_pk_bf16_f32 v126, v212, v213
  v_mfma_f32_16x16x32_bf16 v[196:199], v[220:223], v[164:167], v[196:199]
  ds_read_b128 v[220:223], v1 offset:10240
  v_cvt_pk_bf16_f32 v127, v214, v215
  v_mfma_f32_16x16x32_bf16 v[184:187], v[224:227], v[144:147], v[184:187]
  v_mfma_f32_16x16x32_bf16 v[192:195], v[224:227], v[168:171], v[192:195]
  ds_read_b128 v[224:227], v1 offset:9216
  s_waitcnt lgkmcnt(8)
  v_mfma_f32_16x16x32_bf16 v[188:191], v[228:231], v[144:147], v[188:191]
  v_mfma_f32_16x16x32_bf16 v[196:199], v[228:231], v[168:171], v[196:199]
  ds_read_b128 v[228:231], v1 offset:8192
  v_mfma_f32_16x16x32_bf16 v[184:187], v[232:235], v[148:151], v[184:187]
  v_mfma_f32_16x16x32_bf16 v[192:195], v[232:235], v[172:175], v[192:195]
  ds_read_b128 v[232:235], v1 offset:7168
  s_waitcnt lgkmcnt(8)
  v_mfma_f32_16x16x32_bf16 v[188:191], v[236:239], v[148:151], v[188:191]
  v_mfma_f32_16x16x32_bf16 v[196:199], v[236:239], v[172:175], v[196:199]
  ds_read_b128 v[236:239], v1 offset:6144
  v_mfma_f32_16x16x32_bf16 v[184:187], v[240:243], v[152:155], v[184:187]
  v_mfma_f32_16x16x32_bf16 v[192:195], v[240:243], v[176:179], v[192:195]
  ds_read_b128 v[240:243], v1 offset:5120
  s_waitcnt lgkmcnt(8)
  v_mfma_f32_16x16x32_bf16 v[188:191], v[244:247], v[152:155], v[188:191]
  v_mfma_f32_16x16x32_bf16 v[196:199], v[244:247], v[176:179], v[196:199]
  ds_read_b128 v[244:247], v1 offset:4096
  v_mfma_f32_16x16x32_bf16 v[184:187], v[248:251], v[156:159], v[184:187]
  v_mfma_f32_16x16x32_bf16 v[192:195], v[248:251], v[180:183], v[192:195]
  ds_read_b128 v[248:251], v1 offset:3072
  s_waitcnt lgkmcnt(8)
  v_mfma_f32_16x16x32_bf16 v[188:191], v[252:255], v[156:159], v[188:191]
  v_mfma_f32_16x16x32_bf16 v[196:199], v[252:255], v[180:183], v[196:199]
  ds_read_b128 v[252:255], v1 offset:2048
  v_mfma_f32_16x16x32_bf16 v[200:203], v[216:219], v[136:139], 0
  v_mfma_f32_16x16x32_bf16 v[208:211], v[216:219], v[160:163], 0
  ds_read_b128 v[216:219], v1 offset:1024
  s_waitcnt lgkmcnt(8)
  s_cbranch_vccnz RL2
  s_barrier
RL2:
  v_mfma_f32_16x16x32_bf16 v[204:207], v[220:223], v[136:139], 0
  v_cvt_pk_bf16_f32 v104, v184, v185
  v_cvt_pk_bf16_f32 v105, v186, v187
  v_mfma_f32_16x16x32_bf16 v[212:215], v[220:223], v[160:163], 0
  ds_read_b128 v[220:223], v1 offset:0
  v_cvt_pk_bf16_f32 v106, v188, v189
  v_mfma_f32_16x16x32_bf16 v[200:203], v[224:227], v[140:143], v[200:203]
  v_cvt_pk_bf16_f32 v107, v190, v191
  v_cvt_pk_bf16_f32 v128, v192, v193
  v_mfma_f32_16x16x32_bf16 v[208:211], v[224:227], v[164:167], v[208:211]
  v_cvt_pk_bf16_f32 v129, v194, v195
  s_waitcnt lgkmcnt(7)
  v_mfma_f32_16x16x32_bf16 v[204:207], v[228:231], v[140:143], v[204:207]
  v_cvt_pk_bf16_f32 v130, v196, v197
  v_cvt_pk_bf16_f32 v131, v198, v199
  v_mfma_f32_16x16x32_bf16 v[212:215], v[228:231], v[164:167], v[212:215]
  v_mfma_f32_16x16x32_bf16 v[200:203], v[232:235], v[144:147], v[200:203]
  v_mfma_f32_16x16x32_bf16 v[208:211], v[232:235], v[168:171], v[208:211]
  s_waitcnt lgkmcnt(5)
  v_mfma_f32_16x16x32_bf16 v[204:207], v[236:239], v[144:147], v[204:207]
  v_mfma_f32_16x16x32_bf16 v[212:215], v[236:239], v[168:171], v[212:215]
  v_mfma_f32_16x16x32_bf16 v[200:203], v[240:243], v[148:151], v[200:203]
  v_mfma_f32_16x16x32_bf16 v[208:211], v[240:243], v[172:175], v[208:211]
  s_waitcnt lgkmcnt(4)
  v_mfma_f32_16x16x32_bf16 v[204:207], v[244:247], v[148:151], v[204:207]
  v_mfma_f32_16x16x32_bf16 v[212:215], v[244:247], v[172:175], v[212:215]
  s_waitcnt lgkmcnt(3)
  v_mfma_f32_16x16x32_bf16 v[200:203], v[248:251], v[152:155], v[200:203]
  v_mfma_f32_16x16x32_bf16 v[208:211], v[248:251], v[176:179], v[208:211]
  s_waitcnt lgkmcnt(2)
  v_mfma_f32_16x16x32_bf16 v[204:207], v[252:255], v[152:155], v[204:207]
  v_mfma_f32_16x16x32_bf16 v[212:215], v[252:255], v[176:179], v[212:215]
  s_waitcnt lgkmcnt(1)
  v_mfma_f32_16x16x32_bf16 v[200:203], v[216:219], v[156:159], v[200:203]
  v_mfma_f32_16x16x32_bf16 v[208:211], v[216:219], v[180:183], v[208:211]
  s_waitcnt lgkmcnt(0)
  v_mfma_f32_16x16x32_bf16 v[204:207], v[220:223], v[156:159], v[204:207]
  v_mfma_f32_16x16x32_bf16 v[212:215], v[220:223], v[180:183], v[212:215]
  s_nop 3
  v_cvt_pk_bf16_f32 v108, v200, v201
  v_cvt_pk_bf16_f32 v109, v202, v203
  s_nop 0
  v_cvt_pk_bf16_f32 v110, v204, v205
  v_cvt_pk_bf16_f32 v111, v206, v207
  v_cvt_pk_bf16_f32 v132, v208, v209
  v_cvt_pk_bf16_f32 v133, v210, v211
  v_cvt_pk_bf16_f32 v134, v212, v213
  v_cvt_pk_bf16_f32 v135, v214, v215
  v_add_u32 v2, 117760, v1
  v_mov_b32 v192, 0x3f803f80
  v_mov_b32 v193, 0x3f803f80
  v_mov_b32 v194, 0x3f803f80
  v_mov_b32 v195, 0x3f803f80
  s_cbranch_vccz RL3
  s_mul_i32 s50, s32, 9
  s_add_i32 s50, s50, s31
  s_add_u32 m0, s39, 138240
  s_nop 0
  buffer_load_dwordx4 v13, s[12:15], s50 offen lds
  s_add_u32 m0, s39, 139264
  s_nop 0
  buffer_load_dwordx4 v14, s[12:15], s50 offen lds
  s_add_u32 m0, s39, 140288
  s_nop 0
  buffer_load_dwordx4 v3, s[12:15], s50 offen lds
  s_add_u32 m0, s40, 138240
  s_nop 0
  buffer_load_dwordx4 v4, s[12:15], s50 offen lds
  s_mul_i32 s50, s32, 8
  s_add_i32 s50, s50, s31
  s_add_u32 m0, s39, 122880
  s_nop 0
  buffer_load_dwordx4 v13, s[12:15], s50 offen lds
  s_add_u32 m0, s39, 123904
  s_nop 0
  buffer_load_dwordx4 v14, s[12:15], s50 offen lds
  s_add_u32 m0, s39, 124928
  s_nop 0
  buffer_load_dwordx4 v3, s[12:15], s50 offen lds
  s_add_u32 m0, s40, 122880
  s_nop 0
  buffer_load_dwordx4 v4, s[12:15], s50 offen lds
  s_mul_i32 s50, s32, 7
  s_add_i32 s50, s50, s31
  s_add_u32 m0, s39, 107520
  s_nop 0
  buffer_load_dwordx4 v13, s[12:15], s50 offen lds
  s_add_u32 m0, s39, 108544
  s_nop 0
  buffer_load_dwordx4 v14, s[12:15], s50 offen lds
  s_add_u32 m0, s39, 109568
  s_nop 0
  buffer_load_dwordx4 v3, s[12:15], s50 offen lds
  s_add_u32 m0, s40, 107520
  s_nop 0
  buffer_load_dwordx4 v4, s[12:15], s50 offen lds
  s_mul_i32 s50, s32, 6
  s_add_i32 s50, s50, s31
  s_add_u32 m0, s39, 92160
  s_nop 0
  buffer_load_dwordx4 v13, s[12:15], s50 offen lds
  s_add_u32 m0, s39, 93184
  s_nop 0
  buffer_load_dwordx4 v14, s[12:15], s50 offen lds
  s_add_u32 m0, s39, 94208
  s_nop 0
  buffer_load_dwordx4 v3, s[12:15], s50 offen lds
  s_add_u32 m0, s40, 92160
  s_nop 0
  buffer_load_dwordx4 v4, s[12:15], s50 offen lds
  s_mul_i32 s50, s32, 5
  s_add_i32 s50, s50, s31
  s_add_u32 m0, s39, 76800
  s_nop 0
  buffer_load_dwordx4 v13, s[12:15], s50 offen lds
  s_add_u32 m0, s39, 77824
  s_nop 0
  buffer_load_dwordx4 v14, s[12:15], s50 offen lds
  s_add_u32 m0, s39, 78848
  s_nop 0
  buffer_load_dwordx4 v3, s[12:15], s50 offen lds
  s_add_u32 m0, s40, 76800
  s_nop 0
  buffer_load_dwordx4 v4, s[12:15], s50 offen lds
  s_mul_i32 s50, s32, 4
  s_add_i32 s50, s50, s31
  s_add_u32 m0, s39, 61440
  s_nop 0
  buffer_load_dwordx4 v13, s[12:15], s50 offen lds
  s_add_u32 m0, s39, 62464
  s_nop 0
  buffer_load_dwordx4 v14, s[12:15], s50 offen lds
  s_add_u32 m0, s39, 63488
  s_nop 0
  buffer_load_dwordx4 v3, s[12:15], s50 offen lds
  s_add_u32 m0, s40, 61440
  s_nop 0
  buffer_load_dwordx4 v4, s[12:15], s50 offen lds
  s_barrier
  s_mul_i32 s50, s32, 3
  s_add_i32 s50, s50, s31
  s_add_u32 m0, s39, 46080
  s_nop 0
  buffer_load_dwordx4 v13, s[12:15], s50 offen lds
  s_add_u32 m0, s39, 47104
  s_nop 0
  buffer_load_dwordx4 v14, s[12:15], s50 offen lds
  s_add_u32 m0, s39, 48128
  s_nop 0
  buffer_load_dwordx4 v3, s[12:15], s50 offen lds
  s_add_u32 m0, s40, 46080
  s_nop 0
  buffer_load_dwordx4 v4, s[12:15], s50 offen lds
  s_max_u32 s50, s33, 2
  s_mul_i32 s50, s50, s32
  s_add_i32 s50, s50, s31
  s_add_u32 m0, s39, 30720
  s_nop 0
  buffer_load_dwordx4 v13, s[12:15], s50 offen lds
  s_add_u32 m0, s39, 31744
  s_nop 0
  buffer_load_dwordx4 v14, s[12:15], s50 offen lds
  s_add_u32 m0, s39, 32768
  s_nop 0
  buffer_load_dwordx4 v3, s[12:15], s50 offen lds
  s_add_u32 m0, s40, 30720
  s_nop 0
  buffer_load_dwordx4 v4, s[12:15], s50 offen lds
  s_waitcnt vmcnt(8)
  s_barrier
  s_max_u32 s50, s33, 1
  s_mul_i32 s50, s50, s32
  s_add_i32 s50, s50, s31
  s_add_u32 m0, s39, 15360
  s_nop 0
  buffer_load_dwordx4 v13, s[12:15], s50 offen lds
  s_add_u32 m0, s39, 16384
  s_nop 0
  buffer_load_dwordx4 v14, s[12:15], s50 offen lds
  s_add_u32 m0, s39, 17408
  s_nop 0
  buffer_load_dwordx4 v3, s[12:15], s50 offen lds
  s_add_u32 m0, s40, 15360
  s_nop 0
  buffer_load_dwordx4 v4, s[12:15], s50 offen lds
  s_max_u32 s50, s33, 0
  s_mul_i32 s50, s50, s32
  s_add_i32 s50, s50, s31
  s_add_u32 m0, s39, 0
  s_nop 0
  buffer_load_dwordx4 v13, s[12:15], s50 offen lds
  s_add_u32 m0, s39, 1024
  s_nop 0
  buffer_load_dwordx4 v14, s[12:15], s50 offen lds
  s_add_u32 m0, s39, 2048
  s_nop 0
  buffer_load_dwordx4 v3, s[12:15], s50 offen lds
  s_add_u32 m0, s40, 0
  s_nop 0
  buffer_load_dwordx4 v4, s[12:15], s50 offen lds
  s_branch RM3
RL3:
  s_barrier
RM3:
  ds_read_b128 v[224:227], v17 offset:0
  ds_read_b128 v[228:231], v18 offset:0
  ds_read_b128 v[232:235], v17 offset:128
  ds_read_b128 v[236:239], v18 offset:128
  ds_read_b128 v[240:243], v17 offset:256
  ds_read_b128 v[244:247], v18 offset:256
  ds_read_b128 v[248:251], v7 offset:0
  ds_read_b128 v[252:255], v8 offset:0
  ds_read_b128 v[216:219], v7 offset:128
  ds_read_b128 v[220:223], v8 offset:128
  s_waitcnt lgkmcnt(8)
  v_mfma_f32_16x16x32_bf16 v[24:27], v[224:227], v[88:91], v[24:27]
  ds_read_b128 v[224:227], v7 offset:256
  v_mfma_f32_16x16x32_bf16 v[24:27], v[228:231], v[92:95], v[24:27]
  ds_read_b128 v[228:231], v8 offset:256
  s_waitcnt lgkmcnt(8)
  v_mfma_f32_16x16x32_bf16 v[24:27], v[232:235], v[96:99], v[24:27]
  ds_read_b128 v[232:235], v7 offset:7680
  v_mfma_f32_16x16x32_bf16 v[24:27], v[236:239], v[100:103], v[24:27]
  ds_read_b128 v[236:239], v8 offset:7680
  s_waitcnt lgkmcnt(8)
  v_mfma_f32_16x16x32_bf16 v[24:27], v[240:243], v[104:107], v[24:27]
  ds_read_b128 v[240:243], v7 offset:7808
  v_mfma_f32_16x16x32_bf16 v[24:27], v[244:247], v[108:111], v[24:27]
  ds_read_b128 v[244:247], v8 offset:7808
  s_waitcnt lgkmcnt(8)
  v_mfma_f32_16x16x32_bf16 v[28:31], v[248:251], v[88:91], v[28:31]
  ds_read_b128 v[248:251], v7 offset:7936
  v_mfma_f32_16x16x32_bf16 v[28:31], v[252:255], v[92:95], v[28:31]
  ds_read_b128 v[252:255], v8 offset:7936
  s_waitcnt lgkmcnt(8)
  v_mfma_f32_16x16x32_bf16 v[28:31], v[216:219], v[96:99], v[28:31]
  ds_read_b128 v[216:219], v7 offset:15360
  v_mfma_f32_16x16x32_bf16 v[28:31], v[220:223], v[100:103], v[28:31]
  ds_read_b128 v[220:223], v8 offset:15360
  s_waitcnt lgkmcnt(8)
  v_mfma_f32_16x16x32_bf16 v[28:31], v[224:227], v[104:107], v[28:31]
  ds_read_b128 v[224:227], v7 offset:15488
  v_mfma_f32_16x16x32_bf16 v[28:31], v[228:231], v[108:111], v[28:31]
  ds_read_b128 v[228:231], v8 offset:15488
  s_waitcnt lgkmcnt(8)
  v_mfma_f32_16x16x32_bf16 v[32:35], v[232:235], v[88:91], v[32:35]
  v_exp_f32 v196, v24
  v_mfma_f32_16x16x32_bf16 v[56:59], v[232:235], v[112:115], v[56:59]
  ds_read_b128 v[232:235], v7 offset:15616
  v_exp_f32 v197, v25
  v_mfma_f32_16x16x32_bf16 v[32:35], v[236:239], v[92:95], v[32:35]
  v_exp_f32 v198, v26
  v_mfma_f32_16x16x32_bf16 v[56:59], v[236:239], v[116:119], v[56:59]
  ds_read_b128 v[236:239], v8 offset:15616
  s_waitcnt lgkmcnt(8)
  v_mfma_f32_16x16x32_bf16 v[32:35], v[240:243], v[96:99], v[32:35]
  v_exp_f32 v199, v27
  v_mfma_f32_16x16x32_bf16 v[56:59], v[240:243], v[120:123], v[56:59]
  ds_read_b128 v[240:243], v7 offset:23040
  v_cvt_pk_bf16_f32 v136, v196, v197
  v_mfma_f32_16x16x32_bf16 v[32:35], v[244:247], v[100:103], v[32:35]
  v_cvt_pk_bf16_f32 v137, v198, v199
  v_mfma_f32_16x16x32_bf16 v[56:59], v[244:247], v[124:127], v[56:59]
  ds_read_b128 v[244:247], v8 offset:23040
  s_waitcnt lgkmcnt(8)
  v_mfma_f32_16x16x32_bf16 v[32:35], v[248:251], v[104:107], v[32:35]
  v_exp_f32 v200, v28
  v_mfma_f32_16x16x32_bf16 v[56:59], v[248:251], v[128:131], v[56:59]
  ds_read_b128 v[248:251], v7 offset:23168
  v_mfma_f32_16x16x32_bf16 v[32:35], v[252:255], v[108:111], v[32:35]
  v_exp_f32 v201, v29
  v_mfma_f32_16x16x32_bf16 v[56:59], v[252:255], v[132:135], v[56:59]
  ds_read_b128 v[252:255], v8 offset:23168
  s_waitcnt lgkmcnt(8)
  v_mfma_f32_16x16x32_bf16 v[36:39], v[216:219], v[88:91], v[36:39]
  v_exp_f32 v202, v30
  v_mfma_f32_16x16x32_bf16 v[60:63], v[216:219], v[112:115], v[60:63]
  ds_read_b128 v[216:219], v7 offset:23296
  v_exp_f32 v203, v31
  v_mfma_f32_16x16x32_bf16 v[36:39], v[220:223], v[92:95], v[36:39]
  v_cvt_pk_bf16_f32 v138, v200, v201
  v_cvt_pk_bf16_f32 v139, v202, v203
  v_mfma_f32_16x16x32_bf16 v[60:63], v[220:223], v[116:119], v[60:63]
  ds_read_b128 v[220:223], v8 offset:23296
  v_add_u32 v17, s37, v9
  v_add_u32 v18, s37, v10
  s_waitcnt lgkmcnt(8)
  v_mfma_f32_16x16x32_bf16 v[36:39], v[224:227], v[96:99], v[36:39]
  v_add_u32 v19, s37, v11
  v_add_u32 v20, s37, v12
  v_mfma_f32_16x16x32_bf16 v[60:63], v[224:227], v[120:123], v[60:63]
  ds_read_b128 v[224:227], v7 offset:30720
  v_exp_f32 v204, v32
  v_mfma_f32_16x16x32_bf16 v[36:39], v[228:231], v[100:103], v[36:39]
  v_exp_f32 v205, v33
  v_mfma_f32_16x16x32_bf16 v[60:63], v[228:231], v[124:127], v[60:63]
  ds_read_b128 v[228:231], v8 offset:30720
  s_waitcnt lgkmcnt(8)
  v_mfma_f32_16x16x32_bf16 v[36:39], v[232:235], v[104:107], v[36:39]
  v_exp_f32 v206, v34
  v_mfma_f32_16x16x32_bf16 v[60:63], v[232:235], v[128:131], v[60:63]
  ds_read_b128 v[232:235], v7 offset:30848
  v_mfma_f32_16x16x32_bf16 v[36:39], v[236:239], v[108:111], v[36:39]
  v_exp_f32 v207, v35
  v_mfma_f32_16x16x32_bf16 v[60:63], v[236:239], v[132:135], v[60:63]
  ds_read_b128 v[236:239], v8 offset:30848
  s_waitcnt lgkmcnt(8)
  v_mfma_f32_16x16x32_bf16 v[40:43], v[240:243], v[88:91], v[40:43]
  v_cvt_pk_bf16_f32 v140, v204, v205
  v_cvt_pk_bf16_f32 v141, v206, v207
  v_mfma_f32_16x16x32_bf16 v[64:67], v[240:243], v[112:115], v[64:67]
  ds_read_b128 v[240:243], v7 offset:30976
  v_exp_f32 v208, v56
  v_mfma_f32_16x16x32_bf16 v[40:43], v[244:247], v[92:95], v[40:43]
  v_exp_f32 v209, v57
  v_mfma_f32_16x16x32_bf16 v[64:67], v[244:247], v[116:119], v[64:67]
  ds_read_b128 v[244:247], v8 offset:30976
  v_exp_f32 v210, v58
  s_waitcnt lgkmcnt(8)
  v_mfma_f32_16x16x32_bf16 v[40:43], v[248:251], v[96:99], v[40:43]
  v_exp_f32 v211, v59
  v_mfma_f32_16x16x32_bf16 v[64:67], v[248:251], v[120:123], v[64:67]
  ds_read_b128 v[248:251], v7 offset:38400
  v_cvt_pk_bf16_f32 v152, v208, v209
  v_cvt_pk_bf16_f32 v153, v210, v211
  v_mfma_f32_16x16x32_bf16 v[40:43], v[252:255], v[100:103], v[40:43]
  v_exp_f32 v212, v36
  v_mfma_f32_16x16x32_bf16 v[64:67], v[252:255], v[124:127], v[64:67]
  ds_read_b128 v[252:255], v8 offset:38400
  v_exp_f32 v213, v37
  s_waitcnt lgkmcnt(8)
  v_mfma_f32_16x16x32_bf16 v[40:43], v[216:219], v[104:107], v[40:43]
  v_exp_f32 v214, v38
  v_mfma_f32_16x16x32_bf16 v[64:67], v[216:219], v[128:131], v[64:67]
  ds_read_b128 v[216:219], v7 offset:38528
  v_mfma_f32_16x16x32_bf16 v[40:43], v[220:223], v[108:111], v[40:43]
  v_exp_f32 v215, v39
  v_mfma_f32_16x16x32_bf16 v[64:67], v[220:223], v[132:135], v[64:67]
  ds_read_b128 v[220:223], v8 offset:38528
  s_cbranch_vccz RL4
  s_waitcnt vmcnt(0)
  s_barrier
RL4:
  s_cbranch_vccnz RL5
  s_barrier
RL5:
  s_waitcnt lgkmcnt(8)
  v_mfma_f32_16x16x32_bf16 v[44:47], v[224:227], v[88:91], v[44:47]
  v_cvt_pk_bf16_f32 v142, v212, v213
  v_cvt_pk_bf16_f32 v143, v214, v215
  v_mfma_f32_16x16x32_bf16 v[68:71], v[224:227], v[112:115], v[68:71]
  ds_read_b128 v[224:227], v7 offset:38656
  v_exp_f32 v196, v60
  v_mfma_f32_16x16x32_bf16 v[44:47], v[228:231], v[92:95], v[44:47]
  v_exp_f32 v197, v61
  v_mfma_f32_16x16x32_bf16 v[68:71], v[228:231], v[116:119], v[68:71]
  ds_read_b128 v[228:231], v8 offset:38656
  v_exp_f32 v198, v62
  s_waitcnt lgkmcnt(8)
  v_mfma_f32_16x16x32_bf16 v[44:47], v[232:235], v[96:99], v[44:47]
  v_exp_f32 v199, v63
  v_mfma_f32_16x16x32_bf16 v[68:71], v[232:235], v[120:123], v[68:71]
  ds_read_b128 v[232:235], v7 offset:46080
  v_cvt_pk_bf16_f32 v154, v196, v197
  v_cvt_pk_bf16_f32 v155, v198, v199
  v_mfma_f32_16x16x32_bf16 v[44:47], v[236:239], v[100:103], v[44:47]
  v_exp_f32 v200, v40
  v_mfma_f32_16x16x32_bf16 v[68:71], v[236:239], v[124:127], v[68:71]
  ds_read_b128 v[236:239], v8 offset:46080
  v_exp_f32 v201, v41
  s_waitcnt lgkmcnt(8)
  v_mfma_f32_16x16x32_bf16 v[44:47], v[240:243], v[104:107], v[44:47]
  v_exp_f32 v202, v42
  v_mfma_f32_16x16x32_bf16 v[68:71], v[240:243], v[128:131], v[68:71]
  ds_read_b128 v[240:243], v7 offset:46208
  v_mfma_f32_16x16x32_bf16 v[44:47], v[244:247], v[108:111], v[44:47]
  v_exp_f32 v203, v43
  v_mfma_f32_16x16x32_bf16 v[68:71], v[244:247], v[132:135], v[68:71]
  ds_read_b128 v[244:247], v8 offset:46208
  s_waitcnt lgkmcnt(8)
  v_mfma_f32_16x16x32_bf16 v[48:51], v[248:251], v[88:91], v[48:51]
  v_cvt_pk_bf16_f32 v144, v200, v201
  v_cvt_pk_bf16_f32 v145, v202, v203
  v_mfma_f32_16x16x32_bf16 v[72:75], v[248:251], v[112:115], v[72:75]
  ds_read_b128 v[248:251], v7 offset:46336
  v_exp_f32 v204, v64
  v_mfma_f32_16x16x32_bf16 v[48:51], v[252:255], v[92:95], v[48:51]
  v_exp_f32 v205, v65
  v_mfma_f32_16x16x32_bf16 v[72:75], v[252:255], v[116:119], v[72:75]
  ds_read_b128 v[252:255], v8 offset:46336
  v_exp_f32 v206, v66
  s_waitcnt lgkmcnt(8)
  v_mfma_f32_16x16x32_bf16 v[48:51], v[216:219], v[96:99], v[48:51]
  v_exp_f32 v207, v67
  v_mfma_f32_16x16x32_bf16 v[72:75], v[216:219], v[120:123], v[72:75]
  ds_read_b128 v[216:219], v7 offset:53760
  v_cvt_pk_bf16_f32 v156, v204, v205
  v_cvt_pk_bf16_f32 v157, v206, v207
  v_mfma_f32_16x16x32_bf16 v[48:51], v[220:223], v[100:103], v[48:51]
  v_exp_f32 v208, v44
  v_mfma_f32_16x16x32_bf16 v[72:75], v[220:223], v[124:127], v[72:75]
  ds_read_b128 v[220:223], v8 offset:53760
  v_exp_f32 v209, v45
  s_waitcnt lgkmcnt(8)
  v_mfma_f32_16x16x32_bf16 v[48:51], v[224:227], v[104:107], v[48:51]
  v_exp_f32 v210, v46
  v_mfma_f32_16x16x32_bf16 v[72:75], v[224:227], v[128:131], v[72:75]
  ds_read_b128 v[224:227], v7 offset:53888
  v_mfma_f32_16x16x32_bf16 v[48:51], v[228:231], v[108:111], v[48:51]
  v_exp_f32 v211, v47
  v_mfma_f32_16x16x32_bf16 v[72:75], v[228:231], v[132:135], v[72:75]
  ds_read_b128 v[228:231], v8 offset:53888
  s_waitcnt lgkmcnt(8)
  v_mfma_f32_16x16x32_bf16 v[52:55], v[232:235], v[88:91], v[52:55]
  v_cvt_pk_bf16_f32 v146, v208, v209
  v_cvt_pk_bf16_f32 v147, v210, v211
  v_mfma_f32_16x16x32_bf16 v[76:79], v[232:235], v[112:115], v[76:79]
  ds_read_b128 v[232:235], v7 offset:54016
  v_exp_f32 v212, v68
  v_mfma_f32_16x16x32_bf16 v[52:55], v[236:239], v[92:95], v[52:55]
  v_exp_f32 v213, v69
  v_mfma_f32_16x16x32_bf16 v[76:79], v[236:239], v[116:119], v[76:79]
  ds_read_b128 v[236:239], v8 offset:54016
  v_exp_f32 v214, v70
  s_waitcnt lgkmcnt(8)
  v_mfma_f32_16x16x32_bf16 v[52:55], v[240:243], v[96:99], v[52:55]
  v_exp_f32 v215, v71
  v_mfma_f32_16x16x32_bf16 v[76:79], v[240:243], v[120:123], v[76:79]
  ds_read_b128 v[240:243], v15 offset:0
  v_cvt_pk_bf16_f32 v158, v212, v213
  v_cvt_pk_bf16_f32 v159, v214, v215
  v_mfma_f32_16x16x32_bf16 v[52:55], v[244:247], v[100:103], v[52:55]
  v_exp_f32 v196, v48
  v_mfma_f32_16x16x32_bf16 v[76:79], v[244:247], v[124:127], v[76:79]
  ds_read_b128 v[244:247], v16 offset:0
  v_exp_f32 v197, v49
  s_waitcnt lgkmcnt(8)
  v_mfma_f32_16x16x32_bf16 v[52:55], v[248:251], v[104:107], v[52:55]
  v_exp_f32 v198, v50
  v_mfma_f32_16x16x32_bf16 v[76:79], v[248:251], v[128:131], v[76:79]
  ds_read_b128 v[248:251], v15 offset:128
  v_mfma_f32_16x16x32_bf16 v[52:55], v[252:255], v[108:111], v[52:55]
  v_exp_f32 v199, v51
  v_mfma_f32_16x16x32_bf16 v[76:79], v[252:255], v[132:135], v[76:79]
  ds_read_b128 v[252:255], v16 offset:128
  s_waitcnt lgkmcnt(8)
  v_mfma_f32_16x16x32_bf16 v[80:83], v[216:219], v[112:115], v[80:83]
  ds_read_b128 v[216:219], v15 offset:256
  v_cvt_pk_bf16_f32 v148, v196, v197
  v_cvt_pk_bf16_f32 v149, v198, v199
  v_mfma_f32_16x16x32_bf16 v[80:83], v[220:223], v[116:119], v[80:83]
  ds_read_b128 v[220:223], v16 offset:256
  v_exp_f32 v200, v72
  s_waitcnt lgkmcnt(8)
  v_mfma_f32_16x16x32_bf16 v[80:83], v[224:227], v[120:123], v[80:83]
  ds_read_b64_tr_b16 v[224:225], v17 offset:0
  ds_read_b64_tr_b16 v[226:227], v9 offset:0
  v_exp_f32 v201, v73
  v_mfma_f32_16x16x32_bf16 v[80:83], v[228:231], v[124:127], v[80:83]
  ds_read_b64_tr_b16 v[228:229], v18 offset:0
  ds_read_b64_tr_b16 v[230:231], v10 offset:0
  v_exp_f32 v202, v74
  s_waitcnt lgkmcnt(10)
  v_mfma_f32_16x16x32_bf16 v[80:83], v[232:235], v[128:131], v[80:83]
  ds_read_b64_tr_b16 v[232:233], v19 offset:0
  ds_read_b64_tr_b16 v[234:235], v11 offset:0
  v_exp_f32 v203, v75
  v_mfma_f32_16x16x32_bf16 v[80:83], v[236:239], v[132:135], v[80:83]
  ds_read_b64_tr_b16 v[236:237], v20 offset:0
  ds_read_b64_tr_b16 v[238:239], v12 offset:0
  v_cvt_pk_bf16_f32 v160, v200, v201
  v_cvt_pk_bf16_f32 v161, v202, v203
  s_waitcnt lgkmcnt(12)
  v_mfma_f32_16x16x32_bf16 v[84:87], v[240:243], v[112:115], v[84:87]
  ds_read_b64_tr_b16 v[240:241], v17 offset:128
  ds_read_b64_tr_b16 v[242:243], v9 offset:128
  v_exp_f32 v204, v52
  v_mfma_f32_16x16x32_bf16 v[84:87], v[244:247], v[116:119], v[84:87]
  v_exp_f32 v205, v53
  s_waitcnt lgkmcnt(12)
  v_mfma_f32_16x16x32_bf16 v[84:87], v[248:251], v[120:123], v[84:87]
  ds_read_b64_tr_b16 v[244:245], v18 offset:128
  ds_read_b64_tr_b16 v[246:247], v10 offset:128
  v_exp_f32 v206, v54
  v_exp_f32 v207, v55
  v_cvt_pk_bf16_f32 v150, v204, v205
  v_cvt_pk_bf16_f32 v151, v206, v207
  v_mfma_f32_16x16x32_bf16 v[184:187], v[192:195], v[136:139], 0
  v_exp_f32 v208, v76
  v_mfma_f32_16x16x32_bf16 v[184:187], v[192:195], v[140:143], v[184:187]
  v_exp_f32 v209, v77
  v_mfma_f32_16x16x32_bf16 v[184:187], v[192:195], v[144:147], v[184:187]
  v_exp_f32 v210, v78
  v_mfma_f32_16x16x32_bf16 v[184:187], v[192:195], v[148:151], v[184:187]
  v_exp_f32 v211, v79
  v_mfma_f32_16x16x32_bf16 v[84:87], v[252:255], v[124:127], v[84:87]
  v_cvt_pk_bf16_f32 v162, v208, v209
  s_waitcnt lgkmcnt(12)
  v_mfma_f32_16x16x32_bf16 v[84:87], v[216:219], v[128:131], v[84:87]
  ds_read_b64_tr_b16 v[248:249], v19 offset:128
  ds_read_b64_tr_b16 v[250:251], v11 offset:128
  v_mfma_f32_16x16x32_bf16 v[84:87], v[220:223], v[132:135], v[84:87]
  v_cvt_pk_bf16_f32 v163, v210, v211
  v_subrev_u32 v23, 813694976, v184
  s_mov_b32 s52, 503316480
  v_cmp_gt_u32 s[48:49], s52, v23
  s_or_b64 s[48:49], s[48:49], s[42:43]
  s_cmp_eq_u64 s[48:49], -1
  s_cbranch_scc0 FB0
FBR0:
  s_waitcnt lgkmcnt(10)
  v_mfma_f32_16x16x32_bf16 v[88:91], v[224:227], v[136:139], 0
  ds_read_b64_tr_b16 v[252:253], v20 offset:128
  ds_read_b64_tr_b16 v[254:255], v12 offset:128
  v_exp_f32 v212, v80
  v_mfma_f32_16x16x32_bf16 v[92:95], v[228:231], v[136:139], 0
  ds_read_b64_tr_b16 v[216:217], v17 offset:256
  ds_read_b64_tr_b16 v[218:219], v9 offset:256
  v_exp_f32 v213, v81
  s_waitcnt lgkmcnt(10)
  v_mfma_f32_16x16x32_bf16 v[96:99], v[232:235], v[136:139], 0
  ds_read_b64_tr_b16 v[220:221], v18 offset:256
  ds_read_b64_tr_b16 v[222:223], v10 offset:256
  v_mfma_f32_16x16x32_bf16 v[100:103], v[236:239], v[136:139], 0
  ds_read_b64_tr_b16 v[224:225], v19 offset:256
  ds_read_b64_tr_b16 v[226:227], v11 offset:256
  s_waitcnt lgkmcnt(10)
  v_mfma_f32_16x16x32_bf16 v[104:107], v[240:243], v[136:139], 0
  ds_read_b64_tr_b16 v[228:229], v20 offset:256
  ds_read_b64_tr_b16 v[230:231], v12 offset:256
  v_mfma_f32_16x16x32_bf16 v[108:111], v[244:247], v[136:139], 0
  ds_read_b64_tr_b16 v[232:233], v9 offset:7680
  ds_read_b64_tr_b16 v[234:235], v9 offset:15360
  s_waitcnt lgkmcnt(10)
  v_mfma_f32_16x16x32_bf16 v[112:115], v[248:251], v[136:139], 0
  ds_read_b64_tr_b16 v[236:237], v10 offset:7680
  ds_read_b64_tr_b16 v[238:239], v10 offset:15360
  v_mfma_f32_16x16x32_bf16 v[116:119], v[252:255], v[136:139], 0
  ds_read_b64_tr_b16 v[240:241], v11 offset:7680
  ds_read_b64_tr_b16 v[242:243], v11 offset:15360
  s_waitcnt lgkmcnt(10)
  v_mfma_f32_16x16x32_bf16 v[120:123], v[216:219], v[136:139], 0
  ds_read_b64_tr_b16 v[244:245], v12 offset:7680
  ds_read_b64_tr_b16 v[246:247], v12 offset:15360
  v_mfma_f32_16x16x32_bf16 v[124:127], v[220:223], v[136:139], 0
  ds_read_b64_tr_b16 v[248:249], v9 offset:7808
  ds_read_b64_tr_b16 v[250:251], v9 offset:15488
  s_waitcnt lgkmcnt(10)
  v_mfma_f32_16x16x32_bf16 v[128:131], v[224:227], v[136:139], 0
  ds_read_b64_tr_b16 v[252:253], v10 offset:7808
  ds_read_b64_tr_b16 v[254:255], v10 offset:15488
  v_mfma_f32_16x16x32_bf16 v[132:135], v[228:231], v[136:139], 0
  ds_read_b64_tr_b16 v[216:217], v11 offset:7808
  ds_read_b64_tr_b16 v[218:219], v11 offset:15488
  v_exp_f32 v214, v82
  v_exp_f32 v215, v83
  v_cvt_pk_bf16_f32 v164, v212, v213
  v_cvt_pk_bf16_f32 v165, v214, v215
  v_exp_f32 v196, v84
  v_exp_f32 v197, v85
  v_exp_f32 v198, v86
  v_exp_f32 v199, v87
  v_cvt_pk_bf16_f32 v166, v196, v197
  v_cvt_pk_bf16_f32 v167, v198, v199
  v_mfma_f32_16x16x32_bf16 v[188:191], v[192:195], v[152:155], 0
  v_mfma_f32_16x16x32_bf16 v[188:191], v[192:195], v[156:159], v[188:191]
  v_mfma_f32_16x16x32_bf16 v[188:191], v[192:195], v[160:163], v[188:191]
  v_mfma_f32_16x16x32_bf16 v[188:191], v[192:195], v[164:167], v[188:191]
  v_add_u32 v15, s38, v9
  v_add_u32 v16, s38, v10
  v_add_u32 v21, s38, v11
  v_add_u32 v0, s38, v12
  s_nop 3
  v_subrev_u32 v23, 813694976, v188
  s_mov_b32 s52, 503316480
  v_cmp_gt_u32 s[48:49], s52, v23
  s_or_b64 s[48:49], s[48:49], s[44:45]
  s_cmp_eq_u64 s[48:49], -1
  s_cbranch_scc0 FB1
FBR1:
  s_waitcnt lgkmcnt(10)
  v_mfma_f32_16x16x32_bf16 v[88:91], v[232:235], v[140:143], v[88:91]
  ds_read_b64_tr_b16 v[220:221], v12 offset:7808
  ds_read_b64_tr_b16 v[222:223], v12 offset:15488
  v_mfma_f32_16x16x32_bf16 v[24:27], v[232:235], v[152:155], 0
  ds_read_b64_tr_b16 v[224:225], v9 offset:7936
  ds_read_b64_tr_b16 v[226:227], v9 offset:15616
  v_mfma_f32_16x16x32_bf16 v[92:95], v[236:239], v[140:143], v[92:95]
  v_mfma_f32_16x16x32_bf16 v[28:31], v[236:239], v[152:155], 0
  s_waitcnt lgkmcnt(10)
  v_mfma_f32_16x16x32_bf16 v[96:99], v[240:243], v[140:143], v[96:99]
  ds_read_b64_tr_b16 v[228:229], v10 offset:7936
  ds_read_b64_tr_b16 v[230:231], v10 offset:15616
  v_mfma_f32_16x16x32_bf16 v[32:35], v[240:243], v[152:155], 0
  ds_read_b64_tr_b16 v[232:233], v11 offset:7936
  ds_read_b64_tr_b16 v[234:235], v11 offset:15616
  v_mfma_f32_16x16x32_bf16 v[100:103], v[244:247], v[140:143], v[100:103]
  v_mfma_f32_16x16x32_bf16 v[36:39], v[244:247], v[152:155], 0
  s_waitcnt lgkmcnt(10)
  v_mfma_f32_16x16x32_bf16 v[104:107], v[248:251], v[140:143], v[104:107]
  ds_read_b64_tr_b16 v[236:237], v12 offset:7936
  ds_read_b64_tr_b16 v[238:239], v12 offset:15616
  v_mfma_f32_16x16x32_bf16 v[40:43], v[248:251], v[152:155], 0
  ds_read_b64_tr_b16 v[240:241], v9 offset:23040
  ds_read_b64_tr_b16 v[242:243], v9 offset:30720
  v_mfma_f32_16x16x32_bf16 v[108:111], v[252:255], v[140:143], v[108:111]
  v_mfma_f32_16x16x32_bf16 v[44:47], v[252:255], v[152:155], 0
  s_waitcnt lgkmcnt(10)
  v_mfma_f32_16x16x32_bf16 v[112:115], v[216:219], v[140:143], v[112:115]
  ds_read_b64_tr_b16 v[244:245], v10 offset:23040
  ds_read_b64_tr_b16 v[246:247], v10 offset:30720
  v_mfma_f32_16x16x32_bf16 v[48:51], v[216:219], v[152:155], 0
  ds_read_b64_tr_b16 v[248:249], v11 offset:23040
  ds_read_b64_tr_b16 v[250:251], v11 offset:30720
  v_mfma_f32_16x16x32_bf16 v[116:119], v[220:223], v[140:143], v[116:119]
  v_mfma_f32_16x16x32_bf16 v[52:55], v[220:223], v[152:155], 0
  s_waitcnt lgkmcnt(10)
  v_mfma_f32_16x16x32_bf16 v[120:123], v[224:227], v[140:143], v[120:123]
  ds_read_b64_tr_b16 v[252:253], v12 offset:23040
  ds_read_b64_tr_b16 v[254:255], v12 offset:30720
  v_mfma_f32_16x16x32_bf16 v[56:59], v[224:227], v[152:155], 0
  ds_read_b64_tr_b16 v[216:217], v9 offset:23168
  ds_read_b64_tr_b16 v[218:219], v9 offset:30848
  v_mfma_f32_16x16x32_bf16 v[124:127], v[228:231], v[140:143], v[124:127]
  v_mfma_f32_16x16x32_bf16 v[60:63], v[228:231], v[152:155], 0
  s_waitcnt lgkmcnt(10)
  v_mfma_f32_16x16x32_bf16 v[128:131], v[232:235], v[140:143], v[128:131]
  ds_read_b64_tr_b16 v[220:221], v10 offset:23168
  ds_read_b64_tr_b16 v[222:223], v10 offset:30848
  v_mfma_f32_16x16x32_bf16 v[64:67], v[232:235], v[152:155], 0
  ds_read_b64_tr_b16 v[224:225], v11 offset:23168
  ds_read_b64_tr_b16 v[226:227], v11 offset:30848
  v_mfma_f32_16x16x32_bf16 v[132:135], v[236:239], v[140:143], v[132:135]
  v_mfma_f32_16x16x32_bf16 v[68:71], v[236:239], v[152:155], 0
  s_cbranch_vccnz RL6
  s_barrier
RL6:
  s_waitcnt lgkmcnt(10)
  v_mfma_f32_16x16x32_bf16 v[88:91], v[240:243], v[144:147], v[88:91]
  ds_read_b64_tr_b16 v[228:229], v12 offset:23168
  ds_read_b64_tr_b16 v[230:231], v12 offset:30848
  v_mfma_f32_16x16x32_bf16 v[24:27], v[240:243], v[156:159], v[24:27]
  ds_read_b64_tr_b16 v[232:233], v9 offset:23296
  ds_read_b64_tr_b16 v[234:235], v9 offset:30976
  v_mfma_f32_16x16x32_bf16 v[92:95], v[244:247], v[144:147], v[92:95]
  v_mfma_f32_16x16x32_bf16 v[28:31], v[244:247], v[156:159], v[28:31]
  s_waitcnt lgkmcnt(10)
  v_mfma_f32_16x16x32_bf16 v[96:99], v[248:251], v[144:147], v[96:99]
  ds_read_b64_tr_b16 v[236:237], v10 offset:23296
  ds_read_b64_tr_b16 v[238:239], v10 offset:30976
  v_mfma_f32_16x16x32_bf16 v[32:35], v[248:251], v[156:159], v[32:35]
  ds_read_b64_tr_b16 v[240:241], v11 offset:23296
  ds_read_b64_tr_b16 v[242:243], v11 offset:30976
  v_mfma_f32_16x16x32_bf16 v[100:103], v[252:255], v[144:147], v[100:103]
  v_mfma_f32_16x16x32_bf16 v[36:39], v[252:255], v[156:159], v[36:39]
  s_waitcnt lgkmcnt(10)
  v_mfma_f32_16x16x32_bf16 v[104:107], v[216:219], v[144:147], v[104:107]
  ds_read_b64_tr_b16 v[244:245], v12 offset:23296
  ds_read_b64_tr_b16 v[246:247], v12 offset:30976
  v_mfma_f32_16x16x32_bf16 v[40:43], v[216:219], v[156:159], v[40:43]
  ds_read_b64_tr_b16 v[248:249], v9 offset:38400
  ds_read_b64_tr_b16 v[250:251], v9 offset:46080
  v_mfma_f32_16x16x32_bf16 v[108:111], v[220:223], v[144:147], v[108:111]
  v_mfma_f32_16x16x32_bf16 v[44:47], v[220:223], v[156:159], v[44:47]
  s_waitcnt lgkmcnt(10)
  v_mfma_f32_16x16x32_bf16 v[112:115], v[224:227], v[144:147], v[112:115]
  ds_read_b64_tr_b16 v[252:253], v10 offset:38400
  ds_read_b64_tr_b16 v[254:255], v10 offset:46080
  v_mfma_f32_16x16x32_bf16 v[48:51], v[224:227], v[156:159], v[48:51]
  ds_read_b64_tr_b16 v[216:217], v11 offset:38400
  ds_read_b64_tr_b16 v[218:219], v11 offset:46080
  v_mfma_f32_16x16x32_bf16 v[116:119], v[228:231], v[144:147], v[116:119]
  v_mfma_f32_16x16x32_bf16 v[52:55], v[228:231], v[156:159], v[52:55]
  s_waitcnt lgkmcnt(10)
  v_mfma_f32_16x16x32_bf16 v[120:123], v[232:235], v[144:147], v[120:123]
  ds_read_b64_tr_b16 v[220:221], v12 offset:38400
  ds_read_b64_tr_b16 v[222:223], v12 offset:46080
  v_mfma_f32_16x16x32_bf16 v[56:59], v[232:235], v[156:159], v[56:59]
  ds_read_b64_tr_b16 v[224:225], v9 offset:38528
  ds_read_b64_tr_b16 v[226:227], v9 offset:46208
  v_mfma_f32_16x16x32_bf16 v[124:127], v[236:239], v[144:147], v[124:127]
  v_mfma_f32_16x16x32_bf16 v[60:63], v[236:239], v[156:159], v[60:63]
  s_waitcnt lgkmcnt(10)
  v_mfma_f32_16x16x32_bf16 v[128:131], v[240:243], v[144:147], v[128:131]
  ds_read_b64_tr_b16 v[228:229], v10 offset:38528
  ds_read_b64_tr_b16 v[230:231], v10 offset:46208
  v_mfma_f32_16x16x32_bf16 v[64:67], v[240:243], v[156:159], v[64:67]
  ds_read_b64_tr_b16 v[232:233], v11 offset:38528
  ds_read_b64_tr_b16 v[234:235], v11 offset:46208
  v_mfma_f32_16x16x32_bf16 v[132:135], v[244:247], v[144:147], v[132:135]
  v_mfma_f32_16x16x32_bf16 v[68:71], v[244:247], v[156:159], v[68:71]
  s_waitcnt lgkmcnt(10)
  v_mfma_f32_16x16x32_bf16 v[88:91], v[248:251], v[148:151], v[88:91]
  ds_read_b64_tr_b16 v[236:237], v12 offset:38528
  ds_read_b64_tr_b16 v[238:239], v12 offset:46208
  v_mfma_f32_16x16x32_bf16 v[24:27], v[248:251], v[160:163], v[24:27]
  ds_read_b64_tr_b16 v[240:241], v9 offset:38656
  ds_read_b64_tr_b16 v[242:243], v9 offset:46336
  v_mfma_f32_16x16x32_bf16 v[92:95], v[252:255], v[148:151], v[92:95]
  v_mfma_f32_16x16x32_bf16 v[28:31], v[252:255], v[160:163], v[28:31]
  s_waitcnt lgkmcnt(10)
  v_mfma_f32_16x16x32_bf16 v[96:99], v[216:219], v[148:151], v[96:99]
  ds_read_b64_tr_b16 v[244:245], v10 offset:38656
  ds_read_b64_tr_b16 v[246:247], v10 offset:46336
  v_mfma_f32_16x16x32_bf16 v[32:35], v[216:219], v[160:163], v[32:35]
  ds_read_b64_tr_b16 v[248:249], v11 offset:38656
  ds_read_b64_tr_b16 v[250:251], v11 offset:46336
  v_mfma_f32_16x16x32_bf16 v[100:103], v[220:223], v[148:151], v[100:103]
  v_mfma_f32_16x16x32_bf16 v[36:39], v[220:223], v[160:163], v[36:39]
  s_waitcnt lgkmcnt(10)
  v_mfma_f32_16x16x32_bf16 v[104:107], v[224:227], v[148:151], v[104:107]
  ds_read_b64_tr_b16 v[252:253], v12 offset:38656
  ds_read_b64_tr_b16 v[254:255], v12 offset:46336
  v_mfma_f32_16x16x32_bf16 v[40:43], v[224:227], v[160:163], v[40:43]
  ds_read_b64_tr_b16 v[216:217], v9 offset:53760
  ds_read_b64_tr_b16 v[218:219], v15 offset:0
  v_mfma_f32_16x16x32_bf16 v[108:111], v[228:231], v[148:151], v[108:111]
  v_mfma_f32_16x16x32_bf16 v[44:47], v[228:231], v[160:163], v[44:47]
  s_waitcnt lgkmcnt(10)
  v_mfma_f32_16x16x32_bf16 v[112:115], v[232:235], v[148:151], v[112:115]
  ds_read_b64_tr_b16 v[220:221], v10 offset:53760
  ds_read_b64_tr_b16 v[222:223], v16 offset:0
  v_mfma_f32_16x16x32_bf16 v[48:51], v[232:235], v[160:163], v[48:51]
  ds_read_b64_tr_b16 v[224:225], v11 offset:53760
  ds_read_b64_tr_b16 v[226:227], v21 offset:0
  v_mfma_f32_16x16x32_bf16 v[116:119], v[236:239], v[148:151], v[116:119]
  v_mfma_f32_16x16x32_bf16 v[52:55], v[236:239], v[160:163], v[52:55]
  s_waitcnt lgkmcnt(10)
  v_mfma_f32_16x16x32_bf16 v[120:123], v[240:243], v[148:151], v[120:123]
  ds_read_b64_tr_b16 v[228:229], v12 offset:53760
  ds_read_b64_tr_b16 v[230:231], v0 offset:0
  v_mfma_f32_16x16x32_bf16 v[56:59], v[240:243], v[160:163], v[56:59]
  ds_read_b64_tr_b16 v[232:233], v9 offset:53888
  ds_read_b64_tr_b16 v[234:235], v15 offset:128
  v_mfma_f32_16x16x32_bf16 v[124:127], v[244:247], v[148:151], v[124:127]
  v_mfma_f32_16x16x32_bf16 v[60:63], v[244:247], v[160:163], v[60:63]
  s_waitcnt lgkmcnt(10)
  v_mfma_f32_16x16x32_bf16 v[128:131], v[248:251], v[148:151], v[128:131]
  ds_read_b64_tr_b16 v[236:237], v10 offset:53888
  ds_read_b64_tr_b16 v[238:239], v16 offset:128
  v_mfma_f32_16x16x32_bf16 v[64:67], v[248:251], v[160:163], v[64:67]
  ds_read_b64_tr_b16 v[240:241], v11 offset:53888
  ds_read_b64_tr_b16 v[242:243], v21 offset:128
  v_mfma_f32_16x16x32_bf16 v[132:135], v[252:255], v[148:151], v[132:135]
  v_mfma_f32_16x16x32_bf16 v[68:71], v[252:255], v[160:163], v[68:71]
  s_waitcnt lgkmcnt(10)
  v_mfma_f32_16x16x32_bf16 v[24:27], v[216:219], v[164:167], v[24:27]
  ds_read_b64_tr_b16 v[244:245], v12 offset:53888
  ds_read_b64_tr_b16 v[246:247], v0 offset:128
  v_mfma_f32_16x16x32_bf16 v[28:31], v[220:223], v[164:167], v[28:31]
  ds_read_b64_tr_b16 v[248:249], v9 offset:54016
  ds_read_b64_tr_b16 v[250:251], v15 offset:256
  s_waitcnt lgkmcnt(10)
  v_mfma_f32_16x16x32_bf16 v[32:35], v[224:227], v[164:167], v[32:35]
  ds_read_b64_tr_b16 v[252:253], v10 offset:54016
  ds_read_b64_tr_b16 v[254:255], v16 offset:256
  v_mfma_f32_16x16x32_bf16 v[36:39], v[228:231], v[164:167], v[36:39]
  ds_read_b64_tr_b16 v[216:217], v11 offset:54016
  ds_read_b64_tr_b16 v[218:219], v21 offset:256
  s_waitcnt lgkmcnt(10)
  v_mfma_f32_16x16x32_bf16 v[40:43], v[232:235], v[164:167], v[40:43]
  ds_read_b64_tr_b16 v[220:221], v12 offset:54016
  ds_read_b64_tr_b16 v[222:223], v0 offset:256
  v_mfma_f32_16x16x32_bf16 v[44:47], v[236:239], v[164:167], v[44:47]
  v_cvt_pk_bf16_f32 v136, v88, v89
  s_waitcnt lgkmcnt(8)
  v_mfma_f32_16x16x32_bf16 v[48:51], v[240:243], v[164:167], v[48:51]
  v_cvt_pk_bf16_f32 v137, v90, v91
  v_cvt_pk_bf16_f32 v138, v92, v93
  v_mfma_f32_16x16x32_bf16 v[52:55], v[244:247], v[164:167], v[52:55]
  v_cvt_pk_bf16_f32 v139, v94, v95
  s_waitcnt lgkmcnt(6)
  v_mfma_f32_16x16x32_bf16 v[56:59], v[248:251], v[164:167], v[56:59]
  v_cvt_pk_bf16_f32 v140, v96, v97
  s_waitcnt lgkmcnt(4)
  v_mfma_f32_16x16x32_bf16 v[60:63], v[252:255], v[164:167], v[60:63]
  v_cvt_pk_bf16_f32 v141, v98, v99
  s_waitcnt lgkmcnt(2)
  v_mfma_f32_16x16x32_bf16 v[64:67], v[216:219], v[164:167], v[64:67]
  v_cvt_pk_bf16_f32 v142, v100, v101
  s_waitcnt lgkmcnt(0)
  v_mfma_f32_16x16x32_bf16 v[68:71], v[220:223], v[164:167], v[68:71]
  v_cvt_pk_bf16_f32 v143, v102, v103
  s_cbranch_vccz RL7
  s_barrier
  s_add_u32 m0, s41, 117760
  s_add_u32 s50, s41, 73728
  buffer_load_dwordx4 v1, s[20:23], s50 offen lds
  s_add_u32 m0, s41, 121856
  s_add_u32 s50, s41, 77824
  buffer_load_dwordx4 v1, s[20:23], s50 offen lds
  s_add_u32 m0, s41, 125952
  s_add_u32 s50, s41, 81920
  buffer_load_dwordx4 v1, s[20:23], s50 offen lds
  s_add_u32 m0, s41, 130048
  s_add_u32 s50, s41, 86016
  buffer_load_dwordx4 v1, s[20:23], s50 offen lds
  s_add_u32 m0, s41, 134144
  s_add_u32 s50, s41, 90112
  buffer_load_dwordx4 v1, s[20:23], s50 offen lds
  s_add_u32 m0, s41, 138240
  s_add_u32 s50, s41, 94208
  buffer_load_dwordx4 v1, s[20:23], s50 offen lds
  s_add_u32 m0, s41, 142336
  s_add_u32 s50, s41, 98304
  buffer_load_dwordx4 v1, s[20:23], s50 offen lds
  s_add_u32 m0, s41, 146432
  s_add_u32 s50, s41, 102400
  buffer_load_dwordx4 v1, s[20:23], s50 offen lds
  s_add_u32 m0, s41, 150528
  s_add_u32 s50, s41, 106496
  buffer_load_dwordx4 v1, s[20:23], s50 offen lds
  s_add_u32 m0, s41, 154624
  s_add_u32 s50, s41, 110592
  buffer_load_dwordx4 v1, s[20:23], s50 offen lds
  s_add_u32 m0, s41, 158720
  s_add_u32 s50, s41, 114688
  buffer_load_dwordx4 v1, s[20:23], s50 offen lds
  s_min_u32 s51, s41, 0
  s_add_u32 m0, s51, 162816
  s_add_u32 s50, s51, 118784
  buffer_load_dwordx4 v1, s[20:23], s50 offen lds
  s_add_u32 m0, s41, 0
  s_add_u32 s50, s41, 119808
  buffer_load_dwordx4 v1, s[20:23], s50 offen lds
  s_add_u32 m0, s41, 4096
  s_add_u32 s50, s41, 123904
  buffer_load_dwordx4 v1, s[20:23], s50 offen lds
  s_min_u32 s51, s41, 1024
  s_add_u32 m0, s51, 8192
  s_add_u32 s50, s51, 128000
  buffer_load_dwordx4 v1, s[20:23], s50 offen lds
  s_branch RM7
RL7:
  s_barrier
RM7:
  v_cvt_pk_bf16_f32 v144, v104, v105
  v_cvt_pk_bf16_f32 v145, v106, v107
  v_cvt_pk_bf16_f32 v146, v108, v109
  v_cvt_pk_bf16_f32 v147, v110, v111
  v_cvt_pk_bf16_f32 v148, v112, v113
  v_cvt_pk_bf16_f32 v149, v114, v115
  v_cvt_pk_bf16_f32 v150, v116, v117
  v_cvt_pk_bf16_f32 v151, v118, v119
  v_cvt_pk_bf16_f32 v168, v120, v121
  v_cvt_pk_bf16_f32 v169, v122, v123
  v_cvt_pk_bf16_f32 v170, v124, v125
  v_cvt_pk_bf16_f32 v171, v126, v127
  v_cvt_pk_bf16_f32 v172, v128, v129
  v_cvt_pk_bf16_f32 v173, v130, v131
  v_cvt_pk_bf16_f32 v174, v132, v133
  v_cvt_pk_bf16_f32 v175, v134, v135
  v_cvt_pk_bf16_f32 v152, v24, v25
  v_cvt_pk_bf16_f32 v153, v26, v27
  v_cvt_pk_bf16_f32 v154, v28, v29
  v_cvt_pk_bf16_f32 v155, v30, v31
  v_cvt_pk_bf16_f32 v156, v32, v33
  v_cvt_pk_bf16_f32 v157, v34, v35
  v_cvt_pk_bf16_f32 v158, v36, v37
  v_cvt_pk_bf16_f32 v159, v38, v39
  v_cvt_pk_bf16_f32 v160, v40, v41
  v_cvt_pk_bf16_f32 v161, v42, v43
  v_cvt_pk_bf16_f32 v162, v44, v45
  v_cvt_pk_bf16_f32 v163, v46, v47
  v_cvt_pk_bf16_f32 v164, v48, v49
  v_cvt_pk_bf16_f32 v165, v50, v51
  v_cvt_pk_bf16_f32 v166, v52, v53
  v_cvt_pk_bf16_f32 v167, v54, v55
  v_cvt_pk_bf16_f32 v176, v56, v57
  v_cvt_pk_bf16_f32 v177, v58, v59
  v_cvt_pk_bf16_f32 v178, v60, v61
  v_cvt_pk_bf16_f32 v179, v62, v63
  v_cvt_pk_bf16_f32 v180, v64, v65
  v_cvt_pk_bf16_f32 v181, v66, v67
  v_cvt_pk_bf16_f32 v182, v68, v69
  v_cvt_pk_bf16_f32 v183, v70, v71
  v_rcp_f32 v22, v184
  v_rcp_f32 v23, v188
  s_cbranch_vccz RL8
  s_waitcnt vmcnt(0)
  s_barrier
  s_add_u32 m0, s41, 10240
  s_add_u32 s50, s41, 130048
  buffer_load_dwordx4 v1, s[20:23], s50 offen lds
  s_add_u32 m0, s41, 14336
  s_add_u32 s50, s41, 134144
  buffer_load_dwordx4 v1, s[20:23], s50 offen lds
  s_add_u32 m0, s41, 18432
  s_add_u32 s50, s41, 138240
  buffer_load_dwordx4 v1, s[20:23], s50 offen lds
  s_add_u32 m0, s41, 22528
  s_add_u32 s50, s41, 142336
  buffer_load_dwordx4 v1, s[20:23], s50 offen lds
  s_min_u32 s51, s41, 0
  s_add_u32 m0, s51, 26624
  s_add_u32 s50, s51, 146432
  buffer_load_dwordx4 v1, s[20:23], s50 offen lds
RL8:
  ds_read_b128 v[224:227], v2 offset:0
  ds_read_b128 v[228:231], v2 offset:1024
  ds_read_b128 v[232:235], v2 offset:2048
  ds_read_b128 v[236:239], v2 offset:3072
  ds_read_b128 v[240:243], v2 offset:4096
  ds_read_b128 v[244:247], v2 offset:5120
  ds_read_b128 v[248:251], v2 offset:6144
  ds_read_b128 v[252:255], v2 offset:7168
  ds_read_b128 v[216:219], v2 offset:8192
  ds_read_b128 v[220:223], v2 offset:9216
  s_waitcnt lgkmcnt(8)
  v_mfma_f32_16x16x32_bf16 v[184:187], v[224:227], v[136:139], 0
  v_mfma_f32_16x16x32_bf16 v[192:195], v[224:227], v[152:155], 0
  ds_read_b128 v[224:227], v2 offset:10240
  v_mfma_f32_16x16x32_bf16 v[188:191], v[228:231], v[136:139], 0
  v_mfma_f32_16x16x32_bf16 v[196:199], v[228:231], v[152:155], 0
  ds_read_b128 v[228:231], v2 offset:11264
  s_waitcnt lgkmcnt(8)
  v_mfma_f32_16x16x32_bf16 v[184:187], v[232:235], v[140:143], v[184:187]
  v_mfma_f32_16x16x32_bf16 v[192:195], v[232:235], v[156:159], v[192:195]
  ds_read_b128 v[232:235], v2 offset:12288
  v_mfma_f32_16x16x32_bf16 v[188:191], v[236:239], v[140:143], v[188:191]
  v_mfma_f32_16x16x32_bf16 v[196:199], v[236:239], v[156:159], v[196:199]
  ds_read_b128 v[236:239], v2 offset:13312
  s_waitcnt lgkmcnt(8)
  v_mfma_f32_16x16x32_bf16 v[184:187], v[240:243], v[144:147], v[184:187]
  v_mfma_f32_16x16x32_bf16 v[192:195], v[240:243], v[160:163], v[192:195]
  ds_read_b128 v[240:243], v2 offset:14336
  v_mfma_f32_16x16x32_bf16 v[188:191], v[244:247], v[144:147], v[188:191]
  v_mfma_f32_16x16x32_bf16 v[196:199], v[244:247], v[160:163], v[196:199]
  ds_read_b128 v[244:247], v2 offset:15360
  s_waitcnt lgkmcnt(8)
  v_mfma_f32_16x16x32_bf16 v[184:187], v[248:251], v[148:151], v[184:187]
  v_mfma_f32_16x16x32_bf16 v[192:195], v[248:251], v[164:167], v[192:195]
  ds_read_b128 v[248:251], v2 offset:16384
  v_mfma_f32_16x16x32_bf16 v[188:191], v[252:255], v[148:151], v[188:191]
  v_mfma_f32_16x16x32_bf16 v[196:199], v[252:255], v[164:167], v[196:199]
  ds_read_b128 v[252:255], v2 offset:17408
  s_waitcnt lgkmcnt(8)
  v_mfma_f32_16x16x32_bf16 v[184:187], v[216:219], v[168:171], v[184:187]
  v_mfma_f32_16x16x32_bf16 v[192:195], v[216:219], v[176:179], v[192:195]
  ds_read_b128 v[216:219], v2 offset:18432
  v_mfma_f32_16x16x32_bf16 v[188:191], v[220:223], v[168:171], v[188:191]
  v_mfma_f32_16x16x32_bf16 v[196:199], v[220:223], v[176:179], v[196:199]
  ds_read_b128 v[220:223], v2 offset:19456
  s_waitcnt lgkmcnt(8)
  v_mfma_f32_16x16x32_bf16 v[184:187], v[224:227], v[172:175], v[184:187]
  v_mfma_f32_16x16x32_bf16 v[192:195], v[224:227], v[180:183], v[192:195]
  ds_read_b128 v[224:227], v2 offset:20480
  v_mfma_f32_16x16x32_bf16 v[188:191], v[228:231], v[172:175], v[188:191]
  v_mfma_f32_16x16x32_bf16 v[196:199], v[228:231], v[180:183], v[196:199]
  ds_read_b128 v[228:231], v2 offset:21504
  s_waitcnt lgkmcnt(8)
  v_mfma_f32_16x16x32_bf16 v[200:203], v[232:235], v[136:139], 0
  v_mfma_f32_16x16x32_bf16 v[208:211], v[232:235], v[152:155], 0
  ds_read_b128 v[232:235], v2 offset:22528
  v_mul_f32 v184, v184, v22
  v_mfma_f32_16x16x32_bf16 v[204:207], v[236:239], v[136:139], 0
  v_mul_f32 v185, v185, v22
  v_mul_f32 v186, v186, v22
  v_mfma_f32_16x16x32_bf16 v[212:215], v[236:239], v[152:155], 0
  ds_read_b128 v[236:239], v2 offset:23552
  s_waitcnt lgkmcnt(8)
  v_mfma_f32_16x16x32_bf16 v[200:203], v[240:243], v[140:143], v[200:203]
  v_mul_f32 v187, v187, v22
  v_mul_f32 v188, v188, v22
  v_mfma_f32_16x16x32_bf16 v[208:211], v[240:243], v[156:159], v[208:211]
  ds_read_b128 v[240:243], v2 offset:24576
  v_mul_f32 v189, v189, v22
  v_mfma_f32_16x16x32_bf16 v[204:207], v[244:247], v[140:143], v[204:207]
  v_mul_f32 v190, v190, v22
  v_mul_f32 v191, v191, v22
  v_mfma_f32_16x16x32_bf16 v[212:215], v[244:247], v[156:159], v[212:215]
  ds_read_b128 v[244:247], v2 offset:25600
  s_waitcnt lgkmcnt(8)
  v_mfma_f32_16x16x32_bf16 v[200:203], v[248:251], v[144:147], v[200:203]
  v_cvt_pk_bf16_f32 v24, v184, v185
  v_cvt_pk_bf16_f32 v25, v186, v187
  v_mfma_f32_16x16x32_bf16 v[208:211], v[248:251], v[160:163], v[208:211]
  ds_read_b128 v[248:251], v2 offset:26624
  v_cvt_pk_bf16_f32 v26, v188, v189
  v_mfma_f32_16x16x32_bf16 v[204:207], v[252:255], v[144:147], v[204:207]
  v_cvt_pk_bf16_f32 v27, v190, v191
  buffer_store_dwordx4 v[24:27], v5, s[16:19], 0 offen offset:0 nt sc1
  v_mfma_f32_16x16x32_bf16 v[212:215], v[252:255], v[160:163], v[212:215]
  ds_read_b128 v[252:255], v2 offset:27648
  s_waitcnt lgkmcnt(8)
  v_mfma_f32_16x16x32_bf16 v[200:203], v[216:219], v[148:151], v[200:203]
  v_mul_f32 v192, v192, v23
  v_mul_f32 v193, v193, v23
  v_mfma_f32_16x16x32_bf16 v[208:211], v[216:219], v[164:167], v[208:211]
  ds_read_b128 v[216:219], v2 offset:28672
  v_mul_f32 v194, v194, v23
  v_mfma_f32_16x16x32_bf16 v[204:207], v[220:223], v[148:151], v[204:207]
  v_mul_f32 v195, v195, v23
  v_mul_f32 v196, v196, v23
  v_mfma_f32_16x16x32_bf16 v[212:215], v[220:223], v[164:167], v[212:215]
  ds_read_b128 v[220:223], v2 offset:29696
  s_waitcnt lgkmcnt(8)
  v_mfma_f32_16x16x32_bf16 v[200:203], v[224:227], v[168:171], v[200:203]
  v_mul_f32 v197, v197, v23
  v_mul_f32 v198, v198, v23
  v_mfma_f32_16x16x32_bf16 v[208:211], v[224:227], v[176:179], v[208:211]
  ds_read_b128 v[224:227], v2 offset:30720
  v_mul_f32 v199, v199, v23
  v_mfma_f32_16x16x32_bf16 v[204:207], v[228:231], v[168:171], v[204:207]
  v_cvt_pk_bf16_f32 v28, v192, v193
  v_cvt_pk_bf16_f32 v29, v194, v195
  v_mfma_f32_16x16x32_bf16 v[212:215], v[228:231], v[176:179], v[212:215]
  ds_read_b128 v[228:231], v2 offset:31744
  s_waitcnt lgkmcnt(8)
  v_mfma_f32_16x16x32_bf16 v[200:203], v[232:235], v[172:175], v[200:203]
  v_cvt_pk_bf16_f32 v30, v196, v197
  v_cvt_pk_bf16_f32 v31, v198, v199
  v_mfma_f32_16x16x32_bf16 v[208:211], v[232:235], v[180:183], v[208:211]
  ds_read_b128 v[232:235], v2 offset:32768
  buffer_store_dwordx4 v[28:31], v6, s[16:19], 0 offen offset:0 nt sc1
  v_mfma_f32_16x16x32_bf16 v[204:207], v[236:239], v[172:175], v[204:207]
  v_mfma_f32_16x16x32_bf16 v[212:215], v[236:239], v[180:183], v[212:215]
  ds_read_b128 v[236:239], v2 offset:33792
  s_waitcnt lgkmcnt(8)
  v_mfma_f32_16x16x32_bf16 v[184:187], v[240:243], v[136:139], 0
  v_mul_f32 v200, v200, v22
  v_mul_f32 v201, v201, v22
  v_mfma_f32_16x16x32_bf16 v[192:195], v[240:243], v[152:155], 0
  ds_read_b128 v[240:243], v2 offset:34816
  v_mul_f32 v202, v202, v22
  v_mfma_f32_16x16x32_bf16 v[188:191], v[244:247], v[136:139], 0
  v_mul_f32 v203, v203, v22
  v_mul_f32 v204, v204, v22
  v_mfma_f32_16x16x32_bf16 v[196:199], v[244:247], v[152:155], 0
  ds_read_b128 v[244:247], v2 offset:35840
  s_waitcnt lgkmcnt(8)
  v_mfma_f32_16x16x32_bf16 v[184:187], v[248:251], v[140:143], v[184:187]
  v_mul_f32 v205, v205, v22
  v_mul_f32 v206, v206, v22
  v_mfma_f32_16x16x32_bf16 v[192:195], v[248:251], v[156:159], v[192:195]
  ds_read_b128 v[248:251], v2 offset:36864
  v_mul_f32 v207, v207, v22
  v_mfma_f32_16x16x32_bf16 v[188:191], v[252:255], v[140:143], v[188:191]
  v_cvt_pk_bf16_f32 v32, v200, v201
  v_cvt_pk_bf16_f32 v33, v202, v203
  v_mfma_f32_16x16x32_bf16 v[196:199], v[252:255], v[156:159], v[196:199]
  ds_read_b128 v[252:255], v2 offset:37888
  s_waitcnt lgkmcnt(8)
  v_mfma_f32_16x16x32_bf16 v[184:187], v[216:219], v[144:147], v[184:187]
  v_cvt_pk_bf16_f32 v34, v204, v205
  v_cvt_pk_bf16_f32 v35, v206, v207
  v_mfma_f32_16x16x32_bf16 v[192:195], v[216:219], v[160:163], v[192:195]
  ds_read_b128 v[216:219], v2 offset:38912
  buffer_store_dwordx4 v[32:35], v5, s[16:19], 0 offen offset:64 nt sc1
  v_mfma_f32_16x16x32_bf16 v[188:191], v[220:223], v[144:147], v[188:191]
  v_mul_f32 v208, v208, v23
  v_mul_f32 v209, v209, v23
  v_mfma_f32_16x16x32_bf16 v[196:199], v[220:223], v[160:163], v[196:199]
  ds_read_b128 v[220:223], v2 offset:39936
  s_waitcnt lgkmcnt(8)
  v_mfma_f32_16x16x32_bf16 v[184:187], v[224:227], v[148:151], v[184:187]
  v_mul_f32 v210, v210, v23
  v_mul_f32 v211, v211, v23
  v_mfma_f32_16x16x32_bf16 v[192:195], v[224:227], v[164:167], v[192:195]
  ds_read_b128 v[224:227], v2 offset:40960
  v_mul_f32 v212, v212, v23
  v_mfma_f32_16x16x32_bf16 v[188:191], v[228:231], v[148:151], v[188:191]
  v_mul_f32 v213, v213, v23
  v_mul_f32 v214, v214, v23
  v_mfma_f32_16x16x32_bf16 v[196:199], v[228:231], v[164:167], v[196:199]
  ds_read_b128 v[228:231], v2 offset:41984
  s_waitcnt lgkmcnt(8)
  v_mfma_f32_16x16x32_bf16 v[184:187], v[232:235], v[168:171], v[184:187]
  v_mul_f32 v215, v215, v23
  v_cvt_pk_bf16_f32 v36, v208, v209
  v_mfma_f32_16x16x32_bf16 v[192:195], v[232:235], v[176:179], v[192:195]
  ds_read_b128 v[232:235], v2 offset:43008
  v_cvt_pk_bf16_f32 v37, v210, v211
  v_mfma_f32_16x16x32_bf16 v[188:191], v[236:239], v[168:171], v[188:191]
  v_cvt_pk_bf16_f32 v38, v212, v213
  v_cvt_pk_bf16_f32 v39, v214, v215
  v_mfma_f32_16x16x32_bf16 v[196:199], v[236:239], v[176:179], v[196:199]
  ds_read_b128 v[236:239], v2 offset:44032
  s_waitcnt lgkmcnt(8)
  v_mfma_f32_16x16x32_bf16 v[184:187], v[240:243], v[172:175], v[184:187]
  buffer_store_dwordx4 v[36:39], v6, s[16:19], 0 offen offset:64 nt sc1
  v_mfma_f32_16x16x32_bf16 v[192:195], v[240:243], v[180:183], v[192:195]
  ds_read_b128 v[240:243], v2 offset:45056
  v_mfma_f32_16x16x32_bf16 v[188:191], v[244:247], v[172:175], v[188:191]
  v_mfma_f32_16x16x32_bf16 v[196:199], v[244:247], v[180:183], v[196:199]
  ds_read_b128 v[244:247], v1 offset:0
  s_cbranch_vccz RL9
  s_waitcnt vmcnt(4)
  s_barrier
RL9:
  s_waitcnt lgkmcnt(8)
  v_mfma_f32_16x16x32_bf16 v[200:203], v[248:251], v[136:139], 0
  v_mul_f32 v184, v184, v22
  v_mul_f32 v185, v185, v22
  v_mfma_f32_16x16x32_bf16 v[208:211], v[248:251], v[152:155], 0
  ds_read_b128 v[248:251], v1 offset:1024
  v_mul_f32 v186, v186, v22
  v_mfma_f32_16x16x32_bf16 v[204:207], v[252:255], v[136:139], 0
  v_mul_f32 v187, v187, v22
  v_mul_f32 v188, v188, v22
  v_mfma_f32_16x16x32_bf16 v[212:215], v[252:255], v[152:155], 0
  ds_read_b128 v[252:255], v1 offset:2048
  s_waitcnt lgkmcnt(8)
  v_mfma_f32_16x16x32_bf16 v[200:203], v[216:219], v[140:143], v[200:203]
  v_mul_f32 v189, v189, v22
  v_mul_f32 v190, v190, v22
  v_mfma_f32_16x16x32_bf16 v[208:211], v[216:219], v[156:159], v[208:211]
  ds_read_b128 v[216:219], v1 offset:3072
  v_mul_f32 v191, v191, v22
  v_mfma_f32_16x16x32_bf16 v[204:207], v[220:223], v[140:143], v[204:207]
  v_cvt_pk_bf16_f32 v24, v184, v185
  v_cvt_pk_bf16_f32 v25, v186, v187
  v_mfma_f32_16x16x32_bf16 v[212:215], v[220:223], v[156:159], v[212:215]
  ds_read_b128 v[220:223], v1 offset:4096
  s_waitcnt lgkmcnt(8)
  v_mfma_f32_16x16x32_bf16 v[200:203], v[224:227], v[144:147], v[200:203]
  v_cvt_pk_bf16_f32 v26, v188, v189
  v_cvt_pk_bf16_f32 v27, v190, v191
  v_mfma_f32_16x16x32_bf16 v[208:211], v[224:227], v[160:163], v[208:211]
  ds_read_b128 v[224:227], v1 offset:5120
  buffer_store_dwordx4 v[24:27], v5, s[16:19], 0 offen offset:128 nt sc1
  v_mfma_f32_16x16x32_bf16 v[204:207], v[228:231], v[144:147], v[204:207]
  v_mul_f32 v192, v192, v23
  v_mul_f32 v193, v193, v23
  v_mfma_f32_16x16x32_bf16 v[212:215], v[228:231], v[160:163], v[212:215]
  ds_read_b128 v[228:231], v1 offset:6144
  s_waitcnt lgkmcnt(8)
  v_mfma_f32_16x16x32_bf16 v[200:203], v[232:235], v[148:151], v[200:203]
  v_mul_f32 v194, v194, v23
  v_mul_f32 v195, v195, v23
  v_mfma_f32_16x16x32_bf16 v[208:211], v[232:235], v[164:167], v[208:211]
  ds_read_b128 v[232:235], v1 offset:7168
  v_mul_f32 v196, v196, v23
  v_mfma_f32_16x16x32_bf16 v[204:207], v[236:239], v[148:151], v[204:207]
  v_mul_f32 v197, v197, v23
  v_mul_f32 v198, v198, v23
  v_mfma_f32_16x16x32_bf16 v[212:215], v[236:239], v[164:167], v[212:215]
  ds_read_b128 v[236:239], v1 offset:8192
  s_waitcnt lgkmcnt(8)
  v_mfma_f32_16x16x32_bf16 v[200:203], v[240:243], v[168:171], v[200:203]
  v_mul_f32 v199, v199, v23
  v_cvt_pk_bf16_f32 v28, v192, v193
  v_mfma_f32_16x16x32_bf16 v[208:211], v[240:243], v[176:179], v[208:211]
  ds_read_b128 v[240:243], v1 offset:9216
  v_cvt_pk_bf16_f32 v29, v194, v195
  v_mfma_f32_16x16x32_bf16 v[204:207], v[244:247], v[168:171], v[204:207]
  v_cvt_pk_bf16_f32 v30, v196, v197
  v_cvt_pk_bf16_f32 v31, v198, v199
  v_mfma_f32_16x16x32_bf16 v[212:215], v[244:247], v[176:179], v[212:215]
  ds_read_b128 v[244:247], v1 offset:10240
  s_waitcnt lgkmcnt(8)
  v_mfma_f32_16x16x32_bf16 v[200:203], v[248:251], v[172:175], v[200:203]
  buffer_store_dwordx4 v[28:31], v6, s[16:19], 0 offen offset:128 nt sc1
  v_mfma_f32_16x16x32_bf16 v[208:211], v[248:251], v[180:183], v[208:211]
  ds_read_b128 v[248:251], v1 offset:11264
  v_mfma_f32_16x16x32_bf16 v[204:207], v[252:255], v[172:175], v[204:207]
  v_mfma_f32_16x16x32_bf16 v[212:215], v[252:255], v[180:183], v[212:215]
  ds_read_b128 v[252:255], v1 offset:12288
  s_waitcnt lgkmcnt(8)
  v_mfma_f32_16x16x32_bf16 v[184:187], v[216:219], v[136:139], 0
  v_mul_f32 v200, v200, v22
  v_mul_f32 v201, v201, v22
  v_mfma_f32_16x16x32_bf16 v[192:195], v[216:219], v[152:155], 0
  ds_read_b128 v[216:219], v1 offset:13312
  v_mul_f32 v202, v202, v22
  v_mfma_f32_16x16x32_bf16 v[188:191], v[220:223], v[136:139], 0
  v_mul_f32 v203, v203, v22
  v_mul_f32 v204, v204, v22
  v_mfma_f32_16x16x32_bf16 v[196:199], v[220:223], v[152:155], 0
  ds_read_b128 v[220:223], v1 offset:14336
  s_waitcnt lgkmcnt(8)
  v_mfma_f32_16x16x32_bf16 v[184:187], v[224:227], v[140:143], v[184:187]
  v_mul_f32 v205, v205, v22
  v_mul_f32 v206, v206, v22
  v_mfma_f32_16x16x32_bf16 v[192:195], v[224:227], v[156:159], v[192:195]
  ds_read_b128 v[224:227], v1 offset:15360
  v_mul_f32 v207, v207, v22
  v_mfma_f32_16x16x32_bf16 v[188:191], v[228:231], v[140:143], v[188:191]
  v_cvt_pk_bf16_f32 v32, v200, v201
  v_cvt_pk_bf16_f32 v33, v202, v203
  v_mfma_f32_16x16x32_bf16 v[196:199], v[228:231], v[156:159], v[196:199]
  ds_read_b128 v[228:231], v1 offset:16384
  s_waitcnt lgkmcnt(8)
  v_mfma_f32_16x16x32_bf16 v[184:187], v[232:235], v[144:147], v[184:187]
  v_cvt_pk_bf16_f32 v34, v204, v205
  v_cvt_pk_bf16_f32 v35, v206, v207
  v_mfma_f32_16x16x32_bf16 v[192:195], v[232:235], v[160:163], v[192:195]
  ds_read_b128 v[232:235], v1 offset:17408
  buffer_store_dwordx4 v[32:35], v5, s[16:19], 0 offen offset:192 nt sc1
  v_mfma_f32_16x16x32_bf16 v[188:191], v[236:239], v[144:147], v[188:191]
  v_mul_f32 v208, v208, v23
  v_mul_f32 v209, v209, v23
  v_mfma_f32_16x16x32_bf16 v[196:199], v[236:239], v[160:163], v[196:199]
  ds_read_b128 v[236:239], v1 offset:18432
  s_waitcnt lgkmcnt(8)
  v_mfma_f32_16x16x32_bf16 v[184:187], v[240:243], v[148:151], v[184:187]
  v_mul_f32 v210, v210, v23
  v_mul_f32 v211, v211, v23
  v_mfma_f32_16x16x32_bf16 v[192:195], v[240:243], v[164:167], v[192:195]
  ds_read_b128 v[240:243], v1 offset:19456
  v_mul_f32 v212, v212, v23
  v_mfma_f32_16x16x32_bf16 v[188:191], v[244:247], v[148:151], v[188:191]
  v_mul_f32 v213, v213, v23
  v_mul_f32 v214, v214, v23
  v_mfma_f32_16x16x32_bf16 v[196:199], v[244:247], v[164:167], v[196:199]
  ds_read_b128 v[244:247], v1 offset:20480
  s_waitcnt lgkmcnt(8)
  v_mfma_f32_16x16x32_bf16 v[184:187], v[248:251], v[168:171], v[184:187]
  v_mul_f32 v215, v215, v23
  v_cvt_pk_bf16_f32 v36, v208, v209
  v_mfma_f32_16x16x32_bf16 v[192:195], v[248:251], v[176:179], v[192:195]
  ds_read_b128 v[248:251], v1 offset:21504
  v_cvt_pk_bf16_f32 v37, v210, v211
  v_mfma_f32_16x16x32_bf16 v[188:191], v[252:255], v[168:171], v[188:191]
  v_cvt_pk_bf16_f32 v38, v212, v213
  v_cvt_pk_bf16_f32 v39, v214, v215
  v_mfma_f32_16x16x32_bf16 v[196:199], v[252:255], v[176:179], v[196:199]
  ds_read_b128 v[252:255], v1 offset:22528
  s_waitcnt lgkmcnt(8)
  v_mfma_f32_16x16x32_bf16 v[184:187], v[216:219], v[172:175], v[184:187]
  buffer_store_dwordx4 v[36:39], v6, s[16:19], 0 offen offset:192 nt sc1
  v_mfma_f32_16x16x32_bf16 v[192:195], v[216:219], v[180:183], v[192:195]
  ds_read_b128 v[216:219], v1 offset:23552
  v_mfma_f32_16x16x32_bf16 v[188:191], v[220:223], v[172:175], v[188:191]
  v_mfma_f32_16x16x32_bf16 v[196:199], v[220:223], v[180:183], v[196:199]
  ds_read_b128 v[220:223], v1 offset:24576
  s_waitcnt lgkmcnt(8)
  v_mfma_f32_16x16x32_bf16 v[200:203], v[224:227], v[136:139], 0
  v_mul_f32 v184, v184, v22
  v_mul_f32 v185, v185, v22
  v_mfma_f32_16x16x32_bf16 v[208:211], v[224:227], v[152:155], 0
  ds_read_b128 v[224:227], v1 offset:25600
  v_mul_f32 v186, v186, v22
  v_mfma_f32_16x16x32_bf16 v[204:207], v[228:231], v[136:139], 0
  v_mul_f32 v187, v187, v22
  v_mul_f32 v188, v188, v22
  v_mfma_f32_16x16x32_bf16 v[212:215], v[228:231], v[152:155], 0
  ds_read_b128 v[228:231], v1 offset:26624
  s_waitcnt lgkmcnt(8)
  v_mfma_f32_16x16x32_bf16 v[200:203], v[232:235], v[140:143], v[200:203]
  v_mul_f32 v189, v189, v22
  v_mul_f32 v190, v190, v22
  v_mfma_f32_16x16x32_bf16 v[208:211], v[232:235], v[156:159], v[208:211]
  v_mul_f32 v191, v191, v22
  v_cvt_pk_bf16_f32 v24, v184, v185
  v_mfma_f32_16x16x32_bf16 v[204:207], v[236:239], v[140:143], v[204:207]
  v_cvt_pk_bf16_f32 v25, v186, v187
  v_cvt_pk_bf16_f32 v26, v188, v189
  v_mfma_f32_16x16x32_bf16 v[212:215], v[236:239], v[156:159], v[212:215]
  v_cvt_pk_bf16_f32 v27, v190, v191
  s_waitcnt lgkmcnt(6)
  v_mfma_f32_16x16x32_bf16 v[200:203], v[240:243], v[144:147], v[200:203]
  buffer_store_dwordx4 v[24:27], v5, s[16:19], 0 offen offset:256 nt sc1
  v_mul_f32 v192, v192, v23
  v_mfma_f32_16x16x32_bf16 v[208:211], v[240:243], v[160:163], v[208:211]
  v_mul_f32 v193, v193, v23
  v_mul_f32 v194, v194, v23
  v_mfma_f32_16x16x32_bf16 v[204:207], v[244:247], v[144:147], v[204:207]
  v_mul_f32 v195, v195, v23
  v_mul_f32 v196, v196, v23
  v_mfma_f32_16x16x32_bf16 v[212:215], v[244:247], v[160:163], v[212:215]
  v_mul_f32 v197, v197, v23
  s_waitcnt lgkmcnt(5)
  v_mfma_f32_16x16x32_bf16 v[200:203], v[248:251], v[148:151], v[200:203]
  v_mul_f32 v198, v198, v23
  v_mul_f32 v199, v199, v23
  v_mfma_f32_16x16x32_bf16 v[208:211], v[248:251], v[164:167], v[208:211]
  v_cvt_pk_bf16_f32 v28, v192, v193
  s_waitcnt lgkmcnt(4)
  v_mfma_f32_16x16x32_bf16 v[204:207], v[252:255], v[148:151], v[204:207]
  v_cvt_pk_bf16_f32 v29, v194, v195
  v_cvt_pk_bf16_f32 v30, v196, v197
  v_mfma_f32_16x16x32_bf16 v[212:215], v[252:255], v[164:167], v[212:215]
  v_cvt_pk_bf16_f32 v31, v198, v199
  s_waitcnt lgkmcnt(3)
  v_mfma_f32_16x16x32_bf16 v[200:203], v[216:219], v[168:171], v[200:203]
  buffer_store_dwordx4 v[28:31], v6, s[16:19], 0 offen offset:256 nt sc1
  v_mfma_f32_16x16x32_bf16 v[208:211], v[216:219], v[176:179], v[208:211]
  s_waitcnt lgkmcnt(2)
  v_mfma_f32_16x16x32_bf16 v[204:207], v[220:223], v[168:171], v[204:207]
  v_mfma_f32_16x16x32_bf16 v[212:215], v[220:223], v[176:179], v[212:215]
  s_waitcnt lgkmcnt(1)
  v_mfma_f32_16x16x32_bf16 v[200:203], v[224:227], v[172:175], v[200:203]
  v_mfma_f32_16x16x32_bf16 v[208:211], v[224:227], v[180:183], v[208:211]
  s_waitcnt lgkmcnt(0)
  v_mfma_f32_16x16x32_bf16 v[204:207], v[228:231], v[172:175], v[204:207]
  v_mfma_f32_16x16x32_bf16 v[212:215], v[228:231], v[180:183], v[212:215]
  s_nop 3
  v_mul_f32 v200, v200, v22
  v_mul_f32 v201, v201, v22
  v_mul_f32 v202, v202, v22
  v_mul_f32 v203, v203, v22
  v_mul_f32 v204, v204, v22
  v_mul_f32 v205, v205, v22
  v_mul_f32 v206, v206, v22
  v_mul_f32 v207, v207, v22
  v_cvt_pk_bf16_f32 v32, v200, v201
  v_cvt_pk_bf16_f32 v33, v202, v203
  v_cvt_pk_bf16_f32 v34, v204, v205
  v_cvt_pk_bf16_f32 v35, v206, v207
  buffer_store_dwordx4 v[32:35], v5, s[16:19], 0 offen offset:320 nt sc1
  v_mul_f32 v208, v208, v23
  v_mul_f32 v209, v209, v23
  v_mul_f32 v210, v210, v23
  v_mul_f32 v211, v211, v23
  v_mul_f32 v212, v212, v23
  v_mul_f32 v213, v213, v23
  v_mul_f32 v214, v214, v23
  v_mul_f32 v215, v215, v23
  v_cvt_pk_bf16_f32 v36, v208, v209
  v_cvt_pk_bf16_f32 v37, v210, v211
  v_cvt_pk_bf16_f32 v38, v212, v213
  v_cvt_pk_bf16_f32 v39, v214, v215
  buffer_store_dwordx4 v[36:39], v6, s[16:19], 0 offen offset:320 nt sc1
MK_done:
  s_endpgm
FB0:
  s_nop 7
  v_max3_f32 v22, v24, v25, v26
  v_max3_f32 v22, v22, v27, v28
  v_max3_f32 v22, v22, v29, v30
  v_max3_f32 v22, v22, v31, v32
  v_max3_f32 v22, v22, v33, v34
  v_max3_f32 v22, v22, v35, v36
  v_max3_f32 v22, v22, v37, v38
  v_max3_f32 v22, v22, v39, v40
  v_max3_f32 v22, v22, v41, v42
  v_max3_f32 v22, v22, v43, v44
  v_max3_f32 v22, v22, v45, v46
  v_max3_f32 v22, v22, v47, v48
  v_max3_f32 v22, v22, v49, v50
  v_max3_f32 v22, v22, v51, v52
  v_max3_f32 v22, v22, v53, v54
  s_mov_b32 s52, 0xff7fffff
  v_max3_f32 v22, v22, v55, s52
  v_mov_b32 v23, v22
  s_nop 1
  v_permlane32_swap_b32 v22, v23
  s_nop 1
  v_max_f32 v22, v22, v23
  v_mov_b32 v23, v22
  s_nop 1
  v_permlane16_swap_b32 v22, v23
  s_nop 1
  v_max_f32 v22, v22, v23
  v_sub_f32 v24, v24, v22
  v_sub_f32 v25, v25, v22
  v_sub_f32 v26, v26, v22
  v_sub_f32 v27, v27, v22
  v_sub_f32 v28, v28, v22
  v_sub_f32 v29, v29, v22
  v_sub_f32 v30, v30, v22
  v_sub_f32 v31, v31, v22
  v_sub_f32 v32, v32, v22
  v_sub_f32 v33, v33, v22
  v_sub_f32 v34, v34, v22
  v_sub_f32 v35, v35, v22
  v_sub_f32 v36, v36, v22
  v_sub_f32 v37, v37, v22
  v_sub_f32 v38, v38, v22
  v_sub_f32 v39, v39, v22
  v_sub_f32 v40, v40, v22
  v_sub_f32 v41, v41, v22
  v_sub_f32 v42, v42, v22
  v_sub_f32 v43, v43, v22
  v_sub_f32 v44, v44, v22
  v_sub_f32 v45, v45, v22
  v_sub_f32 v46, v46, v22
  v_sub_f32 v47, v47, v22
  v_sub_f32 v48, v48, v22
  v_sub_f32 v49, v49, v22
  v_sub_f32 v50, v50, v22
  v_sub_f32 v51, v51, v22
  v_sub_f32 v52, v52, v22
  v_sub_f32 v53, v53, v22
  v_sub_f32 v54, v54, v22
  v_sub_f32 v55, v55, v22
  v_exp_f32 v24, v24
  v_exp_f32 v25, v25
  v_exp_f32 v26, v26
  v_exp_f32 v27, v27
  v_exp_f32 v28, v28
  v_exp_f32 v29, v29
  v_exp_f32 v30, v30
  v_exp_f32 v31, v31
  v_exp_f32 v32, v32
  v_exp_f32 v33, v33
  v_exp_f32 v34, v34
  v_exp_f32 v35, v35
  v_exp_f32 v36, v36
  v_exp_f32 v37, v37
  v_exp_f32 v38, v38
  v_exp_f32 v39, v39
  v_exp_f32 v40, v40
  v_exp_f32 v41, v41
  v_exp_f32 v42, v42
  v_exp_f32 v43, v43
  v_exp_f32 v44, v44
  v_exp_f32 v45, v45
  v_exp_f32 v46, v46
  v_exp_f32 v47, v47
  v_exp_f32 v48, v48
  v_exp_f32 v49, v49
  v_exp_f32 v50, v50
  v_exp_f32 v51, v51
  v_exp_f32 v52, v52
  v_exp_f32 v53, v53
  v_exp_f32 v54, v54
  v_exp_f32 v55, v55
  s_nop 0
  v_cvt_pk_bf16_f32 v136, v24, v25
  v_cvt_pk_bf16_f32 v137, v26, v27
  v_cvt_pk_bf16_f32 v138, v28, v29
  v_cvt_pk_bf16_f32 v139, v30, v31
  v_cvt_pk_bf16_f32 v140, v32, v33
  v_cvt_pk_bf16_f32 v141, v34, v35
  v_cvt_pk_bf16_f32 v142, v36, v37
  v_cvt_pk_bf16_f32 v143, v38, v39
  v_cvt_pk_bf16_f32 v144, v40, v41
  v_cvt_pk_bf16_f32 v145, v42, v43
  v_cvt_pk_bf16_f32 v146, v44, v45
  v_cvt_pk_bf16_f32 v147, v46, v47
  v_cvt_pk_bf16_f32 v148, v48, v49
  v_cvt_pk_bf16_f32 v149, v50, v51
  v_cvt_pk_bf16_f32 v150, v52, v53
  v_cvt_pk_bf16_f32 v151, v54, v55
  s_nop 1
  v_mfma_f32_16x16x32_bf16 v[184:187], v[192:195], v[136:139], 0
  v_mfma_f32_16x16x32_bf16 v[184:187], v[192:195], v[140:143], v[184:187]
  v_mfma_f32_16x16x32_bf16 v[184:187], v[192:195], v[144:147], v[184:187]
  v_mfma_f32_16x16x32_bf16 v[184:187], v[192:195], v[148:151], v[184:187]
  s_nop 7
  s_branch FBR0
FB1:
  s_nop 7
  v_max3_f32 v22, v56, v57, v58
  v_max3_f32 v22, v22, v59, v60
  v_max3_f32 v22, v22, v61, v62
  v_max3_f32 v22, v22, v63, v64
  v_max3_f32 v22, v22, v65, v66
  v_max3_f32 v22, v22, v67, v68
  v_max3_f32 v22, v22, v69, v70
  v_max3_f32 v22, v22, v71, v72
  v_max3_f32 v22, v22, v73, v74
  v_max3_f32 v22, v22, v75, v76
  v_max3_f32 v22, v22, v77, v78
  v_max3_f32 v22, v22, v79, v80
  v_max3_f32 v22, v22, v81, v82
  v_max3_f32 v22, v22, v83, v84
  v_max3_f32 v22, v22, v85, v86
  s_mov_b32 s52, 0xff7fffff
  v_max3_f32 v22, v22, v87, s52
  v_mov_b32 v23, v22
  s_nop 1
  v_permlane32_swap_b32 v22, v23
  s_nop 1
  v_max_f32 v22, v22, v23
  v_mov_b32 v23, v22
  s_nop 1
  v_permlane16_swap_b32 v22, v23
  s_nop 1
  v_max_f32 v22, v22, v23
  v_sub_f32 v56, v56, v22
  v_sub_f32 v57, v57, v22
  v_sub_f32 v58, v58, v22
  v_sub_f32 v59, v59, v22
  v_sub_f32 v60, v60, v22
  v_sub_f32 v61, v61, v22
  v_sub_f32 v62, v62, v22
  v_sub_f32 v63, v63, v22
  v_sub_f32 v64, v64, v22
  v_sub_f32 v65, v65, v22
  v_sub_f32 v66, v66, v22
  v_sub_f32 v67, v67, v22
  v_sub_f32 v68, v68, v22
  v_sub_f32 v69, v69, v22
  v_sub_f32 v70, v70, v22
  v_sub_f32 v71, v71, v22
  v_sub_f32 v72, v72, v22
  v_sub_f32 v73, v73, v22
  v_sub_f32 v74, v74, v22
  v_sub_f32 v75, v75, v22
  v_sub_f32 v76, v76, v22
  v_sub_f32 v77, v77, v22
  v_sub_f32 v78, v78, v22
  v_sub_f32 v79, v79, v22
  v_sub_f32 v80, v80, v22
  v_sub_f32 v81, v81, v22
  v_sub_f32 v82, v82, v22
  v_sub_f32 v83, v83, v22
  v_sub_f32 v84, v84, v22
  v_sub_f32 v85, v85, v22
  v_sub_f32 v86, v86, v22
  v_sub_f32 v87, v87, v22
  v_exp_f32 v56, v56
  v_exp_f32 v57, v57
  v_exp_f32 v58, v58
  v_exp_f32 v59, v59
  v_exp_f32 v60, v60
  v_exp_f32 v61, v61
  v_exp_f32 v62, v62
  v_exp_f32 v63, v63
  v_exp_f32 v64, v64
  v_exp_f32 v65, v65
  v_exp_f32 v66, v66
  v_exp_f32 v67, v67
  v_exp_f32 v68, v68
  v_exp_f32 v69, v69
  v_exp_f32 v70, v70
  v_exp_f32 v71, v71
  v_exp_f32 v72, v72
  v_exp_f32 v73, v73
  v_exp_f32 v74, v74
  v_exp_f32 v75, v75
  v_exp_f32 v76, v76
  v_exp_f32 v77, v77
  v_exp_f32 v78, v78
  v_exp_f32 v79, v79
  v_exp_f32 v80, v80
  v_exp_f32 v81, v81
  v_exp_f32 v82, v82
  v_exp_f32 v83, v83
  v_exp_f32 v84, v84
  v_exp_f32 v85, v85
  v_exp_f32 v86, v86
  v_exp_f32 v87, v87
  s_nop 0
  v_cvt_pk_bf16_f32 v152, v56, v57
  v_cvt_pk_bf16_f32 v153, v58, v59
  v_cvt_pk_bf16_f32 v154, v60, v61
  v_cvt_pk_bf16_f32 v155, v62, v63
  v_cvt_pk_bf16_f32 v156, v64, v65
  v_cvt_pk_bf16_f32 v157, v66, v67
  v_cvt_pk_bf16_f32 v158, v68, v69
  v_cvt_pk_bf16_f32 v159, v70, v71
  v_cvt_pk_bf16_f32 v160, v72, v73
  v_cvt_pk_bf16_f32 v161, v74, v75
  v_cvt_pk_bf16_f32 v162, v76, v77
  v_cvt_pk_bf16_f32 v163, v78, v79
  v_cvt_pk_bf16_f32 v164, v80, v81
  v_cvt_pk_bf16_f32 v165, v82, v83
  v_cvt_pk_bf16_f32 v166, v84, v85
  v_cvt_pk_bf16_f32 v167, v86, v87
  s_nop 1
  v_mfma_f32_16x16x32_bf16 v[188:191], v[192:195], v[152:155], 0
  v_mfma_f32_16x16x32_bf16 v[188:191], v[192:195], v[156:159], v[188:191]
  v_mfma_f32_16x16x32_bf16 v[188:191], v[192:195], v[160:163], v[188:191]
  v_mfma_f32_16x16x32_bf16 v[188:191], v[192:195], v[164:167], v[188:191]
  s_nop 7
  s_branch FBR1
.section .rodata,"a"
.p2align 6
.amdhsa_kernel prep_kernel
  .amdhsa_next_free_vgpr 152
  .amdhsa_next_free_sgpr 102
  .amdhsa_accum_offset 152
  .amdhsa_group_segment_fixed_size 0
  .amdhsa_kernarg_size 48
  .amdhsa_user_sgpr_count 2
  .amdhsa_user_sgpr_kernarg_segment_ptr 1
  .amdhsa_system_sgpr_workgroup_id_x 1
.end_amdhsa_kernel
.p2align 6
.amdhsa_kernel main_kernel
  .amdhsa_next_free_vgpr 256
  .amdhsa_next_free_sgpr 102
  .amdhsa_accum_offset 256
  .amdhsa_group_segment_fixed_size 0
  .amdhsa_kernarg_size 48
  .amdhsa_user_sgpr_count 2
  .amdhsa_user_sgpr_kernarg_segment_ptr 1
  .amdhsa_system_sgpr_workgroup_id_x 1
.end_amdhsa_kernel
```

```asm
; @launch grid=(256,1,1) block=(512,1,1) lds=163840
.amdgcn_target "amdgcn-amd-amdhsa--gfx950"
.text
.globl standalone__neighborhood_nat__vision_kernel
.p2align 8
.type standalone__neighborhood_nat__vision_kernel,@function
standalone__neighborhood_nat__vision_kernel:
  s_cmp_ge_u32 s2, 256
  s_cbranch_scc1 MK_done
  s_load_dwordx8 s[4:11], s[0:1], 0
  s_load_dwordx4 s[84:87], s[0:1], 32
  v_lshrrev_b32 v15, 6, v0
  v_and_b32 v0, 63, v0
  v_readfirstlane_b32 s24, v15
  v_lshlrev_b32 v1, 4, v0
  v_add_u32 v2, 36864, v1
  v_and_b32 v15, 15, v0
  v_lshrrev_b32 v16, 4, v0
  v_lshrrev_b32 v19, 5, v0
  v_bfe_u32 v20, v0, 3, 2
  v_lshl_add_u32 v19, v19, 3, v20
  v_mul_u32_u24 v19, 1152, v19
  s_and_b32 s26, s24, 1
  s_lshl_b32 s46, s26, 2
  v_add_u32 v20, s46, v16
  v_and_b32 v21, 7, v0
  v_xor_b32 v20, v20, v21
  v_lshl_add_u32 v96, v20, 4, v19
  s_lshr_b32 s46, s24, 2
  s_lshl_b32 s46, s46, 5
  s_lshl_b32 s47, s26, 4
  s_add_u32 s46, s46, s47
  s_and_b32 s47, s24, 2
  s_lshl_b32 s47, s47, 1
  s_add_u32 s46, s46, s47
  s_mul_i32 s92, s46, 1152
  s_lshl_b32 s55, s24, 10
  s_cmp_lt_u32 s2, 72
  s_cselect_b32 s3, 1, 0
  s_cmp_eq_u32 s24, 4
  s_cselect_b32 s3, s3, 0
  s_waitcnt lgkmcnt(0)
  s_mov_b32 s88, s6
  s_and_b32 s89, s7, 0xffff
  s_mov_b32 s90, 221184
  s_mov_b32 s91, 0x00020000
  s_mov_b32 s12, s4
  s_and_b32 s13, s5, 0xffff
  s_mov_b32 s14, 19267584
  s_mov_b32 s15, 0x00020000
  s_mov_b32 s16, s10
  s_and_b32 s17, s11, 0xffff
  s_mov_b32 s18, 19267584
  s_mov_b32 s19, 0x00020000
  s_mov_b32 s4, s8
  s_and_b32 s5, s9, 0xffff
  s_mov_b32 s6, 73728
  s_mov_b32 s7, 0x00020000
  s_mov_b32 s8, s84
  s_and_b32 s9, s85, 0xffff
  s_mov_b32 s10, 256
  s_mov_b32 s11, 0x00020000
  s_mov_b32 s20, s86
  s_and_b32 s21, s87, 0xffff
  s_mov_b32 s22, 73728
  s_mov_b32 s23, 0x00020000
  s_add_u32 m0, s55, 0
  s_add_u32 s50, s92, 0
  buffer_load_dwordx4 v96, s[88:91], s50 offen lds
  s_add_u32 m0, s55, 8192
  s_add_u32 s50, s92, 73728
  buffer_load_dwordx4 v96, s[88:91], s50 offen lds
  s_add_u32 m0, s55, 16384
  s_add_u32 s50, s92, 147456
  buffer_load_dwordx4 v96, s[88:91], s50 offen lds
  s_add_u32 m0, s55, 24576
  s_add_u32 s50, s92, 384
  buffer_load_dwordx4 v96, s[88:91], s50 offen lds
  s_add_u32 m0, s55, 32768
  s_add_u32 s50, s92, 74112
  buffer_load_dwordx4 v96, s[88:91], s50 offen lds
  s_add_u32 m0, s55, 40960
  s_add_u32 s50, s92, 147840
  buffer_load_dwordx4 v96, s[88:91], s50 offen lds
  s_cmp_eq_u32 s3, 0
  s_cbranch_scc1 MK_np1
  s_mul_hi_u32 s46, s2, 0x15555556
  s_mul_i32 s47, s46, 12
  s_sub_u32 s47, s2, s47
  s_and_b32 s48, s47, 1
  s_lshr_b32 s47, s47, 1
  s_lshl_b32 s46, s46, 6
  v_lshrrev_b32 v21, 2, v0
  v_mul_u32_u24 v21, 384, v21
  v_and_b32 v20, 3, v0
  v_lshl_add_u32 v21, v20, 4, v21
  s_mov_b32 m0, 147456
  s_add_u32 s50, s46, 0
  buffer_load_dwordx4 v21, s[4:7], s50 offen lds
  s_mov_b32 m0, 148480
  s_add_u32 s50, s46, 6144
  buffer_load_dwordx4 v21, s[4:7], s50 offen lds
  s_mov_b32 m0, 149504
  s_add_u32 s50, s46, 12288
  buffer_load_dwordx4 v21, s[4:7], s50 offen lds
  s_mov_b32 m0, 150528
  s_add_u32 s50, s46, 18432
  buffer_load_dwordx4 v21, s[4:7], s50 offen lds
  s_mov_b32 m0, 151552
  s_add_u32 s50, s46, 24576
  buffer_load_dwordx4 v21, s[4:7], s50 offen lds
  s_mov_b32 m0, 152576
  s_add_u32 s50, s46, 30720
  buffer_load_dwordx4 v21, s[4:7], s50 offen lds
  s_mov_b32 m0, 153600
  s_add_u32 s50, s46, 36864
  buffer_load_dwordx4 v21, s[4:7], s50 offen lds
  s_mov_b32 m0, 154624
  s_add_u32 s50, s46, 43008
  buffer_load_dwordx4 v21, s[4:7], s50 offen lds
  s_mov_b32 m0, 155648
  s_add_u32 s50, s46, 49152
  buffer_load_dwordx4 v21, s[4:7], s50 offen lds
  s_mov_b32 m0, 156672
  s_add_u32 s50, s46, 55296
  buffer_load_dwordx4 v21, s[4:7], s50 offen lds
  s_mov_b32 m0, 157696
  s_add_u32 s50, s46, 61440
  buffer_load_dwordx4 v21, s[4:7], s50 offen lds
  s_mov_b32 m0, 158720
  s_add_u32 s50, s46, 67584
  buffer_load_dwordx4 v21, s[4:7], s50 offen lds
  v_lshrrev_b32 v19, 2, v15
  v_lshl_add_u32 v128, v16, 3, v19
  v_lshlrev_b32 v128, 6, v128
  v_lshl_add_u32 v128, v20, 4, v128
  s_lshl_b32 s48, s48, 3
  s_add_u32 s48, s48, 147456
  v_add_u32 v128, s48, v128
  s_lshr_b32 s46, s47, 1
  s_lshl_b32 s46, s46, 3
  s_and_b32 s47, s47, 1
  s_lshl_b32 s47, s47, 1
  s_add_u32 s46, s46, s47
  s_lshl_b32 s46, s46, 3
  v_lshrrev_b32 v21, 1, v19
  v_lshlrev_b32 v21, 5, v21
  v_and_b32 v22, 1, v19
  v_lshl_add_u32 v21, v22, 2, v21
  v_add3_u32 v21, v21, v20, s46
  v_mul_u32_u24 v21, 1152, v21
  v_lshl_add_u32 v21, v16, 4, v21
  v_add_u32 v22, 9216, v21
  buffer_load_dwordx4 v[136:139], v21, s[88:91], 0 offen offset:768
  buffer_load_dwordx4 v[160:163], v22, s[88:91], 0 offen offset:768
  buffer_load_dwordx4 v[140:143], v21, s[88:91], 0 offen offset:832
  buffer_load_dwordx4 v[164:167], v22, s[88:91], 0 offen offset:832
  buffer_load_dwordx4 v[144:147], v21, s[88:91], 0 offen offset:896
  buffer_load_dwordx4 v[168:171], v22, s[88:91], 0 offen offset:896
  buffer_load_dwordx4 v[148:151], v21, s[88:91], 0 offen offset:960
  buffer_load_dwordx4 v[172:175], v22, s[88:91], 0 offen offset:960
  buffer_load_dwordx4 v[152:155], v21, s[88:91], 0 offen offset:1024
  buffer_load_dwordx4 v[176:179], v22, s[88:91], 0 offen offset:1024
  buffer_load_dwordx4 v[156:159], v21, s[88:91], 0 offen offset:1088
  buffer_load_dwordx4 v[180:183], v22, s[88:91], 0 offen offset:1088
MK_np1:
  s_bfe_u32 s27, s2, 0x10002
  s_bfe_u32 s28, s2, 0x10001
  s_and_b32 s29, s2, 1
  s_lshl_b32 s29, s29, 2
  s_lshr_b32 s46, s2, 6
  s_add_u32 s29, s29, s46
  s_bfe_u32 s30, s2, 0x30003
  s_mul_i32 s100, s29, 14
  s_add_i32 s100, s100, -6
  s_max_i32 s29, s100, -4
  s_mul_i32 s30, s30, 14
  s_add_i32 s30, s30, -6
  s_lshr_b32 s25, s24, 1
  s_add_u32 s25, s25, 2
  s_and_b32 s25, s25, 3
  s_and_b32 s41, s24, 3
  s_lshl_b32 s41, s41, 10
  v_lshrrev_b32 v17, 3, v15
  v_and_b32 v18, 7, v15
  s_sub_u32 s56, 0, s27
  s_mul_i32 s57, s27, 224
  s_sub_u32 s58, 0, s28
  s_mul_i32 s59, s28, 224
  s_mul_i32 s46, s26, 7
  s_add_i32 s46, s46, s30
  v_add_u32 v19, s46, v18
  v_max_i32 v20, 0, v19
  v_add3_u32 v19, v19, v20, 6
  v_xor_b32 v19, s58, v19
  v_add_u32 v19, s59, v19
  v_subrev_u32 v20, s30, v20
  v_mul_u32_u24 v19, 384, v19
  v_lshl_add_u32 v19, v16, 4, v19
  s_lshl_b32 s46, s25, 2
  s_add_i32 s46, s46, -2
  s_mov_b32 s47, 86016
  v_cmp_gt_u32 s[48:49], 7, v18
  v_add_u32 v23, s46, v17
  v_add_u32 v5, s100, v23
  v_max_i32 v21, 0, v5
  v_add3_u32 v5, v5, v21, 6
  v_xor_b32 v5, s56, v5
  v_add_u32 v5, s57, v5
  v_subrev_u32 v21, s29, v21
  v_cmp_gt_u32 vcc, 14, v23
  v_mad_u32_u24 v5, v5, s47, v19
  s_and_b64 vcc, vcc, s[48:49]
  v_mov_b32 v23, 0x80000000
  s_nop 0
  v_cndmask_b32 v5, v23, v5, vcc
  v_cndmask_b32 v21, v23, v21, vcc
  v_add_u32 v23, s46, v17
  v_add_u32 v23, 2, v23
  v_add_u32 v6, s100, v23
  v_max_i32 v22, 0, v6
  v_add3_u32 v6, v6, v22, 6
  v_xor_b32 v6, s56, v6
  v_add_u32 v6, s57, v6
  v_subrev_u32 v22, s29, v22
  v_cmp_gt_u32 vcc, 14, v23
  v_mad_u32_u24 v6, v6, s47, v19
  s_and_b64 vcc, vcc, s[48:49]
  v_mov_b32 v23, 0x80000000
  s_nop 0
  v_cndmask_b32 v6, v23, v6, vcc
  v_cndmask_b32 v22, v23, v22, vcc
  v_cmp_gt_i32 s[42:43], 0, v5
  v_cmp_gt_i32 s[44:45], 0, v6
  s_lshl_b32 s46, s29, 1
  s_sub_i32 s47, 221, s46
  s_cmp_eq_u32 s27, 0
  s_cselect_b32 s31, s46, s47
  s_cselect_b32 s32, 1, -1
  s_mul_i32 s32, s32, 344064
  s_mul_i32 s31, s31, 86016
  s_cmp_lt_i32 s29, 0
  s_cselect_b32 s33, 2, 0
  s_lshl_b32 s39, s41, 2
  s_add_u32 s40, s39, 3072
  s_min_u32 s40, s40, 14336
  s_mul_i32 s48, s27, 172032
  s_sub_u32 s49, 172032, s48
  s_lshr_b32 s46, s39, 4
  s_add_u32 s46, s46, 0
  v_add_u32 v23, s46, v0
  v_mul_u32_u24 v13, 2731, v23
  v_lshrrev_b32 v13, 16, v13
  v_mul_u32_u24 v19, 24, v13
  v_sub_u32 v23, v23, v19
  v_cmp_le_u32 vcc, 20, v13
  v_subrev_u32 v19, 20, v13
  v_mov_b32 v100, s48
  v_cndmask_b32 v13, v13, v19, vcc
  v_mov_b32 v101, s49
  v_cndmask_b32 v100, v100, v101, vcc
  v_bfe_u32 v19, v13, 1, 3
  v_xor_b32 v23, v23, v19
  v_lshl_add_u32 v23, v23, 4, v100
  v_add_u32 v13, s30, v13
  v_max_i32 v13, 0, v13
  v_lshlrev_b32 v13, 1, v13
  v_xor_b32 v13, s58, v13
  v_add_u32 v13, s59, v13
  v_mul_u32_u24 v13, 384, v13
  v_add_u32 v13, v13, v23
  s_lshr_b32 s46, s39, 4
  s_add_u32 s46, s46, 64
  v_add_u32 v23, s46, v0
  v_mul_u32_u24 v14, 2731, v23
  v_lshrrev_b32 v14, 16, v14
  v_mul_u32_u24 v19, 24, v14
  v_sub_u32 v23, v23, v19
  v_cmp_le_u32 vcc, 20, v14
  v_subrev_u32 v19, 20, v14
  v_mov_b32 v100, s48
  v_cndmask_b32 v14, v14, v19, vcc
  v_mov_b32 v101, s49
  v_cndmask_b32 v100, v100, v101, vcc
  v_bfe_u32 v19, v14, 1, 3
  v_xor_b32 v23, v23, v19
  v_lshl_add_u32 v23, v23, 4, v100
  v_add_u32 v14, s30, v14
  v_max_i32 v14, 0, v14
  v_lshlrev_b32 v14, 1, v14
  v_xor_b32 v14, s58, v14
  v_add_u32 v14, s59, v14
  v_mul_u32_u24 v14, 384, v14
  v_add_u32 v14, v14, v23
  s_lshr_b32 s46, s39, 4
  s_add_u32 s46, s46, 128
  v_add_u32 v23, s46, v0
  v_mul_u32_u24 v3, 2731, v23
  v_lshrrev_b32 v3, 16, v3
  v_mul_u32_u24 v19, 24, v3
  v_sub_u32 v23, v23, v19
  v_cmp_le_u32 vcc, 20, v3
  v_subrev_u32 v19, 20, v3
  v_mov_b32 v100, s48
  v_cndmask_b32 v3, v3, v19, vcc
  v_mov_b32 v101, s49
  v_cndmask_b32 v100, v100, v101, vcc
  v_bfe_u32 v19, v3, 1, 3
  v_xor_b32 v23, v23, v19
  v_lshl_add_u32 v23, v23, 4, v100
  v_add_u32 v3, s30, v3
  v_max_i32 v3, 0, v3
  v_lshlrev_b32 v3, 1, v3
  v_xor_b32 v3, s58, v3
  v_add_u32 v3, s59, v3
  v_mul_u32_u24 v3, 384, v3
  v_add_u32 v3, v3, v23
  s_lshr_b32 s46, s40, 4
  v_add_u32 v23, s46, v0
  v_mul_u32_u24 v4, 2731, v23
  v_lshrrev_b32 v4, 16, v4
  v_mul_u32_u24 v19, 24, v4
  v_sub_u32 v23, v23, v19
  v_cmp_le_u32 vcc, 20, v4
  v_subrev_u32 v19, 20, v4
  v_mov_b32 v100, s48
  v_cndmask_b32 v4, v4, v19, vcc
  v_mov_b32 v101, s49
  v_cndmask_b32 v100, v100, v101, vcc
  v_bfe_u32 v19, v4, 1, 3
  v_xor_b32 v23, v23, v19
  v_lshl_add_u32 v23, v23, 4, v100
  v_add_u32 v4, s30, v4
  v_max_i32 v4, 0, v4
  v_lshlrev_b32 v4, 1, v4
  v_xor_b32 v4, s58, v4
  v_add_u32 v4, s59, v4
  v_mul_u32_u24 v4, 384, v4
  v_add_u32 v4, v4, v23
  s_add_u32 s39, s39, 10240
  s_add_u32 s40, s40, 10240
  s_lshl_b32 s46, s25, 2
  s_add_i32 s46, s46, -2
  s_max_i32 s46, s46, 0
  s_add_i32 s46, s46, s100
  s_max_i32 s46, s46, 0
  s_sub_i32 s46, s46, s29
  s_lshl_b32 s34, s25, 2
  s_add_i32 s34, s34, 0
  s_max_i32 s34, s34, 0
  s_add_i32 s34, s34, s100
  s_max_i32 s34, s34, 0
  s_sub_i32 s34, s34, s29
  s_sub_u32 s46, s34, s46
  s_cmp_eq_u32 s46, 2
  s_cselect_b32 s37, -1, 7
  s_add_i32 s34, s34, -1
  s_add_i32 s35, s34, s37
  s_mul_i32 s37, s37, 7680
  s_lshl_b32 s47, s26, 2
  s_mul_i32 s46, s34, 7680
  s_add_i32 s46, s46, 10240
  v_add_u32 v19, s47, v15
  v_bfe_u32 v23, v19, 1, 3
  v_xor_b32 v23, v23, v16
  v_mul_u32_u24 v19, 384, v19
  v_lshl_add_u32 v19, v23, 4, v19
  v_add_u32 v7, s46, v19
  v_xor_b32 v8, 64, v7
  v_lshrrev_b32 v19, 2, v15
  v_lshl_add_u32 v19, v16, 2, v19
  v_add_u32 v19, s47, v19
  v_bfe_u32 v23, v19, 1, 3
  v_and_b32 v10, 2, v15
  v_lshlrev_b32 v10, 1, v10
  v_xor_b32 v23, v23, v10
  v_mul_u32_u24 v19, 384, v19
  v_lshl_add_u32 v19, v23, 4, v19
  v_and_b32 v23, 1, v15
  v_lshl_add_u32 v19, v23, 3, v19
  v_add_u32 v9, s46, v19
  v_xor_b32 v10, 16, v9
  v_xor_b32 v11, 32, v9
  v_xor_b32 v12, 48, v9
  v_lshl_add_u32 v19, v16, 2, s47
  v_sub_u32 v19, v19, v20
  v_bfe_u32 v23, v15, 1, 3
  v_xor_b32 v23, v23, v16
  v_lshlrev_b32 v20, 7, v15
  v_lshl_add_u32 v20, v23, 4, v20
  s_lshr_b32 s46, s24, 2
  s_mul_i32 s47, s46, 12288
  v_add_u32 v97, s47, v20
  v_xor_b32 v98, 64, v97
  s_mul_i32 s47, s41, 6
  s_add_u32 s47, s47, 24576
  v_add_u32 v99, s47, v20
  v_xor_b32 v100, 64, v99
  s_mul_i32 s46, s46, 6
  s_sub_u32 s46, 67, s46
  s_and_b32 s47, s24, 3
  s_mul_i32 s47, s47, 3
  s_add_u32 s48, s47, 0
  s_lshr_b32 s49, s48, 1
  s_mul_i32 s49, s49, 12
  s_and_b32 s48, s48, 1
  s_add_u32 s48, s48, s49
  s_sub_u32 s48, s46, s48
  s_lshl_b32 s48, s48, 10
  v_add_u32 v101, s48, v1
  s_add_u32 s48, s47, 1
  s_lshr_b32 s49, s48, 1
  s_mul_i32 s49, s49, 12
  s_and_b32 s48, s48, 1
  s_add_u32 s48, s48, s49
  s_sub_u32 s48, s46, s48
  s_lshl_b32 s48, s48, 10
  v_add_u32 v102, s48, v1
  s_add_u32 s48, s47, 2
  s_lshr_b32 s49, s48, 1
  s_mul_i32 s49, s49, 12
  s_and_b32 s48, s48, 1
  s_add_u32 s48, s48, s49
  s_sub_u32 s48, s46, s48
  s_lshl_b32 s48, s48, 10
  v_add_u32 v103, s48, v1
  v_add_u32 v20, s37, v7
  v_add_u32 v0, s37, v8
  v_add_u32 v15, s37, v9
  v_add_u32 v16, s37, v10
  v_add_u32 v17, s37, v11
  v_add_u32 v18, s37, v12
  s_mov_b32 s93, 1037384597
  s_cmp_lt_u32 s24, 4
  s_cselect_b64 vcc, -1, 0
  s_add_u32 m0, s55, 49152
  s_add_u32 s50, s92, 128
  buffer_load_dwordx4 v96, s[88:91], s50 offen lds
  s_add_u32 m0, s55, 57344
  s_add_u32 s50, s92, 73856
  buffer_load_dwordx4 v96, s[88:91], s50 offen lds
  s_add_u32 m0, s55, 65536
  s_add_u32 s50, s92, 147584
  buffer_load_dwordx4 v96, s[88:91], s50 offen lds
  s_add_u32 m0, s55, 73728
  s_add_u32 s50, s92, 512
  buffer_load_dwordx4 v96, s[88:91], s50 offen lds
  s_add_u32 m0, s55, 81920
  s_add_u32 s50, s92, 74240
  buffer_load_dwordx4 v96, s[88:91], s50 offen lds
  s_add_u32 m0, s55, 90112
  s_add_u32 s50, s92, 147968
  buffer_load_dwordx4 v96, s[88:91], s50 offen lds
  s_waitcnt vmcnt(6)
  s_barrier
  ds_read_b128 v[208:211], v99 offset:0
  ds_read_b128 v[212:215], v99 offset:2048
  ds_read_b128 v[216:219], v99 offset:4096
  ds_read_b128 v[184:187], v97 offset:0
  ds_read_b128 v[188:191], v97 offset:2048
  ds_read_b128 v[192:195], v97 offset:4096
  ds_read_b128 v[196:199], v97 offset:6144
  ds_read_b128 v[200:203], v97 offset:8192
  ds_read_b128 v[204:207], v97 offset:10240
  s_waitcnt lgkmcnt(5)
  v_mfma_f32_16x16x32_bf16 v[24:27], v[184:187], v[208:211], 0
  v_mfma_f32_16x16x32_bf16 v[28:31], v[184:187], v[212:215], 0
  v_mfma_f32_16x16x32_bf16 v[32:35], v[184:187], v[216:219], 0
  s_add_u32 m0, s55, 98304
  s_add_u32 s50, s92, 256
  buffer_load_dwordx4 v96, s[88:91], s50 offen lds
  s_waitcnt lgkmcnt(4)
  v_mfma_f32_16x16x32_bf16 v[36:39], v[188:191], v[208:211], 0
  ds_read_b128 v[244:247], v100 offset:0
  v_mfma_f32_16x16x32_bf16 v[40:43], v[188:191], v[212:215], 0
  ds_read_b128 v[248:251], v100 offset:2048
  v_mfma_f32_16x16x32_bf16 v[44:47], v[188:191], v[216:219], 0
  s_add_u32 m0, s55, 106496
  s_add_u32 s50, s92, 73984
  buffer_load_dwordx4 v96, s[88:91], s50 offen lds
  s_waitcnt lgkmcnt(5)
  v_mfma_f32_16x16x32_bf16 v[48:51], v[192:195], v[208:211], 0
  ds_read_b128 v[252:255], v100 offset:4096
  v_mfma_f32_16x16x32_bf16 v[52:55], v[192:195], v[212:215], 0
  ds_read_b128 v[220:223], v98 offset:0
  v_mfma_f32_16x16x32_bf16 v[56:59], v[192:195], v[216:219], 0
  s_add_u32 m0, s55, 114688
  s_add_u32 s50, s92, 147712
  buffer_load_dwordx4 v96, s[88:91], s50 offen lds
  s_waitcnt lgkmcnt(6)
  v_mfma_f32_16x16x32_bf16 v[60:63], v[196:199], v[208:211], 0
  ds_read_b128 v[224:227], v98 offset:2048
  v_mfma_f32_16x16x32_bf16 v[64:67], v[196:199], v[212:215], 0
  ds_read_b128 v[228:231], v98 offset:4096
  v_mfma_f32_16x16x32_bf16 v[68:71], v[196:199], v[216:219], 0
  s_add_u32 m0, s55, 122880
  s_add_u32 s50, s92, 640
  buffer_load_dwordx4 v96, s[88:91], s50 offen lds
  s_waitcnt lgkmcnt(7)
  v_mfma_f32_16x16x32_bf16 v[72:75], v[200:203], v[208:211], 0
  ds_read_b128 v[232:235], v98 offset:6144
  v_mfma_f32_16x16x32_bf16 v[76:79], v[200:203], v[212:215], 0
  ds_read_b128 v[236:239], v98 offset:8192
  v_mfma_f32_16x16x32_bf16 v[80:83], v[200:203], v[216:219], 0
  s_add_u32 m0, s55, 131072
  s_add_u32 s50, s92, 74368
  buffer_load_dwordx4 v96, s[88:91], s50 offen lds
  s_waitcnt lgkmcnt(8)
  v_mfma_f32_16x16x32_bf16 v[84:87], v[204:207], v[208:211], 0
  ds_read_b128 v[240:243], v98 offset:10240
  v_mfma_f32_16x16x32_bf16 v[88:91], v[204:207], v[212:215], 0
  v_mfma_f32_16x16x32_bf16 v[92:95], v[204:207], v[216:219], 0
  s_add_u32 m0, s55, 139264
  s_add_u32 s50, s92, 148096
  buffer_load_dwordx4 v96, s[88:91], s50 offen lds
  s_waitcnt lgkmcnt(5)
  v_mfma_f32_16x16x32_bf16 v[24:27], v[220:223], v[244:247], v[24:27]
  v_mfma_f32_16x16x32_bf16 v[28:31], v[220:223], v[248:251], v[28:31]
  v_mfma_f32_16x16x32_bf16 v[32:35], v[220:223], v[252:255], v[32:35]
  s_waitcnt lgkmcnt(4)
  v_mfma_f32_16x16x32_bf16 v[36:39], v[224:227], v[244:247], v[36:39]
  v_mfma_f32_16x16x32_bf16 v[40:43], v[224:227], v[248:251], v[40:43]
  v_mfma_f32_16x16x32_bf16 v[44:47], v[224:227], v[252:255], v[44:47]
  s_waitcnt lgkmcnt(3)
  v_mfma_f32_16x16x32_bf16 v[48:51], v[228:231], v[244:247], v[48:51]
  v_mfma_f32_16x16x32_bf16 v[52:55], v[228:231], v[248:251], v[52:55]
  v_mfma_f32_16x16x32_bf16 v[56:59], v[228:231], v[252:255], v[56:59]
  s_waitcnt lgkmcnt(2)
  v_mfma_f32_16x16x32_bf16 v[60:63], v[232:235], v[244:247], v[60:63]
  v_mfma_f32_16x16x32_bf16 v[64:67], v[232:235], v[248:251], v[64:67]
  v_mfma_f32_16x16x32_bf16 v[68:71], v[232:235], v[252:255], v[68:71]
  s_waitcnt lgkmcnt(1)
  v_mfma_f32_16x16x32_bf16 v[72:75], v[236:239], v[244:247], v[72:75]
  v_mfma_f32_16x16x32_bf16 v[76:79], v[236:239], v[248:251], v[76:79]
  v_mfma_f32_16x16x32_bf16 v[80:83], v[236:239], v[252:255], v[80:83]
  s_waitcnt lgkmcnt(0)
  v_mfma_f32_16x16x32_bf16 v[84:87], v[240:243], v[244:247], v[84:87]
  v_mfma_f32_16x16x32_bf16 v[88:91], v[240:243], v[248:251], v[88:91]
  v_mfma_f32_16x16x32_bf16 v[92:95], v[240:243], v[252:255], v[92:95]
  s_waitcnt vmcnt(6)
  s_barrier
  v_add_u32 v97, 49152, v97
  v_add_u32 v98, 49152, v98
  v_add_u32 v99, 49152, v99
  v_add_u32 v100, 49152, v100
  ds_read_b128 v[208:211], v99 offset:0
  ds_read_b128 v[212:215], v99 offset:2048
  ds_read_b128 v[216:219], v99 offset:4096
  ds_read_b128 v[184:187], v97 offset:0
  ds_read_b128 v[188:191], v97 offset:2048
  ds_read_b128 v[192:195], v97 offset:4096
  ds_read_b128 v[196:199], v97 offset:6144
  ds_read_b128 v[200:203], v97 offset:8192
  ds_read_b128 v[204:207], v97 offset:10240
  s_waitcnt lgkmcnt(5)
  v_mfma_f32_16x16x32_bf16 v[24:27], v[184:187], v[208:211], v[24:27]
  v_mfma_f32_16x16x32_bf16 v[28:31], v[184:187], v[212:215], v[28:31]
  v_mfma_f32_16x16x32_bf16 v[32:35], v[184:187], v[216:219], v[32:35]
  s_cbranch_vccz MQ20
  buffer_load_dwordx4 v[136:139], v5, s[12:15], 0 offen offset:0
MQ20:
  s_waitcnt lgkmcnt(4)
  v_mfma_f32_16x16x32_bf16 v[36:39], v[188:191], v[208:211], v[36:39]
  ds_read_b128 v[244:247], v100 offset:0
  v_mfma_f32_16x16x32_bf16 v[40:43], v[188:191], v[212:215], v[40:43]
  ds_read_b128 v[248:251], v100 offset:2048
  v_mfma_f32_16x16x32_bf16 v[44:47], v[188:191], v[216:219], v[44:47]
  s_cbranch_vccz MQ21
  buffer_load_dwordx4 v[160:163], v6, s[12:15], 0 offen offset:0
MQ21:
  s_waitcnt lgkmcnt(5)
  v_mfma_f32_16x16x32_bf16 v[48:51], v[192:195], v[208:211], v[48:51]
  ds_read_b128 v[252:255], v100 offset:4096
  v_mfma_f32_16x16x32_bf16 v[52:55], v[192:195], v[212:215], v[52:55]
  ds_read_b128 v[220:223], v98 offset:0
  v_mfma_f32_16x16x32_bf16 v[56:59], v[192:195], v[216:219], v[56:59]
  s_cbranch_vccz MQ22
  buffer_load_dwordx4 v[140:143], v5, s[12:15], 0 offen offset:64
MQ22:
  s_waitcnt lgkmcnt(6)
  v_mfma_f32_16x16x32_bf16 v[60:63], v[196:199], v[208:211], v[60:63]
  ds_read_b128 v[224:227], v98 offset:2048
  v_mfma_f32_16x16x32_bf16 v[64:67], v[196:199], v[212:215], v[64:67]
  ds_read_b128 v[228:231], v98 offset:4096
  v_mfma_f32_16x16x32_bf16 v[68:71], v[196:199], v[216:219], v[68:71]
  s_cbranch_vccz MQ23
  buffer_load_dwordx4 v[164:167], v6, s[12:15], 0 offen offset:64
MQ23:
  s_waitcnt lgkmcnt(7)
  v_mfma_f32_16x16x32_bf16 v[72:75], v[200:203], v[208:211], v[72:75]
  ds_read_b128 v[232:235], v98 offset:6144
  v_mfma_f32_16x16x32_bf16 v[76:79], v[200:203], v[212:215], v[76:79]
  ds_read_b128 v[236:239], v98 offset:8192
  v_mfma_f32_16x16x32_bf16 v[80:83], v[200:203], v[216:219], v[80:83]
  s_cbranch_vccz MQ24
  buffer_load_dwordx4 v[144:147], v5, s[12:15], 0 offen offset:128
MQ24:
  s_waitcnt lgkmcnt(8)
  v_mfma_f32_16x16x32_bf16 v[84:87], v[204:207], v[208:211], v[84:87]
  ds_read_b128 v[240:243], v98 offset:10240
  v_mfma_f32_16x16x32_bf16 v[88:91], v[204:207], v[212:215], v[88:91]
  v_mfma_f32_16x16x32_bf16 v[92:95], v[204:207], v[216:219], v[92:95]
  s_cbranch_vccz MQ25
  buffer_load_dwordx4 v[168:171], v6, s[12:15], 0 offen offset:128
MQ25:
  s_waitcnt lgkmcnt(5)
  v_mfma_f32_16x16x32_bf16 v[24:27], v[220:223], v[244:247], v[24:27]
  v_mfma_f32_16x16x32_bf16 v[28:31], v[220:223], v[248:251], v[28:31]
  v_mfma_f32_16x16x32_bf16 v[32:35], v[220:223], v[252:255], v[32:35]
  s_cbranch_vccz MQ30
  buffer_load_dwordx4 v[148:151], v5, s[12:15], 0 offen offset:192
MQ30:
  s_waitcnt lgkmcnt(4)
  v_mfma_f32_16x16x32_bf16 v[36:39], v[224:227], v[244:247], v[36:39]
  v_mfma_f32_16x16x32_bf16 v[40:43], v[224:227], v[248:251], v[40:43]
  v_mfma_f32_16x16x32_bf16 v[44:47], v[224:227], v[252:255], v[44:47]
  s_cbranch_vccz MQ31
  buffer_load_dwordx4 v[172:175], v6, s[12:15], 0 offen offset:192
MQ31:
  s_waitcnt lgkmcnt(3)
  v_mfma_f32_16x16x32_bf16 v[48:51], v[228:231], v[244:247], v[48:51]
  v_mfma_f32_16x16x32_bf16 v[52:55], v[228:231], v[248:251], v[52:55]
  v_mfma_f32_16x16x32_bf16 v[56:59], v[228:231], v[252:255], v[56:59]
  s_cbranch_vccz MQ32
  buffer_load_dwordx4 v[152:155], v5, s[12:15], 0 offen offset:256
MQ32:
  s_waitcnt lgkmcnt(2)
  v_mfma_f32_16x16x32_bf16 v[60:63], v[232:235], v[244:247], v[60:63]
  v_mfma_f32_16x16x32_bf16 v[64:67], v[232:235], v[248:251], v[64:67]
  v_mfma_f32_16x16x32_bf16 v[68:71], v[232:235], v[252:255], v[68:71]
  s_cbranch_vccz MQ33
  buffer_load_dwordx4 v[176:179], v6, s[12:15], 0 offen offset:256
MQ33:
  s_waitcnt lgkmcnt(1)
  v_mfma_f32_16x16x32_bf16 v[72:75], v[236:239], v[244:247], v[72:75]
  v_mfma_f32_16x16x32_bf16 v[76:79], v[236:239], v[248:251], v[76:79]
  v_mfma_f32_16x16x32_bf16 v[80:83], v[236:239], v[252:255], v[80:83]
  s_cbranch_vccz MQ34
  buffer_load_dwordx4 v[156:159], v5, s[12:15], 0 offen offset:320
MQ34:
  s_waitcnt lgkmcnt(0)
  v_mfma_f32_16x16x32_bf16 v[84:87], v[240:243], v[244:247], v[84:87]
  v_mfma_f32_16x16x32_bf16 v[88:91], v[240:243], v[248:251], v[88:91]
  v_mfma_f32_16x16x32_bf16 v[92:95], v[240:243], v[252:255], v[92:95]
  s_cbranch_vccz MQ35
  buffer_load_dwordx4 v[180:183], v6, s[12:15], 0 offen offset:320
MQ35:
  s_cbranch_vccz MW2
  s_waitcnt vmcnt(12)
  s_branch MX2
MW2:
  s_waitcnt vmcnt(0)
MX2:
  s_barrier
  v_add_u32 v97, 49152, v97
  v_add_u32 v98, 49152, v98
  v_add_u32 v99, 49152, v99
  v_add_u32 v100, 49152, v100
  ds_read_b128 v[208:211], v99 offset:0
  ds_read_b128 v[212:215], v99 offset:2048
  ds_read_b128 v[216:219], v99 offset:4096
  ds_read_b128 v[184:187], v97 offset:0
  ds_read_b128 v[188:191], v97 offset:2048
  ds_read_b128 v[192:195], v97 offset:4096
  ds_read_b128 v[196:199], v97 offset:6144
  ds_read_b128 v[200:203], v97 offset:8192
  ds_read_b128 v[204:207], v97 offset:10240
  s_waitcnt lgkmcnt(5)
  v_mfma_f32_16x16x32_bf16 v[24:27], v[184:187], v[208:211], v[24:27]
  v_mfma_f32_16x16x32_bf16 v[28:31], v[184:187], v[212:215], v[28:31]
  v_mfma_f32_16x16x32_bf16 v[32:35], v[184:187], v[216:219], v[32:35]
  s_waitcnt lgkmcnt(4)
  v_mfma_f32_16x16x32_bf16 v[36:39], v[188:191], v[208:211], v[36:39]
  ds_read_b128 v[244:247], v100 offset:0
  v_mfma_f32_16x16x32_bf16 v[40:43], v[188:191], v[212:215], v[40:43]
  ds_read_b128 v[248:251], v100 offset:2048
  v_mfma_f32_16x16x32_bf16 v[44:47], v[188:191], v[216:219], v[44:47]
  s_waitcnt lgkmcnt(5)
  v_mfma_f32_16x16x32_bf16 v[48:51], v[192:195], v[208:211], v[48:51]
  ds_read_b128 v[252:255], v100 offset:4096
  v_mfma_f32_16x16x32_bf16 v[52:55], v[192:195], v[212:215], v[52:55]
  ds_read_b128 v[220:223], v98 offset:0
  v_mfma_f32_16x16x32_bf16 v[56:59], v[192:195], v[216:219], v[56:59]
  s_waitcnt lgkmcnt(6)
  v_mfma_f32_16x16x32_bf16 v[60:63], v[196:199], v[208:211], v[60:63]
  ds_read_b128 v[224:227], v98 offset:2048
  v_mfma_f32_16x16x32_bf16 v[64:67], v[196:199], v[212:215], v[64:67]
  ds_read_b128 v[228:231], v98 offset:4096
  v_mfma_f32_16x16x32_bf16 v[68:71], v[196:199], v[216:219], v[68:71]
  s_waitcnt lgkmcnt(7)
  v_mfma_f32_16x16x32_bf16 v[72:75], v[200:203], v[208:211], v[72:75]
  ds_read_b128 v[232:235], v98 offset:6144
  v_mfma_f32_16x16x32_bf16 v[76:79], v[200:203], v[212:215], v[76:79]
  ds_read_b128 v[236:239], v98 offset:8192
  v_mfma_f32_16x16x32_bf16 v[80:83], v[200:203], v[216:219], v[80:83]
  s_waitcnt lgkmcnt(8)
  v_mfma_f32_16x16x32_bf16 v[84:87], v[204:207], v[208:211], v[84:87]
  ds_read_b128 v[240:243], v98 offset:10240
  v_mfma_f32_16x16x32_bf16 v[88:91], v[204:207], v[212:215], v[88:91]
  v_mfma_f32_16x16x32_bf16 v[92:95], v[204:207], v[216:219], v[92:95]
  s_waitcnt lgkmcnt(5)
  v_mfma_f32_16x16x32_bf16 v[24:27], v[220:223], v[244:247], v[24:27]
  v_mfma_f32_16x16x32_bf16 v[28:31], v[220:223], v[248:251], v[28:31]
  v_mfma_f32_16x16x32_bf16 v[32:35], v[220:223], v[252:255], v[32:35]
  s_waitcnt lgkmcnt(4)
  v_mfma_f32_16x16x32_bf16 v[36:39], v[224:227], v[244:247], v[36:39]
  v_mfma_f32_16x16x32_bf16 v[40:43], v[224:227], v[248:251], v[40:43]
  v_mfma_f32_16x16x32_bf16 v[44:47], v[224:227], v[252:255], v[44:47]
  s_waitcnt lgkmcnt(3)
  v_mfma_f32_16x16x32_bf16 v[48:51], v[228:231], v[244:247], v[48:51]
  v_mfma_f32_16x16x32_bf16 v[52:55], v[228:231], v[248:251], v[52:55]
  v_mfma_f32_16x16x32_bf16 v[56:59], v[228:231], v[252:255], v[56:59]
  s_waitcnt lgkmcnt(2)
  v_mfma_f32_16x16x32_bf16 v[60:63], v[232:235], v[244:247], v[60:63]
  v_mfma_f32_16x16x32_bf16 v[64:67], v[232:235], v[248:251], v[64:67]
  v_mfma_f32_16x16x32_bf16 v[68:71], v[232:235], v[252:255], v[68:71]
  s_waitcnt lgkmcnt(1)
  v_mfma_f32_16x16x32_bf16 v[72:75], v[236:239], v[244:247], v[72:75]
  v_mfma_f32_16x16x32_bf16 v[76:79], v[236:239], v[248:251], v[76:79]
  v_mfma_f32_16x16x32_bf16 v[80:83], v[236:239], v[252:255], v[80:83]
  s_waitcnt lgkmcnt(0)
  s_cmp_eq_u32 s3, 0
  s_cbranch_scc1 MK_np2
  ds_read_b64_tr_b16 v[104:105], v128 offset:0
  ds_read_b64_tr_b16 v[106:107], v128 offset:256
  ds_read_b64_tr_b16 v[108:109], v128 offset:2048
  ds_read_b64_tr_b16 v[110:111], v128 offset:2304
  ds_read_b64_tr_b16 v[112:113], v128 offset:4096
  ds_read_b64_tr_b16 v[114:115], v128 offset:4352
  ds_read_b64_tr_b16 v[116:117], v128 offset:6144
  ds_read_b64_tr_b16 v[118:119], v128 offset:6400
  ds_read_b64_tr_b16 v[120:121], v128 offset:8192
  ds_read_b64_tr_b16 v[122:123], v128 offset:8448
  ds_read_b64_tr_b16 v[124:125], v128 offset:10240
  ds_read_b64_tr_b16 v[126:127], v128 offset:10496
  s_waitcnt lgkmcnt(0)
MK_np2:
  s_barrier
  v_mfma_f32_16x16x32_bf16 v[84:87], v[240:243], v[244:247], v[84:87]
  v_mfma_f32_16x16x32_bf16 v[88:91], v[240:243], v[248:251], v[88:91]
  v_mfma_f32_16x16x32_bf16 v[92:95], v[240:243], v[252:255], v[92:95]
  s_nop 4
  v_cvt_pk_bf16_f32 v184, v24, v25
  v_cvt_pk_bf16_f32 v185, v26, v27
  v_cvt_pk_bf16_f32 v186, v36, v37
  v_cvt_pk_bf16_f32 v187, v38, v39
  ds_write_b128 v101, v[184:187] offset:4096
  v_cvt_pk_bf16_f32 v188, v28, v29
  v_cvt_pk_bf16_f32 v189, v30, v31
  v_cvt_pk_bf16_f32 v190, v40, v41
  v_cvt_pk_bf16_f32 v191, v42, v43
  ds_write_b128 v102, v[188:191] offset:4096
  v_cvt_pk_bf16_f32 v192, v32, v33
  v_cvt_pk_bf16_f32 v193, v34, v35
  v_cvt_pk_bf16_f32 v194, v44, v45
  v_cvt_pk_bf16_f32 v195, v46, v47
  ds_write_b128 v103, v[192:195] offset:4096
  v_cvt_pk_bf16_f32 v196, v48, v49
  v_cvt_pk_bf16_f32 v197, v50, v51
  v_cvt_pk_bf16_f32 v198, v60, v61
  v_cvt_pk_bf16_f32 v199, v62, v63
  ds_write_b128 v101, v[196:199] offset:2048
  v_cvt_pk_bf16_f32 v200, v52, v53
  v_cvt_pk_bf16_f32 v201, v54, v55
  v_cvt_pk_bf16_f32 v202, v64, v65
  v_cvt_pk_bf16_f32 v203, v66, v67
  ds_write_b128 v102, v[200:203] offset:2048
  v_cvt_pk_bf16_f32 v204, v56, v57
  v_cvt_pk_bf16_f32 v205, v58, v59
  v_cvt_pk_bf16_f32 v206, v68, v69
  v_cvt_pk_bf16_f32 v207, v70, v71
  ds_write_b128 v103, v[204:207] offset:2048
  v_cvt_pk_bf16_f32 v208, v72, v73
  v_cvt_pk_bf16_f32 v209, v74, v75
  v_cvt_pk_bf16_f32 v210, v84, v85
  v_cvt_pk_bf16_f32 v211, v86, v87
  ds_write_b128 v101, v[208:211] offset:0
  v_cvt_pk_bf16_f32 v212, v76, v77
  v_cvt_pk_bf16_f32 v213, v78, v79
  v_cvt_pk_bf16_f32 v214, v88, v89
  v_cvt_pk_bf16_f32 v215, v90, v91
  ds_write_b128 v102, v[212:215] offset:0
  v_cvt_pk_bf16_f32 v216, v80, v81
  v_cvt_pk_bf16_f32 v217, v82, v83
  v_cvt_pk_bf16_f32 v218, v92, v93
  v_cvt_pk_bf16_f32 v219, v94, v95
  ds_write_b128 v103, v[216:219] offset:0
  s_waitcnt lgkmcnt(0)
  s_barrier
  s_cbranch_vccnz MK_nobi
  s_cmp_eq_u32 s3, 0
  s_cbranch_scc1 MK_np3
  v_mfma_f32_16x16x32_bf16 v[184:187], v[136:139], v[104:107], 0
  v_mfma_f32_16x16x32_bf16 v[188:191], v[160:163], v[104:107], 0
  v_mfma_f32_16x16x32_bf16 v[184:187], v[140:143], v[108:111], v[184:187]
  v_mfma_f32_16x16x32_bf16 v[188:191], v[164:167], v[108:111], v[188:191]
  v_mfma_f32_16x16x32_bf16 v[184:187], v[144:147], v[112:115], v[184:187]
  v_mfma_f32_16x16x32_bf16 v[188:191], v[168:171], v[112:115], v[188:191]
  v_mfma_f32_16x16x32_bf16 v[184:187], v[148:151], v[116:119], v[184:187]
  v_mfma_f32_16x16x32_bf16 v[188:191], v[172:175], v[116:119], v[188:191]
  v_mfma_f32_16x16x32_bf16 v[184:187], v[152:155], v[120:123], v[184:187]
  v_mfma_f32_16x16x32_bf16 v[188:191], v[176:179], v[120:123], v[188:191]
  v_mfma_f32_16x16x32_bf16 v[184:187], v[156:159], v[124:127], v[184:187]
  v_mfma_f32_16x16x32_bf16 v[188:191], v[180:183], v[124:127], v[188:191]
  s_nop 7
  v_cvt_pk_bf16_f32 v132, v184, v185
  v_cvt_pk_bf16_f32 v133, v186, v187
  v_cvt_pk_bf16_f32 v134, v188, v189
  v_cvt_pk_bf16_f32 v135, v190, v191
  s_lshl_b32 s50, s2, 10
  buffer_store_dwordx4 v[132:135], v1, s[20:23], s50 offen sc1
MK_np3:
  buffer_load_dwordx4 v[136:139], v5, s[12:15], 0 offen offset:0
  buffer_load_dwordx4 v[160:163], v6, s[12:15], 0 offen offset:0
  buffer_load_dwordx4 v[140:143], v5, s[12:15], 0 offen offset:64
  buffer_load_dwordx4 v[164:167], v6, s[12:15], 0 offen offset:64
  buffer_load_dwordx4 v[144:147], v5, s[12:15], 0 offen offset:128
  buffer_load_dwordx4 v[168:171], v6, s[12:15], 0 offen offset:128
  buffer_load_dwordx4 v[148:151], v5, s[12:15], 0 offen offset:192
  buffer_load_dwordx4 v[172:175], v6, s[12:15], 0 offen offset:192
  buffer_load_dwordx4 v[152:155], v5, s[12:15], 0 offen offset:256
  buffer_load_dwordx4 v[176:179], v6, s[12:15], 0 offen offset:256
  buffer_load_dwordx4 v[156:159], v5, s[12:15], 0 offen offset:320
  buffer_load_dwordx4 v[180:183], v6, s[12:15], 0 offen offset:320
  v_mov_b32 v92, 0xff800000
  v_add_u32 v93, 0, v19
  v_add_u32 v94, 1, v19
  v_add_u32 v95, 2, v19
  v_add_u32 v96, 3, v19
  v_cmp_gt_u32 s[48:49], 7, v93
  v_cmp_gt_u32 s[50:51], 7, v94
  v_cmp_gt_u32 s[52:53], 7, v95
  v_cmp_gt_u32 s[54:55], 7, v96
  v_cndmask_b32 v88, v92, 0, s[48:49]
  v_cndmask_b32 v89, v92, 0, s[50:51]
  v_cndmask_b32 v90, v92, 0, s[52:53]
  v_cndmask_b32 v91, v92, 0, s[54:55]
  v_sub_u32 v93, s35, v21
  s_add_i32 s46, s34, 0
  v_sub_u32 v94, s46, v21
  s_add_i32 s46, s34, 1
  v_sub_u32 v95, s46, v21
  s_add_i32 s46, s34, 2
  v_sub_u32 v96, s46, v21
  v_cmp_gt_u32 s[48:49], 7, v93
  v_cmp_gt_u32 s[50:51], 7, v94
  v_cmp_gt_u32 s[52:53], 7, v95
  v_cmp_gt_u32 s[54:55], 7, v96
  v_cndmask_b32 v24, v92, v88, s[48:49]
  v_cndmask_b32 v25, v92, v89, s[48:49]
  v_cndmask_b32 v26, v92, v90, s[48:49]
  v_cndmask_b32 v27, v92, v91, s[48:49]
  v_cndmask_b32 v28, v92, v88, s[50:51]
  v_cndmask_b32 v29, v92, v89, s[50:51]
  v_cndmask_b32 v30, v92, v90, s[50:51]
  v_cndmask_b32 v31, v92, v91, s[50:51]
  v_cndmask_b32 v32, v92, v88, s[52:53]
  v_cndmask_b32 v33, v92, v89, s[52:53]
  v_cndmask_b32 v34, v92, v90, s[52:53]
  v_cndmask_b32 v35, v92, v91, s[52:53]
  v_cndmask_b32 v36, v92, v88, s[54:55]
  v_cndmask_b32 v37, v92, v89, s[54:55]
  v_cndmask_b32 v38, v92, v90, s[54:55]
  v_cndmask_b32 v39, v92, v91, s[54:55]
  s_add_i32 s46, s34, 3
  v_sub_u32 v93, s46, v21
  s_add_i32 s46, s34, 4
  v_sub_u32 v94, s46, v21
  s_add_i32 s46, s34, 5
  v_sub_u32 v95, s46, v21
  s_add_i32 s46, s34, 6
  v_sub_u32 v96, s46, v21
  v_cmp_gt_u32 s[48:49], 7, v93
  v_cmp_gt_u32 s[50:51], 7, v94
  v_cmp_gt_u32 s[52:53], 7, v95
  v_cmp_gt_u32 s[54:55], 7, v96
  v_cndmask_b32 v40, v92, v88, s[48:49]
  v_cndmask_b32 v41, v92, v89, s[48:49]
  v_cndmask_b32 v42, v92, v90, s[48:49]
  v_cndmask_b32 v43, v92, v91, s[48:49]
  v_cndmask_b32 v44, v92, v88, s[50:51]
  v_cndmask_b32 v45, v92, v89, s[50:51]
  v_cndmask_b32 v46, v92, v90, s[50:51]
  v_cndmask_b32 v47, v92, v91, s[50:51]
  v_cndmask_b32 v48, v92, v88, s[52:53]
  v_cndmask_b32 v49, v92, v89, s[52:53]
  v_cndmask_b32 v50, v92, v90, s[52:53]
  v_cndmask_b32 v51, v92, v91, s[52:53]
  v_cndmask_b32 v52, v92, v88, s[54:55]
  v_cndmask_b32 v53, v92, v89, s[54:55]
  v_cndmask_b32 v54, v92, v90, s[54:55]
  v_cndmask_b32 v55, v92, v91, s[54:55]
  s_add_i32 s46, s34, 1
  v_sub_u32 v93, s46, v22
  s_add_i32 s46, s34, 2
  v_sub_u32 v94, s46, v22
  s_add_i32 s46, s34, 3
  v_sub_u32 v95, s46, v22
  s_add_i32 s46, s34, 4
  v_sub_u32 v96, s46, v22
  v_cmp_gt_u32 s[48:49], 7, v93
  v_cmp_gt_u32 s[50:51], 7, v94
  v_cmp_gt_u32 s[52:53], 7, v95
  v_cmp_gt_u32 s[54:55], 7, v96
  v_cndmask_b32 v56, v92, v88, s[48:49]
  v_cndmask_b32 v57, v92, v89, s[48:49]
  v_cndmask_b32 v58, v92, v90, s[48:49]
  v_cndmask_b32 v59, v92, v91, s[48:49]
  v_cndmask_b32 v60, v92, v88, s[50:51]
  v_cndmask_b32 v61, v92, v89, s[50:51]
  v_cndmask_b32 v62, v92, v90, s[50:51]
  v_cndmask_b32 v63, v92, v91, s[50:51]
  v_cndmask_b32 v64, v92, v88, s[52:53]
  v_cndmask_b32 v65, v92, v89, s[52:53]
  v_cndmask_b32 v66, v92, v90, s[52:53]
  v_cndmask_b32 v67, v92, v91, s[52:53]
  v_cndmask_b32 v68, v92, v88, s[54:55]
  v_cndmask_b32 v69, v92, v89, s[54:55]
  v_cndmask_b32 v70, v92, v90, s[54:55]
  v_cndmask_b32 v71, v92, v91, s[54:55]
  s_add_i32 s46, s34, 5
  v_sub_u32 v93, s46, v22
  s_add_i32 s46, s34, 6
  v_sub_u32 v94, s46, v22
  s_add_i32 s46, s34, 7
  v_sub_u32 v95, s46, v22
  s_add_i32 s46, s34, 8
  v_sub_u32 v96, s46, v22
  v_cmp_gt_u32 s[48:49], 7, v93
  v_cmp_gt_u32 s[50:51], 7, v94
  v_cmp_gt_u32 s[52:53], 7, v95
  v_cmp_gt_u32 s[54:55], 7, v96
  v_cndmask_b32 v72, v92, v88, s[48:49]
  v_cndmask_b32 v73, v92, v89, s[48:49]
  v_cndmask_b32 v74, v92, v90, s[48:49]
  v_cndmask_b32 v75, v92, v91, s[48:49]
  v_cndmask_b32 v76, v92, v88, s[50:51]
  v_cndmask_b32 v77, v92, v89, s[50:51]
  v_cndmask_b32 v78, v92, v90, s[50:51]
  v_cndmask_b32 v79, v92, v91, s[50:51]
  v_cndmask_b32 v80, v92, v88, s[52:53]
  v_cndmask_b32 v81, v92, v89, s[52:53]
  v_cndmask_b32 v82, v92, v90, s[52:53]
  v_cndmask_b32 v83, v92, v91, s[52:53]
  v_cndmask_b32 v84, v92, v88, s[54:55]
  v_cndmask_b32 v85, v92, v89, s[54:55]
  v_cndmask_b32 v86, v92, v90, s[54:55]
  v_cndmask_b32 v87, v92, v91, s[54:55]
  s_mul_i32 s50, s32, 9
  s_add_i32 s50, s50, s31
  s_add_u32 m0, s39, 138240
  s_nop 0
  buffer_load_dwordx4 v13, s[12:15], s50 offen lds
  s_add_u32 m0, s39, 139264
  s_nop 0
  buffer_load_dwordx4 v14, s[12:15], s50 offen lds
  s_add_u32 m0, s39, 140288
  s_nop 0
  buffer_load_dwordx4 v3, s[12:15], s50 offen lds
  s_add_u32 m0, s40, 138240
  s_nop 0
  buffer_load_dwordx4 v4, s[12:15], s50 offen lds
  s_mul_i32 s50, s32, 8
  s_add_i32 s50, s50, s31
  s_add_u32 m0, s39, 122880
  s_nop 0
  buffer_load_dwordx4 v13, s[12:15], s50 offen lds
  s_add_u32 m0, s39, 123904
  s_nop 0
  buffer_load_dwordx4 v14, s[12:15], s50 offen lds
  s_add_u32 m0, s39, 124928
  s_nop 0
  buffer_load_dwordx4 v3, s[12:15], s50 offen lds
  s_add_u32 m0, s40, 122880
  s_nop 0
  buffer_load_dwordx4 v4, s[12:15], s50 offen lds
  s_mul_i32 s50, s32, 7
  s_add_i32 s50, s50, s31
  s_add_u32 m0, s39, 107520
  s_nop 0
  buffer_load_dwordx4 v13, s[12:15], s50 offen lds
  s_add_u32 m0, s39, 108544
  s_nop 0
  buffer_load_dwordx4 v14, s[12:15], s50 offen lds
  s_add_u32 m0, s39, 109568
  s_nop 0
  buffer_load_dwordx4 v3, s[12:15], s50 offen lds
  s_add_u32 m0, s40, 107520
  s_nop 0
  buffer_load_dwordx4 v4, s[12:15], s50 offen lds
  s_mul_i32 s50, s32, 6
  s_add_i32 s50, s50, s31
  s_add_u32 m0, s39, 92160
  s_nop 0
  buffer_load_dwordx4 v13, s[12:15], s50 offen lds
  s_add_u32 m0, s39, 93184
  s_nop 0
  buffer_load_dwordx4 v14, s[12:15], s50 offen lds
  s_add_u32 m0, s39, 94208
  s_nop 0
  buffer_load_dwordx4 v3, s[12:15], s50 offen lds
  s_add_u32 m0, s40, 92160
  s_nop 0
  buffer_load_dwordx4 v4, s[12:15], s50 offen lds
  s_mul_i32 s50, s32, 5
  s_add_i32 s50, s50, s31
  s_add_u32 m0, s39, 76800
  s_nop 0
  buffer_load_dwordx4 v13, s[12:15], s50 offen lds
  s_add_u32 m0, s39, 77824
  s_nop 0
  buffer_load_dwordx4 v14, s[12:15], s50 offen lds
  s_add_u32 m0, s39, 78848
  s_nop 0
  buffer_load_dwordx4 v3, s[12:15], s50 offen lds
  s_add_u32 m0, s40, 76800
  s_nop 0
  buffer_load_dwordx4 v4, s[12:15], s50 offen lds
MK_nobi:
  ds_read_b128 v[216:219], v2 offset:35840
  ds_read_b128 v[220:223], v2 offset:34816
  ds_read_b128 v[224:227], v2 offset:33792
  ds_read_b128 v[228:231], v2 offset:32768
  ds_read_b128 v[232:235], v2 offset:31744
  ds_read_b128 v[236:239], v2 offset:30720
  ds_read_b128 v[240:243], v2 offset:29696
  ds_read_b128 v[244:247], v2 offset:28672
  ds_read_b128 v[248:251], v2 offset:27648
  ds_read_b128 v[252:255], v2 offset:26624
  s_cbranch_vccz RL1
  s_waitcnt vmcnt(10)
  s_branch RM1
RL1:
  s_waitcnt vmcnt(30)
RM1:
  s_waitcnt lgkmcnt(8)
  v_mfma_f32_16x16x32_bf16 v[184:187], v[216:219], v[136:139], 0
  v_mfma_f32_16x16x32_bf16 v[192:195], v[216:219], v[160:163], 0
  ds_read_b128 v[216:219], v2 offset:25600
  v_mfma_f32_16x16x32_bf16 v[188:191], v[220:223], v[136:139], 0
  v_mfma_f32_16x16x32_bf16 v[196:199], v[220:223], v[160:163], 0
  ds_read_b128 v[220:223], v2 offset:24576
  s_cbranch_vccz RL2
  s_waitcnt vmcnt(8)
  s_branch RM2
RL2:
  s_waitcnt vmcnt(28)
RM2:
  s_waitcnt lgkmcnt(8)
  v_mfma_f32_16x16x32_bf16 v[184:187], v[224:227], v[140:143], v[184:187]
  v_mfma_f32_16x16x32_bf16 v[192:195], v[224:227], v[164:167], v[192:195]
  ds_read_b128 v[224:227], v2 offset:23552
  v_mfma_f32_16x16x32_bf16 v[188:191], v[228:231], v[140:143], v[188:191]
  v_mfma_f32_16x16x32_bf16 v[196:199], v[228:231], v[164:167], v[196:199]
  ds_read_b128 v[228:231], v2 offset:22528
  s_cbranch_vccz RL3
  s_waitcnt vmcnt(6)
  s_branch RM3
RL3:
  s_waitcnt vmcnt(26)
RM3:
  s_waitcnt lgkmcnt(8)
  v_mfma_f32_16x16x32_bf16 v[184:187], v[232:235], v[144:147], v[184:187]
  v_mfma_f32_16x16x32_bf16 v[192:195], v[232:235], v[168:171], v[192:195]
  ds_read_b128 v[232:235], v2 offset:21504
  v_mfma_f32_16x16x32_bf16 v[188:191], v[236:239], v[144:147], v[188:191]
  v_mfma_f32_16x16x32_bf16 v[196:199], v[236:239], v[168:171], v[196:199]
  ds_read_b128 v[236:239], v2 offset:20480
  s_cbranch_vccz RL4
  s_waitcnt vmcnt(4)
  s_branch RM4
RL4:
  s_waitcnt vmcnt(24)
RM4:
  s_waitcnt lgkmcnt(8)
  v_mfma_f32_16x16x32_bf16 v[184:187], v[240:243], v[148:151], v[184:187]
  v_mfma_f32_16x16x32_bf16 v[192:195], v[240:243], v[172:175], v[192:195]
  ds_read_b128 v[240:243], v2 offset:19456
  v_mfma_f32_16x16x32_bf16 v[188:191], v[244:247], v[148:151], v[188:191]
  v_mfma_f32_16x16x32_bf16 v[196:199], v[244:247], v[172:175], v[196:199]
  ds_read_b128 v[244:247], v2 offset:18432
  s_cbranch_vccz RL5
  s_waitcnt vmcnt(2)
  s_branch RM5
RL5:
  s_waitcnt vmcnt(22)
RM5:
  s_waitcnt lgkmcnt(8)
  v_mfma_f32_16x16x32_bf16 v[184:187], v[248:251], v[152:155], v[184:187]
  v_mfma_f32_16x16x32_bf16 v[192:195], v[248:251], v[176:179], v[192:195]
  ds_read_b128 v[248:251], v2 offset:17408
  v_mfma_f32_16x16x32_bf16 v[188:191], v[252:255], v[152:155], v[188:191]
  v_mfma_f32_16x16x32_bf16 v[196:199], v[252:255], v[176:179], v[196:199]
  ds_read_b128 v[252:255], v2 offset:16384
  s_cbranch_vccz RL6
  s_waitcnt vmcnt(0)
  s_branch RM6
RL6:
  s_waitcnt vmcnt(20)
RM6:
  s_waitcnt lgkmcnt(8)
  v_mfma_f32_16x16x32_bf16 v[184:187], v[216:219], v[156:159], v[184:187]
  v_mfma_f32_16x16x32_bf16 v[192:195], v[216:219], v[180:183], v[192:195]
  ds_read_b128 v[216:219], v2 offset:15360
  v_mfma_f32_16x16x32_bf16 v[188:191], v[220:223], v[156:159], v[188:191]
  v_mfma_f32_16x16x32_bf16 v[196:199], v[220:223], v[180:183], v[196:199]
  ds_read_b128 v[220:223], v2 offset:14336
  s_waitcnt lgkmcnt(8)
  v_mfma_f32_16x16x32_bf16 v[200:203], v[224:227], v[136:139], 0
  v_mfma_f32_16x16x32_bf16 v[208:211], v[224:227], v[160:163], 0
  ds_read_b128 v[224:227], v2 offset:13312
  v_mul_f32 v184, s93, v184
  s_cmp_eq_u32 s3, 0
  s_cbranch_scc1 MK_np4
  v_mov_b32 v23, 1
  s_mov_b64 exec, 1
  buffer_atomic_add v23, off, s[8:11], 0 sc1
  s_mov_b64 exec, -1
  s_nop 3
MK_np4:
  v_mfma_f32_16x16x32_bf16 v[204:207], v[228:231], v[136:139], 0
  v_mul_f32 v185, s93, v185
  v_mul_f32 v186, s93, v186
  v_mfma_f32_16x16x32_bf16 v[212:215], v[228:231], v[160:163], 0
  ds_read_b128 v[228:231], v2 offset:12288
  s_waitcnt lgkmcnt(8)
  v_mfma_f32_16x16x32_bf16 v[200:203], v[232:235], v[140:143], v[200:203]
  v_mul_f32 v187, s93, v187
  v_mul_f32 v188, s93, v188
  v_mfma_f32_16x16x32_bf16 v[208:211], v[232:235], v[164:167], v[208:211]
  ds_read_b128 v[232:235], v2 offset:11264
  v_mul_f32 v189, s93, v189
  v_mfma_f32_16x16x32_bf16 v[204:207], v[236:239], v[140:143], v[204:207]
  v_mul_f32 v190, s93, v190
  v_mul_f32 v191, s93, v191
  v_mfma_f32_16x16x32_bf16 v[212:215], v[236:239], v[164:167], v[212:215]
  ds_read_b128 v[236:239], v2 offset:10240
  s_waitcnt lgkmcnt(8)
  v_mfma_f32_16x16x32_bf16 v[200:203], v[240:243], v[144:147], v[200:203]
  v_cvt_pk_bf16_f32 v88, v184, v185
  v_cvt_pk_bf16_f32 v89, v186, v187
  v_mfma_f32_16x16x32_bf16 v[208:211], v[240:243], v[168:171], v[208:211]
  ds_read_b128 v[240:243], v2 offset:9216
  v_cvt_pk_bf16_f32 v90, v188, v189
  v_mfma_f32_16x16x32_bf16 v[204:207], v[244:247], v[144:147], v[204:207]
  v_cvt_pk_bf16_f32 v91, v190, v191
  v_mul_f32 v192, s93, v192
  v_mfma_f32_16x16x32_bf16 v[212:215], v[244:247], v[168:171], v[212:215]
  ds_read_b128 v[244:247], v2 offset:8192
  s_waitcnt lgkmcnt(8)
  v_mfma_f32_16x16x32_bf16 v[200:203], v[248:251], v[148:151], v[200:203]
  v_mul_f32 v193, s93, v193
  v_mul_f32 v194, s93, v194
  v_mfma_f32_16x16x32_bf16 v[208:211], v[248:251], v[172:175], v[208:211]
  ds_read_b128 v[248:251], v2 offset:7168
  v_mul_f32 v195, s93, v195
  v_mfma_f32_16x16x32_bf16 v[204:207], v[252:255], v[148:151], v[204:207]
  v_mul_f32 v196, s93, v196
  v_mul_f32 v197, s93, v197
  v_mfma_f32_16x16x32_bf16 v[212:215], v[252:255], v[172:175], v[212:215]
  ds_read_b128 v[252:255], v2 offset:6144
  s_waitcnt lgkmcnt(8)
  v_mfma_f32_16x16x32_bf16 v[200:203], v[216:219], v[152:155], v[200:203]
  v_mul_f32 v198, s93, v198
  v_mul_f32 v199, s93, v199
  v_mfma_f32_16x16x32_bf16 v[208:211], v[216:219], v[176:179], v[208:211]
  ds_read_b128 v[216:219], v2 offset:5120
  v_cvt_pk_bf16_f32 v112, v192, v193
  v_mfma_f32_16x16x32_bf16 v[204:207], v[220:223], v[152:155], v[204:207]
  v_cvt_pk_bf16_f32 v113, v194, v195
  v_cvt_pk_bf16_f32 v114, v196, v197
  v_mfma_f32_16x16x32_bf16 v[212:215], v[220:223], v[176:179], v[212:215]
  ds_read_b128 v[220:223], v2 offset:4096
  s_waitcnt lgkmcnt(8)
  v_mfma_f32_16x16x32_bf16 v[200:203], v[224:227], v[156:159], v[200:203]
  v_cvt_pk_bf16_f32 v115, v198, v199
  v_mfma_f32_16x16x32_bf16 v[208:211], v[224:227], v[180:183], v[208:211]
  ds_read_b128 v[224:227], v2 offset:3072
  v_mfma_f32_16x16x32_bf16 v[204:207], v[228:231], v[156:159], v[204:207]
  v_mfma_f32_16x16x32_bf16 v[212:215], v[228:231], v[180:183], v[212:215]
  ds_read_b128 v[228:231], v2 offset:2048
  s_waitcnt lgkmcnt(8)
  v_mfma_f32_16x16x32_bf16 v[184:187], v[232:235], v[136:139], 0
  v_mul_f32 v200, s93, v200
  v_mul_f32 v201, s93, v201
  v_mfma_f32_16x16x32_bf16 v[192:195], v[232:235], v[160:163], 0
  ds_read_b128 v[232:235], v2 offset:1024
  v_mul_f32 v202, s93, v202
  v_mfma_f32_16x16x32_bf16 v[188:191], v[236:239], v[136:139], 0
  v_mul_f32 v203, s93, v203
  v_mul_f32 v204, s93, v204
  v_mfma_f32_16x16x32_bf16 v[196:199], v[236:239], v[160:163], 0
  ds_read_b128 v[236:239], v2 offset:0
  s_waitcnt lgkmcnt(8)
  v_mfma_f32_16x16x32_bf16 v[184:187], v[240:243], v[140:143], v[184:187]
  v_mul_f32 v205, s93, v205
  v_mul_f32 v206, s93, v206
  v_mfma_f32_16x16x32_bf16 v[192:195], v[240:243], v[164:167], v[192:195]
  ds_read_b128 v[240:243], v1 offset:35840
  v_mul_f32 v207, s93, v207
  v_mfma_f32_16x16x32_bf16 v[188:191], v[244:247], v[140:143], v[188:191]
  v_cvt_pk_bf16_f32 v92, v200, v201
  v_cvt_pk_bf16_f32 v93, v202, v203
  v_mfma_f32_16x16x32_bf16 v[196:199], v[244:247], v[164:167], v[196:199]
  ds_read_b128 v[244:247], v1 offset:34816
  s_waitcnt lgkmcnt(8)
  v_mfma_f32_16x16x32_bf16 v[184:187], v[248:251], v[144:147], v[184:187]
  v_cvt_pk_bf16_f32 v94, v204, v205
  v_cvt_pk_bf16_f32 v95, v206, v207
  v_mfma_f32_16x16x32_bf16 v[192:195], v[248:251], v[168:171], v[192:195]
  ds_read_b128 v[248:251], v1 offset:33792
  v_mul_f32 v208, s93, v208
  v_mfma_f32_16x16x32_bf16 v[188:191], v[252:255], v[144:147], v[188:191]
  v_mul_f32 v209, s93, v209
  v_mul_f32 v210, s93, v210
  v_mfma_f32_16x16x32_bf16 v[196:199], v[252:255], v[168:171], v[196:199]
  ds_read_b128 v[252:255], v1 offset:32768
  s_waitcnt lgkmcnt(8)
  v_mfma_f32_16x16x32_bf16 v[184:187], v[216:219], v[148:151], v[184:187]
  v_mul_f32 v211, s93, v211
  v_mul_f32 v212, s93, v212
  v_mfma_f32_16x16x32_bf16 v[192:195], v[216:219], v[172:175], v[192:195]
  ds_read_b128 v[216:219], v1 offset:31744
  v_mul_f32 v213, s93, v213
  s_cbranch_vccnz RL7
  s_barrier
RL7:
  v_mfma_f32_16x16x32_bf16 v[188:191], v[220:223], v[148:151], v[188:191]
  v_mul_f32 v214, s93, v214
  v_mul_f32 v215, s93, v215
  v_mfma_f32_16x16x32_bf16 v[196:199], v[220:223], v[172:175], v[196:199]
  ds_read_b128 v[220:223], v1 offset:30720
  s_waitcnt lgkmcnt(8)
  v_mfma_f32_16x16x32_bf16 v[184:187], v[224:227], v[152:155], v[184:187]
  v_cvt_pk_bf16_f32 v116, v208, v209
  v_cvt_pk_bf16_f32 v117, v210, v211
  v_mfma_f32_16x16x32_bf16 v[192:195], v[224:227], v[176:179], v[192:195]
  ds_read_b128 v[224:227], v1 offset:29696
  v_cvt_pk_bf16_f32 v118, v212, v213
  v_mfma_f32_16x16x32_bf16 v[188:191], v[228:231], v[152:155], v[188:191]
  v_cvt_pk_bf16_f32 v119, v214, v215
  v_mfma_f32_16x16x32_bf16 v[196:199], v[228:231], v[176:179], v[196:199]
  ds_read_b128 v[228:231], v1 offset:28672
  s_waitcnt lgkmcnt(8)
  v_mfma_f32_16x16x32_bf16 v[184:187], v[232:235], v[156:159], v[184:187]
  v_mfma_f32_16x16x32_bf16 v[192:195], v[232:235], v[180:183], v[192:195]
  ds_read_b128 v[232:235], v1 offset:27648
  v_mfma_f32_16x16x32_bf16 v[188:191], v[236:239], v[156:159], v[188:191]
  v_mfma_f32_16x16x32_bf16 v[196:199], v[236:239], v[180:183], v[196:199]
  ds_read_b128 v[236:239], v1 offset:26624
  s_waitcnt lgkmcnt(8)
  v_mfma_f32_16x16x32_bf16 v[200:203], v[240:243], v[136:139], 0
  v_mfma_f32_16x16x32_bf16 v[208:211], v[240:243], v[160:163], 0
  ds_read_b128 v[240:243], v1 offset:25600
  v_mul_f32 v184, s93, v184
  v_mfma_f32_16x16x32_bf16 v[204:207], v[244:247], v[136:139], 0
  v_mul_f32 v185, s93, v185
  v_mul_f32 v186, s93, v186
  v_mfma_f32_16x16x32_bf16 v[212:215], v[244:247], v[160:163], 0
  ds_read_b128 v[244:247], v1 offset:24576
  s_waitcnt lgkmcnt(8)
  v_mfma_f32_16x16x32_bf16 v[200:203], v[248:251], v[140:143], v[200:203]
  v_mul_f32 v187, s93, v187
  v_mul_f32 v188, s93, v188
  v_mfma_f32_16x16x32_bf16 v[208:211], v[248:251], v[164:167], v[208:211]
  ds_read_b128 v[248:251], v1 offset:23552
  v_mul_f32 v189, s93, v189
  v_mfma_f32_16x16x32_bf16 v[204:207], v[252:255], v[140:143], v[204:207]
  v_mul_f32 v190, s93, v190
  v_mul_f32 v191, s93, v191
  v_mfma_f32_16x16x32_bf16 v[212:215], v[252:255], v[164:167], v[212:215]
  ds_read_b128 v[252:255], v1 offset:22528
  s_waitcnt lgkmcnt(8)
  v_mfma_f32_16x16x32_bf16 v[200:203], v[216:219], v[144:147], v[200:203]
  v_cvt_pk_bf16_f32 v96, v184, v185
  v_cvt_pk_bf16_f32 v97, v186, v187
  v_mfma_f32_16x16x32_bf16 v[208:211], v[216:219], v[168:171], v[208:211]
  ds_read_b128 v[216:219], v1 offset:21504
  v_cvt_pk_bf16_f32 v98, v188, v189
  v_mfma_f32_16x16x32_bf16 v[204:207], v[220:223], v[144:147], v[204:207]
  v_cvt_pk_bf16_f32 v99, v190, v191
  v_mul_f32 v192, s93, v192
  v_mfma_f32_16x16x32_bf16 v[212:215], v[220:223], v[168:171], v[212:215]
  ds_read_b128 v[220:223], v1 offset:20480
  s_waitcnt lgkmcnt(8)
  v_mfma_f32_16x16x32_bf16 v[200:203], v[224:227], v[148:151], v[200:203]
  v_mul_f32 v193, s93, v193
  v_mul_f32 v194, s93, v194
  v_mfma_f32_16x16x32_bf16 v[208:211], v[224:227], v[172:175], v[208:211]
  ds_read_b128 v[224:227], v1 offset:19456
  v_mul_f32 v195, s93, v195
  v_mfma_f32_16x16x32_bf16 v[204:207], v[228:231], v[148:151], v[204:207]
  v_mul_f32 v196, s93, v196
  v_mul_f32 v197, s93, v197
  v_mfma_f32_16x16x32_bf16 v[212:215], v[228:231], v[172:175], v[212:215]
  ds_read_b128 v[228:231], v1 offset:18432
  s_waitcnt lgkmcnt(8)
  v_mfma_f32_16x16x32_bf16 v[200:203], v[232:235], v[152:155], v[200:203]
  v_mul_f32 v198, s93, v198
  v_mul_f32 v199, s93, v199
  v_mfma_f32_16x16x32_bf16 v[208:211], v[232:235], v[176:179], v[208:211]
  ds_read_b128 v[232:235], v1 offset:17408
  v_cvt_pk_bf16_f32 v120, v192, v193
  v_mfma_f32_16x16x32_bf16 v[204:207], v[236:239], v[152:155], v[204:207]
  v_cvt_pk_bf16_f32 v121, v194, v195
  v_cvt_pk_bf16_f32 v122, v196, v197
  v_mfma_f32_16x16x32_bf16 v[212:215], v[236:239], v[176:179], v[212:215]
  ds_read_b128 v[236:239], v1 offset:16384
  s_waitcnt lgkmcnt(8)
  v_mfma_f32_16x16x32_bf16 v[200:203], v[240:243], v[156:159], v[200:203]
  v_cvt_pk_bf16_f32 v123, v198, v199
  v_mfma_f32_16x16x32_bf16 v[208:211], v[240:243], v[180:183], v[208:211]
  ds_read_b128 v[240:243], v1 offset:15360
  v_mfma_f32_16x16x32_bf16 v[204:207], v[244:247], v[156:159], v[204:207]
  v_mfma_f32_16x16x32_bf16 v[212:215], v[244:247], v[180:183], v[212:215]
  ds_read_b128 v[244:247], v1 offset:14336
  s_waitcnt lgkmcnt(8)
  v_mfma_f32_16x16x32_bf16 v[184:187], v[248:251], v[136:139], 0
  v_mul_f32 v200, s93, v200
  v_mul_f32 v201, s93, v201
  v_mfma_f32_16x16x32_bf16 v[192:195], v[248:251], v[160:163], 0
  ds_read_b128 v[248:251], v1 offset:13312
  v_mul_f32 v202, s93, v202
  v_mfma_f32_16x16x32_bf16 v[188:191], v[252:255], v[136:139], 0
  v_mul_f32 v203, s93, v203
  v_mul_f32 v204, s93, v204
  v_mfma_f32_16x16x32_bf16 v[196:199], v[252:255], v[160:163], 0
  ds_read_b128 v[252:255], v1 offset:12288
  s_waitcnt lgkmcnt(8)
  v_mfma_f32_16x16x32_bf16 v[184:187], v[216:219], v[140:143], v[184:187]
  v_mul_f32 v205, s93, v205
  v_mul_f32 v206, s93, v206
  v_mfma_f32_16x16x32_bf16 v[192:195], v[216:219], v[164:167], v[192:195]
  ds_read_b128 v[216:219], v1 offset:11264
  v_mul_f32 v207, s93, v207
  v_mfma_f32_16x16x32_bf16 v[188:191], v[220:223], v[140:143], v[188:191]
  v_cvt_pk_bf16_f32 v100, v200, v201
  v_cvt_pk_bf16_f32 v101, v202, v203
  v_mfma_f32_16x16x32_bf16 v[196:199], v[220:223], v[164:167], v[196:199]
  ds_read_b128 v[220:223], v1 offset:10240
  s_waitcnt lgkmcnt(8)
  v_mfma_f32_16x16x32_bf16 v[184:187], v[224:227], v[144:147], v[184:187]
  v_cvt_pk_bf16_f32 v102, v204, v205
  v_cvt_pk_bf16_f32 v103, v206, v207
  v_mfma_f32_16x16x32_bf16 v[192:195], v[224:227], v[168:171], v[192:195]
  ds_read_b128 v[224:227], v1 offset:9216
  v_mul_f32 v208, s93, v208
  v_mfma_f32_16x16x32_bf16 v[188:191], v[228:231], v[144:147], v[188:191]
  v_mul_f32 v209, s93, v209
  v_mul_f32 v210, s93, v210
  v_mfma_f32_16x16x32_bf16 v[196:199], v[228:231], v[168:171], v[196:199]
  ds_read_b128 v[228:231], v1 offset:8192
  s_waitcnt lgkmcnt(8)
  v_mfma_f32_16x16x32_bf16 v[184:187], v[232:235], v[148:151], v[184:187]
  v_mul_f32 v211, s93, v211
  v_mul_f32 v212, s93, v212
  v_mfma_f32_16x16x32_bf16 v[192:195], v[232:235], v[172:175], v[192:195]
  ds_read_b128 v[232:235], v1 offset:7168
  v_mul_f32 v213, s93, v213
  v_mfma_f32_16x16x32_bf16 v[188:191], v[236:239], v[148:151], v[188:191]
  v_mul_f32 v214, s93, v214
  v_mul_f32 v215, s93, v215
  v_mfma_f32_16x16x32_bf16 v[196:199], v[236:239], v[172:175], v[196:199]
  ds_read_b128 v[236:239], v1 offset:6144
  s_waitcnt lgkmcnt(8)
  v_mfma_f32_16x16x32_bf16 v[184:187], v[240:243], v[152:155], v[184:187]
  v_cvt_pk_bf16_f32 v124, v208, v209
  v_cvt_pk_bf16_f32 v125, v210, v211
  v_mfma_f32_16x16x32_bf16 v[192:195], v[240:243], v[176:179], v[192:195]
  ds_read_b128 v[240:243], v1 offset:5120
  v_cvt_pk_bf16_f32 v126, v212, v213
  v_mfma_f32_16x16x32_bf16 v[188:191], v[244:247], v[152:155], v[188:191]
  v_cvt_pk_bf16_f32 v127, v214, v215
  v_mfma_f32_16x16x32_bf16 v[196:199], v[244:247], v[176:179], v[196:199]
  ds_read_b128 v[244:247], v1 offset:4096
  s_waitcnt lgkmcnt(8)
  v_mfma_f32_16x16x32_bf16 v[184:187], v[248:251], v[156:159], v[184:187]
  v_mfma_f32_16x16x32_bf16 v[192:195], v[248:251], v[180:183], v[192:195]
  ds_read_b128 v[248:251], v1 offset:3072
  v_mfma_f32_16x16x32_bf16 v[188:191], v[252:255], v[156:159], v[188:191]
  v_mfma_f32_16x16x32_bf16 v[196:199], v[252:255], v[180:183], v[196:199]
  ds_read_b128 v[252:255], v1 offset:2048
  s_waitcnt lgkmcnt(8)
  v_mfma_f32_16x16x32_bf16 v[200:203], v[216:219], v[136:139], 0
  v_mfma_f32_16x16x32_bf16 v[208:211], v[216:219], v[160:163], 0
  ds_read_b128 v[216:219], v1 offset:1024
  v_mul_f32 v184, s93, v184
  s_cbranch_vccnz RL8
  s_waitcnt vmcnt(0)
  s_barrier
RL8:
  v_mfma_f32_16x16x32_bf16 v[204:207], v[220:223], v[136:139], 0
  v_mul_f32 v185, s93, v185
  v_mul_f32 v186, s93, v186
  v_mfma_f32_16x16x32_bf16 v[212:215], v[220:223], v[160:163], 0
  ds_read_b128 v[220:223], v1 offset:0
  s_waitcnt lgkmcnt(8)
  v_mfma_f32_16x16x32_bf16 v[200:203], v[224:227], v[140:143], v[200:203]
  v_mul_f32 v187, s93, v187
  v_mul_f32 v188, s93, v188
  v_mfma_f32_16x16x32_bf16 v[208:211], v[224:227], v[164:167], v[208:211]
  v_mul_f32 v189, s93, v189
  v_mul_f32 v190, s93, v190
  v_mfma_f32_16x16x32_bf16 v[204:207], v[228:231], v[140:143], v[204:207]
  v_mul_f32 v191, s93, v191
  v_cvt_pk_bf16_f32 v104, v184, v185
  v_mfma_f32_16x16x32_bf16 v[212:215], v[228:231], v[164:167], v[212:215]
  v_cvt_pk_bf16_f32 v105, v186, v187
  s_waitcnt lgkmcnt(6)
  v_mfma_f32_16x16x32_bf16 v[200:203], v[232:235], v[144:147], v[200:203]
  v_cvt_pk_bf16_f32 v106, v188, v189
  v_cvt_pk_bf16_f32 v107, v190, v191
  v_mfma_f32_16x16x32_bf16 v[208:211], v[232:235], v[168:171], v[208:211]
  v_mul_f32 v192, s93, v192
  v_mul_f32 v193, s93, v193
  v_mfma_f32_16x16x32_bf16 v[204:207], v[236:239], v[144:147], v[204:207]
  v_mul_f32 v194, s93, v194
  v_mul_f32 v195, s93, v195
  v_mfma_f32_16x16x32_bf16 v[212:215], v[236:239], v[168:171], v[212:215]
  v_mul_f32 v196, s93, v196
  s_waitcnt lgkmcnt(5)
  v_mfma_f32_16x16x32_bf16 v[200:203], v[240:243], v[148:151], v[200:203]
  v_mul_f32 v197, s93, v197
  v_mul_f32 v198, s93, v198
  v_mfma_f32_16x16x32_bf16 v[208:211], v[240:243], v[172:175], v[208:211]
  v_mul_f32 v199, s93, v199
  s_waitcnt lgkmcnt(4)
  v_mfma_f32_16x16x32_bf16 v[204:207], v[244:247], v[148:151], v[204:207]
  v_cvt_pk_bf16_f32 v128, v192, v193
  v_cvt_pk_bf16_f32 v129, v194, v195
  v_mfma_f32_16x16x32_bf16 v[212:215], v[244:247], v[172:175], v[212:215]
  v_cvt_pk_bf16_f32 v130, v196, v197
  s_waitcnt lgkmcnt(3)
  v_mfma_f32_16x16x32_bf16 v[200:203], v[248:251], v[152:155], v[200:203]
  v_cvt_pk_bf16_f32 v131, v198, v199
  v_mfma_f32_16x16x32_bf16 v[208:211], v[248:251], v[176:179], v[208:211]
  s_waitcnt lgkmcnt(2)
  v_mfma_f32_16x16x32_bf16 v[204:207], v[252:255], v[152:155], v[204:207]
  v_mfma_f32_16x16x32_bf16 v[212:215], v[252:255], v[176:179], v[212:215]
  s_waitcnt lgkmcnt(1)
  v_mfma_f32_16x16x32_bf16 v[200:203], v[216:219], v[156:159], v[200:203]
  v_mfma_f32_16x16x32_bf16 v[208:211], v[216:219], v[180:183], v[208:211]
  s_waitcnt lgkmcnt(0)
  v_mfma_f32_16x16x32_bf16 v[204:207], v[220:223], v[156:159], v[204:207]
  v_mfma_f32_16x16x32_bf16 v[212:215], v[220:223], v[180:183], v[212:215]
  s_nop 3
  v_mul_f32 v200, s93, v200
  v_mul_f32 v201, s93, v201
  v_mul_f32 v202, s93, v202
  v_mul_f32 v203, s93, v203
  v_mul_f32 v204, s93, v204
  v_mul_f32 v205, s93, v205
  v_mul_f32 v206, s93, v206
  v_mul_f32 v207, s93, v207
  v_cvt_pk_bf16_f32 v108, v200, v201
  v_cvt_pk_bf16_f32 v109, v202, v203
  v_cvt_pk_bf16_f32 v110, v204, v205
  v_cvt_pk_bf16_f32 v111, v206, v207
  v_mul_f32 v208, s93, v208
  v_mul_f32 v209, s93, v209
  v_mul_f32 v210, s93, v210
  v_mul_f32 v211, s93, v211
  v_mul_f32 v212, s93, v212
  v_mul_f32 v213, s93, v213
  v_mul_f32 v214, s93, v214
  v_mul_f32 v215, s93, v215
  v_cvt_pk_bf16_f32 v132, v208, v209
  v_cvt_pk_bf16_f32 v133, v210, v211
  v_cvt_pk_bf16_f32 v134, v212, v213
  v_cvt_pk_bf16_f32 v135, v214, v215
  v_add_u32 v2, 102400, v1
  v_mov_b32 v192, 0x3f803f80
  v_mov_b32 v193, 0x3f803f80
  v_mov_b32 v194, 0x3f803f80
  v_mov_b32 v195, 0x3f803f80
  s_cbranch_vccz RL9
  v_mov_b32 v140, 0xff800000
  v_add_u32 v141, 0, v19
  v_add_u32 v142, 1, v19
  v_add_u32 v143, 2, v19
  v_add_u32 v144, 3, v19
  v_cmp_gt_u32 s[48:49], 7, v141
  v_cmp_gt_u32 s[50:51], 7, v142
  v_cmp_gt_u32 s[52:53], 7, v143
  v_cmp_gt_u32 s[54:55], 7, v144
  v_cndmask_b32 v136, v140, 0, s[48:49]
  v_cndmask_b32 v137, v140, 0, s[50:51]
  v_cndmask_b32 v138, v140, 0, s[52:53]
  v_cndmask_b32 v139, v140, 0, s[54:55]
  v_sub_u32 v141, s35, v21
  s_add_i32 s46, s34, 0
  v_sub_u32 v142, s46, v21
  s_add_i32 s46, s34, 1
  v_sub_u32 v143, s46, v21
  s_add_i32 s46, s34, 2
  v_sub_u32 v144, s46, v21
  v_cmp_gt_u32 s[48:49], 7, v141
  v_cmp_gt_u32 s[50:51], 7, v142
  v_cmp_gt_u32 s[52:53], 7, v143
  v_cmp_gt_u32 s[54:55], 7, v144
  v_cndmask_b32 v24, v140, v136, s[48:49]
  v_cndmask_b32 v25, v140, v137, s[48:49]
  v_cndmask_b32 v26, v140, v138, s[48:49]
  v_cndmask_b32 v27, v140, v139, s[48:49]
  v_cndmask_b32 v28, v140, v136, s[50:51]
  v_cndmask_b32 v29, v140, v137, s[50:51]
  v_cndmask_b32 v30, v140, v138, s[50:51]
  v_cndmask_b32 v31, v140, v139, s[50:51]
  v_cndmask_b32 v32, v140, v136, s[52:53]
  v_cndmask_b32 v33, v140, v137, s[52:53]
  v_cndmask_b32 v34, v140, v138, s[52:53]
  v_cndmask_b32 v35, v140, v139, s[52:53]
  v_cndmask_b32 v36, v140, v136, s[54:55]
  v_cndmask_b32 v37, v140, v137, s[54:55]
  v_cndmask_b32 v38, v140, v138, s[54:55]
  v_cndmask_b32 v39, v140, v139, s[54:55]
  s_add_i32 s46, s34, 3
  v_sub_u32 v141, s46, v21
  s_add_i32 s46, s34, 4
  v_sub_u32 v142, s46, v21
  s_add_i32 s46, s34, 5
  v_sub_u32 v143, s46, v21
  s_add_i32 s46, s34, 6
  v_sub_u32 v144, s46, v21
  v_cmp_gt_u32 s[48:49], 7, v141
  v_cmp_gt_u32 s[50:51], 7, v142
  v_cmp_gt_u32 s[52:53], 7, v143
  v_cmp_gt_u32 s[54:55], 7, v144
  v_cndmask_b32 v40, v140, v136, s[48:49]
  v_cndmask_b32 v41, v140, v137, s[48:49]
  v_cndmask_b32 v42, v140, v138, s[48:49]
  v_cndmask_b32 v43, v140, v139, s[48:49]
  v_cndmask_b32 v44, v140, v136, s[50:51]
  v_cndmask_b32 v45, v140, v137, s[50:51]
  v_cndmask_b32 v46, v140, v138, s[50:51]
  v_cndmask_b32 v47, v140, v139, s[50:51]
  v_cndmask_b32 v48, v140, v136, s[52:53]
  v_cndmask_b32 v49, v140, v137, s[52:53]
  v_cndmask_b32 v50, v140, v138, s[52:53]
  v_cndmask_b32 v51, v140, v139, s[52:53]
  v_cndmask_b32 v52, v140, v136, s[54:55]
  v_cndmask_b32 v53, v140, v137, s[54:55]
  v_cndmask_b32 v54, v140, v138, s[54:55]
  v_cndmask_b32 v55, v140, v139, s[54:55]
  s_add_i32 s46, s34, 1
  v_sub_u32 v141, s46, v22
  s_add_i32 s46, s34, 2
  v_sub_u32 v142, s46, v22
  s_add_i32 s46, s34, 3
  v_sub_u32 v143, s46, v22
  s_add_i32 s46, s34, 4
  v_sub_u32 v144, s46, v22
  v_cmp_gt_u32 s[48:49], 7, v141
  v_cmp_gt_u32 s[50:51], 7, v142
  v_cmp_gt_u32 s[52:53], 7, v143
  v_cmp_gt_u32 s[54:55], 7, v144
  v_cndmask_b32 v56, v140, v136, s[48:49]
  v_cndmask_b32 v57, v140, v137, s[48:49]
  v_cndmask_b32 v58, v140, v138, s[48:49]
  v_cndmask_b32 v59, v140, v139, s[48:49]
  v_cndmask_b32 v60, v140, v136, s[50:51]
  v_cndmask_b32 v61, v140, v137, s[50:51]
  v_cndmask_b32 v62, v140, v138, s[50:51]
  v_cndmask_b32 v63, v140, v139, s[50:51]
  v_cndmask_b32 v64, v140, v136, s[52:53]
  v_cndmask_b32 v65, v140, v137, s[52:53]
  v_cndmask_b32 v66, v140, v138, s[52:53]
  v_cndmask_b32 v67, v140, v139, s[52:53]
  v_cndmask_b32 v68, v140, v136, s[54:55]
  v_cndmask_b32 v69, v140, v137, s[54:55]
  v_cndmask_b32 v70, v140, v138, s[54:55]
  v_cndmask_b32 v71, v140, v139, s[54:55]
  s_add_i32 s46, s34, 5
  v_sub_u32 v141, s46, v22
  s_add_i32 s46, s34, 6
  v_sub_u32 v142, s46, v22
  s_add_i32 s46, s34, 7
  v_sub_u32 v143, s46, v22
  s_add_i32 s46, s34, 8
  v_sub_u32 v144, s46, v22
  v_cmp_gt_u32 s[48:49], 7, v141
  v_cmp_gt_u32 s[50:51], 7, v142
  v_cmp_gt_u32 s[52:53], 7, v143
  v_cmp_gt_u32 s[54:55], 7, v144
  v_cndmask_b32 v72, v140, v136, s[48:49]
  v_cndmask_b32 v73, v140, v137, s[48:49]
  v_cndmask_b32 v74, v140, v138, s[48:49]
  v_cndmask_b32 v75, v140, v139, s[48:49]
  v_cndmask_b32 v76, v140, v136, s[50:51]
  v_cndmask_b32 v77, v140, v137, s[50:51]
  v_cndmask_b32 v78, v140, v138, s[50:51]
  v_cndmask_b32 v79, v140, v139, s[50:51]
  v_cndmask_b32 v80, v140, v136, s[52:53]
  v_cndmask_b32 v81, v140, v137, s[52:53]
  v_cndmask_b32 v82, v140, v138, s[52:53]
  v_cndmask_b32 v83, v140, v139, s[52:53]
  v_cndmask_b32 v84, v140, v136, s[54:55]
  v_cndmask_b32 v85, v140, v137, s[54:55]
  v_cndmask_b32 v86, v140, v138, s[54:55]
  v_cndmask_b32 v87, v140, v139, s[54:55]
  s_barrier
  s_mul_i32 s50, s32, 4
  s_add_i32 s50, s50, s31
  s_add_u32 m0, s39, 61440
  s_nop 0
  buffer_load_dwordx4 v13, s[12:15], s50 offen lds
  s_add_u32 m0, s39, 62464
  s_nop 0
  buffer_load_dwordx4 v14, s[12:15], s50 offen lds
  s_add_u32 m0, s39, 63488
  s_nop 0
  buffer_load_dwordx4 v3, s[12:15], s50 offen lds
  s_add_u32 m0, s40, 61440
  s_nop 0
  buffer_load_dwordx4 v4, s[12:15], s50 offen lds
  s_mul_i32 s50, s32, 3
  s_add_i32 s50, s50, s31
  s_add_u32 m0, s39, 46080
  s_nop 0
  buffer_load_dwordx4 v13, s[12:15], s50 offen lds
  s_add_u32 m0, s39, 47104
  s_nop 0
  buffer_load_dwordx4 v14, s[12:15], s50 offen lds
  s_add_u32 m0, s39, 48128
  s_nop 0
  buffer_load_dwordx4 v3, s[12:15], s50 offen lds
  s_add_u32 m0, s40, 46080
  s_nop 0
  buffer_load_dwordx4 v4, s[12:15], s50 offen lds
  s_mul_i32 s50, s32, 2
  s_add_i32 s50, s50, s31
  s_add_u32 m0, s39, 30720
  s_nop 0
  buffer_load_dwordx4 v13, s[12:15], s50 offen lds
  s_add_u32 m0, s39, 31744
  s_nop 0
  buffer_load_dwordx4 v14, s[12:15], s50 offen lds
  s_add_u32 m0, s39, 32768
  s_nop 0
  buffer_load_dwordx4 v3, s[12:15], s50 offen lds
  s_add_u32 m0, s40, 30720
  s_nop 0
  buffer_load_dwordx4 v4, s[12:15], s50 offen lds
  s_waitcnt vmcnt(0)
  s_barrier
  s_max_u32 s50, s33, 1
  s_mul_i32 s50, s50, s32
  s_add_i32 s50, s50, s31
  s_add_u32 m0, s39, 15360
  s_nop 0
  buffer_load_dwordx4 v13, s[12:15], s50 offen lds
  s_add_u32 m0, s39, 16384
  s_nop 0
  buffer_load_dwordx4 v14, s[12:15], s50 offen lds
  s_add_u32 m0, s39, 17408
  s_nop 0
  buffer_load_dwordx4 v3, s[12:15], s50 offen lds
  s_add_u32 m0, s40, 15360
  s_nop 0
  buffer_load_dwordx4 v4, s[12:15], s50 offen lds
  s_max_u32 s50, s33, 0
  s_mul_i32 s50, s50, s32
  s_add_i32 s50, s50, s31
  s_add_u32 m0, s39, 0
  s_nop 0
  buffer_load_dwordx4 v13, s[12:15], s50 offen lds
  s_add_u32 m0, s39, 1024
  s_nop 0
  buffer_load_dwordx4 v14, s[12:15], s50 offen lds
  s_add_u32 m0, s39, 2048
  s_nop 0
  buffer_load_dwordx4 v3, s[12:15], s50 offen lds
  s_add_u32 m0, s40, 0
  s_nop 0
  buffer_load_dwordx4 v4, s[12:15], s50 offen lds
  s_branch RM9
RL9:
  s_barrier
RM9:
  ds_read_b128 v[224:227], v20 offset:0
  ds_read_b128 v[228:231], v0 offset:0
  ds_read_b128 v[232:235], v20 offset:128
  ds_read_b128 v[236:239], v0 offset:128
  ds_read_b128 v[240:243], v20 offset:256
  ds_read_b128 v[244:247], v0 offset:256
  ds_read_b128 v[248:251], v7 offset:0
  ds_read_b128 v[252:255], v8 offset:0
  ds_read_b128 v[216:219], v7 offset:128
  ds_read_b128 v[220:223], v8 offset:128
  s_waitcnt lgkmcnt(8)
  v_mfma_f32_16x16x32_bf16 v[24:27], v[224:227], v[88:91], v[24:27]
  ds_read_b128 v[224:227], v7 offset:256
  v_mfma_f32_16x16x32_bf16 v[24:27], v[228:231], v[92:95], v[24:27]
  ds_read_b128 v[228:231], v8 offset:256
  s_waitcnt lgkmcnt(8)
  v_mfma_f32_16x16x32_bf16 v[24:27], v[232:235], v[96:99], v[24:27]
  ds_read_b128 v[232:235], v7 offset:7680
  v_mfma_f32_16x16x32_bf16 v[24:27], v[236:239], v[100:103], v[24:27]
  ds_read_b128 v[236:239], v8 offset:7680
  s_waitcnt lgkmcnt(8)
  v_mfma_f32_16x16x32_bf16 v[24:27], v[240:243], v[104:107], v[24:27]
  ds_read_b128 v[240:243], v7 offset:7808
  v_mfma_f32_16x16x32_bf16 v[24:27], v[244:247], v[108:111], v[24:27]
  ds_read_b128 v[244:247], v8 offset:7808
  s_waitcnt lgkmcnt(8)
  v_mfma_f32_16x16x32_bf16 v[28:31], v[248:251], v[88:91], v[28:31]
  ds_read_b128 v[248:251], v7 offset:7936
  v_mfma_f32_16x16x32_bf16 v[28:31], v[252:255], v[92:95], v[28:31]
  ds_read_b128 v[252:255], v8 offset:7936
  s_waitcnt lgkmcnt(8)
  v_mfma_f32_16x16x32_bf16 v[28:31], v[216:219], v[96:99], v[28:31]
  ds_read_b128 v[216:219], v7 offset:15360
  v_mfma_f32_16x16x32_bf16 v[28:31], v[220:223], v[100:103], v[28:31]
  ds_read_b128 v[220:223], v8 offset:15360
  s_waitcnt lgkmcnt(8)
  v_mfma_f32_16x16x32_bf16 v[28:31], v[224:227], v[104:107], v[28:31]
  ds_read_b128 v[224:227], v7 offset:15488
  v_mfma_f32_16x16x32_bf16 v[28:31], v[228:231], v[108:111], v[28:31]
  ds_read_b128 v[228:231], v8 offset:15488
  s_cbranch_vccnz RL10
  s_barrier
RL10:
  s_waitcnt lgkmcnt(8)
  v_mfma_f32_16x16x32_bf16 v[32:35], v[232:235], v[88:91], v[32:35]
  v_exp_f32 v196, v24
  v_mfma_f32_16x16x32_bf16 v[56:59], v[232:235], v[112:115], v[56:59]
  ds_read_b128 v[232:235], v7 offset:15616
  v_exp_f32 v197, v25
  v_mfma_f32_16x16x32_bf16 v[32:35], v[236:239], v[92:95], v[32:35]
  v_exp_f32 v198, v26
  v_mfma_f32_16x16x32_bf16 v[56:59], v[236:239], v[116:119], v[56:59]
  ds_read_b128 v[236:239], v8 offset:15616
  s_waitcnt lgkmcnt(8)
  v_mfma_f32_16x16x32_bf16 v[32:35], v[240:243], v[96:99], v[32:35]
  v_exp_f32 v199, v27
  v_mfma_f32_16x16x32_bf16 v[56:59], v[240:243], v[120:123], v[56:59]
  ds_read_b128 v[240:243], v7 offset:23040
  v_cvt_pk_bf16_f32 v136, v196, v197
  v_mfma_f32_16x16x32_bf16 v[32:35], v[244:247], v[100:103], v[32:35]
  v_cvt_pk_bf16_f32 v137, v198, v199
  v_mfma_f32_16x16x32_bf16 v[56:59], v[244:247], v[124:127], v[56:59]
  ds_read_b128 v[244:247], v8 offset:23040
  s_waitcnt lgkmcnt(8)
  v_mfma_f32_16x16x32_bf16 v[32:35], v[248:251], v[104:107], v[32:35]
  v_exp_f32 v200, v28
  v_mfma_f32_16x16x32_bf16 v[56:59], v[248:251], v[128:131], v[56:59]
  ds_read_b128 v[248:251], v7 offset:23168
  v_mfma_f32_16x16x32_bf16 v[32:35], v[252:255], v[108:111], v[32:35]
  v_exp_f32 v201, v29
  v_mfma_f32_16x16x32_bf16 v[56:59], v[252:255], v[132:135], v[56:59]
  ds_read_b128 v[252:255], v8 offset:23168
  s_waitcnt lgkmcnt(8)
  v_mfma_f32_16x16x32_bf16 v[36:39], v[216:219], v[88:91], v[36:39]
  v_exp_f32 v202, v30
  v_mfma_f32_16x16x32_bf16 v[60:63], v[216:219], v[112:115], v[60:63]
  ds_read_b128 v[216:219], v7 offset:23296
  v_exp_f32 v203, v31
  v_mfma_f32_16x16x32_bf16 v[36:39], v[220:223], v[92:95], v[36:39]
  v_cvt_pk_bf16_f32 v138, v200, v201
  v_cvt_pk_bf16_f32 v139, v202, v203
  v_mfma_f32_16x16x32_bf16 v[60:63], v[220:223], v[116:119], v[60:63]
  ds_read_b128 v[220:223], v8 offset:23296
  v_exp_f32 v204, v32
  s_waitcnt lgkmcnt(8)
  v_mfma_f32_16x16x32_bf16 v[36:39], v[224:227], v[96:99], v[36:39]
  v_exp_f32 v205, v33
  v_mfma_f32_16x16x32_bf16 v[60:63], v[224:227], v[120:123], v[60:63]
  ds_read_b128 v[224:227], v7 offset:30720
  v_mfma_f32_16x16x32_bf16 v[36:39], v[228:231], v[100:103], v[36:39]
  v_exp_f32 v206, v34
  v_mfma_f32_16x16x32_bf16 v[60:63], v[228:231], v[124:127], v[60:63]
  ds_read_b128 v[228:231], v8 offset:30720
  s_waitcnt lgkmcnt(8)
  v_mfma_f32_16x16x32_bf16 v[36:39], v[232:235], v[104:107], v[36:39]
  v_exp_f32 v207, v35
  v_mfma_f32_16x16x32_bf16 v[60:63], v[232:235], v[128:131], v[60:63]
  ds_read_b128 v[232:235], v7 offset:30848
  v_cvt_pk_bf16_f32 v140, v204, v205
  v_mfma_f32_16x16x32_bf16 v[36:39], v[236:239], v[108:111], v[36:39]
  v_cvt_pk_bf16_f32 v141, v206, v207
  v_mfma_f32_16x16x32_bf16 v[60:63], v[236:239], v[132:135], v[60:63]
  ds_read_b128 v[236:239], v8 offset:30848
  s_waitcnt lgkmcnt(8)
  v_mfma_f32_16x16x32_bf16 v[40:43], v[240:243], v[88:91], v[40:43]
  v_exp_f32 v208, v56
  v_mfma_f32_16x16x32_bf16 v[64:67], v[240:243], v[112:115], v[64:67]
  ds_read_b128 v[240:243], v7 offset:30976
  v_exp_f32 v209, v57
  v_mfma_f32_16x16x32_bf16 v[40:43], v[244:247], v[92:95], v[40:43]
  v_exp_f32 v210, v58
  v_mfma_f32_16x16x32_bf16 v[64:67], v[244:247], v[116:119], v[64:67]
  ds_read_b128 v[244:247], v8 offset:30976
  v_exp_f32 v211, v59
  s_waitcnt lgkmcnt(8)
  v_mfma_f32_16x16x32_bf16 v[40:43], v[248:251], v[96:99], v[40:43]
  v_cvt_pk_bf16_f32 v152, v208, v209
  v_cvt_pk_bf16_f32 v153, v210, v211
  v_mfma_f32_16x16x32_bf16 v[64:67], v[248:251], v[120:123], v[64:67]
  ds_read_b128 v[248:251], v7 offset:38400
  v_exp_f32 v212, v36
  v_mfma_f32_16x16x32_bf16 v[40:43], v[252:255], v[100:103], v[40:43]
  v_exp_f32 v213, v37
  v_mfma_f32_16x16x32_bf16 v[64:67], v[252:255], v[124:127], v[64:67]
  ds_read_b128 v[252:255], v8 offset:38400
  s_waitcnt lgkmcnt(8)
  v_mfma_f32_16x16x32_bf16 v[40:43], v[216:219], v[104:107], v[40:43]
  v_exp_f32 v214, v38
  v_mfma_f32_16x16x32_bf16 v[64:67], v[216:219], v[128:131], v[64:67]
  ds_read_b128 v[216:219], v7 offset:38528
  v_mfma_f32_16x16x32_bf16 v[40:43], v[220:223], v[108:111], v[40:43]
  v_exp_f32 v215, v39
  v_mfma_f32_16x16x32_bf16 v[64:67], v[220:223], v[132:135], v[64:67]
  ds_read_b128 v[220:223], v8 offset:38528
  s_cbranch_vccz RL11
  s_waitcnt vmcnt(0)
  s_barrier
RL11:
  s_waitcnt lgkmcnt(8)
  v_mfma_f32_16x16x32_bf16 v[44:47], v[224:227], v[88:91], v[44:47]
  v_cvt_pk_bf16_f32 v142, v212, v213
  v_cvt_pk_bf16_f32 v143, v214, v215
  v_mfma_f32_16x16x32_bf16 v[68:71], v[224:227], v[112:115], v[68:71]
  ds_read_b128 v[224:227], v7 offset:38656
  v_exp_f32 v196, v60
  v_mfma_f32_16x16x32_bf16 v[44:47], v[228:231], v[92:95], v[44:47]
  v_exp_f32 v197, v61
  v_mfma_f32_16x16x32_bf16 v[68:71], v[228:231], v[116:119], v[68:71]
  ds_read_b128 v[228:231], v8 offset:38656
  v_exp_f32 v198, v62
  s_waitcnt lgkmcnt(8)
  v_mfma_f32_16x16x32_bf16 v[44:47], v[232:235], v[96:99], v[44:47]
  v_exp_f32 v199, v63
  v_mfma_f32_16x16x32_bf16 v[68:71], v[232:235], v[120:123], v[68:71]
  ds_read_b128 v[232:235], v7 offset:46080
  v_cvt_pk_bf16_f32 v154, v196, v197
  v_cvt_pk_bf16_f32 v155, v198, v199
  v_mfma_f32_16x16x32_bf16 v[44:47], v[236:239], v[100:103], v[44:47]
  v_exp_f32 v200, v40
  v_mfma_f32_16x16x32_bf16 v[68:71], v[236:239], v[124:127], v[68:71]
  ds_read_b128 v[236:239], v8 offset:46080
  v_exp_f32 v201, v41
  s_waitcnt lgkmcnt(8)
  v_mfma_f32_16x16x32_bf16 v[44:47], v[240:243], v[104:107], v[44:47]
  v_exp_f32 v202, v42
  v_mfma_f32_16x16x32_bf16 v[68:71], v[240:243], v[128:131], v[68:71]
  ds_read_b128 v[240:243], v7 offset:46208
  v_mfma_f32_16x16x32_bf16 v[44:47], v[244:247], v[108:111], v[44:47]
  v_exp_f32 v203, v43
  v_mfma_f32_16x16x32_bf16 v[68:71], v[244:247], v[132:135], v[68:71]
  ds_read_b128 v[244:247], v8 offset:46208
  s_waitcnt lgkmcnt(8)
  v_mfma_f32_16x16x32_bf16 v[48:51], v[248:251], v[88:91], v[48:51]
  v_cvt_pk_bf16_f32 v144, v200, v201
  v_cvt_pk_bf16_f32 v145, v202, v203
  v_mfma_f32_16x16x32_bf16 v[72:75], v[248:251], v[112:115], v[72:75]
  ds_read_b128 v[248:251], v7 offset:46336
  v_exp_f32 v204, v64
  v_mfma_f32_16x16x32_bf16 v[48:51], v[252:255], v[92:95], v[48:51]
  v_exp_f32 v205, v65
  v_mfma_f32_16x16x32_bf16 v[72:75], v[252:255], v[116:119], v[72:75]
  ds_read_b128 v[252:255], v8 offset:46336
  v_exp_f32 v206, v66
  s_waitcnt lgkmcnt(8)
  v_mfma_f32_16x16x32_bf16 v[48:51], v[216:219], v[96:99], v[48:51]
  v_exp_f32 v207, v67
  v_mfma_f32_16x16x32_bf16 v[72:75], v[216:219], v[120:123], v[72:75]
  ds_read_b128 v[216:219], v7 offset:53760
  v_cvt_pk_bf16_f32 v156, v204, v205
  v_cvt_pk_bf16_f32 v157, v206, v207
  v_mfma_f32_16x16x32_bf16 v[48:51], v[220:223], v[100:103], v[48:51]
  v_exp_f32 v208, v44
  v_mfma_f32_16x16x32_bf16 v[72:75], v[220:223], v[124:127], v[72:75]
  ds_read_b128 v[220:223], v8 offset:53760
  v_exp_f32 v209, v45
  s_waitcnt lgkmcnt(8)
  v_mfma_f32_16x16x32_bf16 v[48:51], v[224:227], v[104:107], v[48:51]
  v_exp_f32 v210, v46
  v_mfma_f32_16x16x32_bf16 v[72:75], v[224:227], v[128:131], v[72:75]
  ds_read_b128 v[224:227], v7 offset:53888
  v_mfma_f32_16x16x32_bf16 v[48:51], v[228:231], v[108:111], v[48:51]
  v_exp_f32 v211, v47
  v_mfma_f32_16x16x32_bf16 v[72:75], v[228:231], v[132:135], v[72:75]
  ds_read_b128 v[228:231], v8 offset:53888
  s_waitcnt lgkmcnt(8)
  v_mfma_f32_16x16x32_bf16 v[52:55], v[232:235], v[88:91], v[52:55]
  v_cvt_pk_bf16_f32 v146, v208, v209
  v_cvt_pk_bf16_f32 v147, v210, v211
  v_mfma_f32_16x16x32_bf16 v[76:79], v[232:235], v[112:115], v[76:79]
  ds_read_b128 v[232:235], v7 offset:54016
  v_exp_f32 v212, v68
  v_mfma_f32_16x16x32_bf16 v[52:55], v[236:239], v[92:95], v[52:55]
  v_exp_f32 v213, v69
  v_mfma_f32_16x16x32_bf16 v[76:79], v[236:239], v[116:119], v[76:79]
  ds_read_b128 v[236:239], v8 offset:54016
  v_exp_f32 v214, v70
  s_waitcnt lgkmcnt(8)
  v_mfma_f32_16x16x32_bf16 v[52:55], v[240:243], v[96:99], v[52:55]
  v_exp_f32 v215, v71
  v_mfma_f32_16x16x32_bf16 v[76:79], v[240:243], v[120:123], v[76:79]
  ds_read_b128 v[240:243], v7 offset:61440
  v_cvt_pk_bf16_f32 v158, v212, v213
  v_cvt_pk_bf16_f32 v159, v214, v215
  v_mfma_f32_16x16x32_bf16 v[52:55], v[244:247], v[100:103], v[52:55]
  v_exp_f32 v196, v48
  v_mfma_f32_16x16x32_bf16 v[76:79], v[244:247], v[124:127], v[76:79]
  ds_read_b128 v[244:247], v8 offset:61440
  v_exp_f32 v197, v49
  s_waitcnt lgkmcnt(8)
  v_mfma_f32_16x16x32_bf16 v[52:55], v[248:251], v[104:107], v[52:55]
  v_exp_f32 v198, v50
  v_mfma_f32_16x16x32_bf16 v[76:79], v[248:251], v[128:131], v[76:79]
  ds_read_b128 v[248:251], v7 offset:61568
  v_mfma_f32_16x16x32_bf16 v[52:55], v[252:255], v[108:111], v[52:55]
  v_exp_f32 v199, v51
  v_mfma_f32_16x16x32_bf16 v[76:79], v[252:255], v[132:135], v[76:79]
  ds_read_b128 v[252:255], v8 offset:61568
  s_waitcnt lgkmcnt(8)
  v_mfma_f32_16x16x32_bf16 v[80:83], v[216:219], v[112:115], v[80:83]
  ds_read_b128 v[216:219], v7 offset:61696
  v_cvt_pk_bf16_f32 v148, v196, v197
  v_cvt_pk_bf16_f32 v149, v198, v199
  v_mfma_f32_16x16x32_bf16 v[80:83], v[220:223], v[116:119], v[80:83]
  ds_read_b128 v[220:223], v8 offset:61696
  v_exp_f32 v200, v72
  s_waitcnt lgkmcnt(8)
  v_mfma_f32_16x16x32_bf16 v[80:83], v[224:227], v[120:123], v[80:83]
  ds_read_b64_tr_b16 v[224:225], v15 offset:0
  ds_read_b64_tr_b16 v[226:227], v9 offset:0
  v_exp_f32 v201, v73
  v_mfma_f32_16x16x32_bf16 v[80:83], v[228:231], v[124:127], v[80:83]
  ds_read_b64_tr_b16 v[228:229], v16 offset:0
  ds_read_b64_tr_b16 v[230:231], v10 offset:0
  v_exp_f32 v202, v74
  s_waitcnt lgkmcnt(10)
  v_mfma_f32_16x16x32_bf16 v[80:83], v[232:235], v[128:131], v[80:83]
  ds_read_b64_tr_b16 v[232:233], v17 offset:0
  ds_read_b64_tr_b16 v[234:235], v11 offset:0
  v_exp_f32 v203, v75
  v_mfma_f32_16x16x32_bf16 v[80:83], v[236:239], v[132:135], v[80:83]
  ds_read_b64_tr_b16 v[236:237], v18 offset:0
  ds_read_b64_tr_b16 v[238:239], v12 offset:0
  v_cvt_pk_bf16_f32 v160, v200, v201
  v_cvt_pk_bf16_f32 v161, v202, v203
  s_waitcnt lgkmcnt(12)
  v_mfma_f32_16x16x32_bf16 v[84:87], v[240:243], v[112:115], v[84:87]
  ds_read_b64_tr_b16 v[240:241], v15 offset:128
  ds_read_b64_tr_b16 v[242:243], v9 offset:128
  v_exp_f32 v204, v52
  v_mfma_f32_16x16x32_bf16 v[84:87], v[244:247], v[116:119], v[84:87]
  v_exp_f32 v205, v53
  s_waitcnt lgkmcnt(12)
  v_mfma_f32_16x16x32_bf16 v[84:87], v[248:251], v[120:123], v[84:87]
  ds_read_b64_tr_b16 v[244:245], v16 offset:128
  ds_read_b64_tr_b16 v[246:247], v10 offset:128
  v_exp_f32 v206, v54
  v_exp_f32 v207, v55
  v_cvt_pk_bf16_f32 v150, v204, v205
  v_cvt_pk_bf16_f32 v151, v206, v207
  v_mfma_f32_16x16x32_bf16 v[184:187], v[192:195], v[136:139], 0
  v_exp_f32 v208, v76
  v_mfma_f32_16x16x32_bf16 v[184:187], v[192:195], v[140:143], v[184:187]
  v_exp_f32 v209, v77
  v_mfma_f32_16x16x32_bf16 v[184:187], v[192:195], v[144:147], v[184:187]
  v_exp_f32 v210, v78
  v_mfma_f32_16x16x32_bf16 v[184:187], v[192:195], v[148:151], v[184:187]
  v_exp_f32 v211, v79
  v_mfma_f32_16x16x32_bf16 v[84:87], v[252:255], v[124:127], v[84:87]
  v_cvt_pk_bf16_f32 v162, v208, v209
  s_waitcnt lgkmcnt(12)
  v_mfma_f32_16x16x32_bf16 v[84:87], v[216:219], v[128:131], v[84:87]
  ds_read_b64_tr_b16 v[248:249], v17 offset:128
  ds_read_b64_tr_b16 v[250:251], v11 offset:128
  v_mfma_f32_16x16x32_bf16 v[84:87], v[220:223], v[132:135], v[84:87]
  v_cvt_pk_bf16_f32 v163, v210, v211
  s_cbranch_vccz RL12
  buffer_load_dword v13, off, s[8:11], 0 sc1
RL12:
  v_subrev_u32 v23, 813694976, v184
  s_mov_b32 s52, 503316480
  v_cmp_gt_u32 s[48:49], s52, v23
  s_or_b64 s[48:49], s[48:49], s[42:43]
  s_cmp_eq_u64 s[48:49], -1
  s_cbranch_scc0 FB0
FBR0:
  s_cbranch_vccnz RL13
  s_barrier
RL13:
  s_waitcnt lgkmcnt(10)
  v_mfma_f32_16x16x32_bf16 v[88:91], v[224:227], v[136:139], 0
  ds_read_b64_tr_b16 v[252:253], v18 offset:128
  ds_read_b64_tr_b16 v[254:255], v12 offset:128
  v_exp_f32 v212, v80
  v_mfma_f32_16x16x32_bf16 v[92:95], v[228:231], v[136:139], 0
  ds_read_b64_tr_b16 v[216:217], v15 offset:256
  ds_read_b64_tr_b16 v[218:219], v9 offset:256
  v_exp_f32 v213, v81
  s_waitcnt lgkmcnt(10)
  v_mfma_f32_16x16x32_bf16 v[96:99], v[232:235], v[136:139], 0
  ds_read_b64_tr_b16 v[220:221], v16 offset:256
  ds_read_b64_tr_b16 v[222:223], v10 offset:256
  v_mfma_f32_16x16x32_bf16 v[100:103], v[236:239], v[136:139], 0
  ds_read_b64_tr_b16 v[224:225], v17 offset:256
  ds_read_b64_tr_b16 v[226:227], v11 offset:256
  s_waitcnt lgkmcnt(10)
  v_mfma_f32_16x16x32_bf16 v[104:107], v[240:243], v[136:139], 0
  ds_read_b64_tr_b16 v[228:229], v18 offset:256
  ds_read_b64_tr_b16 v[230:231], v12 offset:256
  v_mfma_f32_16x16x32_bf16 v[108:111], v[244:247], v[136:139], 0
  ds_read_b64_tr_b16 v[232:233], v9 offset:7680
  ds_read_b64_tr_b16 v[234:235], v9 offset:15360
  s_waitcnt lgkmcnt(10)
  v_mfma_f32_16x16x32_bf16 v[112:115], v[248:251], v[136:139], 0
  ds_read_b64_tr_b16 v[236:237], v10 offset:7680
  ds_read_b64_tr_b16 v[238:239], v10 offset:15360
  v_mfma_f32_16x16x32_bf16 v[116:119], v[252:255], v[136:139], 0
  ds_read_b64_tr_b16 v[240:241], v11 offset:7680
  ds_read_b64_tr_b16 v[242:243], v11 offset:15360
  s_waitcnt lgkmcnt(10)
  v_mfma_f32_16x16x32_bf16 v[120:123], v[216:219], v[136:139], 0
  ds_read_b64_tr_b16 v[244:245], v12 offset:7680
  ds_read_b64_tr_b16 v[246:247], v12 offset:15360
  v_mfma_f32_16x16x32_bf16 v[124:127], v[220:223], v[136:139], 0
  ds_read_b64_tr_b16 v[248:249], v9 offset:7808
  ds_read_b64_tr_b16 v[250:251], v9 offset:15488
  s_waitcnt lgkmcnt(10)
  v_mfma_f32_16x16x32_bf16 v[128:131], v[224:227], v[136:139], 0
  ds_read_b64_tr_b16 v[252:253], v10 offset:7808
  ds_read_b64_tr_b16 v[254:255], v10 offset:15488
  v_mfma_f32_16x16x32_bf16 v[132:135], v[228:231], v[136:139], 0
  ds_read_b64_tr_b16 v[216:217], v11 offset:7808
  ds_read_b64_tr_b16 v[218:219], v11 offset:15488
  v_exp_f32 v214, v82
  v_exp_f32 v215, v83
  v_cvt_pk_bf16_f32 v164, v212, v213
  v_cvt_pk_bf16_f32 v165, v214, v215
  v_exp_f32 v196, v84
  v_exp_f32 v197, v85
  v_exp_f32 v198, v86
  v_exp_f32 v199, v87
  v_cvt_pk_bf16_f32 v166, v196, v197
  v_cvt_pk_bf16_f32 v167, v198, v199
  v_mfma_f32_16x16x32_bf16 v[188:191], v[192:195], v[152:155], 0
  v_mfma_f32_16x16x32_bf16 v[188:191], v[192:195], v[156:159], v[188:191]
  v_mfma_f32_16x16x32_bf16 v[188:191], v[192:195], v[160:163], v[188:191]
  v_mfma_f32_16x16x32_bf16 v[188:191], v[192:195], v[164:167], v[188:191]
  s_nop 7
  v_subrev_u32 v23, 813694976, v188
  s_mov_b32 s52, 503316480
  v_cmp_gt_u32 s[48:49], s52, v23
  s_or_b64 s[48:49], s[48:49], s[44:45]
  s_cmp_eq_u64 s[48:49], -1
  s_cbranch_scc0 FB1
FBR1:
  s_waitcnt lgkmcnt(10)
  v_mfma_f32_16x16x32_bf16 v[88:91], v[232:235], v[140:143], v[88:91]
  ds_read_b64_tr_b16 v[220:221], v12 offset:7808
  ds_read_b64_tr_b16 v[222:223], v12 offset:15488
  v_mfma_f32_16x16x32_bf16 v[24:27], v[232:235], v[152:155], 0
  ds_read_b64_tr_b16 v[224:225], v9 offset:7936
  ds_read_b64_tr_b16 v[226:227], v9 offset:15616
  v_mfma_f32_16x16x32_bf16 v[92:95], v[236:239], v[140:143], v[92:95]
  v_mfma_f32_16x16x32_bf16 v[28:31], v[236:239], v[152:155], 0
  s_waitcnt lgkmcnt(10)
  v_mfma_f32_16x16x32_bf16 v[96:99], v[240:243], v[140:143], v[96:99]
  ds_read_b64_tr_b16 v[228:229], v10 offset:7936
  ds_read_b64_tr_b16 v[230:231], v10 offset:15616
  v_mfma_f32_16x16x32_bf16 v[32:35], v[240:243], v[152:155], 0
  ds_read_b64_tr_b16 v[232:233], v11 offset:7936
  ds_read_b64_tr_b16 v[234:235], v11 offset:15616
  v_mfma_f32_16x16x32_bf16 v[100:103], v[244:247], v[140:143], v[100:103]
  v_mfma_f32_16x16x32_bf16 v[36:39], v[244:247], v[152:155], 0
  s_waitcnt lgkmcnt(10)
  v_mfma_f32_16x16x32_bf16 v[104:107], v[248:251], v[140:143], v[104:107]
  ds_read_b64_tr_b16 v[236:237], v12 offset:7936
  ds_read_b64_tr_b16 v[238:239], v12 offset:15616
  v_mfma_f32_16x16x32_bf16 v[40:43], v[248:251], v[152:155], 0
  ds_read_b64_tr_b16 v[240:241], v9 offset:23040
  ds_read_b64_tr_b16 v[242:243], v9 offset:30720
  v_mfma_f32_16x16x32_bf16 v[108:111], v[252:255], v[140:143], v[108:111]
  v_mfma_f32_16x16x32_bf16 v[44:47], v[252:255], v[152:155], 0
  s_waitcnt lgkmcnt(10)
  v_mfma_f32_16x16x32_bf16 v[112:115], v[216:219], v[140:143], v[112:115]
  ds_read_b64_tr_b16 v[244:245], v10 offset:23040
  ds_read_b64_tr_b16 v[246:247], v10 offset:30720
  v_mfma_f32_16x16x32_bf16 v[48:51], v[216:219], v[152:155], 0
  ds_read_b64_tr_b16 v[248:249], v11 offset:23040
  ds_read_b64_tr_b16 v[250:251], v11 offset:30720
  v_mfma_f32_16x16x32_bf16 v[116:119], v[220:223], v[140:143], v[116:119]
  v_mfma_f32_16x16x32_bf16 v[52:55], v[220:223], v[152:155], 0
  s_waitcnt lgkmcnt(10)
  v_mfma_f32_16x16x32_bf16 v[120:123], v[224:227], v[140:143], v[120:123]
  ds_read_b64_tr_b16 v[252:253], v12 offset:23040
  ds_read_b64_tr_b16 v[254:255], v12 offset:30720
  v_mfma_f32_16x16x32_bf16 v[56:59], v[224:227], v[152:155], 0
  ds_read_b64_tr_b16 v[216:217], v9 offset:23168
  ds_read_b64_tr_b16 v[218:219], v9 offset:30848
  v_mfma_f32_16x16x32_bf16 v[124:127], v[228:231], v[140:143], v[124:127]
  v_mfma_f32_16x16x32_bf16 v[60:63], v[228:231], v[152:155], 0
  s_waitcnt lgkmcnt(10)
  v_mfma_f32_16x16x32_bf16 v[128:131], v[232:235], v[140:143], v[128:131]
  ds_read_b64_tr_b16 v[220:221], v10 offset:23168
  ds_read_b64_tr_b16 v[222:223], v10 offset:30848
  v_mfma_f32_16x16x32_bf16 v[64:67], v[232:235], v[152:155], 0
  ds_read_b64_tr_b16 v[224:225], v11 offset:23168
  ds_read_b64_tr_b16 v[226:227], v11 offset:30848
  v_mfma_f32_16x16x32_bf16 v[132:135], v[236:239], v[140:143], v[132:135]
  v_mfma_f32_16x16x32_bf16 v[68:71], v[236:239], v[152:155], 0
  s_waitcnt lgkmcnt(10)
  v_mfma_f32_16x16x32_bf16 v[88:91], v[240:243], v[144:147], v[88:91]
  ds_read_b64_tr_b16 v[228:229], v12 offset:23168
  ds_read_b64_tr_b16 v[230:231], v12 offset:30848
  v_mfma_f32_16x16x32_bf16 v[24:27], v[240:243], v[156:159], v[24:27]
  ds_read_b64_tr_b16 v[232:233], v9 offset:23296
  ds_read_b64_tr_b16 v[234:235], v9 offset:30976
  v_mfma_f32_16x16x32_bf16 v[92:95], v[244:247], v[144:147], v[92:95]
  v_mfma_f32_16x16x32_bf16 v[28:31], v[244:247], v[156:159], v[28:31]
  s_waitcnt lgkmcnt(10)
  v_mfma_f32_16x16x32_bf16 v[96:99], v[248:251], v[144:147], v[96:99]
  ds_read_b64_tr_b16 v[236:237], v10 offset:23296
  ds_read_b64_tr_b16 v[238:239], v10 offset:30976
  v_mfma_f32_16x16x32_bf16 v[32:35], v[248:251], v[156:159], v[32:35]
  ds_read_b64_tr_b16 v[240:241], v11 offset:23296
  ds_read_b64_tr_b16 v[242:243], v11 offset:30976
  v_mfma_f32_16x16x32_bf16 v[100:103], v[252:255], v[144:147], v[100:103]
  v_mfma_f32_16x16x32_bf16 v[36:39], v[252:255], v[156:159], v[36:39]
  s_waitcnt lgkmcnt(10)
  v_mfma_f32_16x16x32_bf16 v[104:107], v[216:219], v[144:147], v[104:107]
  ds_read_b64_tr_b16 v[244:245], v12 offset:23296
  ds_read_b64_tr_b16 v[246:247], v12 offset:30976
  v_mfma_f32_16x16x32_bf16 v[40:43], v[216:219], v[156:159], v[40:43]
  ds_read_b64_tr_b16 v[248:249], v9 offset:38400
  ds_read_b64_tr_b16 v[250:251], v9 offset:46080
  v_mfma_f32_16x16x32_bf16 v[108:111], v[220:223], v[144:147], v[108:111]
  v_mfma_f32_16x16x32_bf16 v[44:47], v[220:223], v[156:159], v[44:47]
  s_waitcnt lgkmcnt(10)
  v_mfma_f32_16x16x32_bf16 v[112:115], v[224:227], v[144:147], v[112:115]
  ds_read_b64_tr_b16 v[252:253], v10 offset:38400
  ds_read_b64_tr_b16 v[254:255], v10 offset:46080
  v_mfma_f32_16x16x32_bf16 v[48:51], v[224:227], v[156:159], v[48:51]
  ds_read_b64_tr_b16 v[216:217], v11 offset:38400
  ds_read_b64_tr_b16 v[218:219], v11 offset:46080
  v_mfma_f32_16x16x32_bf16 v[116:119], v[228:231], v[144:147], v[116:119]
  v_mfma_f32_16x16x32_bf16 v[52:55], v[228:231], v[156:159], v[52:55]
  s_waitcnt lgkmcnt(10)
  v_mfma_f32_16x16x32_bf16 v[120:123], v[232:235], v[144:147], v[120:123]
  ds_read_b64_tr_b16 v[220:221], v12 offset:38400
  ds_read_b64_tr_b16 v[222:223], v12 offset:46080
  v_mfma_f32_16x16x32_bf16 v[56:59], v[232:235], v[156:159], v[56:59]
  ds_read_b64_tr_b16 v[224:225], v9 offset:38528
  ds_read_b64_tr_b16 v[226:227], v9 offset:46208
  v_mfma_f32_16x16x32_bf16 v[124:127], v[236:239], v[144:147], v[124:127]
  v_mfma_f32_16x16x32_bf16 v[60:63], v[236:239], v[156:159], v[60:63]
  s_waitcnt lgkmcnt(10)
  v_mfma_f32_16x16x32_bf16 v[128:131], v[240:243], v[144:147], v[128:131]
  ds_read_b64_tr_b16 v[228:229], v10 offset:38528
  ds_read_b64_tr_b16 v[230:231], v10 offset:46208
  v_mfma_f32_16x16x32_bf16 v[64:67], v[240:243], v[156:159], v[64:67]
  ds_read_b64_tr_b16 v[232:233], v11 offset:38528
  ds_read_b64_tr_b16 v[234:235], v11 offset:46208
  v_mfma_f32_16x16x32_bf16 v[132:135], v[244:247], v[144:147], v[132:135]
  v_mfma_f32_16x16x32_bf16 v[68:71], v[244:247], v[156:159], v[68:71]
  s_waitcnt lgkmcnt(10)
  v_mfma_f32_16x16x32_bf16 v[88:91], v[248:251], v[148:151], v[88:91]
  ds_read_b64_tr_b16 v[236:237], v12 offset:38528
  ds_read_b64_tr_b16 v[238:239], v12 offset:46208
  v_mfma_f32_16x16x32_bf16 v[24:27], v[248:251], v[160:163], v[24:27]
  ds_read_b64_tr_b16 v[240:241], v9 offset:38656
  ds_read_b64_tr_b16 v[242:243], v9 offset:46336
  v_mfma_f32_16x16x32_bf16 v[92:95], v[252:255], v[148:151], v[92:95]
  v_mfma_f32_16x16x32_bf16 v[28:31], v[252:255], v[160:163], v[28:31]
  s_waitcnt lgkmcnt(10)
  v_mfma_f32_16x16x32_bf16 v[96:99], v[216:219], v[148:151], v[96:99]
  ds_read_b64_tr_b16 v[244:245], v10 offset:38656
  ds_read_b64_tr_b16 v[246:247], v10 offset:46336
  v_mfma_f32_16x16x32_bf16 v[32:35], v[216:219], v[160:163], v[32:35]
  ds_read_b64_tr_b16 v[248:249], v11 offset:38656
  ds_read_b64_tr_b16 v[250:251], v11 offset:46336
  v_mfma_f32_16x16x32_bf16 v[100:103], v[220:223], v[148:151], v[100:103]
  v_mfma_f32_16x16x32_bf16 v[36:39], v[220:223], v[160:163], v[36:39]
  s_waitcnt lgkmcnt(10)
  v_mfma_f32_16x16x32_bf16 v[104:107], v[224:227], v[148:151], v[104:107]
  ds_read_b64_tr_b16 v[252:253], v12 offset:38656
  ds_read_b64_tr_b16 v[254:255], v12 offset:46336
  v_mfma_f32_16x16x32_bf16 v[40:43], v[224:227], v[160:163], v[40:43]
  ds_read_b64_tr_b16 v[216:217], v9 offset:53760
  ds_read_b64_tr_b16 v[218:219], v9 offset:61440
  v_mfma_f32_16x16x32_bf16 v[108:111], v[228:231], v[148:151], v[108:111]
  v_mfma_f32_16x16x32_bf16 v[44:47], v[228:231], v[160:163], v[44:47]
  s_waitcnt lgkmcnt(10)
  v_mfma_f32_16x16x32_bf16 v[112:115], v[232:235], v[148:151], v[112:115]
  ds_read_b64_tr_b16 v[220:221], v10 offset:53760
  ds_read_b64_tr_b16 v[222:223], v10 offset:61440
  v_mfma_f32_16x16x32_bf16 v[48:51], v[232:235], v[160:163], v[48:51]
  ds_read_b64_tr_b16 v[224:225], v11 offset:53760
  ds_read_b64_tr_b16 v[226:227], v11 offset:61440
  v_mfma_f32_16x16x32_bf16 v[116:119], v[236:239], v[148:151], v[116:119]
  v_mfma_f32_16x16x32_bf16 v[52:55], v[236:239], v[160:163], v[52:55]
  s_waitcnt lgkmcnt(10)
  v_mfma_f32_16x16x32_bf16 v[120:123], v[240:243], v[148:151], v[120:123]
  ds_read_b64_tr_b16 v[228:229], v12 offset:53760
  ds_read_b64_tr_b16 v[230:231], v12 offset:61440
  v_mfma_f32_16x16x32_bf16 v[56:59], v[240:243], v[160:163], v[56:59]
  ds_read_b64_tr_b16 v[232:233], v9 offset:53888
  ds_read_b64_tr_b16 v[234:235], v9 offset:61568
  v_mfma_f32_16x16x32_bf16 v[124:127], v[244:247], v[148:151], v[124:127]
  v_mfma_f32_16x16x32_bf16 v[60:63], v[244:247], v[160:163], v[60:63]
  s_waitcnt lgkmcnt(10)
  v_mfma_f32_16x16x32_bf16 v[128:131], v[248:251], v[148:151], v[128:131]
  ds_read_b64_tr_b16 v[236:237], v10 offset:53888
  ds_read_b64_tr_b16 v[238:239], v10 offset:61568
  v_mfma_f32_16x16x32_bf16 v[64:67], v[248:251], v[160:163], v[64:67]
  ds_read_b64_tr_b16 v[240:241], v11 offset:53888
  ds_read_b64_tr_b16 v[242:243], v11 offset:61568
  v_mfma_f32_16x16x32_bf16 v[132:135], v[252:255], v[148:151], v[132:135]
  v_mfma_f32_16x16x32_bf16 v[68:71], v[252:255], v[160:163], v[68:71]
  s_waitcnt lgkmcnt(10)
  v_mfma_f32_16x16x32_bf16 v[24:27], v[216:219], v[164:167], v[24:27]
  ds_read_b64_tr_b16 v[244:245], v12 offset:53888
  ds_read_b64_tr_b16 v[246:247], v12 offset:61568
  v_mfma_f32_16x16x32_bf16 v[28:31], v[220:223], v[164:167], v[28:31]
  ds_read_b64_tr_b16 v[248:249], v9 offset:54016
  ds_read_b64_tr_b16 v[250:251], v9 offset:61696
  s_waitcnt lgkmcnt(10)
  v_mfma_f32_16x16x32_bf16 v[32:35], v[224:227], v[164:167], v[32:35]
  ds_read_b64_tr_b16 v[252:253], v10 offset:54016
  ds_read_b64_tr_b16 v[254:255], v10 offset:61696
  v_mfma_f32_16x16x32_bf16 v[36:39], v[228:231], v[164:167], v[36:39]
  ds_read_b64_tr_b16 v[216:217], v11 offset:54016
  ds_read_b64_tr_b16 v[218:219], v11 offset:61696
  s_waitcnt lgkmcnt(10)
  v_mfma_f32_16x16x32_bf16 v[40:43], v[232:235], v[164:167], v[40:43]
  ds_read_b64_tr_b16 v[220:221], v12 offset:54016
  ds_read_b64_tr_b16 v[222:223], v12 offset:61696
  v_mfma_f32_16x16x32_bf16 v[44:47], v[236:239], v[164:167], v[44:47]
  v_cvt_pk_bf16_f32 v136, v88, v89
  s_waitcnt lgkmcnt(8)
  v_mfma_f32_16x16x32_bf16 v[48:51], v[240:243], v[164:167], v[48:51]
  v_cvt_pk_bf16_f32 v137, v90, v91
  v_cvt_pk_bf16_f32 v138, v92, v93
  v_mfma_f32_16x16x32_bf16 v[52:55], v[244:247], v[164:167], v[52:55]
  v_cvt_pk_bf16_f32 v139, v94, v95
  s_waitcnt lgkmcnt(6)
  v_mfma_f32_16x16x32_bf16 v[56:59], v[248:251], v[164:167], v[56:59]
  v_cvt_pk_bf16_f32 v140, v96, v97
  s_waitcnt lgkmcnt(4)
  v_mfma_f32_16x16x32_bf16 v[60:63], v[252:255], v[164:167], v[60:63]
  v_cvt_pk_bf16_f32 v141, v98, v99
  s_waitcnt lgkmcnt(2)
  v_mfma_f32_16x16x32_bf16 v[64:67], v[216:219], v[164:167], v[64:67]
  v_cvt_pk_bf16_f32 v142, v100, v101
  s_waitcnt lgkmcnt(0)
  v_mfma_f32_16x16x32_bf16 v[68:71], v[220:223], v[164:167], v[68:71]
  v_cvt_pk_bf16_f32 v143, v102, v103
  s_cbranch_vccz RL14
  s_barrier
  s_mov_b32 s53, 0x400000
NPOLL:
  s_waitcnt vmcnt(0)
  v_readfirstlane_b32 s46, v13
  s_sub_u32 s53, s53, 1
  s_cselect_b32 s46, 72, s46
  s_cmp_ge_u32 s46, 72
  s_cbranch_scc1 NPOLLD
  buffer_load_dword v13, off, s[8:11], 0 sc1
  s_branch NPOLL
NPOLLD:
  s_add_u32 m0, s41, 102400
  s_add_u32 s50, s41, 0
  buffer_load_dwordx4 v1, s[20:23], s50 offen sc1 lds
  s_add_u32 m0, s41, 106496
  s_add_u32 s50, s41, 4096
  buffer_load_dwordx4 v1, s[20:23], s50 offen sc1 lds
  s_add_u32 m0, s41, 110592
  s_add_u32 s50, s41, 8192
  buffer_load_dwordx4 v1, s[20:23], s50 offen sc1 lds
  s_add_u32 m0, s41, 114688
  s_add_u32 s50, s41, 12288
  buffer_load_dwordx4 v1, s[20:23], s50 offen sc1 lds
  s_add_u32 m0, s41, 118784
  s_add_u32 s50, s41, 16384
  buffer_load_dwordx4 v1, s[20:23], s50 offen sc1 lds
  s_add_u32 m0, s41, 122880
  s_add_u32 s50, s41, 20480
  buffer_load_dwordx4 v1, s[20:23], s50 offen sc1 lds
  s_add_u32 m0, s41, 126976
  s_add_u32 s50, s41, 24576
  buffer_load_dwordx4 v1, s[20:23], s50 offen sc1 lds
  s_add_u32 m0, s41, 131072
  s_add_u32 s50, s41, 28672
  buffer_load_dwordx4 v1, s[20:23], s50 offen sc1 lds
  s_add_u32 m0, s41, 135168
  s_add_u32 s50, s41, 32768
  buffer_load_dwordx4 v1, s[20:23], s50 offen sc1 lds
  s_add_u32 m0, s41, 139264
  s_add_u32 s50, s41, 36864
  buffer_load_dwordx4 v1, s[20:23], s50 offen sc1 lds
  s_add_u32 m0, s41, 143360
  s_add_u32 s50, s41, 40960
  buffer_load_dwordx4 v1, s[20:23], s50 offen sc1 lds
  s_add_u32 m0, s41, 147456
  s_add_u32 s50, s41, 45056
  buffer_load_dwordx4 v1, s[20:23], s50 offen sc1 lds
  s_add_u32 m0, s41, 151552
  s_add_u32 s50, s41, 49152
  buffer_load_dwordx4 v1, s[20:23], s50 offen sc1 lds
  s_add_u32 m0, s41, 155648
  s_add_u32 s50, s41, 53248
  buffer_load_dwordx4 v1, s[20:23], s50 offen sc1 lds
  s_add_u32 m0, s41, 159744
  s_add_u32 s50, s41, 57344
  buffer_load_dwordx4 v1, s[20:23], s50 offen sc1 lds
  s_add_u32 m0, s41, 0
  s_add_u32 s50, s41, 61440
  buffer_load_dwordx4 v1, s[20:23], s50 offen sc1 lds
  s_add_u32 m0, s41, 4096
  s_add_u32 s50, s41, 65536
  buffer_load_dwordx4 v1, s[20:23], s50 offen sc1 lds
  s_min_u32 s51, s41, 1024
  s_add_u32 m0, s51, 8192
  s_add_u32 s50, s51, 69632
  buffer_load_dwordx4 v1, s[20:23], s50 offen sc1 lds
RL14:
  v_cvt_pk_bf16_f32 v144, v104, v105
  v_cvt_pk_bf16_f32 v145, v106, v107
  v_cvt_pk_bf16_f32 v146, v108, v109
  v_cvt_pk_bf16_f32 v147, v110, v111
  v_cvt_pk_bf16_f32 v148, v112, v113
  v_cvt_pk_bf16_f32 v149, v114, v115
  v_cvt_pk_bf16_f32 v150, v116, v117
  v_cvt_pk_bf16_f32 v151, v118, v119
  v_cvt_pk_bf16_f32 v168, v120, v121
  v_cvt_pk_bf16_f32 v169, v122, v123
  v_cvt_pk_bf16_f32 v170, v124, v125
  v_cvt_pk_bf16_f32 v171, v126, v127
  v_cvt_pk_bf16_f32 v172, v128, v129
  v_cvt_pk_bf16_f32 v173, v130, v131
  v_cvt_pk_bf16_f32 v174, v132, v133
  v_cvt_pk_bf16_f32 v175, v134, v135
  v_cvt_pk_bf16_f32 v152, v24, v25
  v_cvt_pk_bf16_f32 v153, v26, v27
  v_cvt_pk_bf16_f32 v154, v28, v29
  v_cvt_pk_bf16_f32 v155, v30, v31
  v_cvt_pk_bf16_f32 v156, v32, v33
  v_cvt_pk_bf16_f32 v157, v34, v35
  v_cvt_pk_bf16_f32 v158, v36, v37
  v_cvt_pk_bf16_f32 v159, v38, v39
  v_cvt_pk_bf16_f32 v160, v40, v41
  v_cvt_pk_bf16_f32 v161, v42, v43
  v_cvt_pk_bf16_f32 v162, v44, v45
  v_cvt_pk_bf16_f32 v163, v46, v47
  v_cvt_pk_bf16_f32 v164, v48, v49
  v_cvt_pk_bf16_f32 v165, v50, v51
  v_cvt_pk_bf16_f32 v166, v52, v53
  v_cvt_pk_bf16_f32 v167, v54, v55
  v_cvt_pk_bf16_f32 v176, v56, v57
  v_cvt_pk_bf16_f32 v177, v58, v59
  v_cvt_pk_bf16_f32 v178, v60, v61
  v_cvt_pk_bf16_f32 v179, v62, v63
  v_cvt_pk_bf16_f32 v180, v64, v65
  v_cvt_pk_bf16_f32 v181, v66, v67
  v_cvt_pk_bf16_f32 v182, v68, v69
  v_cvt_pk_bf16_f32 v183, v70, v71
  v_rcp_f32 v22, v184
  v_rcp_f32 v23, v188
  s_cbranch_vccz RL15
  s_waitcnt vmcnt(0)
  s_barrier
RL15:
  s_mov_b32 s50, 71680
  buffer_load_dwordx4 v[40:43], v1, s[20:23], s50 offen offset:0 sc1
  buffer_load_dwordx4 v[44:47], v1, s[20:23], s50 offen offset:1024 sc1
  ds_read_b128 v[224:227], v2 offset:0
  ds_read_b128 v[228:231], v2 offset:1024
  ds_read_b128 v[232:235], v2 offset:2048
  ds_read_b128 v[236:239], v2 offset:3072
  ds_read_b128 v[240:243], v2 offset:4096
  ds_read_b128 v[244:247], v2 offset:5120
  ds_read_b128 v[248:251], v2 offset:6144
  ds_read_b128 v[252:255], v2 offset:7168
  ds_read_b128 v[216:219], v2 offset:8192
  ds_read_b128 v[220:223], v2 offset:9216
  s_waitcnt lgkmcnt(8)
  v_mfma_f32_16x16x32_bf16 v[184:187], v[224:227], v[136:139], 0
  v_mfma_f32_16x16x32_bf16 v[192:195], v[224:227], v[152:155], 0
  ds_read_b128 v[224:227], v2 offset:10240
  v_mfma_f32_16x16x32_bf16 v[188:191], v[228:231], v[136:139], 0
  v_mfma_f32_16x16x32_bf16 v[196:199], v[228:231], v[152:155], 0
  ds_read_b128 v[228:231], v2 offset:11264
  s_waitcnt lgkmcnt(8)
  v_mfma_f32_16x16x32_bf16 v[184:187], v[232:235], v[140:143], v[184:187]
  v_mfma_f32_16x16x32_bf16 v[192:195], v[232:235], v[156:159], v[192:195]
  ds_read_b128 v[232:235], v2 offset:12288
  v_mfma_f32_16x16x32_bf16 v[188:191], v[236:239], v[140:143], v[188:191]
  v_mfma_f32_16x16x32_bf16 v[196:199], v[236:239], v[156:159], v[196:199]
  ds_read_b128 v[236:239], v2 offset:13312
  s_waitcnt lgkmcnt(8)
  v_mfma_f32_16x16x32_bf16 v[184:187], v[240:243], v[144:147], v[184:187]
  v_mfma_f32_16x16x32_bf16 v[192:195], v[240:243], v[160:163], v[192:195]
  ds_read_b128 v[240:243], v2 offset:14336
  v_mfma_f32_16x16x32_bf16 v[188:191], v[244:247], v[144:147], v[188:191]
  v_mfma_f32_16x16x32_bf16 v[196:199], v[244:247], v[160:163], v[196:199]
  ds_read_b128 v[244:247], v2 offset:15360
  s_waitcnt lgkmcnt(8)
  v_mfma_f32_16x16x32_bf16 v[184:187], v[248:251], v[148:151], v[184:187]
  v_mfma_f32_16x16x32_bf16 v[192:195], v[248:251], v[164:167], v[192:195]
  ds_read_b128 v[248:251], v2 offset:16384
  v_mfma_f32_16x16x32_bf16 v[188:191], v[252:255], v[148:151], v[188:191]
  v_mfma_f32_16x16x32_bf16 v[196:199], v[252:255], v[164:167], v[196:199]
  ds_read_b128 v[252:255], v2 offset:17408
  s_waitcnt lgkmcnt(8)
  v_mfma_f32_16x16x32_bf16 v[184:187], v[216:219], v[168:171], v[184:187]
  v_mfma_f32_16x16x32_bf16 v[192:195], v[216:219], v[176:179], v[192:195]
  ds_read_b128 v[216:219], v2 offset:18432
  v_mfma_f32_16x16x32_bf16 v[188:191], v[220:223], v[168:171], v[188:191]
  v_mfma_f32_16x16x32_bf16 v[196:199], v[220:223], v[176:179], v[196:199]
  ds_read_b128 v[220:223], v2 offset:19456
  s_waitcnt lgkmcnt(8)
  v_mfma_f32_16x16x32_bf16 v[184:187], v[224:227], v[172:175], v[184:187]
  v_mfma_f32_16x16x32_bf16 v[192:195], v[224:227], v[180:183], v[192:195]
  ds_read_b128 v[224:227], v2 offset:20480
  v_mfma_f32_16x16x32_bf16 v[188:191], v[228:231], v[172:175], v[188:191]
  v_mfma_f32_16x16x32_bf16 v[196:199], v[228:231], v[180:183], v[196:199]
  ds_read_b128 v[228:231], v2 offset:21504
  s_waitcnt lgkmcnt(8)
  v_mfma_f32_16x16x32_bf16 v[200:203], v[232:235], v[136:139], 0
  v_mfma_f32_16x16x32_bf16 v[208:211], v[232:235], v[152:155], 0
  ds_read_b128 v[232:235], v2 offset:22528
  v_mul_f32 v184, v184, v22
  v_mfma_f32_16x16x32_bf16 v[204:207], v[236:239], v[136:139], 0
  v_mul_f32 v185, v185, v22
  v_mul_f32 v186, v186, v22
  v_mfma_f32_16x16x32_bf16 v[212:215], v[236:239], v[152:155], 0
  ds_read_b128 v[236:239], v2 offset:23552
  s_waitcnt lgkmcnt(8)
  v_mfma_f32_16x16x32_bf16 v[200:203], v[240:243], v[140:143], v[200:203]
  v_mul_f32 v187, v187, v22
  v_mul_f32 v188, v188, v22
  v_mfma_f32_16x16x32_bf16 v[208:211], v[240:243], v[156:159], v[208:211]
  ds_read_b128 v[240:243], v2 offset:24576
  v_mul_f32 v189, v189, v22
  v_mfma_f32_16x16x32_bf16 v[204:207], v[244:247], v[140:143], v[204:207]
  v_mul_f32 v190, v190, v22
  v_mul_f32 v191, v191, v22
  v_mfma_f32_16x16x32_bf16 v[212:215], v[244:247], v[156:159], v[212:215]
  ds_read_b128 v[244:247], v2 offset:25600
  s_waitcnt lgkmcnt(8)
  v_mfma_f32_16x16x32_bf16 v[200:203], v[248:251], v[144:147], v[200:203]
  v_cvt_pk_bf16_f32 v24, v184, v185
  v_cvt_pk_bf16_f32 v25, v186, v187
  v_mfma_f32_16x16x32_bf16 v[208:211], v[248:251], v[160:163], v[208:211]
  ds_read_b128 v[248:251], v2 offset:26624
  v_cvt_pk_bf16_f32 v26, v188, v189
  v_mfma_f32_16x16x32_bf16 v[204:207], v[252:255], v[144:147], v[204:207]
  v_cvt_pk_bf16_f32 v27, v190, v191
  buffer_store_dwordx4 v[24:27], v5, s[16:19], 0 offen offset:0 nt sc1
  v_mfma_f32_16x16x32_bf16 v[212:215], v[252:255], v[160:163], v[212:215]
  ds_read_b128 v[252:255], v2 offset:27648
  s_waitcnt lgkmcnt(8)
  v_mfma_f32_16x16x32_bf16 v[200:203], v[216:219], v[148:151], v[200:203]
  v_mul_f32 v192, v192, v23
  v_mul_f32 v193, v193, v23
  v_mfma_f32_16x16x32_bf16 v[208:211], v[216:219], v[164:167], v[208:211]
  ds_read_b128 v[216:219], v2 offset:28672
  v_mul_f32 v194, v194, v23
  v_mfma_f32_16x16x32_bf16 v[204:207], v[220:223], v[148:151], v[204:207]
  v_mul_f32 v195, v195, v23
  v_mul_f32 v196, v196, v23
  v_mfma_f32_16x16x32_bf16 v[212:215], v[220:223], v[164:167], v[212:215]
  ds_read_b128 v[220:223], v2 offset:29696
  s_waitcnt lgkmcnt(8)
  v_mfma_f32_16x16x32_bf16 v[200:203], v[224:227], v[168:171], v[200:203]
  v_mul_f32 v197, v197, v23
  v_mul_f32 v198, v198, v23
  v_mfma_f32_16x16x32_bf16 v[208:211], v[224:227], v[176:179], v[208:211]
  ds_read_b128 v[224:227], v2 offset:30720
  v_mul_f32 v199, v199, v23
  v_mfma_f32_16x16x32_bf16 v[204:207], v[228:231], v[168:171], v[204:207]
  v_cvt_pk_bf16_f32 v28, v192, v193
  v_cvt_pk_bf16_f32 v29, v194, v195
  v_mfma_f32_16x16x32_bf16 v[212:215], v[228:231], v[176:179], v[212:215]
  ds_read_b128 v[228:231], v2 offset:31744
  s_waitcnt lgkmcnt(8)
  v_mfma_f32_16x16x32_bf16 v[200:203], v[232:235], v[172:175], v[200:203]
  v_cvt_pk_bf16_f32 v30, v196, v197
  v_cvt_pk_bf16_f32 v31, v198, v199
  v_mfma_f32_16x16x32_bf16 v[208:211], v[232:235], v[180:183], v[208:211]
  ds_read_b128 v[232:235], v2 offset:32768
  buffer_store_dwordx4 v[28:31], v6, s[16:19], 0 offen offset:0 nt sc1
  v_mfma_f32_16x16x32_bf16 v[204:207], v[236:239], v[172:175], v[204:207]
  v_mfma_f32_16x16x32_bf16 v[212:215], v[236:239], v[180:183], v[212:215]
  ds_read_b128 v[236:239], v2 offset:33792
  s_waitcnt lgkmcnt(8)
  v_mfma_f32_16x16x32_bf16 v[184:187], v[240:243], v[136:139], 0
  v_mul_f32 v200, v200, v22
  v_mul_f32 v201, v201, v22
  v_mfma_f32_16x16x32_bf16 v[192:195], v[240:243], v[152:155], 0
  ds_read_b128 v[240:243], v2 offset:34816
  v_mul_f32 v202, v202, v22
  v_mfma_f32_16x16x32_bf16 v[188:191], v[244:247], v[136:139], 0
  v_mul_f32 v203, v203, v22
  v_mul_f32 v204, v204, v22
  v_mfma_f32_16x16x32_bf16 v[196:199], v[244:247], v[152:155], 0
  ds_read_b128 v[244:247], v2 offset:35840
  s_waitcnt lgkmcnt(8)
  v_mfma_f32_16x16x32_bf16 v[184:187], v[248:251], v[140:143], v[184:187]
  v_mul_f32 v205, v205, v22
  v_mul_f32 v206, v206, v22
  v_mfma_f32_16x16x32_bf16 v[192:195], v[248:251], v[156:159], v[192:195]
  ds_read_b128 v[248:251], v2 offset:36864
  v_mul_f32 v207, v207, v22
  v_mfma_f32_16x16x32_bf16 v[188:191], v[252:255], v[140:143], v[188:191]
  v_cvt_pk_bf16_f32 v32, v200, v201
  v_cvt_pk_bf16_f32 v33, v202, v203
  v_mfma_f32_16x16x32_bf16 v[196:199], v[252:255], v[156:159], v[196:199]
  ds_read_b128 v[252:255], v2 offset:37888
  s_waitcnt lgkmcnt(8)
  v_mfma_f32_16x16x32_bf16 v[184:187], v[216:219], v[144:147], v[184:187]
  v_cvt_pk_bf16_f32 v34, v204, v205
  v_cvt_pk_bf16_f32 v35, v206, v207
  v_mfma_f32_16x16x32_bf16 v[192:195], v[216:219], v[160:163], v[192:195]
  ds_read_b128 v[216:219], v2 offset:38912
  buffer_store_dwordx4 v[32:35], v5, s[16:19], 0 offen offset:64 nt sc1
  v_mfma_f32_16x16x32_bf16 v[188:191], v[220:223], v[144:147], v[188:191]
  v_mul_f32 v208, v208, v23
  v_mul_f32 v209, v209, v23
  v_mfma_f32_16x16x32_bf16 v[196:199], v[220:223], v[160:163], v[196:199]
  ds_read_b128 v[220:223], v2 offset:39936
  s_waitcnt lgkmcnt(8)
  v_mfma_f32_16x16x32_bf16 v[184:187], v[224:227], v[148:151], v[184:187]
  v_mul_f32 v210, v210, v23
  v_mul_f32 v211, v211, v23
  v_mfma_f32_16x16x32_bf16 v[192:195], v[224:227], v[164:167], v[192:195]
  ds_read_b128 v[224:227], v2 offset:40960
  v_mul_f32 v212, v212, v23
  v_mfma_f32_16x16x32_bf16 v[188:191], v[228:231], v[148:151], v[188:191]
  v_mul_f32 v213, v213, v23
  v_mul_f32 v214, v214, v23
  v_mfma_f32_16x16x32_bf16 v[196:199], v[228:231], v[164:167], v[196:199]
  ds_read_b128 v[228:231], v2 offset:41984
  s_waitcnt lgkmcnt(8)
  v_mfma_f32_16x16x32_bf16 v[184:187], v[232:235], v[168:171], v[184:187]
  v_mul_f32 v215, v215, v23
  v_cvt_pk_bf16_f32 v36, v208, v209
  v_mfma_f32_16x16x32_bf16 v[192:195], v[232:235], v[176:179], v[192:195]
  ds_read_b128 v[232:235], v2 offset:43008
  v_cvt_pk_bf16_f32 v37, v210, v211
  v_mfma_f32_16x16x32_bf16 v[188:191], v[236:239], v[168:171], v[188:191]
  v_cvt_pk_bf16_f32 v38, v212, v213
  v_cvt_pk_bf16_f32 v39, v214, v215
  v_mfma_f32_16x16x32_bf16 v[196:199], v[236:239], v[176:179], v[196:199]
  ds_read_b128 v[236:239], v2 offset:44032
  s_waitcnt lgkmcnt(8)
  v_mfma_f32_16x16x32_bf16 v[184:187], v[240:243], v[172:175], v[184:187]
  buffer_store_dwordx4 v[36:39], v6, s[16:19], 0 offen offset:64 nt sc1
  v_mfma_f32_16x16x32_bf16 v[192:195], v[240:243], v[180:183], v[192:195]
  ds_read_b128 v[240:243], v2 offset:45056
  v_mfma_f32_16x16x32_bf16 v[188:191], v[244:247], v[172:175], v[188:191]
  v_mfma_f32_16x16x32_bf16 v[196:199], v[244:247], v[180:183], v[196:199]
  ds_read_b128 v[244:247], v2 offset:46080
  s_waitcnt lgkmcnt(8)
  v_mfma_f32_16x16x32_bf16 v[200:203], v[248:251], v[136:139], 0
  v_mul_f32 v184, v184, v22
  v_mul_f32 v185, v185, v22
  v_mfma_f32_16x16x32_bf16 v[208:211], v[248:251], v[152:155], 0
  ds_read_b128 v[248:251], v2 offset:47104
  v_mul_f32 v186, v186, v22
  v_mfma_f32_16x16x32_bf16 v[204:207], v[252:255], v[136:139], 0
  v_mul_f32 v187, v187, v22
  v_mul_f32 v188, v188, v22
  v_mfma_f32_16x16x32_bf16 v[212:215], v[252:255], v[152:155], 0
  ds_read_b128 v[252:255], v2 offset:48128
  s_waitcnt lgkmcnt(8)
  v_mfma_f32_16x16x32_bf16 v[200:203], v[216:219], v[140:143], v[200:203]
  v_mul_f32 v189, v189, v22
  v_mul_f32 v190, v190, v22
  v_mfma_f32_16x16x32_bf16 v[208:211], v[216:219], v[156:159], v[208:211]
  ds_read_b128 v[216:219], v2 offset:49152
  v_mul_f32 v191, v191, v22
  v_mfma_f32_16x16x32_bf16 v[204:207], v[220:223], v[140:143], v[204:207]
  v_cvt_pk_bf16_f32 v24, v184, v185
  v_cvt_pk_bf16_f32 v25, v186, v187
  v_mfma_f32_16x16x32_bf16 v[212:215], v[220:223], v[156:159], v[212:215]
  ds_read_b128 v[220:223], v2 offset:50176
  s_waitcnt lgkmcnt(8)
  v_mfma_f32_16x16x32_bf16 v[200:203], v[224:227], v[144:147], v[200:203]
  v_cvt_pk_bf16_f32 v26, v188, v189
  v_cvt_pk_bf16_f32 v27, v190, v191
  v_mfma_f32_16x16x32_bf16 v[208:211], v[224:227], v[160:163], v[208:211]
  ds_read_b128 v[224:227], v2 offset:51200
  buffer_store_dwordx4 v[24:27], v5, s[16:19], 0 offen offset:128 nt sc1
  v_mfma_f32_16x16x32_bf16 v[204:207], v[228:231], v[144:147], v[204:207]
  v_mul_f32 v192, v192, v23
  v_mul_f32 v193, v193, v23
  v_mfma_f32_16x16x32_bf16 v[212:215], v[228:231], v[160:163], v[212:215]
  ds_read_b128 v[228:231], v2 offset:52224
  s_waitcnt lgkmcnt(8)
  v_mfma_f32_16x16x32_bf16 v[200:203], v[232:235], v[148:151], v[200:203]
  v_mul_f32 v194, v194, v23
  v_mul_f32 v195, v195, v23
  v_mfma_f32_16x16x32_bf16 v[208:211], v[232:235], v[164:167], v[208:211]
  ds_read_b128 v[232:235], v2 offset:53248
  v_mul_f32 v196, v196, v23
  v_mfma_f32_16x16x32_bf16 v[204:207], v[236:239], v[148:151], v[204:207]
  v_mul_f32 v197, v197, v23
  v_mul_f32 v198, v198, v23
  v_mfma_f32_16x16x32_bf16 v[212:215], v[236:239], v[164:167], v[212:215]
  ds_read_b128 v[236:239], v2 offset:54272
  s_waitcnt lgkmcnt(8)
  v_mfma_f32_16x16x32_bf16 v[200:203], v[240:243], v[168:171], v[200:203]
  v_mul_f32 v199, v199, v23
  v_cvt_pk_bf16_f32 v28, v192, v193
  v_mfma_f32_16x16x32_bf16 v[208:211], v[240:243], v[176:179], v[208:211]
  ds_read_b128 v[240:243], v2 offset:55296
  v_cvt_pk_bf16_f32 v29, v194, v195
  v_mfma_f32_16x16x32_bf16 v[204:207], v[244:247], v[168:171], v[204:207]
  v_cvt_pk_bf16_f32 v30, v196, v197
  v_cvt_pk_bf16_f32 v31, v198, v199
  v_mfma_f32_16x16x32_bf16 v[212:215], v[244:247], v[176:179], v[212:215]
  ds_read_b128 v[244:247], v2 offset:56320
  s_waitcnt lgkmcnt(8)
  v_mfma_f32_16x16x32_bf16 v[200:203], v[248:251], v[172:175], v[200:203]
  buffer_store_dwordx4 v[28:31], v6, s[16:19], 0 offen offset:128 nt sc1
  v_mfma_f32_16x16x32_bf16 v[208:211], v[248:251], v[180:183], v[208:211]
  ds_read_b128 v[248:251], v2 offset:57344
  v_mfma_f32_16x16x32_bf16 v[204:207], v[252:255], v[172:175], v[204:207]
  v_mfma_f32_16x16x32_bf16 v[212:215], v[252:255], v[180:183], v[212:215]
  ds_read_b128 v[252:255], v2 offset:58368
  s_waitcnt lgkmcnt(8)
  v_mfma_f32_16x16x32_bf16 v[184:187], v[216:219], v[136:139], 0
  v_mul_f32 v200, v200, v22
  v_mul_f32 v201, v201, v22
  v_mfma_f32_16x16x32_bf16 v[192:195], v[216:219], v[152:155], 0
  ds_read_b128 v[216:219], v2 offset:59392
  v_mul_f32 v202, v202, v22
  v_mfma_f32_16x16x32_bf16 v[188:191], v[220:223], v[136:139], 0
  v_mul_f32 v203, v203, v22
  v_mul_f32 v204, v204, v22
  v_mfma_f32_16x16x32_bf16 v[196:199], v[220:223], v[152:155], 0
  ds_read_b128 v[220:223], v2 offset:60416
  s_waitcnt lgkmcnt(8)
  v_mfma_f32_16x16x32_bf16 v[184:187], v[224:227], v[140:143], v[184:187]
  v_mul_f32 v205, v205, v22
  v_mul_f32 v206, v206, v22
  v_mfma_f32_16x16x32_bf16 v[192:195], v[224:227], v[156:159], v[192:195]
  ds_read_b128 v[224:227], v1 offset:0
  v_mul_f32 v207, v207, v22
  v_mfma_f32_16x16x32_bf16 v[188:191], v[228:231], v[140:143], v[188:191]
  v_cvt_pk_bf16_f32 v32, v200, v201
  v_cvt_pk_bf16_f32 v33, v202, v203
  v_mfma_f32_16x16x32_bf16 v[196:199], v[228:231], v[156:159], v[196:199]
  ds_read_b128 v[228:231], v1 offset:1024
  s_waitcnt lgkmcnt(8)
  v_mfma_f32_16x16x32_bf16 v[184:187], v[232:235], v[144:147], v[184:187]
  v_cvt_pk_bf16_f32 v34, v204, v205
  v_cvt_pk_bf16_f32 v35, v206, v207
  v_mfma_f32_16x16x32_bf16 v[192:195], v[232:235], v[160:163], v[192:195]
  ds_read_b128 v[232:235], v1 offset:2048
  buffer_store_dwordx4 v[32:35], v5, s[16:19], 0 offen offset:192 nt sc1
  v_mfma_f32_16x16x32_bf16 v[188:191], v[236:239], v[144:147], v[188:191]
  v_mul_f32 v208, v208, v23
  v_mul_f32 v209, v209, v23
  v_mfma_f32_16x16x32_bf16 v[196:199], v[236:239], v[160:163], v[196:199]
  ds_read_b128 v[236:239], v1 offset:3072
  s_waitcnt lgkmcnt(8)
  v_mfma_f32_16x16x32_bf16 v[184:187], v[240:243], v[148:151], v[184:187]
  v_mul_f32 v210, v210, v23
  v_mul_f32 v211, v211, v23
  v_mfma_f32_16x16x32_bf16 v[192:195], v[240:243], v[164:167], v[192:195]
  ds_read_b128 v[240:243], v1 offset:4096
  v_mul_f32 v212, v212, v23
  v_mfma_f32_16x16x32_bf16 v[188:191], v[244:247], v[148:151], v[188:191]
  v_mul_f32 v213, v213, v23
  v_mul_f32 v214, v214, v23
  v_mfma_f32_16x16x32_bf16 v[196:199], v[244:247], v[164:167], v[196:199]
  ds_read_b128 v[244:247], v1 offset:5120
  s_waitcnt lgkmcnt(8)
  v_mfma_f32_16x16x32_bf16 v[184:187], v[248:251], v[168:171], v[184:187]
  v_mul_f32 v215, v215, v23
  v_cvt_pk_bf16_f32 v36, v208, v209
  v_mfma_f32_16x16x32_bf16 v[192:195], v[248:251], v[176:179], v[192:195]
  ds_read_b128 v[248:251], v1 offset:6144
  v_cvt_pk_bf16_f32 v37, v210, v211
  v_mfma_f32_16x16x32_bf16 v[188:191], v[252:255], v[168:171], v[188:191]
  v_cvt_pk_bf16_f32 v38, v212, v213
  v_cvt_pk_bf16_f32 v39, v214, v215
  v_mfma_f32_16x16x32_bf16 v[196:199], v[252:255], v[176:179], v[196:199]
  ds_read_b128 v[252:255], v1 offset:7168
  s_waitcnt lgkmcnt(8)
  v_mfma_f32_16x16x32_bf16 v[184:187], v[216:219], v[172:175], v[184:187]
  buffer_store_dwordx4 v[36:39], v6, s[16:19], 0 offen offset:192 nt sc1
  v_mfma_f32_16x16x32_bf16 v[192:195], v[216:219], v[180:183], v[192:195]
  ds_read_b128 v[216:219], v1 offset:8192
  v_mfma_f32_16x16x32_bf16 v[188:191], v[220:223], v[172:175], v[188:191]
  v_mfma_f32_16x16x32_bf16 v[196:199], v[220:223], v[180:183], v[196:199]
  ds_read_b128 v[220:223], v1 offset:9216
  s_waitcnt vmcnt(8)
  s_waitcnt lgkmcnt(8)
  v_mfma_f32_16x16x32_bf16 v[200:203], v[224:227], v[136:139], 0
  v_mul_f32 v184, v184, v22
  v_mul_f32 v185, v185, v22
  v_mfma_f32_16x16x32_bf16 v[208:211], v[224:227], v[152:155], 0
  v_mul_f32 v186, v186, v22
  v_mul_f32 v187, v187, v22
  v_mfma_f32_16x16x32_bf16 v[204:207], v[228:231], v[136:139], 0
  v_mul_f32 v188, v188, v22
  v_mul_f32 v189, v189, v22
  v_mfma_f32_16x16x32_bf16 v[212:215], v[228:231], v[152:155], 0
  v_mul_f32 v190, v190, v22
  s_waitcnt lgkmcnt(6)
  v_mfma_f32_16x16x32_bf16 v[200:203], v[232:235], v[140:143], v[200:203]
  v_mul_f32 v191, v191, v22
  v_cvt_pk_bf16_f32 v24, v184, v185
  v_mfma_f32_16x16x32_bf16 v[208:211], v[232:235], v[156:159], v[208:211]
  v_cvt_pk_bf16_f32 v25, v186, v187
  v_cvt_pk_bf16_f32 v26, v188, v189
  v_mfma_f32_16x16x32_bf16 v[204:207], v[236:239], v[140:143], v[204:207]
  v_cvt_pk_bf16_f32 v27, v190, v191
  buffer_store_dwordx4 v[24:27], v5, s[16:19], 0 offen offset:256 nt sc1
  v_mfma_f32_16x16x32_bf16 v[212:215], v[236:239], v[156:159], v[212:215]
  v_mul_f32 v192, v192, v23
  s_waitcnt lgkmcnt(5)
  v_mfma_f32_16x16x32_bf16 v[200:203], v[240:243], v[144:147], v[200:203]
  v_mul_f32 v193, v193, v23
  v_mul_f32 v194, v194, v23
  v_mfma_f32_16x16x32_bf16 v[208:211], v[240:243], v[160:163], v[208:211]
  v_mul_f32 v195, v195, v23
  s_waitcnt lgkmcnt(4)
  v_mfma_f32_16x16x32_bf16 v[204:207], v[244:247], v[144:147], v[204:207]
  v_mul_f32 v196, v196, v23
  v_mul_f32 v197, v197, v23
  v_mfma_f32_16x16x32_bf16 v[212:215], v[244:247], v[160:163], v[212:215]
  v_mul_f32 v198, v198, v23
  s_waitcnt lgkmcnt(3)
  v_mfma_f32_16x16x32_bf16 v[200:203], v[248:251], v[148:151], v[200:203]
  v_mul_f32 v199, v199, v23
  v_cvt_pk_bf16_f32 v28, v192, v193
  v_mfma_f32_16x16x32_bf16 v[208:211], v[248:251], v[164:167], v[208:211]
  v_cvt_pk_bf16_f32 v29, v194, v195
  s_waitcnt lgkmcnt(2)
  v_mfma_f32_16x16x32_bf16 v[204:207], v[252:255], v[148:151], v[204:207]
  v_cvt_pk_bf16_f32 v30, v196, v197
  v_cvt_pk_bf16_f32 v31, v198, v199
  v_mfma_f32_16x16x32_bf16 v[212:215], v[252:255], v[164:167], v[212:215]
  buffer_store_dwordx4 v[28:31], v6, s[16:19], 0 offen offset:256 nt sc1
  s_waitcnt lgkmcnt(1)
  v_mfma_f32_16x16x32_bf16 v[200:203], v[216:219], v[168:171], v[200:203]
  v_mfma_f32_16x16x32_bf16 v[208:211], v[216:219], v[176:179], v[208:211]
  s_waitcnt lgkmcnt(0)
  v_mfma_f32_16x16x32_bf16 v[204:207], v[220:223], v[168:171], v[204:207]
  v_mfma_f32_16x16x32_bf16 v[212:215], v[220:223], v[176:179], v[212:215]
  v_mfma_f32_16x16x32_bf16 v[200:203], v[40:43], v[172:175], v[200:203]
  v_mfma_f32_16x16x32_bf16 v[208:211], v[40:43], v[180:183], v[208:211]
  v_mfma_f32_16x16x32_bf16 v[204:207], v[44:47], v[172:175], v[204:207]
  v_mfma_f32_16x16x32_bf16 v[212:215], v[44:47], v[180:183], v[212:215]
  s_nop 4
  v_mul_f32 v200, v200, v22
  v_mul_f32 v201, v201, v22
  v_mul_f32 v202, v202, v22
  v_mul_f32 v203, v203, v22
  v_mul_f32 v204, v204, v22
  v_mul_f32 v205, v205, v22
  v_mul_f32 v206, v206, v22
  v_mul_f32 v207, v207, v22
  v_cvt_pk_bf16_f32 v32, v200, v201
  v_cvt_pk_bf16_f32 v33, v202, v203
  v_cvt_pk_bf16_f32 v34, v204, v205
  v_cvt_pk_bf16_f32 v35, v206, v207
  buffer_store_dwordx4 v[32:35], v5, s[16:19], 0 offen offset:320 nt sc1
  v_mul_f32 v208, v208, v23
  v_mul_f32 v209, v209, v23
  v_mul_f32 v210, v210, v23
  v_mul_f32 v211, v211, v23
  v_mul_f32 v212, v212, v23
  v_mul_f32 v213, v213, v23
  v_mul_f32 v214, v214, v23
  v_mul_f32 v215, v215, v23
  v_cvt_pk_bf16_f32 v36, v208, v209
  v_cvt_pk_bf16_f32 v37, v210, v211
  v_cvt_pk_bf16_f32 v38, v212, v213
  v_cvt_pk_bf16_f32 v39, v214, v215
  buffer_store_dwordx4 v[36:39], v6, s[16:19], 0 offen offset:320 nt sc1
MK_done:
  s_endpgm
FB0:
  s_nop 7
  v_max3_f32 v22, v24, v25, v26
  v_max3_f32 v22, v22, v27, v28
  v_max3_f32 v22, v22, v29, v30
  v_max3_f32 v22, v22, v31, v32
  v_max3_f32 v22, v22, v33, v34
  v_max3_f32 v22, v22, v35, v36
  v_max3_f32 v22, v22, v37, v38
  v_max3_f32 v22, v22, v39, v40
  v_max3_f32 v22, v22, v41, v42
  v_max3_f32 v22, v22, v43, v44
  v_max3_f32 v22, v22, v45, v46
  v_max3_f32 v22, v22, v47, v48
  v_max3_f32 v22, v22, v49, v50
  v_max3_f32 v22, v22, v51, v52
  v_max3_f32 v22, v22, v53, v54
  s_mov_b32 s52, 0xff7fffff
  v_max3_f32 v22, v22, v55, s52
  v_mov_b32 v23, v22
  s_nop 1
  v_permlane32_swap_b32 v22, v23
  s_nop 1
  v_max_f32 v22, v22, v23
  v_mov_b32 v23, v22
  s_nop 1
  v_permlane16_swap_b32 v22, v23
  s_nop 1
  v_max_f32 v22, v22, v23
  v_sub_f32 v24, v24, v22
  v_sub_f32 v25, v25, v22
  v_sub_f32 v26, v26, v22
  v_sub_f32 v27, v27, v22
  v_sub_f32 v28, v28, v22
  v_sub_f32 v29, v29, v22
  v_sub_f32 v30, v30, v22
  v_sub_f32 v31, v31, v22
  v_sub_f32 v32, v32, v22
  v_sub_f32 v33, v33, v22
  v_sub_f32 v34, v34, v22
  v_sub_f32 v35, v35, v22
  v_sub_f32 v36, v36, v22
  v_sub_f32 v37, v37, v22
  v_sub_f32 v38, v38, v22
  v_sub_f32 v39, v39, v22
  v_sub_f32 v40, v40, v22
  v_sub_f32 v41, v41, v22
  v_sub_f32 v42, v42, v22
  v_sub_f32 v43, v43, v22
  v_sub_f32 v44, v44, v22
  v_sub_f32 v45, v45, v22
  v_sub_f32 v46, v46, v22
  v_sub_f32 v47, v47, v22
  v_sub_f32 v48, v48, v22
  v_sub_f32 v49, v49, v22
  v_sub_f32 v50, v50, v22
  v_sub_f32 v51, v51, v22
  v_sub_f32 v52, v52, v22
  v_sub_f32 v53, v53, v22
  v_sub_f32 v54, v54, v22
  v_sub_f32 v55, v55, v22
  v_exp_f32 v24, v24
  v_exp_f32 v25, v25
  v_exp_f32 v26, v26
  v_exp_f32 v27, v27
  v_exp_f32 v28, v28
  v_exp_f32 v29, v29
  v_exp_f32 v30, v30
  v_exp_f32 v31, v31
  v_exp_f32 v32, v32
  v_exp_f32 v33, v33
  v_exp_f32 v34, v34
  v_exp_f32 v35, v35
  v_exp_f32 v36, v36
  v_exp_f32 v37, v37
  v_exp_f32 v38, v38
  v_exp_f32 v39, v39
  v_exp_f32 v40, v40
  v_exp_f32 v41, v41
  v_exp_f32 v42, v42
  v_exp_f32 v43, v43
  v_exp_f32 v44, v44
  v_exp_f32 v45, v45
  v_exp_f32 v46, v46
  v_exp_f32 v47, v47
  v_exp_f32 v48, v48
  v_exp_f32 v49, v49
  v_exp_f32 v50, v50
  v_exp_f32 v51, v51
  v_exp_f32 v52, v52
  v_exp_f32 v53, v53
  v_exp_f32 v54, v54
  v_exp_f32 v55, v55
  s_nop 0
  v_cvt_pk_bf16_f32 v136, v24, v25
  v_cvt_pk_bf16_f32 v137, v26, v27
  v_cvt_pk_bf16_f32 v138, v28, v29
  v_cvt_pk_bf16_f32 v139, v30, v31
  v_cvt_pk_bf16_f32 v140, v32, v33
  v_cvt_pk_bf16_f32 v141, v34, v35
  v_cvt_pk_bf16_f32 v142, v36, v37
  v_cvt_pk_bf16_f32 v143, v38, v39
  v_cvt_pk_bf16_f32 v144, v40, v41
  v_cvt_pk_bf16_f32 v145, v42, v43
  v_cvt_pk_bf16_f32 v146, v44, v45
  v_cvt_pk_bf16_f32 v147, v46, v47
  v_cvt_pk_bf16_f32 v148, v48, v49
  v_cvt_pk_bf16_f32 v149, v50, v51
  v_cvt_pk_bf16_f32 v150, v52, v53
  v_cvt_pk_bf16_f32 v151, v54, v55
  s_nop 1
  v_mfma_f32_16x16x32_bf16 v[184:187], v[192:195], v[136:139], 0
  v_mfma_f32_16x16x32_bf16 v[184:187], v[192:195], v[140:143], v[184:187]
  v_mfma_f32_16x16x32_bf16 v[184:187], v[192:195], v[144:147], v[184:187]
  v_mfma_f32_16x16x32_bf16 v[184:187], v[192:195], v[148:151], v[184:187]
  s_nop 7
  s_branch FBR0
FB1:
  s_nop 7
  v_max3_f32 v22, v56, v57, v58
  v_max3_f32 v22, v22, v59, v60
  v_max3_f32 v22, v22, v61, v62
  v_max3_f32 v22, v22, v63, v64
  v_max3_f32 v22, v22, v65, v66
  v_max3_f32 v22, v22, v67, v68
  v_max3_f32 v22, v22, v69, v70
  v_max3_f32 v22, v22, v71, v72
  v_max3_f32 v22, v22, v73, v74
  v_max3_f32 v22, v22, v75, v76
  v_max3_f32 v22, v22, v77, v78
  v_max3_f32 v22, v22, v79, v80
  v_max3_f32 v22, v22, v81, v82
  v_max3_f32 v22, v22, v83, v84
  v_max3_f32 v22, v22, v85, v86
  s_mov_b32 s52, 0xff7fffff
  v_max3_f32 v22, v22, v87, s52
  v_mov_b32 v23, v22
  s_nop 1
  v_permlane32_swap_b32 v22, v23
  s_nop 1
  v_max_f32 v22, v22, v23
  v_mov_b32 v23, v22
  s_nop 1
  v_permlane16_swap_b32 v22, v23
  s_nop 1
  v_max_f32 v22, v22, v23
  v_sub_f32 v56, v56, v22
  v_sub_f32 v57, v57, v22
  v_sub_f32 v58, v58, v22
  v_sub_f32 v59, v59, v22
  v_sub_f32 v60, v60, v22
  v_sub_f32 v61, v61, v22
  v_sub_f32 v62, v62, v22
  v_sub_f32 v63, v63, v22
  v_sub_f32 v64, v64, v22
  v_sub_f32 v65, v65, v22
  v_sub_f32 v66, v66, v22
  v_sub_f32 v67, v67, v22
  v_sub_f32 v68, v68, v22
  v_sub_f32 v69, v69, v22
  v_sub_f32 v70, v70, v22
  v_sub_f32 v71, v71, v22
  v_sub_f32 v72, v72, v22
  v_sub_f32 v73, v73, v22
  v_sub_f32 v74, v74, v22
  v_sub_f32 v75, v75, v22
  v_sub_f32 v76, v76, v22
  v_sub_f32 v77, v77, v22
  v_sub_f32 v78, v78, v22
  v_sub_f32 v79, v79, v22
  v_sub_f32 v80, v80, v22
  v_sub_f32 v81, v81, v22
  v_sub_f32 v82, v82, v22
  v_sub_f32 v83, v83, v22
  v_sub_f32 v84, v84, v22
  v_sub_f32 v85, v85, v22
  v_sub_f32 v86, v86, v22
  v_sub_f32 v87, v87, v22
  v_exp_f32 v56, v56
  v_exp_f32 v57, v57
  v_exp_f32 v58, v58
  v_exp_f32 v59, v59
  v_exp_f32 v60, v60
  v_exp_f32 v61, v61
  v_exp_f32 v62, v62
  v_exp_f32 v63, v63
  v_exp_f32 v64, v64
  v_exp_f32 v65, v65
  v_exp_f32 v66, v66
  v_exp_f32 v67, v67
  v_exp_f32 v68, v68
  v_exp_f32 v69, v69
  v_exp_f32 v70, v70
  v_exp_f32 v71, v71
  v_exp_f32 v72, v72
  v_exp_f32 v73, v73
  v_exp_f32 v74, v74
  v_exp_f32 v75, v75
  v_exp_f32 v76, v76
  v_exp_f32 v77, v77
  v_exp_f32 v78, v78
  v_exp_f32 v79, v79
  v_exp_f32 v80, v80
  v_exp_f32 v81, v81
  v_exp_f32 v82, v82
  v_exp_f32 v83, v83
  v_exp_f32 v84, v84
  v_exp_f32 v85, v85
  v_exp_f32 v86, v86
  v_exp_f32 v87, v87
  s_nop 0
  v_cvt_pk_bf16_f32 v152, v56, v57
  v_cvt_pk_bf16_f32 v153, v58, v59
  v_cvt_pk_bf16_f32 v154, v60, v61
  v_cvt_pk_bf16_f32 v155, v62, v63
  v_cvt_pk_bf16_f32 v156, v64, v65
  v_cvt_pk_bf16_f32 v157, v66, v67
  v_cvt_pk_bf16_f32 v158, v68, v69
  v_cvt_pk_bf16_f32 v159, v70, v71
  v_cvt_pk_bf16_f32 v160, v72, v73
  v_cvt_pk_bf16_f32 v161, v74, v75
  v_cvt_pk_bf16_f32 v162, v76, v77
  v_cvt_pk_bf16_f32 v163, v78, v79
  v_cvt_pk_bf16_f32 v164, v80, v81
  v_cvt_pk_bf16_f32 v165, v82, v83
  v_cvt_pk_bf16_f32 v166, v84, v85
  v_cvt_pk_bf16_f32 v167, v86, v87
  s_nop 1
  v_mfma_f32_16x16x32_bf16 v[188:191], v[192:195], v[152:155], 0
  v_mfma_f32_16x16x32_bf16 v[188:191], v[192:195], v[156:159], v[188:191]
  v_mfma_f32_16x16x32_bf16 v[188:191], v[192:195], v[160:163], v[188:191]
  v_mfma_f32_16x16x32_bf16 v[188:191], v[192:195], v[164:167], v[188:191]
  s_nop 7
  s_branch FBR1
.section .rodata,"a"
.p2align 6
.amdhsa_kernel standalone__neighborhood_nat__vision_kernel
  .amdhsa_next_free_vgpr 256
  .amdhsa_next_free_sgpr 102
  .amdhsa_accum_offset 256
  .amdhsa_group_segment_fixed_size 0
  .amdhsa_kernarg_size 48
  .amdhsa_user_sgpr_count 2
  .amdhsa_user_sgpr_kernarg_segment_ptr 1
  .amdhsa_system_sgpr_workgroup_id_x 1
.end_amdhsa_kernel
```

```asm
; @launch grid=(256,1,1) block=(512,1,1) lds=163840
.amdgcn_target "amdgcn-amd-amdhsa--gfx950"
.text
.globl standalone__neighborhood_nat__vision_kernel
.p2align 8
.type standalone__neighborhood_nat__vision_kernel,@function
standalone__neighborhood_nat__vision_kernel:
  s_cmp_ge_u32 s2, 256
  s_cbranch_scc1 MK_done
  s_load_dwordx8 s[4:11], s[0:1], 0
  s_load_dwordx4 s[84:87], s[0:1], 32
  s_getpc_b64 s[12:13]
MK_pc:
  s_and_b32 s13, s13, 0xffff
  s_mov_b32 s14, MK_end-MK_pc
  s_mov_b32 s15, 0x00020000
  v_lshlrev_b32 v23, 7, v0
  buffer_load_dword v255, v23, s[12:15], 0 offen
  v_lshrrev_b32 v130, 6, v0
  v_and_b32 v0, 63, v0
  v_readfirstlane_b32 s24, v130
  v_and_b32 v128, 15, v0
  v_lshrrev_b32 v129, 4, v0
  v_lshrrev_b32 v130, 5, v0
  v_bfe_u32 v131, v0, 3, 2
  v_lshl_add_u32 v130, v130, 3, v131
  v_mul_u32_u24 v130, 1152, v130
  s_and_b32 s26, s24, 1
  s_lshl_b32 s46, s26, 2
  v_add_u32 v131, s46, v129
  v_and_b32 v132, 7, v0
  v_xor_b32 v131, v131, v132
  v_lshl_add_u32 v96, v131, 4, v130
  s_lshr_b32 s46, s24, 2
  s_lshl_b32 s46, s46, 5
  s_lshl_b32 s47, s26, 4
  s_add_u32 s46, s46, s47
  s_and_b32 s47, s24, 2
  s_lshl_b32 s47, s47, 1
  s_add_u32 s46, s46, s47
  s_mul_i32 s92, s46, 1152
  s_lshl_b32 s41, s24, 10
  s_cmp_lt_u32 s24, 4
  s_cselect_b64 vcc, -1, 0
  s_bfe_u32 s27, s2, 0x10002
  s_bfe_u32 s28, s2, 0x10001
  s_and_b32 s29, s2, 1
  s_lshl_b32 s29, s29, 2
  s_lshr_b32 s46, s2, 6
  s_add_u32 s29, s29, s46
  s_bfe_u32 s30, s2, 0x30003
  s_mul_i32 s37, s29, 14
  s_add_i32 s37, s37, -6
  s_max_i32 s29, s37, -4
  s_mul_i32 s30, s30, 14
  s_add_i32 s30, s30, -6
  s_lshr_b32 s25, s24, 1
  s_add_u32 s25, s25, 2
  s_and_b32 s25, s25, 3
  s_sub_u32 s56, 0, s27
  s_mul_i32 s57, s27, 224
  s_sub_u32 s58, 0, s28
  s_mul_i32 s59, s28, 224
  v_and_b32 v130, 7, v128
  s_mul_i32 s46, s26, 7
  s_add_i32 s46, s46, s30
  v_cmp_lt_u32 s[48:49], 6, v130
  v_add_u32 v130, s46, v130
  v_max_i32 v19, 0, v130
  v_add3_u32 v130, v130, v19, 6
  v_xor_b32 v130, s58, v130
  v_add_u32 v130, s59, v130
  v_subrev_u32 v19, s30, v19
  v_mul_u32_u24 v130, 384, v130
  v_lshl_add_u32 v130, v129, 4, v130
  s_lshl_b32 s46, s25, 2
  s_add_i32 s46, s46, -2
  s_mov_b32 s47, 86016
  v_lshrrev_b32 v131, 3, v128
  v_add_u32 v131, s46, v131
  v_mov_b32 v132, 0x80000000
  v_cmp_gt_i32 s[42:43], 0, v131
  v_add_u32 v5, s37, v131
  v_max_i32 v21, 0, v5
  v_add3_u32 v5, v5, v21, 6
  s_or_b64 s[42:43], s[42:43], s[48:49]
  v_xor_b32 v5, s56, v5
  v_add_u32 v5, s57, v5
  v_subrev_u32 v21, s29, v21
  v_mad_u32_u24 v5, v5, s47, v130
  v_cndmask_b32 v21, v21, v132, s[42:43]
  v_cndmask_b32 v5, v5, v132, s[42:43]
  v_add_u32 v131, 2, v131
  v_cmp_gt_i32 s[44:45], 0, v131
  v_add_u32 v6, s37, v131
  v_max_i32 v22, 0, v6
  v_add3_u32 v6, v6, v22, 6
  s_or_b64 s[44:45], s[44:45], s[48:49]
  v_xor_b32 v6, s56, v6
  v_add_u32 v6, s57, v6
  v_subrev_u32 v22, s29, v22
  v_mad_u32_u24 v6, v6, s47, v130
  v_cndmask_b32 v22, v22, v132, s[44:45]
  v_cndmask_b32 v6, v6, v132, s[44:45]
  s_waitcnt lgkmcnt(0)
  s_mov_b32 s88, s6
  s_and_b32 s89, s7, 0xffff
  s_mov_b32 s90, 221184
  s_mov_b32 s91, 0x00020000
  s_cmp_lg_u32 s24, 5
  s_cbranch_scc1 MK_ntlb
  s_max_i32 s46, s37, 0
  s_lshl_b32 s46, s46, 1
  s_sub_u32 s47, 184, s46
  s_cmp_eq_u32 s27, 0
  s_cselect_b32 s46, s46, s47
  s_mul_i32 s46, s46, 86016
  s_load_dword s94, s[4:5], s46
  s_load_dword s95, s[10:11], s46
  s_add_u32 s46, s46, 1720256
  s_load_dword s94, s[4:5], s46
  s_load_dword s95, s[10:11], s46
  s_add_u32 s46, s46, 1720256
  s_load_dword s94, s[4:5], s46
  s_load_dword s95, s[10:11], s46
  s_load_dword s94, s[84:85], 128
  s_load_dword s95, s[86:87], 0x20000
MK_ntlb:
  s_cmp_lt_u32 s24, 6
  s_cbranch_scc1 MK_nwpf
  s_cmp_eq_u32 s24, 6
  s_cselect_b32 s46, 54, 18
  s_cselect_b32 s12, s6, s8
  s_cselect_b32 s13, s7, s9
  s_and_b32 s13, s13, 0xffff
  s_lshr_b32 s47, s2, 3
  s_mul_i32 s47, s47, s46
  s_lshl_b32 s100, s47, 7
  s_lshl_b32 s46, s46, 7
  s_add_u32 s14, s100, s46
  s_mov_b32 s15, 0x00020000
  v_lshlrev_b32 v23, 7, v0
  buffer_load_dword v254, v23, s[12:15], s100 offen
MK_nwpf:
  s_mov_b32 s12, s4
  s_and_b32 s13, s5, 0xffff
  s_mov_b32 s14, 19267584
  s_mov_b32 s15, 0x00020000
  s_movk_i32 s54, 112
  s_add_u32 m0, s41, 0
  s_add_u32 s100, s92, 0
  buffer_load_dwordx4 v96, s[88:91], s100 offen lds
  s_add_u32 m0, s41, 8192
  s_add_u32 s100, s92, 73728
  buffer_load_dwordx4 v96, s[88:91], s100 offen lds
  s_add_u32 m0, s41, 16384
  s_add_u32 s100, s92, 147456
  buffer_load_dwordx4 v96, s[88:91], s100 offen lds
  s_add_u32 m0, s41, 24576
  s_add_u32 s100, s92, 384
  buffer_load_dwordx4 v96, s[88:91], s100 offen lds
  s_add_u32 m0, s41, 32768
  s_add_u32 s100, s92, 74112
  buffer_load_dwordx4 v96, s[88:91], s100 offen lds
  s_add_u32 m0, s41, 40960
  s_add_u32 s100, s92, 147840
  buffer_load_dwordx4 v96, s[88:91], s100 offen lds
  s_mov_b32 s16, s10
  s_and_b32 s17, s11, 0xffff
  s_mov_b32 s18, 19267584
  s_mov_b32 s19, 0x00020000
  s_mov_b32 s4, s8
  s_and_b32 s5, s9, 0xffff
  s_mov_b32 s6, 73728
  s_mov_b32 s7, 0x00020000
  s_mov_b32 s8, s84
  s_and_b32 s9, s85, 0xffff
  s_mov_b32 s10, 256
  s_mov_b32 s11, 0x00020000
  s_mov_b32 s20, s86
  s_and_b32 s21, s87, 0xffff
  s_mov_b32 s22, 73728
  s_mov_b32 s23, 0x00020000
  v_lshlrev_b32 v1, 4, v0
  v_add_u32 v2, 36864, v1
  s_and_b32 s40, s24, 3
  s_lshl_b32 s40, s40, 10
  v_bfe_u32 v130, v128, 1, 3
  v_xor_b32 v130, v130, v129
  v_lshlrev_b32 v131, 7, v128
  v_lshl_add_u32 v131, v130, 4, v131
  s_lshr_b32 s46, s24, 2
  s_mul_i32 s47, s46, 12288
  v_add_u32 v97, s47, v131
  v_xor_b32 v98, 64, v97
  s_mul_i32 s47, s40, 6
  s_add_u32 s47, s47, 24576
  v_add_u32 v99, s47, v131
  v_xor_b32 v100, 64, v99
  s_lshr_b32 s46, s24, 2
  s_mul_i32 s46, s46, 6
  s_sub_u32 s46, 67, s46
  s_and_b32 s47, s24, 3
  s_mul_i32 s47, s47, 3
  s_add_u32 s48, s47, 0
  s_lshr_b32 s49, s48, 1
  s_mul_i32 s49, s49, 10
  s_add_u32 s48, s48, s49
  s_sub_u32 s48, s46, s48
  s_lshl_b32 s48, s48, 10
  v_add_u32 v101, s48, v1
  s_add_u32 s48, s47, 1
  s_lshr_b32 s49, s48, 1
  s_mul_i32 s49, s49, 10
  s_add_u32 s48, s48, s49
  s_sub_u32 s48, s46, s48
  s_lshl_b32 s48, s48, 10
  v_add_u32 v102, s48, v1
  s_add_u32 s48, s47, 2
  s_lshr_b32 s49, s48, 1
  s_mul_i32 s49, s49, 10
  s_add_u32 s48, s48, s49
  s_sub_u32 s48, s46, s48
  s_lshl_b32 s48, s48, 10
  v_add_u32 v103, s48, v1
  s_lshl_b32 s46, s29, 1
  s_xor_b32 s46, s46, s56
  s_mul_i32 s47, s27, 222
  s_add_i32 s31, s46, s47
  s_mul_i32 s31, s31, 86016
  s_mul_i32 s32, s27, -688128
  s_add_i32 s32, s32, 344064
  s_lshr_b32 s33, s29, 31
  s_lshl_b32 s33, s33, 1
  s_lshl_b32 s38, s40, 2
  s_add_u32 s39, s38, 3072
  s_min_u32 s39, s39, 14336
  s_mul_i32 s48, s27, 172032
  s_sub_u32 s49, 172032, s48
  v_mov_b32 v132, s48
  v_mov_b32 v133, s49
  s_lshr_b32 s46, s38, 4
  s_add_u32 s46, s46, 0
  v_add_u32 v130, s46, v0
  v_mul_u32_u24 v13, 2731, v130
  v_lshrrev_b32 v13, 16, v13
  v_cmp_le_u32 s[52:53], 20, v13
  v_mul_u32_u24 v131, 24, v13
  v_sub_u32 v130, v130, v131
  v_subrev_u32 v131, 20, v13
  v_cndmask_b32 v13, v13, v131, s[52:53]
  v_bfe_u32 v131, v13, 1, 3
  v_xor_b32 v130, v130, v131
  v_cndmask_b32 v131, v132, v133, s[52:53]
  v_lshl_add_u32 v130, v130, 4, v131
  v_add_u32 v13, s30, v13
  v_max_i32 v13, 0, v13
  v_lshlrev_b32 v13, 1, v13
  v_xor_b32 v13, s58, v13
  v_add_u32 v13, s59, v13
  v_mul_u32_u24 v13, 384, v13
  v_add_u32 v13, v13, v130
  s_lshr_b32 s46, s38, 4
  s_add_u32 s46, s46, 64
  v_add_u32 v130, s46, v0
  v_mul_u32_u24 v14, 2731, v130
  v_lshrrev_b32 v14, 16, v14
  v_cmp_le_u32 s[52:53], 20, v14
  v_mul_u32_u24 v131, 24, v14
  v_sub_u32 v130, v130, v131
  v_subrev_u32 v131, 20, v14
  v_cndmask_b32 v14, v14, v131, s[52:53]
  v_bfe_u32 v131, v14, 1, 3
  v_xor_b32 v130, v130, v131
  v_cndmask_b32 v131, v132, v133, s[52:53]
  v_lshl_add_u32 v130, v130, 4, v131
  v_add_u32 v14, s30, v14
  v_max_i32 v14, 0, v14
  v_lshlrev_b32 v14, 1, v14
  v_xor_b32 v14, s58, v14
  v_add_u32 v14, s59, v14
  v_mul_u32_u24 v14, 384, v14
  v_add_u32 v14, v14, v130
  s_lshr_b32 s46, s38, 4
  s_add_u32 s46, s46, 128
  v_add_u32 v130, s46, v0
  v_mul_u32_u24 v3, 2731, v130
  v_lshrrev_b32 v3, 16, v3
  v_cmp_le_u32 s[52:53], 20, v3
  v_mul_u32_u24 v131, 24, v3
  v_sub_u32 v130, v130, v131
  v_subrev_u32 v131, 20, v3
  v_cndmask_b32 v3, v3, v131, s[52:53]
  v_bfe_u32 v131, v3, 1, 3
  v_xor_b32 v130, v130, v131
  v_cndmask_b32 v131, v132, v133, s[52:53]
  v_lshl_add_u32 v130, v130, 4, v131
  v_add_u32 v3, s30, v3
  v_max_i32 v3, 0, v3
  v_lshlrev_b32 v3, 1, v3
  v_xor_b32 v3, s58, v3
  v_add_u32 v3, s59, v3
  v_mul_u32_u24 v3, 384, v3
  v_add_u32 v3, v3, v130
  s_lshr_b32 s46, s39, 4
  v_add_u32 v130, s46, v0
  v_mul_u32_u24 v4, 2731, v130
  v_lshrrev_b32 v4, 16, v4
  v_cmp_le_u32 s[52:53], 20, v4
  v_mul_u32_u24 v131, 24, v4
  v_sub_u32 v130, v130, v131
  v_subrev_u32 v131, 20, v4
  v_cndmask_b32 v4, v4, v131, s[52:53]
  v_bfe_u32 v131, v4, 1, 3
  v_xor_b32 v130, v130, v131
  v_cndmask_b32 v131, v132, v133, s[52:53]
  v_lshl_add_u32 v130, v130, 4, v131
  v_add_u32 v4, s30, v4
  v_max_i32 v4, 0, v4
  v_lshlrev_b32 v4, 1, v4
  v_xor_b32 v4, s58, v4
  v_add_u32 v4, s59, v4
  v_mul_u32_u24 v4, 384, v4
  v_add_u32 v4, v4, v130
  s_add_u32 s38, s38, 10240
  s_add_u32 s39, s39, 10240
  s_lshl_b32 s46, s25, 2
  s_add_i32 s46, s46, -2
  s_max_i32 s46, s46, 0
  s_add_i32 s46, s46, s37
  s_max_i32 s46, s46, 0
  s_sub_i32 s46, s46, s29
  s_lshl_b32 s34, s25, 2
  s_add_i32 s34, s34, s37
  s_max_i32 s34, s34, 0
  s_sub_i32 s34, s34, s29
  s_sub_u32 s46, s34, s46
  s_lshr_b32 s46, s46, 1
  s_mul_i32 s36, s46, -8
  s_add_i32 s36, s36, 7
  s_add_i32 s34, s34, -1
  s_add_i32 s35, s34, s36
  s_mul_i32 s36, s36, 7680
  s_lshl_b32 s47, s26, 2
  s_mul_i32 s46, s34, 7680
  s_add_i32 s46, s46, 10240
  v_add_u32 v130, s47, v128
  v_bfe_u32 v131, v130, 1, 3
  v_xor_b32 v131, v131, v129
  v_mul_u32_u24 v130, 384, v130
  v_lshl_add_u32 v130, v131, 4, v130
  v_add_u32 v7, s46, v130
  v_xor_b32 v8, 64, v7
  v_lshrrev_b32 v130, 2, v128
  v_lshl_add_u32 v130, v129, 2, v130
  v_add_u32 v130, s47, v130
  v_bfe_u32 v131, v130, 1, 3
  v_and_b32 v132, 2, v128
  v_lshlrev_b32 v132, 1, v132
  v_xor_b32 v131, v131, v132
  v_mul_u32_u24 v130, 384, v130
  v_lshl_add_u32 v130, v131, 4, v130
  v_and_b32 v131, 1, v128
  v_lshl_add_u32 v130, v131, 3, v130
  v_add_u32 v9, s46, v130
  v_xor_b32 v10, 16, v9
  v_xor_b32 v11, 32, v9
  v_xor_b32 v12, 48, v9
  v_lshl_add_u32 v130, v129, 2, s47
  v_sub_u32 v19, v130, v19
  v_add_u32 v20, s36, v7
  v_add_u32 v0, s36, v8
  v_add_u32 v15, s36, v9
  v_add_u32 v16, s36, v10
  v_add_u32 v17, s36, v11
  v_add_u32 v18, s36, v12
  s_mov_b32 s93, 1037384597
  s_add_u32 m0, s41, 49152
  s_add_u32 s100, s92, 128
  buffer_load_dwordx4 v96, s[88:91], s100 offen lds
  s_add_u32 m0, s41, 57344
  s_add_u32 s100, s92, 73856
  buffer_load_dwordx4 v96, s[88:91], s100 offen lds
  s_add_u32 m0, s41, 65536
  s_add_u32 s100, s92, 147584
  buffer_load_dwordx4 v96, s[88:91], s100 offen lds
  s_add_u32 m0, s41, 73728
  s_add_u32 s100, s92, 512
  buffer_load_dwordx4 v96, s[88:91], s100 offen lds
  s_add_u32 m0, s41, 81920
  s_add_u32 s100, s92, 74240
  buffer_load_dwordx4 v96, s[88:91], s100 offen lds
  s_add_u32 m0, s41, 90112
  s_add_u32 s100, s92, 147968
  buffer_load_dwordx4 v96, s[88:91], s100 offen lds
  s_waitcnt vmcnt(6)
  s_barrier
  ds_read_b128 v[208:211], v99 offset:0
  ds_read_b128 v[212:215], v99 offset:2048
  ds_read_b128 v[216:219], v99 offset:4096
  ds_read_b128 v[184:187], v97 offset:0
  ds_read_b128 v[188:191], v97 offset:2048
  ds_read_b128 v[192:195], v97 offset:4096
  ds_read_b128 v[196:199], v97 offset:6144
  ds_read_b128 v[200:203], v97 offset:8192
  ds_read_b128 v[204:207], v97 offset:10240
  s_waitcnt lgkmcnt(5)
  v_mfma_f32_16x16x32_bf16 v[24:27], v[184:187], v[208:211], 0
  s_add_u32 m0, s41, 98304
  s_add_u32 s100, s92, 256
  buffer_load_dwordx4 v96, s[88:91], s100 offen lds
  v_mfma_f32_16x16x32_bf16 v[28:31], v[184:187], v[212:215], 0
  v_mfma_f32_16x16x32_bf16 v[32:35], v[184:187], v[216:219], 0
  s_waitcnt lgkmcnt(4)
  v_mfma_f32_16x16x32_bf16 v[36:39], v[188:191], v[208:211], 0
  ds_read_b128 v[244:247], v100 offset:0
  s_add_u32 m0, s41, 106496
  s_add_u32 s100, s92, 73984
  buffer_load_dwordx4 v96, s[88:91], s100 offen lds
  v_mfma_f32_16x16x32_bf16 v[40:43], v[188:191], v[212:215], 0
  ds_read_b128 v[248:251], v100 offset:2048
  v_mfma_f32_16x16x32_bf16 v[44:47], v[188:191], v[216:219], 0
  s_waitcnt lgkmcnt(5)
  v_mfma_f32_16x16x32_bf16 v[48:51], v[192:195], v[208:211], 0
  ds_read_b128 v[252:255], v100 offset:4096
  s_add_u32 m0, s41, 114688
  s_add_u32 s100, s92, 147712
  buffer_load_dwordx4 v96, s[88:91], s100 offen lds
  v_mfma_f32_16x16x32_bf16 v[52:55], v[192:195], v[212:215], 0
  ds_read_b128 v[220:223], v98 offset:0
  v_mfma_f32_16x16x32_bf16 v[56:59], v[192:195], v[216:219], 0
  s_waitcnt lgkmcnt(6)
  v_mfma_f32_16x16x32_bf16 v[60:63], v[196:199], v[208:211], 0
  ds_read_b128 v[224:227], v98 offset:2048
  s_add_u32 m0, s41, 122880
  s_add_u32 s100, s92, 640
  buffer_load_dwordx4 v96, s[88:91], s100 offen lds
  v_mfma_f32_16x16x32_bf16 v[64:67], v[196:199], v[212:215], 0
  ds_read_b128 v[228:231], v98 offset:4096
  v_mfma_f32_16x16x32_bf16 v[68:71], v[196:199], v[216:219], 0
  s_waitcnt lgkmcnt(7)
  v_mfma_f32_16x16x32_bf16 v[72:75], v[200:203], v[208:211], 0
  ds_read_b128 v[232:235], v98 offset:6144
  s_add_u32 m0, s41, 131072
  s_add_u32 s100, s92, 74368
  buffer_load_dwordx4 v96, s[88:91], s100 offen lds
  v_mfma_f32_16x16x32_bf16 v[76:79], v[200:203], v[212:215], 0
  ds_read_b128 v[236:239], v98 offset:8192
  v_mfma_f32_16x16x32_bf16 v[80:83], v[200:203], v[216:219], 0
  s_waitcnt lgkmcnt(8)
  v_mfma_f32_16x16x32_bf16 v[84:87], v[204:207], v[208:211], 0
  ds_read_b128 v[240:243], v98 offset:10240
  s_add_u32 m0, s41, 139264
  s_add_u32 s100, s92, 148096
  buffer_load_dwordx4 v96, s[88:91], s100 offen lds
  v_mfma_f32_16x16x32_bf16 v[88:91], v[204:207], v[212:215], 0
  v_mfma_f32_16x16x32_bf16 v[92:95], v[204:207], v[216:219], 0
  v_lshrrev_b32 v107, 4, v1
  s_cmp_lt_u32 s2, 72
  s_cbranch_scc0 MK_np1
  s_mul_hi_u32 s54, s2, 0x15555556
  s_lshl_b32 s54, s54, 6
  s_mul_i32 s55, s24, 6144
  s_add_u32 s100, s54, s55
  v_lshrrev_b32 v104, 2, v107
  v_mul_u32_u24 v104, 384, v104
  v_and_b32 v105, 3, v107
  v_lshl_add_u32 v104, v105, 4, v104
  s_add_u32 m0, s41, 147456
  s_nop 0
  buffer_load_dwordx4 v104, s[4:7], s100 offen lds
  s_mul_i32 s55, s40, 6
  s_add_u32 s100, s54, s55
  s_add_u32 m0, s40, 155648
  s_add_u32 s100, s100, 49152
  buffer_load_dwordx4 v104, s[4:7], s100 offen lds
MK_np1:
  s_sub_u32 s3, s2, 72
  s_lshr_b32 s3, s3, 31
  s_lshr_b32 s3, s3, s25
  v_mov_b32 v134, 0
  s_cmp_eq_u32 s3, 0
  s_cbranch_scc1 MK_np3
  s_mul_hi_u32 s54, s2, 0x15555556
  s_mul_i32 s55, s54, 12
  s_sub_u32 s55, s2, s55
  s_and_b32 s51, s55, 1
  s_lshr_b32 s55, s55, 1
  v_lshrrev_b32 v106, 2, v128
  v_and_b32 v105, 3, v128
  v_lshl_add_u32 v134, v129, 3, v106
  v_lshlrev_b32 v134, 6, v134
  v_lshl_add_u32 v134, v105, 4, v134
  s_lshl_b32 s51, s51, 3
  s_add_u32 s51, s51, 147456
  v_add_u32 v134, s51, v134
  s_lshr_b32 s54, s55, 1
  s_lshl_b32 s54, s54, 6
  s_and_b32 s55, s55, 1
  s_lshl_b32 s55, s55, 4
  s_add_u32 s54, s54, s55
  v_lshrrev_b32 v104, 1, v106
  v_lshlrev_b32 v104, 5, v104
  v_and_b32 v106, 1, v106
  v_lshl_add_u32 v104, v106, 2, v104
  v_add3_u32 v104, v104, v105, s54
  v_mul_u32_u24 v104, 1152, v104
  v_lshl_add_u32 v135, v129, 4, v104
  s_mul_i32 s100, s26, 9216
  buffer_load_dwordx4 v[136:139], v135, s[88:91], s100 offen offset:768
  buffer_load_dwordx4 v[140:143], v135, s[88:91], s100 offen offset:832
  buffer_load_dwordx4 v[144:147], v135, s[88:91], s100 offen offset:896
  buffer_load_dwordx4 v[148:151], v135, s[88:91], s100 offen offset:960
  buffer_load_dwordx4 v[152:155], v135, s[88:91], s100 offen offset:1024
  buffer_load_dwordx4 v[156:159], v135, s[88:91], s100 offen offset:1088
MK_np3:
  s_cmp_lg_u32 s3, 0
  s_cbranch_scc1 CA1
  s_cmp_lt_u32 s2, 72
  s_cbranch_scc1 CB1
  s_waitcnt vmcnt(6)
CB1:
  s_waitcnt vmcnt(8)
CA1:
  s_waitcnt vmcnt(14) lgkmcnt(0)
  s_barrier
  v_add_u32 v97, 49152, v97
  v_add_u32 v98, 49152, v98
  v_add_u32 v99, 49152, v99
  v_add_u32 v100, 49152, v100
  v_mfma_f32_16x16x32_bf16 v[24:27], v[220:223], v[244:247], v[24:27]
  ds_read_b128 v[208:211], v99 offset:0
  s_cbranch_vccz SL2
  buffer_load_dwordx4 v[160:163], v6, s[12:15], 0 offen offset:0
SL2:
  v_mfma_f32_16x16x32_bf16 v[28:31], v[220:223], v[248:251], v[28:31]
  ds_read_b128 v[212:215], v99 offset:2048
  v_mfma_f32_16x16x32_bf16 v[32:35], v[220:223], v[252:255], v[32:35]
  v_mfma_f32_16x16x32_bf16 v[36:39], v[224:227], v[244:247], v[36:39]
  ds_read_b128 v[216:219], v99 offset:4096
  s_cbranch_vccz SL3
  buffer_load_dwordx4 v[164:167], v6, s[12:15], 0 offen offset:64
SL3:
  v_mfma_f32_16x16x32_bf16 v[40:43], v[224:227], v[248:251], v[40:43]
  ds_read_b128 v[184:187], v97 offset:0
  v_mfma_f32_16x16x32_bf16 v[44:47], v[224:227], v[252:255], v[44:47]
  v_mfma_f32_16x16x32_bf16 v[48:51], v[228:231], v[244:247], v[48:51]
  ds_read_b128 v[188:191], v97 offset:2048
  s_cbranch_vccz SL4
  buffer_load_dwordx4 v[168:171], v6, s[12:15], 0 offen offset:128
SL4:
  v_mfma_f32_16x16x32_bf16 v[52:55], v[228:231], v[248:251], v[52:55]
  ds_read_b128 v[192:195], v97 offset:4096
  v_mfma_f32_16x16x32_bf16 v[56:59], v[228:231], v[252:255], v[56:59]
  v_mfma_f32_16x16x32_bf16 v[60:63], v[232:235], v[244:247], v[60:63]
  ds_read_b128 v[196:199], v97 offset:6144
  s_cbranch_vccz SL5
  buffer_load_dwordx4 v[172:175], v6, s[12:15], 0 offen offset:192
SL5:
  v_mfma_f32_16x16x32_bf16 v[64:67], v[232:235], v[248:251], v[64:67]
  ds_read_b128 v[200:203], v97 offset:8192
  v_mfma_f32_16x16x32_bf16 v[68:71], v[232:235], v[252:255], v[68:71]
  v_mfma_f32_16x16x32_bf16 v[72:75], v[236:239], v[244:247], v[72:75]
  ds_read_b128 v[204:207], v97 offset:10240
  s_cbranch_vccz SL6
  buffer_load_dwordx4 v[176:179], v6, s[12:15], 0 offen offset:256
SL6:
  v_mfma_f32_16x16x32_bf16 v[76:79], v[236:239], v[248:251], v[76:79]
  v_mfma_f32_16x16x32_bf16 v[80:83], v[236:239], v[252:255], v[80:83]
  v_mfma_f32_16x16x32_bf16 v[84:87], v[240:243], v[244:247], v[84:87]
  s_cbranch_vccz SL7
  buffer_load_dwordx4 v[180:183], v6, s[12:15], 0 offen offset:320
SL7:
  v_mfma_f32_16x16x32_bf16 v[88:91], v[240:243], v[248:251], v[88:91]
  v_mfma_f32_16x16x32_bf16 v[92:95], v[240:243], v[252:255], v[92:95]
  s_waitcnt lgkmcnt(5)
  v_mfma_f32_16x16x32_bf16 v[24:27], v[184:187], v[208:211], v[24:27]
  s_cbranch_vccz SL8
  buffer_load_dwordx4 v[136:139], v5, s[12:15], 0 offen offset:0
SL8:
  v_mfma_f32_16x16x32_bf16 v[28:31], v[184:187], v[212:215], v[28:31]
  v_mfma_f32_16x16x32_bf16 v[32:35], v[184:187], v[216:219], v[32:35]
  s_waitcnt lgkmcnt(4)
  v_mfma_f32_16x16x32_bf16 v[36:39], v[188:191], v[208:211], v[36:39]
  ds_read_b128 v[244:247], v100 offset:0
  s_cbranch_vccz SL9
  buffer_load_dwordx4 v[140:143], v5, s[12:15], 0 offen offset:64
SL9:
  v_mfma_f32_16x16x32_bf16 v[40:43], v[188:191], v[212:215], v[40:43]
  ds_read_b128 v[248:251], v100 offset:2048
  v_mfma_f32_16x16x32_bf16 v[44:47], v[188:191], v[216:219], v[44:47]
  s_waitcnt lgkmcnt(5)
  v_mfma_f32_16x16x32_bf16 v[48:51], v[192:195], v[208:211], v[48:51]
  ds_read_b128 v[252:255], v100 offset:4096
  s_cbranch_vccz SL10
  buffer_load_dwordx4 v[144:147], v5, s[12:15], 0 offen offset:128
SL10:
  v_mfma_f32_16x16x32_bf16 v[52:55], v[192:195], v[212:215], v[52:55]
  ds_read_b128 v[220:223], v98 offset:0
  v_mfma_f32_16x16x32_bf16 v[56:59], v[192:195], v[216:219], v[56:59]
  s_waitcnt lgkmcnt(6)
  v_mfma_f32_16x16x32_bf16 v[60:63], v[196:199], v[208:211], v[60:63]
  ds_read_b128 v[224:227], v98 offset:2048
  s_cbranch_vccz SL11
  buffer_load_dwordx4 v[148:151], v5, s[12:15], 0 offen offset:192
SL11:
  v_mfma_f32_16x16x32_bf16 v[64:67], v[196:199], v[212:215], v[64:67]
  ds_read_b128 v[228:231], v98 offset:4096
  v_mfma_f32_16x16x32_bf16 v[68:71], v[196:199], v[216:219], v[68:71]
  s_waitcnt lgkmcnt(7)
  v_mfma_f32_16x16x32_bf16 v[72:75], v[200:203], v[208:211], v[72:75]
  ds_read_b128 v[232:235], v98 offset:6144
  s_cbranch_vccz SL12
  buffer_load_dwordx4 v[152:155], v5, s[12:15], 0 offen offset:256
SL12:
  v_mfma_f32_16x16x32_bf16 v[76:79], v[200:203], v[212:215], v[76:79]
  ds_read_b128 v[236:239], v98 offset:8192
  v_mfma_f32_16x16x32_bf16 v[80:83], v[200:203], v[216:219], v[80:83]
  s_waitcnt lgkmcnt(8)
  v_mfma_f32_16x16x32_bf16 v[84:87], v[204:207], v[208:211], v[84:87]
  ds_read_b128 v[240:243], v98 offset:10240
  s_cbranch_vccz SL13
  buffer_load_dwordx4 v[156:159], v5, s[12:15], 0 offen offset:320
SL13:
  v_mfma_f32_16x16x32_bf16 v[88:91], v[204:207], v[212:215], v[88:91]
  v_mfma_f32_16x16x32_bf16 v[92:95], v[204:207], v[216:219], v[92:95]
  s_cbranch_vccz SL14
  s_waitcnt vmcnt(12) lgkmcnt(0)
  s_branch SM14
SL14:
  s_waitcnt vmcnt(0) lgkmcnt(0)
SM14:
  s_barrier
  v_add_u32 v97, 49152, v97
  v_add_u32 v98, 49152, v98
  v_add_u32 v99, 49152, v99
  v_add_u32 v100, 49152, v100
  v_mfma_f32_16x16x32_bf16 v[24:27], v[220:223], v[244:247], v[24:27]
  ds_read_b128 v[208:211], v99 offset:0
  s_cbranch_vccnz SL15
  buffer_load_dwordx4 v[160:163], v6, s[12:15], 0 offen offset:0
SL15:
  v_mfma_f32_16x16x32_bf16 v[28:31], v[220:223], v[248:251], v[28:31]
  ds_read_b128 v[212:215], v99 offset:2048
  v_mfma_f32_16x16x32_bf16 v[32:35], v[220:223], v[252:255], v[32:35]
  v_mfma_f32_16x16x32_bf16 v[36:39], v[224:227], v[244:247], v[36:39]
  ds_read_b128 v[216:219], v99 offset:4096
  s_cbranch_vccnz SL16
  buffer_load_dwordx4 v[164:167], v6, s[12:15], 0 offen offset:64
SL16:
  v_mfma_f32_16x16x32_bf16 v[40:43], v[224:227], v[248:251], v[40:43]
  ds_read_b128 v[184:187], v97 offset:0
  v_mfma_f32_16x16x32_bf16 v[44:47], v[224:227], v[252:255], v[44:47]
  v_mfma_f32_16x16x32_bf16 v[48:51], v[228:231], v[244:247], v[48:51]
  ds_read_b128 v[188:191], v97 offset:2048
  s_cbranch_vccnz SL17
  buffer_load_dwordx4 v[168:171], v6, s[12:15], 0 offen offset:128
SL17:
  v_mfma_f32_16x16x32_bf16 v[52:55], v[228:231], v[248:251], v[52:55]
  ds_read_b128 v[192:195], v97 offset:4096
  v_mfma_f32_16x16x32_bf16 v[56:59], v[228:231], v[252:255], v[56:59]
  v_mfma_f32_16x16x32_bf16 v[60:63], v[232:235], v[244:247], v[60:63]
  ds_read_b128 v[196:199], v97 offset:6144
  s_cbranch_vccnz SL18
  buffer_load_dwordx4 v[172:175], v6, s[12:15], 0 offen offset:192
SL18:
  v_mfma_f32_16x16x32_bf16 v[64:67], v[232:235], v[248:251], v[64:67]
  ds_read_b128 v[200:203], v97 offset:8192
  v_mfma_f32_16x16x32_bf16 v[68:71], v[232:235], v[252:255], v[68:71]
  v_mfma_f32_16x16x32_bf16 v[72:75], v[236:239], v[244:247], v[72:75]
  ds_read_b128 v[204:207], v97 offset:10240
  s_cbranch_vccnz SL19
  buffer_load_dwordx4 v[176:179], v6, s[12:15], 0 offen offset:256
SL19:
  v_mfma_f32_16x16x32_bf16 v[76:79], v[236:239], v[248:251], v[76:79]
  v_mfma_f32_16x16x32_bf16 v[80:83], v[236:239], v[252:255], v[80:83]
  v_mfma_f32_16x16x32_bf16 v[84:87], v[240:243], v[244:247], v[84:87]
  s_cbranch_vccnz SL20
  buffer_load_dwordx4 v[180:183], v6, s[12:15], 0 offen offset:320
SL20:
  v_mfma_f32_16x16x32_bf16 v[88:91], v[240:243], v[248:251], v[88:91]
  v_mfma_f32_16x16x32_bf16 v[92:95], v[240:243], v[252:255], v[92:95]
  s_cmp_eq_u32 s3, 0
  s_cbranch_scc1 MK_np2
  s_waitcnt lgkmcnt(0)
  ds_read_b64_tr_b16 v[104:105], v134 offset:0
  ds_read_b64_tr_b16 v[106:107], v134 offset:256
  ds_read_b64_tr_b16 v[108:109], v134 offset:2048
  ds_read_b64_tr_b16 v[110:111], v134 offset:2304
  ds_read_b64_tr_b16 v[112:113], v134 offset:4096
  ds_read_b64_tr_b16 v[114:115], v134 offset:4352
  ds_read_b64_tr_b16 v[116:117], v134 offset:6144
  ds_read_b64_tr_b16 v[118:119], v134 offset:6400
  ds_read_b64_tr_b16 v[120:121], v134 offset:8192
  ds_read_b64_tr_b16 v[122:123], v134 offset:8448
  ds_read_b64_tr_b16 v[124:125], v134 offset:10240
  ds_read_b64_tr_b16 v[126:127], v134 offset:10496
  s_setprio 3
  s_waitcnt lgkmcnt(0)
  v_mfma_f32_16x16x32_bf16 v[128:131], v[136:139], v[104:107], 0
  v_mfma_f32_16x16x32_bf16 v[128:131], v[140:143], v[108:111], v[128:131]
  v_mfma_f32_16x16x32_bf16 v[128:131], v[144:147], v[112:115], v[128:131]
  v_mfma_f32_16x16x32_bf16 v[128:131], v[148:151], v[116:119], v[128:131]
  v_mfma_f32_16x16x32_bf16 v[128:131], v[152:155], v[120:123], v[128:131]
  v_mfma_f32_16x16x32_bf16 v[128:131], v[156:159], v[124:127], v[128:131]
  s_lshl_b32 s100, s2, 10
  s_lshl_b32 s54, s26, 3
  s_add_u32 s100, s100, s54
  s_nop 5
  v_cvt_pk_bf16_f32 v132, v128, v129
  v_cvt_pk_bf16_f32 v133, v130, v131
  buffer_store_dwordx2 v[132:133], v1, s[20:23], s100 offen sc1
  s_setprio 0
MK_np2:
  ds_read_b128 v[244:247], v100 offset:0
  ds_read_b128 v[248:251], v100 offset:2048
  ds_read_b128 v[252:255], v100 offset:4096
  ds_read_b128 v[220:223], v98 offset:0
  ds_read_b128 v[224:227], v98 offset:2048
  s_waitcnt lgkmcnt(5)
  v_mfma_f32_16x16x32_bf16 v[24:27], v[184:187], v[208:211], v[24:27]
  ds_read_b128 v[228:231], v98 offset:4096
  s_cbranch_vccnz SL21
  buffer_load_dwordx4 v[136:139], v5, s[12:15], 0 offen offset:0
SL21:
  v_mfma_f32_16x16x32_bf16 v[36:39], v[188:191], v[208:211], v[36:39]
  ds_read_b128 v[232:235], v98 offset:6144
  s_waitcnt lgkmcnt(2)
  v_mfma_f32_16x16x32_bf16 v[24:27], v[220:223], v[244:247], v[24:27]
  ds_read_b128 v[236:239], v98 offset:8192
  v_mfma_f32_16x16x32_bf16 v[36:39], v[224:227], v[244:247], v[36:39]
  ds_read_b128 v[240:243], v98 offset:10240
  v_mfma_f32_16x16x32_bf16 v[28:31], v[184:187], v[212:215], v[28:31]
  v_mfma_f32_16x16x32_bf16 v[40:43], v[188:191], v[212:215], v[40:43]
  v_mfma_f32_16x16x32_bf16 v[28:31], v[220:223], v[248:251], v[28:31]
  s_cbranch_vccnz SL22
  buffer_load_dwordx4 v[140:143], v5, s[12:15], 0 offen offset:64
SL22:
  v_mfma_f32_16x16x32_bf16 v[40:43], v[224:227], v[248:251], v[40:43]
  v_mfma_f32_16x16x32_bf16 v[32:35], v[184:187], v[216:219], v[32:35]
  v_cvt_pk_bf16_f32 v104, v24, v25
  v_cvt_pk_bf16_f32 v105, v26, v27
  v_mfma_f32_16x16x32_bf16 v[44:47], v[188:191], v[216:219], v[44:47]
  v_cvt_pk_bf16_f32 v106, v36, v37
  v_cvt_pk_bf16_f32 v107, v38, v39
  v_mfma_f32_16x16x32_bf16 v[32:35], v[220:223], v[252:255], v[32:35]
  ds_write_b128 v101, v[104:107] offset:4096
  v_mfma_f32_16x16x32_bf16 v[44:47], v[224:227], v[252:255], v[44:47]
  v_mfma_f32_16x16x32_bf16 v[48:51], v[192:195], v[208:211], v[48:51]
  v_cvt_pk_bf16_f32 v108, v28, v29
  v_cvt_pk_bf16_f32 v109, v30, v31
  s_cbranch_vccnz SL23
  buffer_load_dwordx4 v[144:147], v5, s[12:15], 0 offen offset:128
SL23:
  v_mfma_f32_16x16x32_bf16 v[60:63], v[196:199], v[208:211], v[60:63]
  v_cvt_pk_bf16_f32 v110, v40, v41
  v_cvt_pk_bf16_f32 v111, v42, v43
  s_waitcnt lgkmcnt(1)
  v_mfma_f32_16x16x32_bf16 v[48:51], v[228:231], v[244:247], v[48:51]
  ds_write_b128 v102, v[108:111] offset:4096
  v_mfma_f32_16x16x32_bf16 v[60:63], v[232:235], v[244:247], v[60:63]
  v_mfma_f32_16x16x32_bf16 v[52:55], v[192:195], v[212:215], v[52:55]
  v_cvt_pk_bf16_f32 v112, v32, v33
  v_cvt_pk_bf16_f32 v113, v34, v35
  v_mfma_f32_16x16x32_bf16 v[64:67], v[196:199], v[212:215], v[64:67]
  v_cvt_pk_bf16_f32 v114, v44, v45
  v_cvt_pk_bf16_f32 v115, v46, v47
  v_mfma_f32_16x16x32_bf16 v[52:55], v[228:231], v[248:251], v[52:55]
  ds_write_b128 v103, v[112:115] offset:4096
  s_cbranch_vccnz SL24
  buffer_load_dwordx4 v[148:151], v5, s[12:15], 0 offen offset:192
SL24:
  v_mfma_f32_16x16x32_bf16 v[64:67], v[232:235], v[248:251], v[64:67]
  v_mfma_f32_16x16x32_bf16 v[56:59], v[192:195], v[216:219], v[56:59]
  v_cvt_pk_bf16_f32 v116, v48, v49
  v_cvt_pk_bf16_f32 v117, v50, v51
  v_mfma_f32_16x16x32_bf16 v[68:71], v[196:199], v[216:219], v[68:71]
  v_cvt_pk_bf16_f32 v118, v60, v61
  v_cvt_pk_bf16_f32 v119, v62, v63
  v_mfma_f32_16x16x32_bf16 v[56:59], v[228:231], v[252:255], v[56:59]
  ds_write_b128 v101, v[116:119] offset:2048
  v_mfma_f32_16x16x32_bf16 v[68:71], v[232:235], v[252:255], v[68:71]
  v_mfma_f32_16x16x32_bf16 v[72:75], v[200:203], v[208:211], v[72:75]
  v_cvt_pk_bf16_f32 v120, v52, v53
  v_cvt_pk_bf16_f32 v121, v54, v55
  s_cbranch_vccnz SL25
  buffer_load_dwordx4 v[152:155], v5, s[12:15], 0 offen offset:256
SL25:
  v_mfma_f32_16x16x32_bf16 v[84:87], v[204:207], v[208:211], v[84:87]
  v_cvt_pk_bf16_f32 v122, v64, v65
  v_cvt_pk_bf16_f32 v123, v66, v67
  v_mfma_f32_16x16x32_bf16 v[72:75], v[236:239], v[244:247], v[72:75]
  ds_write_b128 v102, v[120:123] offset:2048
  v_mfma_f32_16x16x32_bf16 v[84:87], v[240:243], v[244:247], v[84:87]
  v_mfma_f32_16x16x32_bf16 v[76:79], v[200:203], v[212:215], v[76:79]
  v_cvt_pk_bf16_f32 v124, v56, v57
  v_cvt_pk_bf16_f32 v125, v58, v59
  v_mfma_f32_16x16x32_bf16 v[88:91], v[204:207], v[212:215], v[88:91]
  v_cvt_pk_bf16_f32 v126, v68, v69
  v_cvt_pk_bf16_f32 v127, v70, v71
  v_mfma_f32_16x16x32_bf16 v[76:79], v[236:239], v[248:251], v[76:79]
  ds_write_b128 v103, v[124:127] offset:2048
  s_cbranch_vccnz SL26
  buffer_load_dwordx4 v[156:159], v5, s[12:15], 0 offen offset:320
SL26:
  v_mfma_f32_16x16x32_bf16 v[88:91], v[240:243], v[248:251], v[88:91]
  v_mfma_f32_16x16x32_bf16 v[80:83], v[200:203], v[216:219], v[80:83]
  v_cvt_pk_bf16_f32 v104, v72, v73
  v_cvt_pk_bf16_f32 v105, v74, v75
  v_mfma_f32_16x16x32_bf16 v[92:95], v[204:207], v[216:219], v[92:95]
  v_cvt_pk_bf16_f32 v106, v84, v85
  v_cvt_pk_bf16_f32 v107, v86, v87
  v_mfma_f32_16x16x32_bf16 v[80:83], v[236:239], v[252:255], v[80:83]
  ds_write_b128 v101, v[104:107] offset:0
  v_mfma_f32_16x16x32_bf16 v[92:95], v[240:243], v[252:255], v[92:95]
  v_cvt_pk_bf16_f32 v108, v76, v77
  v_cvt_pk_bf16_f32 v109, v78, v79
  v_cvt_pk_bf16_f32 v110, v88, v89
  v_cvt_pk_bf16_f32 v111, v90, v91
  ds_write_b128 v102, v[108:111] offset:0
  s_nop 3
  v_cvt_pk_bf16_f32 v112, v80, v81
  v_cvt_pk_bf16_f32 v113, v82, v83
  v_cvt_pk_bf16_f32 v114, v92, v93
  v_cvt_pk_bf16_f32 v115, v94, v95
  ds_write_b128 v103, v[112:115] offset:0
  s_waitcnt lgkmcnt(0)
  s_barrier
  ds_read_b128 v[216:219], v2 offset:35840
  ds_read_b128 v[220:223], v2 offset:34816
  ds_read_b128 v[224:227], v2 offset:33792
  ds_read_b128 v[228:231], v2 offset:32768
  ds_read_b128 v[232:235], v2 offset:31744
  ds_read_b128 v[236:239], v2 offset:30720
  ds_read_b128 v[240:243], v2 offset:29696
  ds_read_b128 v[244:247], v2 offset:28672
  ds_read_b128 v[248:251], v2 offset:27648
  ds_read_b128 v[252:255], v2 offset:26624
  s_cbranch_vccz SL27
  s_waitcnt vmcnt(0)
  s_branch SM27
SL27:
  s_cmp_eq_u32 s3, 0
  s_cbranch_scc1 MK_np4
  s_waitcnt vmcnt(6)
  v_mov_b32 v23, 1
  s_mov_b64 exec, 1
  buffer_atomic_add v23, off, s[8:11], 0 sc1
  s_mov_b64 exec, -1
MK_np4:
  s_mul_i32 s100, s32, 9
  s_add_i32 s100, s100, s31
  s_add_u32 m0, s38, 138240
  s_nop 0
  buffer_load_dwordx4 v13, s[12:15], s100 offen lds
  s_add_u32 m0, s38, 139264
  s_nop 0
  buffer_load_dwordx4 v14, s[12:15], s100 offen lds
  s_add_u32 m0, s38, 140288
  s_nop 0
  buffer_load_dwordx4 v3, s[12:15], s100 offen lds
  s_add_u32 m0, s39, 138240
  s_nop 0
  buffer_load_dwordx4 v4, s[12:15], s100 offen lds
  s_mul_i32 s100, s32, 8
  s_add_i32 s100, s100, s31
  s_add_u32 m0, s38, 122880
  s_nop 0
  buffer_load_dwordx4 v13, s[12:15], s100 offen lds
  s_add_u32 m0, s38, 123904
  s_nop 0
  buffer_load_dwordx4 v14, s[12:15], s100 offen lds
  s_add_u32 m0, s38, 124928
  s_nop 0
  buffer_load_dwordx4 v3, s[12:15], s100 offen lds
  s_add_u32 m0, s39, 122880
  s_nop 0
  buffer_load_dwordx4 v4, s[12:15], s100 offen lds
  s_mul_i32 s100, s32, 7
  s_add_i32 s100, s100, s31
  s_add_u32 m0, s38, 107520
  s_nop 0
  buffer_load_dwordx4 v13, s[12:15], s100 offen lds
  s_add_u32 m0, s38, 108544
  s_nop 0
  buffer_load_dwordx4 v14, s[12:15], s100 offen lds
  s_add_u32 m0, s38, 109568
  s_nop 0
  buffer_load_dwordx4 v3, s[12:15], s100 offen lds
  s_add_u32 m0, s39, 107520
  s_nop 0
  buffer_load_dwordx4 v4, s[12:15], s100 offen lds
  s_waitcnt vmcnt(12)
SM27:
  s_waitcnt lgkmcnt(8)
  v_mfma_f32_16x16x32_bf16 v[184:187], v[216:219], v[136:139], 0
  v_mfma_f32_16x16x32_bf16 v[192:195], v[216:219], v[160:163], 0
  ds_read_b128 v[216:219], v2 offset:25600
  v_mfma_f32_16x16x32_bf16 v[188:191], v[220:223], v[136:139], 0
  v_mfma_f32_16x16x32_bf16 v[196:199], v[220:223], v[160:163], 0
  ds_read_b128 v[220:223], v2 offset:24576
  s_waitcnt lgkmcnt(8)
  v_mfma_f32_16x16x32_bf16 v[184:187], v[224:227], v[140:143], v[184:187]
  v_mfma_f32_16x16x32_bf16 v[192:195], v[224:227], v[164:167], v[192:195]
  ds_read_b128 v[224:227], v2 offset:23552
  v_mfma_f32_16x16x32_bf16 v[188:191], v[228:231], v[140:143], v[188:191]
  v_mfma_f32_16x16x32_bf16 v[196:199], v[228:231], v[164:167], v[196:199]
  ds_read_b128 v[228:231], v2 offset:22528
  s_waitcnt lgkmcnt(8)
  v_mfma_f32_16x16x32_bf16 v[184:187], v[232:235], v[144:147], v[184:187]
  v_mfma_f32_16x16x32_bf16 v[192:195], v[232:235], v[168:171], v[192:195]
  ds_read_b128 v[232:235], v2 offset:21504
  v_mfma_f32_16x16x32_bf16 v[188:191], v[236:239], v[144:147], v[188:191]
  v_mfma_f32_16x16x32_bf16 v[196:199], v[236:239], v[168:171], v[196:199]
  ds_read_b128 v[236:239], v2 offset:20480
  s_waitcnt lgkmcnt(8)
  v_mfma_f32_16x16x32_bf16 v[184:187], v[240:243], v[148:151], v[184:187]
  v_mfma_f32_16x16x32_bf16 v[192:195], v[240:243], v[172:175], v[192:195]
  ds_read_b128 v[240:243], v2 offset:19456
  v_mfma_f32_16x16x32_bf16 v[188:191], v[244:247], v[148:151], v[188:191]
  v_mfma_f32_16x16x32_bf16 v[196:199], v[244:247], v[172:175], v[196:199]
  ds_read_b128 v[244:247], v2 offset:18432
  s_waitcnt lgkmcnt(8)
  v_mfma_f32_16x16x32_bf16 v[184:187], v[248:251], v[152:155], v[184:187]
  v_mfma_f32_16x16x32_bf16 v[192:195], v[248:251], v[176:179], v[192:195]
  ds_read_b128 v[248:251], v2 offset:17408
  v_mfma_f32_16x16x32_bf16 v[188:191], v[252:255], v[152:155], v[188:191]
  v_mfma_f32_16x16x32_bf16 v[196:199], v[252:255], v[176:179], v[196:199]
  ds_read_b128 v[252:255], v2 offset:16384
  s_waitcnt lgkmcnt(8)
  v_mfma_f32_16x16x32_bf16 v[184:187], v[216:219], v[156:159], v[184:187]
  v_mfma_f32_16x16x32_bf16 v[192:195], v[216:219], v[180:183], v[192:195]
  ds_read_b128 v[216:219], v2 offset:15360
  v_mfma_f32_16x16x32_bf16 v[188:191], v[220:223], v[156:159], v[188:191]
  v_mfma_f32_16x16x32_bf16 v[196:199], v[220:223], v[180:183], v[196:199]
  ds_read_b128 v[220:223], v2 offset:14336
  s_waitcnt lgkmcnt(8)
  v_mfma_f32_16x16x32_bf16 v[200:203], v[224:227], v[136:139], 0
  v_mfma_f32_16x16x32_bf16 v[208:211], v[224:227], v[160:163], 0
  ds_read_b128 v[224:227], v2 offset:13312
  v_mul_f32 v184, s93, v184
  v_mfma_f32_16x16x32_bf16 v[204:207], v[228:231], v[136:139], 0
  v_mul_f32 v185, s93, v185
  v_mul_f32 v186, s93, v186
  v_mfma_f32_16x16x32_bf16 v[212:215], v[228:231], v[160:163], 0
  ds_read_b128 v[228:231], v2 offset:12288
  s_waitcnt lgkmcnt(8)
  v_mfma_f32_16x16x32_bf16 v[200:203], v[232:235], v[140:143], v[200:203]
  v_mul_f32 v187, s93, v187
  v_mul_f32 v188, s93, v188
  v_mfma_f32_16x16x32_bf16 v[208:211], v[232:235], v[164:167], v[208:211]
  ds_read_b128 v[232:235], v2 offset:11264
  v_mul_f32 v189, s93, v189
  v_mfma_f32_16x16x32_bf16 v[204:207], v[236:239], v[140:143], v[204:207]
  v_mul_f32 v190, s93, v190
  v_mul_f32 v191, s93, v191
  v_mfma_f32_16x16x32_bf16 v[212:215], v[236:239], v[164:167], v[212:215]
  ds_read_b128 v[236:239], v2 offset:10240
  s_waitcnt lgkmcnt(8)
  v_mfma_f32_16x16x32_bf16 v[200:203], v[240:243], v[144:147], v[200:203]
  v_cvt_pk_bf16_f32 v88, v184, v185
  v_cvt_pk_bf16_f32 v89, v186, v187
  v_mfma_f32_16x16x32_bf16 v[208:211], v[240:243], v[168:171], v[208:211]
  ds_read_b128 v[240:243], v2 offset:9216
  v_cvt_pk_bf16_f32 v90, v188, v189
  v_mfma_f32_16x16x32_bf16 v[204:207], v[244:247], v[144:147], v[204:207]
  v_cvt_pk_bf16_f32 v91, v190, v191
  v_mul_f32 v192, s93, v192
  v_mfma_f32_16x16x32_bf16 v[212:215], v[244:247], v[168:171], v[212:215]
  ds_read_b128 v[244:247], v2 offset:8192
  s_waitcnt lgkmcnt(8)
  v_mfma_f32_16x16x32_bf16 v[200:203], v[248:251], v[148:151], v[200:203]
  v_mul_f32 v193, s93, v193
  v_mul_f32 v194, s93, v194
  v_mfma_f32_16x16x32_bf16 v[208:211], v[248:251], v[172:175], v[208:211]
  ds_read_b128 v[248:251], v2 offset:7168
  v_mul_f32 v195, s93, v195
  v_mfma_f32_16x16x32_bf16 v[204:207], v[252:255], v[148:151], v[204:207]
  v_mul_f32 v196, s93, v196
  v_mul_f32 v197, s93, v197
  v_mfma_f32_16x16x32_bf16 v[212:215], v[252:255], v[172:175], v[212:215]
  ds_read_b128 v[252:255], v2 offset:6144
  s_waitcnt lgkmcnt(8)
  v_mfma_f32_16x16x32_bf16 v[200:203], v[216:219], v[152:155], v[200:203]
  v_mul_f32 v198, s93, v198
  v_mul_f32 v199, s93, v199
  v_mfma_f32_16x16x32_bf16 v[208:211], v[216:219], v[176:179], v[208:211]
  ds_read_b128 v[216:219], v2 offset:5120
  v_cvt_pk_bf16_f32 v112, v192, v193
  v_mfma_f32_16x16x32_bf16 v[204:207], v[220:223], v[152:155], v[204:207]
  v_cvt_pk_bf16_f32 v113, v194, v195
  v_cvt_pk_bf16_f32 v114, v196, v197
  v_mfma_f32_16x16x32_bf16 v[212:215], v[220:223], v[176:179], v[212:215]
  ds_read_b128 v[220:223], v2 offset:4096
  s_waitcnt lgkmcnt(8)
  v_mfma_f32_16x16x32_bf16 v[200:203], v[224:227], v[156:159], v[200:203]
  v_cvt_pk_bf16_f32 v115, v198, v199
  v_mfma_f32_16x16x32_bf16 v[208:211], v[224:227], v[180:183], v[208:211]
  ds_read_b128 v[224:227], v2 offset:3072
  v_mfma_f32_16x16x32_bf16 v[204:207], v[228:231], v[156:159], v[204:207]
  v_mfma_f32_16x16x32_bf16 v[212:215], v[228:231], v[180:183], v[212:215]
  ds_read_b128 v[228:231], v2 offset:2048
  s_waitcnt lgkmcnt(8)
  v_mfma_f32_16x16x32_bf16 v[184:187], v[232:235], v[136:139], 0
  v_mul_f32 v200, s93, v200
  v_mul_f32 v201, s93, v201
  v_mfma_f32_16x16x32_bf16 v[192:195], v[232:235], v[160:163], 0
  ds_read_b128 v[232:235], v2 offset:1024
  v_mul_f32 v202, s93, v202
  v_mfma_f32_16x16x32_bf16 v[188:191], v[236:239], v[136:139], 0
  v_mul_f32 v203, s93, v203
  v_mul_f32 v204, s93, v204
  v_mfma_f32_16x16x32_bf16 v[196:199], v[236:239], v[160:163], 0
  ds_read_b128 v[236:239], v2 offset:0
  s_waitcnt lgkmcnt(8)
  v_mfma_f32_16x16x32_bf16 v[184:187], v[240:243], v[140:143], v[184:187]
  v_mul_f32 v205, s93, v205
  v_mul_f32 v206, s93, v206
  v_mfma_f32_16x16x32_bf16 v[192:195], v[240:243], v[164:167], v[192:195]
  ds_read_b128 v[240:243], v1 offset:35840
  v_mul_f32 v207, s93, v207
  v_mfma_f32_16x16x32_bf16 v[188:191], v[244:247], v[140:143], v[188:191]
  v_cvt_pk_bf16_f32 v92, v200, v201
  v_cvt_pk_bf16_f32 v93, v202, v203
  v_mfma_f32_16x16x32_bf16 v[196:199], v[244:247], v[164:167], v[196:199]
  ds_read_b128 v[244:247], v1 offset:34816
  s_waitcnt lgkmcnt(8)
  v_mfma_f32_16x16x32_bf16 v[184:187], v[248:251], v[144:147], v[184:187]
  v_cvt_pk_bf16_f32 v94, v204, v205
  v_cvt_pk_bf16_f32 v95, v206, v207
  v_mfma_f32_16x16x32_bf16 v[192:195], v[248:251], v[168:171], v[192:195]
  ds_read_b128 v[248:251], v1 offset:33792
  v_mul_f32 v208, s93, v208
  v_mfma_f32_16x16x32_bf16 v[188:191], v[252:255], v[144:147], v[188:191]
  v_mul_f32 v209, s93, v209
  v_mul_f32 v210, s93, v210
  v_mfma_f32_16x16x32_bf16 v[196:199], v[252:255], v[168:171], v[196:199]
  ds_read_b128 v[252:255], v1 offset:32768
  s_waitcnt lgkmcnt(8)
  v_mfma_f32_16x16x32_bf16 v[184:187], v[216:219], v[148:151], v[184:187]
  v_mul_f32 v211, s93, v211
  v_mul_f32 v212, s93, v212
  v_mfma_f32_16x16x32_bf16 v[192:195], v[216:219], v[172:175], v[192:195]
  ds_read_b128 v[216:219], v1 offset:31744
  v_mul_f32 v213, s93, v213
  s_cbranch_vccnz SL28
  s_barrier
SL28:
  v_mfma_f32_16x16x32_bf16 v[188:191], v[220:223], v[148:151], v[188:191]
  v_mul_f32 v214, s93, v214
  v_mul_f32 v215, s93, v215
  v_mfma_f32_16x16x32_bf16 v[196:199], v[220:223], v[172:175], v[196:199]
  ds_read_b128 v[220:223], v1 offset:30720
  s_waitcnt lgkmcnt(8)
  v_mfma_f32_16x16x32_bf16 v[184:187], v[224:227], v[152:155], v[184:187]
  v_cvt_pk_bf16_f32 v116, v208, v209
  v_cvt_pk_bf16_f32 v117, v210, v211
  v_mfma_f32_16x16x32_bf16 v[192:195], v[224:227], v[176:179], v[192:195]
  ds_read_b128 v[224:227], v1 offset:29696
  v_cvt_pk_bf16_f32 v118, v212, v213
  v_mfma_f32_16x16x32_bf16 v[188:191], v[228:231], v[152:155], v[188:191]
  v_cvt_pk_bf16_f32 v119, v214, v215
  v_mfma_f32_16x16x32_bf16 v[196:199], v[228:231], v[176:179], v[196:199]
  ds_read_b128 v[228:231], v1 offset:28672
  s_waitcnt lgkmcnt(8)
  v_mfma_f32_16x16x32_bf16 v[184:187], v[232:235], v[156:159], v[184:187]
  v_mfma_f32_16x16x32_bf16 v[192:195], v[232:235], v[180:183], v[192:195]
  ds_read_b128 v[232:235], v1 offset:27648
  v_mfma_f32_16x16x32_bf16 v[188:191], v[236:239], v[156:159], v[188:191]
  v_mfma_f32_16x16x32_bf16 v[196:199], v[236:239], v[180:183], v[196:199]
  ds_read_b128 v[236:239], v1 offset:26624
  s_waitcnt lgkmcnt(8)
  v_mfma_f32_16x16x32_bf16 v[200:203], v[240:243], v[136:139], 0
  v_mfma_f32_16x16x32_bf16 v[208:211], v[240:243], v[160:163], 0
  ds_read_b128 v[240:243], v1 offset:25600
  v_mul_f32 v184, s93, v184
  v_mfma_f32_16x16x32_bf16 v[204:207], v[244:247], v[136:139], 0
  v_mul_f32 v185, s93, v185
  v_mul_f32 v186, s93, v186
  v_mfma_f32_16x16x32_bf16 v[212:215], v[244:247], v[160:163], 0
  ds_read_b128 v[244:247], v1 offset:24576
  s_waitcnt lgkmcnt(8)
  v_mfma_f32_16x16x32_bf16 v[200:203], v[248:251], v[140:143], v[200:203]
  v_mul_f32 v187, s93, v187
  v_mul_f32 v188, s93, v188
  v_mfma_f32_16x16x32_bf16 v[208:211], v[248:251], v[164:167], v[208:211]
  ds_read_b128 v[248:251], v1 offset:23552
  v_mul_f32 v189, s93, v189
  v_mfma_f32_16x16x32_bf16 v[204:207], v[252:255], v[140:143], v[204:207]
  v_mul_f32 v190, s93, v190
  v_mul_f32 v191, s93, v191
  v_mfma_f32_16x16x32_bf16 v[212:215], v[252:255], v[164:167], v[212:215]
  ds_read_b128 v[252:255], v1 offset:22528
  s_waitcnt lgkmcnt(8)
  v_mfma_f32_16x16x32_bf16 v[200:203], v[216:219], v[144:147], v[200:203]
  v_cvt_pk_bf16_f32 v96, v184, v185
  v_cvt_pk_bf16_f32 v97, v186, v187
  v_mfma_f32_16x16x32_bf16 v[208:211], v[216:219], v[168:171], v[208:211]
  ds_read_b128 v[216:219], v1 offset:21504
  v_cvt_pk_bf16_f32 v98, v188, v189
  v_mfma_f32_16x16x32_bf16 v[204:207], v[220:223], v[144:147], v[204:207]
  v_cvt_pk_bf16_f32 v99, v190, v191
  v_mul_f32 v192, s93, v192
  v_mfma_f32_16x16x32_bf16 v[212:215], v[220:223], v[168:171], v[212:215]
  ds_read_b128 v[220:223], v1 offset:20480
  s_waitcnt lgkmcnt(8)
  v_mfma_f32_16x16x32_bf16 v[200:203], v[224:227], v[148:151], v[200:203]
  v_mul_f32 v193, s93, v193
  v_mul_f32 v194, s93, v194
  v_mfma_f32_16x16x32_bf16 v[208:211], v[224:227], v[172:175], v[208:211]
  ds_read_b128 v[224:227], v1 offset:19456
  v_mul_f32 v195, s93, v195
  v_mfma_f32_16x16x32_bf16 v[204:207], v[228:231], v[148:151], v[204:207]
  v_mul_f32 v196, s93, v196
  v_mul_f32 v197, s93, v197
  v_mfma_f32_16x16x32_bf16 v[212:215], v[228:231], v[172:175], v[212:215]
  ds_read_b128 v[228:231], v1 offset:18432
  s_waitcnt lgkmcnt(8)
  v_mfma_f32_16x16x32_bf16 v[200:203], v[232:235], v[152:155], v[200:203]
  v_mul_f32 v198, s93, v198
  v_mul_f32 v199, s93, v199
  v_mfma_f32_16x16x32_bf16 v[208:211], v[232:235], v[176:179], v[208:211]
  ds_read_b128 v[232:235], v1 offset:17408
  v_cvt_pk_bf16_f32 v120, v192, v193
  v_mfma_f32_16x16x32_bf16 v[204:207], v[236:239], v[152:155], v[204:207]
  v_cvt_pk_bf16_f32 v121, v194, v195
  v_cvt_pk_bf16_f32 v122, v196, v197
  v_mfma_f32_16x16x32_bf16 v[212:215], v[236:239], v[176:179], v[212:215]
  ds_read_b128 v[236:239], v1 offset:16384
  s_waitcnt lgkmcnt(8)
  v_mfma_f32_16x16x32_bf16 v[200:203], v[240:243], v[156:159], v[200:203]
  v_cvt_pk_bf16_f32 v123, v198, v199
  v_mfma_f32_16x16x32_bf16 v[208:211], v[240:243], v[180:183], v[208:211]
  ds_read_b128 v[240:243], v1 offset:15360
  v_mfma_f32_16x16x32_bf16 v[204:207], v[244:247], v[156:159], v[204:207]
  v_mfma_f32_16x16x32_bf16 v[212:215], v[244:247], v[180:183], v[212:215]
  ds_read_b128 v[244:247], v1 offset:14336
  s_waitcnt lgkmcnt(8)
  v_mfma_f32_16x16x32_bf16 v[184:187], v[248:251], v[136:139], 0
  v_mul_f32 v200, s93, v200
  v_mul_f32 v201, s93, v201
  v_mfma_f32_16x16x32_bf16 v[192:195], v[248:251], v[160:163], 0
  ds_read_b128 v[248:251], v1 offset:13312
  v_mul_f32 v202, s93, v202
  v_mfma_f32_16x16x32_bf16 v[188:191], v[252:255], v[136:139], 0
  v_mul_f32 v203, s93, v203
  v_mul_f32 v204, s93, v204
  v_mfma_f32_16x16x32_bf16 v[196:199], v[252:255], v[160:163], 0
  ds_read_b128 v[252:255], v1 offset:12288
  s_waitcnt lgkmcnt(8)
  v_mfma_f32_16x16x32_bf16 v[184:187], v[216:219], v[140:143], v[184:187]
  v_mul_f32 v205, s93, v205
  v_mul_f32 v206, s93, v206
  v_mfma_f32_16x16x32_bf16 v[192:195], v[216:219], v[164:167], v[192:195]
  ds_read_b128 v[216:219], v1 offset:11264
  v_mul_f32 v207, s93, v207
  v_mfma_f32_16x16x32_bf16 v[188:191], v[220:223], v[140:143], v[188:191]
  v_cvt_pk_bf16_f32 v100, v200, v201
  v_cvt_pk_bf16_f32 v101, v202, v203
  v_mfma_f32_16x16x32_bf16 v[196:199], v[220:223], v[164:167], v[196:199]
  ds_read_b128 v[220:223], v1 offset:10240
  s_waitcnt lgkmcnt(8)
  v_mfma_f32_16x16x32_bf16 v[184:187], v[224:227], v[144:147], v[184:187]
  v_cvt_pk_bf16_f32 v102, v204, v205
  v_cvt_pk_bf16_f32 v103, v206, v207
  v_mfma_f32_16x16x32_bf16 v[192:195], v[224:227], v[168:171], v[192:195]
  ds_read_b128 v[224:227], v1 offset:9216
  v_mul_f32 v208, s93, v208
  v_mfma_f32_16x16x32_bf16 v[188:191], v[228:231], v[144:147], v[188:191]
  v_mul_f32 v209, s93, v209
  v_mul_f32 v210, s93, v210
  v_mfma_f32_16x16x32_bf16 v[196:199], v[228:231], v[168:171], v[196:199]
  ds_read_b128 v[228:231], v1 offset:8192
  s_waitcnt lgkmcnt(8)
  v_mfma_f32_16x16x32_bf16 v[184:187], v[232:235], v[148:151], v[184:187]
  v_mul_f32 v211, s93, v211
  v_mul_f32 v212, s93, v212
  v_mfma_f32_16x16x32_bf16 v[192:195], v[232:235], v[172:175], v[192:195]
  ds_read_b128 v[232:235], v1 offset:7168
  v_mul_f32 v213, s93, v213
  v_mfma_f32_16x16x32_bf16 v[188:191], v[236:239], v[148:151], v[188:191]
  v_mul_f32 v214, s93, v214
  v_mul_f32 v215, s93, v215
  v_mfma_f32_16x16x32_bf16 v[196:199], v[236:239], v[172:175], v[196:199]
  ds_read_b128 v[236:239], v1 offset:6144
  s_waitcnt lgkmcnt(8)
  v_mfma_f32_16x16x32_bf16 v[184:187], v[240:243], v[152:155], v[184:187]
  v_cvt_pk_bf16_f32 v124, v208, v209
  v_cvt_pk_bf16_f32 v125, v210, v211
  v_mfma_f32_16x16x32_bf16 v[192:195], v[240:243], v[176:179], v[192:195]
  ds_read_b128 v[240:243], v1 offset:5120
  v_cvt_pk_bf16_f32 v126, v212, v213
  v_mfma_f32_16x16x32_bf16 v[188:191], v[244:247], v[152:155], v[188:191]
  v_cvt_pk_bf16_f32 v127, v214, v215
  v_mfma_f32_16x16x32_bf16 v[196:199], v[244:247], v[176:179], v[196:199]
  ds_read_b128 v[244:247], v1 offset:4096
  s_waitcnt lgkmcnt(8)
  v_mfma_f32_16x16x32_bf16 v[184:187], v[248:251], v[156:159], v[184:187]
  v_mfma_f32_16x16x32_bf16 v[192:195], v[248:251], v[180:183], v[192:195]
  ds_read_b128 v[248:251], v1 offset:3072
  v_mfma_f32_16x16x32_bf16 v[188:191], v[252:255], v[156:159], v[188:191]
  v_mfma_f32_16x16x32_bf16 v[196:199], v[252:255], v[180:183], v[196:199]
  ds_read_b128 v[252:255], v1 offset:2048
  s_waitcnt lgkmcnt(8)
  v_mfma_f32_16x16x32_bf16 v[200:203], v[216:219], v[136:139], 0
  v_mfma_f32_16x16x32_bf16 v[208:211], v[216:219], v[160:163], 0
  ds_read_b128 v[216:219], v1 offset:1024
  v_mul_f32 v184, s93, v184
  s_cbranch_vccnz SL29
  s_waitcnt vmcnt(0)
  s_barrier
SL29:
  v_mfma_f32_16x16x32_bf16 v[204:207], v[220:223], v[136:139], 0
  v_mul_f32 v185, s93, v185
  v_mul_f32 v186, s93, v186
  v_mfma_f32_16x16x32_bf16 v[212:215], v[220:223], v[160:163], 0
  ds_read_b128 v[220:223], v1 offset:0
  s_waitcnt lgkmcnt(8)
  v_mfma_f32_16x16x32_bf16 v[200:203], v[224:227], v[140:143], v[200:203]
  v_mul_f32 v187, s93, v187
  v_mul_f32 v188, s93, v188
  v_mfma_f32_16x16x32_bf16 v[208:211], v[224:227], v[164:167], v[208:211]
  v_mul_f32 v189, s93, v189
  v_mul_f32 v190, s93, v190
  v_mfma_f32_16x16x32_bf16 v[204:207], v[228:231], v[140:143], v[204:207]
  v_mul_f32 v191, s93, v191
  v_cvt_pk_bf16_f32 v104, v184, v185
  v_mfma_f32_16x16x32_bf16 v[212:215], v[228:231], v[164:167], v[212:215]
  v_cvt_pk_bf16_f32 v105, v186, v187
  s_waitcnt lgkmcnt(6)
  v_mfma_f32_16x16x32_bf16 v[200:203], v[232:235], v[144:147], v[200:203]
  v_cvt_pk_bf16_f32 v106, v188, v189
  v_cvt_pk_bf16_f32 v107, v190, v191
  v_mfma_f32_16x16x32_bf16 v[208:211], v[232:235], v[168:171], v[208:211]
  v_mul_f32 v192, s93, v192
  v_mul_f32 v193, s93, v193
  v_mfma_f32_16x16x32_bf16 v[204:207], v[236:239], v[144:147], v[204:207]
  v_mul_f32 v194, s93, v194
  v_mul_f32 v195, s93, v195
  v_mfma_f32_16x16x32_bf16 v[212:215], v[236:239], v[168:171], v[212:215]
  v_mul_f32 v196, s93, v196
  s_waitcnt lgkmcnt(5)
  v_mfma_f32_16x16x32_bf16 v[200:203], v[240:243], v[148:151], v[200:203]
  v_mul_f32 v197, s93, v197
  v_mul_f32 v198, s93, v198
  v_mfma_f32_16x16x32_bf16 v[208:211], v[240:243], v[172:175], v[208:211]
  v_mul_f32 v199, s93, v199
  s_waitcnt lgkmcnt(4)
  v_mfma_f32_16x16x32_bf16 v[204:207], v[244:247], v[148:151], v[204:207]
  v_cvt_pk_bf16_f32 v128, v192, v193
  v_cvt_pk_bf16_f32 v129, v194, v195
  v_mfma_f32_16x16x32_bf16 v[212:215], v[244:247], v[172:175], v[212:215]
  v_cvt_pk_bf16_f32 v130, v196, v197
  s_waitcnt lgkmcnt(3)
  v_mfma_f32_16x16x32_bf16 v[200:203], v[248:251], v[152:155], v[200:203]
  v_cvt_pk_bf16_f32 v131, v198, v199
  v_mfma_f32_16x16x32_bf16 v[208:211], v[248:251], v[176:179], v[208:211]
  s_waitcnt lgkmcnt(2)
  v_mfma_f32_16x16x32_bf16 v[204:207], v[252:255], v[152:155], v[204:207]
  v_mfma_f32_16x16x32_bf16 v[212:215], v[252:255], v[176:179], v[212:215]
  s_waitcnt lgkmcnt(1)
  v_mfma_f32_16x16x32_bf16 v[200:203], v[216:219], v[156:159], v[200:203]
  v_mfma_f32_16x16x32_bf16 v[208:211], v[216:219], v[180:183], v[208:211]
  s_waitcnt lgkmcnt(0)
  v_mfma_f32_16x16x32_bf16 v[204:207], v[220:223], v[156:159], v[204:207]
  v_mfma_f32_16x16x32_bf16 v[212:215], v[220:223], v[180:183], v[212:215]
  s_nop 3
  v_mul_f32 v200, s93, v200
  v_mul_f32 v201, s93, v201
  v_mul_f32 v202, s93, v202
  v_mul_f32 v203, s93, v203
  v_mul_f32 v204, s93, v204
  v_mul_f32 v205, s93, v205
  v_mul_f32 v206, s93, v206
  v_mul_f32 v207, s93, v207
  v_cvt_pk_bf16_f32 v108, v200, v201
  v_cvt_pk_bf16_f32 v109, v202, v203
  v_cvt_pk_bf16_f32 v110, v204, v205
  v_cvt_pk_bf16_f32 v111, v206, v207
  v_mul_f32 v208, s93, v208
  v_mul_f32 v209, s93, v209
  v_mul_f32 v210, s93, v210
  v_mul_f32 v211, s93, v211
  v_mul_f32 v212, s93, v212
  v_mul_f32 v213, s93, v213
  v_mul_f32 v214, s93, v214
  v_mul_f32 v215, s93, v215
  v_cvt_pk_bf16_f32 v132, v208, v209
  v_cvt_pk_bf16_f32 v133, v210, v211
  v_cvt_pk_bf16_f32 v134, v212, v213
  v_cvt_pk_bf16_f32 v135, v214, v215
  v_add_u32 v2, 102400, v1
  v_mov_b32 v192, 0x3f803f80
  v_mov_b32 v193, 0x3f803f80
  v_mov_b32 v194, 0x3f803f80
  v_mov_b32 v195, 0x3f803f80
  s_cbranch_vccz SL30
  s_mul_i32 s100, s32, 6
  s_add_i32 s100, s100, s31
  s_add_u32 m0, s38, 92160
  s_nop 0
  buffer_load_dwordx4 v13, s[12:15], s100 offen lds
  s_add_u32 m0, s38, 93184
  s_nop 0
  buffer_load_dwordx4 v14, s[12:15], s100 offen lds
  s_add_u32 m0, s38, 94208
  s_nop 0
  buffer_load_dwordx4 v3, s[12:15], s100 offen lds
  s_add_u32 m0, s39, 92160
  s_nop 0
  buffer_load_dwordx4 v4, s[12:15], s100 offen lds
  s_mul_i32 s100, s32, 5
  s_add_i32 s100, s100, s31
  s_add_u32 m0, s38, 76800
  s_nop 0
  buffer_load_dwordx4 v13, s[12:15], s100 offen lds
  s_add_u32 m0, s38, 77824
  s_nop 0
  buffer_load_dwordx4 v14, s[12:15], s100 offen lds
  s_add_u32 m0, s38, 78848
  s_nop 0
  buffer_load_dwordx4 v3, s[12:15], s100 offen lds
  s_add_u32 m0, s39, 76800
  s_nop 0
  buffer_load_dwordx4 v4, s[12:15], s100 offen lds
  s_barrier
  s_mul_i32 s100, s32, 4
  s_add_i32 s100, s100, s31
  s_add_u32 m0, s38, 61440
  s_nop 0
  buffer_load_dwordx4 v13, s[12:15], s100 offen lds
  s_add_u32 m0, s38, 62464
  s_nop 0
  buffer_load_dwordx4 v14, s[12:15], s100 offen lds
  s_add_u32 m0, s38, 63488
  s_nop 0
  buffer_load_dwordx4 v3, s[12:15], s100 offen lds
  s_add_u32 m0, s39, 61440
  s_nop 0
  buffer_load_dwordx4 v4, s[12:15], s100 offen lds
  s_mul_i32 s100, s32, 3
  s_add_i32 s100, s100, s31
  s_add_u32 m0, s38, 46080
  s_nop 0
  buffer_load_dwordx4 v13, s[12:15], s100 offen lds
  s_add_u32 m0, s38, 47104
  s_nop 0
  buffer_load_dwordx4 v14, s[12:15], s100 offen lds
  s_add_u32 m0, s38, 48128
  s_nop 0
  buffer_load_dwordx4 v3, s[12:15], s100 offen lds
  s_add_u32 m0, s39, 46080
  s_nop 0
  buffer_load_dwordx4 v4, s[12:15], s100 offen lds
  s_mul_i32 s100, s32, 2
  s_add_i32 s100, s100, s31
  s_add_u32 m0, s38, 30720
  s_nop 0
  buffer_load_dwordx4 v13, s[12:15], s100 offen lds
  s_add_u32 m0, s38, 31744
  s_nop 0
  buffer_load_dwordx4 v14, s[12:15], s100 offen lds
  s_add_u32 m0, s38, 32768
  s_nop 0
  buffer_load_dwordx4 v3, s[12:15], s100 offen lds
  s_add_u32 m0, s39, 30720
  s_nop 0
  buffer_load_dwordx4 v4, s[12:15], s100 offen lds
SL30:
  v_mov_b32 v140, 0xff800000
  v_add_u32 v141, 0, v19
  v_add_u32 v142, 1, v19
  v_add_u32 v143, 2, v19
  v_add_u32 v144, 3, v19
  v_cmp_gt_u32 s[48:49], 7, v141
  v_cmp_gt_u32 s[50:51], 7, v142
  v_cmp_gt_u32 s[52:53], 7, v143
  v_cmp_gt_u32 s[54:55], 7, v144
  v_cndmask_b32 v136, v140, 0, s[48:49]
  v_cndmask_b32 v137, v140, 0, s[50:51]
  v_cndmask_b32 v138, v140, 0, s[52:53]
  v_cndmask_b32 v139, v140, 0, s[54:55]
  v_sub_u32 v141, s35, v21
  s_add_i32 s46, s34, 0
  v_sub_u32 v142, s46, v21
  s_add_i32 s46, s34, 1
  v_sub_u32 v143, s46, v21
  s_add_i32 s46, s34, 2
  v_sub_u32 v144, s46, v21
  v_cmp_gt_u32 s[48:49], 7, v141
  v_cmp_gt_u32 s[50:51], 7, v142
  v_cmp_gt_u32 s[52:53], 7, v143
  v_cmp_gt_u32 s[54:55], 7, v144
  v_cndmask_b32 v24, v140, v136, s[48:49]
  v_cndmask_b32 v25, v140, v137, s[48:49]
  v_cndmask_b32 v26, v140, v138, s[48:49]
  v_cndmask_b32 v27, v140, v139, s[48:49]
  v_cndmask_b32 v28, v140, v136, s[50:51]
  v_cndmask_b32 v29, v140, v137, s[50:51]
  v_cndmask_b32 v30, v140, v138, s[50:51]
  v_cndmask_b32 v31, v140, v139, s[50:51]
  v_cndmask_b32 v32, v140, v136, s[52:53]
  v_cndmask_b32 v33, v140, v137, s[52:53]
  v_cndmask_b32 v34, v140, v138, s[52:53]
  v_cndmask_b32 v35, v140, v139, s[52:53]
  v_cndmask_b32 v36, v140, v136, s[54:55]
  v_cndmask_b32 v37, v140, v137, s[54:55]
  v_cndmask_b32 v38, v140, v138, s[54:55]
  v_cndmask_b32 v39, v140, v139, s[54:55]
  s_add_i32 s46, s34, 3
  v_sub_u32 v141, s46, v21
  s_add_i32 s46, s34, 4
  v_sub_u32 v142, s46, v21
  s_add_i32 s46, s34, 5
  v_sub_u32 v143, s46, v21
  s_add_i32 s46, s34, 6
  v_sub_u32 v144, s46, v21
  v_cmp_gt_u32 s[48:49], 7, v141
  v_cmp_gt_u32 s[50:51], 7, v142
  v_cmp_gt_u32 s[52:53], 7, v143
  v_cmp_gt_u32 s[54:55], 7, v144
  v_cndmask_b32 v40, v140, v136, s[48:49]
  v_cndmask_b32 v41, v140, v137, s[48:49]
  v_cndmask_b32 v42, v140, v138, s[48:49]
  v_cndmask_b32 v43, v140, v139, s[48:49]
  v_cndmask_b32 v44, v140, v136, s[50:51]
  v_cndmask_b32 v45, v140, v137, s[50:51]
  v_cndmask_b32 v46, v140, v138, s[50:51]
  v_cndmask_b32 v47, v140, v139, s[50:51]
  v_cndmask_b32 v48, v140, v136, s[52:53]
  v_cndmask_b32 v49, v140, v137, s[52:53]
  v_cndmask_b32 v50, v140, v138, s[52:53]
  v_cndmask_b32 v51, v140, v139, s[52:53]
  v_cndmask_b32 v52, v140, v136, s[54:55]
  v_cndmask_b32 v53, v140, v137, s[54:55]
  v_cndmask_b32 v54, v140, v138, s[54:55]
  v_cndmask_b32 v55, v140, v139, s[54:55]
  s_add_i32 s46, s34, 1
  v_sub_u32 v141, s46, v22
  s_add_i32 s46, s34, 2
  v_sub_u32 v142, s46, v22
  s_add_i32 s46, s34, 3
  v_sub_u32 v143, s46, v22
  s_add_i32 s46, s34, 4
  v_sub_u32 v144, s46, v22
  v_cmp_gt_u32 s[48:49], 7, v141
  v_cmp_gt_u32 s[50:51], 7, v142
  v_cmp_gt_u32 s[52:53], 7, v143
  v_cmp_gt_u32 s[54:55], 7, v144
  v_cndmask_b32 v56, v140, v136, s[48:49]
  v_cndmask_b32 v57, v140, v137, s[48:49]
  v_cndmask_b32 v58, v140, v138, s[48:49]
  v_cndmask_b32 v59, v140, v139, s[48:49]
  v_cndmask_b32 v60, v140, v136, s[50:51]
  v_cndmask_b32 v61, v140, v137, s[50:51]
  v_cndmask_b32 v62, v140, v138, s[50:51]
  v_cndmask_b32 v63, v140, v139, s[50:51]
  v_cndmask_b32 v64, v140, v136, s[52:53]
  v_cndmask_b32 v65, v140, v137, s[52:53]
  v_cndmask_b32 v66, v140, v138, s[52:53]
  v_cndmask_b32 v67, v140, v139, s[52:53]
  v_cndmask_b32 v68, v140, v136, s[54:55]
  v_cndmask_b32 v69, v140, v137, s[54:55]
  v_cndmask_b32 v70, v140, v138, s[54:55]
  v_cndmask_b32 v71, v140, v139, s[54:55]
  s_add_i32 s46, s34, 5
  v_sub_u32 v141, s46, v22
  s_add_i32 s46, s34, 6
  v_sub_u32 v142, s46, v22
  s_add_i32 s46, s34, 7
  v_sub_u32 v143, s46, v22
  s_add_i32 s46, s34, 8
  v_sub_u32 v144, s46, v22
  v_cmp_gt_u32 s[48:49], 7, v141
  v_cmp_gt_u32 s[50:51], 7, v142
  v_cmp_gt_u32 s[52:53], 7, v143
  v_cmp_gt_u32 s[54:55], 7, v144
  v_cndmask_b32 v72, v140, v136, s[48:49]
  v_cndmask_b32 v73, v140, v137, s[48:49]
  v_cndmask_b32 v74, v140, v138, s[48:49]
  v_cndmask_b32 v75, v140, v139, s[48:49]
  v_cndmask_b32 v76, v140, v136, s[50:51]
  v_cndmask_b32 v77, v140, v137, s[50:51]
  v_cndmask_b32 v78, v140, v138, s[50:51]
  v_cndmask_b32 v79, v140, v139, s[50:51]
  v_cndmask_b32 v80, v140, v136, s[52:53]
  v_cndmask_b32 v81, v140, v137, s[52:53]
  v_cndmask_b32 v82, v140, v138, s[52:53]
  v_cndmask_b32 v83, v140, v139, s[52:53]
  v_cndmask_b32 v84, v140, v136, s[54:55]
  v_cndmask_b32 v85, v140, v137, s[54:55]
  v_cndmask_b32 v86, v140, v138, s[54:55]
  v_cndmask_b32 v87, v140, v139, s[54:55]
  s_cbranch_vccz SL31
  s_waitcnt vmcnt(12)
  s_barrier
  s_max_u32 s100, s33, 1
  s_mul_i32 s100, s100, s32
  s_add_i32 s100, s100, s31
  s_add_u32 m0, s38, 15360
  s_nop 0
  buffer_load_dwordx4 v13, s[12:15], s100 offen lds
  s_add_u32 m0, s38, 16384
  s_nop 0
  buffer_load_dwordx4 v14, s[12:15], s100 offen lds
  s_add_u32 m0, s38, 17408
  s_nop 0
  buffer_load_dwordx4 v3, s[12:15], s100 offen lds
  s_add_u32 m0, s39, 15360
  s_nop 0
  buffer_load_dwordx4 v4, s[12:15], s100 offen lds
  s_max_u32 s100, s33, 0
  s_mul_i32 s100, s100, s32
  s_add_i32 s100, s100, s31
  s_add_u32 m0, s38, 0
  s_nop 0
  buffer_load_dwordx4 v13, s[12:15], s100 offen lds
  s_add_u32 m0, s38, 1024
  s_nop 0
  buffer_load_dwordx4 v14, s[12:15], s100 offen lds
  s_add_u32 m0, s38, 2048
  s_nop 0
  buffer_load_dwordx4 v3, s[12:15], s100 offen lds
  s_add_u32 m0, s39, 0
  s_nop 0
  buffer_load_dwordx4 v4, s[12:15], s100 offen lds
  s_branch SM31
SL31:
  s_barrier
SM31:
  ds_read_b128 v[224:227], v7 offset:61440
  ds_read_b128 v[228:231], v8 offset:61440
  ds_read_b128 v[232:235], v7 offset:61568
  ds_read_b128 v[236:239], v8 offset:61568
  ds_read_b128 v[240:243], v7 offset:61696
  ds_read_b128 v[244:247], v8 offset:61696
  ds_read_b128 v[248:251], v7 offset:53760
  ds_read_b128 v[252:255], v8 offset:53760
  ds_read_b128 v[216:219], v7 offset:53888
  ds_read_b128 v[220:223], v8 offset:53888
  s_waitcnt lgkmcnt(8)
  v_mfma_f32_16x16x32_bf16 v[84:87], v[224:227], v[112:115], v[84:87]
  ds_read_b128 v[224:227], v7 offset:54016
  v_mfma_f32_16x16x32_bf16 v[84:87], v[228:231], v[116:119], v[84:87]
  ds_read_b128 v[228:231], v8 offset:54016
  s_waitcnt lgkmcnt(8)
  v_mfma_f32_16x16x32_bf16 v[84:87], v[232:235], v[120:123], v[84:87]
  ds_read_b128 v[232:235], v7 offset:46080
  v_mfma_f32_16x16x32_bf16 v[84:87], v[236:239], v[124:127], v[84:87]
  ds_read_b128 v[236:239], v8 offset:46080
  s_waitcnt lgkmcnt(8)
  v_mfma_f32_16x16x32_bf16 v[84:87], v[240:243], v[128:131], v[84:87]
  ds_read_b128 v[240:243], v7 offset:46208
  v_mfma_f32_16x16x32_bf16 v[84:87], v[244:247], v[132:135], v[84:87]
  ds_read_b128 v[244:247], v8 offset:46208
  s_waitcnt lgkmcnt(8)
  v_mfma_f32_16x16x32_bf16 v[80:83], v[248:251], v[112:115], v[80:83]
  ds_read_b128 v[248:251], v7 offset:46336
  v_mfma_f32_16x16x32_bf16 v[80:83], v[252:255], v[116:119], v[80:83]
  ds_read_b128 v[252:255], v8 offset:46336
  s_waitcnt lgkmcnt(8)
  v_mfma_f32_16x16x32_bf16 v[80:83], v[216:219], v[120:123], v[80:83]
  ds_read_b128 v[216:219], v7 offset:38400
  v_mfma_f32_16x16x32_bf16 v[80:83], v[220:223], v[124:127], v[80:83]
  ds_read_b128 v[220:223], v8 offset:38400
  s_waitcnt lgkmcnt(8)
  v_mfma_f32_16x16x32_bf16 v[80:83], v[224:227], v[128:131], v[80:83]
  ds_read_b128 v[224:227], v7 offset:38528
  v_mfma_f32_16x16x32_bf16 v[80:83], v[228:231], v[132:135], v[80:83]
  ds_read_b128 v[228:231], v8 offset:38528
  s_cbranch_vccz SL32
  s_waitcnt vmcnt(8)
  s_barrier
  s_branch SM32
SL32:
  s_barrier
SM32:
  s_waitcnt lgkmcnt(8)
  v_mfma_f32_16x16x32_bf16 v[76:79], v[232:235], v[112:115], v[76:79]
  v_exp_f32 v196, v84
  v_mfma_f32_16x16x32_bf16 v[52:55], v[232:235], v[88:91], v[52:55]
  ds_read_b128 v[232:235], v7 offset:38656
  v_exp_f32 v197, v85
  v_mfma_f32_16x16x32_bf16 v[76:79], v[236:239], v[116:119], v[76:79]
  v_exp_f32 v198, v86
  v_mfma_f32_16x16x32_bf16 v[52:55], v[236:239], v[92:95], v[52:55]
  ds_read_b128 v[236:239], v8 offset:38656
  s_waitcnt lgkmcnt(8)
  v_mfma_f32_16x16x32_bf16 v[76:79], v[240:243], v[120:123], v[76:79]
  v_exp_f32 v199, v87
  v_mfma_f32_16x16x32_bf16 v[52:55], v[240:243], v[96:99], v[52:55]
  ds_read_b128 v[240:243], v7 offset:30720
  v_cvt_pk_bf16_f32 v166, v196, v197
  v_mfma_f32_16x16x32_bf16 v[76:79], v[244:247], v[124:127], v[76:79]
  v_cvt_pk_bf16_f32 v167, v198, v199
  v_mfma_f32_16x16x32_bf16 v[52:55], v[244:247], v[100:103], v[52:55]
  ds_read_b128 v[244:247], v8 offset:30720
  s_waitcnt lgkmcnt(8)
  v_mfma_f32_16x16x32_bf16 v[76:79], v[248:251], v[128:131], v[76:79]
  v_exp_f32 v200, v80
  v_mfma_f32_16x16x32_bf16 v[52:55], v[248:251], v[104:107], v[52:55]
  ds_read_b128 v[248:251], v7 offset:30848
  v_mfma_f32_16x16x32_bf16 v[76:79], v[252:255], v[132:135], v[76:79]
  v_exp_f32 v201, v81
  v_mfma_f32_16x16x32_bf16 v[52:55], v[252:255], v[108:111], v[52:55]
  ds_read_b128 v[252:255], v8 offset:30848
  s_waitcnt lgkmcnt(8)
  v_mfma_f32_16x16x32_bf16 v[72:75], v[216:219], v[112:115], v[72:75]
  v_exp_f32 v202, v82
  v_mfma_f32_16x16x32_bf16 v[48:51], v[216:219], v[88:91], v[48:51]
  ds_read_b128 v[216:219], v7 offset:30976
  v_exp_f32 v203, v83
  v_mfma_f32_16x16x32_bf16 v[72:75], v[220:223], v[116:119], v[72:75]
  v_cvt_pk_bf16_f32 v164, v200, v201
  v_cvt_pk_bf16_f32 v165, v202, v203
  v_mfma_f32_16x16x32_bf16 v[48:51], v[220:223], v[92:95], v[48:51]
  ds_read_b128 v[220:223], v8 offset:30976
  v_exp_f32 v204, v76
  s_waitcnt lgkmcnt(8)
  v_mfma_f32_16x16x32_bf16 v[72:75], v[224:227], v[120:123], v[72:75]
  v_exp_f32 v205, v77
  v_mfma_f32_16x16x32_bf16 v[48:51], v[224:227], v[96:99], v[48:51]
  ds_read_b128 v[224:227], v7 offset:23040
  v_mfma_f32_16x16x32_bf16 v[72:75], v[228:231], v[124:127], v[72:75]
  v_exp_f32 v206, v78
  v_mfma_f32_16x16x32_bf16 v[48:51], v[228:231], v[100:103], v[48:51]
  ds_read_b128 v[228:231], v8 offset:23040
  s_waitcnt lgkmcnt(8)
  v_mfma_f32_16x16x32_bf16 v[72:75], v[232:235], v[128:131], v[72:75]
  v_exp_f32 v207, v79
  v_mfma_f32_16x16x32_bf16 v[48:51], v[232:235], v[104:107], v[48:51]
  ds_read_b128 v[232:235], v7 offset:23168
  v_cvt_pk_bf16_f32 v162, v204, v205
  v_mfma_f32_16x16x32_bf16 v[72:75], v[236:239], v[132:135], v[72:75]
  v_cvt_pk_bf16_f32 v163, v206, v207
  v_mfma_f32_16x16x32_bf16 v[48:51], v[236:239], v[108:111], v[48:51]
  ds_read_b128 v[236:239], v8 offset:23168
  s_waitcnt lgkmcnt(8)
  v_mfma_f32_16x16x32_bf16 v[68:71], v[240:243], v[112:115], v[68:71]
  v_exp_f32 v208, v52
  v_mfma_f32_16x16x32_bf16 v[44:47], v[240:243], v[88:91], v[44:47]
  ds_read_b128 v[240:243], v7 offset:23296
  v_exp_f32 v209, v53
  v_mfma_f32_16x16x32_bf16 v[68:71], v[244:247], v[116:119], v[68:71]
  v_exp_f32 v210, v54
  v_mfma_f32_16x16x32_bf16 v[44:47], v[244:247], v[92:95], v[44:47]
  ds_read_b128 v[244:247], v8 offset:23296
  v_exp_f32 v211, v55
  s_waitcnt lgkmcnt(8)
  v_mfma_f32_16x16x32_bf16 v[68:71], v[248:251], v[120:123], v[68:71]
  v_cvt_pk_bf16_f32 v150, v208, v209
  v_cvt_pk_bf16_f32 v151, v210, v211
  v_mfma_f32_16x16x32_bf16 v[44:47], v[248:251], v[96:99], v[44:47]
  ds_read_b128 v[248:251], v7 offset:15360
  v_exp_f32 v212, v72
  v_mfma_f32_16x16x32_bf16 v[68:71], v[252:255], v[124:127], v[68:71]
  v_exp_f32 v213, v73
  v_mfma_f32_16x16x32_bf16 v[44:47], v[252:255], v[100:103], v[44:47]
  ds_read_b128 v[252:255], v8 offset:15360
  s_waitcnt lgkmcnt(8)
  v_mfma_f32_16x16x32_bf16 v[68:71], v[216:219], v[128:131], v[68:71]
  v_exp_f32 v214, v74
  v_mfma_f32_16x16x32_bf16 v[44:47], v[216:219], v[104:107], v[44:47]
  ds_read_b128 v[216:219], v7 offset:15488
  v_mfma_f32_16x16x32_bf16 v[68:71], v[220:223], v[132:135], v[68:71]
  v_exp_f32 v215, v75
  v_mfma_f32_16x16x32_bf16 v[44:47], v[220:223], v[108:111], v[44:47]
  ds_read_b128 v[220:223], v8 offset:15488
  s_waitcnt lgkmcnt(8)
  v_mfma_f32_16x16x32_bf16 v[64:67], v[224:227], v[112:115], v[64:67]
  v_cvt_pk_bf16_f32 v160, v212, v213
  v_cvt_pk_bf16_f32 v161, v214, v215
  v_mfma_f32_16x16x32_bf16 v[40:43], v[224:227], v[88:91], v[40:43]
  ds_read_b128 v[224:227], v7 offset:15616
  v_exp_f32 v196, v48
  v_mfma_f32_16x16x32_bf16 v[64:67], v[228:231], v[116:119], v[64:67]
  v_exp_f32 v197, v49
  v_mfma_f32_16x16x32_bf16 v[40:43], v[228:231], v[92:95], v[40:43]
  ds_read_b128 v[228:231], v8 offset:15616
  v_exp_f32 v198, v50
  s_waitcnt lgkmcnt(8)
  v_mfma_f32_16x16x32_bf16 v[64:67], v[232:235], v[120:123], v[64:67]
  v_exp_f32 v199, v51
  v_mfma_f32_16x16x32_bf16 v[40:43], v[232:235], v[96:99], v[40:43]
  ds_read_b128 v[232:235], v7 offset:7680
  v_cvt_pk_bf16_f32 v148, v196, v197
  v_cvt_pk_bf16_f32 v149, v198, v199
  v_mfma_f32_16x16x32_bf16 v[64:67], v[236:239], v[124:127], v[64:67]
  v_exp_f32 v200, v68
  v_mfma_f32_16x16x32_bf16 v[40:43], v[236:239], v[100:103], v[40:43]
  ds_read_b128 v[236:239], v8 offset:7680
  v_exp_f32 v201, v69
  s_waitcnt lgkmcnt(8)
  v_mfma_f32_16x16x32_bf16 v[64:67], v[240:243], v[128:131], v[64:67]
  v_exp_f32 v202, v70
  v_mfma_f32_16x16x32_bf16 v[40:43], v[240:243], v[104:107], v[40:43]
  ds_read_b128 v[240:243], v7 offset:7808
  v_mfma_f32_16x16x32_bf16 v[64:67], v[244:247], v[132:135], v[64:67]
  v_exp_f32 v203, v71
  v_mfma_f32_16x16x32_bf16 v[40:43], v[244:247], v[108:111], v[40:43]
  ds_read_b128 v[244:247], v8 offset:7808
  s_cbranch_vccz SL33
  s_waitcnt vmcnt(0)
  s_barrier
  buffer_load_dword v13, off, s[8:11], 0
SL33:
  s_waitcnt lgkmcnt(8)
  v_mfma_f32_16x16x32_bf16 v[60:63], v[248:251], v[112:115], v[60:63]
  v_cvt_pk_bf16_f32 v158, v200, v201
  v_cvt_pk_bf16_f32 v159, v202, v203
  v_mfma_f32_16x16x32_bf16 v[36:39], v[248:251], v[88:91], v[36:39]
  ds_read_b128 v[248:251], v7 offset:7936
  v_exp_f32 v204, v44
  v_mfma_f32_16x16x32_bf16 v[60:63], v[252:255], v[116:119], v[60:63]
  v_exp_f32 v205, v45
  v_mfma_f32_16x16x32_bf16 v[36:39], v[252:255], v[92:95], v[36:39]
  ds_read_b128 v[252:255], v8 offset:7936
  v_exp_f32 v206, v46
  s_waitcnt lgkmcnt(8)
  v_mfma_f32_16x16x32_bf16 v[60:63], v[216:219], v[120:123], v[60:63]
  v_exp_f32 v207, v47
  v_mfma_f32_16x16x32_bf16 v[36:39], v[216:219], v[96:99], v[36:39]
  ds_read_b128 v[216:219], v7 offset:0
  v_cvt_pk_bf16_f32 v146, v204, v205
  v_cvt_pk_bf16_f32 v147, v206, v207
  v_mfma_f32_16x16x32_bf16 v[60:63], v[220:223], v[124:127], v[60:63]
  v_exp_f32 v208, v64
  v_mfma_f32_16x16x32_bf16 v[36:39], v[220:223], v[100:103], v[36:39]
  ds_read_b128 v[220:223], v8 offset:0
  v_exp_f32 v209, v65
  s_waitcnt lgkmcnt(8)
  v_mfma_f32_16x16x32_bf16 v[60:63], v[224:227], v[128:131], v[60:63]
  v_exp_f32 v210, v66
  v_mfma_f32_16x16x32_bf16 v[36:39], v[224:227], v[104:107], v[36:39]
  ds_read_b128 v[224:227], v7 offset:128
  v_mfma_f32_16x16x32_bf16 v[60:63], v[228:231], v[132:135], v[60:63]
  v_exp_f32 v211, v67
  v_mfma_f32_16x16x32_bf16 v[36:39], v[228:231], v[108:111], v[36:39]
  ds_read_b128 v[228:231], v8 offset:128
  s_waitcnt lgkmcnt(8)
  v_mfma_f32_16x16x32_bf16 v[56:59], v[232:235], v[112:115], v[56:59]
  v_cvt_pk_bf16_f32 v156, v208, v209
  v_cvt_pk_bf16_f32 v157, v210, v211
  v_mfma_f32_16x16x32_bf16 v[32:35], v[232:235], v[88:91], v[32:35]
  ds_read_b128 v[232:235], v7 offset:256
  v_exp_f32 v212, v40
  v_mfma_f32_16x16x32_bf16 v[56:59], v[236:239], v[116:119], v[56:59]
  v_exp_f32 v213, v41
  v_mfma_f32_16x16x32_bf16 v[32:35], v[236:239], v[92:95], v[32:35]
  ds_read_b128 v[236:239], v8 offset:256
  v_exp_f32 v214, v42
  s_waitcnt lgkmcnt(8)
  v_mfma_f32_16x16x32_bf16 v[56:59], v[240:243], v[120:123], v[56:59]
  v_exp_f32 v215, v43
  v_mfma_f32_16x16x32_bf16 v[32:35], v[240:243], v[96:99], v[32:35]
  ds_read_b128 v[240:243], v20 offset:0
  v_cvt_pk_bf16_f32 v144, v212, v213
  v_cvt_pk_bf16_f32 v145, v214, v215
  v_mfma_f32_16x16x32_bf16 v[56:59], v[244:247], v[124:127], v[56:59]
  v_exp_f32 v196, v60
  v_mfma_f32_16x16x32_bf16 v[32:35], v[244:247], v[100:103], v[32:35]
  ds_read_b128 v[244:247], v0 offset:0
  v_exp_f32 v197, v61
  s_waitcnt lgkmcnt(8)
  v_mfma_f32_16x16x32_bf16 v[56:59], v[248:251], v[128:131], v[56:59]
  v_exp_f32 v198, v62
  v_mfma_f32_16x16x32_bf16 v[32:35], v[248:251], v[104:107], v[32:35]
  ds_read_b128 v[248:251], v20 offset:128
  v_mfma_f32_16x16x32_bf16 v[56:59], v[252:255], v[132:135], v[56:59]
  v_exp_f32 v199, v63
  v_mfma_f32_16x16x32_bf16 v[32:35], v[252:255], v[108:111], v[32:35]
  ds_read_b128 v[252:255], v0 offset:128
  s_waitcnt lgkmcnt(8)
  v_mfma_f32_16x16x32_bf16 v[28:31], v[216:219], v[88:91], v[28:31]
  ds_read_b128 v[216:219], v20 offset:256
  v_cvt_pk_bf16_f32 v154, v196, v197
  v_cvt_pk_bf16_f32 v155, v198, v199
  v_mfma_f32_16x16x32_bf16 v[28:31], v[220:223], v[92:95], v[28:31]
  ds_read_b128 v[220:223], v0 offset:256
  v_exp_f32 v200, v36
  s_waitcnt lgkmcnt(8)
  v_mfma_f32_16x16x32_bf16 v[28:31], v[224:227], v[96:99], v[28:31]
  ds_read_b64_tr_b16 v[224:225], v9 offset:53760
  ds_read_b64_tr_b16 v[226:227], v9 offset:61440
  v_exp_f32 v201, v37
  v_mfma_f32_16x16x32_bf16 v[28:31], v[228:231], v[100:103], v[28:31]
  ds_read_b64_tr_b16 v[228:229], v10 offset:53760
  ds_read_b64_tr_b16 v[230:231], v10 offset:61440
  v_exp_f32 v202, v38
  s_waitcnt lgkmcnt(10)
  v_mfma_f32_16x16x32_bf16 v[28:31], v[232:235], v[104:107], v[28:31]
  ds_read_b64_tr_b16 v[232:233], v11 offset:53760
  ds_read_b64_tr_b16 v[234:235], v11 offset:61440
  v_exp_f32 v203, v39
  v_mfma_f32_16x16x32_bf16 v[28:31], v[236:239], v[108:111], v[28:31]
  ds_read_b64_tr_b16 v[236:237], v12 offset:53760
  ds_read_b64_tr_b16 v[238:239], v12 offset:61440
  v_cvt_pk_bf16_f32 v142, v200, v201
  v_cvt_pk_bf16_f32 v143, v202, v203
  s_cbranch_vccnz SL34
  s_barrier
SL34:
  s_waitcnt lgkmcnt(12)
  v_mfma_f32_16x16x32_bf16 v[24:27], v[240:243], v[88:91], v[24:27]
  ds_read_b64_tr_b16 v[240:241], v9 offset:53888
  ds_read_b64_tr_b16 v[242:243], v9 offset:61568
  v_exp_f32 v204, v56
  v_mfma_f32_16x16x32_bf16 v[24:27], v[244:247], v[92:95], v[24:27]
  v_exp_f32 v205, v57
  s_waitcnt lgkmcnt(12)
  v_mfma_f32_16x16x32_bf16 v[24:27], v[248:251], v[96:99], v[24:27]
  ds_read_b64_tr_b16 v[244:245], v10 offset:53888
  ds_read_b64_tr_b16 v[246:247], v10 offset:61568
  v_exp_f32 v206, v58
  v_exp_f32 v207, v59
  v_cvt_pk_bf16_f32 v152, v204, v205
  v_cvt_pk_bf16_f32 v153, v206, v207
  v_mfma_f32_16x16x32_bf16 v[188:191], v[192:195], v[164:167], 0
  v_exp_f32 v208, v32
  v_mfma_f32_16x16x32_bf16 v[188:191], v[192:195], v[160:163], v[188:191]
  v_exp_f32 v209, v33
  v_mfma_f32_16x16x32_bf16 v[188:191], v[192:195], v[156:159], v[188:191]
  v_exp_f32 v210, v34
  v_mfma_f32_16x16x32_bf16 v[188:191], v[192:195], v[152:155], v[188:191]
  v_exp_f32 v211, v35
  v_mfma_f32_16x16x32_bf16 v[24:27], v[252:255], v[100:103], v[24:27]
  v_cvt_pk_bf16_f32 v140, v208, v209
  s_waitcnt lgkmcnt(12)
  v_mfma_f32_16x16x32_bf16 v[24:27], v[216:219], v[104:107], v[24:27]
  ds_read_b64_tr_b16 v[248:249], v11 offset:53888
  ds_read_b64_tr_b16 v[250:251], v11 offset:61568
  v_mfma_f32_16x16x32_bf16 v[24:27], v[220:223], v[108:111], v[24:27]
  v_cvt_pk_bf16_f32 v141, v210, v211
  v_subrev_u32 v23, 813694976, v188
  s_mov_b32 s52, 503316480
  v_cmp_gt_u32 s[48:49], s52, v23
  s_or_b64 s[48:49], s[48:49], s[44:45]
  s_cmp_eq_u64 s[48:49], -1
  s_cbranch_scc0 FB1
FBR1:
  s_waitcnt lgkmcnt(10)
  v_mfma_f32_16x16x32_bf16 v[88:91], v[224:227], v[164:167], 0
  ds_read_b64_tr_b16 v[252:253], v12 offset:53888
  ds_read_b64_tr_b16 v[254:255], v12 offset:61568
  v_exp_f32 v212, v28
  v_mfma_f32_16x16x32_bf16 v[92:95], v[228:231], v[164:167], 0
  ds_read_b64_tr_b16 v[216:217], v9 offset:54016
  ds_read_b64_tr_b16 v[218:219], v9 offset:61696
  v_exp_f32 v213, v29
  s_waitcnt lgkmcnt(10)
  v_mfma_f32_16x16x32_bf16 v[96:99], v[232:235], v[164:167], 0
  ds_read_b64_tr_b16 v[220:221], v10 offset:54016
  ds_read_b64_tr_b16 v[222:223], v10 offset:61696
  v_mfma_f32_16x16x32_bf16 v[100:103], v[236:239], v[164:167], 0
  ds_read_b64_tr_b16 v[224:225], v11 offset:54016
  ds_read_b64_tr_b16 v[226:227], v11 offset:61696
  s_waitcnt lgkmcnt(10)
  v_mfma_f32_16x16x32_bf16 v[104:107], v[240:243], v[164:167], 0
  ds_read_b64_tr_b16 v[228:229], v12 offset:54016
  ds_read_b64_tr_b16 v[230:231], v12 offset:61696
  v_mfma_f32_16x16x32_bf16 v[108:111], v[244:247], v[164:167], 0
  ds_read_b64_tr_b16 v[232:233], v9 offset:38400
  ds_read_b64_tr_b16 v[234:235], v9 offset:46080
  s_waitcnt lgkmcnt(10)
  v_mfma_f32_16x16x32_bf16 v[112:115], v[248:251], v[164:167], 0
  ds_read_b64_tr_b16 v[236:237], v10 offset:38400
  ds_read_b64_tr_b16 v[238:239], v10 offset:46080
  v_mfma_f32_16x16x32_bf16 v[116:119], v[252:255], v[164:167], 0
  ds_read_b64_tr_b16 v[240:241], v11 offset:38400
  ds_read_b64_tr_b16 v[242:243], v11 offset:46080
  s_waitcnt lgkmcnt(10)
  v_mfma_f32_16x16x32_bf16 v[120:123], v[216:219], v[164:167], 0
  ds_read_b64_tr_b16 v[244:245], v12 offset:38400
  ds_read_b64_tr_b16 v[246:247], v12 offset:46080
  v_mfma_f32_16x16x32_bf16 v[124:127], v[220:223], v[164:167], 0
  ds_read_b64_tr_b16 v[248:249], v9 offset:38528
  ds_read_b64_tr_b16 v[250:251], v9 offset:46208
  s_waitcnt lgkmcnt(10)
  v_mfma_f32_16x16x32_bf16 v[128:131], v[224:227], v[164:167], 0
  ds_read_b64_tr_b16 v[252:253], v10 offset:38528
  ds_read_b64_tr_b16 v[254:255], v10 offset:46208
  v_mfma_f32_16x16x32_bf16 v[132:135], v[228:231], v[164:167], 0
  ds_read_b64_tr_b16 v[216:217], v11 offset:38528
  ds_read_b64_tr_b16 v[218:219], v11 offset:46208
  v_exp_f32 v214, v30
  v_exp_f32 v215, v31
  v_cvt_pk_bf16_f32 v138, v212, v213
  v_cvt_pk_bf16_f32 v139, v214, v215
  v_exp_f32 v196, v24
  v_exp_f32 v197, v25
  v_exp_f32 v198, v26
  v_exp_f32 v199, v27
  v_cvt_pk_bf16_f32 v136, v196, v197
  v_cvt_pk_bf16_f32 v137, v198, v199
  v_mfma_f32_16x16x32_bf16 v[184:187], v[192:195], v[148:151], 0
  v_mfma_f32_16x16x32_bf16 v[184:187], v[192:195], v[144:147], v[184:187]
  v_mfma_f32_16x16x32_bf16 v[184:187], v[192:195], v[140:143], v[184:187]
  v_mfma_f32_16x16x32_bf16 v[184:187], v[192:195], v[136:139], v[184:187]
  s_nop 7
  v_subrev_u32 v23, 813694976, v184
  s_mov_b32 s52, 503316480
  v_cmp_gt_u32 s[48:49], s52, v23
  s_or_b64 s[48:49], s[48:49], s[42:43]
  s_cmp_eq_u64 s[48:49], -1
  s_cbranch_scc0 FB0
FBR0:
  s_waitcnt lgkmcnt(10)
  v_mfma_f32_16x16x32_bf16 v[88:91], v[232:235], v[160:163], v[88:91]
  ds_read_b64_tr_b16 v[220:221], v12 offset:38528
  ds_read_b64_tr_b16 v[222:223], v12 offset:46208
  v_mfma_f32_16x16x32_bf16 v[24:27], v[232:235], v[148:151], 0
  ds_read_b64_tr_b16 v[224:225], v9 offset:38656
  ds_read_b64_tr_b16 v[226:227], v9 offset:46336
  v_mfma_f32_16x16x32_bf16 v[92:95], v[236:239], v[160:163], v[92:95]
  v_rcp_f32 v22, v184
  v_mfma_f32_16x16x32_bf16 v[28:31], v[236:239], v[148:151], 0
  s_waitcnt lgkmcnt(10)
  v_mfma_f32_16x16x32_bf16 v[96:99], v[240:243], v[160:163], v[96:99]
  ds_read_b64_tr_b16 v[228:229], v10 offset:38656
  ds_read_b64_tr_b16 v[230:231], v10 offset:46336
  v_mfma_f32_16x16x32_bf16 v[32:35], v[240:243], v[148:151], 0
  ds_read_b64_tr_b16 v[232:233], v11 offset:38656
  ds_read_b64_tr_b16 v[234:235], v11 offset:46336
  v_mfma_f32_16x16x32_bf16 v[100:103], v[244:247], v[160:163], v[100:103]
  v_rcp_f32 v23, v188
  v_mfma_f32_16x16x32_bf16 v[36:39], v[244:247], v[148:151], 0
  s_waitcnt lgkmcnt(10)
  v_mfma_f32_16x16x32_bf16 v[104:107], v[248:251], v[160:163], v[104:107]
  ds_read_b64_tr_b16 v[236:237], v12 offset:38656
  ds_read_b64_tr_b16 v[238:239], v12 offset:46336
  v_mfma_f32_16x16x32_bf16 v[40:43], v[248:251], v[148:151], 0
  ds_read_b64_tr_b16 v[240:241], v9 offset:23040
  ds_read_b64_tr_b16 v[242:243], v9 offset:30720
  v_mfma_f32_16x16x32_bf16 v[108:111], v[252:255], v[160:163], v[108:111]
  v_mfma_f32_16x16x32_bf16 v[44:47], v[252:255], v[148:151], 0
  s_waitcnt lgkmcnt(10)
  v_mfma_f32_16x16x32_bf16 v[112:115], v[216:219], v[160:163], v[112:115]
  ds_read_b64_tr_b16 v[244:245], v10 offset:23040
  ds_read_b64_tr_b16 v[246:247], v10 offset:30720
  v_mfma_f32_16x16x32_bf16 v[48:51], v[216:219], v[148:151], 0
  ds_read_b64_tr_b16 v[248:249], v11 offset:23040
  ds_read_b64_tr_b16 v[250:251], v11 offset:30720
  v_mfma_f32_16x16x32_bf16 v[116:119], v[220:223], v[160:163], v[116:119]
  v_mfma_f32_16x16x32_bf16 v[52:55], v[220:223], v[148:151], 0
  s_waitcnt lgkmcnt(10)
  v_mfma_f32_16x16x32_bf16 v[120:123], v[224:227], v[160:163], v[120:123]
  ds_read_b64_tr_b16 v[252:253], v12 offset:23040
  ds_read_b64_tr_b16 v[254:255], v12 offset:30720
  v_mfma_f32_16x16x32_bf16 v[56:59], v[224:227], v[148:151], 0
  ds_read_b64_tr_b16 v[216:217], v9 offset:23168
  ds_read_b64_tr_b16 v[218:219], v9 offset:30848
  v_mfma_f32_16x16x32_bf16 v[124:127], v[228:231], v[160:163], v[124:127]
  v_mfma_f32_16x16x32_bf16 v[60:63], v[228:231], v[148:151], 0
  s_waitcnt lgkmcnt(10)
  v_mfma_f32_16x16x32_bf16 v[128:131], v[232:235], v[160:163], v[128:131]
  ds_read_b64_tr_b16 v[220:221], v10 offset:23168
  ds_read_b64_tr_b16 v[222:223], v10 offset:30848
  v_mfma_f32_16x16x32_bf16 v[64:67], v[232:235], v[148:151], 0
  ds_read_b64_tr_b16 v[224:225], v11 offset:23168
  ds_read_b64_tr_b16 v[226:227], v11 offset:30848
  v_mfma_f32_16x16x32_bf16 v[132:135], v[236:239], v[160:163], v[132:135]
  v_mfma_f32_16x16x32_bf16 v[68:71], v[236:239], v[148:151], 0
  s_cbranch_vccz SL35
  s_barrier
  s_mov_b32 s53, 0x400000
NPOLL:
  s_waitcnt vmcnt(0)
  v_readfirstlane_b32 s46, v13
  s_sub_u32 s53, s53, 1
  s_cselect_b32 s46, 144, s46
  s_cmp_ge_u32 s46, 144
  s_cbranch_scc1 NPOLLD
  buffer_load_dword v13, off, s[8:11], 0 sc1
  s_branch NPOLL
NPOLLD:
  s_add_u32 m0, s40, 0
  s_add_u32 s100, s40, 30720
  buffer_load_dwordx4 v1, s[20:23], s100 offen sc1 lds
  s_add_u32 m0, s40, 4096
  s_add_u32 s100, s40, 34816
  buffer_load_dwordx4 v1, s[20:23], s100 offen sc1 lds
  s_min_u32 s51, s40, 1024
  s_add_u32 m0, s51, 8192
  s_add_u32 s100, s51, 38912
  buffer_load_dwordx4 v1, s[20:23], s100 offen sc1 lds
  s_add_u32 m0, s40, 133120
  s_add_u32 s100, s40, 0
  buffer_load_dwordx4 v1, s[20:23], s100 offen sc1 lds
  s_add_u32 m0, s40, 137216
  s_add_u32 s100, s40, 4096
  buffer_load_dwordx4 v1, s[20:23], s100 offen sc1 lds
  s_add_u32 m0, s40, 141312
  s_add_u32 s100, s40, 8192
  buffer_load_dwordx4 v1, s[20:23], s100 offen sc1 lds
  s_add_u32 m0, s40, 145408
  s_add_u32 s100, s40, 12288
  buffer_load_dwordx4 v1, s[20:23], s100 offen sc1 lds
  s_add_u32 m0, s40, 149504
  s_add_u32 s100, s40, 16384
  buffer_load_dwordx4 v1, s[20:23], s100 offen sc1 lds
  s_add_u32 m0, s40, 153600
  s_add_u32 s100, s40, 20480
  buffer_load_dwordx4 v1, s[20:23], s100 offen sc1 lds
  s_add_u32 m0, s40, 157696
  s_add_u32 s100, s40, 24576
  buffer_load_dwordx4 v1, s[20:23], s100 offen sc1 lds
  s_min_u32 s51, s40, 1024
  s_add_u32 m0, s51, 161792
  s_add_u32 s100, s51, 28672
  buffer_load_dwordx4 v1, s[20:23], s100 offen sc1 lds
SL35:
  s_cbranch_vccnz SL36
  s_barrier
SL36:
  s_waitcnt lgkmcnt(10)
  v_mfma_f32_16x16x32_bf16 v[88:91], v[240:243], v[156:159], v[88:91]
  ds_read_b64_tr_b16 v[228:229], v12 offset:23168
  ds_read_b64_tr_b16 v[230:231], v12 offset:30848
  v_mfma_f32_16x16x32_bf16 v[24:27], v[240:243], v[144:147], v[24:27]
  ds_read_b64_tr_b16 v[232:233], v9 offset:23296
  ds_read_b64_tr_b16 v[234:235], v9 offset:30976
  v_mfma_f32_16x16x32_bf16 v[92:95], v[244:247], v[156:159], v[92:95]
  v_mfma_f32_16x16x32_bf16 v[28:31], v[244:247], v[144:147], v[28:31]
  s_waitcnt lgkmcnt(10)
  v_mfma_f32_16x16x32_bf16 v[96:99], v[248:251], v[156:159], v[96:99]
  ds_read_b64_tr_b16 v[236:237], v10 offset:23296
  ds_read_b64_tr_b16 v[238:239], v10 offset:30976
  v_mfma_f32_16x16x32_bf16 v[32:35], v[248:251], v[144:147], v[32:35]
  ds_read_b64_tr_b16 v[240:241], v11 offset:23296
  ds_read_b64_tr_b16 v[242:243], v11 offset:30976
  v_mfma_f32_16x16x32_bf16 v[100:103], v[252:255], v[156:159], v[100:103]
  v_mfma_f32_16x16x32_bf16 v[36:39], v[252:255], v[144:147], v[36:39]
  s_waitcnt lgkmcnt(10)
  v_mfma_f32_16x16x32_bf16 v[104:107], v[216:219], v[156:159], v[104:107]
  ds_read_b64_tr_b16 v[244:245], v12 offset:23296
  ds_read_b64_tr_b16 v[246:247], v12 offset:30976
  v_mfma_f32_16x16x32_bf16 v[40:43], v[216:219], v[144:147], v[40:43]
  ds_read_b64_tr_b16 v[248:249], v9 offset:7680
  ds_read_b64_tr_b16 v[250:251], v9 offset:15360
  v_mfma_f32_16x16x32_bf16 v[108:111], v[220:223], v[156:159], v[108:111]
  v_mfma_f32_16x16x32_bf16 v[44:47], v[220:223], v[144:147], v[44:47]
  s_waitcnt lgkmcnt(10)
  v_mfma_f32_16x16x32_bf16 v[112:115], v[224:227], v[156:159], v[112:115]
  ds_read_b64_tr_b16 v[252:253], v10 offset:7680
  ds_read_b64_tr_b16 v[254:255], v10 offset:15360
  v_mfma_f32_16x16x32_bf16 v[48:51], v[224:227], v[144:147], v[48:51]
  ds_read_b64_tr_b16 v[216:217], v11 offset:7680
  ds_read_b64_tr_b16 v[218:219], v11 offset:15360
  v_mfma_f32_16x16x32_bf16 v[116:119], v[228:231], v[156:159], v[116:119]
  v_mfma_f32_16x16x32_bf16 v[52:55], v[228:231], v[144:147], v[52:55]
  s_waitcnt lgkmcnt(10)
  v_mfma_f32_16x16x32_bf16 v[120:123], v[232:235], v[156:159], v[120:123]
  ds_read_b64_tr_b16 v[220:221], v12 offset:7680
  ds_read_b64_tr_b16 v[222:223], v12 offset:15360
  v_mfma_f32_16x16x32_bf16 v[56:59], v[232:235], v[144:147], v[56:59]
  ds_read_b64_tr_b16 v[224:225], v9 offset:7808
  ds_read_b64_tr_b16 v[226:227], v9 offset:15488
  v_mfma_f32_16x16x32_bf16 v[124:127], v[236:239], v[156:159], v[124:127]
  v_mfma_f32_16x16x32_bf16 v[60:63], v[236:239], v[144:147], v[60:63]
  s_waitcnt lgkmcnt(10)
  v_mfma_f32_16x16x32_bf16 v[128:131], v[240:243], v[156:159], v[128:131]
  ds_read_b64_tr_b16 v[228:229], v10 offset:7808
  ds_read_b64_tr_b16 v[230:231], v10 offset:15488
  v_mfma_f32_16x16x32_bf16 v[64:67], v[240:243], v[144:147], v[64:67]
  ds_read_b64_tr_b16 v[232:233], v11 offset:7808
  ds_read_b64_tr_b16 v[234:235], v11 offset:15488
  v_mfma_f32_16x16x32_bf16 v[132:135], v[244:247], v[156:159], v[132:135]
  v_mfma_f32_16x16x32_bf16 v[68:71], v[244:247], v[144:147], v[68:71]
  s_waitcnt lgkmcnt(10)
  v_mfma_f32_16x16x32_bf16 v[88:91], v[248:251], v[152:155], v[88:91]
  ds_read_b64_tr_b16 v[236:237], v12 offset:7808
  ds_read_b64_tr_b16 v[238:239], v12 offset:15488
  v_mfma_f32_16x16x32_bf16 v[24:27], v[248:251], v[140:143], v[24:27]
  ds_read_b64_tr_b16 v[240:241], v9 offset:7936
  ds_read_b64_tr_b16 v[242:243], v9 offset:15616
  v_mfma_f32_16x16x32_bf16 v[92:95], v[252:255], v[152:155], v[92:95]
  v_mfma_f32_16x16x32_bf16 v[28:31], v[252:255], v[140:143], v[28:31]
  s_waitcnt lgkmcnt(10)
  v_mfma_f32_16x16x32_bf16 v[96:99], v[216:219], v[152:155], v[96:99]
  ds_read_b64_tr_b16 v[244:245], v10 offset:7936
  ds_read_b64_tr_b16 v[246:247], v10 offset:15616
  v_mfma_f32_16x16x32_bf16 v[32:35], v[216:219], v[140:143], v[32:35]
  ds_read_b64_tr_b16 v[248:249], v11 offset:7936
  ds_read_b64_tr_b16 v[250:251], v11 offset:15616
  v_mfma_f32_16x16x32_bf16 v[100:103], v[220:223], v[152:155], v[100:103]
  v_mfma_f32_16x16x32_bf16 v[36:39], v[220:223], v[140:143], v[36:39]
  s_waitcnt lgkmcnt(10)
  v_mfma_f32_16x16x32_bf16 v[104:107], v[224:227], v[152:155], v[104:107]
  ds_read_b64_tr_b16 v[252:253], v12 offset:7936
  ds_read_b64_tr_b16 v[254:255], v12 offset:15616
  v_mfma_f32_16x16x32_bf16 v[40:43], v[224:227], v[140:143], v[40:43]
  ds_read_b64_tr_b16 v[216:217], v15 offset:0
  ds_read_b64_tr_b16 v[218:219], v9 offset:0
  v_mfma_f32_16x16x32_bf16 v[108:111], v[228:231], v[152:155], v[108:111]
  v_mfma_f32_16x16x32_bf16 v[44:47], v[228:231], v[140:143], v[44:47]
  s_waitcnt lgkmcnt(10)
  v_mfma_f32_16x16x32_bf16 v[112:115], v[232:235], v[152:155], v[112:115]
  ds_read_b64_tr_b16 v[220:221], v16 offset:0
  ds_read_b64_tr_b16 v[222:223], v10 offset:0
  v_mfma_f32_16x16x32_bf16 v[48:51], v[232:235], v[140:143], v[48:51]
  ds_read_b64_tr_b16 v[224:225], v17 offset:0
  ds_read_b64_tr_b16 v[226:227], v11 offset:0
  v_mfma_f32_16x16x32_bf16 v[116:119], v[236:239], v[152:155], v[116:119]
  v_mfma_f32_16x16x32_bf16 v[52:55], v[236:239], v[140:143], v[52:55]
  s_waitcnt lgkmcnt(10)
  v_mfma_f32_16x16x32_bf16 v[120:123], v[240:243], v[152:155], v[120:123]
  ds_read_b64_tr_b16 v[228:229], v18 offset:0
  ds_read_b64_tr_b16 v[230:231], v12 offset:0
  v_mfma_f32_16x16x32_bf16 v[56:59], v[240:243], v[140:143], v[56:59]
  ds_read_b64_tr_b16 v[232:233], v15 offset:128
  ds_read_b64_tr_b16 v[234:235], v9 offset:128
  v_mfma_f32_16x16x32_bf16 v[124:127], v[244:247], v[152:155], v[124:127]
  v_mfma_f32_16x16x32_bf16 v[60:63], v[244:247], v[140:143], v[60:63]
  s_waitcnt lgkmcnt(10)
  v_mfma_f32_16x16x32_bf16 v[128:131], v[248:251], v[152:155], v[128:131]
  ds_read_b64_tr_b16 v[236:237], v16 offset:128
  ds_read_b64_tr_b16 v[238:239], v10 offset:128
  v_mfma_f32_16x16x32_bf16 v[64:67], v[248:251], v[140:143], v[64:67]
  ds_read_b64_tr_b16 v[240:241], v17 offset:128
  ds_read_b64_tr_b16 v[242:243], v11 offset:128
  v_mfma_f32_16x16x32_bf16 v[132:135], v[252:255], v[152:155], v[132:135]
  v_mfma_f32_16x16x32_bf16 v[68:71], v[252:255], v[140:143], v[68:71]
  s_cbranch_vccnz SL37
  s_barrier
SL37:
  s_waitcnt lgkmcnt(10)
  v_mfma_f32_16x16x32_bf16 v[24:27], v[216:219], v[136:139], v[24:27]
  ds_read_b64_tr_b16 v[244:245], v18 offset:128
  ds_read_b64_tr_b16 v[246:247], v12 offset:128
  v_mfma_f32_16x16x32_bf16 v[28:31], v[220:223], v[136:139], v[28:31]
  ds_read_b64_tr_b16 v[248:249], v15 offset:256
  ds_read_b64_tr_b16 v[250:251], v9 offset:256
  s_waitcnt lgkmcnt(10)
  v_mfma_f32_16x16x32_bf16 v[32:35], v[224:227], v[136:139], v[32:35]
  ds_read_b64_tr_b16 v[252:253], v16 offset:256
  ds_read_b64_tr_b16 v[254:255], v10 offset:256
  v_mfma_f32_16x16x32_bf16 v[36:39], v[228:231], v[136:139], v[36:39]
  ds_read_b64_tr_b16 v[216:217], v17 offset:256
  ds_read_b64_tr_b16 v[218:219], v11 offset:256
  s_waitcnt lgkmcnt(10)
  v_mfma_f32_16x16x32_bf16 v[40:43], v[232:235], v[136:139], v[40:43]
  ds_read_b64_tr_b16 v[220:221], v18 offset:256
  ds_read_b64_tr_b16 v[222:223], v12 offset:256
  v_mfma_f32_16x16x32_bf16 v[44:47], v[236:239], v[136:139], v[44:47]
  v_cvt_pk_bf16_f32 v152, v88, v89
  s_waitcnt lgkmcnt(0)
  s_cbranch_vccz SL38
  s_waitcnt vmcnt(0)
  s_barrier
  s_add_u32 m0, s40, 102400
  s_add_u32 s100, s40, 40960
  buffer_load_dwordx4 v1, s[20:23], s100 offen sc1 lds
  s_add_u32 m0, s40, 106496
  s_add_u32 s100, s40, 45056
  buffer_load_dwordx4 v1, s[20:23], s100 offen sc1 lds
  s_add_u32 m0, s40, 110592
  s_add_u32 s100, s40, 49152
  buffer_load_dwordx4 v1, s[20:23], s100 offen sc1 lds
  s_add_u32 m0, s40, 114688
  s_add_u32 s100, s40, 53248
  buffer_load_dwordx4 v1, s[20:23], s100 offen sc1 lds
  s_add_u32 m0, s40, 118784
  s_add_u32 s100, s40, 57344
  buffer_load_dwordx4 v1, s[20:23], s100 offen sc1 lds
  s_add_u32 m0, s40, 122880
  s_add_u32 s100, s40, 61440
  buffer_load_dwordx4 v1, s[20:23], s100 offen sc1 lds
  s_add_u32 m0, s40, 126976
  s_add_u32 s100, s40, 65536
  buffer_load_dwordx4 v1, s[20:23], s100 offen sc1 lds
  s_min_u32 s51, s40, 1024
  s_add_u32 m0, s51, 131072
  s_add_u32 s100, s51, 69632
  buffer_load_dwordx4 v1, s[20:23], s100 offen sc1 lds
SL38:
  ds_read_b128 v[224:227], v2 offset:30720
  ds_read_b128 v[228:231], v2 offset:31744
  ds_read_b128 v[232:235], v2 offset:32768
  ds_read_b128 v[236:239], v2 offset:33792
  v_mfma_f32_16x16x32_bf16 v[48:51], v[240:243], v[136:139], v[48:51]
  ds_read_b128 v[240:243], v2 offset:34816
  v_cvt_pk_bf16_f32 v153, v90, v91
  v_mfma_f32_16x16x32_bf16 v[52:55], v[244:247], v[136:139], v[52:55]
  ds_read_b128 v[244:247], v2 offset:35840
  v_cvt_pk_bf16_f32 v154, v92, v93
  v_mfma_f32_16x16x32_bf16 v[56:59], v[248:251], v[136:139], v[56:59]
  ds_read_b128 v[248:251], v2 offset:36864
  v_cvt_pk_bf16_f32 v155, v94, v95
  v_mfma_f32_16x16x32_bf16 v[60:63], v[252:255], v[136:139], v[60:63]
  ds_read_b128 v[252:255], v2 offset:37888
  v_cvt_pk_bf16_f32 v156, v96, v97
  v_mfma_f32_16x16x32_bf16 v[64:67], v[216:219], v[136:139], v[64:67]
  ds_read_b128 v[216:219], v2 offset:38912
  v_cvt_pk_bf16_f32 v157, v98, v99
  v_mfma_f32_16x16x32_bf16 v[68:71], v[220:223], v[136:139], v[68:71]
  ds_read_b128 v[220:223], v2 offset:39936
  v_cvt_pk_bf16_f32 v158, v100, v101
  v_cvt_pk_bf16_f32 v159, v102, v103
  v_cvt_pk_bf16_f32 v160, v104, v105
  v_cvt_pk_bf16_f32 v161, v106, v107
  v_cvt_pk_bf16_f32 v162, v108, v109
  v_cvt_pk_bf16_f32 v163, v110, v111
  v_cvt_pk_bf16_f32 v164, v112, v113
  v_cvt_pk_bf16_f32 v165, v114, v115
  v_cvt_pk_bf16_f32 v166, v116, v117
  v_cvt_pk_bf16_f32 v167, v118, v119
  v_cvt_pk_bf16_f32 v176, v120, v121
  v_cvt_pk_bf16_f32 v177, v122, v123
  v_cvt_pk_bf16_f32 v178, v124, v125
  v_cvt_pk_bf16_f32 v179, v126, v127
  v_cvt_pk_bf16_f32 v180, v128, v129
  v_cvt_pk_bf16_f32 v181, v130, v131
  v_cvt_pk_bf16_f32 v182, v132, v133
  v_cvt_pk_bf16_f32 v183, v134, v135
  v_cvt_pk_bf16_f32 v136, v24, v25
  v_cvt_pk_bf16_f32 v137, v26, v27
  v_cvt_pk_bf16_f32 v138, v28, v29
  v_cvt_pk_bf16_f32 v139, v30, v31
  v_cvt_pk_bf16_f32 v140, v32, v33
  v_cvt_pk_bf16_f32 v141, v34, v35
  v_cvt_pk_bf16_f32 v142, v36, v37
  v_cvt_pk_bf16_f32 v143, v38, v39
  v_cvt_pk_bf16_f32 v144, v40, v41
  v_cvt_pk_bf16_f32 v145, v42, v43
  v_cvt_pk_bf16_f32 v146, v44, v45
  v_cvt_pk_bf16_f32 v147, v46, v47
  v_cvt_pk_bf16_f32 v148, v48, v49
  v_cvt_pk_bf16_f32 v149, v50, v51
  v_cvt_pk_bf16_f32 v150, v52, v53
  v_cvt_pk_bf16_f32 v151, v54, v55
  v_cvt_pk_bf16_f32 v168, v56, v57
  v_cvt_pk_bf16_f32 v169, v58, v59
  v_cvt_pk_bf16_f32 v170, v60, v61
  v_cvt_pk_bf16_f32 v171, v62, v63
  v_cvt_pk_bf16_f32 v172, v64, v65
  v_cvt_pk_bf16_f32 v173, v66, v67
  v_cvt_pk_bf16_f32 v174, v68, v69
  v_cvt_pk_bf16_f32 v175, v70, v71
  s_mov_b32 s100, 71680
  buffer_load_dwordx4 v[40:43], v1, s[20:23], s100 offen offset:0 sc1
  buffer_load_dwordx4 v[44:47], v1, s[20:23], s100 offen offset:1024 sc1
  s_waitcnt lgkmcnt(8)
  v_mfma_f32_16x16x32_bf16 v[184:187], v[224:227], v[136:139], 0
  v_mfma_f32_16x16x32_bf16 v[192:195], v[224:227], v[152:155], 0
  ds_read_b128 v[224:227], v2 offset:40960
  v_mfma_f32_16x16x32_bf16 v[188:191], v[228:231], v[136:139], 0
  v_mfma_f32_16x16x32_bf16 v[196:199], v[228:231], v[152:155], 0
  ds_read_b128 v[228:231], v2 offset:41984
  s_waitcnt lgkmcnt(8)
  v_mfma_f32_16x16x32_bf16 v[184:187], v[232:235], v[140:143], v[184:187]
  v_mfma_f32_16x16x32_bf16 v[192:195], v[232:235], v[156:159], v[192:195]
  ds_read_b128 v[232:235], v2 offset:43008
  v_mfma_f32_16x16x32_bf16 v[188:191], v[236:239], v[140:143], v[188:191]
  v_mfma_f32_16x16x32_bf16 v[196:199], v[236:239], v[156:159], v[196:199]
  ds_read_b128 v[236:239], v2 offset:44032
  s_waitcnt lgkmcnt(8)
  v_mfma_f32_16x16x32_bf16 v[184:187], v[240:243], v[144:147], v[184:187]
  v_mfma_f32_16x16x32_bf16 v[192:195], v[240:243], v[160:163], v[192:195]
  ds_read_b128 v[240:243], v2 offset:45056
  v_mfma_f32_16x16x32_bf16 v[188:191], v[244:247], v[144:147], v[188:191]
  v_mfma_f32_16x16x32_bf16 v[196:199], v[244:247], v[160:163], v[196:199]
  ds_read_b128 v[244:247], v2 offset:46080
  s_waitcnt lgkmcnt(8)
  v_mfma_f32_16x16x32_bf16 v[184:187], v[248:251], v[148:151], v[184:187]
  v_mfma_f32_16x16x32_bf16 v[192:195], v[248:251], v[164:167], v[192:195]
  ds_read_b128 v[248:251], v2 offset:47104
  v_mfma_f32_16x16x32_bf16 v[188:191], v[252:255], v[148:151], v[188:191]
  v_mfma_f32_16x16x32_bf16 v[196:199], v[252:255], v[164:167], v[196:199]
  ds_read_b128 v[252:255], v2 offset:48128
  s_waitcnt lgkmcnt(8)
  v_mfma_f32_16x16x32_bf16 v[184:187], v[216:219], v[168:171], v[184:187]
  v_mfma_f32_16x16x32_bf16 v[192:195], v[216:219], v[176:179], v[192:195]
  ds_read_b128 v[216:219], v2 offset:49152
  v_mfma_f32_16x16x32_bf16 v[188:191], v[220:223], v[168:171], v[188:191]
  v_mfma_f32_16x16x32_bf16 v[196:199], v[220:223], v[176:179], v[196:199]
  ds_read_b128 v[220:223], v2 offset:50176
  s_waitcnt lgkmcnt(8)
  v_mfma_f32_16x16x32_bf16 v[184:187], v[224:227], v[172:175], v[184:187]
  v_mfma_f32_16x16x32_bf16 v[192:195], v[224:227], v[180:183], v[192:195]
  ds_read_b128 v[224:227], v2 offset:51200
  v_mfma_f32_16x16x32_bf16 v[188:191], v[228:231], v[172:175], v[188:191]
  v_mfma_f32_16x16x32_bf16 v[196:199], v[228:231], v[180:183], v[196:199]
  ds_read_b128 v[228:231], v2 offset:52224
  s_waitcnt lgkmcnt(8)
  v_mfma_f32_16x16x32_bf16 v[200:203], v[232:235], v[136:139], 0
  v_mfma_f32_16x16x32_bf16 v[208:211], v[232:235], v[152:155], 0
  ds_read_b128 v[232:235], v2 offset:53248
  v_mul_f32 v184, v184, v22
  v_mfma_f32_16x16x32_bf16 v[204:207], v[236:239], v[136:139], 0
  v_mul_f32 v185, v185, v22
  v_mul_f32 v186, v186, v22
  v_mfma_f32_16x16x32_bf16 v[212:215], v[236:239], v[152:155], 0
  ds_read_b128 v[236:239], v2 offset:54272
  s_waitcnt lgkmcnt(8)
  v_mfma_f32_16x16x32_bf16 v[200:203], v[240:243], v[140:143], v[200:203]
  v_mul_f32 v187, v187, v22
  v_mul_f32 v188, v188, v22
  v_mfma_f32_16x16x32_bf16 v[208:211], v[240:243], v[156:159], v[208:211]
  ds_read_b128 v[240:243], v2 offset:55296
  v_mul_f32 v189, v189, v22
  v_mfma_f32_16x16x32_bf16 v[204:207], v[244:247], v[140:143], v[204:207]
  v_mul_f32 v190, v190, v22
  v_mul_f32 v191, v191, v22
  v_mfma_f32_16x16x32_bf16 v[212:215], v[244:247], v[156:159], v[212:215]
  ds_read_b128 v[244:247], v2 offset:56320
  s_waitcnt lgkmcnt(8)
  v_mfma_f32_16x16x32_bf16 v[200:203], v[248:251], v[144:147], v[200:203]
  v_cvt_pk_bf16_f32 v24, v184, v185
  v_cvt_pk_bf16_f32 v25, v186, v187
  v_mfma_f32_16x16x32_bf16 v[208:211], v[248:251], v[160:163], v[208:211]
  ds_read_b128 v[248:251], v2 offset:57344
  v_cvt_pk_bf16_f32 v26, v188, v189
  v_mfma_f32_16x16x32_bf16 v[204:207], v[252:255], v[144:147], v[204:207]
  v_cvt_pk_bf16_f32 v27, v190, v191
  buffer_store_dwordx4 v[24:27], v5, s[16:19], 0 offen offset:0 nt sc1
  v_mfma_f32_16x16x32_bf16 v[212:215], v[252:255], v[160:163], v[212:215]
  ds_read_b128 v[252:255], v2 offset:58368
  s_waitcnt lgkmcnt(8)
  v_mfma_f32_16x16x32_bf16 v[200:203], v[216:219], v[148:151], v[200:203]
  v_mul_f32 v192, v192, v23
  v_mul_f32 v193, v193, v23
  v_mfma_f32_16x16x32_bf16 v[208:211], v[216:219], v[164:167], v[208:211]
  ds_read_b128 v[216:219], v2 offset:59392
  v_mul_f32 v194, v194, v23
  v_mfma_f32_16x16x32_bf16 v[204:207], v[220:223], v[148:151], v[204:207]
  v_mul_f32 v195, v195, v23
  v_mul_f32 v196, v196, v23
  v_mfma_f32_16x16x32_bf16 v[212:215], v[220:223], v[164:167], v[212:215]
  ds_read_b128 v[220:223], v2 offset:60416
  s_waitcnt lgkmcnt(8)
  v_mfma_f32_16x16x32_bf16 v[200:203], v[224:227], v[168:171], v[200:203]
  v_mul_f32 v197, v197, v23
  v_mul_f32 v198, v198, v23
  v_mfma_f32_16x16x32_bf16 v[208:211], v[224:227], v[176:179], v[208:211]
  ds_read_b128 v[224:227], v1 offset:0
  v_mul_f32 v199, v199, v23
  v_mfma_f32_16x16x32_bf16 v[204:207], v[228:231], v[168:171], v[204:207]
  v_cvt_pk_bf16_f32 v28, v192, v193
  v_cvt_pk_bf16_f32 v29, v194, v195
  v_mfma_f32_16x16x32_bf16 v[212:215], v[228:231], v[176:179], v[212:215]
  ds_read_b128 v[228:231], v1 offset:1024
  s_waitcnt lgkmcnt(8)
  v_mfma_f32_16x16x32_bf16 v[200:203], v[232:235], v[172:175], v[200:203]
  v_cvt_pk_bf16_f32 v30, v196, v197
  v_cvt_pk_bf16_f32 v31, v198, v199
  v_mfma_f32_16x16x32_bf16 v[208:211], v[232:235], v[180:183], v[208:211]
  ds_read_b128 v[232:235], v1 offset:2048
  buffer_store_dwordx4 v[28:31], v6, s[16:19], 0 offen offset:0 nt sc1
  v_mfma_f32_16x16x32_bf16 v[204:207], v[236:239], v[172:175], v[204:207]
  v_mfma_f32_16x16x32_bf16 v[212:215], v[236:239], v[180:183], v[212:215]
  ds_read_b128 v[236:239], v1 offset:3072
  s_cbranch_vccz SL39
  s_waitcnt vmcnt(4)
  s_barrier
SL39:
  s_waitcnt lgkmcnt(8)
  v_mfma_f32_16x16x32_bf16 v[184:187], v[240:243], v[136:139], 0
  v_mul_f32 v200, v200, v22
  v_mul_f32 v201, v201, v22
  v_mfma_f32_16x16x32_bf16 v[192:195], v[240:243], v[152:155], 0
  ds_read_b128 v[240:243], v1 offset:4096
  v_mul_f32 v202, v202, v22
  v_mfma_f32_16x16x32_bf16 v[188:191], v[244:247], v[136:139], 0
  v_mul_f32 v203, v203, v22
  v_mul_f32 v204, v204, v22
  v_mfma_f32_16x16x32_bf16 v[196:199], v[244:247], v[152:155], 0
  ds_read_b128 v[244:247], v1 offset:5120
  s_waitcnt lgkmcnt(8)
  v_mfma_f32_16x16x32_bf16 v[184:187], v[248:251], v[140:143], v[184:187]
  v_mul_f32 v205, v205, v22
  v_mul_f32 v206, v206, v22
  v_mfma_f32_16x16x32_bf16 v[192:195], v[248:251], v[156:159], v[192:195]
  ds_read_b128 v[248:251], v1 offset:6144
  v_mul_f32 v207, v207, v22
  v_mfma_f32_16x16x32_bf16 v[188:191], v[252:255], v[140:143], v[188:191]
  v_cvt_pk_bf16_f32 v32, v200, v201
  v_cvt_pk_bf16_f32 v33, v202, v203
  v_mfma_f32_16x16x32_bf16 v[196:199], v[252:255], v[156:159], v[196:199]
  ds_read_b128 v[252:255], v1 offset:7168
  s_waitcnt lgkmcnt(8)
  v_mfma_f32_16x16x32_bf16 v[184:187], v[216:219], v[144:147], v[184:187]
  v_cvt_pk_bf16_f32 v34, v204, v205
  v_cvt_pk_bf16_f32 v35, v206, v207
  v_mfma_f32_16x16x32_bf16 v[192:195], v[216:219], v[160:163], v[192:195]
  ds_read_b128 v[216:219], v1 offset:8192
  buffer_store_dwordx4 v[32:35], v5, s[16:19], 0 offen offset:64 nt sc1
  v_mfma_f32_16x16x32_bf16 v[188:191], v[220:223], v[144:147], v[188:191]
  v_mul_f32 v208, v208, v23
  v_mul_f32 v209, v209, v23
  v_mfma_f32_16x16x32_bf16 v[196:199], v[220:223], v[160:163], v[196:199]
  ds_read_b128 v[220:223], v1 offset:9216
  s_waitcnt lgkmcnt(8)
  v_mfma_f32_16x16x32_bf16 v[184:187], v[224:227], v[148:151], v[184:187]
  v_mul_f32 v210, v210, v23
  v_mul_f32 v211, v211, v23
  v_mfma_f32_16x16x32_bf16 v[192:195], v[224:227], v[164:167], v[192:195]
  ds_read_b128 v[224:227], v2 offset:0
  v_mul_f32 v212, v212, v23
  v_mfma_f32_16x16x32_bf16 v[188:191], v[228:231], v[148:151], v[188:191]
  v_mul_f32 v213, v213, v23
  v_mul_f32 v214, v214, v23
  v_mfma_f32_16x16x32_bf16 v[196:199], v[228:231], v[164:167], v[196:199]
  ds_read_b128 v[228:231], v2 offset:1024
  s_waitcnt lgkmcnt(8)
  v_mfma_f32_16x16x32_bf16 v[184:187], v[232:235], v[168:171], v[184:187]
  v_mul_f32 v215, v215, v23
  v_cvt_pk_bf16_f32 v36, v208, v209
  v_mfma_f32_16x16x32_bf16 v[192:195], v[232:235], v[176:179], v[192:195]
  ds_read_b128 v[232:235], v2 offset:2048
  v_cvt_pk_bf16_f32 v37, v210, v211
  v_mfma_f32_16x16x32_bf16 v[188:191], v[236:239], v[168:171], v[188:191]
  v_cvt_pk_bf16_f32 v38, v212, v213
  v_cvt_pk_bf16_f32 v39, v214, v215
  v_mfma_f32_16x16x32_bf16 v[196:199], v[236:239], v[176:179], v[196:199]
  ds_read_b128 v[236:239], v2 offset:3072
  s_waitcnt lgkmcnt(8)
  v_mfma_f32_16x16x32_bf16 v[184:187], v[240:243], v[172:175], v[184:187]
  buffer_store_dwordx4 v[36:39], v6, s[16:19], 0 offen offset:64 nt sc1
  v_mfma_f32_16x16x32_bf16 v[192:195], v[240:243], v[180:183], v[192:195]
  ds_read_b128 v[240:243], v2 offset:4096
  v_mfma_f32_16x16x32_bf16 v[188:191], v[244:247], v[172:175], v[188:191]
  v_mfma_f32_16x16x32_bf16 v[196:199], v[244:247], v[180:183], v[196:199]
  ds_read_b128 v[244:247], v2 offset:5120
  s_waitcnt lgkmcnt(8)
  v_mfma_f32_16x16x32_bf16 v[200:203], v[248:251], v[136:139], 0
  v_mul_f32 v184, v184, v22
  v_mul_f32 v185, v185, v22
  v_mfma_f32_16x16x32_bf16 v[208:211], v[248:251], v[152:155], 0
  ds_read_b128 v[248:251], v2 offset:6144
  v_mul_f32 v186, v186, v22
  v_mfma_f32_16x16x32_bf16 v[204:207], v[252:255], v[136:139], 0
  v_mul_f32 v187, v187, v22
  v_mul_f32 v188, v188, v22
  v_mfma_f32_16x16x32_bf16 v[212:215], v[252:255], v[152:155], 0
  ds_read_b128 v[252:255], v2 offset:7168
  s_waitcnt lgkmcnt(8)
  v_mfma_f32_16x16x32_bf16 v[200:203], v[216:219], v[140:143], v[200:203]
  v_mul_f32 v189, v189, v22
  v_mul_f32 v190, v190, v22
  v_mfma_f32_16x16x32_bf16 v[208:211], v[216:219], v[156:159], v[208:211]
  ds_read_b128 v[216:219], v2 offset:8192
  v_mul_f32 v191, v191, v22
  v_mfma_f32_16x16x32_bf16 v[204:207], v[220:223], v[140:143], v[204:207]
  v_cvt_pk_bf16_f32 v24, v184, v185
  v_cvt_pk_bf16_f32 v25, v186, v187
  v_mfma_f32_16x16x32_bf16 v[212:215], v[220:223], v[156:159], v[212:215]
  ds_read_b128 v[220:223], v2 offset:9216
  s_waitcnt lgkmcnt(8)
  v_mfma_f32_16x16x32_bf16 v[200:203], v[224:227], v[144:147], v[200:203]
  v_cvt_pk_bf16_f32 v26, v188, v189
  v_cvt_pk_bf16_f32 v27, v190, v191
  v_mfma_f32_16x16x32_bf16 v[208:211], v[224:227], v[160:163], v[208:211]
  ds_read_b128 v[224:227], v2 offset:10240
  buffer_store_dwordx4 v[24:27], v5, s[16:19], 0 offen offset:128 nt sc1
  v_mfma_f32_16x16x32_bf16 v[204:207], v[228:231], v[144:147], v[204:207]
  v_mul_f32 v192, v192, v23
  v_mul_f32 v193, v193, v23
  v_mfma_f32_16x16x32_bf16 v[212:215], v[228:231], v[160:163], v[212:215]
  ds_read_b128 v[228:231], v2 offset:11264
  s_waitcnt lgkmcnt(8)
  v_mfma_f32_16x16x32_bf16 v[200:203], v[232:235], v[148:151], v[200:203]
  v_mul_f32 v194, v194, v23
  v_mul_f32 v195, v195, v23
  v_mfma_f32_16x16x32_bf16 v[208:211], v[232:235], v[164:167], v[208:211]
  ds_read_b128 v[232:235], v2 offset:12288
  v_mul_f32 v196, v196, v23
  v_mfma_f32_16x16x32_bf16 v[204:207], v[236:239], v[148:151], v[204:207]
  v_mul_f32 v197, v197, v23
  v_mul_f32 v198, v198, v23
  v_mfma_f32_16x16x32_bf16 v[212:215], v[236:239], v[164:167], v[212:215]
  ds_read_b128 v[236:239], v2 offset:13312
  s_waitcnt lgkmcnt(8)
  v_mfma_f32_16x16x32_bf16 v[200:203], v[240:243], v[168:171], v[200:203]
  v_mul_f32 v199, v199, v23
  v_cvt_pk_bf16_f32 v28, v192, v193
  v_mfma_f32_16x16x32_bf16 v[208:211], v[240:243], v[176:179], v[208:211]
  ds_read_b128 v[240:243], v2 offset:14336
  v_cvt_pk_bf16_f32 v29, v194, v195
  v_mfma_f32_16x16x32_bf16 v[204:207], v[244:247], v[168:171], v[204:207]
  v_cvt_pk_bf16_f32 v30, v196, v197
  v_cvt_pk_bf16_f32 v31, v198, v199
  v_mfma_f32_16x16x32_bf16 v[212:215], v[244:247], v[176:179], v[212:215]
  ds_read_b128 v[244:247], v2 offset:15360
  s_waitcnt lgkmcnt(8)
  v_mfma_f32_16x16x32_bf16 v[200:203], v[248:251], v[172:175], v[200:203]
  buffer_store_dwordx4 v[28:31], v6, s[16:19], 0 offen offset:128 nt sc1
  v_mfma_f32_16x16x32_bf16 v[208:211], v[248:251], v[180:183], v[208:211]
  ds_read_b128 v[248:251], v2 offset:16384
  v_mfma_f32_16x16x32_bf16 v[204:207], v[252:255], v[172:175], v[204:207]
  v_mfma_f32_16x16x32_bf16 v[212:215], v[252:255], v[180:183], v[212:215]
  ds_read_b128 v[252:255], v2 offset:17408
  s_waitcnt lgkmcnt(8)
  v_mfma_f32_16x16x32_bf16 v[184:187], v[216:219], v[136:139], 0
  v_mul_f32 v200, v200, v22
  v_mul_f32 v201, v201, v22
  v_mfma_f32_16x16x32_bf16 v[192:195], v[216:219], v[152:155], 0
  ds_read_b128 v[216:219], v2 offset:18432
  v_mul_f32 v202, v202, v22
  v_mfma_f32_16x16x32_bf16 v[188:191], v[220:223], v[136:139], 0
  v_mul_f32 v203, v203, v22
  v_mul_f32 v204, v204, v22
  v_mfma_f32_16x16x32_bf16 v[196:199], v[220:223], v[152:155], 0
  ds_read_b128 v[220:223], v2 offset:19456
  s_waitcnt lgkmcnt(8)
  v_mfma_f32_16x16x32_bf16 v[184:187], v[224:227], v[140:143], v[184:187]
  v_mul_f32 v205, v205, v22
  v_mul_f32 v206, v206, v22
  v_mfma_f32_16x16x32_bf16 v[192:195], v[224:227], v[156:159], v[192:195]
  ds_read_b128 v[224:227], v2 offset:20480
  v_mul_f32 v207, v207, v22
  v_mfma_f32_16x16x32_bf16 v[188:191], v[228:231], v[140:143], v[188:191]
  v_cvt_pk_bf16_f32 v32, v200, v201
  v_cvt_pk_bf16_f32 v33, v202, v203
  v_mfma_f32_16x16x32_bf16 v[196:199], v[228:231], v[156:159], v[196:199]
  ds_read_b128 v[228:231], v2 offset:21504
  s_waitcnt lgkmcnt(8)
  v_mfma_f32_16x16x32_bf16 v[184:187], v[232:235], v[144:147], v[184:187]
  v_cvt_pk_bf16_f32 v34, v204, v205
  v_cvt_pk_bf16_f32 v35, v206, v207
  v_mfma_f32_16x16x32_bf16 v[192:195], v[232:235], v[160:163], v[192:195]
  ds_read_b128 v[232:235], v2 offset:22528
  buffer_store_dwordx4 v[32:35], v5, s[16:19], 0 offen offset:192 nt sc1
  v_mfma_f32_16x16x32_bf16 v[188:191], v[236:239], v[144:147], v[188:191]
  v_mul_f32 v208, v208, v23
  v_mul_f32 v209, v209, v23
  v_mfma_f32_16x16x32_bf16 v[196:199], v[236:239], v[160:163], v[196:199]
  ds_read_b128 v[236:239], v2 offset:23552
  s_waitcnt lgkmcnt(8)
  v_mfma_f32_16x16x32_bf16 v[184:187], v[240:243], v[148:151], v[184:187]
  v_mul_f32 v210, v210, v23
  v_mul_f32 v211, v211, v23
  v_mfma_f32_16x16x32_bf16 v[192:195], v[240:243], v[164:167], v[192:195]
  ds_read_b128 v[240:243], v2 offset:24576
  v_mul_f32 v212, v212, v23
  v_mfma_f32_16x16x32_bf16 v[188:191], v[244:247], v[148:151], v[188:191]
  v_mul_f32 v213, v213, v23
  v_mul_f32 v214, v214, v23
  v_mfma_f32_16x16x32_bf16 v[196:199], v[244:247], v[164:167], v[196:199]
  ds_read_b128 v[244:247], v2 offset:25600
  s_waitcnt lgkmcnt(8)
  v_mfma_f32_16x16x32_bf16 v[184:187], v[248:251], v[168:171], v[184:187]
  v_mul_f32 v215, v215, v23
  v_cvt_pk_bf16_f32 v36, v208, v209
  v_mfma_f32_16x16x32_bf16 v[192:195], v[248:251], v[176:179], v[192:195]
  ds_read_b128 v[248:251], v2 offset:26624
  v_cvt_pk_bf16_f32 v37, v210, v211
  v_mfma_f32_16x16x32_bf16 v[188:191], v[252:255], v[168:171], v[188:191]
  v_cvt_pk_bf16_f32 v38, v212, v213
  v_cvt_pk_bf16_f32 v39, v214, v215
  v_mfma_f32_16x16x32_bf16 v[196:199], v[252:255], v[176:179], v[196:199]
  ds_read_b128 v[252:255], v2 offset:27648
  s_waitcnt lgkmcnt(8)
  v_mfma_f32_16x16x32_bf16 v[184:187], v[216:219], v[172:175], v[184:187]
  buffer_store_dwordx4 v[36:39], v6, s[16:19], 0 offen offset:192 nt sc1
  v_mfma_f32_16x16x32_bf16 v[192:195], v[216:219], v[180:183], v[192:195]
  ds_read_b128 v[216:219], v2 offset:28672
  v_mfma_f32_16x16x32_bf16 v[188:191], v[220:223], v[172:175], v[188:191]
  v_mfma_f32_16x16x32_bf16 v[196:199], v[220:223], v[180:183], v[196:199]
  ds_read_b128 v[220:223], v2 offset:29696
  s_waitcnt vmcnt(8)
  s_waitcnt lgkmcnt(8)
  v_mfma_f32_16x16x32_bf16 v[200:203], v[224:227], v[136:139], 0
  v_mul_f32 v184, v184, v22
  v_mul_f32 v185, v185, v22
  v_mfma_f32_16x16x32_bf16 v[208:211], v[224:227], v[152:155], 0
  v_mul_f32 v186, v186, v22
  v_mul_f32 v187, v187, v22
  v_mfma_f32_16x16x32_bf16 v[204:207], v[228:231], v[136:139], 0
  v_mul_f32 v188, v188, v22
  v_mul_f32 v189, v189, v22
  v_mfma_f32_16x16x32_bf16 v[212:215], v[228:231], v[152:155], 0
  v_mul_f32 v190, v190, v22
  s_waitcnt lgkmcnt(6)
  v_mfma_f32_16x16x32_bf16 v[200:203], v[232:235], v[140:143], v[200:203]
  v_mul_f32 v191, v191, v22
  v_cvt_pk_bf16_f32 v24, v184, v185
  v_mfma_f32_16x16x32_bf16 v[208:211], v[232:235], v[156:159], v[208:211]
  v_cvt_pk_bf16_f32 v25, v186, v187
  v_cvt_pk_bf16_f32 v26, v188, v189
  v_mfma_f32_16x16x32_bf16 v[204:207], v[236:239], v[140:143], v[204:207]
  v_cvt_pk_bf16_f32 v27, v190, v191
  buffer_store_dwordx4 v[24:27], v5, s[16:19], 0 offen offset:256 nt sc1
  v_mfma_f32_16x16x32_bf16 v[212:215], v[236:239], v[156:159], v[212:215]
  v_mul_f32 v192, v192, v23
  s_waitcnt lgkmcnt(5)
  v_mfma_f32_16x16x32_bf16 v[200:203], v[240:243], v[144:147], v[200:203]
  v_mul_f32 v193, v193, v23
  v_mul_f32 v194, v194, v23
  v_mfma_f32_16x16x32_bf16 v[208:211], v[240:243], v[160:163], v[208:211]
  v_mul_f32 v195, v195, v23
  s_waitcnt lgkmcnt(4)
  v_mfma_f32_16x16x32_bf16 v[204:207], v[244:247], v[144:147], v[204:207]
  v_mul_f32 v196, v196, v23
  v_mul_f32 v197, v197, v23
  v_mfma_f32_16x16x32_bf16 v[212:215], v[244:247], v[160:163], v[212:215]
  v_mul_f32 v198, v198, v23
  s_waitcnt lgkmcnt(3)
  v_mfma_f32_16x16x32_bf16 v[200:203], v[248:251], v[148:151], v[200:203]
  v_mul_f32 v199, v199, v23
  v_cvt_pk_bf16_f32 v28, v192, v193
  v_mfma_f32_16x16x32_bf16 v[208:211], v[248:251], v[164:167], v[208:211]
  v_cvt_pk_bf16_f32 v29, v194, v195
  s_waitcnt lgkmcnt(2)
  v_mfma_f32_16x16x32_bf16 v[204:207], v[252:255], v[148:151], v[204:207]
  v_cvt_pk_bf16_f32 v30, v196, v197
  v_cvt_pk_bf16_f32 v31, v198, v199
  v_mfma_f32_16x16x32_bf16 v[212:215], v[252:255], v[164:167], v[212:215]
  buffer_store_dwordx4 v[28:31], v6, s[16:19], 0 offen offset:256 nt sc1
  s_waitcnt lgkmcnt(1)
  v_mfma_f32_16x16x32_bf16 v[200:203], v[216:219], v[168:171], v[200:203]
  v_mfma_f32_16x16x32_bf16 v[208:211], v[216:219], v[176:179], v[208:211]
  s_waitcnt lgkmcnt(0)
  v_mfma_f32_16x16x32_bf16 v[204:207], v[220:223], v[168:171], v[204:207]
  v_mfma_f32_16x16x32_bf16 v[212:215], v[220:223], v[176:179], v[212:215]
  v_mfma_f32_16x16x32_bf16 v[200:203], v[40:43], v[172:175], v[200:203]
  v_mfma_f32_16x16x32_bf16 v[208:211], v[40:43], v[180:183], v[208:211]
  v_mfma_f32_16x16x32_bf16 v[204:207], v[44:47], v[172:175], v[204:207]
  v_mfma_f32_16x16x32_bf16 v[212:215], v[44:47], v[180:183], v[212:215]
  s_nop 4
  v_mul_f32 v200, v200, v22
  v_mul_f32 v201, v201, v22
  v_mul_f32 v202, v202, v22
  v_mul_f32 v203, v203, v22
  v_mul_f32 v204, v204, v22
  v_mul_f32 v205, v205, v22
  v_mul_f32 v206, v206, v22
  v_mul_f32 v207, v207, v22
  v_cvt_pk_bf16_f32 v32, v200, v201
  v_cvt_pk_bf16_f32 v33, v202, v203
  v_cvt_pk_bf16_f32 v34, v204, v205
  v_cvt_pk_bf16_f32 v35, v206, v207
  buffer_store_dwordx4 v[32:35], v5, s[16:19], 0 offen offset:320 nt sc1
  v_mul_f32 v208, v208, v23
  v_mul_f32 v209, v209, v23
  v_mul_f32 v210, v210, v23
  v_mul_f32 v211, v211, v23
  v_mul_f32 v212, v212, v23
  v_mul_f32 v213, v213, v23
  v_mul_f32 v214, v214, v23
  v_mul_f32 v215, v215, v23
  v_cvt_pk_bf16_f32 v36, v208, v209
  v_cvt_pk_bf16_f32 v37, v210, v211
  v_cvt_pk_bf16_f32 v38, v212, v213
  v_cvt_pk_bf16_f32 v39, v214, v215
  buffer_store_dwordx4 v[36:39], v6, s[16:19], 0 offen offset:320 nt sc1
MK_done:
  s_endpgm
FB0:
  s_nop 7
  v_max3_f32 v22, v24, v25, v26
  v_max3_f32 v22, v22, v27, v28
  v_max3_f32 v22, v22, v29, v30
  v_max3_f32 v22, v22, v31, v32
  v_max3_f32 v22, v22, v33, v34
  v_max3_f32 v22, v22, v35, v36
  v_max3_f32 v22, v22, v37, v38
  v_max3_f32 v22, v22, v39, v40
  v_max3_f32 v22, v22, v41, v42
  v_max3_f32 v22, v22, v43, v44
  v_max3_f32 v22, v22, v45, v46
  v_max3_f32 v22, v22, v47, v48
  v_max3_f32 v22, v22, v49, v50
  v_max3_f32 v22, v22, v51, v52
  v_max3_f32 v22, v22, v53, v54
  s_mov_b32 s52, 0xff7fffff
  v_max3_f32 v22, v22, v55, s52
  v_mov_b32 v23, v22
  s_nop 1
  v_permlane32_swap_b32 v22, v23
  s_nop 1
  v_max_f32 v22, v22, v23
  v_mov_b32 v23, v22
  s_nop 1
  v_permlane16_swap_b32 v22, v23
  s_nop 1
  v_max_f32 v22, v22, v23
  v_sub_f32 v24, v24, v22
  v_sub_f32 v25, v25, v22
  v_sub_f32 v26, v26, v22
  v_sub_f32 v27, v27, v22
  v_sub_f32 v28, v28, v22
  v_sub_f32 v29, v29, v22
  v_sub_f32 v30, v30, v22
  v_sub_f32 v31, v31, v22
  v_sub_f32 v32, v32, v22
  v_sub_f32 v33, v33, v22
  v_sub_f32 v34, v34, v22
  v_sub_f32 v35, v35, v22
  v_sub_f32 v36, v36, v22
  v_sub_f32 v37, v37, v22
  v_sub_f32 v38, v38, v22
  v_sub_f32 v39, v39, v22
  v_sub_f32 v40, v40, v22
  v_sub_f32 v41, v41, v22
  v_sub_f32 v42, v42, v22
  v_sub_f32 v43, v43, v22
  v_sub_f32 v44, v44, v22
  v_sub_f32 v45, v45, v22
  v_sub_f32 v46, v46, v22
  v_sub_f32 v47, v47, v22
  v_sub_f32 v48, v48, v22
  v_sub_f32 v49, v49, v22
  v_sub_f32 v50, v50, v22
  v_sub_f32 v51, v51, v22
  v_sub_f32 v52, v52, v22
  v_sub_f32 v53, v53, v22
  v_sub_f32 v54, v54, v22
  v_sub_f32 v55, v55, v22
  v_exp_f32 v24, v24
  v_exp_f32 v25, v25
  v_exp_f32 v26, v26
  v_exp_f32 v27, v27
  v_exp_f32 v28, v28
  v_exp_f32 v29, v29
  v_exp_f32 v30, v30
  v_exp_f32 v31, v31
  v_exp_f32 v32, v32
  v_exp_f32 v33, v33
  v_exp_f32 v34, v34
  v_exp_f32 v35, v35
  v_exp_f32 v36, v36
  v_exp_f32 v37, v37
  v_exp_f32 v38, v38
  v_exp_f32 v39, v39
  v_exp_f32 v40, v40
  v_exp_f32 v41, v41
  v_exp_f32 v42, v42
  v_exp_f32 v43, v43
  v_exp_f32 v44, v44
  v_exp_f32 v45, v45
  v_exp_f32 v46, v46
  v_exp_f32 v47, v47
  v_exp_f32 v48, v48
  v_exp_f32 v49, v49
  v_exp_f32 v50, v50
  v_exp_f32 v51, v51
  v_exp_f32 v52, v52
  v_exp_f32 v53, v53
  v_exp_f32 v54, v54
  v_exp_f32 v55, v55
  s_nop 0
  v_cvt_pk_bf16_f32 v136, v24, v25
  v_cvt_pk_bf16_f32 v137, v26, v27
  v_cvt_pk_bf16_f32 v138, v28, v29
  v_cvt_pk_bf16_f32 v139, v30, v31
  v_cvt_pk_bf16_f32 v140, v32, v33
  v_cvt_pk_bf16_f32 v141, v34, v35
  v_cvt_pk_bf16_f32 v142, v36, v37
  v_cvt_pk_bf16_f32 v143, v38, v39
  v_cvt_pk_bf16_f32 v144, v40, v41
  v_cvt_pk_bf16_f32 v145, v42, v43
  v_cvt_pk_bf16_f32 v146, v44, v45
  v_cvt_pk_bf16_f32 v147, v46, v47
  v_cvt_pk_bf16_f32 v148, v48, v49
  v_cvt_pk_bf16_f32 v149, v50, v51
  v_cvt_pk_bf16_f32 v150, v52, v53
  v_cvt_pk_bf16_f32 v151, v54, v55
  s_nop 1
  v_mfma_f32_16x16x32_bf16 v[184:187], v[192:195], v[136:139], 0
  v_mfma_f32_16x16x32_bf16 v[184:187], v[192:195], v[140:143], v[184:187]
  v_mfma_f32_16x16x32_bf16 v[184:187], v[192:195], v[144:147], v[184:187]
  v_mfma_f32_16x16x32_bf16 v[184:187], v[192:195], v[148:151], v[184:187]
  s_nop 7
  s_branch FBR0
FB1:
  s_nop 7
  v_max3_f32 v22, v56, v57, v58
  v_max3_f32 v22, v22, v59, v60
  v_max3_f32 v22, v22, v61, v62
  v_max3_f32 v22, v22, v63, v64
  v_max3_f32 v22, v22, v65, v66
  v_max3_f32 v22, v22, v67, v68
  v_max3_f32 v22, v22, v69, v70
  v_max3_f32 v22, v22, v71, v72
  v_max3_f32 v22, v22, v73, v74
  v_max3_f32 v22, v22, v75, v76
  v_max3_f32 v22, v22, v77, v78
  v_max3_f32 v22, v22, v79, v80
  v_max3_f32 v22, v22, v81, v82
  v_max3_f32 v22, v22, v83, v84
  v_max3_f32 v22, v22, v85, v86
  s_mov_b32 s52, 0xff7fffff
  v_max3_f32 v22, v22, v87, s52
  v_mov_b32 v23, v22
  s_nop 1
  v_permlane32_swap_b32 v22, v23
  s_nop 1
  v_max_f32 v22, v22, v23
  v_mov_b32 v23, v22
  s_nop 1
  v_permlane16_swap_b32 v22, v23
  s_nop 1
  v_max_f32 v22, v22, v23
  v_sub_f32 v56, v56, v22
  v_sub_f32 v57, v57, v22
  v_sub_f32 v58, v58, v22
  v_sub_f32 v59, v59, v22
  v_sub_f32 v60, v60, v22
  v_sub_f32 v61, v61, v22
  v_sub_f32 v62, v62, v22
  v_sub_f32 v63, v63, v22
  v_sub_f32 v64, v64, v22
  v_sub_f32 v65, v65, v22
  v_sub_f32 v66, v66, v22
  v_sub_f32 v67, v67, v22
  v_sub_f32 v68, v68, v22
  v_sub_f32 v69, v69, v22
  v_sub_f32 v70, v70, v22
  v_sub_f32 v71, v71, v22
  v_sub_f32 v72, v72, v22
  v_sub_f32 v73, v73, v22
  v_sub_f32 v74, v74, v22
  v_sub_f32 v75, v75, v22
  v_sub_f32 v76, v76, v22
  v_sub_f32 v77, v77, v22
  v_sub_f32 v78, v78, v22
  v_sub_f32 v79, v79, v22
  v_sub_f32 v80, v80, v22
  v_sub_f32 v81, v81, v22
  v_sub_f32 v82, v82, v22
  v_sub_f32 v83, v83, v22
  v_sub_f32 v84, v84, v22
  v_sub_f32 v85, v85, v22
  v_sub_f32 v86, v86, v22
  v_sub_f32 v87, v87, v22
  v_exp_f32 v56, v56
  v_exp_f32 v57, v57
  v_exp_f32 v58, v58
  v_exp_f32 v59, v59
  v_exp_f32 v60, v60
  v_exp_f32 v61, v61
  v_exp_f32 v62, v62
  v_exp_f32 v63, v63
  v_exp_f32 v64, v64
  v_exp_f32 v65, v65
  v_exp_f32 v66, v66
  v_exp_f32 v67, v67
  v_exp_f32 v68, v68
  v_exp_f32 v69, v69
  v_exp_f32 v70, v70
  v_exp_f32 v71, v71
  v_exp_f32 v72, v72
  v_exp_f32 v73, v73
  v_exp_f32 v74, v74
  v_exp_f32 v75, v75
  v_exp_f32 v76, v76
  v_exp_f32 v77, v77
  v_exp_f32 v78, v78
  v_exp_f32 v79, v79
  v_exp_f32 v80, v80
  v_exp_f32 v81, v81
  v_exp_f32 v82, v82
  v_exp_f32 v83, v83
  v_exp_f32 v84, v84
  v_exp_f32 v85, v85
  v_exp_f32 v86, v86
  v_exp_f32 v87, v87
  s_nop 0
  v_cvt_pk_bf16_f32 v152, v56, v57
  v_cvt_pk_bf16_f32 v153, v58, v59
  v_cvt_pk_bf16_f32 v154, v60, v61
  v_cvt_pk_bf16_f32 v155, v62, v63
  v_cvt_pk_bf16_f32 v156, v64, v65
  v_cvt_pk_bf16_f32 v157, v66, v67
  v_cvt_pk_bf16_f32 v158, v68, v69
  v_cvt_pk_bf16_f32 v159, v70, v71
  v_cvt_pk_bf16_f32 v160, v72, v73
  v_cvt_pk_bf16_f32 v161, v74, v75
  v_cvt_pk_bf16_f32 v162, v76, v77
  v_cvt_pk_bf16_f32 v163, v78, v79
  v_cvt_pk_bf16_f32 v164, v80, v81
  v_cvt_pk_bf16_f32 v165, v82, v83
  v_cvt_pk_bf16_f32 v166, v84, v85
  v_cvt_pk_bf16_f32 v167, v86, v87
  s_nop 1
  v_mfma_f32_16x16x32_bf16 v[188:191], v[192:195], v[152:155], 0
  v_mfma_f32_16x16x32_bf16 v[188:191], v[192:195], v[156:159], v[188:191]
  v_mfma_f32_16x16x32_bf16 v[188:191], v[192:195], v[160:163], v[188:191]
  v_mfma_f32_16x16x32_bf16 v[188:191], v[192:195], v[164:167], v[188:191]
  s_nop 7
  s_branch FBR1
MK_end:
.section .rodata,"a"
.p2align 6
.amdhsa_kernel standalone__neighborhood_nat__vision_kernel
  .amdhsa_next_free_vgpr 256
  .amdhsa_next_free_sgpr 102
  .amdhsa_accum_offset 256
  .amdhsa_group_segment_fixed_size 0
  .amdhsa_kernarg_size 48
  .amdhsa_user_sgpr_count 2
  .amdhsa_user_sgpr_kernarg_segment_ptr 1
  .amdhsa_system_sgpr_workgroup_id_x 1
.end_amdhsa_kernel
```

```asm
; @launch grid=(256,1,1) block=(512,1,1) lds=163840
.amdgcn_target "amdgcn-amd-amdhsa--gfx950"
.text
.globl standalone__neighborhood_nat__vision_kernel
.p2align 8
.type standalone__neighborhood_nat__vision_kernel,@function
standalone__neighborhood_nat__vision_kernel:
  s_cmp_ge_u32 s2, 256
  s_cbranch_scc1 MK_done
  s_load_dwordx8 s[4:11], s[0:1], 0
  s_load_dwordx4 s[84:87], s[0:1], 32
  s_getpc_b64 s[12:13]
MK_pc:
  s_and_b32 s13, s13, 0xffff
  s_mov_b32 s14, MK_end-MK_pc
  s_mov_b32 s15, 0x00020000
  v_lshlrev_b32 v23, 7, v0
  buffer_load_dword v255, v23, s[12:15], 0 offen
  v_lshrrev_b32 v130, 6, v0
  v_and_b32 v0, 63, v0
  v_readfirstlane_b32 s24, v130
  v_and_b32 v128, 15, v0
  v_lshrrev_b32 v129, 4, v0
  v_lshrrev_b32 v130, 5, v0
  v_bfe_u32 v131, v0, 3, 2
  v_lshl_add_u32 v130, v130, 3, v131
  v_mul_u32_u24 v130, 1152, v130
  s_and_b32 s26, s24, 1
  s_lshl_b32 s46, s26, 2
  v_add_u32 v131, s46, v129
  v_and_b32 v132, 7, v0
  v_xor_b32 v131, v131, v132
  v_lshl_add_u32 v96, v131, 4, v130
  s_lshr_b32 s46, s24, 2
  s_lshl_b32 s46, s46, 5
  s_lshl_b32 s47, s26, 4
  s_add_u32 s46, s46, s47
  s_and_b32 s47, s24, 2
  s_lshl_b32 s47, s47, 1
  s_add_u32 s46, s46, s47
  s_mul_i32 s92, s46, 1152
  s_lshl_b32 s41, s24, 10
  s_cmp_lt_u32 s24, 4
  s_cselect_b64 vcc, -1, 0
  s_bfe_u32 s27, s2, 0x10002
  s_bfe_u32 s28, s2, 0x10001
  s_and_b32 s29, s2, 1
  s_lshl_b32 s29, s29, 2
  s_lshr_b32 s46, s2, 6
  s_add_u32 s29, s29, s46
  s_bfe_u32 s30, s2, 0x30003
  s_mul_i32 s37, s29, 14
  s_add_i32 s37, s37, -6
  s_max_i32 s29, s37, -4
  s_mul_i32 s30, s30, 14
  s_add_i32 s30, s30, -6
  s_lshr_b32 s25, s24, 1
  s_add_u32 s25, s25, 2
  s_and_b32 s25, s25, 3
  s_sub_u32 s56, 0, s27
  s_mul_i32 s57, s27, 224
  s_sub_u32 s58, 0, s28
  s_mul_i32 s59, s28, 224
  v_and_b32 v130, 7, v128
  s_mul_i32 s46, s26, 7
  s_add_i32 s46, s46, s30
  v_cmp_lt_u32 s[48:49], 6, v130
  v_add_u32 v130, s46, v130
  v_max_i32 v19, 0, v130
  v_add3_u32 v130, v130, v19, 6
  v_xor_b32 v130, s58, v130
  v_add_u32 v130, s59, v130
  v_subrev_u32 v19, s30, v19
  v_mul_u32_u24 v130, 384, v130
  v_lshl_add_u32 v130, v129, 4, v130
  s_lshl_b32 s46, s25, 2
  s_add_i32 s46, s46, -2
  s_mov_b32 s47, 86016
  v_lshrrev_b32 v131, 3, v128
  v_add_u32 v131, s46, v131
  v_mov_b32 v132, 0x80000000
  v_cmp_gt_i32 s[42:43], 0, v131
  v_add_u32 v5, s37, v131
  v_max_i32 v21, 0, v5
  v_add3_u32 v5, v5, v21, 6
  s_or_b64 s[42:43], s[42:43], s[48:49]
  v_xor_b32 v5, s56, v5
  v_add_u32 v5, s57, v5
  v_subrev_u32 v21, s29, v21
  v_mad_u32_u24 v5, v5, s47, v130
  v_cndmask_b32 v21, v21, v132, s[42:43]
  v_cndmask_b32 v5, v5, v132, s[42:43]
  v_add_u32 v131, 2, v131
  v_cmp_gt_i32 s[44:45], 0, v131
  v_add_u32 v6, s37, v131
  v_max_i32 v22, 0, v6
  v_add3_u32 v6, v6, v22, 6
  s_or_b64 s[44:45], s[44:45], s[48:49]
  v_xor_b32 v6, s56, v6
  v_add_u32 v6, s57, v6
  v_subrev_u32 v22, s29, v22
  v_mad_u32_u24 v6, v6, s47, v130
  v_cndmask_b32 v22, v22, v132, s[44:45]
  v_cndmask_b32 v6, v6, v132, s[44:45]
  s_waitcnt lgkmcnt(0)
  s_mov_b32 s88, s6
  s_and_b32 s89, s7, 0xffff
  s_mov_b32 s90, 221184
  s_mov_b32 s91, 0x00020000
  s_cmp_lg_u32 s24, 5
  s_cbranch_scc1 MK_ntlb
  s_max_i32 s46, s37, 0
  s_lshl_b32 s46, s46, 1
  s_sub_u32 s47, 184, s46
  s_cmp_eq_u32 s27, 0
  s_cselect_b32 s46, s46, s47
  s_mul_i32 s46, s46, 86016
  s_load_dword s94, s[4:5], s46
  s_load_dword s95, s[10:11], s46
  s_add_u32 s46, s46, 1720256
  s_load_dword s94, s[4:5], s46
  s_load_dword s95, s[10:11], s46
  s_add_u32 s46, s46, 1720256
  s_load_dword s94, s[4:5], s46
  s_load_dword s95, s[10:11], s46
  s_load_dword s94, s[84:85], 128
  s_load_dword s95, s[86:87], 0x20000
MK_ntlb:
  s_cmp_lt_u32 s24, 6
  s_cbranch_scc1 MK_nwpf
  s_cmp_eq_u32 s24, 6
  s_cselect_b32 s46, 54, 18
  s_cselect_b32 s12, s6, s8
  s_cselect_b32 s13, s7, s9
  s_and_b32 s13, s13, 0xffff
  s_lshr_b32 s47, s2, 3
  s_mul_i32 s47, s47, s46
  s_lshl_b32 s100, s47, 7
  s_lshl_b32 s46, s46, 7
  s_add_u32 s14, s100, s46
  s_mov_b32 s15, 0x00020000
  v_lshlrev_b32 v23, 7, v0
  buffer_load_dword v254, v23, s[12:15], s100 offen
MK_nwpf:
  s_mov_b32 s12, s4
  s_and_b32 s13, s5, 0xffff
  s_mov_b32 s14, 19267584
  s_mov_b32 s15, 0x00020000
  s_movk_i32 s54, 112
  s_add_u32 m0, s41, 0
  s_add_u32 s100, s92, 0
  buffer_load_dwordx4 v96, s[88:91], s100 offen lds
  s_add_u32 m0, s41, 8192
  s_add_u32 s100, s92, 73728
  buffer_load_dwordx4 v96, s[88:91], s100 offen lds
  s_add_u32 m0, s41, 16384
  s_add_u32 s100, s92, 147456
  buffer_load_dwordx4 v96, s[88:91], s100 offen lds
  s_add_u32 m0, s41, 24576
  s_add_u32 s100, s92, 384
  buffer_load_dwordx4 v96, s[88:91], s100 offen lds
  s_add_u32 m0, s41, 32768
  s_add_u32 s100, s92, 74112
  buffer_load_dwordx4 v96, s[88:91], s100 offen lds
  s_add_u32 m0, s41, 40960
  s_add_u32 s100, s92, 147840
  buffer_load_dwordx4 v96, s[88:91], s100 offen lds
  s_mov_b32 s16, s10
  s_and_b32 s17, s11, 0xffff
  s_mov_b32 s18, 19267584
  s_mov_b32 s19, 0x00020000
  s_mov_b32 s4, s8
  s_and_b32 s5, s9, 0xffff
  s_mov_b32 s6, 73728
  s_mov_b32 s7, 0x00020000
  s_mov_b32 s8, s84
  s_and_b32 s9, s85, 0xffff
  s_mov_b32 s10, 256
  s_mov_b32 s11, 0x00020000
  s_mov_b32 s20, s86
  s_and_b32 s21, s87, 0xffff
  s_mov_b32 s22, 73728
  s_mov_b32 s23, 0x00020000
  v_lshlrev_b32 v1, 4, v0
  v_add_u32 v2, 36864, v1
  s_and_b32 s40, s24, 3
  s_lshl_b32 s40, s40, 10
  v_bfe_u32 v130, v128, 1, 3
  v_xor_b32 v130, v130, v129
  v_lshlrev_b32 v131, 7, v128
  v_lshl_add_u32 v131, v130, 4, v131
  s_lshr_b32 s46, s24, 2
  s_mul_i32 s47, s46, 12288
  v_add_u32 v97, s47, v131
  v_xor_b32 v98, 64, v97
  s_mul_i32 s47, s40, 6
  s_add_u32 s47, s47, 24576
  v_add_u32 v99, s47, v131
  v_xor_b32 v100, 64, v99
  s_lshr_b32 s46, s24, 2
  s_mul_i32 s46, s46, 6
  s_sub_u32 s46, 67, s46
  s_and_b32 s47, s24, 3
  s_mul_i32 s47, s47, 3
  s_add_u32 s48, s47, 0
  s_lshr_b32 s49, s48, 1
  s_mul_i32 s49, s49, 10
  s_add_u32 s48, s48, s49
  s_sub_u32 s48, s46, s48
  s_lshl_b32 s48, s48, 10
  v_add_u32 v101, s48, v1
  s_add_u32 s48, s47, 1
  s_lshr_b32 s49, s48, 1
  s_mul_i32 s49, s49, 10
  s_add_u32 s48, s48, s49
  s_sub_u32 s48, s46, s48
  s_lshl_b32 s48, s48, 10
  v_add_u32 v102, s48, v1
  s_add_u32 s48, s47, 2
  s_lshr_b32 s49, s48, 1
  s_mul_i32 s49, s49, 10
  s_add_u32 s48, s48, s49
  s_sub_u32 s48, s46, s48
  s_lshl_b32 s48, s48, 10
  v_add_u32 v103, s48, v1
  s_lshl_b32 s46, s29, 1
  s_xor_b32 s46, s46, s56
  s_mul_i32 s47, s27, 222
  s_add_i32 s31, s46, s47
  s_mul_i32 s31, s31, 86016
  s_mul_i32 s32, s27, -688128
  s_add_i32 s32, s32, 344064
  s_lshr_b32 s33, s29, 31
  s_lshl_b32 s33, s33, 1
  s_lshl_b32 s38, s40, 2
  s_add_u32 s39, s38, 3072
  s_min_u32 s39, s39, 14336
  s_mul_i32 s48, s27, 172032
  s_sub_u32 s49, 172032, s48
  v_mov_b32 v132, s48
  v_mov_b32 v133, s49
  s_lshr_b32 s46, s38, 4
  s_add_u32 s46, s46, 0
  v_add_u32 v130, s46, v0
  v_mul_u32_u24 v13, 2731, v130
  v_lshrrev_b32 v13, 16, v13
  v_cmp_le_u32 s[52:53], 20, v13
  v_mul_u32_u24 v131, 24, v13
  v_sub_u32 v130, v130, v131
  v_subrev_u32 v131, 20, v13
  v_cndmask_b32 v13, v13, v131, s[52:53]
  v_bfe_u32 v131, v13, 1, 3
  v_xor_b32 v130, v130, v131
  v_cndmask_b32 v131, v132, v133, s[52:53]
  v_lshl_add_u32 v130, v130, 4, v131
  v_add_u32 v13, s30, v13
  v_max_i32 v13, 0, v13
  v_lshlrev_b32 v13, 1, v13
  v_xor_b32 v13, s58, v13
  v_add_u32 v13, s59, v13
  v_mul_u32_u24 v13, 384, v13
  v_add_u32 v13, v13, v130
  s_lshr_b32 s46, s38, 4
  s_add_u32 s46, s46, 64
  v_add_u32 v130, s46, v0
  v_mul_u32_u24 v14, 2731, v130
  v_lshrrev_b32 v14, 16, v14
  v_cmp_le_u32 s[52:53], 20, v14
  v_mul_u32_u24 v131, 24, v14
  v_sub_u32 v130, v130, v131
  v_subrev_u32 v131, 20, v14
  v_cndmask_b32 v14, v14, v131, s[52:53]
  v_bfe_u32 v131, v14, 1, 3
  v_xor_b32 v130, v130, v131
  v_cndmask_b32 v131, v132, v133, s[52:53]
  v_lshl_add_u32 v130, v130, 4, v131
  v_add_u32 v14, s30, v14
  v_max_i32 v14, 0, v14
  v_lshlrev_b32 v14, 1, v14
  v_xor_b32 v14, s58, v14
  v_add_u32 v14, s59, v14
  v_mul_u32_u24 v14, 384, v14
  v_add_u32 v14, v14, v130
  s_lshr_b32 s46, s38, 4
  s_add_u32 s46, s46, 128
  v_add_u32 v130, s46, v0
  v_mul_u32_u24 v3, 2731, v130
  v_lshrrev_b32 v3, 16, v3
  v_cmp_le_u32 s[52:53], 20, v3
  v_mul_u32_u24 v131, 24, v3
  v_sub_u32 v130, v130, v131
  v_subrev_u32 v131, 20, v3
  v_cndmask_b32 v3, v3, v131, s[52:53]
  v_bfe_u32 v131, v3, 1, 3
  v_xor_b32 v130, v130, v131
  v_cndmask_b32 v131, v132, v133, s[52:53]
  v_lshl_add_u32 v130, v130, 4, v131
  v_add_u32 v3, s30, v3
  v_max_i32 v3, 0, v3
  v_lshlrev_b32 v3, 1, v3
  v_xor_b32 v3, s58, v3
  v_add_u32 v3, s59, v3
  v_mul_u32_u24 v3, 384, v3
  v_add_u32 v3, v3, v130
  s_lshr_b32 s46, s39, 4
  v_add_u32 v130, s46, v0
  v_mul_u32_u24 v4, 2731, v130
  v_lshrrev_b32 v4, 16, v4
  v_cmp_le_u32 s[52:53], 20, v4
  v_mul_u32_u24 v131, 24, v4
  v_sub_u32 v130, v130, v131
  v_subrev_u32 v131, 20, v4
  v_cndmask_b32 v4, v4, v131, s[52:53]
  v_bfe_u32 v131, v4, 1, 3
  v_xor_b32 v130, v130, v131
  v_cndmask_b32 v131, v132, v133, s[52:53]
  v_lshl_add_u32 v130, v130, 4, v131
  v_add_u32 v4, s30, v4
  v_max_i32 v4, 0, v4
  v_lshlrev_b32 v4, 1, v4
  v_xor_b32 v4, s58, v4
  v_add_u32 v4, s59, v4
  v_mul_u32_u24 v4, 384, v4
  v_add_u32 v4, v4, v130
  s_add_u32 s38, s38, 10240
  s_add_u32 s39, s39, 10240
  s_lshl_b32 s46, s25, 2
  s_add_i32 s46, s46, -2
  s_max_i32 s46, s46, 0
  s_add_i32 s46, s46, s37
  s_max_i32 s46, s46, 0
  s_sub_i32 s46, s46, s29
  s_lshl_b32 s34, s25, 2
  s_add_i32 s34, s34, s37
  s_max_i32 s34, s34, 0
  s_sub_i32 s34, s34, s29
  s_sub_u32 s46, s34, s46
  s_lshr_b32 s46, s46, 1
  s_mul_i32 s36, s46, -8
  s_add_i32 s36, s36, 7
  s_add_i32 s34, s34, -1
  s_add_i32 s35, s34, s36
  s_mul_i32 s36, s36, 7680
  s_lshl_b32 s47, s26, 2
  s_mul_i32 s46, s34, 7680
  s_add_i32 s46, s46, 10240
  v_add_u32 v130, s47, v128
  v_bfe_u32 v131, v130, 1, 3
  v_xor_b32 v131, v131, v129
  v_mul_u32_u24 v130, 384, v130
  v_lshl_add_u32 v130, v131, 4, v130
  v_add_u32 v7, s46, v130
  v_xor_b32 v8, 64, v7
  v_lshrrev_b32 v130, 2, v128
  v_lshl_add_u32 v130, v129, 2, v130
  v_add_u32 v130, s47, v130
  v_bfe_u32 v131, v130, 1, 3
  v_and_b32 v132, 2, v128
  v_lshlrev_b32 v132, 1, v132
  v_xor_b32 v131, v131, v132
  v_mul_u32_u24 v130, 384, v130
  v_lshl_add_u32 v130, v131, 4, v130
  v_and_b32 v131, 1, v128
  v_lshl_add_u32 v130, v131, 3, v130
  v_add_u32 v9, s46, v130
  v_xor_b32 v10, 16, v9
  v_xor_b32 v11, 32, v9
  v_xor_b32 v12, 48, v9
  v_lshl_add_u32 v130, v129, 2, s47
  v_sub_u32 v19, v130, v19
  v_add_u32 v20, s36, v7
  v_add_u32 v0, s36, v8
  v_add_u32 v15, s36, v9
  v_add_u32 v16, s36, v10
  v_add_u32 v17, s36, v11
  v_add_u32 v18, s36, v12
  s_mov_b32 s93, 1037384597
  s_add_u32 m0, s41, 49152
  s_add_u32 s100, s92, 128
  buffer_load_dwordx4 v96, s[88:91], s100 offen lds
  s_add_u32 m0, s41, 57344
  s_add_u32 s100, s92, 73856
  buffer_load_dwordx4 v96, s[88:91], s100 offen lds
  s_add_u32 m0, s41, 65536
  s_add_u32 s100, s92, 147584
  buffer_load_dwordx4 v96, s[88:91], s100 offen lds
  s_add_u32 m0, s41, 73728
  s_add_u32 s100, s92, 512
  buffer_load_dwordx4 v96, s[88:91], s100 offen lds
  s_add_u32 m0, s41, 81920
  s_add_u32 s100, s92, 74240
  buffer_load_dwordx4 v96, s[88:91], s100 offen lds
  s_add_u32 m0, s41, 90112
  s_add_u32 s100, s92, 147968
  buffer_load_dwordx4 v96, s[88:91], s100 offen lds
  s_waitcnt vmcnt(6)
  s_barrier
  ds_read_b128 v[208:211], v99 offset:0
  ds_read_b128 v[212:215], v99 offset:2048
  ds_read_b128 v[216:219], v99 offset:4096
  ds_read_b128 v[184:187], v97 offset:0
  ds_read_b128 v[188:191], v97 offset:2048
  ds_read_b128 v[192:195], v97 offset:4096
  ds_read_b128 v[196:199], v97 offset:6144
  ds_read_b128 v[200:203], v97 offset:8192
  ds_read_b128 v[204:207], v97 offset:10240
  s_waitcnt lgkmcnt(5)
  v_mfma_f32_16x16x32_bf16 v[24:27], v[184:187], v[208:211], 0
  s_add_u32 m0, s41, 98304
  s_add_u32 s100, s92, 256
  buffer_load_dwordx4 v96, s[88:91], s100 offen lds
  v_mfma_f32_16x16x32_bf16 v[28:31], v[184:187], v[212:215], 0
  v_mfma_f32_16x16x32_bf16 v[32:35], v[184:187], v[216:219], 0
  s_waitcnt lgkmcnt(4)
  v_mfma_f32_16x16x32_bf16 v[36:39], v[188:191], v[208:211], 0
  ds_read_b128 v[244:247], v100 offset:0
  s_add_u32 m0, s41, 106496
  s_add_u32 s100, s92, 73984
  buffer_load_dwordx4 v96, s[88:91], s100 offen lds
  v_mfma_f32_16x16x32_bf16 v[40:43], v[188:191], v[212:215], 0
  ds_read_b128 v[248:251], v100 offset:2048
  v_mfma_f32_16x16x32_bf16 v[44:47], v[188:191], v[216:219], 0
  s_waitcnt lgkmcnt(5)
  v_mfma_f32_16x16x32_bf16 v[48:51], v[192:195], v[208:211], 0
  ds_read_b128 v[252:255], v100 offset:4096
  s_add_u32 m0, s41, 114688
  s_add_u32 s100, s92, 147712
  buffer_load_dwordx4 v96, s[88:91], s100 offen lds
  v_mfma_f32_16x16x32_bf16 v[52:55], v[192:195], v[212:215], 0
  ds_read_b128 v[220:223], v98 offset:0
  v_mfma_f32_16x16x32_bf16 v[56:59], v[192:195], v[216:219], 0
  s_waitcnt lgkmcnt(6)
  v_mfma_f32_16x16x32_bf16 v[60:63], v[196:199], v[208:211], 0
  ds_read_b128 v[224:227], v98 offset:2048
  s_add_u32 m0, s41, 122880
  s_add_u32 s100, s92, 640
  buffer_load_dwordx4 v96, s[88:91], s100 offen lds
  v_mfma_f32_16x16x32_bf16 v[64:67], v[196:199], v[212:215], 0
  ds_read_b128 v[228:231], v98 offset:4096
  v_mfma_f32_16x16x32_bf16 v[68:71], v[196:199], v[216:219], 0
  s_waitcnt lgkmcnt(7)
  v_mfma_f32_16x16x32_bf16 v[72:75], v[200:203], v[208:211], 0
  ds_read_b128 v[232:235], v98 offset:6144
  s_add_u32 m0, s41, 131072
  s_add_u32 s100, s92, 74368
  buffer_load_dwordx4 v96, s[88:91], s100 offen lds
  v_mfma_f32_16x16x32_bf16 v[76:79], v[200:203], v[212:215], 0
  ds_read_b128 v[236:239], v98 offset:8192
  v_mfma_f32_16x16x32_bf16 v[80:83], v[200:203], v[216:219], 0
  s_waitcnt lgkmcnt(8)
  v_mfma_f32_16x16x32_bf16 v[84:87], v[204:207], v[208:211], 0
  ds_read_b128 v[240:243], v98 offset:10240
  s_add_u32 m0, s41, 139264
  s_add_u32 s100, s92, 148096
  buffer_load_dwordx4 v96, s[88:91], s100 offen lds
  v_mfma_f32_16x16x32_bf16 v[88:91], v[204:207], v[212:215], 0
  v_mfma_f32_16x16x32_bf16 v[92:95], v[204:207], v[216:219], 0
  v_lshrrev_b32 v107, 4, v1
  s_cmp_lt_u32 s2, 72
  s_cbranch_scc0 MK_np1
  s_mul_hi_u32 s54, s2, 0x15555556
  s_lshl_b32 s54, s54, 6
  s_mul_i32 s55, s24, 6144
  s_add_u32 s100, s54, s55
  v_lshrrev_b32 v104, 2, v107
  v_mul_u32_u24 v104, 384, v104
  v_and_b32 v105, 3, v107
  v_lshl_add_u32 v104, v105, 4, v104
  s_add_u32 m0, s41, 147456
  s_nop 0
  buffer_load_dwordx4 v104, s[4:7], s100 offen lds
  s_mul_i32 s55, s40, 6
  s_add_u32 s100, s54, s55
  s_add_u32 m0, s40, 155648
  s_add_u32 s100, s100, 49152
  buffer_load_dwordx4 v104, s[4:7], s100 offen lds
MK_np1:
  s_sub_u32 s3, s2, 72
  s_lshr_b32 s3, s3, 31
  s_lshr_b32 s3, s3, s25
  v_mov_b32 v134, 0
  s_cmp_eq_u32 s3, 0
  s_cbranch_scc1 MK_np3
  s_mul_hi_u32 s54, s2, 0x15555556
  s_mul_i32 s55, s54, 12
  s_sub_u32 s55, s2, s55
  s_and_b32 s51, s55, 1
  s_lshr_b32 s55, s55, 1
  v_lshrrev_b32 v106, 2, v128
  v_and_b32 v105, 3, v128
  v_lshl_add_u32 v134, v129, 3, v106
  v_lshlrev_b32 v134, 6, v134
  v_lshl_add_u32 v134, v105, 4, v134
  s_lshl_b32 s51, s51, 3
  s_add_u32 s51, s51, 147456
  v_add_u32 v134, s51, v134
  s_lshr_b32 s54, s55, 1
  s_lshl_b32 s54, s54, 6
  s_and_b32 s55, s55, 1
  s_lshl_b32 s55, s55, 4
  s_add_u32 s54, s54, s55
  v_lshrrev_b32 v104, 1, v106
  v_lshlrev_b32 v104, 5, v104
  v_and_b32 v106, 1, v106
  v_lshl_add_u32 v104, v106, 2, v104
  v_add3_u32 v104, v104, v105, s54
  v_mul_u32_u24 v104, 1152, v104
  v_lshl_add_u32 v135, v129, 4, v104
  s_mul_i32 s100, s26, 9216
  buffer_load_dwordx4 v[136:139], v135, s[88:91], s100 offen offset:768
  buffer_load_dwordx4 v[140:143], v135, s[88:91], s100 offen offset:832
  buffer_load_dwordx4 v[144:147], v135, s[88:91], s100 offen offset:896
  buffer_load_dwordx4 v[148:151], v135, s[88:91], s100 offen offset:960
  buffer_load_dwordx4 v[152:155], v135, s[88:91], s100 offen offset:1024
  buffer_load_dwordx4 v[156:159], v135, s[88:91], s100 offen offset:1088
MK_np3:
  s_cmp_lg_u32 s3, 0
  s_cbranch_scc1 CA1
  s_cmp_lt_u32 s2, 72
  s_cbranch_scc1 CB1
  s_waitcnt vmcnt(6)
CB1:
  s_waitcnt vmcnt(8)
CA1:
  s_waitcnt vmcnt(14) lgkmcnt(0)
  s_barrier
  v_add_u32 v97, 49152, v97
  v_add_u32 v98, 49152, v98
  v_add_u32 v99, 49152, v99
  v_add_u32 v100, 49152, v100
  v_mfma_f32_16x16x32_bf16 v[24:27], v[220:223], v[244:247], v[24:27]
  ds_read_b128 v[208:211], v99 offset:0
  s_cbranch_vccnz SL2
  buffer_load_dwordx4 v[160:163], v6, s[12:15], 0 offen offset:0
SL2:
  v_mfma_f32_16x16x32_bf16 v[28:31], v[220:223], v[248:251], v[28:31]
  ds_read_b128 v[212:215], v99 offset:2048
  v_mfma_f32_16x16x32_bf16 v[32:35], v[220:223], v[252:255], v[32:35]
  v_mfma_f32_16x16x32_bf16 v[36:39], v[224:227], v[244:247], v[36:39]
  ds_read_b128 v[216:219], v99 offset:4096
  s_cbranch_vccnz SL3
  buffer_load_dwordx4 v[164:167], v6, s[12:15], 0 offen offset:64
SL3:
  v_mfma_f32_16x16x32_bf16 v[40:43], v[224:227], v[248:251], v[40:43]
  ds_read_b128 v[184:187], v97 offset:0
  v_mfma_f32_16x16x32_bf16 v[44:47], v[224:227], v[252:255], v[44:47]
  v_mfma_f32_16x16x32_bf16 v[48:51], v[228:231], v[244:247], v[48:51]
  ds_read_b128 v[188:191], v97 offset:2048
  s_cbranch_vccnz SL4
  buffer_load_dwordx4 v[168:171], v6, s[12:15], 0 offen offset:128
SL4:
  v_mfma_f32_16x16x32_bf16 v[52:55], v[228:231], v[248:251], v[52:55]
  ds_read_b128 v[192:195], v97 offset:4096
  v_mfma_f32_16x16x32_bf16 v[56:59], v[228:231], v[252:255], v[56:59]
  v_mfma_f32_16x16x32_bf16 v[60:63], v[232:235], v[244:247], v[60:63]
  ds_read_b128 v[196:199], v97 offset:6144
  s_cbranch_vccnz SL5
  buffer_load_dwordx4 v[172:175], v6, s[12:15], 0 offen offset:192
SL5:
  v_mfma_f32_16x16x32_bf16 v[64:67], v[232:235], v[248:251], v[64:67]
  ds_read_b128 v[200:203], v97 offset:8192
  v_mfma_f32_16x16x32_bf16 v[68:71], v[232:235], v[252:255], v[68:71]
  v_mfma_f32_16x16x32_bf16 v[72:75], v[236:239], v[244:247], v[72:75]
  ds_read_b128 v[204:207], v97 offset:10240
  s_cbranch_vccnz SL6
  buffer_load_dwordx4 v[176:179], v6, s[12:15], 0 offen offset:256
SL6:
  v_mfma_f32_16x16x32_bf16 v[76:79], v[236:239], v[248:251], v[76:79]
  v_mfma_f32_16x16x32_bf16 v[80:83], v[236:239], v[252:255], v[80:83]
  v_mfma_f32_16x16x32_bf16 v[84:87], v[240:243], v[244:247], v[84:87]
  s_cbranch_vccnz SL7
  buffer_load_dwordx4 v[180:183], v6, s[12:15], 0 offen offset:320
SL7:
  v_mfma_f32_16x16x32_bf16 v[88:91], v[240:243], v[248:251], v[88:91]
  v_mfma_f32_16x16x32_bf16 v[92:95], v[240:243], v[252:255], v[92:95]
  s_waitcnt lgkmcnt(5)
  v_mfma_f32_16x16x32_bf16 v[24:27], v[184:187], v[208:211], v[24:27]
  s_cbranch_vccnz SL8
  s_cmp_eq_u32 s25, 0
  s_cbranch_scc1 QB6
  buffer_load_dwordx4 v[136:139], v5, s[12:15], 0 offen offset:0
QB6:
SL8:
  v_mfma_f32_16x16x32_bf16 v[28:31], v[184:187], v[212:215], v[28:31]
  v_mfma_f32_16x16x32_bf16 v[32:35], v[184:187], v[216:219], v[32:35]
  s_waitcnt lgkmcnt(4)
  v_mfma_f32_16x16x32_bf16 v[36:39], v[188:191], v[208:211], v[36:39]
  ds_read_b128 v[244:247], v100 offset:0
  s_cbranch_vccnz SL9
  s_cmp_eq_u32 s25, 0
  s_cbranch_scc1 QB7
  buffer_load_dwordx4 v[140:143], v5, s[12:15], 0 offen offset:64
QB7:
SL9:
  v_mfma_f32_16x16x32_bf16 v[40:43], v[188:191], v[212:215], v[40:43]
  ds_read_b128 v[248:251], v100 offset:2048
  v_mfma_f32_16x16x32_bf16 v[44:47], v[188:191], v[216:219], v[44:47]
  s_waitcnt lgkmcnt(5)
  v_mfma_f32_16x16x32_bf16 v[48:51], v[192:195], v[208:211], v[48:51]
  ds_read_b128 v[252:255], v100 offset:4096
  s_cbranch_vccnz SL10
  s_cmp_eq_u32 s25, 0
  s_cbranch_scc1 QB8
  buffer_load_dwordx4 v[144:147], v5, s[12:15], 0 offen offset:128
QB8:
SL10:
  v_mfma_f32_16x16x32_bf16 v[52:55], v[192:195], v[212:215], v[52:55]
  ds_read_b128 v[220:223], v98 offset:0
  v_mfma_f32_16x16x32_bf16 v[56:59], v[192:195], v[216:219], v[56:59]
  s_waitcnt lgkmcnt(6)
  v_mfma_f32_16x16x32_bf16 v[60:63], v[196:199], v[208:211], v[60:63]
  ds_read_b128 v[224:227], v98 offset:2048
  s_cbranch_vccnz SL11
  s_cmp_eq_u32 s25, 0
  s_cbranch_scc1 QB9
  buffer_load_dwordx4 v[148:151], v5, s[12:15], 0 offen offset:192
QB9:
SL11:
  v_mfma_f32_16x16x32_bf16 v[64:67], v[196:199], v[212:215], v[64:67]
  ds_read_b128 v[228:231], v98 offset:4096
  v_mfma_f32_16x16x32_bf16 v[68:71], v[196:199], v[216:219], v[68:71]
  s_waitcnt lgkmcnt(7)
  v_mfma_f32_16x16x32_bf16 v[72:75], v[200:203], v[208:211], v[72:75]
  ds_read_b128 v[232:235], v98 offset:6144
  s_cbranch_vccnz SL12
  s_cmp_eq_u32 s25, 0
  s_cbranch_scc1 QB10
  buffer_load_dwordx4 v[152:155], v5, s[12:15], 0 offen offset:256
QB10:
SL12:
  v_mfma_f32_16x16x32_bf16 v[76:79], v[200:203], v[212:215], v[76:79]
  ds_read_b128 v[236:239], v98 offset:8192
  v_mfma_f32_16x16x32_bf16 v[80:83], v[200:203], v[216:219], v[80:83]
  s_waitcnt lgkmcnt(8)
  v_mfma_f32_16x16x32_bf16 v[84:87], v[204:207], v[208:211], v[84:87]
  ds_read_b128 v[240:243], v98 offset:10240
  s_cbranch_vccnz SL13
  s_cmp_eq_u32 s25, 0
  s_cbranch_scc1 QB11
  buffer_load_dwordx4 v[156:159], v5, s[12:15], 0 offen offset:320
QB11:
SL13:
  v_mfma_f32_16x16x32_bf16 v[88:91], v[204:207], v[212:215], v[88:91]
  v_mfma_f32_16x16x32_bf16 v[92:95], v[204:207], v[216:219], v[92:95]
  s_cbranch_vccz SL14
  s_waitcnt vmcnt(0) lgkmcnt(0)
  s_branch SM14
SL14:
  s_cmp_lg_u32 s25, 0
  s_cbranch_scc1 MK_c2
  s_waitcnt vmcnt(6)
MK_c2:
  s_waitcnt vmcnt(12) lgkmcnt(0)
SM14:
  s_barrier
  v_add_u32 v97, 49152, v97
  v_add_u32 v98, 49152, v98
  v_add_u32 v99, 49152, v99
  v_add_u32 v100, 49152, v100
  v_mfma_f32_16x16x32_bf16 v[24:27], v[220:223], v[244:247], v[24:27]
  ds_read_b128 v[208:211], v99 offset:0
  s_cbranch_vccz SL15
  buffer_load_dwordx4 v[160:163], v6, s[12:15], 0 offen offset:0
SL15:
  v_mfma_f32_16x16x32_bf16 v[28:31], v[220:223], v[248:251], v[28:31]
  ds_read_b128 v[212:215], v99 offset:2048
  v_mfma_f32_16x16x32_bf16 v[32:35], v[220:223], v[252:255], v[32:35]
  v_mfma_f32_16x16x32_bf16 v[36:39], v[224:227], v[244:247], v[36:39]
  ds_read_b128 v[216:219], v99 offset:4096
  v_mfma_f32_16x16x32_bf16 v[40:43], v[224:227], v[248:251], v[40:43]
  ds_read_b128 v[184:187], v97 offset:0
  s_cbranch_vccz SL16
  buffer_load_dwordx4 v[164:167], v6, s[12:15], 0 offen offset:64
SL16:
  v_mfma_f32_16x16x32_bf16 v[44:47], v[224:227], v[252:255], v[44:47]
  v_mfma_f32_16x16x32_bf16 v[48:51], v[228:231], v[244:247], v[48:51]
  ds_read_b128 v[188:191], v97 offset:2048
  v_mfma_f32_16x16x32_bf16 v[52:55], v[228:231], v[248:251], v[52:55]
  ds_read_b128 v[192:195], v97 offset:4096
  v_mfma_f32_16x16x32_bf16 v[56:59], v[228:231], v[252:255], v[56:59]
  v_mfma_f32_16x16x32_bf16 v[60:63], v[232:235], v[244:247], v[60:63]
  ds_read_b128 v[196:199], v97 offset:6144
  s_cbranch_vccz SL17
  buffer_load_dwordx4 v[168:171], v6, s[12:15], 0 offen offset:128
SL17:
  v_mfma_f32_16x16x32_bf16 v[64:67], v[232:235], v[248:251], v[64:67]
  ds_read_b128 v[200:203], v97 offset:8192
  v_mfma_f32_16x16x32_bf16 v[68:71], v[232:235], v[252:255], v[68:71]
  v_mfma_f32_16x16x32_bf16 v[72:75], v[236:239], v[244:247], v[72:75]
  ds_read_b128 v[204:207], v97 offset:10240
  v_mfma_f32_16x16x32_bf16 v[76:79], v[236:239], v[248:251], v[76:79]
  s_cbranch_vccz SL18
  buffer_load_dwordx4 v[172:175], v6, s[12:15], 0 offen offset:192
SL18:
  v_mfma_f32_16x16x32_bf16 v[80:83], v[236:239], v[252:255], v[80:83]
  v_mfma_f32_16x16x32_bf16 v[84:87], v[240:243], v[244:247], v[84:87]
  v_mfma_f32_16x16x32_bf16 v[88:91], v[240:243], v[248:251], v[88:91]
  v_mfma_f32_16x16x32_bf16 v[92:95], v[240:243], v[252:255], v[92:95]
  s_cmp_eq_u32 s3, 0
  s_cbranch_scc1 MK_np2
  s_waitcnt lgkmcnt(0)
  ds_read_b64_tr_b16 v[104:105], v134 offset:0
  ds_read_b64_tr_b16 v[106:107], v134 offset:256
  ds_read_b64_tr_b16 v[108:109], v134 offset:2048
  ds_read_b64_tr_b16 v[110:111], v134 offset:2304
  ds_read_b64_tr_b16 v[112:113], v134 offset:4096
  ds_read_b64_tr_b16 v[114:115], v134 offset:4352
  ds_read_b64_tr_b16 v[116:117], v134 offset:6144
  ds_read_b64_tr_b16 v[118:119], v134 offset:6400
  ds_read_b64_tr_b16 v[120:121], v134 offset:8192
  ds_read_b64_tr_b16 v[122:123], v134 offset:8448
  ds_read_b64_tr_b16 v[124:125], v134 offset:10240
  ds_read_b64_tr_b16 v[126:127], v134 offset:10496
  s_setprio 3
  s_waitcnt lgkmcnt(0)
  v_mfma_f32_16x16x32_bf16 v[128:131], v[136:139], v[104:107], 0
  v_mfma_f32_16x16x32_bf16 v[128:131], v[140:143], v[108:111], v[128:131]
  v_mfma_f32_16x16x32_bf16 v[128:131], v[144:147], v[112:115], v[128:131]
  v_mfma_f32_16x16x32_bf16 v[128:131], v[148:151], v[116:119], v[128:131]
  v_mfma_f32_16x16x32_bf16 v[128:131], v[152:155], v[120:123], v[128:131]
  v_mfma_f32_16x16x32_bf16 v[128:131], v[156:159], v[124:127], v[128:131]
  s_lshl_b32 s100, s2, 10
  s_lshl_b32 s54, s26, 3
  s_add_u32 s100, s100, s54
  s_nop 5
  v_cvt_pk_bf16_f32 v132, v128, v129
  v_cvt_pk_bf16_f32 v133, v130, v131
  buffer_store_dwordx2 v[132:133], v1, s[20:23], s100 offen sc1
  s_setprio 0
MK_np2:
  ds_read_b128 v[244:247], v100 offset:0
  ds_read_b128 v[248:251], v100 offset:2048
  ds_read_b128 v[252:255], v100 offset:4096
  ds_read_b128 v[220:223], v98 offset:0
  ds_read_b128 v[224:227], v98 offset:2048
  s_waitcnt lgkmcnt(5)
  v_mfma_f32_16x16x32_bf16 v[24:27], v[184:187], v[208:211], v[24:27]
  ds_read_b128 v[228:231], v98 offset:4096
  s_cbranch_vccz SL19
  buffer_load_dwordx4 v[176:179], v6, s[12:15], 0 offen offset:256
SL19:
  v_mfma_f32_16x16x32_bf16 v[36:39], v[188:191], v[208:211], v[36:39]
  ds_read_b128 v[232:235], v98 offset:6144
  s_waitcnt lgkmcnt(2)
  v_mfma_f32_16x16x32_bf16 v[24:27], v[220:223], v[244:247], v[24:27]
  ds_read_b128 v[236:239], v98 offset:8192
  v_mfma_f32_16x16x32_bf16 v[36:39], v[224:227], v[244:247], v[36:39]
  ds_read_b128 v[240:243], v98 offset:10240
  v_mfma_f32_16x16x32_bf16 v[28:31], v[184:187], v[212:215], v[28:31]
  s_cbranch_vccz SL20
  buffer_load_dwordx4 v[180:183], v6, s[12:15], 0 offen offset:320
SL20:
  v_mfma_f32_16x16x32_bf16 v[40:43], v[188:191], v[212:215], v[40:43]
  v_mfma_f32_16x16x32_bf16 v[28:31], v[220:223], v[248:251], v[28:31]
  v_mfma_f32_16x16x32_bf16 v[40:43], v[224:227], v[248:251], v[40:43]
  v_mfma_f32_16x16x32_bf16 v[32:35], v[184:187], v[216:219], v[32:35]
  v_cvt_pk_bf16_f32 v104, v24, v25
  v_cvt_pk_bf16_f32 v105, v26, v27
  v_mfma_f32_16x16x32_bf16 v[44:47], v[188:191], v[216:219], v[44:47]
  v_cvt_pk_bf16_f32 v106, v36, v37
  v_cvt_pk_bf16_f32 v107, v38, v39
  s_cbranch_vccz SL21
  buffer_load_dwordx4 v[136:139], v5, s[12:15], 0 offen offset:0
SL21:
  v_mfma_f32_16x16x32_bf16 v[32:35], v[220:223], v[252:255], v[32:35]
  ds_write_b128 v101, v[104:107] offset:4096
  v_mfma_f32_16x16x32_bf16 v[44:47], v[224:227], v[252:255], v[44:47]
  v_mfma_f32_16x16x32_bf16 v[48:51], v[192:195], v[208:211], v[48:51]
  v_cvt_pk_bf16_f32 v108, v28, v29
  v_cvt_pk_bf16_f32 v109, v30, v31
  v_mfma_f32_16x16x32_bf16 v[60:63], v[196:199], v[208:211], v[60:63]
  v_cvt_pk_bf16_f32 v110, v40, v41
  v_cvt_pk_bf16_f32 v111, v42, v43
  s_cbranch_vccz SL22
  buffer_load_dwordx4 v[140:143], v5, s[12:15], 0 offen offset:64
SL22:
  s_waitcnt lgkmcnt(1)
  v_mfma_f32_16x16x32_bf16 v[48:51], v[228:231], v[244:247], v[48:51]
  ds_write_b128 v102, v[108:111] offset:4096
  v_mfma_f32_16x16x32_bf16 v[60:63], v[232:235], v[244:247], v[60:63]
  v_mfma_f32_16x16x32_bf16 v[52:55], v[192:195], v[212:215], v[52:55]
  v_cvt_pk_bf16_f32 v112, v32, v33
  v_cvt_pk_bf16_f32 v113, v34, v35
  v_mfma_f32_16x16x32_bf16 v[64:67], v[196:199], v[212:215], v[64:67]
  v_cvt_pk_bf16_f32 v114, v44, v45
  v_cvt_pk_bf16_f32 v115, v46, v47
  v_mfma_f32_16x16x32_bf16 v[52:55], v[228:231], v[248:251], v[52:55]
  ds_write_b128 v103, v[112:115] offset:4096
  s_cbranch_vccz SL23
  buffer_load_dwordx4 v[144:147], v5, s[12:15], 0 offen offset:128
SL23:
  v_mfma_f32_16x16x32_bf16 v[64:67], v[232:235], v[248:251], v[64:67]
  v_mfma_f32_16x16x32_bf16 v[56:59], v[192:195], v[216:219], v[56:59]
  v_cvt_pk_bf16_f32 v116, v48, v49
  v_cvt_pk_bf16_f32 v117, v50, v51
  v_mfma_f32_16x16x32_bf16 v[68:71], v[196:199], v[216:219], v[68:71]
  v_cvt_pk_bf16_f32 v118, v60, v61
  v_cvt_pk_bf16_f32 v119, v62, v63
  v_mfma_f32_16x16x32_bf16 v[56:59], v[228:231], v[252:255], v[56:59]
  ds_write_b128 v101, v[116:119] offset:2048
  s_cbranch_vccz SL24
  buffer_load_dwordx4 v[148:151], v5, s[12:15], 0 offen offset:192
SL24:
  v_mfma_f32_16x16x32_bf16 v[68:71], v[232:235], v[252:255], v[68:71]
  v_mfma_f32_16x16x32_bf16 v[72:75], v[200:203], v[208:211], v[72:75]
  v_cvt_pk_bf16_f32 v120, v52, v53
  v_cvt_pk_bf16_f32 v121, v54, v55
  v_mfma_f32_16x16x32_bf16 v[84:87], v[204:207], v[208:211], v[84:87]
  v_cvt_pk_bf16_f32 v122, v64, v65
  v_cvt_pk_bf16_f32 v123, v66, v67
  v_mfma_f32_16x16x32_bf16 v[72:75], v[236:239], v[244:247], v[72:75]
  ds_write_b128 v102, v[120:123] offset:2048
  v_mfma_f32_16x16x32_bf16 v[84:87], v[240:243], v[244:247], v[84:87]
  s_cbranch_vccz SL25
  buffer_load_dwordx4 v[152:155], v5, s[12:15], 0 offen offset:256
SL25:
  v_mfma_f32_16x16x32_bf16 v[76:79], v[200:203], v[212:215], v[76:79]
  v_cvt_pk_bf16_f32 v124, v56, v57
  v_cvt_pk_bf16_f32 v125, v58, v59
  v_mfma_f32_16x16x32_bf16 v[88:91], v[204:207], v[212:215], v[88:91]
  v_cvt_pk_bf16_f32 v126, v68, v69
  v_cvt_pk_bf16_f32 v127, v70, v71
  v_mfma_f32_16x16x32_bf16 v[76:79], v[236:239], v[248:251], v[76:79]
  ds_write_b128 v103, v[124:127] offset:2048
  v_mfma_f32_16x16x32_bf16 v[88:91], v[240:243], v[248:251], v[88:91]
  s_cbranch_vccz SL26
  buffer_load_dwordx4 v[156:159], v5, s[12:15], 0 offen offset:320
SL26:
  v_mfma_f32_16x16x32_bf16 v[80:83], v[200:203], v[216:219], v[80:83]
  v_cvt_pk_bf16_f32 v104, v72, v73
  v_cvt_pk_bf16_f32 v105, v74, v75
  v_mfma_f32_16x16x32_bf16 v[92:95], v[204:207], v[216:219], v[92:95]
  v_cvt_pk_bf16_f32 v106, v84, v85
  v_cvt_pk_bf16_f32 v107, v86, v87
  v_mfma_f32_16x16x32_bf16 v[80:83], v[236:239], v[252:255], v[80:83]
  ds_write_b128 v101, v[104:107] offset:0
  v_mfma_f32_16x16x32_bf16 v[92:95], v[240:243], v[252:255], v[92:95]
  v_cvt_pk_bf16_f32 v108, v76, v77
  v_cvt_pk_bf16_f32 v109, v78, v79
  v_cvt_pk_bf16_f32 v110, v88, v89
  v_cvt_pk_bf16_f32 v111, v90, v91
  ds_write_b128 v102, v[108:111] offset:0
  s_nop 3
  v_cvt_pk_bf16_f32 v112, v80, v81
  v_cvt_pk_bf16_f32 v113, v82, v83
  v_cvt_pk_bf16_f32 v114, v92, v93
  v_cvt_pk_bf16_f32 v115, v94, v95
  ds_write_b128 v103, v[112:115] offset:0
  s_waitcnt lgkmcnt(0)
  s_barrier
  ds_read_b128 v[216:219], v2 offset:35840
  ds_read_b128 v[220:223], v2 offset:34816
  ds_read_b128 v[224:227], v2 offset:33792
  ds_read_b128 v[228:231], v2 offset:32768
  ds_read_b128 v[232:235], v2 offset:31744
  ds_read_b128 v[236:239], v2 offset:30720
  ds_read_b128 v[240:243], v2 offset:29696
  ds_read_b128 v[244:247], v2 offset:28672
  ds_read_b128 v[248:251], v2 offset:27648
  ds_read_b128 v[252:255], v2 offset:26624
  s_cbranch_vccz SL27
  s_mul_i32 s100, s32, 9
  s_add_i32 s100, s100, s31
  s_add_u32 m0, s38, 138240
  s_nop 0
  buffer_load_dwordx4 v13, s[12:15], s100 offen lds
  s_add_u32 m0, s38, 139264
  s_nop 0
  buffer_load_dwordx4 v14, s[12:15], s100 offen lds
  s_add_u32 m0, s38, 140288
  s_nop 0
  buffer_load_dwordx4 v3, s[12:15], s100 offen lds
  s_add_u32 m0, s39, 138240
  s_nop 0
  buffer_load_dwordx4 v4, s[12:15], s100 offen lds
  s_mul_i32 s100, s32, 8
  s_add_i32 s100, s100, s31
  s_add_u32 m0, s38, 122880
  s_nop 0
  buffer_load_dwordx4 v13, s[12:15], s100 offen lds
  s_add_u32 m0, s38, 123904
  s_nop 0
  buffer_load_dwordx4 v14, s[12:15], s100 offen lds
  s_add_u32 m0, s38, 124928
  s_nop 0
  buffer_load_dwordx4 v3, s[12:15], s100 offen lds
  s_add_u32 m0, s39, 122880
  s_nop 0
  buffer_load_dwordx4 v4, s[12:15], s100 offen lds
  v_mov_b32 v104, 0xff800000
  v_add_u32 v105, 0, v19
  v_add_u32 v106, 1, v19
  v_add_u32 v107, 2, v19
  v_add_u32 v108, 3, v19
  v_cmp_gt_u32 s[48:49], 7, v105
  v_cmp_gt_u32 s[50:51], 7, v106
  v_cmp_gt_u32 s[52:53], 7, v107
  v_cmp_gt_u32 s[54:55], 7, v108
  v_cndmask_b32 v100, v104, 0, s[48:49]
  v_cndmask_b32 v101, v104, 0, s[50:51]
  v_cndmask_b32 v102, v104, 0, s[52:53]
  v_cndmask_b32 v103, v104, 0, s[54:55]
  v_sub_u32 v105, s35, v21
  s_add_i32 s46, s34, 0
  v_sub_u32 v106, s46, v21
  s_add_i32 s46, s34, 1
  v_sub_u32 v107, s46, v21
  s_add_i32 s46, s34, 2
  v_sub_u32 v108, s46, v21
  v_cmp_gt_u32 s[48:49], 7, v105
  v_cmp_gt_u32 s[50:51], 7, v106
  v_cmp_gt_u32 s[52:53], 7, v107
  v_cmp_gt_u32 s[54:55], 7, v108
  v_cndmask_b32 v24, v104, v100, s[48:49]
  v_cndmask_b32 v25, v104, v101, s[48:49]
  v_cndmask_b32 v26, v104, v102, s[48:49]
  v_cndmask_b32 v27, v104, v103, s[48:49]
  v_cndmask_b32 v28, v104, v100, s[50:51]
  v_cndmask_b32 v29, v104, v101, s[50:51]
  v_cndmask_b32 v30, v104, v102, s[50:51]
  v_cndmask_b32 v31, v104, v103, s[50:51]
  v_cndmask_b32 v32, v104, v100, s[52:53]
  v_cndmask_b32 v33, v104, v101, s[52:53]
  v_cndmask_b32 v34, v104, v102, s[52:53]
  v_cndmask_b32 v35, v104, v103, s[52:53]
  v_cndmask_b32 v36, v104, v100, s[54:55]
  v_cndmask_b32 v37, v104, v101, s[54:55]
  v_cndmask_b32 v38, v104, v102, s[54:55]
  v_cndmask_b32 v39, v104, v103, s[54:55]
  s_add_i32 s46, s34, 3
  v_sub_u32 v105, s46, v21
  s_add_i32 s46, s34, 4
  v_sub_u32 v106, s46, v21
  s_add_i32 s46, s34, 5
  v_sub_u32 v107, s46, v21
  s_add_i32 s46, s34, 6
  v_sub_u32 v108, s46, v21
  v_cmp_gt_u32 s[48:49], 7, v105
  v_cmp_gt_u32 s[50:51], 7, v106
  v_cmp_gt_u32 s[52:53], 7, v107
  v_cmp_gt_u32 s[54:55], 7, v108
  v_cndmask_b32 v40, v104, v100, s[48:49]
  v_cndmask_b32 v41, v104, v101, s[48:49]
  v_cndmask_b32 v42, v104, v102, s[48:49]
  v_cndmask_b32 v43, v104, v103, s[48:49]
  v_cndmask_b32 v44, v104, v100, s[50:51]
  v_cndmask_b32 v45, v104, v101, s[50:51]
  v_cndmask_b32 v46, v104, v102, s[50:51]
  v_cndmask_b32 v47, v104, v103, s[50:51]
  v_cndmask_b32 v48, v104, v100, s[52:53]
  v_cndmask_b32 v49, v104, v101, s[52:53]
  v_cndmask_b32 v50, v104, v102, s[52:53]
  v_cndmask_b32 v51, v104, v103, s[52:53]
  v_cndmask_b32 v52, v104, v100, s[54:55]
  v_cndmask_b32 v53, v104, v101, s[54:55]
  v_cndmask_b32 v54, v104, v102, s[54:55]
  v_cndmask_b32 v55, v104, v103, s[54:55]
  s_add_i32 s46, s34, 1
  v_sub_u32 v105, s46, v22
  s_add_i32 s46, s34, 2
  v_sub_u32 v106, s46, v22
  s_add_i32 s46, s34, 3
  v_sub_u32 v107, s46, v22
  s_add_i32 s46, s34, 4
  v_sub_u32 v108, s46, v22
  v_cmp_gt_u32 s[48:49], 7, v105
  v_cmp_gt_u32 s[50:51], 7, v106
  v_cmp_gt_u32 s[52:53], 7, v107
  v_cmp_gt_u32 s[54:55], 7, v108
  v_cndmask_b32 v56, v104, v100, s[48:49]
  v_cndmask_b32 v57, v104, v101, s[48:49]
  v_cndmask_b32 v58, v104, v102, s[48:49]
  v_cndmask_b32 v59, v104, v103, s[48:49]
  v_cndmask_b32 v60, v104, v100, s[50:51]
  v_cndmask_b32 v61, v104, v101, s[50:51]
  v_cndmask_b32 v62, v104, v102, s[50:51]
  v_cndmask_b32 v63, v104, v103, s[50:51]
  v_cndmask_b32 v64, v104, v100, s[52:53]
  v_cndmask_b32 v65, v104, v101, s[52:53]
  v_cndmask_b32 v66, v104, v102, s[52:53]
  v_cndmask_b32 v67, v104, v103, s[52:53]
  v_cndmask_b32 v68, v104, v100, s[54:55]
  v_cndmask_b32 v69, v104, v101, s[54:55]
  v_cndmask_b32 v70, v104, v102, s[54:55]
  v_cndmask_b32 v71, v104, v103, s[54:55]
  s_add_i32 s46, s34, 5
  v_sub_u32 v105, s46, v22
  s_add_i32 s46, s34, 6
  v_sub_u32 v106, s46, v22
  s_add_i32 s46, s34, 7
  v_sub_u32 v107, s46, v22
  s_add_i32 s46, s34, 8
  v_sub_u32 v108, s46, v22
  v_cmp_gt_u32 s[48:49], 7, v105
  v_cmp_gt_u32 s[50:51], 7, v106
  v_cmp_gt_u32 s[52:53], 7, v107
  v_cmp_gt_u32 s[54:55], 7, v108
  v_cndmask_b32 v72, v104, v100, s[48:49]
  v_cndmask_b32 v73, v104, v101, s[48:49]
  v_cndmask_b32 v74, v104, v102, s[48:49]
  v_cndmask_b32 v75, v104, v103, s[48:49]
  v_cndmask_b32 v76, v104, v100, s[50:51]
  v_cndmask_b32 v77, v104, v101, s[50:51]
  v_cndmask_b32 v78, v104, v102, s[50:51]
  v_cndmask_b32 v79, v104, v103, s[50:51]
  v_cndmask_b32 v80, v104, v100, s[52:53]
  v_cndmask_b32 v81, v104, v101, s[52:53]
  v_cndmask_b32 v82, v104, v102, s[52:53]
  v_cndmask_b32 v83, v104, v103, s[52:53]
  v_cndmask_b32 v84, v104, v100, s[54:55]
  v_cndmask_b32 v85, v104, v101, s[54:55]
  v_cndmask_b32 v86, v104, v102, s[54:55]
  v_cndmask_b32 v87, v104, v103, s[54:55]
  s_waitcnt vmcnt(8)
  s_branch SM27
SL27:
  s_cmp_lg_u32 s25, 0
  s_cbranch_scc1 MK_z1
  v_mov_b32 v136, 0
  v_mov_b32 v137, 0
  v_mov_b32 v138, 0
  v_mov_b32 v139, 0
  v_mov_b32 v140, 0
  v_mov_b32 v141, 0
  v_mov_b32 v142, 0
  v_mov_b32 v143, 0
  v_mov_b32 v144, 0
  v_mov_b32 v145, 0
  v_mov_b32 v146, 0
  v_mov_b32 v147, 0
  v_mov_b32 v148, 0
  v_mov_b32 v149, 0
  v_mov_b32 v150, 0
  v_mov_b32 v151, 0
  v_mov_b32 v152, 0
  v_mov_b32 v153, 0
  v_mov_b32 v154, 0
  v_mov_b32 v155, 0
  v_mov_b32 v156, 0
  v_mov_b32 v157, 0
  v_mov_b32 v158, 0
  v_mov_b32 v159, 0
MK_z1:
  s_cmp_lg_u32 s3, 0
  s_cbranch_scc1 MK_np4
  s_waitcnt vmcnt(0)
MK_np4:
  s_waitcnt vmcnt(1)
  s_setprio 1
SM27:
  s_waitcnt lgkmcnt(8)
  v_mfma_f32_16x16x32_bf16 v[184:187], v[216:219], v[136:139], 0
  v_mfma_f32_16x16x32_bf16 v[192:195], v[216:219], v[160:163], 0
  ds_read_b128 v[216:219], v2 offset:25600
  v_mfma_f32_16x16x32_bf16 v[188:191], v[220:223], v[136:139], 0
  v_mfma_f32_16x16x32_bf16 v[196:199], v[220:223], v[160:163], 0
  ds_read_b128 v[220:223], v2 offset:24576
  s_waitcnt lgkmcnt(8)
  v_mfma_f32_16x16x32_bf16 v[184:187], v[224:227], v[140:143], v[184:187]
  v_mfma_f32_16x16x32_bf16 v[192:195], v[224:227], v[164:167], v[192:195]
  ds_read_b128 v[224:227], v2 offset:23552
  v_mfma_f32_16x16x32_bf16 v[188:191], v[228:231], v[140:143], v[188:191]
  v_mfma_f32_16x16x32_bf16 v[196:199], v[228:231], v[164:167], v[196:199]
  ds_read_b128 v[228:231], v2 offset:22528
  s_waitcnt lgkmcnt(8)
  v_mfma_f32_16x16x32_bf16 v[184:187], v[232:235], v[144:147], v[184:187]
  v_mfma_f32_16x16x32_bf16 v[192:195], v[232:235], v[168:171], v[192:195]
  ds_read_b128 v[232:235], v2 offset:21504
  v_mfma_f32_16x16x32_bf16 v[188:191], v[236:239], v[144:147], v[188:191]
  v_mfma_f32_16x16x32_bf16 v[196:199], v[236:239], v[168:171], v[196:199]
  ds_read_b128 v[236:239], v2 offset:20480
  s_waitcnt lgkmcnt(8)
  v_mfma_f32_16x16x32_bf16 v[184:187], v[240:243], v[148:151], v[184:187]
  v_mfma_f32_16x16x32_bf16 v[192:195], v[240:243], v[172:175], v[192:195]
  ds_read_b128 v[240:243], v2 offset:19456
  v_mfma_f32_16x16x32_bf16 v[188:191], v[244:247], v[148:151], v[188:191]
  v_mfma_f32_16x16x32_bf16 v[196:199], v[244:247], v[172:175], v[196:199]
  ds_read_b128 v[244:247], v2 offset:18432
  s_waitcnt lgkmcnt(8)
  v_mfma_f32_16x16x32_bf16 v[184:187], v[248:251], v[152:155], v[184:187]
  v_mfma_f32_16x16x32_bf16 v[192:195], v[248:251], v[176:179], v[192:195]
  ds_read_b128 v[248:251], v2 offset:17408
  v_mfma_f32_16x16x32_bf16 v[188:191], v[252:255], v[152:155], v[188:191]
  v_mfma_f32_16x16x32_bf16 v[196:199], v[252:255], v[176:179], v[196:199]
  ds_read_b128 v[252:255], v2 offset:16384
  s_waitcnt lgkmcnt(8)
  v_mfma_f32_16x16x32_bf16 v[184:187], v[216:219], v[156:159], v[184:187]
  v_mfma_f32_16x16x32_bf16 v[192:195], v[216:219], v[180:183], v[192:195]
  ds_read_b128 v[216:219], v2 offset:15360
  v_mfma_f32_16x16x32_bf16 v[188:191], v[220:223], v[156:159], v[188:191]
  v_mfma_f32_16x16x32_bf16 v[196:199], v[220:223], v[180:183], v[196:199]
  ds_read_b128 v[220:223], v2 offset:14336
  s_waitcnt lgkmcnt(8)
  v_mfma_f32_16x16x32_bf16 v[200:203], v[224:227], v[136:139], 0
  v_mfma_f32_16x16x32_bf16 v[208:211], v[224:227], v[160:163], 0
  ds_read_b128 v[224:227], v2 offset:13312
  v_mul_f32 v184, s93, v184
  v_mfma_f32_16x16x32_bf16 v[204:207], v[228:231], v[136:139], 0
  v_mul_f32 v185, s93, v185
  v_mul_f32 v186, s93, v186
  v_mfma_f32_16x16x32_bf16 v[212:215], v[228:231], v[160:163], 0
  ds_read_b128 v[228:231], v2 offset:12288
  s_waitcnt lgkmcnt(8)
  v_mfma_f32_16x16x32_bf16 v[200:203], v[232:235], v[140:143], v[200:203]
  v_mul_f32 v187, s93, v187
  v_mul_f32 v188, s93, v188
  v_mfma_f32_16x16x32_bf16 v[208:211], v[232:235], v[164:167], v[208:211]
  ds_read_b128 v[232:235], v2 offset:11264
  v_mul_f32 v189, s93, v189
  v_mfma_f32_16x16x32_bf16 v[204:207], v[236:239], v[140:143], v[204:207]
  v_mul_f32 v190, s93, v190
  v_mul_f32 v191, s93, v191
  v_mfma_f32_16x16x32_bf16 v[212:215], v[236:239], v[164:167], v[212:215]
  ds_read_b128 v[236:239], v2 offset:10240
  s_waitcnt lgkmcnt(8)
  v_mfma_f32_16x16x32_bf16 v[200:203], v[240:243], v[144:147], v[200:203]
  v_cvt_pk_bf16_f32 v88, v184, v185
  v_cvt_pk_bf16_f32 v89, v186, v187
  v_mfma_f32_16x16x32_bf16 v[208:211], v[240:243], v[168:171], v[208:211]
  ds_read_b128 v[240:243], v2 offset:9216
  v_cvt_pk_bf16_f32 v90, v188, v189
  v_mfma_f32_16x16x32_bf16 v[204:207], v[244:247], v[144:147], v[204:207]
  v_cvt_pk_bf16_f32 v91, v190, v191
  v_mul_f32 v192, s93, v192
  v_mfma_f32_16x16x32_bf16 v[212:215], v[244:247], v[168:171], v[212:215]
  ds_read_b128 v[244:247], v2 offset:8192
  s_waitcnt lgkmcnt(8)
  v_mfma_f32_16x16x32_bf16 v[200:203], v[248:251], v[148:151], v[200:203]
  v_mul_f32 v193, s93, v193
  v_mul_f32 v194, s93, v194
  v_mfma_f32_16x16x32_bf16 v[208:211], v[248:251], v[172:175], v[208:211]
  ds_read_b128 v[248:251], v2 offset:7168
  v_mul_f32 v195, s93, v195
  v_mfma_f32_16x16x32_bf16 v[204:207], v[252:255], v[148:151], v[204:207]
  v_mul_f32 v196, s93, v196
  v_mul_f32 v197, s93, v197
  v_mfma_f32_16x16x32_bf16 v[212:215], v[252:255], v[172:175], v[212:215]
  ds_read_b128 v[252:255], v2 offset:6144
  s_waitcnt lgkmcnt(8)
  v_mfma_f32_16x16x32_bf16 v[200:203], v[216:219], v[152:155], v[200:203]
  v_mul_f32 v198, s93, v198
  v_mul_f32 v199, s93, v199
  v_mfma_f32_16x16x32_bf16 v[208:211], v[216:219], v[176:179], v[208:211]
  ds_read_b128 v[216:219], v2 offset:5120
  v_cvt_pk_bf16_f32 v112, v192, v193
  v_mfma_f32_16x16x32_bf16 v[204:207], v[220:223], v[152:155], v[204:207]
  v_cvt_pk_bf16_f32 v113, v194, v195
  v_cvt_pk_bf16_f32 v114, v196, v197
  v_mfma_f32_16x16x32_bf16 v[212:215], v[220:223], v[176:179], v[212:215]
  ds_read_b128 v[220:223], v2 offset:4096
  s_waitcnt lgkmcnt(8)
  v_mfma_f32_16x16x32_bf16 v[200:203], v[224:227], v[156:159], v[200:203]
  v_cvt_pk_bf16_f32 v115, v198, v199
  v_mfma_f32_16x16x32_bf16 v[208:211], v[224:227], v[180:183], v[208:211]
  ds_read_b128 v[224:227], v2 offset:3072
  v_mfma_f32_16x16x32_bf16 v[204:207], v[228:231], v[156:159], v[204:207]
  v_mfma_f32_16x16x32_bf16 v[212:215], v[228:231], v[180:183], v[212:215]
  ds_read_b128 v[228:231], v2 offset:2048
  s_waitcnt lgkmcnt(8)
  v_mfma_f32_16x16x32_bf16 v[184:187], v[232:235], v[136:139], 0
  v_mul_f32 v200, s93, v200
  v_mul_f32 v201, s93, v201
  v_mfma_f32_16x16x32_bf16 v[192:195], v[232:235], v[160:163], 0
  ds_read_b128 v[232:235], v2 offset:1024
  v_mul_f32 v202, s93, v202
  v_mfma_f32_16x16x32_bf16 v[188:191], v[236:239], v[136:139], 0
  v_mul_f32 v203, s93, v203
  v_mul_f32 v204, s93, v204
  v_mfma_f32_16x16x32_bf16 v[196:199], v[236:239], v[160:163], 0
  ds_read_b128 v[236:239], v2 offset:0
  s_waitcnt lgkmcnt(8)
  v_mfma_f32_16x16x32_bf16 v[184:187], v[240:243], v[140:143], v[184:187]
  v_mul_f32 v205, s93, v205
  v_mul_f32 v206, s93, v206
  v_mfma_f32_16x16x32_bf16 v[192:195], v[240:243], v[164:167], v[192:195]
  ds_read_b128 v[240:243], v1 offset:35840
  v_mul_f32 v207, s93, v207
  v_mfma_f32_16x16x32_bf16 v[188:191], v[244:247], v[140:143], v[188:191]
  v_cvt_pk_bf16_f32 v92, v200, v201
  v_cvt_pk_bf16_f32 v93, v202, v203
  v_mfma_f32_16x16x32_bf16 v[196:199], v[244:247], v[164:167], v[196:199]
  ds_read_b128 v[244:247], v1 offset:34816
  s_waitcnt lgkmcnt(8)
  v_mfma_f32_16x16x32_bf16 v[184:187], v[248:251], v[144:147], v[184:187]
  v_cvt_pk_bf16_f32 v94, v204, v205
  v_cvt_pk_bf16_f32 v95, v206, v207
  v_mfma_f32_16x16x32_bf16 v[192:195], v[248:251], v[168:171], v[192:195]
  ds_read_b128 v[248:251], v1 offset:33792
  v_mul_f32 v208, s93, v208
  v_mfma_f32_16x16x32_bf16 v[188:191], v[252:255], v[144:147], v[188:191]
  v_mul_f32 v209, s93, v209
  v_mul_f32 v210, s93, v210
  v_mfma_f32_16x16x32_bf16 v[196:199], v[252:255], v[168:171], v[196:199]
  ds_read_b128 v[252:255], v1 offset:32768
  s_waitcnt lgkmcnt(8)
  v_mfma_f32_16x16x32_bf16 v[184:187], v[216:219], v[148:151], v[184:187]
  v_mul_f32 v211, s93, v211
  v_mul_f32 v212, s93, v212
  v_mfma_f32_16x16x32_bf16 v[192:195], v[216:219], v[172:175], v[192:195]
  ds_read_b128 v[216:219], v1 offset:31744
  v_mul_f32 v213, s93, v213
  s_cbranch_vccz SL28
  s_barrier
  s_branch SM28
SL28:
  s_cmp_eq_u32 s3, 0
  s_cbranch_scc1 MK_np5
  s_waitcnt vmcnt(0)
  v_mov_b32 v23, 1
  s_mov_b64 exec, 1
  buffer_atomic_add v23, off, s[8:11], 0 sc1
  s_mov_b64 exec, -1
  s_nop 3
MK_np5:
SM28:
  v_mfma_f32_16x16x32_bf16 v[188:191], v[220:223], v[148:151], v[188:191]
  v_mul_f32 v214, s93, v214
  v_mul_f32 v215, s93, v215
  v_mfma_f32_16x16x32_bf16 v[196:199], v[220:223], v[172:175], v[196:199]
  ds_read_b128 v[220:223], v1 offset:30720
  s_waitcnt lgkmcnt(8)
  v_mfma_f32_16x16x32_bf16 v[184:187], v[224:227], v[152:155], v[184:187]
  v_cvt_pk_bf16_f32 v116, v208, v209
  v_cvt_pk_bf16_f32 v117, v210, v211
  v_mfma_f32_16x16x32_bf16 v[192:195], v[224:227], v[176:179], v[192:195]
  ds_read_b128 v[224:227], v1 offset:29696
  v_cvt_pk_bf16_f32 v118, v212, v213
  v_mfma_f32_16x16x32_bf16 v[188:191], v[228:231], v[152:155], v[188:191]
  v_cvt_pk_bf16_f32 v119, v214, v215
  v_mfma_f32_16x16x32_bf16 v[196:199], v[228:231], v[176:179], v[196:199]
  ds_read_b128 v[228:231], v1 offset:28672
  s_waitcnt lgkmcnt(8)
  v_mfma_f32_16x16x32_bf16 v[184:187], v[232:235], v[156:159], v[184:187]
  v_mfma_f32_16x16x32_bf16 v[192:195], v[232:235], v[180:183], v[192:195]
  ds_read_b128 v[232:235], v1 offset:27648
  v_mfma_f32_16x16x32_bf16 v[188:191], v[236:239], v[156:159], v[188:191]
  v_mfma_f32_16x16x32_bf16 v[196:199], v[236:239], v[180:183], v[196:199]
  ds_read_b128 v[236:239], v1 offset:26624
  s_waitcnt lgkmcnt(8)
  v_mfma_f32_16x16x32_bf16 v[200:203], v[240:243], v[136:139], 0
  v_mfma_f32_16x16x32_bf16 v[208:211], v[240:243], v[160:163], 0
  ds_read_b128 v[240:243], v1 offset:25600
  v_mul_f32 v184, s93, v184
  v_mfma_f32_16x16x32_bf16 v[204:207], v[244:247], v[136:139], 0
  v_mul_f32 v185, s93, v185
  v_mul_f32 v186, s93, v186
  v_mfma_f32_16x16x32_bf16 v[212:215], v[244:247], v[160:163], 0
  ds_read_b128 v[244:247], v1 offset:24576
  s_waitcnt lgkmcnt(8)
  v_mfma_f32_16x16x32_bf16 v[200:203], v[248:251], v[140:143], v[200:203]
  v_mul_f32 v187, s93, v187
  v_mul_f32 v188, s93, v188
  v_mfma_f32_16x16x32_bf16 v[208:211], v[248:251], v[164:167], v[208:211]
  ds_read_b128 v[248:251], v1 offset:23552
  v_mul_f32 v189, s93, v189
  v_mfma_f32_16x16x32_bf16 v[204:207], v[252:255], v[140:143], v[204:207]
  v_mul_f32 v190, s93, v190
  v_mul_f32 v191, s93, v191
  v_mfma_f32_16x16x32_bf16 v[212:215], v[252:255], v[164:167], v[212:215]
  ds_read_b128 v[252:255], v1 offset:22528
  s_waitcnt lgkmcnt(8)
  v_mfma_f32_16x16x32_bf16 v[200:203], v[216:219], v[144:147], v[200:203]
  v_cvt_pk_bf16_f32 v96, v184, v185
  v_cvt_pk_bf16_f32 v97, v186, v187
  v_mfma_f32_16x16x32_bf16 v[208:211], v[216:219], v[168:171], v[208:211]
  ds_read_b128 v[216:219], v1 offset:21504
  v_cvt_pk_bf16_f32 v98, v188, v189
  v_mfma_f32_16x16x32_bf16 v[204:207], v[220:223], v[144:147], v[204:207]
  v_cvt_pk_bf16_f32 v99, v190, v191
  v_mul_f32 v192, s93, v192
  v_mfma_f32_16x16x32_bf16 v[212:215], v[220:223], v[168:171], v[212:215]
  ds_read_b128 v[220:223], v1 offset:20480
  s_waitcnt lgkmcnt(8)
  v_mfma_f32_16x16x32_bf16 v[200:203], v[224:227], v[148:151], v[200:203]
  v_mul_f32 v193, s93, v193
  v_mul_f32 v194, s93, v194
  v_mfma_f32_16x16x32_bf16 v[208:211], v[224:227], v[172:175], v[208:211]
  ds_read_b128 v[224:227], v1 offset:19456
  v_mul_f32 v195, s93, v195
  v_mfma_f32_16x16x32_bf16 v[204:207], v[228:231], v[148:151], v[204:207]
  v_mul_f32 v196, s93, v196
  v_mul_f32 v197, s93, v197
  v_mfma_f32_16x16x32_bf16 v[212:215], v[228:231], v[172:175], v[212:215]
  ds_read_b128 v[228:231], v1 offset:18432
  s_waitcnt lgkmcnt(8)
  v_mfma_f32_16x16x32_bf16 v[200:203], v[232:235], v[152:155], v[200:203]
  v_mul_f32 v198, s93, v198
  v_mul_f32 v199, s93, v199
  v_mfma_f32_16x16x32_bf16 v[208:211], v[232:235], v[176:179], v[208:211]
  ds_read_b128 v[232:235], v1 offset:17408
  v_cvt_pk_bf16_f32 v120, v192, v193
  v_mfma_f32_16x16x32_bf16 v[204:207], v[236:239], v[152:155], v[204:207]
  v_cvt_pk_bf16_f32 v121, v194, v195
  v_cvt_pk_bf16_f32 v122, v196, v197
  v_mfma_f32_16x16x32_bf16 v[212:215], v[236:239], v[176:179], v[212:215]
  ds_read_b128 v[236:239], v1 offset:16384
  s_waitcnt lgkmcnt(8)
  v_mfma_f32_16x16x32_bf16 v[200:203], v[240:243], v[156:159], v[200:203]
  v_cvt_pk_bf16_f32 v123, v198, v199
  v_mfma_f32_16x16x32_bf16 v[208:211], v[240:243], v[180:183], v[208:211]
  ds_read_b128 v[240:243], v1 offset:15360
  v_mfma_f32_16x16x32_bf16 v[204:207], v[244:247], v[156:159], v[204:207]
  v_mfma_f32_16x16x32_bf16 v[212:215], v[244:247], v[180:183], v[212:215]
  ds_read_b128 v[244:247], v1 offset:14336
  s_waitcnt lgkmcnt(8)
  v_mfma_f32_16x16x32_bf16 v[184:187], v[248:251], v[136:139], 0
  v_mul_f32 v200, s93, v200
  v_mul_f32 v201, s93, v201
  v_mfma_f32_16x16x32_bf16 v[192:195], v[248:251], v[160:163], 0
  ds_read_b128 v[248:251], v1 offset:13312
  v_mul_f32 v202, s93, v202
  v_mfma_f32_16x16x32_bf16 v[188:191], v[252:255], v[136:139], 0
  v_mul_f32 v203, s93, v203
  v_mul_f32 v204, s93, v204
  v_mfma_f32_16x16x32_bf16 v[196:199], v[252:255], v[160:163], 0
  ds_read_b128 v[252:255], v1 offset:12288
  s_waitcnt lgkmcnt(8)
  v_mfma_f32_16x16x32_bf16 v[184:187], v[216:219], v[140:143], v[184:187]
  v_mul_f32 v205, s93, v205
  v_mul_f32 v206, s93, v206
  v_mfma_f32_16x16x32_bf16 v[192:195], v[216:219], v[164:167], v[192:195]
  ds_read_b128 v[216:219], v1 offset:11264
  v_mul_f32 v207, s93, v207
  v_mfma_f32_16x16x32_bf16 v[188:191], v[220:223], v[140:143], v[188:191]
  v_cvt_pk_bf16_f32 v100, v200, v201
  v_cvt_pk_bf16_f32 v101, v202, v203
  v_mfma_f32_16x16x32_bf16 v[196:199], v[220:223], v[164:167], v[196:199]
  ds_read_b128 v[220:223], v1 offset:10240
  s_waitcnt lgkmcnt(8)
  v_mfma_f32_16x16x32_bf16 v[184:187], v[224:227], v[144:147], v[184:187]
  v_cvt_pk_bf16_f32 v102, v204, v205
  v_cvt_pk_bf16_f32 v103, v206, v207
  v_mfma_f32_16x16x32_bf16 v[192:195], v[224:227], v[168:171], v[192:195]
  ds_read_b128 v[224:227], v1 offset:9216
  v_mul_f32 v208, s93, v208
  v_mfma_f32_16x16x32_bf16 v[188:191], v[228:231], v[144:147], v[188:191]
  v_mul_f32 v209, s93, v209
  v_mul_f32 v210, s93, v210
  v_mfma_f32_16x16x32_bf16 v[196:199], v[228:231], v[168:171], v[196:199]
  ds_read_b128 v[228:231], v1 offset:8192
  s_waitcnt lgkmcnt(8)
  v_mfma_f32_16x16x32_bf16 v[184:187], v[232:235], v[148:151], v[184:187]
  v_mul_f32 v211, s93, v211
  v_mul_f32 v212, s93, v212
  v_mfma_f32_16x16x32_bf16 v[192:195], v[232:235], v[172:175], v[192:195]
  ds_read_b128 v[232:235], v1 offset:7168
  v_mul_f32 v213, s93, v213
  v_mfma_f32_16x16x32_bf16 v[188:191], v[236:239], v[148:151], v[188:191]
  v_mul_f32 v214, s93, v214
  v_mul_f32 v215, s93, v215
  v_mfma_f32_16x16x32_bf16 v[196:199], v[236:239], v[172:175], v[196:199]
  ds_read_b128 v[236:239], v1 offset:6144
  s_waitcnt lgkmcnt(8)
  v_mfma_f32_16x16x32_bf16 v[184:187], v[240:243], v[152:155], v[184:187]
  v_cvt_pk_bf16_f32 v124, v208, v209
  v_cvt_pk_bf16_f32 v125, v210, v211
  v_mfma_f32_16x16x32_bf16 v[192:195], v[240:243], v[176:179], v[192:195]
  ds_read_b128 v[240:243], v1 offset:5120
  v_cvt_pk_bf16_f32 v126, v212, v213
  v_mfma_f32_16x16x32_bf16 v[188:191], v[244:247], v[152:155], v[188:191]
  v_cvt_pk_bf16_f32 v127, v214, v215
  v_mfma_f32_16x16x32_bf16 v[196:199], v[244:247], v[176:179], v[196:199]
  ds_read_b128 v[244:247], v1 offset:4096
  s_waitcnt lgkmcnt(8)
  v_mfma_f32_16x16x32_bf16 v[184:187], v[248:251], v[156:159], v[184:187]
  v_mfma_f32_16x16x32_bf16 v[192:195], v[248:251], v[180:183], v[192:195]
  ds_read_b128 v[248:251], v1 offset:3072
  v_mfma_f32_16x16x32_bf16 v[188:191], v[252:255], v[156:159], v[188:191]
  v_mfma_f32_16x16x32_bf16 v[196:199], v[252:255], v[180:183], v[196:199]
  ds_read_b128 v[252:255], v1 offset:2048
  s_waitcnt lgkmcnt(8)
  v_mfma_f32_16x16x32_bf16 v[200:203], v[216:219], v[136:139], 0
  v_mfma_f32_16x16x32_bf16 v[208:211], v[216:219], v[160:163], 0
  ds_read_b128 v[216:219], v1 offset:1024
  v_mul_f32 v184, s93, v184
  s_cbranch_vccz SL29
  s_waitcnt vmcnt(0)
  s_barrier
SL29:
  v_mfma_f32_16x16x32_bf16 v[204:207], v[220:223], v[136:139], 0
  v_mul_f32 v185, s93, v185
  v_mul_f32 v186, s93, v186
  v_mfma_f32_16x16x32_bf16 v[212:215], v[220:223], v[160:163], 0
  ds_read_b128 v[220:223], v1 offset:0
  s_waitcnt lgkmcnt(8)
  v_mfma_f32_16x16x32_bf16 v[200:203], v[224:227], v[140:143], v[200:203]
  v_mul_f32 v187, s93, v187
  v_mul_f32 v188, s93, v188
  v_mfma_f32_16x16x32_bf16 v[208:211], v[224:227], v[164:167], v[208:211]
  v_mul_f32 v189, s93, v189
  v_mul_f32 v190, s93, v190
  v_mfma_f32_16x16x32_bf16 v[204:207], v[228:231], v[140:143], v[204:207]
  v_mul_f32 v191, s93, v191
  v_cvt_pk_bf16_f32 v104, v184, v185
  v_mfma_f32_16x16x32_bf16 v[212:215], v[228:231], v[164:167], v[212:215]
  v_cvt_pk_bf16_f32 v105, v186, v187
  s_waitcnt lgkmcnt(6)
  v_mfma_f32_16x16x32_bf16 v[200:203], v[232:235], v[144:147], v[200:203]
  v_cvt_pk_bf16_f32 v106, v188, v189
  v_cvt_pk_bf16_f32 v107, v190, v191
  v_mfma_f32_16x16x32_bf16 v[208:211], v[232:235], v[168:171], v[208:211]
  v_mul_f32 v192, s93, v192
  v_mul_f32 v193, s93, v193
  v_mfma_f32_16x16x32_bf16 v[204:207], v[236:239], v[144:147], v[204:207]
  v_mul_f32 v194, s93, v194
  v_mul_f32 v195, s93, v195
  v_mfma_f32_16x16x32_bf16 v[212:215], v[236:239], v[168:171], v[212:215]
  v_mul_f32 v196, s93, v196
  s_waitcnt lgkmcnt(5)
  v_mfma_f32_16x16x32_bf16 v[200:203], v[240:243], v[148:151], v[200:203]
  v_mul_f32 v197, s93, v197
  v_mul_f32 v198, s93, v198
  v_mfma_f32_16x16x32_bf16 v[208:211], v[240:243], v[172:175], v[208:211]
  v_mul_f32 v199, s93, v199
  s_waitcnt lgkmcnt(4)
  v_mfma_f32_16x16x32_bf16 v[204:207], v[244:247], v[148:151], v[204:207]
  v_cvt_pk_bf16_f32 v128, v192, v193
  v_cvt_pk_bf16_f32 v129, v194, v195
  v_mfma_f32_16x16x32_bf16 v[212:215], v[244:247], v[172:175], v[212:215]
  v_cvt_pk_bf16_f32 v130, v196, v197
  s_waitcnt lgkmcnt(3)
  v_mfma_f32_16x16x32_bf16 v[200:203], v[248:251], v[152:155], v[200:203]
  v_cvt_pk_bf16_f32 v131, v198, v199
  v_mfma_f32_16x16x32_bf16 v[208:211], v[248:251], v[176:179], v[208:211]
  s_waitcnt lgkmcnt(2)
  v_mfma_f32_16x16x32_bf16 v[204:207], v[252:255], v[152:155], v[204:207]
  v_mfma_f32_16x16x32_bf16 v[212:215], v[252:255], v[176:179], v[212:215]
  s_waitcnt lgkmcnt(1)
  v_mfma_f32_16x16x32_bf16 v[200:203], v[216:219], v[156:159], v[200:203]
  v_mfma_f32_16x16x32_bf16 v[208:211], v[216:219], v[180:183], v[208:211]
  s_waitcnt lgkmcnt(0)
  v_mfma_f32_16x16x32_bf16 v[204:207], v[220:223], v[156:159], v[204:207]
  v_mfma_f32_16x16x32_bf16 v[212:215], v[220:223], v[180:183], v[212:215]
  s_nop 3
  v_mul_f32 v200, s93, v200
  v_mul_f32 v201, s93, v201
  v_mul_f32 v202, s93, v202
  v_mul_f32 v203, s93, v203
  v_mul_f32 v204, s93, v204
  v_mul_f32 v205, s93, v205
  v_mul_f32 v206, s93, v206
  v_mul_f32 v207, s93, v207
  v_cvt_pk_bf16_f32 v108, v200, v201
  v_cvt_pk_bf16_f32 v109, v202, v203
  v_cvt_pk_bf16_f32 v110, v204, v205
  v_cvt_pk_bf16_f32 v111, v206, v207
  v_mul_f32 v208, s93, v208
  v_mul_f32 v209, s93, v209
  v_mul_f32 v210, s93, v210
  v_mul_f32 v211, s93, v211
  v_mul_f32 v212, s93, v212
  v_mul_f32 v213, s93, v213
  v_mul_f32 v214, s93, v214
  v_mul_f32 v215, s93, v215
  v_cvt_pk_bf16_f32 v132, v208, v209
  v_cvt_pk_bf16_f32 v133, v210, v211
  v_cvt_pk_bf16_f32 v134, v212, v213
  v_cvt_pk_bf16_f32 v135, v214, v215
  v_add_u32 v2, 102400, v1
  v_mov_b32 v192, 0x3f803f80
  v_mov_b32 v193, 0x3f803f80
  v_mov_b32 v194, 0x3f803f80
  v_mov_b32 v195, 0x3f803f80
  s_cbranch_vccnz SL30
  s_setprio 0
  s_mul_i32 s100, s32, 7
  s_add_i32 s100, s100, s31
  s_add_u32 m0, s38, 107520
  s_nop 0
  buffer_load_dwordx4 v13, s[12:15], s100 offen lds
  s_add_u32 m0, s38, 108544
  s_nop 0
  buffer_load_dwordx4 v14, s[12:15], s100 offen lds
  s_add_u32 m0, s38, 109568
  s_nop 0
  buffer_load_dwordx4 v3, s[12:15], s100 offen lds
  s_add_u32 m0, s39, 107520
  s_nop 0
  buffer_load_dwordx4 v4, s[12:15], s100 offen lds
  s_mul_i32 s100, s32, 6
  s_add_i32 s100, s100, s31
  s_add_u32 m0, s38, 92160
  s_nop 0
  buffer_load_dwordx4 v13, s[12:15], s100 offen lds
  s_add_u32 m0, s38, 93184
  s_nop 0
  buffer_load_dwordx4 v14, s[12:15], s100 offen lds
  s_add_u32 m0, s38, 94208
  s_nop 0
  buffer_load_dwordx4 v3, s[12:15], s100 offen lds
  s_add_u32 m0, s39, 92160
  s_nop 0
  buffer_load_dwordx4 v4, s[12:15], s100 offen lds
  s_mul_i32 s100, s32, 5
  s_add_i32 s100, s100, s31
  s_add_u32 m0, s38, 76800
  s_nop 0
  buffer_load_dwordx4 v13, s[12:15], s100 offen lds
  s_add_u32 m0, s38, 77824
  s_nop 0
  buffer_load_dwordx4 v14, s[12:15], s100 offen lds
  s_add_u32 m0, s38, 78848
  s_nop 0
  buffer_load_dwordx4 v3, s[12:15], s100 offen lds
  s_add_u32 m0, s39, 76800
  s_nop 0
  buffer_load_dwordx4 v4, s[12:15], s100 offen lds
  s_barrier
  s_mul_i32 s100, s32, 4
  s_add_i32 s100, s100, s31
  s_add_u32 m0, s38, 61440
  s_nop 0
  buffer_load_dwordx4 v13, s[12:15], s100 offen lds
  s_add_u32 m0, s38, 62464
  s_nop 0
  buffer_load_dwordx4 v14, s[12:15], s100 offen lds
  s_add_u32 m0, s38, 63488
  s_nop 0
  buffer_load_dwordx4 v3, s[12:15], s100 offen lds
  s_add_u32 m0, s39, 61440
  s_nop 0
  buffer_load_dwordx4 v4, s[12:15], s100 offen lds
  s_mul_i32 s100, s32, 3
  s_add_i32 s100, s100, s31
  s_add_u32 m0, s38, 46080
  s_nop 0
  buffer_load_dwordx4 v13, s[12:15], s100 offen lds
  s_add_u32 m0, s38, 47104
  s_nop 0
  buffer_load_dwordx4 v14, s[12:15], s100 offen lds
  s_add_u32 m0, s38, 48128
  s_nop 0
  buffer_load_dwordx4 v3, s[12:15], s100 offen lds
  s_add_u32 m0, s39, 46080
  s_nop 0
  buffer_load_dwordx4 v4, s[12:15], s100 offen lds
  s_mul_i32 s100, s32, 2
  s_add_i32 s100, s100, s31
  s_add_u32 m0, s38, 30720
  s_nop 0
  buffer_load_dwordx4 v13, s[12:15], s100 offen lds
  s_add_u32 m0, s38, 31744
  s_nop 0
  buffer_load_dwordx4 v14, s[12:15], s100 offen lds
  s_add_u32 m0, s38, 32768
  s_nop 0
  buffer_load_dwordx4 v3, s[12:15], s100 offen lds
  s_add_u32 m0, s39, 30720
  s_nop 0
  buffer_load_dwordx4 v4, s[12:15], s100 offen lds
  v_mov_b32 v140, 0xff800000
  v_add_u32 v141, 0, v19
  v_add_u32 v142, 1, v19
  v_add_u32 v143, 2, v19
  v_add_u32 v144, 3, v19
  v_cmp_gt_u32 s[48:49], 7, v141
  v_cmp_gt_u32 s[50:51], 7, v142
  v_cmp_gt_u32 s[52:53], 7, v143
  v_cmp_gt_u32 s[54:55], 7, v144
  v_cndmask_b32 v136, v140, 0, s[48:49]
  v_cndmask_b32 v137, v140, 0, s[50:51]
  v_cndmask_b32 v138, v140, 0, s[52:53]
  v_cndmask_b32 v139, v140, 0, s[54:55]
  v_sub_u32 v141, s35, v21
  s_add_i32 s46, s34, 0
  v_sub_u32 v142, s46, v21
  s_add_i32 s46, s34, 1
  v_sub_u32 v143, s46, v21
  s_add_i32 s46, s34, 2
  v_sub_u32 v144, s46, v21
  v_cmp_gt_u32 s[48:49], 7, v141
  v_cmp_gt_u32 s[50:51], 7, v142
  v_cmp_gt_u32 s[52:53], 7, v143
  v_cmp_gt_u32 s[54:55], 7, v144
  v_cndmask_b32 v24, v140, v136, s[48:49]
  v_cndmask_b32 v25, v140, v137, s[48:49]
  v_cndmask_b32 v26, v140, v138, s[48:49]
  v_cndmask_b32 v27, v140, v139, s[48:49]
  v_cndmask_b32 v28, v140, v136, s[50:51]
  v_cndmask_b32 v29, v140, v137, s[50:51]
  v_cndmask_b32 v30, v140, v138, s[50:51]
  v_cndmask_b32 v31, v140, v139, s[50:51]
  v_cndmask_b32 v32, v140, v136, s[52:53]
  v_cndmask_b32 v33, v140, v137, s[52:53]
  v_cndmask_b32 v34, v140, v138, s[52:53]
  v_cndmask_b32 v35, v140, v139, s[52:53]
  v_cndmask_b32 v36, v140, v136, s[54:55]
  v_cndmask_b32 v37, v140, v137, s[54:55]
  v_cndmask_b32 v38, v140, v138, s[54:55]
  v_cndmask_b32 v39, v140, v139, s[54:55]
  s_add_i32 s46, s34, 3
  v_sub_u32 v141, s46, v21
  s_add_i32 s46, s34, 4
  v_sub_u32 v142, s46, v21
  s_add_i32 s46, s34, 5
  v_sub_u32 v143, s46, v21
  s_add_i32 s46, s34, 6
  v_sub_u32 v144, s46, v21
  v_cmp_gt_u32 s[48:49], 7, v141
  v_cmp_gt_u32 s[50:51], 7, v142
  v_cmp_gt_u32 s[52:53], 7, v143
  v_cmp_gt_u32 s[54:55], 7, v144
  v_cndmask_b32 v40, v140, v136, s[48:49]
  v_cndmask_b32 v41, v140, v137, s[48:49]
  v_cndmask_b32 v42, v140, v138, s[48:49]
  v_cndmask_b32 v43, v140, v139, s[48:49]
  v_cndmask_b32 v44, v140, v136, s[50:51]
  v_cndmask_b32 v45, v140, v137, s[50:51]
  v_cndmask_b32 v46, v140, v138, s[50:51]
  v_cndmask_b32 v47, v140, v139, s[50:51]
  v_cndmask_b32 v48, v140, v136, s[52:53]
  v_cndmask_b32 v49, v140, v137, s[52:53]
  v_cndmask_b32 v50, v140, v138, s[52:53]
  v_cndmask_b32 v51, v140, v139, s[52:53]
  v_cndmask_b32 v52, v140, v136, s[54:55]
  v_cndmask_b32 v53, v140, v137, s[54:55]
  v_cndmask_b32 v54, v140, v138, s[54:55]
  v_cndmask_b32 v55, v140, v139, s[54:55]
  s_add_i32 s46, s34, 1
  v_sub_u32 v141, s46, v22
  s_add_i32 s46, s34, 2
  v_sub_u32 v142, s46, v22
  s_add_i32 s46, s34, 3
  v_sub_u32 v143, s46, v22
  s_add_i32 s46, s34, 4
  v_sub_u32 v144, s46, v22
  v_cmp_gt_u32 s[48:49], 7, v141
  v_cmp_gt_u32 s[50:51], 7, v142
  v_cmp_gt_u32 s[52:53], 7, v143
  v_cmp_gt_u32 s[54:55], 7, v144
  v_cndmask_b32 v56, v140, v136, s[48:49]
  v_cndmask_b32 v57, v140, v137, s[48:49]
  v_cndmask_b32 v58, v140, v138, s[48:49]
  v_cndmask_b32 v59, v140, v139, s[48:49]
  v_cndmask_b32 v60, v140, v136, s[50:51]
  v_cndmask_b32 v61, v140, v137, s[50:51]
  v_cndmask_b32 v62, v140, v138, s[50:51]
  v_cndmask_b32 v63, v140, v139, s[50:51]
  v_cndmask_b32 v64, v140, v136, s[52:53]
  v_cndmask_b32 v65, v140, v137, s[52:53]
  v_cndmask_b32 v66, v140, v138, s[52:53]
  v_cndmask_b32 v67, v140, v139, s[52:53]
  v_cndmask_b32 v68, v140, v136, s[54:55]
  v_cndmask_b32 v69, v140, v137, s[54:55]
  v_cndmask_b32 v70, v140, v138, s[54:55]
  v_cndmask_b32 v71, v140, v139, s[54:55]
  s_add_i32 s46, s34, 5
  v_sub_u32 v141, s46, v22
  s_add_i32 s46, s34, 6
  v_sub_u32 v142, s46, v22
  s_add_i32 s46, s34, 7
  v_sub_u32 v143, s46, v22
  s_add_i32 s46, s34, 8
  v_sub_u32 v144, s46, v22
  v_cmp_gt_u32 s[48:49], 7, v141
  v_cmp_gt_u32 s[50:51], 7, v142
  v_cmp_gt_u32 s[52:53], 7, v143
  v_cmp_gt_u32 s[54:55], 7, v144
  v_cndmask_b32 v72, v140, v136, s[48:49]
  v_cndmask_b32 v73, v140, v137, s[48:49]
  v_cndmask_b32 v74, v140, v138, s[48:49]
  v_cndmask_b32 v75, v140, v139, s[48:49]
  v_cndmask_b32 v76, v140, v136, s[50:51]
  v_cndmask_b32 v77, v140, v137, s[50:51]
  v_cndmask_b32 v78, v140, v138, s[50:51]
  v_cndmask_b32 v79, v140, v139, s[50:51]
  v_cndmask_b32 v80, v140, v136, s[52:53]
  v_cndmask_b32 v81, v140, v137, s[52:53]
  v_cndmask_b32 v82, v140, v138, s[52:53]
  v_cndmask_b32 v83, v140, v139, s[52:53]
  v_cndmask_b32 v84, v140, v136, s[54:55]
  v_cndmask_b32 v85, v140, v137, s[54:55]
  v_cndmask_b32 v86, v140, v138, s[54:55]
  v_cndmask_b32 v87, v140, v139, s[54:55]
  s_waitcnt vmcnt(12)
  s_barrier
  s_max_u32 s100, s33, 1
  s_mul_i32 s100, s100, s32
  s_add_i32 s100, s100, s31
  s_add_u32 m0, s38, 15360
  s_nop 0
  buffer_load_dwordx4 v13, s[12:15], s100 offen lds
  s_add_u32 m0, s38, 16384
  s_nop 0
  buffer_load_dwordx4 v14, s[12:15], s100 offen lds
  s_add_u32 m0, s38, 17408
  s_nop 0
  buffer_load_dwordx4 v3, s[12:15], s100 offen lds
  s_add_u32 m0, s39, 15360
  s_nop 0
  buffer_load_dwordx4 v4, s[12:15], s100 offen lds
  s_max_u32 s100, s33, 0
  s_mul_i32 s100, s100, s32
  s_add_i32 s100, s100, s31
  s_add_u32 m0, s38, 0
  s_nop 0
  buffer_load_dwordx4 v13, s[12:15], s100 offen lds
  s_add_u32 m0, s38, 1024
  s_nop 0
  buffer_load_dwordx4 v14, s[12:15], s100 offen lds
  s_add_u32 m0, s38, 2048
  s_nop 0
  buffer_load_dwordx4 v3, s[12:15], s100 offen lds
  s_add_u32 m0, s39, 0
  s_nop 0
  buffer_load_dwordx4 v4, s[12:15], s100 offen lds
  s_waitcnt vmcnt(8)
  s_barrier
SL30:
  ds_read_b128 v[224:227], v7 offset:61440
  ds_read_b128 v[228:231], v8 offset:61440
  ds_read_b128 v[232:235], v7 offset:61568
  ds_read_b128 v[236:239], v8 offset:61568
  ds_read_b128 v[240:243], v7 offset:61696
  ds_read_b128 v[244:247], v8 offset:61696
  ds_read_b128 v[248:251], v7 offset:53760
  ds_read_b128 v[252:255], v8 offset:53760
  ds_read_b128 v[216:219], v7 offset:53888
  ds_read_b128 v[220:223], v8 offset:53888
  s_waitcnt lgkmcnt(8)
  v_mfma_f32_16x16x32_bf16 v[84:87], v[224:227], v[112:115], v[84:87]
  ds_read_b128 v[224:227], v7 offset:54016
  v_mfma_f32_16x16x32_bf16 v[84:87], v[228:231], v[116:119], v[84:87]
  ds_read_b128 v[228:231], v8 offset:54016
  s_waitcnt lgkmcnt(8)
  v_mfma_f32_16x16x32_bf16 v[84:87], v[232:235], v[120:123], v[84:87]
  ds_read_b128 v[232:235], v7 offset:46080
  v_mfma_f32_16x16x32_bf16 v[84:87], v[236:239], v[124:127], v[84:87]
  ds_read_b128 v[236:239], v8 offset:46080
  s_waitcnt lgkmcnt(8)
  v_mfma_f32_16x16x32_bf16 v[84:87], v[240:243], v[128:131], v[84:87]
  ds_read_b128 v[240:243], v7 offset:46208
  v_mfma_f32_16x16x32_bf16 v[84:87], v[244:247], v[132:135], v[84:87]
  ds_read_b128 v[244:247], v8 offset:46208
  s_waitcnt lgkmcnt(8)
  v_mfma_f32_16x16x32_bf16 v[80:83], v[248:251], v[112:115], v[80:83]
  ds_read_b128 v[248:251], v7 offset:46336
  v_mfma_f32_16x16x32_bf16 v[80:83], v[252:255], v[116:119], v[80:83]
  ds_read_b128 v[252:255], v8 offset:46336
  s_waitcnt lgkmcnt(8)
  v_mfma_f32_16x16x32_bf16 v[80:83], v[216:219], v[120:123], v[80:83]
  ds_read_b128 v[216:219], v7 offset:38400
  v_mfma_f32_16x16x32_bf16 v[80:83], v[220:223], v[124:127], v[80:83]
  ds_read_b128 v[220:223], v8 offset:38400
  s_waitcnt lgkmcnt(8)
  v_mfma_f32_16x16x32_bf16 v[80:83], v[224:227], v[128:131], v[80:83]
  ds_read_b128 v[224:227], v7 offset:38528
  v_mfma_f32_16x16x32_bf16 v[80:83], v[228:231], v[132:135], v[80:83]
  ds_read_b128 v[228:231], v8 offset:38528
  s_cbranch_vccz SL31
  s_barrier
  s_branch SM31
SL31:
  s_waitcnt vmcnt(0)
  s_barrier
SM31:
  s_waitcnt lgkmcnt(8)
  v_mfma_f32_16x16x32_bf16 v[76:79], v[232:235], v[112:115], v[76:79]
  v_exp_f32 v196, v84
  v_mfma_f32_16x16x32_bf16 v[52:55], v[232:235], v[88:91], v[52:55]
  ds_read_b128 v[232:235], v7 offset:38656
  v_exp_f32 v197, v85
  v_mfma_f32_16x16x32_bf16 v[76:79], v[236:239], v[116:119], v[76:79]
  v_exp_f32 v198, v86
  v_mfma_f32_16x16x32_bf16 v[52:55], v[236:239], v[92:95], v[52:55]
  ds_read_b128 v[236:239], v8 offset:38656
  s_waitcnt lgkmcnt(8)
  v_mfma_f32_16x16x32_bf16 v[76:79], v[240:243], v[120:123], v[76:79]
  v_exp_f32 v199, v87
  v_mfma_f32_16x16x32_bf16 v[52:55], v[240:243], v[96:99], v[52:55]
  ds_read_b128 v[240:243], v7 offset:30720
  v_cvt_pk_bf16_f32 v166, v196, v197
  v_mfma_f32_16x16x32_bf16 v[76:79], v[244:247], v[124:127], v[76:79]
  v_cvt_pk_bf16_f32 v167, v198, v199
  v_mfma_f32_16x16x32_bf16 v[52:55], v[244:247], v[100:103], v[52:55]
  ds_read_b128 v[244:247], v8 offset:30720
  s_waitcnt lgkmcnt(8)
  v_mfma_f32_16x16x32_bf16 v[76:79], v[248:251], v[128:131], v[76:79]
  v_exp_f32 v200, v80
  v_mfma_f32_16x16x32_bf16 v[52:55], v[248:251], v[104:107], v[52:55]
  ds_read_b128 v[248:251], v7 offset:30848
  v_mfma_f32_16x16x32_bf16 v[76:79], v[252:255], v[132:135], v[76:79]
  v_exp_f32 v201, v81
  v_mfma_f32_16x16x32_bf16 v[52:55], v[252:255], v[108:111], v[52:55]
  ds_read_b128 v[252:255], v8 offset:30848
  s_waitcnt lgkmcnt(8)
  v_mfma_f32_16x16x32_bf16 v[72:75], v[216:219], v[112:115], v[72:75]
  v_exp_f32 v202, v82
  v_mfma_f32_16x16x32_bf16 v[48:51], v[216:219], v[88:91], v[48:51]
  ds_read_b128 v[216:219], v7 offset:30976
  v_exp_f32 v203, v83
  v_mfma_f32_16x16x32_bf16 v[72:75], v[220:223], v[116:119], v[72:75]
  v_cvt_pk_bf16_f32 v164, v200, v201
  v_cvt_pk_bf16_f32 v165, v202, v203
  v_mfma_f32_16x16x32_bf16 v[48:51], v[220:223], v[92:95], v[48:51]
  ds_read_b128 v[220:223], v8 offset:30976
  v_exp_f32 v204, v76
  s_waitcnt lgkmcnt(8)
  v_mfma_f32_16x16x32_bf16 v[72:75], v[224:227], v[120:123], v[72:75]
  v_exp_f32 v205, v77
  v_mfma_f32_16x16x32_bf16 v[48:51], v[224:227], v[96:99], v[48:51]
  ds_read_b128 v[224:227], v7 offset:23040
  v_mfma_f32_16x16x32_bf16 v[72:75], v[228:231], v[124:127], v[72:75]
  v_exp_f32 v206, v78
  v_mfma_f32_16x16x32_bf16 v[48:51], v[228:231], v[100:103], v[48:51]
  ds_read_b128 v[228:231], v8 offset:23040
  s_waitcnt lgkmcnt(8)
  v_mfma_f32_16x16x32_bf16 v[72:75], v[232:235], v[128:131], v[72:75]
  v_exp_f32 v207, v79
  v_mfma_f32_16x16x32_bf16 v[48:51], v[232:235], v[104:107], v[48:51]
  ds_read_b128 v[232:235], v7 offset:23168
  v_cvt_pk_bf16_f32 v162, v204, v205
  v_mfma_f32_16x16x32_bf16 v[72:75], v[236:239], v[132:135], v[72:75]
  v_cvt_pk_bf16_f32 v163, v206, v207
  v_mfma_f32_16x16x32_bf16 v[48:51], v[236:239], v[108:111], v[48:51]
  ds_read_b128 v[236:239], v8 offset:23168
  s_waitcnt lgkmcnt(8)
  v_mfma_f32_16x16x32_bf16 v[68:71], v[240:243], v[112:115], v[68:71]
  v_exp_f32 v208, v52
  v_mfma_f32_16x16x32_bf16 v[44:47], v[240:243], v[88:91], v[44:47]
  ds_read_b128 v[240:243], v7 offset:23296
  v_exp_f32 v209, v53
  v_mfma_f32_16x16x32_bf16 v[68:71], v[244:247], v[116:119], v[68:71]
  v_exp_f32 v210, v54
  v_mfma_f32_16x16x32_bf16 v[44:47], v[244:247], v[92:95], v[44:47]
  ds_read_b128 v[244:247], v8 offset:23296
  v_exp_f32 v211, v55
  s_waitcnt lgkmcnt(8)
  v_mfma_f32_16x16x32_bf16 v[68:71], v[248:251], v[120:123], v[68:71]
  v_cvt_pk_bf16_f32 v150, v208, v209
  v_cvt_pk_bf16_f32 v151, v210, v211
  v_mfma_f32_16x16x32_bf16 v[44:47], v[248:251], v[96:99], v[44:47]
  ds_read_b128 v[248:251], v7 offset:15360
  v_exp_f32 v212, v72
  v_mfma_f32_16x16x32_bf16 v[68:71], v[252:255], v[124:127], v[68:71]
  v_exp_f32 v213, v73
  v_mfma_f32_16x16x32_bf16 v[44:47], v[252:255], v[100:103], v[44:47]
  ds_read_b128 v[252:255], v8 offset:15360
  s_waitcnt lgkmcnt(8)
  v_mfma_f32_16x16x32_bf16 v[68:71], v[216:219], v[128:131], v[68:71]
  v_exp_f32 v214, v74
  v_mfma_f32_16x16x32_bf16 v[44:47], v[216:219], v[104:107], v[44:47]
  ds_read_b128 v[216:219], v7 offset:15488
  v_mfma_f32_16x16x32_bf16 v[68:71], v[220:223], v[132:135], v[68:71]
  v_exp_f32 v215, v75
  v_mfma_f32_16x16x32_bf16 v[44:47], v[220:223], v[108:111], v[44:47]
  ds_read_b128 v[220:223], v8 offset:15488
  s_waitcnt lgkmcnt(8)
  v_mfma_f32_16x16x32_bf16 v[64:67], v[224:227], v[112:115], v[64:67]
  v_cvt_pk_bf16_f32 v160, v212, v213
  v_cvt_pk_bf16_f32 v161, v214, v215
  v_mfma_f32_16x16x32_bf16 v[40:43], v[224:227], v[88:91], v[40:43]
  ds_read_b128 v[224:227], v7 offset:15616
  v_exp_f32 v196, v48
  v_mfma_f32_16x16x32_bf16 v[64:67], v[228:231], v[116:119], v[64:67]
  v_exp_f32 v197, v49
  v_mfma_f32_16x16x32_bf16 v[40:43], v[228:231], v[92:95], v[40:43]
  ds_read_b128 v[228:231], v8 offset:15616
  v_exp_f32 v198, v50
  s_waitcnt lgkmcnt(8)
  v_mfma_f32_16x16x32_bf16 v[64:67], v[232:235], v[120:123], v[64:67]
  v_exp_f32 v199, v51
  v_mfma_f32_16x16x32_bf16 v[40:43], v[232:235], v[96:99], v[40:43]
  ds_read_b128 v[232:235], v7 offset:7680
  v_cvt_pk_bf16_f32 v148, v196, v197
  v_cvt_pk_bf16_f32 v149, v198, v199
  v_mfma_f32_16x16x32_bf16 v[64:67], v[236:239], v[124:127], v[64:67]
  v_exp_f32 v200, v68
  v_mfma_f32_16x16x32_bf16 v[40:43], v[236:239], v[100:103], v[40:43]
  ds_read_b128 v[236:239], v8 offset:7680
  v_exp_f32 v201, v69
  s_waitcnt lgkmcnt(8)
  v_mfma_f32_16x16x32_bf16 v[64:67], v[240:243], v[128:131], v[64:67]
  v_exp_f32 v202, v70
  v_mfma_f32_16x16x32_bf16 v[40:43], v[240:243], v[104:107], v[40:43]
  ds_read_b128 v[240:243], v7 offset:7808
  v_mfma_f32_16x16x32_bf16 v[64:67], v[244:247], v[132:135], v[64:67]
  v_exp_f32 v203, v71
  v_mfma_f32_16x16x32_bf16 v[40:43], v[244:247], v[108:111], v[40:43]
  ds_read_b128 v[244:247], v8 offset:7808
  s_cbranch_vccz SL32
  s_barrier
  buffer_load_dword v13, off, s[8:11], 0
SL32:
  s_waitcnt lgkmcnt(8)
  v_mfma_f32_16x16x32_bf16 v[60:63], v[248:251], v[112:115], v[60:63]
  v_cvt_pk_bf16_f32 v158, v200, v201
  v_cvt_pk_bf16_f32 v159, v202, v203
  v_mfma_f32_16x16x32_bf16 v[36:39], v[248:251], v[88:91], v[36:39]
  ds_read_b128 v[248:251], v7 offset:7936
  v_exp_f32 v204, v44
  v_mfma_f32_16x16x32_bf16 v[60:63], v[252:255], v[116:119], v[60:63]
  v_exp_f32 v205, v45
  v_mfma_f32_16x16x32_bf16 v[36:39], v[252:255], v[92:95], v[36:39]
  ds_read_b128 v[252:255], v8 offset:7936
  v_exp_f32 v206, v46
  s_waitcnt lgkmcnt(8)
  v_mfma_f32_16x16x32_bf16 v[60:63], v[216:219], v[120:123], v[60:63]
  v_exp_f32 v207, v47
  v_mfma_f32_16x16x32_bf16 v[36:39], v[216:219], v[96:99], v[36:39]
  ds_read_b128 v[216:219], v7 offset:0
  v_cvt_pk_bf16_f32 v146, v204, v205
  v_cvt_pk_bf16_f32 v147, v206, v207
  v_mfma_f32_16x16x32_bf16 v[60:63], v[220:223], v[124:127], v[60:63]
  v_exp_f32 v208, v64
  v_mfma_f32_16x16x32_bf16 v[36:39], v[220:223], v[100:103], v[36:39]
  ds_read_b128 v[220:223], v8 offset:0
  v_exp_f32 v209, v65
  s_waitcnt lgkmcnt(8)
  v_mfma_f32_16x16x32_bf16 v[60:63], v[224:227], v[128:131], v[60:63]
  v_exp_f32 v210, v66
  v_mfma_f32_16x16x32_bf16 v[36:39], v[224:227], v[104:107], v[36:39]
  ds_read_b128 v[224:227], v7 offset:128
  v_mfma_f32_16x16x32_bf16 v[60:63], v[228:231], v[132:135], v[60:63]
  v_exp_f32 v211, v67
  v_mfma_f32_16x16x32_bf16 v[36:39], v[228:231], v[108:111], v[36:39]
  ds_read_b128 v[228:231], v8 offset:128
  s_cbranch_vccnz SL33
  s_barrier
SL33:
  s_waitcnt lgkmcnt(8)
  v_mfma_f32_16x16x32_bf16 v[56:59], v[232:235], v[112:115], v[56:59]
  v_cvt_pk_bf16_f32 v156, v208, v209
  v_cvt_pk_bf16_f32 v157, v210, v211
  v_mfma_f32_16x16x32_bf16 v[32:35], v[232:235], v[88:91], v[32:35]
  ds_read_b128 v[232:235], v7 offset:256
  v_exp_f32 v212, v40
  v_mfma_f32_16x16x32_bf16 v[56:59], v[236:239], v[116:119], v[56:59]
  v_exp_f32 v213, v41
  v_mfma_f32_16x16x32_bf16 v[32:35], v[236:239], v[92:95], v[32:35]
  ds_read_b128 v[236:239], v8 offset:256
  v_exp_f32 v214, v42
  s_waitcnt lgkmcnt(8)
  v_mfma_f32_16x16x32_bf16 v[56:59], v[240:243], v[120:123], v[56:59]
  v_exp_f32 v215, v43
  v_mfma_f32_16x16x32_bf16 v[32:35], v[240:243], v[96:99], v[32:35]
  ds_read_b128 v[240:243], v20 offset:0
  v_cvt_pk_bf16_f32 v144, v212, v213
  v_cvt_pk_bf16_f32 v145, v214, v215
  v_mfma_f32_16x16x32_bf16 v[56:59], v[244:247], v[124:127], v[56:59]
  v_exp_f32 v196, v60
  v_mfma_f32_16x16x32_bf16 v[32:35], v[244:247], v[100:103], v[32:35]
  ds_read_b128 v[244:247], v0 offset:0
  v_exp_f32 v197, v61
  s_waitcnt lgkmcnt(8)
  v_mfma_f32_16x16x32_bf16 v[56:59], v[248:251], v[128:131], v[56:59]
  v_exp_f32 v198, v62
  v_mfma_f32_16x16x32_bf16 v[32:35], v[248:251], v[104:107], v[32:35]
  ds_read_b128 v[248:251], v20 offset:128
  v_mfma_f32_16x16x32_bf16 v[56:59], v[252:255], v[132:135], v[56:59]
  v_exp_f32 v199, v63
  v_mfma_f32_16x16x32_bf16 v[32:35], v[252:255], v[108:111], v[32:35]
  ds_read_b128 v[252:255], v0 offset:128
  s_waitcnt lgkmcnt(8)
  v_mfma_f32_16x16x32_bf16 v[28:31], v[216:219], v[88:91], v[28:31]
  ds_read_b128 v[216:219], v20 offset:256
  v_cvt_pk_bf16_f32 v154, v196, v197
  v_cvt_pk_bf16_f32 v155, v198, v199
  v_mfma_f32_16x16x32_bf16 v[28:31], v[220:223], v[92:95], v[28:31]
  ds_read_b128 v[220:223], v0 offset:256
  v_exp_f32 v200, v36
  s_waitcnt lgkmcnt(8)
  v_mfma_f32_16x16x32_bf16 v[28:31], v[224:227], v[96:99], v[28:31]
  ds_read_b64_tr_b16 v[224:225], v9 offset:53760
  ds_read_b64_tr_b16 v[226:227], v9 offset:61440
  v_exp_f32 v201, v37
  v_mfma_f32_16x16x32_bf16 v[28:31], v[228:231], v[100:103], v[28:31]
  ds_read_b64_tr_b16 v[228:229], v10 offset:53760
  ds_read_b64_tr_b16 v[230:231], v10 offset:61440
  v_exp_f32 v202, v38
  s_waitcnt lgkmcnt(10)
  v_mfma_f32_16x16x32_bf16 v[28:31], v[232:235], v[104:107], v[28:31]
  ds_read_b64_tr_b16 v[232:233], v11 offset:53760
  ds_read_b64_tr_b16 v[234:235], v11 offset:61440
  v_exp_f32 v203, v39
  v_mfma_f32_16x16x32_bf16 v[28:31], v[236:239], v[108:111], v[28:31]
  ds_read_b64_tr_b16 v[236:237], v12 offset:53760
  ds_read_b64_tr_b16 v[238:239], v12 offset:61440
  v_cvt_pk_bf16_f32 v142, v200, v201
  v_cvt_pk_bf16_f32 v143, v202, v203
  s_waitcnt lgkmcnt(12)
  v_mfma_f32_16x16x32_bf16 v[24:27], v[240:243], v[88:91], v[24:27]
  ds_read_b64_tr_b16 v[240:241], v9 offset:53888
  ds_read_b64_tr_b16 v[242:243], v9 offset:61568
  v_exp_f32 v204, v56
  v_mfma_f32_16x16x32_bf16 v[24:27], v[244:247], v[92:95], v[24:27]
  v_exp_f32 v205, v57
  s_waitcnt lgkmcnt(12)
  v_mfma_f32_16x16x32_bf16 v[24:27], v[248:251], v[96:99], v[24:27]
  ds_read_b64_tr_b16 v[244:245], v10 offset:53888
  ds_read_b64_tr_b16 v[246:247], v10 offset:61568
  v_exp_f32 v206, v58
  v_exp_f32 v207, v59
  v_cvt_pk_bf16_f32 v152, v204, v205
  v_cvt_pk_bf16_f32 v153, v206, v207
  v_mfma_f32_16x16x32_bf16 v[188:191], v[192:195], v[164:167], 0
  v_exp_f32 v208, v32
  v_mfma_f32_16x16x32_bf16 v[188:191], v[192:195], v[160:163], v[188:191]
  v_exp_f32 v209, v33
  v_mfma_f32_16x16x32_bf16 v[188:191], v[192:195], v[156:159], v[188:191]
  v_exp_f32 v210, v34
  v_mfma_f32_16x16x32_bf16 v[188:191], v[192:195], v[152:155], v[188:191]
  v_exp_f32 v211, v35
  v_mfma_f32_16x16x32_bf16 v[24:27], v[252:255], v[100:103], v[24:27]
  v_cvt_pk_bf16_f32 v140, v208, v209
  s_waitcnt lgkmcnt(12)
  v_mfma_f32_16x16x32_bf16 v[24:27], v[216:219], v[104:107], v[24:27]
  ds_read_b64_tr_b16 v[248:249], v11 offset:53888
  ds_read_b64_tr_b16 v[250:251], v11 offset:61568
  v_mfma_f32_16x16x32_bf16 v[24:27], v[220:223], v[108:111], v[24:27]
  v_cvt_pk_bf16_f32 v141, v210, v211
  v_subrev_u32 v23, 813694976, v188
  s_mov_b32 s52, 503316480
  v_cmp_gt_u32 s[48:49], s52, v23
  s_or_b64 s[48:49], s[48:49], s[44:45]
  s_cmp_eq_u64 s[48:49], -1
  s_cbranch_scc0 FB1
FBR1:
  s_cbranch_vccnz SL34
  s_barrier
SL34:
  s_waitcnt lgkmcnt(10)
  v_mfma_f32_16x16x32_bf16 v[88:91], v[224:227], v[164:167], 0
  ds_read_b64_tr_b16 v[252:253], v12 offset:53888
  ds_read_b64_tr_b16 v[254:255], v12 offset:61568
  v_exp_f32 v212, v28
  v_mfma_f32_16x16x32_bf16 v[92:95], v[228:231], v[164:167], 0
  ds_read_b64_tr_b16 v[216:217], v9 offset:54016
  ds_read_b64_tr_b16 v[218:219], v9 offset:61696
  v_exp_f32 v213, v29
  s_waitcnt lgkmcnt(10)
  v_mfma_f32_16x16x32_bf16 v[96:99], v[232:235], v[164:167], 0
  ds_read_b64_tr_b16 v[220:221], v10 offset:54016
  ds_read_b64_tr_b16 v[222:223], v10 offset:61696
  v_mfma_f32_16x16x32_bf16 v[100:103], v[236:239], v[164:167], 0
  ds_read_b64_tr_b16 v[224:225], v11 offset:54016
  ds_read_b64_tr_b16 v[226:227], v11 offset:61696
  s_waitcnt lgkmcnt(10)
  v_mfma_f32_16x16x32_bf16 v[104:107], v[240:243], v[164:167], 0
  ds_read_b64_tr_b16 v[228:229], v12 offset:54016
  ds_read_b64_tr_b16 v[230:231], v12 offset:61696
  v_mfma_f32_16x16x32_bf16 v[108:111], v[244:247], v[164:167], 0
  ds_read_b64_tr_b16 v[232:233], v9 offset:38400
  ds_read_b64_tr_b16 v[234:235], v9 offset:46080
  s_waitcnt lgkmcnt(10)
  v_mfma_f32_16x16x32_bf16 v[112:115], v[248:251], v[164:167], 0
  ds_read_b64_tr_b16 v[236:237], v10 offset:38400
  ds_read_b64_tr_b16 v[238:239], v10 offset:46080
  v_mfma_f32_16x16x32_bf16 v[116:119], v[252:255], v[164:167], 0
  ds_read_b64_tr_b16 v[240:241], v11 offset:38400
  ds_read_b64_tr_b16 v[242:243], v11 offset:46080
  s_waitcnt lgkmcnt(10)
  v_mfma_f32_16x16x32_bf16 v[120:123], v[216:219], v[164:167], 0
  ds_read_b64_tr_b16 v[244:245], v12 offset:38400
  ds_read_b64_tr_b16 v[246:247], v12 offset:46080
  v_mfma_f32_16x16x32_bf16 v[124:127], v[220:223], v[164:167], 0
  ds_read_b64_tr_b16 v[248:249], v9 offset:38528
  ds_read_b64_tr_b16 v[250:251], v9 offset:46208
  s_waitcnt lgkmcnt(10)
  v_mfma_f32_16x16x32_bf16 v[128:131], v[224:227], v[164:167], 0
  ds_read_b64_tr_b16 v[252:253], v10 offset:38528
  ds_read_b64_tr_b16 v[254:255], v10 offset:46208
  v_mfma_f32_16x16x32_bf16 v[132:135], v[228:231], v[164:167], 0
  ds_read_b64_tr_b16 v[216:217], v11 offset:38528
  ds_read_b64_tr_b16 v[218:219], v11 offset:46208
  v_exp_f32 v214, v30
  v_exp_f32 v215, v31
  v_cvt_pk_bf16_f32 v138, v212, v213
  v_cvt_pk_bf16_f32 v139, v214, v215
  v_exp_f32 v196, v24
  v_exp_f32 v197, v25
  v_exp_f32 v198, v26
  v_exp_f32 v199, v27
  v_cvt_pk_bf16_f32 v136, v196, v197
  v_cvt_pk_bf16_f32 v137, v198, v199
  v_mfma_f32_16x16x32_bf16 v[184:187], v[192:195], v[148:151], 0
  v_mfma_f32_16x16x32_bf16 v[184:187], v[192:195], v[144:147], v[184:187]
  v_mfma_f32_16x16x32_bf16 v[184:187], v[192:195], v[140:143], v[184:187]
  v_mfma_f32_16x16x32_bf16 v[184:187], v[192:195], v[136:139], v[184:187]
  s_nop 7
  v_subrev_u32 v23, 813694976, v184
  s_mov_b32 s52, 503316480
  v_cmp_gt_u32 s[48:49], s52, v23
  s_or_b64 s[48:49], s[48:49], s[42:43]
  s_cmp_eq_u64 s[48:49], -1
  s_cbranch_scc0 FB0
FBR0:
  s_waitcnt lgkmcnt(10)
  v_mfma_f32_16x16x32_bf16 v[88:91], v[232:235], v[160:163], v[88:91]
  ds_read_b64_tr_b16 v[220:221], v12 offset:38528
  ds_read_b64_tr_b16 v[222:223], v12 offset:46208
  v_mfma_f32_16x16x32_bf16 v[24:27], v[232:235], v[148:151], 0
  ds_read_b64_tr_b16 v[224:225], v9 offset:38656
  ds_read_b64_tr_b16 v[226:227], v9 offset:46336
  v_mfma_f32_16x16x32_bf16 v[92:95], v[236:239], v[160:163], v[92:95]
  v_rcp_f32 v22, v184
  v_mfma_f32_16x16x32_bf16 v[28:31], v[236:239], v[148:151], 0
  s_waitcnt lgkmcnt(10)
  v_mfma_f32_16x16x32_bf16 v[96:99], v[240:243], v[160:163], v[96:99]
  ds_read_b64_tr_b16 v[228:229], v10 offset:38656
  ds_read_b64_tr_b16 v[230:231], v10 offset:46336
  v_mfma_f32_16x16x32_bf16 v[32:35], v[240:243], v[148:151], 0
  ds_read_b64_tr_b16 v[232:233], v11 offset:38656
  ds_read_b64_tr_b16 v[234:235], v11 offset:46336
  v_mfma_f32_16x16x32_bf16 v[100:103], v[244:247], v[160:163], v[100:103]
  v_rcp_f32 v23, v188
  v_mfma_f32_16x16x32_bf16 v[36:39], v[244:247], v[148:151], 0
  s_waitcnt lgkmcnt(10)
  v_mfma_f32_16x16x32_bf16 v[104:107], v[248:251], v[160:163], v[104:107]
  ds_read_b64_tr_b16 v[236:237], v12 offset:38656
  ds_read_b64_tr_b16 v[238:239], v12 offset:46336
  v_mfma_f32_16x16x32_bf16 v[40:43], v[248:251], v[148:151], 0
  ds_read_b64_tr_b16 v[240:241], v9 offset:23040
  ds_read_b64_tr_b16 v[242:243], v9 offset:30720
  v_mfma_f32_16x16x32_bf16 v[108:111], v[252:255], v[160:163], v[108:111]
  v_mfma_f32_16x16x32_bf16 v[44:47], v[252:255], v[148:151], 0
  s_waitcnt lgkmcnt(10)
  v_mfma_f32_16x16x32_bf16 v[112:115], v[216:219], v[160:163], v[112:115]
  ds_read_b64_tr_b16 v[244:245], v10 offset:23040
  ds_read_b64_tr_b16 v[246:247], v10 offset:30720
  v_mfma_f32_16x16x32_bf16 v[48:51], v[216:219], v[148:151], 0
  ds_read_b64_tr_b16 v[248:249], v11 offset:23040
  ds_read_b64_tr_b16 v[250:251], v11 offset:30720
  v_mfma_f32_16x16x32_bf16 v[116:119], v[220:223], v[160:163], v[116:119]
  v_mfma_f32_16x16x32_bf16 v[52:55], v[220:223], v[148:151], 0
  s_waitcnt lgkmcnt(10)
  v_mfma_f32_16x16x32_bf16 v[120:123], v[224:227], v[160:163], v[120:123]
  ds_read_b64_tr_b16 v[252:253], v12 offset:23040
  ds_read_b64_tr_b16 v[254:255], v12 offset:30720
  v_mfma_f32_16x16x32_bf16 v[56:59], v[224:227], v[148:151], 0
  ds_read_b64_tr_b16 v[216:217], v9 offset:23168
  ds_read_b64_tr_b16 v[218:219], v9 offset:30848
  v_mfma_f32_16x16x32_bf16 v[124:127], v[228:231], v[160:163], v[124:127]
  v_mfma_f32_16x16x32_bf16 v[60:63], v[228:231], v[148:151], 0
  s_waitcnt lgkmcnt(10)
  v_mfma_f32_16x16x32_bf16 v[128:131], v[232:235], v[160:163], v[128:131]
  ds_read_b64_tr_b16 v[220:221], v10 offset:23168
  ds_read_b64_tr_b16 v[222:223], v10 offset:30848
  v_mfma_f32_16x16x32_bf16 v[64:67], v[232:235], v[148:151], 0
  ds_read_b64_tr_b16 v[224:225], v11 offset:23168
  ds_read_b64_tr_b16 v[226:227], v11 offset:30848
  v_mfma_f32_16x16x32_bf16 v[132:135], v[236:239], v[160:163], v[132:135]
  v_mfma_f32_16x16x32_bf16 v[68:71], v[236:239], v[148:151], 0
  s_cbranch_vccz SL35
  s_barrier
  s_mov_b32 s53, 0x400000
NPOLL:
  s_waitcnt vmcnt(0)
  v_readfirstlane_b32 s46, v13
  s_sub_u32 s53, s53, 1
  s_cselect_b32 s46, 144, s46
  s_cmp_ge_u32 s46, 144
  s_cbranch_scc1 NPOLLD
  buffer_load_dword v13, off, s[8:11], 0 sc1
  s_branch NPOLL
NPOLLD:
  s_add_u32 m0, s40, 0
  s_add_u32 s100, s40, 30720
  buffer_load_dwordx4 v1, s[20:23], s100 offen sc1 lds
  s_add_u32 m0, s40, 4096
  s_add_u32 s100, s40, 34816
  buffer_load_dwordx4 v1, s[20:23], s100 offen sc1 lds
  s_min_u32 s51, s40, 1024
  s_add_u32 m0, s51, 8192
  s_add_u32 s100, s51, 38912
  buffer_load_dwordx4 v1, s[20:23], s100 offen sc1 lds
  s_add_u32 m0, s40, 133120
  s_add_u32 s100, s40, 0
  buffer_load_dwordx4 v1, s[20:23], s100 offen sc1 lds
  s_add_u32 m0, s40, 137216
  s_add_u32 s100, s40, 4096
  buffer_load_dwordx4 v1, s[20:23], s100 offen sc1 lds
  s_add_u32 m0, s40, 141312
  s_add_u32 s100, s40, 8192
  buffer_load_dwordx4 v1, s[20:23], s100 offen sc1 lds
  s_add_u32 m0, s40, 145408
  s_add_u32 s100, s40, 12288
  buffer_load_dwordx4 v1, s[20:23], s100 offen sc1 lds
  s_add_u32 m0, s40, 149504
  s_add_u32 s100, s40, 16384
  buffer_load_dwordx4 v1, s[20:23], s100 offen sc1 lds
  s_add_u32 m0, s40, 153600
  s_add_u32 s100, s40, 20480
  buffer_load_dwordx4 v1, s[20:23], s100 offen sc1 lds
  s_add_u32 m0, s40, 157696
  s_add_u32 s100, s40, 24576
  buffer_load_dwordx4 v1, s[20:23], s100 offen sc1 lds
  s_min_u32 s51, s40, 1024
  s_add_u32 m0, s51, 161792
  s_add_u32 s100, s51, 28672
  buffer_load_dwordx4 v1, s[20:23], s100 offen sc1 lds
SL35:
  s_cbranch_vccnz SL36
  s_barrier
SL36:
  s_waitcnt lgkmcnt(10)
  v_mfma_f32_16x16x32_bf16 v[88:91], v[240:243], v[156:159], v[88:91]
  ds_read_b64_tr_b16 v[228:229], v12 offset:23168
  ds_read_b64_tr_b16 v[230:231], v12 offset:30848
  v_mfma_f32_16x16x32_bf16 v[24:27], v[240:243], v[144:147], v[24:27]
  ds_read_b64_tr_b16 v[232:233], v9 offset:23296
  ds_read_b64_tr_b16 v[234:235], v9 offset:30976
  v_mfma_f32_16x16x32_bf16 v[92:95], v[244:247], v[156:159], v[92:95]
  v_mfma_f32_16x16x32_bf16 v[28:31], v[244:247], v[144:147], v[28:31]
  s_waitcnt lgkmcnt(10)
  v_mfma_f32_16x16x32_bf16 v[96:99], v[248:251], v[156:159], v[96:99]
  ds_read_b64_tr_b16 v[236:237], v10 offset:23296
  ds_read_b64_tr_b16 v[238:239], v10 offset:30976
  v_mfma_f32_16x16x32_bf16 v[32:35], v[248:251], v[144:147], v[32:35]
  ds_read_b64_tr_b16 v[240:241], v11 offset:23296
  ds_read_b64_tr_b16 v[242:243], v11 offset:30976
  v_mfma_f32_16x16x32_bf16 v[100:103], v[252:255], v[156:159], v[100:103]
  v_mfma_f32_16x16x32_bf16 v[36:39], v[252:255], v[144:147], v[36:39]
  s_waitcnt lgkmcnt(10)
  v_mfma_f32_16x16x32_bf16 v[104:107], v[216:219], v[156:159], v[104:107]
  ds_read_b64_tr_b16 v[244:245], v12 offset:23296
  ds_read_b64_tr_b16 v[246:247], v12 offset:30976
  v_mfma_f32_16x16x32_bf16 v[40:43], v[216:219], v[144:147], v[40:43]
  ds_read_b64_tr_b16 v[248:249], v9 offset:7680
  ds_read_b64_tr_b16 v[250:251], v9 offset:15360
  v_mfma_f32_16x16x32_bf16 v[108:111], v[220:223], v[156:159], v[108:111]
  v_mfma_f32_16x16x32_bf16 v[44:47], v[220:223], v[144:147], v[44:47]
  s_waitcnt lgkmcnt(10)
  v_mfma_f32_16x16x32_bf16 v[112:115], v[224:227], v[156:159], v[112:115]
  ds_read_b64_tr_b16 v[252:253], v10 offset:7680
  ds_read_b64_tr_b16 v[254:255], v10 offset:15360
  v_mfma_f32_16x16x32_bf16 v[48:51], v[224:227], v[144:147], v[48:51]
  ds_read_b64_tr_b16 v[216:217], v11 offset:7680
  ds_read_b64_tr_b16 v[218:219], v11 offset:15360
  v_mfma_f32_16x16x32_bf16 v[116:119], v[228:231], v[156:159], v[116:119]
  v_mfma_f32_16x16x32_bf16 v[52:55], v[228:231], v[144:147], v[52:55]
  s_waitcnt lgkmcnt(10)
  v_mfma_f32_16x16x32_bf16 v[120:123], v[232:235], v[156:159], v[120:123]
  ds_read_b64_tr_b16 v[220:221], v12 offset:7680
  ds_read_b64_tr_b16 v[222:223], v12 offset:15360
  v_mfma_f32_16x16x32_bf16 v[56:59], v[232:235], v[144:147], v[56:59]
  ds_read_b64_tr_b16 v[224:225], v9 offset:7808
  ds_read_b64_tr_b16 v[226:227], v9 offset:15488
  v_mfma_f32_16x16x32_bf16 v[124:127], v[236:239], v[156:159], v[124:127]
  v_mfma_f32_16x16x32_bf16 v[60:63], v[236:239], v[144:147], v[60:63]
  s_waitcnt lgkmcnt(10)
  v_mfma_f32_16x16x32_bf16 v[128:131], v[240:243], v[156:159], v[128:131]
  ds_read_b64_tr_b16 v[228:229], v10 offset:7808
  ds_read_b64_tr_b16 v[230:231], v10 offset:15488
  v_mfma_f32_16x16x32_bf16 v[64:67], v[240:243], v[144:147], v[64:67]
  ds_read_b64_tr_b16 v[232:233], v11 offset:7808
  ds_read_b64_tr_b16 v[234:235], v11 offset:15488
  v_mfma_f32_16x16x32_bf16 v[132:135], v[244:247], v[156:159], v[132:135]
  v_mfma_f32_16x16x32_bf16 v[68:71], v[244:247], v[144:147], v[68:71]
  s_waitcnt lgkmcnt(10)
  v_mfma_f32_16x16x32_bf16 v[88:91], v[248:251], v[152:155], v[88:91]
  ds_read_b64_tr_b16 v[236:237], v12 offset:7808
  ds_read_b64_tr_b16 v[238:239], v12 offset:15488
  v_mfma_f32_16x16x32_bf16 v[24:27], v[248:251], v[140:143], v[24:27]
  ds_read_b64_tr_b16 v[240:241], v9 offset:7936
  ds_read_b64_tr_b16 v[242:243], v9 offset:15616
  v_mfma_f32_16x16x32_bf16 v[92:95], v[252:255], v[152:155], v[92:95]
  v_mfma_f32_16x16x32_bf16 v[28:31], v[252:255], v[140:143], v[28:31]
  s_waitcnt lgkmcnt(10)
  v_mfma_f32_16x16x32_bf16 v[96:99], v[216:219], v[152:155], v[96:99]
  ds_read_b64_tr_b16 v[244:245], v10 offset:7936
  ds_read_b64_tr_b16 v[246:247], v10 offset:15616
  v_mfma_f32_16x16x32_bf16 v[32:35], v[216:219], v[140:143], v[32:35]
  ds_read_b64_tr_b16 v[248:249], v11 offset:7936
  ds_read_b64_tr_b16 v[250:251], v11 offset:15616
  v_mfma_f32_16x16x32_bf16 v[100:103], v[220:223], v[152:155], v[100:103]
  v_mfma_f32_16x16x32_bf16 v[36:39], v[220:223], v[140:143], v[36:39]
  s_waitcnt lgkmcnt(10)
  v_mfma_f32_16x16x32_bf16 v[104:107], v[224:227], v[152:155], v[104:107]
  ds_read_b64_tr_b16 v[252:253], v12 offset:7936
  ds_read_b64_tr_b16 v[254:255], v12 offset:15616
  v_mfma_f32_16x16x32_bf16 v[40:43], v[224:227], v[140:143], v[40:43]
  ds_read_b64_tr_b16 v[216:217], v15 offset:0
  ds_read_b64_tr_b16 v[218:219], v9 offset:0
  v_mfma_f32_16x16x32_bf16 v[108:111], v[228:231], v[152:155], v[108:111]
  v_mfma_f32_16x16x32_bf16 v[44:47], v[228:231], v[140:143], v[44:47]
  s_waitcnt lgkmcnt(10)
  v_mfma_f32_16x16x32_bf16 v[112:115], v[232:235], v[152:155], v[112:115]
  ds_read_b64_tr_b16 v[220:221], v16 offset:0
  ds_read_b64_tr_b16 v[222:223], v10 offset:0
  v_mfma_f32_16x16x32_bf16 v[48:51], v[232:235], v[140:143], v[48:51]
  ds_read_b64_tr_b16 v[224:225], v17 offset:0
  ds_read_b64_tr_b16 v[226:227], v11 offset:0
  v_mfma_f32_16x16x32_bf16 v[116:119], v[236:239], v[152:155], v[116:119]
  v_mfma_f32_16x16x32_bf16 v[52:55], v[236:239], v[140:143], v[52:55]
  s_waitcnt lgkmcnt(10)
  v_mfma_f32_16x16x32_bf16 v[120:123], v[240:243], v[152:155], v[120:123]
  ds_read_b64_tr_b16 v[228:229], v18 offset:0
  ds_read_b64_tr_b16 v[230:231], v12 offset:0
  v_mfma_f32_16x16x32_bf16 v[56:59], v[240:243], v[140:143], v[56:59]
  ds_read_b64_tr_b16 v[232:233], v15 offset:128
  ds_read_b64_tr_b16 v[234:235], v9 offset:128
  v_mfma_f32_16x16x32_bf16 v[124:127], v[244:247], v[152:155], v[124:127]
  v_mfma_f32_16x16x32_bf16 v[60:63], v[244:247], v[140:143], v[60:63]
  s_waitcnt lgkmcnt(10)
  v_mfma_f32_16x16x32_bf16 v[128:131], v[248:251], v[152:155], v[128:131]
  ds_read_b64_tr_b16 v[236:237], v16 offset:128
  ds_read_b64_tr_b16 v[238:239], v10 offset:128
  v_mfma_f32_16x16x32_bf16 v[64:67], v[248:251], v[140:143], v[64:67]
  ds_read_b64_tr_b16 v[240:241], v17 offset:128
  ds_read_b64_tr_b16 v[242:243], v11 offset:128
  v_mfma_f32_16x16x32_bf16 v[132:135], v[252:255], v[152:155], v[132:135]
  v_mfma_f32_16x16x32_bf16 v[68:71], v[252:255], v[140:143], v[68:71]
  s_waitcnt lgkmcnt(10)
  v_mfma_f32_16x16x32_bf16 v[24:27], v[216:219], v[136:139], v[24:27]
  ds_read_b64_tr_b16 v[244:245], v18 offset:128
  ds_read_b64_tr_b16 v[246:247], v12 offset:128
  v_mfma_f32_16x16x32_bf16 v[28:31], v[220:223], v[136:139], v[28:31]
  ds_read_b64_tr_b16 v[248:249], v15 offset:256
  ds_read_b64_tr_b16 v[250:251], v9 offset:256
  s_waitcnt lgkmcnt(10)
  v_mfma_f32_16x16x32_bf16 v[32:35], v[224:227], v[136:139], v[32:35]
  ds_read_b64_tr_b16 v[252:253], v16 offset:256
  ds_read_b64_tr_b16 v[254:255], v10 offset:256
  v_mfma_f32_16x16x32_bf16 v[36:39], v[228:231], v[136:139], v[36:39]
  ds_read_b64_tr_b16 v[216:217], v17 offset:256
  ds_read_b64_tr_b16 v[218:219], v11 offset:256
  s_waitcnt lgkmcnt(10)
  v_mfma_f32_16x16x32_bf16 v[40:43], v[232:235], v[136:139], v[40:43]
  ds_read_b64_tr_b16 v[220:221], v18 offset:256
  ds_read_b64_tr_b16 v[222:223], v12 offset:256
  v_mfma_f32_16x16x32_bf16 v[44:47], v[236:239], v[136:139], v[44:47]
  v_cvt_pk_bf16_f32 v152, v88, v89
  s_waitcnt lgkmcnt(0)
  s_cbranch_vccz SL37
  s_waitcnt vmcnt(0)
  s_barrier
  s_add_u32 m0, s40, 102400
  s_add_u32 s100, s40, 40960
  buffer_load_dwordx4 v1, s[20:23], s100 offen sc1 lds
  s_add_u32 m0, s40, 106496
  s_add_u32 s100, s40, 45056
  buffer_load_dwordx4 v1, s[20:23], s100 offen sc1 lds
  s_add_u32 m0, s40, 110592
  s_add_u32 s100, s40, 49152
  buffer_load_dwordx4 v1, s[20:23], s100 offen sc1 lds
  s_add_u32 m0, s40, 114688
  s_add_u32 s100, s40, 53248
  buffer_load_dwordx4 v1, s[20:23], s100 offen sc1 lds
  s_add_u32 m0, s40, 118784
  s_add_u32 s100, s40, 57344
  buffer_load_dwordx4 v1, s[20:23], s100 offen sc1 lds
  s_add_u32 m0, s40, 122880
  s_add_u32 s100, s40, 61440
  buffer_load_dwordx4 v1, s[20:23], s100 offen sc1 lds
  s_add_u32 m0, s40, 126976
  s_add_u32 s100, s40, 65536
  buffer_load_dwordx4 v1, s[20:23], s100 offen sc1 lds
  s_min_u32 s51, s40, 1024
  s_add_u32 m0, s51, 131072
  s_add_u32 s100, s51, 69632
  buffer_load_dwordx4 v1, s[20:23], s100 offen sc1 lds
SL37:
  ds_read_b128 v[224:227], v2 offset:30720
  ds_read_b128 v[228:231], v2 offset:31744
  ds_read_b128 v[232:235], v2 offset:32768
  ds_read_b128 v[236:239], v2 offset:33792
  v_mfma_f32_16x16x32_bf16 v[48:51], v[240:243], v[136:139], v[48:51]
  ds_read_b128 v[240:243], v2 offset:34816
  v_cvt_pk_bf16_f32 v153, v90, v91
  v_mfma_f32_16x16x32_bf16 v[52:55], v[244:247], v[136:139], v[52:55]
  ds_read_b128 v[244:247], v2 offset:35840
  v_cvt_pk_bf16_f32 v154, v92, v93
  v_mfma_f32_16x16x32_bf16 v[56:59], v[248:251], v[136:139], v[56:59]
  ds_read_b128 v[248:251], v2 offset:36864
  v_cvt_pk_bf16_f32 v155, v94, v95
  v_mfma_f32_16x16x32_bf16 v[60:63], v[252:255], v[136:139], v[60:63]
  ds_read_b128 v[252:255], v2 offset:37888
  v_cvt_pk_bf16_f32 v156, v96, v97
  v_mfma_f32_16x16x32_bf16 v[64:67], v[216:219], v[136:139], v[64:67]
  ds_read_b128 v[216:219], v2 offset:38912
  v_cvt_pk_bf16_f32 v157, v98, v99
  v_mfma_f32_16x16x32_bf16 v[68:71], v[220:223], v[136:139], v[68:71]
  ds_read_b128 v[220:223], v2 offset:39936
  v_cvt_pk_bf16_f32 v158, v100, v101
  v_cvt_pk_bf16_f32 v159, v102, v103
  v_cvt_pk_bf16_f32 v160, v104, v105
  v_cvt_pk_bf16_f32 v161, v106, v107
  v_cvt_pk_bf16_f32 v162, v108, v109
  v_cvt_pk_bf16_f32 v163, v110, v111
  v_cvt_pk_bf16_f32 v164, v112, v113
  v_cvt_pk_bf16_f32 v165, v114, v115
  v_cvt_pk_bf16_f32 v166, v116, v117
  v_cvt_pk_bf16_f32 v167, v118, v119
  v_cvt_pk_bf16_f32 v176, v120, v121
  v_cvt_pk_bf16_f32 v177, v122, v123
  v_cvt_pk_bf16_f32 v178, v124, v125
  v_cvt_pk_bf16_f32 v179, v126, v127
  v_cvt_pk_bf16_f32 v180, v128, v129
  v_cvt_pk_bf16_f32 v181, v130, v131
  v_cvt_pk_bf16_f32 v182, v132, v133
  v_cvt_pk_bf16_f32 v183, v134, v135
  v_cvt_pk_bf16_f32 v136, v24, v25
  v_cvt_pk_bf16_f32 v137, v26, v27
  v_cvt_pk_bf16_f32 v138, v28, v29
  v_cvt_pk_bf16_f32 v139, v30, v31
  v_cvt_pk_bf16_f32 v140, v32, v33
  v_cvt_pk_bf16_f32 v141, v34, v35
  v_cvt_pk_bf16_f32 v142, v36, v37
  v_cvt_pk_bf16_f32 v143, v38, v39
  v_cvt_pk_bf16_f32 v144, v40, v41
  v_cvt_pk_bf16_f32 v145, v42, v43
  v_cvt_pk_bf16_f32 v146, v44, v45
  v_cvt_pk_bf16_f32 v147, v46, v47
  v_cvt_pk_bf16_f32 v148, v48, v49
  v_cvt_pk_bf16_f32 v149, v50, v51
  v_cvt_pk_bf16_f32 v150, v52, v53
  v_cvt_pk_bf16_f32 v151, v54, v55
  v_cvt_pk_bf16_f32 v168, v56, v57
  v_cvt_pk_bf16_f32 v169, v58, v59
  v_cvt_pk_bf16_f32 v170, v60, v61
  v_cvt_pk_bf16_f32 v171, v62, v63
  v_cvt_pk_bf16_f32 v172, v64, v65
  v_cvt_pk_bf16_f32 v173, v66, v67
  v_cvt_pk_bf16_f32 v174, v68, v69
  v_cvt_pk_bf16_f32 v175, v70, v71
  s_mov_b32 s100, 71680
  buffer_load_dwordx4 v[40:43], v1, s[20:23], s100 offen offset:0 sc1
  buffer_load_dwordx4 v[44:47], v1, s[20:23], s100 offen offset:1024 sc1
  s_waitcnt lgkmcnt(8)
  v_mfma_f32_16x16x32_bf16 v[184:187], v[224:227], v[136:139], 0
  v_mfma_f32_16x16x32_bf16 v[192:195], v[224:227], v[152:155], 0
  ds_read_b128 v[224:227], v2 offset:40960
  v_mfma_f32_16x16x32_bf16 v[188:191], v[228:231], v[136:139], 0
  v_mfma_f32_16x16x32_bf16 v[196:199], v[228:231], v[152:155], 0
  ds_read_b128 v[228:231], v2 offset:41984
  s_waitcnt lgkmcnt(8)
  v_mfma_f32_16x16x32_bf16 v[184:187], v[232:235], v[140:143], v[184:187]
  v_mfma_f32_16x16x32_bf16 v[192:195], v[232:235], v[156:159], v[192:195]
  ds_read_b128 v[232:235], v2 offset:43008
  v_mfma_f32_16x16x32_bf16 v[188:191], v[236:239], v[140:143], v[188:191]
  v_mfma_f32_16x16x32_bf16 v[196:199], v[236:239], v[156:159], v[196:199]
  ds_read_b128 v[236:239], v2 offset:44032
  s_waitcnt lgkmcnt(8)
  v_mfma_f32_16x16x32_bf16 v[184:187], v[240:243], v[144:147], v[184:187]
  v_mfma_f32_16x16x32_bf16 v[192:195], v[240:243], v[160:163], v[192:195]
  ds_read_b128 v[240:243], v2 offset:45056
  v_mfma_f32_16x16x32_bf16 v[188:191], v[244:247], v[144:147], v[188:191]
  v_mfma_f32_16x16x32_bf16 v[196:199], v[244:247], v[160:163], v[196:199]
  ds_read_b128 v[244:247], v2 offset:46080
  s_waitcnt lgkmcnt(8)
  v_mfma_f32_16x16x32_bf16 v[184:187], v[248:251], v[148:151], v[184:187]
  v_mfma_f32_16x16x32_bf16 v[192:195], v[248:251], v[164:167], v[192:195]
  ds_read_b128 v[248:251], v2 offset:47104
  v_mfma_f32_16x16x32_bf16 v[188:191], v[252:255], v[148:151], v[188:191]
  v_mfma_f32_16x16x32_bf16 v[196:199], v[252:255], v[164:167], v[196:199]
  ds_read_b128 v[252:255], v2 offset:48128
  s_waitcnt lgkmcnt(8)
  v_mfma_f32_16x16x32_bf16 v[184:187], v[216:219], v[168:171], v[184:187]
  v_mfma_f32_16x16x32_bf16 v[192:195], v[216:219], v[176:179], v[192:195]
  ds_read_b128 v[216:219], v2 offset:49152
  v_mfma_f32_16x16x32_bf16 v[188:191], v[220:223], v[168:171], v[188:191]
  v_mfma_f32_16x16x32_bf16 v[196:199], v[220:223], v[176:179], v[196:199]
  ds_read_b128 v[220:223], v2 offset:50176
  s_waitcnt lgkmcnt(8)
  v_mfma_f32_16x16x32_bf16 v[184:187], v[224:227], v[172:175], v[184:187]
  v_mfma_f32_16x16x32_bf16 v[192:195], v[224:227], v[180:183], v[192:195]
  ds_read_b128 v[224:227], v2 offset:51200
  v_mfma_f32_16x16x32_bf16 v[188:191], v[228:231], v[172:175], v[188:191]
  v_mfma_f32_16x16x32_bf16 v[196:199], v[228:231], v[180:183], v[196:199]
  ds_read_b128 v[228:231], v2 offset:52224
  s_waitcnt lgkmcnt(8)
  v_mfma_f32_16x16x32_bf16 v[200:203], v[232:235], v[136:139], 0
  v_mfma_f32_16x16x32_bf16 v[208:211], v[232:235], v[152:155], 0
  ds_read_b128 v[232:235], v2 offset:53248
  v_mul_f32 v184, v184, v22
  v_mfma_f32_16x16x32_bf16 v[204:207], v[236:239], v[136:139], 0
  v_mul_f32 v185, v185, v22
  v_mul_f32 v186, v186, v22
  v_mfma_f32_16x16x32_bf16 v[212:215], v[236:239], v[152:155], 0
  ds_read_b128 v[236:239], v2 offset:54272
  s_waitcnt lgkmcnt(8)
  v_mfma_f32_16x16x32_bf16 v[200:203], v[240:243], v[140:143], v[200:203]
  v_mul_f32 v187, v187, v22
  v_mul_f32 v188, v188, v22
  v_mfma_f32_16x16x32_bf16 v[208:211], v[240:243], v[156:159], v[208:211]
  ds_read_b128 v[240:243], v2 offset:55296
  v_mul_f32 v189, v189, v22
  v_mfma_f32_16x16x32_bf16 v[204:207], v[244:247], v[140:143], v[204:207]
  v_mul_f32 v190, v190, v22
  v_mul_f32 v191, v191, v22
  v_mfma_f32_16x16x32_bf16 v[212:215], v[244:247], v[156:159], v[212:215]
  ds_read_b128 v[244:247], v2 offset:56320
  s_waitcnt lgkmcnt(8)
  v_mfma_f32_16x16x32_bf16 v[200:203], v[248:251], v[144:147], v[200:203]
  v_cvt_pk_bf16_f32 v24, v184, v185
  v_cvt_pk_bf16_f32 v25, v186, v187
  v_mfma_f32_16x16x32_bf16 v[208:211], v[248:251], v[160:163], v[208:211]
  ds_read_b128 v[248:251], v2 offset:57344
  v_cvt_pk_bf16_f32 v26, v188, v189
  v_mfma_f32_16x16x32_bf16 v[204:207], v[252:255], v[144:147], v[204:207]
  v_cvt_pk_bf16_f32 v27, v190, v191
  buffer_store_dwordx4 v[24:27], v5, s[16:19], 0 offen offset:0 nt sc1
  v_mfma_f32_16x16x32_bf16 v[212:215], v[252:255], v[160:163], v[212:215]
  ds_read_b128 v[252:255], v2 offset:58368
  s_waitcnt lgkmcnt(8)
  v_mfma_f32_16x16x32_bf16 v[200:203], v[216:219], v[148:151], v[200:203]
  v_mul_f32 v192, v192, v23
  v_mul_f32 v193, v193, v23
  v_mfma_f32_16x16x32_bf16 v[208:211], v[216:219], v[164:167], v[208:211]
  ds_read_b128 v[216:219], v2 offset:59392
  v_mul_f32 v194, v194, v23
  v_mfma_f32_16x16x32_bf16 v[204:207], v[220:223], v[148:151], v[204:207]
  v_mul_f32 v195, v195, v23
  v_mul_f32 v196, v196, v23
  v_mfma_f32_16x16x32_bf16 v[212:215], v[220:223], v[164:167], v[212:215]
  ds_read_b128 v[220:223], v2 offset:60416
  s_waitcnt lgkmcnt(8)
  v_mfma_f32_16x16x32_bf16 v[200:203], v[224:227], v[168:171], v[200:203]
  v_mul_f32 v197, v197, v23
  v_mul_f32 v198, v198, v23
  v_mfma_f32_16x16x32_bf16 v[208:211], v[224:227], v[176:179], v[208:211]
  ds_read_b128 v[224:227], v1 offset:0
  v_mul_f32 v199, v199, v23
  v_mfma_f32_16x16x32_bf16 v[204:207], v[228:231], v[168:171], v[204:207]
  v_cvt_pk_bf16_f32 v28, v192, v193
  v_cvt_pk_bf16_f32 v29, v194, v195
  v_mfma_f32_16x16x32_bf16 v[212:215], v[228:231], v[176:179], v[212:215]
  ds_read_b128 v[228:231], v1 offset:1024
  s_waitcnt lgkmcnt(8)
  v_mfma_f32_16x16x32_bf16 v[200:203], v[232:235], v[172:175], v[200:203]
  v_cvt_pk_bf16_f32 v30, v196, v197
  v_cvt_pk_bf16_f32 v31, v198, v199
  v_mfma_f32_16x16x32_bf16 v[208:211], v[232:235], v[180:183], v[208:211]
  ds_read_b128 v[232:235], v1 offset:2048
  buffer_store_dwordx4 v[28:31], v6, s[16:19], 0 offen offset:0 nt sc1
  v_mfma_f32_16x16x32_bf16 v[204:207], v[236:239], v[172:175], v[204:207]
  v_mfma_f32_16x16x32_bf16 v[212:215], v[236:239], v[180:183], v[212:215]
  ds_read_b128 v[236:239], v1 offset:3072
  s_cbranch_vccz SL38
  s_waitcnt vmcnt(4)
  s_barrier
SL38:
  s_waitcnt lgkmcnt(8)
  v_mfma_f32_16x16x32_bf16 v[184:187], v[240:243], v[136:139], 0
  v_mul_f32 v200, v200, v22
  v_mul_f32 v201, v201, v22
  v_mfma_f32_16x16x32_bf16 v[192:195], v[240:243], v[152:155], 0
  ds_read_b128 v[240:243], v1 offset:4096
  v_mul_f32 v202, v202, v22
  v_mfma_f32_16x16x32_bf16 v[188:191], v[244:247], v[136:139], 0
  v_mul_f32 v203, v203, v22
  v_mul_f32 v204, v204, v22
  v_mfma_f32_16x16x32_bf16 v[196:199], v[244:247], v[152:155], 0
  ds_read_b128 v[244:247], v1 offset:5120
  s_waitcnt lgkmcnt(8)
  v_mfma_f32_16x16x32_bf16 v[184:187], v[248:251], v[140:143], v[184:187]
  v_mul_f32 v205, v205, v22
  v_mul_f32 v206, v206, v22
  v_mfma_f32_16x16x32_bf16 v[192:195], v[248:251], v[156:159], v[192:195]
  ds_read_b128 v[248:251], v1 offset:6144
  v_mul_f32 v207, v207, v22
  v_mfma_f32_16x16x32_bf16 v[188:191], v[252:255], v[140:143], v[188:191]
  v_cvt_pk_bf16_f32 v32, v200, v201
  v_cvt_pk_bf16_f32 v33, v202, v203
  v_mfma_f32_16x16x32_bf16 v[196:199], v[252:255], v[156:159], v[196:199]
  ds_read_b128 v[252:255], v1 offset:7168
  s_waitcnt lgkmcnt(8)
  v_mfma_f32_16x16x32_bf16 v[184:187], v[216:219], v[144:147], v[184:187]
  v_cvt_pk_bf16_f32 v34, v204, v205
  v_cvt_pk_bf16_f32 v35, v206, v207
  v_mfma_f32_16x16x32_bf16 v[192:195], v[216:219], v[160:163], v[192:195]
  ds_read_b128 v[216:219], v1 offset:8192
  buffer_store_dwordx4 v[32:35], v5, s[16:19], 0 offen offset:64 nt sc1
  v_mfma_f32_16x16x32_bf16 v[188:191], v[220:223], v[144:147], v[188:191]
  v_mul_f32 v208, v208, v23
  v_mul_f32 v209, v209, v23
  v_mfma_f32_16x16x32_bf16 v[196:199], v[220:223], v[160:163], v[196:199]
  ds_read_b128 v[220:223], v1 offset:9216
  s_waitcnt lgkmcnt(8)
  v_mfma_f32_16x16x32_bf16 v[184:187], v[224:227], v[148:151], v[184:187]
  v_mul_f32 v210, v210, v23
  v_mul_f32 v211, v211, v23
  v_mfma_f32_16x16x32_bf16 v[192:195], v[224:227], v[164:167], v[192:195]
  ds_read_b128 v[224:227], v2 offset:0
  v_mul_f32 v212, v212, v23
  v_mfma_f32_16x16x32_bf16 v[188:191], v[228:231], v[148:151], v[188:191]
  v_mul_f32 v213, v213, v23
  v_mul_f32 v214, v214, v23
  v_mfma_f32_16x16x32_bf16 v[196:199], v[228:231], v[164:167], v[196:199]
  ds_read_b128 v[228:231], v2 offset:1024
  s_waitcnt lgkmcnt(8)
  v_mfma_f32_16x16x32_bf16 v[184:187], v[232:235], v[168:171], v[184:187]
  v_mul_f32 v215, v215, v23
  v_cvt_pk_bf16_f32 v36, v208, v209
  v_mfma_f32_16x16x32_bf16 v[192:195], v[232:235], v[176:179], v[192:195]
  ds_read_b128 v[232:235], v2 offset:2048
  v_cvt_pk_bf16_f32 v37, v210, v211
  v_mfma_f32_16x16x32_bf16 v[188:191], v[236:239], v[168:171], v[188:191]
  v_cvt_pk_bf16_f32 v38, v212, v213
  v_cvt_pk_bf16_f32 v39, v214, v215
  v_mfma_f32_16x16x32_bf16 v[196:199], v[236:239], v[176:179], v[196:199]
  ds_read_b128 v[236:239], v2 offset:3072
  s_waitcnt lgkmcnt(8)
  v_mfma_f32_16x16x32_bf16 v[184:187], v[240:243], v[172:175], v[184:187]
  buffer_store_dwordx4 v[36:39], v6, s[16:19], 0 offen offset:64 nt sc1
  v_mfma_f32_16x16x32_bf16 v[192:195], v[240:243], v[180:183], v[192:195]
  ds_read_b128 v[240:243], v2 offset:4096
  v_mfma_f32_16x16x32_bf16 v[188:191], v[244:247], v[172:175], v[188:191]
  v_mfma_f32_16x16x32_bf16 v[196:199], v[244:247], v[180:183], v[196:199]
  ds_read_b128 v[244:247], v2 offset:5120
  s_waitcnt lgkmcnt(8)
  v_mfma_f32_16x16x32_bf16 v[200:203], v[248:251], v[136:139], 0
  v_mul_f32 v184, v184, v22
  v_mul_f32 v185, v185, v22
  v_mfma_f32_16x16x32_bf16 v[208:211], v[248:251], v[152:155], 0
  ds_read_b128 v[248:251], v2 offset:6144
  v_mul_f32 v186, v186, v22
  v_mfma_f32_16x16x32_bf16 v[204:207], v[252:255], v[136:139], 0
  v_mul_f32 v187, v187, v22
  v_mul_f32 v188, v188, v22
  v_mfma_f32_16x16x32_bf16 v[212:215], v[252:255], v[152:155], 0
  ds_read_b128 v[252:255], v2 offset:7168
  s_waitcnt lgkmcnt(8)
  v_mfma_f32_16x16x32_bf16 v[200:203], v[216:219], v[140:143], v[200:203]
  v_mul_f32 v189, v189, v22
  v_mul_f32 v190, v190, v22
  v_mfma_f32_16x16x32_bf16 v[208:211], v[216:219], v[156:159], v[208:211]
  ds_read_b128 v[216:219], v2 offset:8192
  v_mul_f32 v191, v191, v22
  v_mfma_f32_16x16x32_bf16 v[204:207], v[220:223], v[140:143], v[204:207]
  v_cvt_pk_bf16_f32 v24, v184, v185
  v_cvt_pk_bf16_f32 v25, v186, v187
  v_mfma_f32_16x16x32_bf16 v[212:215], v[220:223], v[156:159], v[212:215]
  ds_read_b128 v[220:223], v2 offset:9216
  s_waitcnt lgkmcnt(8)
  v_mfma_f32_16x16x32_bf16 v[200:203], v[224:227], v[144:147], v[200:203]
  v_cvt_pk_bf16_f32 v26, v188, v189
  v_cvt_pk_bf16_f32 v27, v190, v191
  v_mfma_f32_16x16x32_bf16 v[208:211], v[224:227], v[160:163], v[208:211]
  ds_read_b128 v[224:227], v2 offset:10240
  buffer_store_dwordx4 v[24:27], v5, s[16:19], 0 offen offset:128 nt sc1
  v_mfma_f32_16x16x32_bf16 v[204:207], v[228:231], v[144:147], v[204:207]
  v_mul_f32 v192, v192, v23
  v_mul_f32 v193, v193, v23
  v_mfma_f32_16x16x32_bf16 v[212:215], v[228:231], v[160:163], v[212:215]
  ds_read_b128 v[228:231], v2 offset:11264
  s_waitcnt lgkmcnt(8)
  v_mfma_f32_16x16x32_bf16 v[200:203], v[232:235], v[148:151], v[200:203]
  v_mul_f32 v194, v194, v23
  v_mul_f32 v195, v195, v23
  v_mfma_f32_16x16x32_bf16 v[208:211], v[232:235], v[164:167], v[208:211]
  ds_read_b128 v[232:235], v2 offset:12288
  v_mul_f32 v196, v196, v23
  v_mfma_f32_16x16x32_bf16 v[204:207], v[236:239], v[148:151], v[204:207]
  v_mul_f32 v197, v197, v23
  v_mul_f32 v198, v198, v23
  v_mfma_f32_16x16x32_bf16 v[212:215], v[236:239], v[164:167], v[212:215]
  ds_read_b128 v[236:239], v2 offset:13312
  s_waitcnt lgkmcnt(8)
  v_mfma_f32_16x16x32_bf16 v[200:203], v[240:243], v[168:171], v[200:203]
  v_mul_f32 v199, v199, v23
  v_cvt_pk_bf16_f32 v28, v192, v193
  v_mfma_f32_16x16x32_bf16 v[208:211], v[240:243], v[176:179], v[208:211]
  ds_read_b128 v[240:243], v2 offset:14336
  v_cvt_pk_bf16_f32 v29, v194, v195
  v_mfma_f32_16x16x32_bf16 v[204:207], v[244:247], v[168:171], v[204:207]
  v_cvt_pk_bf16_f32 v30, v196, v197
  v_cvt_pk_bf16_f32 v31, v198, v199
  v_mfma_f32_16x16x32_bf16 v[212:215], v[244:247], v[176:179], v[212:215]
  ds_read_b128 v[244:247], v2 offset:15360
  s_waitcnt lgkmcnt(8)
  v_mfma_f32_16x16x32_bf16 v[200:203], v[248:251], v[172:175], v[200:203]
  buffer_store_dwordx4 v[28:31], v6, s[16:19], 0 offen offset:128 nt sc1
  v_mfma_f32_16x16x32_bf16 v[208:211], v[248:251], v[180:183], v[208:211]
  ds_read_b128 v[248:251], v2 offset:16384
  v_mfma_f32_16x16x32_bf16 v[204:207], v[252:255], v[172:175], v[204:207]
  v_mfma_f32_16x16x32_bf16 v[212:215], v[252:255], v[180:183], v[212:215]
  ds_read_b128 v[252:255], v2 offset:17408
  s_waitcnt lgkmcnt(8)
  v_mfma_f32_16x16x32_bf16 v[184:187], v[216:219], v[136:139], 0
  v_mul_f32 v200, v200, v22
  v_mul_f32 v201, v201, v22
  v_mfma_f32_16x16x32_bf16 v[192:195], v[216:219], v[152:155], 0
  ds_read_b128 v[216:219], v2 offset:18432
  v_mul_f32 v202, v202, v22
  v_mfma_f32_16x16x32_bf16 v[188:191], v[220:223], v[136:139], 0
  v_mul_f32 v203, v203, v22
  v_mul_f32 v204, v204, v22
  v_mfma_f32_16x16x32_bf16 v[196:199], v[220:223], v[152:155], 0
  ds_read_b128 v[220:223], v2 offset:19456
  s_waitcnt lgkmcnt(8)
  v_mfma_f32_16x16x32_bf16 v[184:187], v[224:227], v[140:143], v[184:187]
  v_mul_f32 v205, v205, v22
  v_mul_f32 v206, v206, v22
  v_mfma_f32_16x16x32_bf16 v[192:195], v[224:227], v[156:159], v[192:195]
  ds_read_b128 v[224:227], v2 offset:20480
  v_mul_f32 v207, v207, v22
  v_mfma_f32_16x16x32_bf16 v[188:191], v[228:231], v[140:143], v[188:191]
  v_cvt_pk_bf16_f32 v32, v200, v201
  v_cvt_pk_bf16_f32 v33, v202, v203
  v_mfma_f32_16x16x32_bf16 v[196:199], v[228:231], v[156:159], v[196:199]
  ds_read_b128 v[228:231], v2 offset:21504
  s_waitcnt lgkmcnt(8)
  v_mfma_f32_16x16x32_bf16 v[184:187], v[232:235], v[144:147], v[184:187]
  v_cvt_pk_bf16_f32 v34, v204, v205
  v_cvt_pk_bf16_f32 v35, v206, v207
  v_mfma_f32_16x16x32_bf16 v[192:195], v[232:235], v[160:163], v[192:195]
  ds_read_b128 v[232:235], v2 offset:22528
  buffer_store_dwordx4 v[32:35], v5, s[16:19], 0 offen offset:192 nt sc1
  v_mfma_f32_16x16x32_bf16 v[188:191], v[236:239], v[144:147], v[188:191]
  v_mul_f32 v208, v208, v23
  v_mul_f32 v209, v209, v23
  v_mfma_f32_16x16x32_bf16 v[196:199], v[236:239], v[160:163], v[196:199]
  ds_read_b128 v[236:239], v2 offset:23552
  s_waitcnt lgkmcnt(8)
  v_mfma_f32_16x16x32_bf16 v[184:187], v[240:243], v[148:151], v[184:187]
  v_mul_f32 v210, v210, v23
  v_mul_f32 v211, v211, v23
  v_mfma_f32_16x16x32_bf16 v[192:195], v[240:243], v[164:167], v[192:195]
  ds_read_b128 v[240:243], v2 offset:24576
  v_mul_f32 v212, v212, v23
  v_mfma_f32_16x16x32_bf16 v[188:191], v[244:247], v[148:151], v[188:191]
  v_mul_f32 v213, v213, v23
  v_mul_f32 v214, v214, v23
  v_mfma_f32_16x16x32_bf16 v[196:199], v[244:247], v[164:167], v[196:199]
  ds_read_b128 v[244:247], v2 offset:25600
  s_waitcnt lgkmcnt(8)
  v_mfma_f32_16x16x32_bf16 v[184:187], v[248:251], v[168:171], v[184:187]
  v_mul_f32 v215, v215, v23
  v_cvt_pk_bf16_f32 v36, v208, v209
  v_mfma_f32_16x16x32_bf16 v[192:195], v[248:251], v[176:179], v[192:195]
  ds_read_b128 v[248:251], v2 offset:26624
  v_cvt_pk_bf16_f32 v37, v210, v211
  v_mfma_f32_16x16x32_bf16 v[188:191], v[252:255], v[168:171], v[188:191]
  v_cvt_pk_bf16_f32 v38, v212, v213
  v_cvt_pk_bf16_f32 v39, v214, v215
  v_mfma_f32_16x16x32_bf16 v[196:199], v[252:255], v[176:179], v[196:199]
  ds_read_b128 v[252:255], v2 offset:27648
  s_waitcnt lgkmcnt(8)
  v_mfma_f32_16x16x32_bf16 v[184:187], v[216:219], v[172:175], v[184:187]
  buffer_store_dwordx4 v[36:39], v6, s[16:19], 0 offen offset:192 nt sc1
  v_mfma_f32_16x16x32_bf16 v[192:195], v[216:219], v[180:183], v[192:195]
  ds_read_b128 v[216:219], v2 offset:28672
  v_mfma_f32_16x16x32_bf16 v[188:191], v[220:223], v[172:175], v[188:191]
  v_mfma_f32_16x16x32_bf16 v[196:199], v[220:223], v[180:183], v[196:199]
  ds_read_b128 v[220:223], v2 offset:29696
  s_waitcnt vmcnt(8)
  s_waitcnt lgkmcnt(8)
  v_mfma_f32_16x16x32_bf16 v[200:203], v[224:227], v[136:139], 0
  v_mul_f32 v184, v184, v22
  v_mul_f32 v185, v185, v22
  v_mfma_f32_16x16x32_bf16 v[208:211], v[224:227], v[152:155], 0
  v_mul_f32 v186, v186, v22
  v_mul_f32 v187, v187, v22
  v_mfma_f32_16x16x32_bf16 v[204:207], v[228:231], v[136:139], 0
  v_mul_f32 v188, v188, v22
  v_mul_f32 v189, v189, v22
  v_mfma_f32_16x16x32_bf16 v[212:215], v[228:231], v[152:155], 0
  v_mul_f32 v190, v190, v22
  s_waitcnt lgkmcnt(6)
  v_mfma_f32_16x16x32_bf16 v[200:203], v[232:235], v[140:143], v[200:203]
  v_mul_f32 v191, v191, v22
  v_cvt_pk_bf16_f32 v24, v184, v185
  v_mfma_f32_16x16x32_bf16 v[208:211], v[232:235], v[156:159], v[208:211]
  v_cvt_pk_bf16_f32 v25, v186, v187
  v_cvt_pk_bf16_f32 v26, v188, v189
  v_mfma_f32_16x16x32_bf16 v[204:207], v[236:239], v[140:143], v[204:207]
  v_cvt_pk_bf16_f32 v27, v190, v191
  buffer_store_dwordx4 v[24:27], v5, s[16:19], 0 offen offset:256 nt sc1
  v_mfma_f32_16x16x32_bf16 v[212:215], v[236:239], v[156:159], v[212:215]
  v_mul_f32 v192, v192, v23
  s_waitcnt lgkmcnt(5)
  v_mfma_f32_16x16x32_bf16 v[200:203], v[240:243], v[144:147], v[200:203]
  v_mul_f32 v193, v193, v23
  v_mul_f32 v194, v194, v23
  v_mfma_f32_16x16x32_bf16 v[208:211], v[240:243], v[160:163], v[208:211]
  v_mul_f32 v195, v195, v23
  s_waitcnt lgkmcnt(4)
  v_mfma_f32_16x16x32_bf16 v[204:207], v[244:247], v[144:147], v[204:207]
  v_mul_f32 v196, v196, v23
  v_mul_f32 v197, v197, v23
  v_mfma_f32_16x16x32_bf16 v[212:215], v[244:247], v[160:163], v[212:215]
  v_mul_f32 v198, v198, v23
  s_waitcnt lgkmcnt(3)
  v_mfma_f32_16x16x32_bf16 v[200:203], v[248:251], v[148:151], v[200:203]
  v_mul_f32 v199, v199, v23
  v_cvt_pk_bf16_f32 v28, v192, v193
  v_mfma_f32_16x16x32_bf16 v[208:211], v[248:251], v[164:167], v[208:211]
  v_cvt_pk_bf16_f32 v29, v194, v195
  s_waitcnt lgkmcnt(2)
  v_mfma_f32_16x16x32_bf16 v[204:207], v[252:255], v[148:151], v[204:207]
  v_cvt_pk_bf16_f32 v30, v196, v197
  v_cvt_pk_bf16_f32 v31, v198, v199
  v_mfma_f32_16x16x32_bf16 v[212:215], v[252:255], v[164:167], v[212:215]
  buffer_store_dwordx4 v[28:31], v6, s[16:19], 0 offen offset:256 nt sc1
  s_waitcnt lgkmcnt(1)
  v_mfma_f32_16x16x32_bf16 v[200:203], v[216:219], v[168:171], v[200:203]
  v_mfma_f32_16x16x32_bf16 v[208:211], v[216:219], v[176:179], v[208:211]
  s_waitcnt lgkmcnt(0)
  v_mfma_f32_16x16x32_bf16 v[204:207], v[220:223], v[168:171], v[204:207]
  v_mfma_f32_16x16x32_bf16 v[212:215], v[220:223], v[176:179], v[212:215]
  v_mfma_f32_16x16x32_bf16 v[200:203], v[40:43], v[172:175], v[200:203]
  v_mfma_f32_16x16x32_bf16 v[208:211], v[40:43], v[180:183], v[208:211]
  v_mfma_f32_16x16x32_bf16 v[204:207], v[44:47], v[172:175], v[204:207]
  v_mfma_f32_16x16x32_bf16 v[212:215], v[44:47], v[180:183], v[212:215]
  s_nop 4
  v_mul_f32 v200, v200, v22
  v_mul_f32 v201, v201, v22
  v_mul_f32 v202, v202, v22
  v_mul_f32 v203, v203, v22
  v_mul_f32 v204, v204, v22
  v_mul_f32 v205, v205, v22
  v_mul_f32 v206, v206, v22
  v_mul_f32 v207, v207, v22
  v_cvt_pk_bf16_f32 v32, v200, v201
  v_cvt_pk_bf16_f32 v33, v202, v203
  v_cvt_pk_bf16_f32 v34, v204, v205
  v_cvt_pk_bf16_f32 v35, v206, v207
  buffer_store_dwordx4 v[32:35], v5, s[16:19], 0 offen offset:320 nt sc1
  v_mul_f32 v208, v208, v23
  v_mul_f32 v209, v209, v23
  v_mul_f32 v210, v210, v23
  v_mul_f32 v211, v211, v23
  v_mul_f32 v212, v212, v23
  v_mul_f32 v213, v213, v23
  v_mul_f32 v214, v214, v23
  v_mul_f32 v215, v215, v23
  v_cvt_pk_bf16_f32 v36, v208, v209
  v_cvt_pk_bf16_f32 v37, v210, v211
  v_cvt_pk_bf16_f32 v38, v212, v213
  v_cvt_pk_bf16_f32 v39, v214, v215
  buffer_store_dwordx4 v[36:39], v6, s[16:19], 0 offen offset:320 nt sc1
MK_done:
  s_endpgm
FB0:
  s_nop 7
  v_max3_f32 v22, v24, v25, v26
  v_max3_f32 v22, v22, v27, v28
  v_max3_f32 v22, v22, v29, v30
  v_max3_f32 v22, v22, v31, v32
  v_max3_f32 v22, v22, v33, v34
  v_max3_f32 v22, v22, v35, v36
  v_max3_f32 v22, v22, v37, v38
  v_max3_f32 v22, v22, v39, v40
  v_max3_f32 v22, v22, v41, v42
  v_max3_f32 v22, v22, v43, v44
  v_max3_f32 v22, v22, v45, v46
  v_max3_f32 v22, v22, v47, v48
  v_max3_f32 v22, v22, v49, v50
  v_max3_f32 v22, v22, v51, v52
  v_max3_f32 v22, v22, v53, v54
  s_mov_b32 s52, 0xff7fffff
  v_max3_f32 v22, v22, v55, s52
  v_mov_b32 v23, v22
  s_nop 1
  v_permlane32_swap_b32 v22, v23
  s_nop 1
  v_max_f32 v22, v22, v23
  v_mov_b32 v23, v22
  s_nop 1
  v_permlane16_swap_b32 v22, v23
  s_nop 1
  v_max_f32 v22, v22, v23
  v_sub_f32 v24, v24, v22
  v_sub_f32 v25, v25, v22
  v_sub_f32 v26, v26, v22
  v_sub_f32 v27, v27, v22
  v_sub_f32 v28, v28, v22
  v_sub_f32 v29, v29, v22
  v_sub_f32 v30, v30, v22
  v_sub_f32 v31, v31, v22
  v_sub_f32 v32, v32, v22
  v_sub_f32 v33, v33, v22
  v_sub_f32 v34, v34, v22
  v_sub_f32 v35, v35, v22
  v_sub_f32 v36, v36, v22
  v_sub_f32 v37, v37, v22
  v_sub_f32 v38, v38, v22
  v_sub_f32 v39, v39, v22
  v_sub_f32 v40, v40, v22
  v_sub_f32 v41, v41, v22
  v_sub_f32 v42, v42, v22
  v_sub_f32 v43, v43, v22
  v_sub_f32 v44, v44, v22
  v_sub_f32 v45, v45, v22
  v_sub_f32 v46, v46, v22
  v_sub_f32 v47, v47, v22
  v_sub_f32 v48, v48, v22
  v_sub_f32 v49, v49, v22
  v_sub_f32 v50, v50, v22
  v_sub_f32 v51, v51, v22
  v_sub_f32 v52, v52, v22
  v_sub_f32 v53, v53, v22
  v_sub_f32 v54, v54, v22
  v_sub_f32 v55, v55, v22
  v_exp_f32 v24, v24
  v_exp_f32 v25, v25
  v_exp_f32 v26, v26
  v_exp_f32 v27, v27
  v_exp_f32 v28, v28
  v_exp_f32 v29, v29
  v_exp_f32 v30, v30
  v_exp_f32 v31, v31
  v_exp_f32 v32, v32
  v_exp_f32 v33, v33
  v_exp_f32 v34, v34
  v_exp_f32 v35, v35
  v_exp_f32 v36, v36
  v_exp_f32 v37, v37
  v_exp_f32 v38, v38
  v_exp_f32 v39, v39
  v_exp_f32 v40, v40
  v_exp_f32 v41, v41
  v_exp_f32 v42, v42
  v_exp_f32 v43, v43
  v_exp_f32 v44, v44
  v_exp_f32 v45, v45
  v_exp_f32 v46, v46
  v_exp_f32 v47, v47
  v_exp_f32 v48, v48
  v_exp_f32 v49, v49
  v_exp_f32 v50, v50
  v_exp_f32 v51, v51
  v_exp_f32 v52, v52
  v_exp_f32 v53, v53
  v_exp_f32 v54, v54
  v_exp_f32 v55, v55
  s_nop 0
  v_cvt_pk_bf16_f32 v136, v24, v25
  v_cvt_pk_bf16_f32 v137, v26, v27
  v_cvt_pk_bf16_f32 v138, v28, v29
  v_cvt_pk_bf16_f32 v139, v30, v31
  v_cvt_pk_bf16_f32 v140, v32, v33
  v_cvt_pk_bf16_f32 v141, v34, v35
  v_cvt_pk_bf16_f32 v142, v36, v37
  v_cvt_pk_bf16_f32 v143, v38, v39
  v_cvt_pk_bf16_f32 v144, v40, v41
  v_cvt_pk_bf16_f32 v145, v42, v43
  v_cvt_pk_bf16_f32 v146, v44, v45
  v_cvt_pk_bf16_f32 v147, v46, v47
  v_cvt_pk_bf16_f32 v148, v48, v49
  v_cvt_pk_bf16_f32 v149, v50, v51
  v_cvt_pk_bf16_f32 v150, v52, v53
  v_cvt_pk_bf16_f32 v151, v54, v55
  s_nop 1
  v_mfma_f32_16x16x32_bf16 v[184:187], v[192:195], v[136:139], 0
  v_mfma_f32_16x16x32_bf16 v[184:187], v[192:195], v[140:143], v[184:187]
  v_mfma_f32_16x16x32_bf16 v[184:187], v[192:195], v[144:147], v[184:187]
  v_mfma_f32_16x16x32_bf16 v[184:187], v[192:195], v[148:151], v[184:187]
  s_nop 7
  s_branch FBR0
FB1:
  s_nop 7
  v_max3_f32 v22, v56, v57, v58
  v_max3_f32 v22, v22, v59, v60
  v_max3_f32 v22, v22, v61, v62
  v_max3_f32 v22, v22, v63, v64
  v_max3_f32 v22, v22, v65, v66
  v_max3_f32 v22, v22, v67, v68
  v_max3_f32 v22, v22, v69, v70
  v_max3_f32 v22, v22, v71, v72
  v_max3_f32 v22, v22, v73, v74
  v_max3_f32 v22, v22, v75, v76
  v_max3_f32 v22, v22, v77, v78
  v_max3_f32 v22, v22, v79, v80
  v_max3_f32 v22, v22, v81, v82
  v_max3_f32 v22, v22, v83, v84
  v_max3_f32 v22, v22, v85, v86
  s_mov_b32 s52, 0xff7fffff
  v_max3_f32 v22, v22, v87, s52
  v_mov_b32 v23, v22
  s_nop 1
  v_permlane32_swap_b32 v22, v23
  s_nop 1
  v_max_f32 v22, v22, v23
  v_mov_b32 v23, v22
  s_nop 1
  v_permlane16_swap_b32 v22, v23
  s_nop 1
  v_max_f32 v22, v22, v23
  v_sub_f32 v56, v56, v22
  v_sub_f32 v57, v57, v22
  v_sub_f32 v58, v58, v22
  v_sub_f32 v59, v59, v22
  v_sub_f32 v60, v60, v22
  v_sub_f32 v61, v61, v22
  v_sub_f32 v62, v62, v22
  v_sub_f32 v63, v63, v22
  v_sub_f32 v64, v64, v22
  v_sub_f32 v65, v65, v22
  v_sub_f32 v66, v66, v22
  v_sub_f32 v67, v67, v22
  v_sub_f32 v68, v68, v22
  v_sub_f32 v69, v69, v22
  v_sub_f32 v70, v70, v22
  v_sub_f32 v71, v71, v22
  v_sub_f32 v72, v72, v22
  v_sub_f32 v73, v73, v22
  v_sub_f32 v74, v74, v22
  v_sub_f32 v75, v75, v22
  v_sub_f32 v76, v76, v22
  v_sub_f32 v77, v77, v22
  v_sub_f32 v78, v78, v22
  v_sub_f32 v79, v79, v22
  v_sub_f32 v80, v80, v22
  v_sub_f32 v81, v81, v22
  v_sub_f32 v82, v82, v22
  v_sub_f32 v83, v83, v22
  v_sub_f32 v84, v84, v22
  v_sub_f32 v85, v85, v22
  v_sub_f32 v86, v86, v22
  v_sub_f32 v87, v87, v22
  v_exp_f32 v56, v56
  v_exp_f32 v57, v57
  v_exp_f32 v58, v58
  v_exp_f32 v59, v59
  v_exp_f32 v60, v60
  v_exp_f32 v61, v61
  v_exp_f32 v62, v62
  v_exp_f32 v63, v63
  v_exp_f32 v64, v64
  v_exp_f32 v65, v65
  v_exp_f32 v66, v66
  v_exp_f32 v67, v67
  v_exp_f32 v68, v68
  v_exp_f32 v69, v69
  v_exp_f32 v70, v70
  v_exp_f32 v71, v71
  v_exp_f32 v72, v72
  v_exp_f32 v73, v73
  v_exp_f32 v74, v74
  v_exp_f32 v75, v75
  v_exp_f32 v76, v76
  v_exp_f32 v77, v77
  v_exp_f32 v78, v78
  v_exp_f32 v79, v79
  v_exp_f32 v80, v80
  v_exp_f32 v81, v81
  v_exp_f32 v82, v82
  v_exp_f32 v83, v83
  v_exp_f32 v84, v84
  v_exp_f32 v85, v85
  v_exp_f32 v86, v86
  v_exp_f32 v87, v87
  s_nop 0
  v_cvt_pk_bf16_f32 v152, v56, v57
  v_cvt_pk_bf16_f32 v153, v58, v59
  v_cvt_pk_bf16_f32 v154, v60, v61
  v_cvt_pk_bf16_f32 v155, v62, v63
  v_cvt_pk_bf16_f32 v156, v64, v65
  v_cvt_pk_bf16_f32 v157, v66, v67
  v_cvt_pk_bf16_f32 v158, v68, v69
  v_cvt_pk_bf16_f32 v159, v70, v71
  v_cvt_pk_bf16_f32 v160, v72, v73
  v_cvt_pk_bf16_f32 v161, v74, v75
  v_cvt_pk_bf16_f32 v162, v76, v77
  v_cvt_pk_bf16_f32 v163, v78, v79
  v_cvt_pk_bf16_f32 v164, v80, v81
  v_cvt_pk_bf16_f32 v165, v82, v83
  v_cvt_pk_bf16_f32 v166, v84, v85
  v_cvt_pk_bf16_f32 v167, v86, v87
  s_nop 1
  v_mfma_f32_16x16x32_bf16 v[188:191], v[192:195], v[152:155], 0
  v_mfma_f32_16x16x32_bf16 v[188:191], v[192:195], v[156:159], v[188:191]
  v_mfma_f32_16x16x32_bf16 v[188:191], v[192:195], v[160:163], v[188:191]
  v_mfma_f32_16x16x32_bf16 v[188:191], v[192:195], v[164:167], v[188:191]
  s_nop 7
  s_branch FBR1
MK_end:
.section .rodata,"a"
.p2align 6
.amdhsa_kernel standalone__neighborhood_nat__vision_kernel
  .amdhsa_next_free_vgpr 256
  .amdhsa_next_free_sgpr 102
  .amdhsa_accum_offset 256
  .amdhsa_group_segment_fixed_size 0
  .amdhsa_kernarg_size 48
  .amdhsa_user_sgpr_count 2
  .amdhsa_user_sgpr_kernarg_segment_ptr 1
  .amdhsa_system_sgpr_workgroup_id_x 1
.end_amdhsa_kernel
```

```asm
; @launch grid=(256,1,1) block=(512,1,1) lds=163840
.amdgcn_target "amdgcn-amd-amdhsa--gfx950"
.text
.globl standalone__neighborhood_nat__vision_kernel
.p2align 8
.type standalone__neighborhood_nat__vision_kernel,@function
standalone__neighborhood_nat__vision_kernel:
  s_cmp_ge_u32 s2, 256
  s_cbranch_scc1 MK_done
  s_load_dwordx8 s[4:11], s[0:1], 0
  s_load_dwordx4 s[84:87], s[0:1], 32
  s_getpc_b64 s[12:13]
MK_pc:
  s_and_b32 s13, s13, 0xffff
  s_mov_b32 s14, MK_end-MK_pc
  s_mov_b32 s15, 0x00020000
  v_lshlrev_b32 v23, 7, v0
  buffer_load_dword v255, v23, s[12:15], 0 offen
  v_lshrrev_b32 v130, 6, v0
  v_and_b32 v0, 63, v0
  v_readfirstlane_b32 s24, v130
  v_and_b32 v128, 15, v0
  v_lshrrev_b32 v129, 4, v0
  v_lshrrev_b32 v130, 5, v0
  v_bfe_u32 v131, v0, 3, 2
  v_lshl_add_u32 v130, v130, 3, v131
  v_mul_u32_u24 v130, 1152, v130
  s_and_b32 s26, s24, 1
  s_lshl_b32 s46, s26, 2
  v_add_u32 v131, s46, v129
  v_and_b32 v132, 7, v0
  v_xor_b32 v131, v131, v132
  v_lshl_add_u32 v96, v131, 4, v130
  s_lshr_b32 s46, s24, 2
  s_lshl_b32 s46, s46, 5
  s_lshl_b32 s47, s26, 4
  s_add_u32 s46, s46, s47
  s_and_b32 s47, s24, 2
  s_lshl_b32 s47, s47, 1
  s_add_u32 s46, s46, s47
  s_mul_i32 s92, s46, 1152
  s_lshl_b32 s41, s24, 10
  s_cmp_lt_u32 s24, 4
  s_cselect_b64 vcc, -1, 0
  s_bfe_u32 s27, s2, 0x10002
  s_bfe_u32 s28, s2, 0x10001
  s_and_b32 s29, s2, 1
  s_lshl_b32 s29, s29, 2
  s_lshr_b32 s46, s2, 6
  s_add_u32 s29, s29, s46
  s_bfe_u32 s30, s2, 0x30003
  s_mul_i32 s37, s29, 14
  s_add_i32 s37, s37, -6
  s_max_i32 s29, s37, -4
  s_mul_i32 s30, s30, 14
  s_add_i32 s30, s30, -6
  s_lshr_b32 s25, s24, 1
  s_add_u32 s25, s25, 2
  s_and_b32 s25, s25, 3
  s_sub_u32 s56, 0, s27
  s_mul_i32 s57, s27, 224
  s_sub_u32 s58, 0, s28
  s_mul_i32 s59, s28, 224
  v_and_b32 v130, 7, v128
  s_mul_i32 s46, s26, 7
  s_add_i32 s46, s46, s30
  v_cmp_lt_u32 s[48:49], 6, v130
  v_add_u32 v130, s46, v130
  v_max_i32 v19, 0, v130
  v_add3_u32 v130, v130, v19, 6
  v_xor_b32 v130, s58, v130
  v_add_u32 v130, s59, v130
  v_subrev_u32 v19, s30, v19
  v_mul_u32_u24 v130, 384, v130
  v_lshl_add_u32 v130, v129, 4, v130
  s_lshl_b32 s46, s25, 2
  s_add_i32 s46, s46, -2
  s_mov_b32 s47, 86016
  v_lshrrev_b32 v131, 3, v128
  v_add_u32 v131, s46, v131
  v_mov_b32 v132, 0x80000000
  v_cmp_gt_i32 s[42:43], 0, v131
  v_add_u32 v5, s37, v131
  v_max_i32 v21, 0, v5
  v_add3_u32 v5, v5, v21, 6
  s_or_b64 s[42:43], s[42:43], s[48:49]
  v_xor_b32 v5, s56, v5
  v_add_u32 v5, s57, v5
  v_subrev_u32 v21, s29, v21
  v_mad_u32_u24 v5, v5, s47, v130
  v_cndmask_b32 v21, v21, v132, s[42:43]
  v_cndmask_b32 v5, v5, v132, s[42:43]
  v_add_u32 v131, 2, v131
  v_cmp_gt_i32 s[44:45], 0, v131
  v_add_u32 v6, s37, v131
  v_max_i32 v22, 0, v6
  v_add3_u32 v6, v6, v22, 6
  s_or_b64 s[44:45], s[44:45], s[48:49]
  v_xor_b32 v6, s56, v6
  v_add_u32 v6, s57, v6
  v_subrev_u32 v22, s29, v22
  v_mad_u32_u24 v6, v6, s47, v130
  v_cndmask_b32 v22, v22, v132, s[44:45]
  v_cndmask_b32 v6, v6, v132, s[44:45]
  s_waitcnt lgkmcnt(0)
  s_mov_b32 s88, s6
  s_and_b32 s89, s7, 0xffff
  s_mov_b32 s90, 221184
  s_mov_b32 s91, 0x00020000
  s_cmp_lg_u32 s24, 5
  s_cbranch_scc1 MK_ntlb
  s_max_i32 s46, s37, 0
  s_lshl_b32 s46, s46, 1
  s_sub_u32 s47, 184, s46
  s_cmp_eq_u32 s27, 0
  s_cselect_b32 s46, s46, s47
  s_mul_i32 s46, s46, 86016
  s_load_dword s94, s[4:5], s46
  s_load_dword s95, s[10:11], s46
  s_add_u32 s46, s46, 1720256
  s_load_dword s94, s[4:5], s46
  s_load_dword s95, s[10:11], s46
  s_add_u32 s46, s46, 1720256
  s_load_dword s94, s[4:5], s46
  s_load_dword s95, s[10:11], s46
  s_load_dword s94, s[84:85], 128
  s_load_dword s95, s[86:87], 0x20000
MK_ntlb:
  s_cmp_lt_u32 s24, 6
  s_cbranch_scc1 MK_nwpf
  s_cmp_eq_u32 s24, 6
  s_cselect_b32 s46, 54, 18
  s_cselect_b32 s12, s6, s8
  s_cselect_b32 s13, s7, s9
  s_and_b32 s13, s13, 0xffff
  s_lshr_b32 s47, s2, 3
  s_mul_i32 s47, s47, s46
  s_lshl_b32 s100, s47, 7
  s_lshl_b32 s46, s46, 7
  s_add_u32 s14, s100, s46
  s_mov_b32 s15, 0x00020000
  v_lshlrev_b32 v23, 7, v0
  buffer_load_dword v254, v23, s[12:15], s100 offen
MK_nwpf:
  s_mov_b32 s12, s4
  s_and_b32 s13, s5, 0xffff
  s_mov_b32 s14, 19267584
  s_mov_b32 s15, 0x00020000
  s_movk_i32 s54, 112
  s_add_u32 m0, s41, 0
  s_add_u32 s100, s92, 0
  buffer_load_dwordx4 v96, s[88:91], s100 offen lds
  s_add_u32 m0, s41, 8192
  s_add_u32 s100, s92, 73728
  buffer_load_dwordx4 v96, s[88:91], s100 offen lds
  s_add_u32 m0, s41, 16384
  s_add_u32 s100, s92, 147456
  buffer_load_dwordx4 v96, s[88:91], s100 offen lds
  s_add_u32 m0, s41, 24576
  s_add_u32 s100, s92, 384
  buffer_load_dwordx4 v96, s[88:91], s100 offen lds
  s_add_u32 m0, s41, 32768
  s_add_u32 s100, s92, 74112
  buffer_load_dwordx4 v96, s[88:91], s100 offen lds
  s_add_u32 m0, s41, 40960
  s_add_u32 s100, s92, 147840
  buffer_load_dwordx4 v96, s[88:91], s100 offen lds
  s_mov_b32 s16, s10
  s_and_b32 s17, s11, 0xffff
  s_mov_b32 s18, 19267584
  s_mov_b32 s19, 0x00020000
  s_mov_b32 s4, s8
  s_and_b32 s5, s9, 0xffff
  s_mov_b32 s6, 73728
  s_mov_b32 s7, 0x00020000
  s_mov_b32 s8, s84
  s_and_b32 s9, s85, 0xffff
  s_mov_b32 s10, 256
  s_mov_b32 s11, 0x00020000
  s_mov_b32 s20, s86
  s_and_b32 s21, s87, 0xffff
  s_mov_b32 s22, 73728
  s_mov_b32 s23, 0x00020000
  v_lshlrev_b32 v1, 4, v0
  v_add_u32 v2, 36864, v1
  s_and_b32 s40, s24, 3
  s_lshl_b32 s40, s40, 10
  v_bfe_u32 v130, v128, 1, 3
  v_xor_b32 v130, v130, v129
  v_lshlrev_b32 v131, 7, v128
  v_lshl_add_u32 v131, v130, 4, v131
  s_lshr_b32 s46, s24, 2
  s_mul_i32 s47, s46, 12288
  v_add_u32 v97, s47, v131
  v_xor_b32 v98, 64, v97
  s_mul_i32 s47, s40, 6
  s_add_u32 s47, s47, 24576
  v_add_u32 v99, s47, v131
  v_xor_b32 v100, 64, v99
  s_lshr_b32 s46, s24, 2
  s_mul_i32 s46, s46, 6
  s_sub_u32 s46, 67, s46
  s_and_b32 s47, s24, 3
  s_mul_i32 s47, s47, 3
  s_add_u32 s48, s47, 0
  s_lshr_b32 s49, s48, 1
  s_mul_i32 s49, s49, 10
  s_add_u32 s48, s48, s49
  s_sub_u32 s48, s46, s48
  s_lshl_b32 s48, s48, 10
  v_add_u32 v101, s48, v1
  s_add_u32 s48, s47, 1
  s_lshr_b32 s49, s48, 1
  s_mul_i32 s49, s49, 10
  s_add_u32 s48, s48, s49
  s_sub_u32 s48, s46, s48
  s_lshl_b32 s48, s48, 10
  v_add_u32 v102, s48, v1
  s_add_u32 s48, s47, 2
  s_lshr_b32 s49, s48, 1
  s_mul_i32 s49, s49, 10
  s_add_u32 s48, s48, s49
  s_sub_u32 s48, s46, s48
  s_lshl_b32 s48, s48, 10
  v_add_u32 v103, s48, v1
  s_lshl_b32 s46, s29, 1
  s_xor_b32 s46, s46, s56
  s_mul_i32 s47, s27, 222
  s_add_i32 s31, s46, s47
  s_mul_i32 s31, s31, 86016
  s_mul_i32 s32, s27, -688128
  s_add_i32 s32, s32, 344064
  s_lshr_b32 s33, s29, 31
  s_lshl_b32 s33, s33, 1
  s_lshl_b32 s38, s40, 2
  s_add_u32 s39, s38, 3072
  s_min_u32 s39, s39, 14336
  s_mul_i32 s48, s27, 172032
  s_sub_u32 s49, 172032, s48
  v_mov_b32 v132, s48
  v_mov_b32 v133, s49
  s_lshr_b32 s46, s38, 4
  s_add_u32 s46, s46, 0
  v_add_u32 v130, s46, v0
  v_mul_u32_u24 v13, 2731, v130
  v_lshrrev_b32 v13, 16, v13
  v_cmp_le_u32 s[52:53], 20, v13
  v_mul_u32_u24 v131, 24, v13
  v_sub_u32 v130, v130, v131
  v_subrev_u32 v131, 20, v13
  v_cndmask_b32 v13, v13, v131, s[52:53]
  v_bfe_u32 v131, v13, 1, 3
  v_xor_b32 v130, v130, v131
  v_cndmask_b32 v131, v132, v133, s[52:53]
  v_lshl_add_u32 v130, v130, 4, v131
  v_add_u32 v13, s30, v13
  v_max_i32 v13, 0, v13
  v_lshlrev_b32 v13, 1, v13
  v_xor_b32 v13, s58, v13
  v_add_u32 v13, s59, v13
  v_mul_u32_u24 v13, 384, v13
  v_add_u32 v13, v13, v130
  s_lshr_b32 s46, s38, 4
  s_add_u32 s46, s46, 64
  v_add_u32 v130, s46, v0
  v_mul_u32_u24 v14, 2731, v130
  v_lshrrev_b32 v14, 16, v14
  v_cmp_le_u32 s[52:53], 20, v14
  v_mul_u32_u24 v131, 24, v14
  v_sub_u32 v130, v130, v131
  v_subrev_u32 v131, 20, v14
  v_cndmask_b32 v14, v14, v131, s[52:53]
  v_bfe_u32 v131, v14, 1, 3
  v_xor_b32 v130, v130, v131
  v_cndmask_b32 v131, v132, v133, s[52:53]
  v_lshl_add_u32 v130, v130, 4, v131
  v_add_u32 v14, s30, v14
  v_max_i32 v14, 0, v14
  v_lshlrev_b32 v14, 1, v14
  v_xor_b32 v14, s58, v14
  v_add_u32 v14, s59, v14
  v_mul_u32_u24 v14, 384, v14
  v_add_u32 v14, v14, v130
  s_lshr_b32 s46, s38, 4
  s_add_u32 s46, s46, 128
  v_add_u32 v130, s46, v0
  v_mul_u32_u24 v3, 2731, v130
  v_lshrrev_b32 v3, 16, v3
  v_cmp_le_u32 s[52:53], 20, v3
  v_mul_u32_u24 v131, 24, v3
  v_sub_u32 v130, v130, v131
  v_subrev_u32 v131, 20, v3
  v_cndmask_b32 v3, v3, v131, s[52:53]
  v_bfe_u32 v131, v3, 1, 3
  v_xor_b32 v130, v130, v131
  v_cndmask_b32 v131, v132, v133, s[52:53]
  v_lshl_add_u32 v130, v130, 4, v131
  v_add_u32 v3, s30, v3
  v_max_i32 v3, 0, v3
  v_lshlrev_b32 v3, 1, v3
  v_xor_b32 v3, s58, v3
  v_add_u32 v3, s59, v3
  v_mul_u32_u24 v3, 384, v3
  v_add_u32 v3, v3, v130
  s_lshr_b32 s46, s39, 4
  v_add_u32 v130, s46, v0
  v_mul_u32_u24 v4, 2731, v130
  v_lshrrev_b32 v4, 16, v4
  v_cmp_le_u32 s[52:53], 20, v4
  v_mul_u32_u24 v131, 24, v4
  v_sub_u32 v130, v130, v131
  v_subrev_u32 v131, 20, v4
  v_cndmask_b32 v4, v4, v131, s[52:53]
  v_bfe_u32 v131, v4, 1, 3
  v_xor_b32 v130, v130, v131
  v_cndmask_b32 v131, v132, v133, s[52:53]
  v_lshl_add_u32 v130, v130, 4, v131
  v_add_u32 v4, s30, v4
  v_max_i32 v4, 0, v4
  v_lshlrev_b32 v4, 1, v4
  v_xor_b32 v4, s58, v4
  v_add_u32 v4, s59, v4
  v_mul_u32_u24 v4, 384, v4
  v_add_u32 v4, v4, v130
  s_add_u32 s38, s38, 10240
  s_add_u32 s39, s39, 10240
  s_lshl_b32 s46, s25, 2
  s_add_i32 s46, s46, -2
  s_max_i32 s46, s46, 0
  s_add_i32 s46, s46, s37
  s_max_i32 s46, s46, 0
  s_sub_i32 s46, s46, s29
  s_lshl_b32 s34, s25, 2
  s_add_i32 s34, s34, s37
  s_max_i32 s34, s34, 0
  s_sub_i32 s34, s34, s29
  s_sub_u32 s46, s34, s46
  s_lshr_b32 s46, s46, 1
  s_mul_i32 s36, s46, -8
  s_add_i32 s36, s36, 7
  s_add_i32 s34, s34, -1
  s_add_i32 s35, s34, s36
  s_mul_i32 s36, s36, 7680
  s_lshl_b32 s47, s26, 2
  s_mul_i32 s46, s34, 7680
  s_add_i32 s46, s46, 10240
  v_add_u32 v130, s47, v128
  v_bfe_u32 v131, v130, 1, 3
  v_xor_b32 v131, v131, v129
  v_mul_u32_u24 v130, 384, v130
  v_lshl_add_u32 v130, v131, 4, v130
  v_add_u32 v7, s46, v130
  v_xor_b32 v8, 64, v7
  v_lshrrev_b32 v130, 2, v128
  v_lshl_add_u32 v130, v129, 2, v130
  v_add_u32 v130, s47, v130
  v_bfe_u32 v131, v130, 1, 3
  v_and_b32 v132, 2, v128
  v_lshlrev_b32 v132, 1, v132
  v_xor_b32 v131, v131, v132
  v_mul_u32_u24 v130, 384, v130
  v_lshl_add_u32 v130, v131, 4, v130
  v_and_b32 v131, 1, v128
  v_lshl_add_u32 v130, v131, 3, v130
  v_add_u32 v9, s46, v130
  v_xor_b32 v10, 16, v9
  v_xor_b32 v11, 32, v9
  v_xor_b32 v12, 48, v9
  v_lshl_add_u32 v130, v129, 2, s47
  v_sub_u32 v19, v130, v19
  v_add_u32 v20, s36, v7
  v_add_u32 v0, s36, v8
  v_add_u32 v15, s36, v9
  v_add_u32 v16, s36, v10
  v_add_u32 v17, s36, v11
  v_add_u32 v18, s36, v12
  s_mov_b32 s93, 1037384597
  s_add_u32 m0, s41, 49152
  s_add_u32 s100, s92, 128
  buffer_load_dwordx4 v96, s[88:91], s100 offen lds
  s_add_u32 m0, s41, 57344
  s_add_u32 s100, s92, 73856
  buffer_load_dwordx4 v96, s[88:91], s100 offen lds
  s_add_u32 m0, s41, 65536
  s_add_u32 s100, s92, 147584
  buffer_load_dwordx4 v96, s[88:91], s100 offen lds
  s_add_u32 m0, s41, 73728
  s_add_u32 s100, s92, 512
  buffer_load_dwordx4 v96, s[88:91], s100 offen lds
  s_add_u32 m0, s41, 81920
  s_add_u32 s100, s92, 74240
  buffer_load_dwordx4 v96, s[88:91], s100 offen lds
  s_add_u32 m0, s41, 90112
  s_add_u32 s100, s92, 147968
  buffer_load_dwordx4 v96, s[88:91], s100 offen lds
  s_waitcnt vmcnt(6)
  s_barrier
  ds_read_b128 v[208:211], v99 offset:0
  ds_read_b128 v[212:215], v99 offset:2048
  ds_read_b128 v[216:219], v99 offset:4096
  ds_read_b128 v[184:187], v97 offset:0
  ds_read_b128 v[188:191], v97 offset:2048
  ds_read_b128 v[192:195], v97 offset:4096
  ds_read_b128 v[196:199], v97 offset:6144
  ds_read_b128 v[200:203], v97 offset:8192
  ds_read_b128 v[204:207], v97 offset:10240
  s_waitcnt lgkmcnt(5)
  v_mfma_f32_16x16x32_bf16 v[24:27], v[184:187], v[208:211], 0
  s_add_u32 m0, s41, 98304
  s_add_u32 s100, s92, 256
  buffer_load_dwordx4 v96, s[88:91], s100 offen lds
  v_mfma_f32_16x16x32_bf16 v[28:31], v[184:187], v[212:215], 0
  v_mfma_f32_16x16x32_bf16 v[32:35], v[184:187], v[216:219], 0
  s_waitcnt lgkmcnt(4)
  v_mfma_f32_16x16x32_bf16 v[36:39], v[188:191], v[208:211], 0
  ds_read_b128 v[244:247], v100 offset:0
  s_add_u32 m0, s41, 106496
  s_add_u32 s100, s92, 73984
  buffer_load_dwordx4 v96, s[88:91], s100 offen lds
  v_mfma_f32_16x16x32_bf16 v[40:43], v[188:191], v[212:215], 0
  ds_read_b128 v[248:251], v100 offset:2048
  v_mfma_f32_16x16x32_bf16 v[44:47], v[188:191], v[216:219], 0
  s_waitcnt lgkmcnt(5)
  v_mfma_f32_16x16x32_bf16 v[48:51], v[192:195], v[208:211], 0
  ds_read_b128 v[252:255], v100 offset:4096
  s_add_u32 m0, s41, 114688
  s_add_u32 s100, s92, 147712
  buffer_load_dwordx4 v96, s[88:91], s100 offen lds
  v_mfma_f32_16x16x32_bf16 v[52:55], v[192:195], v[212:215], 0
  ds_read_b128 v[220:223], v98 offset:0
  v_mfma_f32_16x16x32_bf16 v[56:59], v[192:195], v[216:219], 0
  s_waitcnt lgkmcnt(6)
  v_mfma_f32_16x16x32_bf16 v[60:63], v[196:199], v[208:211], 0
  ds_read_b128 v[224:227], v98 offset:2048
  s_add_u32 m0, s41, 122880
  s_add_u32 s100, s92, 640
  buffer_load_dwordx4 v96, s[88:91], s100 offen lds
  v_mfma_f32_16x16x32_bf16 v[64:67], v[196:199], v[212:215], 0
  ds_read_b128 v[228:231], v98 offset:4096
  v_mfma_f32_16x16x32_bf16 v[68:71], v[196:199], v[216:219], 0
  s_waitcnt lgkmcnt(7)
  v_mfma_f32_16x16x32_bf16 v[72:75], v[200:203], v[208:211], 0
  ds_read_b128 v[232:235], v98 offset:6144
  s_add_u32 m0, s41, 131072
  s_add_u32 s100, s92, 74368
  buffer_load_dwordx4 v96, s[88:91], s100 offen lds
  v_mfma_f32_16x16x32_bf16 v[76:79], v[200:203], v[212:215], 0
  ds_read_b128 v[236:239], v98 offset:8192
  v_mfma_f32_16x16x32_bf16 v[80:83], v[200:203], v[216:219], 0
  s_waitcnt lgkmcnt(8)
  v_mfma_f32_16x16x32_bf16 v[84:87], v[204:207], v[208:211], 0
  ds_read_b128 v[240:243], v98 offset:10240
  s_add_u32 m0, s41, 139264
  s_add_u32 s100, s92, 148096
  buffer_load_dwordx4 v96, s[88:91], s100 offen lds
  v_mfma_f32_16x16x32_bf16 v[88:91], v[204:207], v[212:215], 0
  v_mfma_f32_16x16x32_bf16 v[92:95], v[204:207], v[216:219], 0
  v_lshrrev_b32 v107, 4, v1
  s_cmp_lt_u32 s2, 72
  s_cbranch_scc0 MK_np1
  s_mul_hi_u32 s54, s2, 0x15555556
  s_lshl_b32 s54, s54, 6
  s_mul_i32 s55, s24, 6144
  s_add_u32 s100, s54, s55
  v_lshrrev_b32 v104, 2, v107
  v_mul_u32_u24 v104, 384, v104
  v_and_b32 v105, 3, v107
  v_lshl_add_u32 v104, v105, 4, v104
  s_add_u32 m0, s41, 147456
  s_nop 0
  buffer_load_dwordx4 v104, s[4:7], s100 offen lds
  s_mul_i32 s55, s40, 6
  s_add_u32 s100, s54, s55
  s_add_u32 m0, s40, 155648
  s_add_u32 s100, s100, 49152
  buffer_load_dwordx4 v104, s[4:7], s100 offen lds
MK_np1:
  s_sub_u32 s3, s2, 72
  s_lshr_b32 s3, s3, 31
  s_lshr_b32 s3, s3, s25
  v_mov_b32 v134, 0
  s_cmp_eq_u32 s3, 0
  s_cbranch_scc1 MK_np3
  s_mul_hi_u32 s54, s2, 0x15555556
  s_mul_i32 s55, s54, 12
  s_sub_u32 s55, s2, s55
  s_and_b32 s51, s55, 1
  s_lshr_b32 s55, s55, 1
  v_lshrrev_b32 v106, 2, v128
  v_and_b32 v105, 3, v128
  v_lshl_add_u32 v134, v129, 3, v106
  v_lshlrev_b32 v134, 6, v134
  v_lshl_add_u32 v134, v105, 4, v134
  s_lshl_b32 s51, s51, 3
  s_add_u32 s51, s51, 147456
  v_add_u32 v134, s51, v134
  s_lshr_b32 s54, s55, 1
  s_lshl_b32 s54, s54, 6
  s_and_b32 s55, s55, 1
  s_lshl_b32 s55, s55, 4
  s_add_u32 s54, s54, s55
  v_lshrrev_b32 v104, 1, v106
  v_lshlrev_b32 v104, 5, v104
  v_and_b32 v106, 1, v106
  v_lshl_add_u32 v104, v106, 2, v104
  v_add3_u32 v104, v104, v105, s54
  v_mul_u32_u24 v104, 1152, v104
  v_lshl_add_u32 v135, v129, 4, v104
  s_mul_i32 s100, s26, 9216
  buffer_load_dwordx4 v[136:139], v135, s[88:91], s100 offen offset:768
  buffer_load_dwordx4 v[140:143], v135, s[88:91], s100 offen offset:832
  buffer_load_dwordx4 v[144:147], v135, s[88:91], s100 offen offset:896
  buffer_load_dwordx4 v[148:151], v135, s[88:91], s100 offen offset:960
  buffer_load_dwordx4 v[152:155], v135, s[88:91], s100 offen offset:1024
  buffer_load_dwordx4 v[156:159], v135, s[88:91], s100 offen offset:1088
MK_np3:
  s_cmp_lg_u32 s3, 0
  s_cbranch_scc1 CA1
  s_cmp_lt_u32 s2, 72
  s_cbranch_scc1 CB1
  s_waitcnt vmcnt(6)
CB1:
  s_waitcnt vmcnt(8)
CA1:
  s_waitcnt vmcnt(14) lgkmcnt(0)
  s_barrier
  v_add_u32 v97, 49152, v97
  v_add_u32 v98, 49152, v98
  v_add_u32 v99, 49152, v99
  v_add_u32 v100, 49152, v100
  v_mfma_f32_16x16x32_bf16 v[24:27], v[220:223], v[244:247], v[24:27]
  ds_read_b128 v[208:211], v99 offset:0
  s_cbranch_vccnz SL2
  buffer_load_dwordx4 v[160:163], v6, s[12:15], 0 offen offset:0
SL2:
  v_mfma_f32_16x16x32_bf16 v[28:31], v[220:223], v[248:251], v[28:31]
  ds_read_b128 v[212:215], v99 offset:2048
  v_mfma_f32_16x16x32_bf16 v[32:35], v[220:223], v[252:255], v[32:35]
  v_mfma_f32_16x16x32_bf16 v[36:39], v[224:227], v[244:247], v[36:39]
  ds_read_b128 v[216:219], v99 offset:4096
  s_cbranch_vccnz SL3
  buffer_load_dwordx4 v[164:167], v6, s[12:15], 0 offen offset:64
SL3:
  v_mfma_f32_16x16x32_bf16 v[40:43], v[224:227], v[248:251], v[40:43]
  ds_read_b128 v[184:187], v97 offset:0
  v_mfma_f32_16x16x32_bf16 v[44:47], v[224:227], v[252:255], v[44:47]
  v_mfma_f32_16x16x32_bf16 v[48:51], v[228:231], v[244:247], v[48:51]
  ds_read_b128 v[188:191], v97 offset:2048
  s_cbranch_vccnz SL4
  buffer_load_dwordx4 v[168:171], v6, s[12:15], 0 offen offset:128
SL4:
  v_mfma_f32_16x16x32_bf16 v[52:55], v[228:231], v[248:251], v[52:55]
  ds_read_b128 v[192:195], v97 offset:4096
  v_mfma_f32_16x16x32_bf16 v[56:59], v[228:231], v[252:255], v[56:59]
  v_mfma_f32_16x16x32_bf16 v[60:63], v[232:235], v[244:247], v[60:63]
  ds_read_b128 v[196:199], v97 offset:6144
  s_cbranch_vccnz SL5
  buffer_load_dwordx4 v[172:175], v6, s[12:15], 0 offen offset:192
SL5:
  v_mfma_f32_16x16x32_bf16 v[64:67], v[232:235], v[248:251], v[64:67]
  ds_read_b128 v[200:203], v97 offset:8192
  v_mfma_f32_16x16x32_bf16 v[68:71], v[232:235], v[252:255], v[68:71]
  v_mfma_f32_16x16x32_bf16 v[72:75], v[236:239], v[244:247], v[72:75]
  ds_read_b128 v[204:207], v97 offset:10240
  s_cbranch_vccnz SL6
  buffer_load_dwordx4 v[176:179], v6, s[12:15], 0 offen offset:256
SL6:
  v_mfma_f32_16x16x32_bf16 v[76:79], v[236:239], v[248:251], v[76:79]
  v_mfma_f32_16x16x32_bf16 v[80:83], v[236:239], v[252:255], v[80:83]
  v_mfma_f32_16x16x32_bf16 v[84:87], v[240:243], v[244:247], v[84:87]
  s_cbranch_vccnz SL7
  buffer_load_dwordx4 v[180:183], v6, s[12:15], 0 offen offset:320
SL7:
  v_mfma_f32_16x16x32_bf16 v[88:91], v[240:243], v[248:251], v[88:91]
  v_mfma_f32_16x16x32_bf16 v[92:95], v[240:243], v[252:255], v[92:95]
  s_waitcnt lgkmcnt(5)
  v_mfma_f32_16x16x32_bf16 v[24:27], v[184:187], v[208:211], v[24:27]
  s_cbranch_vccnz SL8
  s_cmp_eq_u32 s25, 0
  s_cbranch_scc1 QB6
  buffer_load_dwordx4 v[136:139], v5, s[12:15], 0 offen offset:0
QB6:
SL8:
  v_mfma_f32_16x16x32_bf16 v[28:31], v[184:187], v[212:215], v[28:31]
  v_mfma_f32_16x16x32_bf16 v[32:35], v[184:187], v[216:219], v[32:35]
  s_waitcnt lgkmcnt(4)
  v_mfma_f32_16x16x32_bf16 v[36:39], v[188:191], v[208:211], v[36:39]
  ds_read_b128 v[244:247], v100 offset:0
  s_cbranch_vccnz SL9
  s_cmp_eq_u32 s25, 0
  s_cbranch_scc1 QB7
  buffer_load_dwordx4 v[140:143], v5, s[12:15], 0 offen offset:64
QB7:
SL9:
  v_mfma_f32_16x16x32_bf16 v[40:43], v[188:191], v[212:215], v[40:43]
  ds_read_b128 v[248:251], v100 offset:2048
  v_mfma_f32_16x16x32_bf16 v[44:47], v[188:191], v[216:219], v[44:47]
  s_waitcnt lgkmcnt(5)
  v_mfma_f32_16x16x32_bf16 v[48:51], v[192:195], v[208:211], v[48:51]
  ds_read_b128 v[252:255], v100 offset:4096
  s_cbranch_vccnz SL10
  s_cmp_eq_u32 s25, 0
  s_cbranch_scc1 QB8
  buffer_load_dwordx4 v[144:147], v5, s[12:15], 0 offen offset:128
QB8:
SL10:
  v_mfma_f32_16x16x32_bf16 v[52:55], v[192:195], v[212:215], v[52:55]
  ds_read_b128 v[220:223], v98 offset:0
  v_mfma_f32_16x16x32_bf16 v[56:59], v[192:195], v[216:219], v[56:59]
  s_waitcnt lgkmcnt(6)
  v_mfma_f32_16x16x32_bf16 v[60:63], v[196:199], v[208:211], v[60:63]
  ds_read_b128 v[224:227], v98 offset:2048
  s_cbranch_vccnz SL11
  s_cmp_eq_u32 s25, 0
  s_cbranch_scc1 QB9
  buffer_load_dwordx4 v[148:151], v5, s[12:15], 0 offen offset:192
QB9:
SL11:
  v_mfma_f32_16x16x32_bf16 v[64:67], v[196:199], v[212:215], v[64:67]
  ds_read_b128 v[228:231], v98 offset:4096
  v_mfma_f32_16x16x32_bf16 v[68:71], v[196:199], v[216:219], v[68:71]
  s_waitcnt lgkmcnt(7)
  v_mfma_f32_16x16x32_bf16 v[72:75], v[200:203], v[208:211], v[72:75]
  ds_read_b128 v[232:235], v98 offset:6144
  s_cbranch_vccnz SL12
  s_cmp_eq_u32 s25, 0
  s_cbranch_scc1 QB10
  buffer_load_dwordx4 v[152:155], v5, s[12:15], 0 offen offset:256
QB10:
SL12:
  v_mfma_f32_16x16x32_bf16 v[76:79], v[200:203], v[212:215], v[76:79]
  ds_read_b128 v[236:239], v98 offset:8192
  v_mfma_f32_16x16x32_bf16 v[80:83], v[200:203], v[216:219], v[80:83]
  s_waitcnt lgkmcnt(8)
  v_mfma_f32_16x16x32_bf16 v[84:87], v[204:207], v[208:211], v[84:87]
  ds_read_b128 v[240:243], v98 offset:10240
  s_cbranch_vccnz SL13
  s_cmp_eq_u32 s25, 0
  s_cbranch_scc1 QB11
  buffer_load_dwordx4 v[156:159], v5, s[12:15], 0 offen offset:320
QB11:
SL13:
  v_mfma_f32_16x16x32_bf16 v[88:91], v[204:207], v[212:215], v[88:91]
  v_mfma_f32_16x16x32_bf16 v[92:95], v[204:207], v[216:219], v[92:95]
  s_cbranch_vccz SL14
  s_waitcnt vmcnt(0) lgkmcnt(0)
  s_branch SM14
SL14:
  s_cmp_lg_u32 s25, 0
  s_cbranch_scc1 MK_c2
  s_waitcnt vmcnt(6)
MK_c2:
  s_waitcnt vmcnt(12) lgkmcnt(0)
SM14:
  s_barrier
  v_add_u32 v97, 49152, v97
  v_add_u32 v98, 49152, v98
  v_add_u32 v99, 49152, v99
  v_add_u32 v100, 49152, v100
  v_mfma_f32_16x16x32_bf16 v[24:27], v[220:223], v[244:247], v[24:27]
  ds_read_b128 v[208:211], v99 offset:0
  s_cbranch_vccz SL15
  buffer_load_dwordx4 v[160:163], v6, s[12:15], 0 offen offset:0
SL15:
  v_mfma_f32_16x16x32_bf16 v[28:31], v[220:223], v[248:251], v[28:31]
  ds_read_b128 v[212:215], v99 offset:2048
  v_mfma_f32_16x16x32_bf16 v[32:35], v[220:223], v[252:255], v[32:35]
  v_mfma_f32_16x16x32_bf16 v[36:39], v[224:227], v[244:247], v[36:39]
  ds_read_b128 v[216:219], v99 offset:4096
  v_mfma_f32_16x16x32_bf16 v[40:43], v[224:227], v[248:251], v[40:43]
  ds_read_b128 v[184:187], v97 offset:0
  s_cbranch_vccz SL16
  buffer_load_dwordx4 v[164:167], v6, s[12:15], 0 offen offset:64
SL16:
  v_mfma_f32_16x16x32_bf16 v[44:47], v[224:227], v[252:255], v[44:47]
  v_mfma_f32_16x16x32_bf16 v[48:51], v[228:231], v[244:247], v[48:51]
  ds_read_b128 v[188:191], v97 offset:2048
  v_mfma_f32_16x16x32_bf16 v[52:55], v[228:231], v[248:251], v[52:55]
  ds_read_b128 v[192:195], v97 offset:4096
  v_mfma_f32_16x16x32_bf16 v[56:59], v[228:231], v[252:255], v[56:59]
  v_mfma_f32_16x16x32_bf16 v[60:63], v[232:235], v[244:247], v[60:63]
  ds_read_b128 v[196:199], v97 offset:6144
  s_cbranch_vccz SL17
  buffer_load_dwordx4 v[168:171], v6, s[12:15], 0 offen offset:128
SL17:
  v_mfma_f32_16x16x32_bf16 v[64:67], v[232:235], v[248:251], v[64:67]
  ds_read_b128 v[200:203], v97 offset:8192
  v_mfma_f32_16x16x32_bf16 v[68:71], v[232:235], v[252:255], v[68:71]
  v_mfma_f32_16x16x32_bf16 v[72:75], v[236:239], v[244:247], v[72:75]
  ds_read_b128 v[204:207], v97 offset:10240
  v_mfma_f32_16x16x32_bf16 v[76:79], v[236:239], v[248:251], v[76:79]
  s_cbranch_vccz SL18
  buffer_load_dwordx4 v[172:175], v6, s[12:15], 0 offen offset:192
SL18:
  v_mfma_f32_16x16x32_bf16 v[80:83], v[236:239], v[252:255], v[80:83]
  v_mfma_f32_16x16x32_bf16 v[84:87], v[240:243], v[244:247], v[84:87]
  v_mfma_f32_16x16x32_bf16 v[88:91], v[240:243], v[248:251], v[88:91]
  v_mfma_f32_16x16x32_bf16 v[92:95], v[240:243], v[252:255], v[92:95]
  s_cmp_eq_u32 s3, 0
  s_cbranch_scc1 MK_np2
  s_waitcnt lgkmcnt(0)
  ds_read_b64_tr_b16 v[104:105], v134 offset:0
  ds_read_b64_tr_b16 v[106:107], v134 offset:256
  ds_read_b64_tr_b16 v[108:109], v134 offset:2048
  ds_read_b64_tr_b16 v[110:111], v134 offset:2304
  ds_read_b64_tr_b16 v[112:113], v134 offset:4096
  ds_read_b64_tr_b16 v[114:115], v134 offset:4352
  ds_read_b64_tr_b16 v[116:117], v134 offset:6144
  ds_read_b64_tr_b16 v[118:119], v134 offset:6400
  ds_read_b64_tr_b16 v[120:121], v134 offset:8192
  ds_read_b64_tr_b16 v[122:123], v134 offset:8448
  ds_read_b64_tr_b16 v[124:125], v134 offset:10240
  ds_read_b64_tr_b16 v[126:127], v134 offset:10496
  s_setprio 3
  s_waitcnt lgkmcnt(0)
  v_mfma_f32_16x16x32_bf16 v[128:131], v[136:139], v[104:107], 0
  v_mfma_f32_16x16x32_bf16 v[128:131], v[140:143], v[108:111], v[128:131]
  v_mfma_f32_16x16x32_bf16 v[128:131], v[144:147], v[112:115], v[128:131]
  v_mfma_f32_16x16x32_bf16 v[128:131], v[148:151], v[116:119], v[128:131]
  v_mfma_f32_16x16x32_bf16 v[128:131], v[152:155], v[120:123], v[128:131]
  v_mfma_f32_16x16x32_bf16 v[128:131], v[156:159], v[124:127], v[128:131]
  s_lshl_b32 s100, s2, 10
  s_lshl_b32 s54, s26, 3
  s_add_u32 s100, s100, s54
  s_nop 5
  v_cvt_pk_bf16_f32 v132, v128, v129
  v_cvt_pk_bf16_f32 v133, v130, v131
  buffer_store_dwordx2 v[132:133], v1, s[20:23], s100 offen sc1
  s_setprio 0
MK_np2:
  ds_read_b128 v[244:247], v100 offset:0
  ds_read_b128 v[248:251], v100 offset:2048
  ds_read_b128 v[252:255], v100 offset:4096
  ds_read_b128 v[220:223], v98 offset:0
  ds_read_b128 v[224:227], v98 offset:2048
  s_waitcnt lgkmcnt(5)
  v_mfma_f32_16x16x32_bf16 v[24:27], v[184:187], v[208:211], v[24:27]
  ds_read_b128 v[228:231], v98 offset:4096
  s_cbranch_vccz SL19
  buffer_load_dwordx4 v[176:179], v6, s[12:15], 0 offen offset:256
SL19:
  v_mfma_f32_16x16x32_bf16 v[36:39], v[188:191], v[208:211], v[36:39]
  ds_read_b128 v[232:235], v98 offset:6144
  s_waitcnt lgkmcnt(2)
  v_mfma_f32_16x16x32_bf16 v[24:27], v[220:223], v[244:247], v[24:27]
  ds_read_b128 v[236:239], v98 offset:8192
  v_mfma_f32_16x16x32_bf16 v[36:39], v[224:227], v[244:247], v[36:39]
  ds_read_b128 v[240:243], v98 offset:10240
  v_mfma_f32_16x16x32_bf16 v[28:31], v[184:187], v[212:215], v[28:31]
  s_cbranch_vccz SL20
  buffer_load_dwordx4 v[180:183], v6, s[12:15], 0 offen offset:320
SL20:
  v_mfma_f32_16x16x32_bf16 v[40:43], v[188:191], v[212:215], v[40:43]
  v_mfma_f32_16x16x32_bf16 v[28:31], v[220:223], v[248:251], v[28:31]
  v_mfma_f32_16x16x32_bf16 v[40:43], v[224:227], v[248:251], v[40:43]
  v_mfma_f32_16x16x32_bf16 v[32:35], v[184:187], v[216:219], v[32:35]
  v_cvt_pk_bf16_f32 v104, v24, v25
  v_cvt_pk_bf16_f32 v105, v26, v27
  v_mfma_f32_16x16x32_bf16 v[44:47], v[188:191], v[216:219], v[44:47]
  v_cvt_pk_bf16_f32 v106, v36, v37
  v_cvt_pk_bf16_f32 v107, v38, v39
  s_cbranch_vccz SL21
  buffer_load_dwordx4 v[136:139], v5, s[12:15], 0 offen offset:0
SL21:
  v_mfma_f32_16x16x32_bf16 v[32:35], v[220:223], v[252:255], v[32:35]
  ds_write_b128 v101, v[104:107] offset:4096
  v_mfma_f32_16x16x32_bf16 v[44:47], v[224:227], v[252:255], v[44:47]
  v_mfma_f32_16x16x32_bf16 v[48:51], v[192:195], v[208:211], v[48:51]
  v_cvt_pk_bf16_f32 v108, v28, v29
  v_cvt_pk_bf16_f32 v109, v30, v31
  v_mfma_f32_16x16x32_bf16 v[60:63], v[196:199], v[208:211], v[60:63]
  v_cvt_pk_bf16_f32 v110, v40, v41
  v_cvt_pk_bf16_f32 v111, v42, v43
  s_cbranch_vccz SL22
  buffer_load_dwordx4 v[140:143], v5, s[12:15], 0 offen offset:64
SL22:
  s_waitcnt lgkmcnt(1)
  v_mfma_f32_16x16x32_bf16 v[48:51], v[228:231], v[244:247], v[48:51]
  ds_write_b128 v102, v[108:111] offset:4096
  v_mfma_f32_16x16x32_bf16 v[60:63], v[232:235], v[244:247], v[60:63]
  v_mfma_f32_16x16x32_bf16 v[52:55], v[192:195], v[212:215], v[52:55]
  v_cvt_pk_bf16_f32 v112, v32, v33
  v_cvt_pk_bf16_f32 v113, v34, v35
  v_mfma_f32_16x16x32_bf16 v[64:67], v[196:199], v[212:215], v[64:67]
  v_cvt_pk_bf16_f32 v114, v44, v45
  v_cvt_pk_bf16_f32 v115, v46, v47
  v_mfma_f32_16x16x32_bf16 v[52:55], v[228:231], v[248:251], v[52:55]
  ds_write_b128 v103, v[112:115] offset:4096
  s_cbranch_vccz SL23
  buffer_load_dwordx4 v[144:147], v5, s[12:15], 0 offen offset:128
SL23:
  v_mfma_f32_16x16x32_bf16 v[64:67], v[232:235], v[248:251], v[64:67]
  v_mfma_f32_16x16x32_bf16 v[56:59], v[192:195], v[216:219], v[56:59]
  v_cvt_pk_bf16_f32 v116, v48, v49
  v_cvt_pk_bf16_f32 v117, v50, v51
  v_mfma_f32_16x16x32_bf16 v[68:71], v[196:199], v[216:219], v[68:71]
  v_cvt_pk_bf16_f32 v118, v60, v61
  v_cvt_pk_bf16_f32 v119, v62, v63
  v_mfma_f32_16x16x32_bf16 v[56:59], v[228:231], v[252:255], v[56:59]
  ds_write_b128 v101, v[116:119] offset:2048
  s_cbranch_vccz SL24
  buffer_load_dwordx4 v[148:151], v5, s[12:15], 0 offen offset:192
SL24:
  v_mfma_f32_16x16x32_bf16 v[68:71], v[232:235], v[252:255], v[68:71]
  v_mfma_f32_16x16x32_bf16 v[72:75], v[200:203], v[208:211], v[72:75]
  v_cvt_pk_bf16_f32 v120, v52, v53
  v_cvt_pk_bf16_f32 v121, v54, v55
  v_mfma_f32_16x16x32_bf16 v[84:87], v[204:207], v[208:211], v[84:87]
  v_cvt_pk_bf16_f32 v122, v64, v65
  v_cvt_pk_bf16_f32 v123, v66, v67
  v_mfma_f32_16x16x32_bf16 v[72:75], v[236:239], v[244:247], v[72:75]
  ds_write_b128 v102, v[120:123] offset:2048
  v_mfma_f32_16x16x32_bf16 v[84:87], v[240:243], v[244:247], v[84:87]
  s_cbranch_vccz SL25
  buffer_load_dwordx4 v[152:155], v5, s[12:15], 0 offen offset:256
SL25:
  v_mfma_f32_16x16x32_bf16 v[76:79], v[200:203], v[212:215], v[76:79]
  v_cvt_pk_bf16_f32 v124, v56, v57
  v_cvt_pk_bf16_f32 v125, v58, v59
  v_mfma_f32_16x16x32_bf16 v[88:91], v[204:207], v[212:215], v[88:91]
  v_cvt_pk_bf16_f32 v126, v68, v69
  v_cvt_pk_bf16_f32 v127, v70, v71
  v_mfma_f32_16x16x32_bf16 v[76:79], v[236:239], v[248:251], v[76:79]
  ds_write_b128 v103, v[124:127] offset:2048
  v_mfma_f32_16x16x32_bf16 v[88:91], v[240:243], v[248:251], v[88:91]
  s_cbranch_vccz SL26
  buffer_load_dwordx4 v[156:159], v5, s[12:15], 0 offen offset:320
SL26:
  v_mfma_f32_16x16x32_bf16 v[80:83], v[200:203], v[216:219], v[80:83]
  v_cvt_pk_bf16_f32 v104, v72, v73
  v_cvt_pk_bf16_f32 v105, v74, v75
  v_mfma_f32_16x16x32_bf16 v[92:95], v[204:207], v[216:219], v[92:95]
  v_cvt_pk_bf16_f32 v106, v84, v85
  v_cvt_pk_bf16_f32 v107, v86, v87
  v_mfma_f32_16x16x32_bf16 v[80:83], v[236:239], v[252:255], v[80:83]
  ds_write_b128 v101, v[104:107] offset:0
  v_mfma_f32_16x16x32_bf16 v[92:95], v[240:243], v[252:255], v[92:95]
  v_cvt_pk_bf16_f32 v108, v76, v77
  v_cvt_pk_bf16_f32 v109, v78, v79
  v_cvt_pk_bf16_f32 v110, v88, v89
  v_cvt_pk_bf16_f32 v111, v90, v91
  ds_write_b128 v102, v[108:111] offset:0
  s_nop 3
  v_cvt_pk_bf16_f32 v112, v80, v81
  v_cvt_pk_bf16_f32 v113, v82, v83
  v_cvt_pk_bf16_f32 v114, v92, v93
  v_cvt_pk_bf16_f32 v115, v94, v95
  ds_write_b128 v103, v[112:115] offset:0
  s_waitcnt lgkmcnt(0)
  s_barrier
  ds_read_b128 v[216:219], v2 offset:35840
  ds_read_b128 v[220:223], v2 offset:34816
  ds_read_b128 v[224:227], v2 offset:33792
  ds_read_b128 v[228:231], v2 offset:32768
  ds_read_b128 v[232:235], v2 offset:31744
  ds_read_b128 v[236:239], v2 offset:30720
  ds_read_b128 v[240:243], v2 offset:29696
  ds_read_b128 v[244:247], v2 offset:28672
  ds_read_b128 v[248:251], v2 offset:27648
  ds_read_b128 v[252:255], v2 offset:26624
  s_cbranch_vccz SL27
  s_mul_i32 s100, s32, 9
  s_add_i32 s100, s100, s31
  s_add_u32 m0, s38, 138240
  s_nop 0
  buffer_load_dwordx4 v13, s[12:15], s100 offen lds
  s_add_u32 m0, s38, 139264
  s_nop 0
  buffer_load_dwordx4 v14, s[12:15], s100 offen lds
  s_add_u32 m0, s38, 140288
  s_nop 0
  buffer_load_dwordx4 v3, s[12:15], s100 offen lds
  s_add_u32 m0, s39, 138240
  s_nop 0
  buffer_load_dwordx4 v4, s[12:15], s100 offen lds
  s_mul_i32 s100, s32, 8
  s_add_i32 s100, s100, s31
  s_add_u32 m0, s38, 122880
  s_nop 0
  buffer_load_dwordx4 v13, s[12:15], s100 offen lds
  s_add_u32 m0, s38, 123904
  s_nop 0
  buffer_load_dwordx4 v14, s[12:15], s100 offen lds
  s_add_u32 m0, s38, 124928
  s_nop 0
  buffer_load_dwordx4 v3, s[12:15], s100 offen lds
  s_add_u32 m0, s39, 122880
  s_nop 0
  buffer_load_dwordx4 v4, s[12:15], s100 offen lds
  v_mov_b32 v104, 0xff800000
  v_add_u32 v105, 0, v19
  v_add_u32 v106, 1, v19
  v_add_u32 v107, 2, v19
  v_add_u32 v108, 3, v19
  v_cmp_gt_u32 s[48:49], 7, v105
  v_cmp_gt_u32 s[50:51], 7, v106
  v_cmp_gt_u32 s[52:53], 7, v107
  v_cmp_gt_u32 s[54:55], 7, v108
  v_cndmask_b32 v100, v104, 0, s[48:49]
  v_cndmask_b32 v101, v104, 0, s[50:51]
  v_cndmask_b32 v102, v104, 0, s[52:53]
  v_cndmask_b32 v103, v104, 0, s[54:55]
  v_sub_u32 v105, s35, v21
  s_add_i32 s46, s34, 0
  v_sub_u32 v106, s46, v21
  s_add_i32 s46, s34, 1
  v_sub_u32 v107, s46, v21
  s_add_i32 s46, s34, 2
  v_sub_u32 v108, s46, v21
  v_cmp_gt_u32 s[48:49], 7, v105
  v_cmp_gt_u32 s[50:51], 7, v106
  v_cmp_gt_u32 s[52:53], 7, v107
  v_cmp_gt_u32 s[54:55], 7, v108
  v_cndmask_b32 v24, v104, v100, s[48:49]
  v_cndmask_b32 v25, v104, v101, s[48:49]
  v_cndmask_b32 v26, v104, v102, s[48:49]
  v_cndmask_b32 v27, v104, v103, s[48:49]
  v_cndmask_b32 v28, v104, v100, s[50:51]
  v_cndmask_b32 v29, v104, v101, s[50:51]
  v_cndmask_b32 v30, v104, v102, s[50:51]
  v_cndmask_b32 v31, v104, v103, s[50:51]
  v_cndmask_b32 v32, v104, v100, s[52:53]
  v_cndmask_b32 v33, v104, v101, s[52:53]
  v_cndmask_b32 v34, v104, v102, s[52:53]
  v_cndmask_b32 v35, v104, v103, s[52:53]
  v_cndmask_b32 v36, v104, v100, s[54:55]
  v_cndmask_b32 v37, v104, v101, s[54:55]
  v_cndmask_b32 v38, v104, v102, s[54:55]
  v_cndmask_b32 v39, v104, v103, s[54:55]
  s_add_i32 s46, s34, 3
  v_sub_u32 v105, s46, v21
  s_add_i32 s46, s34, 4
  v_sub_u32 v106, s46, v21
  s_add_i32 s46, s34, 5
  v_sub_u32 v107, s46, v21
  s_add_i32 s46, s34, 6
  v_sub_u32 v108, s46, v21
  v_cmp_gt_u32 s[48:49], 7, v105
  v_cmp_gt_u32 s[50:51], 7, v106
  v_cmp_gt_u32 s[52:53], 7, v107
  v_cmp_gt_u32 s[54:55], 7, v108
  v_cndmask_b32 v40, v104, v100, s[48:49]
  v_cndmask_b32 v41, v104, v101, s[48:49]
  v_cndmask_b32 v42, v104, v102, s[48:49]
  v_cndmask_b32 v43, v104, v103, s[48:49]
  v_cndmask_b32 v44, v104, v100, s[50:51]
  v_cndmask_b32 v45, v104, v101, s[50:51]
  v_cndmask_b32 v46, v104, v102, s[50:51]
  v_cndmask_b32 v47, v104, v103, s[50:51]
  v_cndmask_b32 v48, v104, v100, s[52:53]
  v_cndmask_b32 v49, v104, v101, s[52:53]
  v_cndmask_b32 v50, v104, v102, s[52:53]
  v_cndmask_b32 v51, v104, v103, s[52:53]
  v_cndmask_b32 v52, v104, v100, s[54:55]
  v_cndmask_b32 v53, v104, v101, s[54:55]
  v_cndmask_b32 v54, v104, v102, s[54:55]
  v_cndmask_b32 v55, v104, v103, s[54:55]
  s_add_i32 s46, s34, 1
  v_sub_u32 v105, s46, v22
  s_add_i32 s46, s34, 2
  v_sub_u32 v106, s46, v22
  s_add_i32 s46, s34, 3
  v_sub_u32 v107, s46, v22
  s_add_i32 s46, s34, 4
  v_sub_u32 v108, s46, v22
  v_cmp_gt_u32 s[48:49], 7, v105
  v_cmp_gt_u32 s[50:51], 7, v106
  v_cmp_gt_u32 s[52:53], 7, v107
  v_cmp_gt_u32 s[54:55], 7, v108
  v_cndmask_b32 v56, v104, v100, s[48:49]
  v_cndmask_b32 v57, v104, v101, s[48:49]
  v_cndmask_b32 v58, v104, v102, s[48:49]
  v_cndmask_b32 v59, v104, v103, s[48:49]
  v_cndmask_b32 v60, v104, v100, s[50:51]
  v_cndmask_b32 v61, v104, v101, s[50:51]
  v_cndmask_b32 v62, v104, v102, s[50:51]
  v_cndmask_b32 v63, v104, v103, s[50:51]
  v_cndmask_b32 v64, v104, v100, s[52:53]
  v_cndmask_b32 v65, v104, v101, s[52:53]
  v_cndmask_b32 v66, v104, v102, s[52:53]
  v_cndmask_b32 v67, v104, v103, s[52:53]
  v_cndmask_b32 v68, v104, v100, s[54:55]
  v_cndmask_b32 v69, v104, v101, s[54:55]
  v_cndmask_b32 v70, v104, v102, s[54:55]
  v_cndmask_b32 v71, v104, v103, s[54:55]
  s_add_i32 s46, s34, 5
  v_sub_u32 v105, s46, v22
  s_add_i32 s46, s34, 6
  v_sub_u32 v106, s46, v22
  s_add_i32 s46, s34, 7
  v_sub_u32 v107, s46, v22
  s_add_i32 s46, s34, 8
  v_sub_u32 v108, s46, v22
  v_cmp_gt_u32 s[48:49], 7, v105
  v_cmp_gt_u32 s[50:51], 7, v106
  v_cmp_gt_u32 s[52:53], 7, v107
  v_cmp_gt_u32 s[54:55], 7, v108
  v_cndmask_b32 v72, v104, v100, s[48:49]
  v_cndmask_b32 v73, v104, v101, s[48:49]
  v_cndmask_b32 v74, v104, v102, s[48:49]
  v_cndmask_b32 v75, v104, v103, s[48:49]
  v_cndmask_b32 v76, v104, v100, s[50:51]
  v_cndmask_b32 v77, v104, v101, s[50:51]
  v_cndmask_b32 v78, v104, v102, s[50:51]
  v_cndmask_b32 v79, v104, v103, s[50:51]
  v_cndmask_b32 v80, v104, v100, s[52:53]
  v_cndmask_b32 v81, v104, v101, s[52:53]
  v_cndmask_b32 v82, v104, v102, s[52:53]
  v_cndmask_b32 v83, v104, v103, s[52:53]
  v_cndmask_b32 v84, v104, v100, s[54:55]
  v_cndmask_b32 v85, v104, v101, s[54:55]
  v_cndmask_b32 v86, v104, v102, s[54:55]
  v_cndmask_b32 v87, v104, v103, s[54:55]
  s_waitcnt vmcnt(8)
  s_branch SM27
SL27:
  s_cmp_lg_u32 s25, 0
  s_cbranch_scc1 MK_z1
  v_mov_b32 v136, 0
  v_mov_b32 v137, 0
  v_mov_b32 v138, 0
  v_mov_b32 v139, 0
  v_mov_b32 v140, 0
  v_mov_b32 v141, 0
  v_mov_b32 v142, 0
  v_mov_b32 v143, 0
  v_mov_b32 v144, 0
  v_mov_b32 v145, 0
  v_mov_b32 v146, 0
  v_mov_b32 v147, 0
  v_mov_b32 v148, 0
  v_mov_b32 v149, 0
  v_mov_b32 v150, 0
  v_mov_b32 v151, 0
  v_mov_b32 v152, 0
  v_mov_b32 v153, 0
  v_mov_b32 v154, 0
  v_mov_b32 v155, 0
  v_mov_b32 v156, 0
  v_mov_b32 v157, 0
  v_mov_b32 v158, 0
  v_mov_b32 v159, 0
MK_z1:
  s_cmp_lg_u32 s3, 0
  s_cbranch_scc1 MK_np4
  s_waitcnt vmcnt(0)
MK_np4:
  s_waitcnt vmcnt(1)
  s_setprio 1
SM27:
  s_waitcnt lgkmcnt(8)
  v_mfma_f32_16x16x32_bf16 v[184:187], v[216:219], v[136:139], 0
  v_mfma_f32_16x16x32_bf16 v[192:195], v[216:219], v[160:163], 0
  ds_read_b128 v[216:219], v2 offset:25600
  v_mfma_f32_16x16x32_bf16 v[188:191], v[220:223], v[136:139], 0
  v_mfma_f32_16x16x32_bf16 v[196:199], v[220:223], v[160:163], 0
  ds_read_b128 v[220:223], v2 offset:24576
  s_waitcnt lgkmcnt(8)
  v_mfma_f32_16x16x32_bf16 v[184:187], v[224:227], v[140:143], v[184:187]
  v_mfma_f32_16x16x32_bf16 v[192:195], v[224:227], v[164:167], v[192:195]
  ds_read_b128 v[224:227], v2 offset:23552
  v_mfma_f32_16x16x32_bf16 v[188:191], v[228:231], v[140:143], v[188:191]
  v_mfma_f32_16x16x32_bf16 v[196:199], v[228:231], v[164:167], v[196:199]
  ds_read_b128 v[228:231], v2 offset:22528
  s_waitcnt lgkmcnt(8)
  v_mfma_f32_16x16x32_bf16 v[184:187], v[232:235], v[144:147], v[184:187]
  v_mfma_f32_16x16x32_bf16 v[192:195], v[232:235], v[168:171], v[192:195]
  ds_read_b128 v[232:235], v2 offset:21504
  v_mfma_f32_16x16x32_bf16 v[188:191], v[236:239], v[144:147], v[188:191]
  v_mfma_f32_16x16x32_bf16 v[196:199], v[236:239], v[168:171], v[196:199]
  ds_read_b128 v[236:239], v2 offset:20480
  s_waitcnt lgkmcnt(8)
  v_mfma_f32_16x16x32_bf16 v[184:187], v[240:243], v[148:151], v[184:187]
  v_mfma_f32_16x16x32_bf16 v[192:195], v[240:243], v[172:175], v[192:195]
  ds_read_b128 v[240:243], v2 offset:19456
  v_mfma_f32_16x16x32_bf16 v[188:191], v[244:247], v[148:151], v[188:191]
  v_mfma_f32_16x16x32_bf16 v[196:199], v[244:247], v[172:175], v[196:199]
  ds_read_b128 v[244:247], v2 offset:18432
  s_waitcnt lgkmcnt(8)
  v_mfma_f32_16x16x32_bf16 v[184:187], v[248:251], v[152:155], v[184:187]
  v_mfma_f32_16x16x32_bf16 v[192:195], v[248:251], v[176:179], v[192:195]
  ds_read_b128 v[248:251], v2 offset:17408
  v_mfma_f32_16x16x32_bf16 v[188:191], v[252:255], v[152:155], v[188:191]
  v_mfma_f32_16x16x32_bf16 v[196:199], v[252:255], v[176:179], v[196:199]
  ds_read_b128 v[252:255], v2 offset:16384
  s_waitcnt lgkmcnt(8)
  v_mfma_f32_16x16x32_bf16 v[184:187], v[216:219], v[156:159], v[184:187]
  v_mfma_f32_16x16x32_bf16 v[192:195], v[216:219], v[180:183], v[192:195]
  ds_read_b128 v[216:219], v2 offset:15360
  v_mfma_f32_16x16x32_bf16 v[188:191], v[220:223], v[156:159], v[188:191]
  v_mfma_f32_16x16x32_bf16 v[196:199], v[220:223], v[180:183], v[196:199]
  ds_read_b128 v[220:223], v2 offset:14336
  s_waitcnt lgkmcnt(8)
  v_mfma_f32_16x16x32_bf16 v[200:203], v[224:227], v[136:139], 0
  v_mfma_f32_16x16x32_bf16 v[208:211], v[224:227], v[160:163], 0
  ds_read_b128 v[224:227], v2 offset:13312
  v_mul_f32 v192, s93, v192
  v_mfma_f32_16x16x32_bf16 v[204:207], v[228:231], v[136:139], 0
  v_mul_f32 v193, s93, v193
  v_mul_f32 v194, s93, v194
  v_mfma_f32_16x16x32_bf16 v[212:215], v[228:231], v[160:163], 0
  ds_read_b128 v[228:231], v2 offset:12288
  s_waitcnt lgkmcnt(8)
  v_mfma_f32_16x16x32_bf16 v[200:203], v[232:235], v[140:143], v[200:203]
  v_mul_f32 v195, s93, v195
  v_mul_f32 v196, s93, v196
  v_mfma_f32_16x16x32_bf16 v[208:211], v[232:235], v[164:167], v[208:211]
  ds_read_b128 v[232:235], v2 offset:11264
  v_mul_f32 v197, s93, v197
  v_mfma_f32_16x16x32_bf16 v[204:207], v[236:239], v[140:143], v[204:207]
  v_mul_f32 v198, s93, v198
  v_mul_f32 v199, s93, v199
  v_mfma_f32_16x16x32_bf16 v[212:215], v[236:239], v[164:167], v[212:215]
  ds_read_b128 v[236:239], v2 offset:10240
  s_waitcnt lgkmcnt(8)
  v_mfma_f32_16x16x32_bf16 v[200:203], v[240:243], v[144:147], v[200:203]
  v_cvt_pk_bf16_f32 v112, v192, v193
  v_cvt_pk_bf16_f32 v113, v194, v195
  v_mfma_f32_16x16x32_bf16 v[208:211], v[240:243], v[168:171], v[208:211]
  ds_read_b128 v[240:243], v2 offset:9216
  v_cvt_pk_bf16_f32 v114, v196, v197
  v_mfma_f32_16x16x32_bf16 v[204:207], v[244:247], v[144:147], v[204:207]
  v_cvt_pk_bf16_f32 v115, v198, v199
  v_mul_f32 v184, s93, v184
  v_mfma_f32_16x16x32_bf16 v[212:215], v[244:247], v[168:171], v[212:215]
  ds_read_b128 v[244:247], v2 offset:8192
  s_waitcnt lgkmcnt(8)
  v_mfma_f32_16x16x32_bf16 v[200:203], v[248:251], v[148:151], v[200:203]
  v_mul_f32 v185, s93, v185
  v_mul_f32 v186, s93, v186
  v_mfma_f32_16x16x32_bf16 v[208:211], v[248:251], v[172:175], v[208:211]
  ds_read_b128 v[248:251], v2 offset:7168
  v_mul_f32 v187, s93, v187
  v_mfma_f32_16x16x32_bf16 v[204:207], v[252:255], v[148:151], v[204:207]
  v_mul_f32 v188, s93, v188
  v_mul_f32 v189, s93, v189
  v_mfma_f32_16x16x32_bf16 v[212:215], v[252:255], v[172:175], v[212:215]
  ds_read_b128 v[252:255], v2 offset:6144
  s_waitcnt lgkmcnt(8)
  v_mfma_f32_16x16x32_bf16 v[200:203], v[216:219], v[152:155], v[200:203]
  v_mul_f32 v190, s93, v190
  v_mul_f32 v191, s93, v191
  v_mfma_f32_16x16x32_bf16 v[208:211], v[216:219], v[176:179], v[208:211]
  ds_read_b128 v[216:219], v2 offset:5120
  v_cvt_pk_bf16_f32 v88, v184, v185
  v_mfma_f32_16x16x32_bf16 v[204:207], v[220:223], v[152:155], v[204:207]
  v_cvt_pk_bf16_f32 v89, v186, v187
  v_cvt_pk_bf16_f32 v90, v188, v189
  v_mfma_f32_16x16x32_bf16 v[212:215], v[220:223], v[176:179], v[212:215]
  ds_read_b128 v[220:223], v2 offset:4096
  s_waitcnt lgkmcnt(8)
  v_mfma_f32_16x16x32_bf16 v[200:203], v[224:227], v[156:159], v[200:203]
  v_cvt_pk_bf16_f32 v91, v190, v191
  v_mfma_f32_16x16x32_bf16 v[208:211], v[224:227], v[180:183], v[208:211]
  ds_read_b128 v[224:227], v2 offset:3072
  v_mfma_f32_16x16x32_bf16 v[204:207], v[228:231], v[156:159], v[204:207]
  v_mfma_f32_16x16x32_bf16 v[212:215], v[228:231], v[180:183], v[212:215]
  ds_read_b128 v[228:231], v2 offset:2048
  s_waitcnt lgkmcnt(8)
  v_mfma_f32_16x16x32_bf16 v[184:187], v[232:235], v[136:139], 0
  v_mul_f32 v200, s93, v200
  v_mul_f32 v201, s93, v201
  v_mfma_f32_16x16x32_bf16 v[192:195], v[232:235], v[160:163], 0
  ds_read_b128 v[232:235], v2 offset:1024
  v_mul_f32 v208, s93, v208
  v_mfma_f32_16x16x32_bf16 v[188:191], v[236:239], v[136:139], 0
  v_mul_f32 v209, s93, v209
  v_mul_f32 v210, s93, v210
  v_mfma_f32_16x16x32_bf16 v[196:199], v[236:239], v[160:163], 0
  ds_read_b128 v[236:239], v2 offset:0
  s_waitcnt lgkmcnt(8)
  v_mfma_f32_16x16x32_bf16 v[184:187], v[240:243], v[140:143], v[184:187]
  v_mul_f32 v211, s93, v211
  v_mul_f32 v212, s93, v212
  v_mfma_f32_16x16x32_bf16 v[192:195], v[240:243], v[164:167], v[192:195]
  ds_read_b128 v[240:243], v1 offset:35840
  v_mul_f32 v213, s93, v213
  v_mfma_f32_16x16x32_bf16 v[188:191], v[244:247], v[140:143], v[188:191]
  v_mul_f32 v214, s93, v214
  v_mul_f32 v215, s93, v215
  v_mfma_f32_16x16x32_bf16 v[196:199], v[244:247], v[164:167], v[196:199]
  ds_read_b128 v[244:247], v1 offset:34816
  s_waitcnt lgkmcnt(8)
  v_mfma_f32_16x16x32_bf16 v[184:187], v[248:251], v[144:147], v[184:187]
  v_cvt_pk_bf16_f32 v116, v208, v209
  v_cvt_pk_bf16_f32 v117, v210, v211
  v_mfma_f32_16x16x32_bf16 v[192:195], v[248:251], v[168:171], v[192:195]
  ds_read_b128 v[248:251], v1 offset:33792
  v_cvt_pk_bf16_f32 v118, v212, v213
  v_mfma_f32_16x16x32_bf16 v[188:191], v[252:255], v[144:147], v[188:191]
  v_cvt_pk_bf16_f32 v119, v214, v215
  v_mul_f32 v202, s93, v202
  v_mfma_f32_16x16x32_bf16 v[196:199], v[252:255], v[168:171], v[196:199]
  ds_read_b128 v[252:255], v1 offset:32768
  s_waitcnt lgkmcnt(8)
  v_mfma_f32_16x16x32_bf16 v[184:187], v[216:219], v[148:151], v[184:187]
  v_mul_f32 v203, s93, v203
  v_mul_f32 v204, s93, v204
  v_mfma_f32_16x16x32_bf16 v[192:195], v[216:219], v[172:175], v[192:195]
  ds_read_b128 v[216:219], v1 offset:31744
  v_mul_f32 v205, s93, v205
  s_cbranch_vccz SL28
  s_barrier
  s_branch SM28
SL28:
  s_cmp_eq_u32 s3, 0
  s_cbranch_scc1 MK_np5
  s_waitcnt vmcnt(0)
  v_mov_b32 v23, 1
  s_mov_b64 exec, 1
  buffer_atomic_add v23, off, s[8:11], 0 sc1
  s_mov_b64 exec, -1
  s_nop 3
MK_np5:
SM28:
  v_mfma_f32_16x16x32_bf16 v[188:191], v[220:223], v[148:151], v[188:191]
  v_mul_f32 v206, s93, v206
  v_mul_f32 v207, s93, v207
  v_mfma_f32_16x16x32_bf16 v[196:199], v[220:223], v[172:175], v[196:199]
  ds_read_b128 v[220:223], v1 offset:30720
  s_waitcnt lgkmcnt(8)
  v_mfma_f32_16x16x32_bf16 v[184:187], v[224:227], v[152:155], v[184:187]
  v_cvt_pk_bf16_f32 v92, v200, v201
  v_cvt_pk_bf16_f32 v93, v202, v203
  v_mfma_f32_16x16x32_bf16 v[192:195], v[224:227], v[176:179], v[192:195]
  ds_read_b128 v[224:227], v1 offset:29696
  v_cvt_pk_bf16_f32 v94, v204, v205
  v_mfma_f32_16x16x32_bf16 v[188:191], v[228:231], v[152:155], v[188:191]
  v_cvt_pk_bf16_f32 v95, v206, v207
  v_mfma_f32_16x16x32_bf16 v[196:199], v[228:231], v[176:179], v[196:199]
  ds_read_b128 v[228:231], v1 offset:28672
  s_waitcnt lgkmcnt(8)
  v_mfma_f32_16x16x32_bf16 v[184:187], v[232:235], v[156:159], v[184:187]
  v_mfma_f32_16x16x32_bf16 v[192:195], v[232:235], v[180:183], v[192:195]
  ds_read_b128 v[232:235], v1 offset:27648
  v_mfma_f32_16x16x32_bf16 v[188:191], v[236:239], v[156:159], v[188:191]
  v_mfma_f32_16x16x32_bf16 v[196:199], v[236:239], v[180:183], v[196:199]
  ds_read_b128 v[236:239], v1 offset:26624
  s_waitcnt lgkmcnt(8)
  v_mfma_f32_16x16x32_bf16 v[200:203], v[240:243], v[136:139], 0
  v_mfma_f32_16x16x32_bf16 v[208:211], v[240:243], v[160:163], 0
  ds_read_b128 v[240:243], v1 offset:25600
  v_mul_f32 v192, s93, v192
  v_mfma_f32_16x16x32_bf16 v[204:207], v[244:247], v[136:139], 0
  v_mul_f32 v193, s93, v193
  v_mul_f32 v194, s93, v194
  v_mfma_f32_16x16x32_bf16 v[212:215], v[244:247], v[160:163], 0
  ds_read_b128 v[244:247], v1 offset:24576
  s_waitcnt lgkmcnt(8)
  v_mfma_f32_16x16x32_bf16 v[200:203], v[248:251], v[140:143], v[200:203]
  v_mul_f32 v195, s93, v195
  v_mul_f32 v196, s93, v196
  v_mfma_f32_16x16x32_bf16 v[208:211], v[248:251], v[164:167], v[208:211]
  ds_read_b128 v[248:251], v1 offset:23552
  v_mul_f32 v197, s93, v197
  v_mfma_f32_16x16x32_bf16 v[204:207], v[252:255], v[140:143], v[204:207]
  v_mul_f32 v198, s93, v198
  v_mul_f32 v199, s93, v199
  v_mfma_f32_16x16x32_bf16 v[212:215], v[252:255], v[164:167], v[212:215]
  ds_read_b128 v[252:255], v1 offset:22528
  s_waitcnt lgkmcnt(8)
  v_mfma_f32_16x16x32_bf16 v[200:203], v[216:219], v[144:147], v[200:203]
  v_cvt_pk_bf16_f32 v120, v192, v193
  v_cvt_pk_bf16_f32 v121, v194, v195
  v_mfma_f32_16x16x32_bf16 v[208:211], v[216:219], v[168:171], v[208:211]
  ds_read_b128 v[216:219], v1 offset:21504
  v_cvt_pk_bf16_f32 v122, v196, v197
  v_mfma_f32_16x16x32_bf16 v[204:207], v[220:223], v[144:147], v[204:207]
  v_cvt_pk_bf16_f32 v123, v198, v199
  v_mul_f32 v184, s93, v184
  v_mfma_f32_16x16x32_bf16 v[212:215], v[220:223], v[168:171], v[212:215]
  ds_read_b128 v[220:223], v1 offset:20480
  s_waitcnt lgkmcnt(8)
  v_mfma_f32_16x16x32_bf16 v[200:203], v[224:227], v[148:151], v[200:203]
  v_mul_f32 v185, s93, v185
  v_mul_f32 v186, s93, v186
  v_mfma_f32_16x16x32_bf16 v[208:211], v[224:227], v[172:175], v[208:211]
  ds_read_b128 v[224:227], v1 offset:19456
  v_mul_f32 v187, s93, v187
  v_mfma_f32_16x16x32_bf16 v[204:207], v[228:231], v[148:151], v[204:207]
  v_mul_f32 v188, s93, v188
  v_mul_f32 v189, s93, v189
  v_mfma_f32_16x16x32_bf16 v[212:215], v[228:231], v[172:175], v[212:215]
  ds_read_b128 v[228:231], v1 offset:18432
  s_waitcnt lgkmcnt(8)
  v_mfma_f32_16x16x32_bf16 v[200:203], v[232:235], v[152:155], v[200:203]
  v_mul_f32 v190, s93, v190
  v_mul_f32 v191, s93, v191
  v_mfma_f32_16x16x32_bf16 v[208:211], v[232:235], v[176:179], v[208:211]
  ds_read_b128 v[232:235], v1 offset:17408
  v_cvt_pk_bf16_f32 v96, v184, v185
  v_mfma_f32_16x16x32_bf16 v[204:207], v[236:239], v[152:155], v[204:207]
  v_cvt_pk_bf16_f32 v97, v186, v187
  v_cvt_pk_bf16_f32 v98, v188, v189
  v_mfma_f32_16x16x32_bf16 v[212:215], v[236:239], v[176:179], v[212:215]
  ds_read_b128 v[236:239], v1 offset:16384
  s_waitcnt lgkmcnt(8)
  v_mfma_f32_16x16x32_bf16 v[200:203], v[240:243], v[156:159], v[200:203]
  v_cvt_pk_bf16_f32 v99, v190, v191
  v_mfma_f32_16x16x32_bf16 v[208:211], v[240:243], v[180:183], v[208:211]
  ds_read_b128 v[240:243], v1 offset:15360
  v_mfma_f32_16x16x32_bf16 v[204:207], v[244:247], v[156:159], v[204:207]
  v_mfma_f32_16x16x32_bf16 v[212:215], v[244:247], v[180:183], v[212:215]
  ds_read_b128 v[244:247], v1 offset:14336
  s_waitcnt lgkmcnt(8)
  v_mfma_f32_16x16x32_bf16 v[184:187], v[248:251], v[136:139], 0
  v_mul_f32 v200, s93, v200
  v_mul_f32 v201, s93, v201
  v_mfma_f32_16x16x32_bf16 v[192:195], v[248:251], v[160:163], 0
  ds_read_b128 v[248:251], v1 offset:13312
  v_mul_f32 v208, s93, v208
  v_mfma_f32_16x16x32_bf16 v[188:191], v[252:255], v[136:139], 0
  v_mul_f32 v209, s93, v209
  v_mul_f32 v210, s93, v210
  v_mfma_f32_16x16x32_bf16 v[196:199], v[252:255], v[160:163], 0
  ds_read_b128 v[252:255], v1 offset:12288
  s_waitcnt lgkmcnt(8)
  v_mfma_f32_16x16x32_bf16 v[184:187], v[216:219], v[140:143], v[184:187]
  v_mul_f32 v211, s93, v211
  v_mul_f32 v212, s93, v212
  v_mfma_f32_16x16x32_bf16 v[192:195], v[216:219], v[164:167], v[192:195]
  ds_read_b128 v[216:219], v1 offset:11264
  v_mul_f32 v213, s93, v213
  v_mfma_f32_16x16x32_bf16 v[188:191], v[220:223], v[140:143], v[188:191]
  v_mul_f32 v214, s93, v214
  v_mul_f32 v215, s93, v215
  v_mfma_f32_16x16x32_bf16 v[196:199], v[220:223], v[164:167], v[196:199]
  ds_read_b128 v[220:223], v1 offset:10240
  s_waitcnt lgkmcnt(8)
  v_mfma_f32_16x16x32_bf16 v[184:187], v[224:227], v[144:147], v[184:187]
  v_cvt_pk_bf16_f32 v124, v208, v209
  v_cvt_pk_bf16_f32 v125, v210, v211
  v_mfma_f32_16x16x32_bf16 v[192:195], v[224:227], v[168:171], v[192:195]
  ds_read_b128 v[224:227], v1 offset:9216
  v_cvt_pk_bf16_f32 v126, v212, v213
  v_mfma_f32_16x16x32_bf16 v[188:191], v[228:231], v[144:147], v[188:191]
  v_cvt_pk_bf16_f32 v127, v214, v215
  v_mul_f32 v202, s93, v202
  v_mfma_f32_16x16x32_bf16 v[196:199], v[228:231], v[168:171], v[196:199]
  ds_read_b128 v[228:231], v1 offset:8192
  s_waitcnt lgkmcnt(8)
  v_mfma_f32_16x16x32_bf16 v[184:187], v[232:235], v[148:151], v[184:187]
  v_mul_f32 v203, s93, v203
  v_mul_f32 v204, s93, v204
  v_mfma_f32_16x16x32_bf16 v[192:195], v[232:235], v[172:175], v[192:195]
  ds_read_b128 v[232:235], v1 offset:7168
  v_mul_f32 v205, s93, v205
  v_mfma_f32_16x16x32_bf16 v[188:191], v[236:239], v[148:151], v[188:191]
  v_mul_f32 v206, s93, v206
  v_mul_f32 v207, s93, v207
  v_mfma_f32_16x16x32_bf16 v[196:199], v[236:239], v[172:175], v[196:199]
  ds_read_b128 v[236:239], v1 offset:6144
  s_waitcnt lgkmcnt(8)
  v_mfma_f32_16x16x32_bf16 v[184:187], v[240:243], v[152:155], v[184:187]
  v_cvt_pk_bf16_f32 v100, v200, v201
  v_cvt_pk_bf16_f32 v101, v202, v203
  v_mfma_f32_16x16x32_bf16 v[192:195], v[240:243], v[176:179], v[192:195]
  ds_read_b128 v[240:243], v1 offset:5120
  v_cvt_pk_bf16_f32 v102, v204, v205
  v_mfma_f32_16x16x32_bf16 v[188:191], v[244:247], v[152:155], v[188:191]
  v_cvt_pk_bf16_f32 v103, v206, v207
  v_mfma_f32_16x16x32_bf16 v[196:199], v[244:247], v[176:179], v[196:199]
  ds_read_b128 v[244:247], v1 offset:4096
  s_waitcnt lgkmcnt(8)
  v_mfma_f32_16x16x32_bf16 v[184:187], v[248:251], v[156:159], v[184:187]
  v_mfma_f32_16x16x32_bf16 v[192:195], v[248:251], v[180:183], v[192:195]
  ds_read_b128 v[248:251], v1 offset:3072
  v_mfma_f32_16x16x32_bf16 v[188:191], v[252:255], v[156:159], v[188:191]
  v_mfma_f32_16x16x32_bf16 v[196:199], v[252:255], v[180:183], v[196:199]
  ds_read_b128 v[252:255], v1 offset:2048
  s_waitcnt lgkmcnt(8)
  v_mfma_f32_16x16x32_bf16 v[200:203], v[216:219], v[136:139], 0
  v_mfma_f32_16x16x32_bf16 v[208:211], v[216:219], v[160:163], 0
  ds_read_b128 v[216:219], v1 offset:1024
  v_mul_f32 v192, s93, v192
  s_cbranch_vccz SL29
  s_waitcnt vmcnt(0)
  s_barrier
SL29:
  v_mfma_f32_16x16x32_bf16 v[204:207], v[220:223], v[136:139], 0
  v_mul_f32 v193, s93, v193
  v_mul_f32 v194, s93, v194
  v_mfma_f32_16x16x32_bf16 v[212:215], v[220:223], v[160:163], 0
  ds_read_b128 v[220:223], v1 offset:0
  s_waitcnt lgkmcnt(8)
  v_mfma_f32_16x16x32_bf16 v[200:203], v[224:227], v[140:143], v[200:203]
  v_mul_f32 v195, s93, v195
  v_mul_f32 v196, s93, v196
  v_mfma_f32_16x16x32_bf16 v[208:211], v[224:227], v[164:167], v[208:211]
  v_mul_f32 v197, s93, v197
  v_mul_f32 v198, s93, v198
  v_mfma_f32_16x16x32_bf16 v[204:207], v[228:231], v[140:143], v[204:207]
  v_mul_f32 v199, s93, v199
  v_cvt_pk_bf16_f32 v128, v192, v193
  v_mfma_f32_16x16x32_bf16 v[212:215], v[228:231], v[164:167], v[212:215]
  v_cvt_pk_bf16_f32 v129, v194, v195
  s_waitcnt lgkmcnt(6)
  v_mfma_f32_16x16x32_bf16 v[200:203], v[232:235], v[144:147], v[200:203]
  v_cvt_pk_bf16_f32 v130, v196, v197
  v_cvt_pk_bf16_f32 v131, v198, v199
  v_mfma_f32_16x16x32_bf16 v[208:211], v[232:235], v[168:171], v[208:211]
  v_mul_f32 v184, s93, v184
  v_mul_f32 v185, s93, v185
  v_mfma_f32_16x16x32_bf16 v[204:207], v[236:239], v[144:147], v[204:207]
  v_mul_f32 v186, s93, v186
  v_mul_f32 v187, s93, v187
  v_mfma_f32_16x16x32_bf16 v[212:215], v[236:239], v[168:171], v[212:215]
  v_mul_f32 v188, s93, v188
  s_waitcnt lgkmcnt(5)
  v_mfma_f32_16x16x32_bf16 v[200:203], v[240:243], v[148:151], v[200:203]
  v_mul_f32 v189, s93, v189
  v_mul_f32 v190, s93, v190
  v_mfma_f32_16x16x32_bf16 v[208:211], v[240:243], v[172:175], v[208:211]
  v_mul_f32 v191, s93, v191
  s_waitcnt lgkmcnt(4)
  v_mfma_f32_16x16x32_bf16 v[204:207], v[244:247], v[148:151], v[204:207]
  v_cvt_pk_bf16_f32 v104, v184, v185
  v_cvt_pk_bf16_f32 v105, v186, v187
  v_mfma_f32_16x16x32_bf16 v[212:215], v[244:247], v[172:175], v[212:215]
  v_cvt_pk_bf16_f32 v106, v188, v189
  s_waitcnt lgkmcnt(3)
  v_mfma_f32_16x16x32_bf16 v[200:203], v[248:251], v[152:155], v[200:203]
  v_cvt_pk_bf16_f32 v107, v190, v191
  v_mfma_f32_16x16x32_bf16 v[208:211], v[248:251], v[176:179], v[208:211]
  s_waitcnt lgkmcnt(2)
  v_mfma_f32_16x16x32_bf16 v[204:207], v[252:255], v[152:155], v[204:207]
  v_mfma_f32_16x16x32_bf16 v[212:215], v[252:255], v[176:179], v[212:215]
  s_waitcnt lgkmcnt(1)
  v_mfma_f32_16x16x32_bf16 v[200:203], v[216:219], v[156:159], v[200:203]
  v_mfma_f32_16x16x32_bf16 v[208:211], v[216:219], v[180:183], v[208:211]
  s_waitcnt lgkmcnt(0)
  v_mfma_f32_16x16x32_bf16 v[204:207], v[220:223], v[156:159], v[204:207]
  v_mfma_f32_16x16x32_bf16 v[212:215], v[220:223], v[180:183], v[212:215]
  s_cbranch_vccnz SL30
  s_setprio 0
  s_mul_i32 s100, s32, 7
  s_add_i32 s100, s100, s31
  s_add_u32 m0, s38, 107520
  s_nop 0
  buffer_load_dwordx4 v13, s[12:15], s100 offen lds
  s_add_u32 m0, s38, 108544
  s_nop 0
  buffer_load_dwordx4 v14, s[12:15], s100 offen lds
  s_add_u32 m0, s38, 109568
  s_nop 0
  buffer_load_dwordx4 v3, s[12:15], s100 offen lds
  s_add_u32 m0, s39, 107520
  s_nop 0
  buffer_load_dwordx4 v4, s[12:15], s100 offen lds
  s_mul_i32 s100, s32, 6
  s_add_i32 s100, s100, s31
  s_add_u32 m0, s38, 92160
  s_nop 0
  buffer_load_dwordx4 v13, s[12:15], s100 offen lds
  s_add_u32 m0, s38, 93184
  s_nop 0
  buffer_load_dwordx4 v14, s[12:15], s100 offen lds
  s_add_u32 m0, s38, 94208
  s_nop 0
  buffer_load_dwordx4 v3, s[12:15], s100 offen lds
  s_add_u32 m0, s39, 92160
  s_nop 0
  buffer_load_dwordx4 v4, s[12:15], s100 offen lds
  s_mul_i32 s100, s32, 5
  s_add_i32 s100, s100, s31
  s_add_u32 m0, s38, 76800
  s_nop 0
  buffer_load_dwordx4 v13, s[12:15], s100 offen lds
  s_add_u32 m0, s38, 77824
  s_nop 0
  buffer_load_dwordx4 v14, s[12:15], s100 offen lds
  s_add_u32 m0, s38, 78848
  s_nop 0
  buffer_load_dwordx4 v3, s[12:15], s100 offen lds
  s_add_u32 m0, s39, 76800
  s_nop 0
  buffer_load_dwordx4 v4, s[12:15], s100 offen lds
  s_barrier
  s_mul_i32 s100, s32, 4
  s_add_i32 s100, s100, s31
  s_add_u32 m0, s38, 61440
  s_nop 0
  buffer_load_dwordx4 v13, s[12:15], s100 offen lds
  s_add_u32 m0, s38, 62464
  s_nop 0
  buffer_load_dwordx4 v14, s[12:15], s100 offen lds
  s_add_u32 m0, s38, 63488
  s_nop 0
  buffer_load_dwordx4 v3, s[12:15], s100 offen lds
  s_add_u32 m0, s39, 61440
  s_nop 0
  buffer_load_dwordx4 v4, s[12:15], s100 offen lds
  s_mul_i32 s100, s32, 3
  s_add_i32 s100, s100, s31
  s_add_u32 m0, s38, 46080
  s_nop 0
  buffer_load_dwordx4 v13, s[12:15], s100 offen lds
  s_add_u32 m0, s38, 47104
  s_nop 0
  buffer_load_dwordx4 v14, s[12:15], s100 offen lds
  s_add_u32 m0, s38, 48128
  s_nop 0
  buffer_load_dwordx4 v3, s[12:15], s100 offen lds
  s_add_u32 m0, s39, 46080
  s_nop 0
  buffer_load_dwordx4 v4, s[12:15], s100 offen lds
  s_mul_i32 s100, s32, 2
  s_add_i32 s100, s100, s31
  s_add_u32 m0, s38, 30720
  s_nop 0
  buffer_load_dwordx4 v13, s[12:15], s100 offen lds
  s_add_u32 m0, s38, 31744
  s_nop 0
  buffer_load_dwordx4 v14, s[12:15], s100 offen lds
  s_add_u32 m0, s38, 32768
  s_nop 0
  buffer_load_dwordx4 v3, s[12:15], s100 offen lds
  s_add_u32 m0, s39, 30720
  s_nop 0
  buffer_load_dwordx4 v4, s[12:15], s100 offen lds
  v_mov_b32 v140, 0xff800000
  v_add_u32 v141, 0, v19
  v_add_u32 v142, 1, v19
  v_add_u32 v143, 2, v19
  v_add_u32 v144, 3, v19
  v_cmp_gt_u32 s[48:49], 7, v141
  v_cmp_gt_u32 s[50:51], 7, v142
  v_cmp_gt_u32 s[52:53], 7, v143
  v_cmp_gt_u32 s[54:55], 7, v144
  v_cndmask_b32 v136, v140, 0, s[48:49]
  v_cndmask_b32 v137, v140, 0, s[50:51]
  v_cndmask_b32 v138, v140, 0, s[52:53]
  v_cndmask_b32 v139, v140, 0, s[54:55]
  v_sub_u32 v141, s35, v21
  s_add_i32 s46, s34, 0
  v_sub_u32 v142, s46, v21
  s_add_i32 s46, s34, 1
  v_sub_u32 v143, s46, v21
  s_add_i32 s46, s34, 2
  v_sub_u32 v144, s46, v21
  v_cmp_gt_u32 s[48:49], 7, v141
  v_cmp_gt_u32 s[50:51], 7, v142
  v_cmp_gt_u32 s[52:53], 7, v143
  v_cmp_gt_u32 s[54:55], 7, v144
  v_cndmask_b32 v24, v140, v136, s[48:49]
  v_cndmask_b32 v25, v140, v137, s[48:49]
  v_cndmask_b32 v26, v140, v138, s[48:49]
  v_cndmask_b32 v27, v140, v139, s[48:49]
  v_cndmask_b32 v28, v140, v136, s[50:51]
  v_cndmask_b32 v29, v140, v137, s[50:51]
  v_cndmask_b32 v30, v140, v138, s[50:51]
  v_cndmask_b32 v31, v140, v139, s[50:51]
  v_cndmask_b32 v32, v140, v136, s[52:53]
  v_cndmask_b32 v33, v140, v137, s[52:53]
  v_cndmask_b32 v34, v140, v138, s[52:53]
  v_cndmask_b32 v35, v140, v139, s[52:53]
  v_cndmask_b32 v36, v140, v136, s[54:55]
  v_cndmask_b32 v37, v140, v137, s[54:55]
  v_cndmask_b32 v38, v140, v138, s[54:55]
  v_cndmask_b32 v39, v140, v139, s[54:55]
  s_add_i32 s46, s34, 3
  v_sub_u32 v141, s46, v21
  s_add_i32 s46, s34, 4
  v_sub_u32 v142, s46, v21
  s_add_i32 s46, s34, 5
  v_sub_u32 v143, s46, v21
  s_add_i32 s46, s34, 6
  v_sub_u32 v144, s46, v21
  v_cmp_gt_u32 s[48:49], 7, v141
  v_cmp_gt_u32 s[50:51], 7, v142
  v_cmp_gt_u32 s[52:53], 7, v143
  v_cmp_gt_u32 s[54:55], 7, v144
  v_cndmask_b32 v40, v140, v136, s[48:49]
  v_cndmask_b32 v41, v140, v137, s[48:49]
  v_cndmask_b32 v42, v140, v138, s[48:49]
  v_cndmask_b32 v43, v140, v139, s[48:49]
  v_cndmask_b32 v44, v140, v136, s[50:51]
  v_cndmask_b32 v45, v140, v137, s[50:51]
  v_cndmask_b32 v46, v140, v138, s[50:51]
  v_cndmask_b32 v47, v140, v139, s[50:51]
  v_cndmask_b32 v48, v140, v136, s[52:53]
  v_cndmask_b32 v49, v140, v137, s[52:53]
  v_cndmask_b32 v50, v140, v138, s[52:53]
  v_cndmask_b32 v51, v140, v139, s[52:53]
  v_cndmask_b32 v52, v140, v136, s[54:55]
  v_cndmask_b32 v53, v140, v137, s[54:55]
  v_cndmask_b32 v54, v140, v138, s[54:55]
  v_cndmask_b32 v55, v140, v139, s[54:55]
  s_add_i32 s46, s34, 1
  v_sub_u32 v141, s46, v22
  s_add_i32 s46, s34, 2
  v_sub_u32 v142, s46, v22
  s_add_i32 s46, s34, 3
  v_sub_u32 v143, s46, v22
  s_add_i32 s46, s34, 4
  v_sub_u32 v144, s46, v22
  v_cmp_gt_u32 s[48:49], 7, v141
  v_cmp_gt_u32 s[50:51], 7, v142
  v_cmp_gt_u32 s[52:53], 7, v143
  v_cmp_gt_u32 s[54:55], 7, v144
  v_cndmask_b32 v56, v140, v136, s[48:49]
  v_cndmask_b32 v57, v140, v137, s[48:49]
  v_cndmask_b32 v58, v140, v138, s[48:49]
  v_cndmask_b32 v59, v140, v139, s[48:49]
  v_cndmask_b32 v60, v140, v136, s[50:51]
  v_cndmask_b32 v61, v140, v137, s[50:51]
  v_cndmask_b32 v62, v140, v138, s[50:51]
  v_cndmask_b32 v63, v140, v139, s[50:51]
  v_cndmask_b32 v64, v140, v136, s[52:53]
  v_cndmask_b32 v65, v140, v137, s[52:53]
  v_cndmask_b32 v66, v140, v138, s[52:53]
  v_cndmask_b32 v67, v140, v139, s[52:53]
  v_cndmask_b32 v68, v140, v136, s[54:55]
  v_cndmask_b32 v69, v140, v137, s[54:55]
  v_cndmask_b32 v70, v140, v138, s[54:55]
  v_cndmask_b32 v71, v140, v139, s[54:55]
  s_add_i32 s46, s34, 5
  v_sub_u32 v141, s46, v22
  s_add_i32 s46, s34, 6
  v_sub_u32 v142, s46, v22
  s_add_i32 s46, s34, 7
  v_sub_u32 v143, s46, v22
  s_add_i32 s46, s34, 8
  v_sub_u32 v144, s46, v22
  v_cmp_gt_u32 s[48:49], 7, v141
  v_cmp_gt_u32 s[50:51], 7, v142
  v_cmp_gt_u32 s[52:53], 7, v143
  v_cmp_gt_u32 s[54:55], 7, v144
  v_cndmask_b32 v72, v140, v136, s[48:49]
  v_cndmask_b32 v73, v140, v137, s[48:49]
  v_cndmask_b32 v74, v140, v138, s[48:49]
  v_cndmask_b32 v75, v140, v139, s[48:49]
  v_cndmask_b32 v76, v140, v136, s[50:51]
  v_cndmask_b32 v77, v140, v137, s[50:51]
  v_cndmask_b32 v78, v140, v138, s[50:51]
  v_cndmask_b32 v79, v140, v139, s[50:51]
  v_cndmask_b32 v80, v140, v136, s[52:53]
  v_cndmask_b32 v81, v140, v137, s[52:53]
  v_cndmask_b32 v82, v140, v138, s[52:53]
  v_cndmask_b32 v83, v140, v139, s[52:53]
  v_cndmask_b32 v84, v140, v136, s[54:55]
  v_cndmask_b32 v85, v140, v137, s[54:55]
  v_cndmask_b32 v86, v140, v138, s[54:55]
  v_cndmask_b32 v87, v140, v139, s[54:55]
  s_waitcnt vmcnt(12)
  s_barrier
  s_max_u32 s100, s33, 1
  s_mul_i32 s100, s100, s32
  s_add_i32 s100, s100, s31
  s_add_u32 m0, s38, 15360
  s_nop 0
  buffer_load_dwordx4 v13, s[12:15], s100 offen lds
  s_add_u32 m0, s38, 16384
  s_nop 0
  buffer_load_dwordx4 v14, s[12:15], s100 offen lds
  s_add_u32 m0, s38, 17408
  s_nop 0
  buffer_load_dwordx4 v3, s[12:15], s100 offen lds
  s_add_u32 m0, s39, 15360
  s_nop 0
  buffer_load_dwordx4 v4, s[12:15], s100 offen lds
  s_max_u32 s100, s33, 0
  s_mul_i32 s100, s100, s32
  s_add_i32 s100, s100, s31
  s_add_u32 m0, s38, 0
  s_nop 0
  buffer_load_dwordx4 v13, s[12:15], s100 offen lds
  s_add_u32 m0, s38, 1024
  s_nop 0
  buffer_load_dwordx4 v14, s[12:15], s100 offen lds
  s_add_u32 m0, s38, 2048
  s_nop 0
  buffer_load_dwordx4 v3, s[12:15], s100 offen lds
  s_add_u32 m0, s39, 0
  s_nop 0
  buffer_load_dwordx4 v4, s[12:15], s100 offen lds
  s_waitcnt vmcnt(8)
  s_barrier
SL30:
  ds_read_b128 v[224:227], v7 offset:61440
  ds_read_b128 v[228:231], v8 offset:61440
  ds_read_b128 v[232:235], v7 offset:61568
  ds_read_b128 v[236:239], v8 offset:61568
  ds_read_b128 v[240:243], v7 offset:61696
  ds_read_b128 v[244:247], v8 offset:61696
  ds_read_b128 v[248:251], v7 offset:53760
  ds_read_b128 v[252:255], v8 offset:53760
  ds_read_b128 v[216:219], v7 offset:53888
  ds_read_b128 v[220:223], v8 offset:53888
  s_waitcnt lgkmcnt(8)
  v_mfma_f32_16x16x32_bf16 v[84:87], v[224:227], v[112:115], v[84:87]
  ds_read_b128 v[224:227], v7 offset:54016
  v_mul_f32 v208, s93, v208
  v_mfma_f32_16x16x32_bf16 v[84:87], v[228:231], v[116:119], v[84:87]
  ds_read_b128 v[228:231], v8 offset:54016
  s_waitcnt lgkmcnt(8)
  v_mfma_f32_16x16x32_bf16 v[84:87], v[232:235], v[120:123], v[84:87]
  ds_read_b128 v[232:235], v7 offset:46080
  v_mul_f32 v209, s93, v209
  v_mfma_f32_16x16x32_bf16 v[84:87], v[236:239], v[124:127], v[84:87]
  ds_read_b128 v[236:239], v8 offset:46080
  s_waitcnt lgkmcnt(8)
  v_mfma_f32_16x16x32_bf16 v[84:87], v[240:243], v[128:131], v[84:87]
  ds_read_b128 v[240:243], v7 offset:46208
  v_mul_f32 v210, s93, v210
  v_mul_f32 v211, s93, v211
  v_mul_f32 v212, s93, v212
  v_mul_f32 v213, s93, v213
  v_mul_f32 v214, s93, v214
  v_mul_f32 v215, s93, v215
  v_cvt_pk_bf16_f32 v132, v208, v209
  v_cvt_pk_bf16_f32 v133, v210, v211
  v_cvt_pk_bf16_f32 v134, v212, v213
  v_cvt_pk_bf16_f32 v135, v214, v215
  s_nop 1
  v_mfma_f32_16x16x32_bf16 v[84:87], v[244:247], v[132:135], v[84:87]
  ds_read_b128 v[244:247], v8 offset:46208
  s_waitcnt lgkmcnt(8)
  v_mfma_f32_16x16x32_bf16 v[80:83], v[248:251], v[112:115], v[80:83]
  ds_read_b128 v[248:251], v7 offset:46336
  v_mul_f32 v200, s93, v200
  v_mfma_f32_16x16x32_bf16 v[80:83], v[252:255], v[116:119], v[80:83]
  ds_read_b128 v[252:255], v8 offset:46336
  s_waitcnt lgkmcnt(8)
  v_mfma_f32_16x16x32_bf16 v[80:83], v[216:219], v[120:123], v[80:83]
  ds_read_b128 v[216:219], v7 offset:38400
  v_mul_f32 v201, s93, v201
  v_mfma_f32_16x16x32_bf16 v[80:83], v[220:223], v[124:127], v[80:83]
  ds_read_b128 v[220:223], v8 offset:38400
  s_waitcnt lgkmcnt(8)
  v_mfma_f32_16x16x32_bf16 v[80:83], v[224:227], v[128:131], v[80:83]
  ds_read_b128 v[224:227], v7 offset:38528
  v_mul_f32 v202, s93, v202
  v_mfma_f32_16x16x32_bf16 v[80:83], v[228:231], v[132:135], v[80:83]
  ds_read_b128 v[228:231], v8 offset:38528
  s_cbranch_vccz SL31
  s_barrier
  s_branch SM31
SL31:
  s_waitcnt vmcnt(0)
  s_barrier
SM31:
  s_waitcnt lgkmcnt(8)
  v_mfma_f32_16x16x32_bf16 v[76:79], v[232:235], v[112:115], v[76:79]
  v_exp_f32 v196, v84
  v_mfma_f32_16x16x32_bf16 v[52:55], v[232:235], v[88:91], v[52:55]
  v_exp_f32 v197, v85
  v_mfma_f32_16x16x32_bf16 v[76:79], v[236:239], v[116:119], v[76:79]
  v_exp_f32 v198, v86
  v_mfma_f32_16x16x32_bf16 v[52:55], v[236:239], v[92:95], v[52:55]
  ds_read_b128 v[232:235], v7 offset:38656
  s_waitcnt lgkmcnt(7)
  v_mfma_f32_16x16x32_bf16 v[76:79], v[240:243], v[120:123], v[76:79]
  v_exp_f32 v199, v87
  v_mfma_f32_16x16x32_bf16 v[52:55], v[240:243], v[96:99], v[52:55]
  ds_read_b128 v[236:239], v8 offset:38656
  ds_read_b128 v[240:243], v7 offset:30720
  v_mfma_f32_16x16x32_bf16 v[76:79], v[244:247], v[124:127], v[76:79]
  v_mul_f32 v203, s93, v203
  v_mul_f32 v204, s93, v204
  v_mfma_f32_16x16x32_bf16 v[52:55], v[244:247], v[100:103], v[52:55]
  ds_read_b128 v[244:247], v8 offset:30720
  s_waitcnt lgkmcnt(8)
  v_mfma_f32_16x16x32_bf16 v[76:79], v[248:251], v[128:131], v[76:79]
  v_mul_f32 v205, s93, v205
  v_mul_f32 v206, s93, v206
  v_mfma_f32_16x16x32_bf16 v[52:55], v[248:251], v[104:107], v[52:55]
  ds_read_b128 v[248:251], v7 offset:30848
  v_mul_f32 v207, s93, v207
  v_cvt_pk_bf16_f32 v108, v200, v201
  v_cvt_pk_bf16_f32 v109, v202, v203
  v_cvt_pk_bf16_f32 v110, v204, v205
  v_cvt_pk_bf16_f32 v111, v206, v207
  v_mfma_f32_16x16x32_bf16 v[76:79], v[252:255], v[132:135], v[76:79]
  v_exp_f32 v200, v80
  v_mfma_f32_16x16x32_bf16 v[52:55], v[252:255], v[108:111], v[52:55]
  ds_read_b128 v[252:255], v8 offset:30848
  s_waitcnt lgkmcnt(8)
  v_mfma_f32_16x16x32_bf16 v[72:75], v[216:219], v[112:115], v[72:75]
  v_exp_f32 v201, v81
  v_mfma_f32_16x16x32_bf16 v[48:51], v[216:219], v[88:91], v[48:51]
  v_exp_f32 v202, v82
  v_mfma_f32_16x16x32_bf16 v[72:75], v[220:223], v[116:119], v[72:75]
  v_exp_f32 v203, v83
  v_mfma_f32_16x16x32_bf16 v[48:51], v[220:223], v[92:95], v[48:51]
  ds_read_b128 v[216:219], v7 offset:30976
  v_add_u32 v2, 102400, v1
  s_waitcnt lgkmcnt(7)
  v_mfma_f32_16x16x32_bf16 v[72:75], v[224:227], v[120:123], v[72:75]
  v_exp_f32 v204, v76
  v_mfma_f32_16x16x32_bf16 v[48:51], v[224:227], v[96:99], v[48:51]
  v_exp_f32 v205, v77
  v_mfma_f32_16x16x32_bf16 v[72:75], v[228:231], v[124:127], v[72:75]
  v_exp_f32 v206, v78
  v_mfma_f32_16x16x32_bf16 v[48:51], v[228:231], v[100:103], v[48:51]
  ds_read_b128 v[220:223], v8 offset:30976
  s_waitcnt lgkmcnt(6)
  v_mfma_f32_16x16x32_bf16 v[72:75], v[232:235], v[128:131], v[72:75]
  v_exp_f32 v207, v79
  v_mfma_f32_16x16x32_bf16 v[48:51], v[232:235], v[104:107], v[48:51]
  v_exp_f32 v208, v52
  v_mfma_f32_16x16x32_bf16 v[72:75], v[236:239], v[132:135], v[72:75]
  v_exp_f32 v209, v53
  v_mfma_f32_16x16x32_bf16 v[48:51], v[236:239], v[108:111], v[48:51]
  ds_read_b128 v[224:227], v7 offset:23040
  s_waitcnt lgkmcnt(5)
  v_mfma_f32_16x16x32_bf16 v[68:71], v[240:243], v[112:115], v[68:71]
  v_exp_f32 v210, v54
  v_mfma_f32_16x16x32_bf16 v[44:47], v[240:243], v[88:91], v[44:47]
  v_exp_f32 v211, v55
  v_mfma_f32_16x16x32_bf16 v[68:71], v[244:247], v[116:119], v[68:71]
  ds_read_b128 v[228:231], v8 offset:23040
  ds_read_b128 v[232:235], v7 offset:23168
  v_mov_b32 v192, 0x3f803f80
  v_mfma_f32_16x16x32_bf16 v[44:47], v[244:247], v[92:95], v[44:47]
  ds_read_b128 v[236:239], v8 offset:23168
  v_mov_b32 v193, 0x3f803f80
  s_waitcnt lgkmcnt(6)
  v_mfma_f32_16x16x32_bf16 v[68:71], v[248:251], v[120:123], v[68:71]
  v_exp_f32 v212, v72
  v_mfma_f32_16x16x32_bf16 v[44:47], v[248:251], v[96:99], v[44:47]
  v_exp_f32 v213, v73
  v_mfma_f32_16x16x32_bf16 v[68:71], v[252:255], v[124:127], v[68:71]
  v_exp_f32 v214, v74
  v_mfma_f32_16x16x32_bf16 v[44:47], v[252:255], v[100:103], v[44:47]
  ds_read_b128 v[240:243], v7 offset:23296
  s_waitcnt lgkmcnt(5)
  v_mfma_f32_16x16x32_bf16 v[68:71], v[216:219], v[128:131], v[68:71]
  v_exp_f32 v215, v75
  v_mfma_f32_16x16x32_bf16 v[44:47], v[216:219], v[104:107], v[44:47]
  ds_read_b128 v[244:247], v8 offset:23296
  ds_read_b128 v[248:251], v7 offset:15360
  v_mfma_f32_16x16x32_bf16 v[68:71], v[220:223], v[132:135], v[68:71]
  ds_read_b128 v[252:255], v8 offset:15360
  ds_read_b128 v[216:219], v7 offset:15488
  v_mfma_f32_16x16x32_bf16 v[44:47], v[220:223], v[108:111], v[44:47]
  ds_read_b128 v[220:223], v8 offset:15488
  s_waitcnt lgkmcnt(8)
  v_mfma_f32_16x16x32_bf16 v[64:67], v[224:227], v[112:115], v[64:67]
  v_mov_b32 v194, 0x3f803f80
  v_mov_b32 v195, 0x3f803f80
  v_mfma_f32_16x16x32_bf16 v[40:43], v[224:227], v[88:91], v[40:43]
  ds_read_b128 v[224:227], v7 offset:15616
  v_cvt_pk_bf16_f32 v166, v196, v197
  v_mfma_f32_16x16x32_bf16 v[64:67], v[228:231], v[116:119], v[64:67]
  v_exp_f32 v196, v48
  v_mfma_f32_16x16x32_bf16 v[40:43], v[228:231], v[92:95], v[40:43]
  ds_read_b128 v[228:231], v8 offset:15616
  v_cvt_pk_bf16_f32 v167, v198, v199
  s_waitcnt lgkmcnt(8)
  v_mfma_f32_16x16x32_bf16 v[64:67], v[232:235], v[120:123], v[64:67]
  v_exp_f32 v197, v49
  v_mfma_f32_16x16x32_bf16 v[40:43], v[232:235], v[96:99], v[40:43]
  v_exp_f32 v198, v50
  v_mfma_f32_16x16x32_bf16 v[64:67], v[236:239], v[124:127], v[64:67]
  v_exp_f32 v199, v51
  v_mfma_f32_16x16x32_bf16 v[40:43], v[236:239], v[100:103], v[40:43]
  ds_read_b128 v[232:235], v7 offset:7680
  v_cvt_pk_bf16_f32 v164, v200, v201
  s_waitcnt lgkmcnt(7)
  v_mfma_f32_16x16x32_bf16 v[64:67], v[240:243], v[128:131], v[64:67]
  v_exp_f32 v200, v68
  v_mfma_f32_16x16x32_bf16 v[40:43], v[240:243], v[104:107], v[40:43]
  v_exp_f32 v201, v69
  v_mfma_f32_16x16x32_bf16 v[64:67], v[244:247], v[132:135], v[64:67]
  ds_read_b128 v[236:239], v8 offset:7680
  ds_read_b128 v[240:243], v7 offset:7808
  v_mfma_f32_16x16x32_bf16 v[40:43], v[244:247], v[108:111], v[40:43]
  ds_read_b128 v[244:247], v8 offset:7808
  s_cbranch_vccz SL32
  s_barrier
  buffer_load_dword v13, off, s[8:11], 0
SL32:
  s_waitcnt lgkmcnt(8)
  v_mfma_f32_16x16x32_bf16 v[60:63], v[248:251], v[112:115], v[60:63]
  v_cvt_pk_bf16_f32 v165, v202, v203
  v_cvt_pk_bf16_f32 v162, v204, v205
  v_mfma_f32_16x16x32_bf16 v[36:39], v[248:251], v[88:91], v[36:39]
  v_exp_f32 v202, v70
  v_mfma_f32_16x16x32_bf16 v[60:63], v[252:255], v[116:119], v[60:63]
  v_exp_f32 v203, v71
  v_mfma_f32_16x16x32_bf16 v[36:39], v[252:255], v[92:95], v[36:39]
  ds_read_b128 v[248:251], v7 offset:7936
  v_cvt_pk_bf16_f32 v163, v206, v207
  s_waitcnt lgkmcnt(7)
  v_mfma_f32_16x16x32_bf16 v[60:63], v[216:219], v[120:123], v[60:63]
  v_exp_f32 v204, v44
  v_mfma_f32_16x16x32_bf16 v[36:39], v[216:219], v[96:99], v[36:39]
  v_exp_f32 v205, v45
  v_mfma_f32_16x16x32_bf16 v[60:63], v[220:223], v[124:127], v[60:63]
  v_exp_f32 v206, v46
  v_mfma_f32_16x16x32_bf16 v[36:39], v[220:223], v[100:103], v[36:39]
  ds_read_b128 v[252:255], v8 offset:7936
  v_cvt_pk_bf16_f32 v150, v208, v209
  s_waitcnt lgkmcnt(6)
  v_mfma_f32_16x16x32_bf16 v[60:63], v[224:227], v[128:131], v[60:63]
  v_exp_f32 v207, v47
  v_mfma_f32_16x16x32_bf16 v[36:39], v[224:227], v[104:107], v[36:39]
  v_exp_f32 v208, v64
  v_mfma_f32_16x16x32_bf16 v[60:63], v[228:231], v[132:135], v[60:63]
  v_exp_f32 v209, v65
  v_mfma_f32_16x16x32_bf16 v[36:39], v[228:231], v[108:111], v[36:39]
  ds_read_b128 v[216:219], v7 offset:0
  s_cbranch_vccnz SL33
  s_barrier
SL33:
  s_waitcnt lgkmcnt(5)
  v_mfma_f32_16x16x32_bf16 v[56:59], v[232:235], v[112:115], v[56:59]
  ds_read_b128 v[220:223], v8 offset:0
  ds_read_b128 v[224:227], v7 offset:128
  v_cvt_pk_bf16_f32 v151, v210, v211
  v_mfma_f32_16x16x32_bf16 v[32:35], v[232:235], v[88:91], v[32:35]
  v_exp_f32 v210, v66
  v_mfma_f32_16x16x32_bf16 v[56:59], v[236:239], v[116:119], v[56:59]
  v_exp_f32 v211, v67
  v_mfma_f32_16x16x32_bf16 v[32:35], v[236:239], v[92:95], v[32:35]
  ds_read_b128 v[228:231], v8 offset:128
  v_cvt_pk_bf16_f32 v160, v212, v213
  s_waitcnt lgkmcnt(6)
  v_mfma_f32_16x16x32_bf16 v[56:59], v[240:243], v[120:123], v[56:59]
  v_exp_f32 v212, v40
  v_mfma_f32_16x16x32_bf16 v[32:35], v[240:243], v[96:99], v[32:35]
  v_exp_f32 v213, v41
  v_mfma_f32_16x16x32_bf16 v[56:59], v[244:247], v[124:127], v[56:59]
  ds_read_b128 v[232:235], v7 offset:256
  ds_read_b128 v[236:239], v8 offset:256
  v_cvt_pk_bf16_f32 v161, v214, v215
  v_mfma_f32_16x16x32_bf16 v[32:35], v[244:247], v[100:103], v[32:35]
  ds_read_b128 v[240:243], v20 offset:0
  v_cvt_pk_bf16_f32 v148, v196, v197
  s_waitcnt lgkmcnt(7)
  v_mfma_f32_16x16x32_bf16 v[56:59], v[248:251], v[128:131], v[56:59]
  v_exp_f32 v214, v42
  v_mfma_f32_16x16x32_bf16 v[32:35], v[248:251], v[104:107], v[32:35]
  v_exp_f32 v215, v43
  v_mfma_f32_16x16x32_bf16 v[56:59], v[252:255], v[132:135], v[56:59]
  v_exp_f32 v196, v60
  v_mfma_f32_16x16x32_bf16 v[32:35], v[252:255], v[108:111], v[32:35]
  ds_read_b128 v[244:247], v0 offset:0
  v_cvt_pk_bf16_f32 v149, v198, v199
  s_waitcnt lgkmcnt(6)
  v_mfma_f32_16x16x32_bf16 v[28:31], v[216:219], v[88:91], v[28:31]
  v_exp_f32 v197, v61
  v_mfma_f32_16x16x32_bf16 v[28:31], v[220:223], v[92:95], v[28:31]
  ds_read_b128 v[248:251], v20 offset:128
  v_cvt_pk_bf16_f32 v158, v200, v201
  s_waitcnt lgkmcnt(5)
  v_mfma_f32_16x16x32_bf16 v[28:31], v[224:227], v[96:99], v[28:31]
  v_exp_f32 v198, v62
  v_mfma_f32_16x16x32_bf16 v[28:31], v[228:231], v[100:103], v[28:31]
  ds_read_b128 v[252:255], v0 offset:128
  v_cvt_pk_bf16_f32 v159, v202, v203
  s_waitcnt lgkmcnt(5)
  v_mfma_f32_16x16x32_bf16 v[28:31], v[232:235], v[104:107], v[28:31]
  ds_read_b128 v[216:219], v20 offset:256
  v_cvt_pk_bf16_f32 v146, v204, v205
  s_waitcnt lgkmcnt(5)
  v_mfma_f32_16x16x32_bf16 v[28:31], v[236:239], v[108:111], v[28:31]
  ds_read_b128 v[220:223], v0 offset:256
  v_cvt_pk_bf16_f32 v147, v206, v207
  s_waitcnt lgkmcnt(5)
  v_mfma_f32_16x16x32_bf16 v[24:27], v[240:243], v[88:91], v[24:27]
  ds_read_b64_tr_b16 v[224:225], v9 offset:53760
  ds_read_b64_tr_b16 v[226:227], v9 offset:61440
  v_cvt_pk_bf16_f32 v156, v208, v209
  s_waitcnt lgkmcnt(5)
  v_mfma_f32_16x16x32_bf16 v[24:27], v[244:247], v[92:95], v[24:27]
  ds_read_b64_tr_b16 v[228:229], v10 offset:53760
  ds_read_b64_tr_b16 v[230:231], v10 offset:61440
  v_cvt_pk_bf16_f32 v157, v210, v211
  v_mfma_f32_16x16x32_bf16 v[24:27], v[248:251], v[96:99], v[24:27]
  ds_read_b64_tr_b16 v[232:233], v11 offset:53760
  ds_read_b64_tr_b16 v[234:235], v11 offset:61440
  v_cvt_pk_bf16_f32 v144, v212, v213
  v_cvt_pk_bf16_f32 v145, v214, v215
  v_exp_f32 v199, v63
  v_cvt_pk_bf16_f32 v154, v196, v197
  v_cvt_pk_bf16_f32 v155, v198, v199
  v_exp_f32 v200, v36
  v_exp_f32 v201, v37
  v_exp_f32 v202, v38
  v_exp_f32 v203, v39
  v_cvt_pk_bf16_f32 v142, v200, v201
  v_cvt_pk_bf16_f32 v143, v202, v203
  v_exp_f32 v204, v56
  v_exp_f32 v205, v57
  v_exp_f32 v206, v58
  v_exp_f32 v207, v59
  v_cvt_pk_bf16_f32 v152, v204, v205
  v_cvt_pk_bf16_f32 v153, v206, v207
  v_mfma_f32_16x16x32_bf16 v[188:191], v[192:195], v[164:167], 0
  v_exp_f32 v208, v32
  v_mfma_f32_16x16x32_bf16 v[188:191], v[192:195], v[160:163], v[188:191]
  v_exp_f32 v209, v33
  v_mfma_f32_16x16x32_bf16 v[188:191], v[192:195], v[156:159], v[188:191]
  v_exp_f32 v210, v34
  v_mfma_f32_16x16x32_bf16 v[188:191], v[192:195], v[152:155], v[188:191]
  ds_read_b64_tr_b16 v[236:237], v12 offset:53760
  ds_read_b64_tr_b16 v[238:239], v12 offset:61440
  s_waitcnt lgkmcnt(9)
  v_mfma_f32_16x16x32_bf16 v[24:27], v[252:255], v[100:103], v[24:27]
  v_exp_f32 v211, v35
  v_mfma_f32_16x16x32_bf16 v[24:27], v[216:219], v[104:107], v[24:27]
  ds_read_b64_tr_b16 v[240:241], v9 offset:53888
  ds_read_b64_tr_b16 v[242:243], v9 offset:61568
  s_waitcnt lgkmcnt(8)
  v_mfma_f32_16x16x32_bf16 v[24:27], v[220:223], v[108:111], v[24:27]
  ds_read_b64_tr_b16 v[244:245], v10 offset:53888
  ds_read_b64_tr_b16 v[246:247], v10 offset:61568
  v_subrev_u32 v23, 813694976, v188
  s_mov_b32 s52, 503316480
  v_cmp_gt_u32 s[48:49], s52, v23
  s_or_b64 s[48:49], s[48:49], s[44:45]
  s_cmp_eq_u64 s[48:49], -1
  s_cbranch_scc0 FB1
FBR1:
  s_cbranch_vccnz SL34
  s_barrier
SL34:
  v_mfma_f32_16x16x32_bf16 v[88:91], v[224:227], v[164:167], 0
  ds_read_b64_tr_b16 v[248:249], v11 offset:53888
  ds_read_b64_tr_b16 v[250:251], v11 offset:61568
  v_cvt_pk_bf16_f32 v140, v208, v209
  s_waitcnt lgkmcnt(8)
  v_mfma_f32_16x16x32_bf16 v[92:95], v[228:231], v[164:167], 0
  ds_read_b64_tr_b16 v[252:253], v12 offset:53888
  ds_read_b64_tr_b16 v[254:255], v12 offset:61568
  v_cvt_pk_bf16_f32 v141, v210, v211
  v_mfma_f32_16x16x32_bf16 v[96:99], v[232:235], v[164:167], 0
  ds_read_b64_tr_b16 v[216:217], v9 offset:54016
  ds_read_b64_tr_b16 v[218:219], v9 offset:61696
  v_exp_f32 v212, v28
  s_waitcnt lgkmcnt(8)
  v_mfma_f32_16x16x32_bf16 v[100:103], v[236:239], v[164:167], 0
  ds_read_b64_tr_b16 v[220:221], v10 offset:54016
  ds_read_b64_tr_b16 v[222:223], v10 offset:61696
  v_exp_f32 v213, v29
  v_mfma_f32_16x16x32_bf16 v[104:107], v[240:243], v[164:167], 0
  ds_read_b64_tr_b16 v[224:225], v11 offset:54016
  ds_read_b64_tr_b16 v[226:227], v11 offset:61696
  s_waitcnt lgkmcnt(8)
  v_mfma_f32_16x16x32_bf16 v[108:111], v[244:247], v[164:167], 0
  ds_read_b64_tr_b16 v[228:229], v12 offset:54016
  ds_read_b64_tr_b16 v[230:231], v12 offset:61696
  v_mfma_f32_16x16x32_bf16 v[112:115], v[248:251], v[164:167], 0
  ds_read_b64_tr_b16 v[232:233], v9 offset:38400
  ds_read_b64_tr_b16 v[234:235], v9 offset:46080
  s_waitcnt lgkmcnt(8)
  v_mfma_f32_16x16x32_bf16 v[116:119], v[252:255], v[164:167], 0
  ds_read_b64_tr_b16 v[236:237], v10 offset:38400
  ds_read_b64_tr_b16 v[238:239], v10 offset:46080
  v_mfma_f32_16x16x32_bf16 v[120:123], v[216:219], v[164:167], 0
  ds_read_b64_tr_b16 v[240:241], v11 offset:38400
  ds_read_b64_tr_b16 v[242:243], v11 offset:46080
  s_waitcnt lgkmcnt(8)
  v_mfma_f32_16x16x32_bf16 v[124:127], v[220:223], v[164:167], 0
  ds_read_b64_tr_b16 v[244:245], v12 offset:38400
  ds_read_b64_tr_b16 v[246:247], v12 offset:46080
  v_mfma_f32_16x16x32_bf16 v[128:131], v[224:227], v[164:167], 0
  ds_read_b64_tr_b16 v[248:249], v9 offset:38528
  ds_read_b64_tr_b16 v[250:251], v9 offset:46208
  s_waitcnt lgkmcnt(8)
  v_mfma_f32_16x16x32_bf16 v[132:135], v[228:231], v[164:167], 0
  ds_read_b64_tr_b16 v[252:253], v10 offset:38528
  ds_read_b64_tr_b16 v[254:255], v10 offset:46208
  v_exp_f32 v214, v30
  v_exp_f32 v215, v31
  v_cvt_pk_bf16_f32 v138, v212, v213
  v_cvt_pk_bf16_f32 v139, v214, v215
  v_exp_f32 v196, v24
  v_exp_f32 v197, v25
  v_exp_f32 v198, v26
  v_exp_f32 v199, v27
  v_cvt_pk_bf16_f32 v136, v196, v197
  v_cvt_pk_bf16_f32 v137, v198, v199
  v_mfma_f32_16x16x32_bf16 v[184:187], v[192:195], v[148:151], 0
  ds_read_b64_tr_b16 v[216:217], v11 offset:38528
  ds_read_b64_tr_b16 v[218:219], v11 offset:46208
  v_mfma_f32_16x16x32_bf16 v[184:187], v[192:195], v[144:147], v[184:187]
  ds_read_b64_tr_b16 v[220:221], v12 offset:38528
  ds_read_b64_tr_b16 v[222:223], v12 offset:46208
  v_mfma_f32_16x16x32_bf16 v[184:187], v[192:195], v[140:143], v[184:187]
  v_mfma_f32_16x16x32_bf16 v[184:187], v[192:195], v[136:139], v[184:187]
  s_nop 7
  v_subrev_u32 v23, 813694976, v184
  s_mov_b32 s52, 503316480
  v_cmp_gt_u32 s[48:49], s52, v23
  s_or_b64 s[48:49], s[48:49], s[42:43]
  s_cmp_eq_u64 s[48:49], -1
  s_cbranch_scc0 FB0
FBR0:
  v_mfma_f32_16x16x32_bf16 v[88:91], v[232:235], v[160:163], v[88:91]
  v_rcp_f32 v22, v184
  v_mfma_f32_16x16x32_bf16 v[24:27], v[232:235], v[148:151], 0
  s_waitcnt lgkmcnt(10)
  v_mfma_f32_16x16x32_bf16 v[92:95], v[236:239], v[160:163], v[92:95]
  v_rcp_f32 v23, v188
  v_mfma_f32_16x16x32_bf16 v[28:31], v[236:239], v[148:151], 0
  ds_read_b64_tr_b16 v[224:225], v9 offset:38656
  ds_read_b64_tr_b16 v[226:227], v9 offset:46336
  v_mfma_f32_16x16x32_bf16 v[96:99], v[240:243], v[160:163], v[96:99]
  ds_read_b64_tr_b16 v[228:229], v10 offset:38656
  ds_read_b64_tr_b16 v[230:231], v10 offset:46336
  v_mfma_f32_16x16x32_bf16 v[32:35], v[240:243], v[148:151], 0
  s_waitcnt lgkmcnt(10)
  v_mfma_f32_16x16x32_bf16 v[100:103], v[244:247], v[160:163], v[100:103]
  ds_read_b64_tr_b16 v[232:233], v11 offset:38656
  ds_read_b64_tr_b16 v[234:235], v11 offset:46336
  v_mfma_f32_16x16x32_bf16 v[36:39], v[244:247], v[148:151], 0
  ds_read_b64_tr_b16 v[236:237], v12 offset:38656
  ds_read_b64_tr_b16 v[238:239], v12 offset:46336
  v_mfma_f32_16x16x32_bf16 v[104:107], v[248:251], v[160:163], v[104:107]
  v_mfma_f32_16x16x32_bf16 v[40:43], v[248:251], v[148:151], 0
  s_waitcnt lgkmcnt(10)
  v_mfma_f32_16x16x32_bf16 v[108:111], v[252:255], v[160:163], v[108:111]
  ds_read_b64_tr_b16 v[240:241], v9 offset:23040
  ds_read_b64_tr_b16 v[242:243], v9 offset:30720
  v_mfma_f32_16x16x32_bf16 v[44:47], v[252:255], v[148:151], 0
  ds_read_b64_tr_b16 v[244:245], v10 offset:23040
  ds_read_b64_tr_b16 v[246:247], v10 offset:30720
  v_mfma_f32_16x16x32_bf16 v[112:115], v[216:219], v[160:163], v[112:115]
  v_mfma_f32_16x16x32_bf16 v[48:51], v[216:219], v[148:151], 0
  s_waitcnt lgkmcnt(10)
  v_mfma_f32_16x16x32_bf16 v[116:119], v[220:223], v[160:163], v[116:119]
  ds_read_b64_tr_b16 v[248:249], v11 offset:23040
  ds_read_b64_tr_b16 v[250:251], v11 offset:30720
  v_mfma_f32_16x16x32_bf16 v[52:55], v[220:223], v[148:151], 0
  ds_read_b64_tr_b16 v[252:253], v12 offset:23040
  ds_read_b64_tr_b16 v[254:255], v12 offset:30720
  v_mfma_f32_16x16x32_bf16 v[120:123], v[224:227], v[160:163], v[120:123]
  v_mfma_f32_16x16x32_bf16 v[56:59], v[224:227], v[148:151], 0
  s_waitcnt lgkmcnt(10)
  v_mfma_f32_16x16x32_bf16 v[124:127], v[228:231], v[160:163], v[124:127]
  ds_read_b64_tr_b16 v[216:217], v9 offset:23168
  ds_read_b64_tr_b16 v[218:219], v9 offset:30848
  v_mfma_f32_16x16x32_bf16 v[60:63], v[228:231], v[148:151], 0
  ds_read_b64_tr_b16 v[220:221], v10 offset:23168
  ds_read_b64_tr_b16 v[222:223], v10 offset:30848
  v_mfma_f32_16x16x32_bf16 v[128:131], v[232:235], v[160:163], v[128:131]
  v_mfma_f32_16x16x32_bf16 v[64:67], v[232:235], v[148:151], 0
  s_waitcnt lgkmcnt(10)
  v_mfma_f32_16x16x32_bf16 v[132:135], v[236:239], v[160:163], v[132:135]
  ds_read_b64_tr_b16 v[224:225], v11 offset:23168
  ds_read_b64_tr_b16 v[226:227], v11 offset:30848
  v_mfma_f32_16x16x32_bf16 v[68:71], v[236:239], v[148:151], 0
  ds_read_b64_tr_b16 v[228:229], v12 offset:23168
  ds_read_b64_tr_b16 v[230:231], v12 offset:30848
  s_cbranch_vccz SL35
  s_barrier
  s_mov_b32 s53, 0x400000
NPOLL:
  s_waitcnt vmcnt(0)
  v_readfirstlane_b32 s46, v13
  s_sub_u32 s53, s53, 1
  s_cselect_b32 s46, 144, s46
  s_cmp_ge_u32 s46, 144
  s_cbranch_scc1 NPOLLD
  buffer_load_dword v13, off, s[8:11], 0 sc1
  s_branch NPOLL
NPOLLD:
  s_add_u32 m0, s40, 0
  s_add_u32 s100, s40, 30720
  buffer_load_dwordx4 v1, s[20:23], s100 offen sc1 lds
  s_add_u32 m0, s40, 4096
  s_add_u32 s100, s40, 34816
  buffer_load_dwordx4 v1, s[20:23], s100 offen sc1 lds
  s_min_u32 s51, s40, 1024
  s_add_u32 m0, s51, 8192
  s_add_u32 s100, s51, 38912
  buffer_load_dwordx4 v1, s[20:23], s100 offen sc1 lds
  s_add_u32 m0, s40, 133120
  s_add_u32 s100, s40, 0
  buffer_load_dwordx4 v1, s[20:23], s100 offen sc1 lds
  s_add_u32 m0, s40, 137216
  s_add_u32 s100, s40, 4096
  buffer_load_dwordx4 v1, s[20:23], s100 offen sc1 lds
  s_add_u32 m0, s40, 141312
  s_add_u32 s100, s40, 8192
  buffer_load_dwordx4 v1, s[20:23], s100 offen sc1 lds
  s_add_u32 m0, s40, 145408
  s_add_u32 s100, s40, 12288
  buffer_load_dwordx4 v1, s[20:23], s100 offen sc1 lds
  s_add_u32 m0, s40, 149504
  s_add_u32 s100, s40, 16384
  buffer_load_dwordx4 v1, s[20:23], s100 offen sc1 lds
  s_add_u32 m0, s40, 153600
  s_add_u32 s100, s40, 20480
  buffer_load_dwordx4 v1, s[20:23], s100 offen sc1 lds
  s_add_u32 m0, s40, 157696
  s_add_u32 s100, s40, 24576
  buffer_load_dwordx4 v1, s[20:23], s100 offen sc1 lds
  s_min_u32 s51, s40, 1024
  s_add_u32 m0, s51, 161792
  s_add_u32 s100, s51, 28672
  buffer_load_dwordx4 v1, s[20:23], s100 offen sc1 lds
SL35:
  s_cbranch_vccnz SL36
  s_barrier
SL36:
  v_mfma_f32_16x16x32_bf16 v[88:91], v[240:243], v[156:159], v[88:91]
  v_mfma_f32_16x16x32_bf16 v[24:27], v[240:243], v[144:147], v[24:27]
  s_waitcnt lgkmcnt(10)
  v_mfma_f32_16x16x32_bf16 v[92:95], v[244:247], v[156:159], v[92:95]
  ds_read_b64_tr_b16 v[232:233], v9 offset:23296
  ds_read_b64_tr_b16 v[234:235], v9 offset:30976
  v_mfma_f32_16x16x32_bf16 v[28:31], v[244:247], v[144:147], v[28:31]
  ds_read_b64_tr_b16 v[236:237], v10 offset:23296
  ds_read_b64_tr_b16 v[238:239], v10 offset:30976
  v_mfma_f32_16x16x32_bf16 v[96:99], v[248:251], v[156:159], v[96:99]
  v_mfma_f32_16x16x32_bf16 v[32:35], v[248:251], v[144:147], v[32:35]
  s_waitcnt lgkmcnt(10)
  v_mfma_f32_16x16x32_bf16 v[100:103], v[252:255], v[156:159], v[100:103]
  ds_read_b64_tr_b16 v[240:241], v11 offset:23296
  ds_read_b64_tr_b16 v[242:243], v11 offset:30976
  v_mfma_f32_16x16x32_bf16 v[36:39], v[252:255], v[144:147], v[36:39]
  ds_read_b64_tr_b16 v[244:245], v12 offset:23296
  ds_read_b64_tr_b16 v[246:247], v12 offset:30976
  v_mfma_f32_16x16x32_bf16 v[104:107], v[216:219], v[156:159], v[104:107]
  v_mfma_f32_16x16x32_bf16 v[40:43], v[216:219], v[144:147], v[40:43]
  s_waitcnt lgkmcnt(10)
  v_mfma_f32_16x16x32_bf16 v[108:111], v[220:223], v[156:159], v[108:111]
  ds_read_b64_tr_b16 v[248:249], v9 offset:7680
  ds_read_b64_tr_b16 v[250:251], v9 offset:15360
  v_mfma_f32_16x16x32_bf16 v[44:47], v[220:223], v[144:147], v[44:47]
  ds_read_b64_tr_b16 v[252:253], v10 offset:7680
  ds_read_b64_tr_b16 v[254:255], v10 offset:15360
  v_mfma_f32_16x16x32_bf16 v[112:115], v[224:227], v[156:159], v[112:115]
  v_mfma_f32_16x16x32_bf16 v[48:51], v[224:227], v[144:147], v[48:51]
  s_waitcnt lgkmcnt(10)
  v_mfma_f32_16x16x32_bf16 v[116:119], v[228:231], v[156:159], v[116:119]
  ds_read_b64_tr_b16 v[216:217], v11 offset:7680
  ds_read_b64_tr_b16 v[218:219], v11 offset:15360
  v_mfma_f32_16x16x32_bf16 v[52:55], v[228:231], v[144:147], v[52:55]
  ds_read_b64_tr_b16 v[220:221], v12 offset:7680
  ds_read_b64_tr_b16 v[222:223], v12 offset:15360
  v_mfma_f32_16x16x32_bf16 v[120:123], v[232:235], v[156:159], v[120:123]
  v_mfma_f32_16x16x32_bf16 v[56:59], v[232:235], v[144:147], v[56:59]
  s_waitcnt lgkmcnt(10)
  v_mfma_f32_16x16x32_bf16 v[124:127], v[236:239], v[156:159], v[124:127]
  ds_read_b64_tr_b16 v[224:225], v9 offset:7808
  ds_read_b64_tr_b16 v[226:227], v9 offset:15488
  v_mfma_f32_16x16x32_bf16 v[60:63], v[236:239], v[144:147], v[60:63]
  ds_read_b64_tr_b16 v[228:229], v10 offset:7808
  ds_read_b64_tr_b16 v[230:231], v10 offset:15488
  v_mfma_f32_16x16x32_bf16 v[128:131], v[240:243], v[156:159], v[128:131]
  v_mfma_f32_16x16x32_bf16 v[64:67], v[240:243], v[144:147], v[64:67]
  s_waitcnt lgkmcnt(10)
  v_mfma_f32_16x16x32_bf16 v[132:135], v[244:247], v[156:159], v[132:135]
  ds_read_b64_tr_b16 v[232:233], v11 offset:7808
  ds_read_b64_tr_b16 v[234:235], v11 offset:15488
  v_mfma_f32_16x16x32_bf16 v[68:71], v[244:247], v[144:147], v[68:71]
  ds_read_b64_tr_b16 v[236:237], v12 offset:7808
  ds_read_b64_tr_b16 v[238:239], v12 offset:15488
  v_mfma_f32_16x16x32_bf16 v[88:91], v[248:251], v[152:155], v[88:91]
  v_mfma_f32_16x16x32_bf16 v[24:27], v[248:251], v[140:143], v[24:27]
  s_waitcnt lgkmcnt(10)
  v_mfma_f32_16x16x32_bf16 v[92:95], v[252:255], v[152:155], v[92:95]
  ds_read_b64_tr_b16 v[240:241], v9 offset:7936
  ds_read_b64_tr_b16 v[242:243], v9 offset:15616
  v_mfma_f32_16x16x32_bf16 v[28:31], v[252:255], v[140:143], v[28:31]
  ds_read_b64_tr_b16 v[244:245], v10 offset:7936
  ds_read_b64_tr_b16 v[246:247], v10 offset:15616
  v_mfma_f32_16x16x32_bf16 v[96:99], v[216:219], v[152:155], v[96:99]
  v_cvt_pk_bf16_f32 v156, v88, v89
  v_cvt_pk_bf16_f32 v157, v90, v91
  v_mfma_f32_16x16x32_bf16 v[32:35], v[216:219], v[140:143], v[32:35]
  v_cvt_pk_bf16_f32 v158, v92, v93
  s_waitcnt lgkmcnt(10)
  v_mfma_f32_16x16x32_bf16 v[100:103], v[220:223], v[152:155], v[100:103]
  ds_read_b64_tr_b16 v[248:249], v11 offset:7936
  ds_read_b64_tr_b16 v[250:251], v11 offset:15616
  v_mfma_f32_16x16x32_bf16 v[36:39], v[220:223], v[140:143], v[36:39]
  ds_read_b64_tr_b16 v[252:253], v12 offset:7936
  ds_read_b64_tr_b16 v[254:255], v12 offset:15616
  v_mfma_f32_16x16x32_bf16 v[104:107], v[224:227], v[152:155], v[104:107]
  v_cvt_pk_bf16_f32 v159, v94, v95
  v_cvt_pk_bf16_f32 v160, v96, v97
  v_mfma_f32_16x16x32_bf16 v[40:43], v[224:227], v[140:143], v[40:43]
  v_cvt_pk_bf16_f32 v161, v98, v99
  s_waitcnt lgkmcnt(10)
  v_mfma_f32_16x16x32_bf16 v[108:111], v[228:231], v[152:155], v[108:111]
  ds_read_b64_tr_b16 v[216:217], v15 offset:0
  ds_read_b64_tr_b16 v[218:219], v9 offset:0
  v_mfma_f32_16x16x32_bf16 v[44:47], v[228:231], v[140:143], v[44:47]
  ds_read_b64_tr_b16 v[220:221], v16 offset:0
  ds_read_b64_tr_b16 v[222:223], v10 offset:0
  v_mfma_f32_16x16x32_bf16 v[112:115], v[232:235], v[152:155], v[112:115]
  v_cvt_pk_bf16_f32 v162, v100, v101
  v_cvt_pk_bf16_f32 v163, v102, v103
  v_mfma_f32_16x16x32_bf16 v[48:51], v[232:235], v[140:143], v[48:51]
  v_cvt_pk_bf16_f32 v164, v104, v105
  s_waitcnt lgkmcnt(10)
  v_mfma_f32_16x16x32_bf16 v[116:119], v[236:239], v[152:155], v[116:119]
  ds_read_b64_tr_b16 v[224:225], v17 offset:0
  ds_read_b64_tr_b16 v[226:227], v11 offset:0
  v_mfma_f32_16x16x32_bf16 v[52:55], v[236:239], v[140:143], v[52:55]
  ds_read_b64_tr_b16 v[228:229], v18 offset:0
  ds_read_b64_tr_b16 v[230:231], v12 offset:0
  v_mfma_f32_16x16x32_bf16 v[120:123], v[240:243], v[152:155], v[120:123]
  v_cvt_pk_bf16_f32 v165, v106, v107
  v_cvt_pk_bf16_f32 v166, v108, v109
  v_mfma_f32_16x16x32_bf16 v[56:59], v[240:243], v[140:143], v[56:59]
  v_cvt_pk_bf16_f32 v167, v110, v111
  s_waitcnt lgkmcnt(10)
  v_mfma_f32_16x16x32_bf16 v[124:127], v[244:247], v[152:155], v[124:127]
  ds_read_b64_tr_b16 v[232:233], v15 offset:128
  ds_read_b64_tr_b16 v[234:235], v9 offset:128
  v_mfma_f32_16x16x32_bf16 v[60:63], v[244:247], v[140:143], v[60:63]
  ds_read_b64_tr_b16 v[236:237], v16 offset:128
  ds_read_b64_tr_b16 v[238:239], v10 offset:128
  v_mfma_f32_16x16x32_bf16 v[128:131], v[248:251], v[152:155], v[128:131]
  v_cvt_pk_bf16_f32 v176, v112, v113
  v_cvt_pk_bf16_f32 v177, v114, v115
  v_mfma_f32_16x16x32_bf16 v[64:67], v[248:251], v[140:143], v[64:67]
  v_cvt_pk_bf16_f32 v178, v116, v117
  s_waitcnt lgkmcnt(10)
  v_mfma_f32_16x16x32_bf16 v[132:135], v[252:255], v[152:155], v[132:135]
  ds_read_b64_tr_b16 v[240:241], v17 offset:128
  ds_read_b64_tr_b16 v[242:243], v11 offset:128
  v_mfma_f32_16x16x32_bf16 v[68:71], v[252:255], v[140:143], v[68:71]
  ds_read_b64_tr_b16 v[244:245], v18 offset:128
  ds_read_b64_tr_b16 v[246:247], v12 offset:128
  v_mfma_f32_16x16x32_bf16 v[24:27], v[216:219], v[136:139], v[24:27]
  v_cvt_pk_bf16_f32 v179, v118, v119
  s_waitcnt lgkmcnt(10)
  v_mfma_f32_16x16x32_bf16 v[28:31], v[220:223], v[136:139], v[28:31]
  ds_read_b64_tr_b16 v[248:249], v15 offset:256
  ds_read_b64_tr_b16 v[250:251], v9 offset:256
  v_mfma_f32_16x16x32_bf16 v[32:35], v[224:227], v[136:139], v[32:35]
  ds_read_b64_tr_b16 v[252:253], v16 offset:256
  ds_read_b64_tr_b16 v[254:255], v10 offset:256
  s_waitcnt lgkmcnt(10)
  v_mfma_f32_16x16x32_bf16 v[36:39], v[228:231], v[136:139], v[36:39]
  ds_read_b64_tr_b16 v[216:217], v17 offset:256
  ds_read_b64_tr_b16 v[218:219], v11 offset:256
  v_mfma_f32_16x16x32_bf16 v[40:43], v[232:235], v[136:139], v[40:43]
  ds_read_b64_tr_b16 v[220:221], v18 offset:256
  ds_read_b64_tr_b16 v[222:223], v12 offset:256
  s_waitcnt lgkmcnt(10)
  v_mfma_f32_16x16x32_bf16 v[44:47], v[236:239], v[136:139], v[44:47]
  v_cvt_pk_bf16_f32 v180, v120, v121
  v_cvt_pk_bf16_f32 v181, v122, v123
  s_waitcnt lgkmcnt(0)
  s_cbranch_vccz SL37
  s_waitcnt vmcnt(0)
  s_barrier
  s_add_u32 m0, s40, 102400
  s_add_u32 s100, s40, 40960
  buffer_load_dwordx4 v1, s[20:23], s100 offen sc1 lds
  s_add_u32 m0, s40, 106496
  s_add_u32 s100, s40, 45056
  buffer_load_dwordx4 v1, s[20:23], s100 offen sc1 lds
  s_add_u32 m0, s40, 110592
  s_add_u32 s100, s40, 49152
  buffer_load_dwordx4 v1, s[20:23], s100 offen sc1 lds
  s_add_u32 m0, s40, 114688
  s_add_u32 s100, s40, 53248
  buffer_load_dwordx4 v1, s[20:23], s100 offen sc1 lds
  s_add_u32 m0, s40, 118784
  s_add_u32 s100, s40, 57344
  buffer_load_dwordx4 v1, s[20:23], s100 offen sc1 lds
  s_add_u32 m0, s40, 122880
  s_add_u32 s100, s40, 61440
  buffer_load_dwordx4 v1, s[20:23], s100 offen sc1 lds
  s_add_u32 m0, s40, 126976
  s_add_u32 s100, s40, 65536
  buffer_load_dwordx4 v1, s[20:23], s100 offen sc1 lds
  s_min_u32 s51, s40, 1024
  s_add_u32 m0, s51, 131072
  s_add_u32 s100, s51, 69632
  buffer_load_dwordx4 v1, s[20:23], s100 offen sc1 lds
SL37:
  ds_read_b128 v[224:227], v2 offset:30720
  ds_read_b128 v[228:231], v2 offset:31744
  ds_read_b128 v[232:235], v2 offset:32768
  ds_read_b128 v[236:239], v2 offset:33792
  v_mfma_f32_16x16x32_bf16 v[48:51], v[240:243], v[136:139], v[48:51]
  ds_read_b128 v[240:243], v2 offset:34816
  v_cvt_pk_bf16_f32 v182, v124, v125
  v_mfma_f32_16x16x32_bf16 v[52:55], v[244:247], v[136:139], v[52:55]
  ds_read_b128 v[244:247], v2 offset:35840
  v_cvt_pk_bf16_f32 v183, v126, v127
  v_mfma_f32_16x16x32_bf16 v[56:59], v[248:251], v[136:139], v[56:59]
  ds_read_b128 v[248:251], v2 offset:36864
  v_cvt_pk_bf16_f32 v72, v128, v129
  v_mfma_f32_16x16x32_bf16 v[60:63], v[252:255], v[136:139], v[60:63]
  ds_read_b128 v[252:255], v2 offset:37888
  v_cvt_pk_bf16_f32 v73, v130, v131
  v_mfma_f32_16x16x32_bf16 v[64:67], v[216:219], v[136:139], v[64:67]
  ds_read_b128 v[216:219], v2 offset:38912
  v_cvt_pk_bf16_f32 v74, v132, v133
  v_mfma_f32_16x16x32_bf16 v[68:71], v[220:223], v[136:139], v[68:71]
  ds_read_b128 v[220:223], v2 offset:39936
  v_cvt_pk_bf16_f32 v75, v134, v135
  v_cvt_pk_bf16_f32 v140, v24, v25
  v_cvt_pk_bf16_f32 v141, v26, v27
  v_cvt_pk_bf16_f32 v142, v28, v29
  v_cvt_pk_bf16_f32 v143, v30, v31
  s_waitcnt lgkmcnt(8)
  s_nop 0
  v_mfma_f32_16x16x32_bf16 v[184:187], v[224:227], v[140:143], 0
  v_cvt_pk_bf16_f32 v144, v32, v33
  v_cvt_pk_bf16_f32 v145, v34, v35
  v_mfma_f32_16x16x32_bf16 v[192:195], v[224:227], v[156:159], 0
  ds_read_b128 v[224:227], v2 offset:40960
  v_cvt_pk_bf16_f32 v146, v36, v37
  v_mfma_f32_16x16x32_bf16 v[188:191], v[228:231], v[140:143], 0
  v_cvt_pk_bf16_f32 v147, v38, v39
  v_cvt_pk_bf16_f32 v148, v40, v41
  v_mfma_f32_16x16x32_bf16 v[196:199], v[228:231], v[156:159], 0
  ds_read_b128 v[228:231], v2 offset:41984
  s_waitcnt lgkmcnt(8)
  v_mfma_f32_16x16x32_bf16 v[184:187], v[232:235], v[144:147], v[184:187]
  v_cvt_pk_bf16_f32 v149, v42, v43
  v_cvt_pk_bf16_f32 v150, v44, v45
  v_mfma_f32_16x16x32_bf16 v[192:195], v[232:235], v[160:163], v[192:195]
  ds_read_b128 v[232:235], v2 offset:43008
  v_cvt_pk_bf16_f32 v151, v46, v47
  v_mfma_f32_16x16x32_bf16 v[188:191], v[236:239], v[144:147], v[188:191]
  v_cvt_pk_bf16_f32 v168, v48, v49
  v_cvt_pk_bf16_f32 v169, v50, v51
  v_mfma_f32_16x16x32_bf16 v[196:199], v[236:239], v[160:163], v[196:199]
  ds_read_b128 v[236:239], v2 offset:44032
  s_waitcnt lgkmcnt(8)
  v_mfma_f32_16x16x32_bf16 v[184:187], v[240:243], v[148:151], v[184:187]
  v_cvt_pk_bf16_f32 v170, v52, v53
  v_cvt_pk_bf16_f32 v171, v54, v55
  v_mfma_f32_16x16x32_bf16 v[192:195], v[240:243], v[164:167], v[192:195]
  ds_read_b128 v[240:243], v2 offset:45056
  v_cvt_pk_bf16_f32 v172, v56, v57
  v_mfma_f32_16x16x32_bf16 v[188:191], v[244:247], v[148:151], v[188:191]
  v_cvt_pk_bf16_f32 v173, v58, v59
  v_cvt_pk_bf16_f32 v174, v60, v61
  v_mfma_f32_16x16x32_bf16 v[196:199], v[244:247], v[164:167], v[196:199]
  ds_read_b128 v[244:247], v2 offset:46080
  s_waitcnt lgkmcnt(8)
  v_mfma_f32_16x16x32_bf16 v[184:187], v[248:251], v[168:171], v[184:187]
  v_cvt_pk_bf16_f32 v175, v62, v63
  v_cvt_pk_bf16_f32 v152, v64, v65
  v_mfma_f32_16x16x32_bf16 v[192:195], v[248:251], v[176:179], v[192:195]
  ds_read_b128 v[248:251], v2 offset:47104
  v_cvt_pk_bf16_f32 v153, v66, v67
  v_mfma_f32_16x16x32_bf16 v[188:191], v[252:255], v[168:171], v[188:191]
  v_cvt_pk_bf16_f32 v154, v68, v69
  v_cvt_pk_bf16_f32 v155, v70, v71
  v_mfma_f32_16x16x32_bf16 v[196:199], v[252:255], v[176:179], v[196:199]
  ds_read_b128 v[252:255], v2 offset:48128
  s_waitcnt lgkmcnt(8)
  v_mfma_f32_16x16x32_bf16 v[184:187], v[216:219], v[172:175], v[184:187]
  v_mfma_f32_16x16x32_bf16 v[192:195], v[216:219], v[180:183], v[192:195]
  ds_read_b128 v[216:219], v2 offset:49152
  v_mfma_f32_16x16x32_bf16 v[188:191], v[220:223], v[172:175], v[188:191]
  v_mfma_f32_16x16x32_bf16 v[196:199], v[220:223], v[180:183], v[196:199]
  ds_read_b128 v[220:223], v2 offset:50176
  s_waitcnt lgkmcnt(8)
  v_mfma_f32_16x16x32_bf16 v[184:187], v[224:227], v[152:155], v[184:187]
  v_mfma_f32_16x16x32_bf16 v[192:195], v[224:227], v[72:75], v[192:195]
  ds_read_b128 v[224:227], v2 offset:51200
  v_mfma_f32_16x16x32_bf16 v[188:191], v[228:231], v[152:155], v[188:191]
  v_mfma_f32_16x16x32_bf16 v[196:199], v[228:231], v[72:75], v[196:199]
  ds_read_b128 v[228:231], v2 offset:52224
  s_mov_b32 s100, 71680
  buffer_load_dwordx4 v[40:43], v1, s[20:23], s100 offen offset:0 sc1
  buffer_load_dwordx4 v[44:47], v1, s[20:23], s100 offen offset:1024 sc1
  s_waitcnt lgkmcnt(8)
  v_mfma_f32_16x16x32_bf16 v[200:203], v[232:235], v[140:143], 0
  v_mul_f32 v184, v184, v22
  v_mul_f32 v185, v185, v22
  v_mfma_f32_16x16x32_bf16 v[208:211], v[232:235], v[156:159], 0
  ds_read_b128 v[232:235], v2 offset:53248
  v_mul_f32 v186, v186, v22
  v_mfma_f32_16x16x32_bf16 v[204:207], v[236:239], v[140:143], 0
  v_mul_f32 v187, v187, v22
  v_mul_f32 v188, v188, v22
  v_mfma_f32_16x16x32_bf16 v[212:215], v[236:239], v[156:159], 0
  ds_read_b128 v[236:239], v2 offset:54272
  s_waitcnt lgkmcnt(8)
  v_mfma_f32_16x16x32_bf16 v[200:203], v[240:243], v[144:147], v[200:203]
  v_mul_f32 v189, v189, v22
  v_mul_f32 v190, v190, v22
  v_mfma_f32_16x16x32_bf16 v[208:211], v[240:243], v[160:163], v[208:211]
  ds_read_b128 v[240:243], v2 offset:55296
  v_mul_f32 v191, v191, v22
  v_mfma_f32_16x16x32_bf16 v[204:207], v[244:247], v[144:147], v[204:207]
  v_cvt_pk_bf16_f32 v24, v184, v185
  v_cvt_pk_bf16_f32 v25, v186, v187
  v_mfma_f32_16x16x32_bf16 v[212:215], v[244:247], v[160:163], v[212:215]
  ds_read_b128 v[244:247], v2 offset:56320
  s_waitcnt lgkmcnt(8)
  v_mfma_f32_16x16x32_bf16 v[200:203], v[248:251], v[148:151], v[200:203]
  v_cvt_pk_bf16_f32 v26, v188, v189
  v_cvt_pk_bf16_f32 v27, v190, v191
  v_mfma_f32_16x16x32_bf16 v[208:211], v[248:251], v[164:167], v[208:211]
  buffer_store_dwordx4 v[24:27], v5, s[16:19], 0 offen offset:0 nt sc1
  v_mul_f32 v192, v192, v23
  v_mfma_f32_16x16x32_bf16 v[204:207], v[252:255], v[148:151], v[204:207]
  ds_read_b128 v[248:251], v2 offset:57344
  v_mul_f32 v193, v193, v23
  v_mfma_f32_16x16x32_bf16 v[212:215], v[252:255], v[164:167], v[212:215]
  ds_read_b128 v[252:255], v2 offset:58368
  s_waitcnt lgkmcnt(8)
  v_mfma_f32_16x16x32_bf16 v[200:203], v[216:219], v[168:171], v[200:203]
  v_mul_f32 v194, v194, v23
  v_mul_f32 v195, v195, v23
  v_mfma_f32_16x16x32_bf16 v[208:211], v[216:219], v[176:179], v[208:211]
  ds_read_b128 v[216:219], v2 offset:59392
  v_mul_f32 v196, v196, v23
  v_mfma_f32_16x16x32_bf16 v[204:207], v[220:223], v[168:171], v[204:207]
  v_mul_f32 v197, v197, v23
  v_mul_f32 v198, v198, v23
  v_mfma_f32_16x16x32_bf16 v[212:215], v[220:223], v[176:179], v[212:215]
  ds_read_b128 v[220:223], v2 offset:60416
  s_waitcnt lgkmcnt(8)
  v_mfma_f32_16x16x32_bf16 v[200:203], v[224:227], v[172:175], v[200:203]
  v_mul_f32 v199, v199, v23
  v_cvt_pk_bf16_f32 v28, v192, v193
  v_mfma_f32_16x16x32_bf16 v[208:211], v[224:227], v[180:183], v[208:211]
  ds_read_b128 v[224:227], v1 offset:0
  v_cvt_pk_bf16_f32 v29, v194, v195
  v_mfma_f32_16x16x32_bf16 v[204:207], v[228:231], v[172:175], v[204:207]
  v_cvt_pk_bf16_f32 v30, v196, v197
  v_cvt_pk_bf16_f32 v31, v198, v199
  v_mfma_f32_16x16x32_bf16 v[212:215], v[228:231], v[180:183], v[212:215]
  buffer_store_dwordx4 v[28:31], v6, s[16:19], 0 offen offset:0 nt sc1
  s_waitcnt lgkmcnt(7)
  v_mfma_f32_16x16x32_bf16 v[200:203], v[232:235], v[152:155], v[200:203]
  ds_read_b128 v[228:231], v1 offset:1024
  v_mfma_f32_16x16x32_bf16 v[208:211], v[232:235], v[72:75], v[208:211]
  ds_read_b128 v[232:235], v1 offset:2048
  v_mfma_f32_16x16x32_bf16 v[204:207], v[236:239], v[152:155], v[204:207]
  v_mfma_f32_16x16x32_bf16 v[212:215], v[236:239], v[72:75], v[212:215]
  ds_read_b128 v[236:239], v1 offset:3072
  s_cbranch_vccz SL38
  s_waitcnt vmcnt(4)
  s_barrier
SL38:
  s_waitcnt lgkmcnt(8)
  v_mfma_f32_16x16x32_bf16 v[184:187], v[240:243], v[140:143], 0
  v_mul_f32 v200, v200, v22
  v_mul_f32 v201, v201, v22
  v_mfma_f32_16x16x32_bf16 v[192:195], v[240:243], v[156:159], 0
  ds_read_b128 v[240:243], v1 offset:4096
  v_mul_f32 v202, v202, v22
  v_mfma_f32_16x16x32_bf16 v[188:191], v[244:247], v[140:143], 0
  v_mul_f32 v203, v203, v22
  v_mul_f32 v204, v204, v22
  v_mfma_f32_16x16x32_bf16 v[196:199], v[244:247], v[156:159], 0
  ds_read_b128 v[244:247], v1 offset:5120
  s_waitcnt lgkmcnt(8)
  v_mfma_f32_16x16x32_bf16 v[184:187], v[248:251], v[144:147], v[184:187]
  v_mul_f32 v205, v205, v22
  v_mul_f32 v206, v206, v22
  v_mfma_f32_16x16x32_bf16 v[192:195], v[248:251], v[160:163], v[192:195]
  ds_read_b128 v[248:251], v1 offset:6144
  v_mul_f32 v207, v207, v22
  v_mfma_f32_16x16x32_bf16 v[188:191], v[252:255], v[144:147], v[188:191]
  v_cvt_pk_bf16_f32 v32, v200, v201
  v_cvt_pk_bf16_f32 v33, v202, v203
  v_mfma_f32_16x16x32_bf16 v[196:199], v[252:255], v[160:163], v[196:199]
  ds_read_b128 v[252:255], v1 offset:7168
  s_waitcnt lgkmcnt(8)
  v_mfma_f32_16x16x32_bf16 v[184:187], v[216:219], v[148:151], v[184:187]
  v_cvt_pk_bf16_f32 v34, v204, v205
  v_cvt_pk_bf16_f32 v35, v206, v207
  v_mfma_f32_16x16x32_bf16 v[192:195], v[216:219], v[164:167], v[192:195]
  buffer_store_dwordx4 v[32:35], v5, s[16:19], 0 offen offset:64 nt sc1
  v_mul_f32 v208, v208, v23
  v_mfma_f32_16x16x32_bf16 v[188:191], v[220:223], v[148:151], v[188:191]
  ds_read_b128 v[216:219], v1 offset:8192
  v_mul_f32 v209, v209, v23
  v_mfma_f32_16x16x32_bf16 v[196:199], v[220:223], v[164:167], v[196:199]
  ds_read_b128 v[220:223], v1 offset:9216
  s_waitcnt lgkmcnt(8)
  v_mfma_f32_16x16x32_bf16 v[184:187], v[224:227], v[168:171], v[184:187]
  v_mul_f32 v210, v210, v23
  v_mul_f32 v211, v211, v23
  v_mfma_f32_16x16x32_bf16 v[192:195], v[224:227], v[176:179], v[192:195]
  ds_read_b128 v[224:227], v2 offset:0
  v_mul_f32 v212, v212, v23
  v_mfma_f32_16x16x32_bf16 v[188:191], v[228:231], v[168:171], v[188:191]
  v_mul_f32 v213, v213, v23
  v_mul_f32 v214, v214, v23
  v_mfma_f32_16x16x32_bf16 v[196:199], v[228:231], v[176:179], v[196:199]
  ds_read_b128 v[228:231], v2 offset:1024
  s_waitcnt lgkmcnt(8)
  v_mfma_f32_16x16x32_bf16 v[184:187], v[232:235], v[172:175], v[184:187]
  v_mul_f32 v215, v215, v23
  v_cvt_pk_bf16_f32 v36, v208, v209
  v_mfma_f32_16x16x32_bf16 v[192:195], v[232:235], v[180:183], v[192:195]
  ds_read_b128 v[232:235], v2 offset:2048
  v_cvt_pk_bf16_f32 v37, v210, v211
  v_mfma_f32_16x16x32_bf16 v[188:191], v[236:239], v[172:175], v[188:191]
  v_cvt_pk_bf16_f32 v38, v212, v213
  v_cvt_pk_bf16_f32 v39, v214, v215
  v_mfma_f32_16x16x32_bf16 v[196:199], v[236:239], v[180:183], v[196:199]
  buffer_store_dwordx4 v[36:39], v6, s[16:19], 0 offen offset:64 nt sc1
  s_waitcnt lgkmcnt(7)
  v_mfma_f32_16x16x32_bf16 v[184:187], v[240:243], v[152:155], v[184:187]
  ds_read_b128 v[236:239], v2 offset:3072
  v_mfma_f32_16x16x32_bf16 v[192:195], v[240:243], v[72:75], v[192:195]
  ds_read_b128 v[240:243], v2 offset:4096
  v_mfma_f32_16x16x32_bf16 v[188:191], v[244:247], v[152:155], v[188:191]
  v_mfma_f32_16x16x32_bf16 v[196:199], v[244:247], v[72:75], v[196:199]
  ds_read_b128 v[244:247], v2 offset:5120
  s_waitcnt lgkmcnt(8)
  v_mfma_f32_16x16x32_bf16 v[200:203], v[248:251], v[140:143], 0
  v_mul_f32 v184, v184, v22
  v_mul_f32 v185, v185, v22
  v_mfma_f32_16x16x32_bf16 v[208:211], v[248:251], v[156:159], 0
  ds_read_b128 v[248:251], v2 offset:6144
  v_mul_f32 v186, v186, v22
  v_mfma_f32_16x16x32_bf16 v[204:207], v[252:255], v[140:143], 0
  v_mul_f32 v187, v187, v22
  v_mul_f32 v188, v188, v22
  v_mfma_f32_16x16x32_bf16 v[212:215], v[252:255], v[156:159], 0
  ds_read_b128 v[252:255], v2 offset:7168
  s_waitcnt lgkmcnt(8)
  v_mfma_f32_16x16x32_bf16 v[200:203], v[216:219], v[144:147], v[200:203]
  v_mul_f32 v189, v189, v22
  v_mul_f32 v190, v190, v22
  v_mfma_f32_16x16x32_bf16 v[208:211], v[216:219], v[160:163], v[208:211]
  ds_read_b128 v[216:219], v2 offset:8192
  v_mul_f32 v191, v191, v22
  v_mfma_f32_16x16x32_bf16 v[204:207], v[220:223], v[144:147], v[204:207]
  v_cvt_pk_bf16_f32 v24, v184, v185
  v_cvt_pk_bf16_f32 v25, v186, v187
  v_mfma_f32_16x16x32_bf16 v[212:215], v[220:223], v[160:163], v[212:215]
  ds_read_b128 v[220:223], v2 offset:9216
  s_waitcnt lgkmcnt(8)
  v_mfma_f32_16x16x32_bf16 v[200:203], v[224:227], v[148:151], v[200:203]
  v_cvt_pk_bf16_f32 v26, v188, v189
  v_cvt_pk_bf16_f32 v27, v190, v191
  v_mfma_f32_16x16x32_bf16 v[208:211], v[224:227], v[164:167], v[208:211]
  buffer_store_dwordx4 v[24:27], v5, s[16:19], 0 offen offset:128 nt sc1
  v_mul_f32 v192, v192, v23
  v_mfma_f32_16x16x32_bf16 v[204:207], v[228:231], v[148:151], v[204:207]
  ds_read_b128 v[224:227], v2 offset:10240
  v_mul_f32 v193, v193, v23
  v_mfma_f32_16x16x32_bf16 v[212:215], v[228:231], v[164:167], v[212:215]
  ds_read_b128 v[228:231], v2 offset:11264
  s_waitcnt lgkmcnt(8)
  v_mfma_f32_16x16x32_bf16 v[200:203], v[232:235], v[168:171], v[200:203]
  v_mul_f32 v194, v194, v23
  v_mul_f32 v195, v195, v23
  v_mfma_f32_16x16x32_bf16 v[208:211], v[232:235], v[176:179], v[208:211]
  ds_read_b128 v[232:235], v2 offset:12288
  v_mul_f32 v196, v196, v23
  v_mfma_f32_16x16x32_bf16 v[204:207], v[236:239], v[168:171], v[204:207]
  v_mul_f32 v197, v197, v23
  v_mul_f32 v198, v198, v23
  v_mfma_f32_16x16x32_bf16 v[212:215], v[236:239], v[176:179], v[212:215]
  ds_read_b128 v[236:239], v2 offset:13312
  s_waitcnt lgkmcnt(8)
  v_mfma_f32_16x16x32_bf16 v[200:203], v[240:243], v[172:175], v[200:203]
  v_mul_f32 v199, v199, v23
  v_cvt_pk_bf16_f32 v28, v192, v193
  v_mfma_f32_16x16x32_bf16 v[208:211], v[240:243], v[180:183], v[208:211]
  ds_read_b128 v[240:243], v2 offset:14336
  v_cvt_pk_bf16_f32 v29, v194, v195
  v_mfma_f32_16x16x32_bf16 v[204:207], v[244:247], v[172:175], v[204:207]
  v_cvt_pk_bf16_f32 v30, v196, v197
  v_cvt_pk_bf16_f32 v31, v198, v199
  v_mfma_f32_16x16x32_bf16 v[212:215], v[244:247], v[180:183], v[212:215]
  buffer_store_dwordx4 v[28:31], v6, s[16:19], 0 offen offset:128 nt sc1
  s_waitcnt lgkmcnt(7)
  v_mfma_f32_16x16x32_bf16 v[200:203], v[248:251], v[152:155], v[200:203]
  ds_read_b128 v[244:247], v2 offset:15360
  v_mfma_f32_16x16x32_bf16 v[208:211], v[248:251], v[72:75], v[208:211]
  ds_read_b128 v[248:251], v2 offset:16384
  v_mfma_f32_16x16x32_bf16 v[204:207], v[252:255], v[152:155], v[204:207]
  v_mfma_f32_16x16x32_bf16 v[212:215], v[252:255], v[72:75], v[212:215]
  ds_read_b128 v[252:255], v2 offset:17408
  s_waitcnt lgkmcnt(8)
  v_mfma_f32_16x16x32_bf16 v[184:187], v[216:219], v[140:143], 0
  v_mul_f32 v200, v200, v22
  v_mul_f32 v201, v201, v22
  v_mfma_f32_16x16x32_bf16 v[192:195], v[216:219], v[156:159], 0
  ds_read_b128 v[216:219], v2 offset:18432
  v_mul_f32 v202, v202, v22
  v_mfma_f32_16x16x32_bf16 v[188:191], v[220:223], v[140:143], 0
  v_mul_f32 v203, v203, v22
  v_mul_f32 v204, v204, v22
  v_mfma_f32_16x16x32_bf16 v[196:199], v[220:223], v[156:159], 0
  ds_read_b128 v[220:223], v2 offset:19456
  s_waitcnt lgkmcnt(8)
  v_mfma_f32_16x16x32_bf16 v[184:187], v[224:227], v[144:147], v[184:187]
  v_mul_f32 v205, v205, v22
  v_mul_f32 v206, v206, v22
  v_mfma_f32_16x16x32_bf16 v[192:195], v[224:227], v[160:163], v[192:195]
  ds_read_b128 v[224:227], v2 offset:20480
  v_mul_f32 v207, v207, v22
  v_mfma_f32_16x16x32_bf16 v[188:191], v[228:231], v[144:147], v[188:191]
  v_cvt_pk_bf16_f32 v32, v200, v201
  v_cvt_pk_bf16_f32 v33, v202, v203
  v_mfma_f32_16x16x32_bf16 v[196:199], v[228:231], v[160:163], v[196:199]
  ds_read_b128 v[228:231], v2 offset:21504
  s_waitcnt lgkmcnt(8)
  v_mfma_f32_16x16x32_bf16 v[184:187], v[232:235], v[148:151], v[184:187]
  v_cvt_pk_bf16_f32 v34, v204, v205
  v_cvt_pk_bf16_f32 v35, v206, v207
  v_mfma_f32_16x16x32_bf16 v[192:195], v[232:235], v[164:167], v[192:195]
  buffer_store_dwordx4 v[32:35], v5, s[16:19], 0 offen offset:192 nt sc1
  v_mul_f32 v208, v208, v23
  v_mfma_f32_16x16x32_bf16 v[188:191], v[236:239], v[148:151], v[188:191]
  ds_read_b128 v[232:235], v2 offset:22528
  v_mul_f32 v209, v209, v23
  v_mfma_f32_16x16x32_bf16 v[196:199], v[236:239], v[164:167], v[196:199]
  ds_read_b128 v[236:239], v2 offset:23552
  s_waitcnt lgkmcnt(8)
  v_mfma_f32_16x16x32_bf16 v[184:187], v[240:243], v[168:171], v[184:187]
  v_mul_f32 v210, v210, v23
  v_mul_f32 v211, v211, v23
  v_mfma_f32_16x16x32_bf16 v[192:195], v[240:243], v[176:179], v[192:195]
  ds_read_b128 v[240:243], v2 offset:24576
  v_mul_f32 v212, v212, v23
  v_mfma_f32_16x16x32_bf16 v[188:191], v[244:247], v[168:171], v[188:191]
  v_mul_f32 v213, v213, v23
  v_mul_f32 v214, v214, v23
  v_mfma_f32_16x16x32_bf16 v[196:199], v[244:247], v[176:179], v[196:199]
  ds_read_b128 v[244:247], v2 offset:25600
  s_waitcnt lgkmcnt(8)
  v_mfma_f32_16x16x32_bf16 v[184:187], v[248:251], v[172:175], v[184:187]
  v_mul_f32 v215, v215, v23
  v_cvt_pk_bf16_f32 v36, v208, v209
  v_mfma_f32_16x16x32_bf16 v[192:195], v[248:251], v[180:183], v[192:195]
  ds_read_b128 v[248:251], v2 offset:26624
  v_cvt_pk_bf16_f32 v37, v210, v211
  v_mfma_f32_16x16x32_bf16 v[188:191], v[252:255], v[172:175], v[188:191]
  v_cvt_pk_bf16_f32 v38, v212, v213
  v_cvt_pk_bf16_f32 v39, v214, v215
  v_mfma_f32_16x16x32_bf16 v[196:199], v[252:255], v[180:183], v[196:199]
  buffer_store_dwordx4 v[36:39], v6, s[16:19], 0 offen offset:192 nt sc1
  s_waitcnt lgkmcnt(7)
  v_mfma_f32_16x16x32_bf16 v[184:187], v[216:219], v[152:155], v[184:187]
  ds_read_b128 v[252:255], v2 offset:27648
  v_mfma_f32_16x16x32_bf16 v[192:195], v[216:219], v[72:75], v[192:195]
  ds_read_b128 v[216:219], v2 offset:28672
  v_mfma_f32_16x16x32_bf16 v[188:191], v[220:223], v[152:155], v[188:191]
  v_mfma_f32_16x16x32_bf16 v[196:199], v[220:223], v[72:75], v[196:199]
  ds_read_b128 v[220:223], v2 offset:29696
  s_waitcnt vmcnt(8)
  s_waitcnt lgkmcnt(8)
  v_mfma_f32_16x16x32_bf16 v[200:203], v[224:227], v[140:143], 0
  v_mul_f32 v184, v184, v22
  v_mul_f32 v185, v185, v22
  v_mfma_f32_16x16x32_bf16 v[208:211], v[224:227], v[156:159], 0
  v_mul_f32 v186, v186, v22
  v_mul_f32 v187, v187, v22
  v_mfma_f32_16x16x32_bf16 v[204:207], v[228:231], v[140:143], 0
  v_mul_f32 v188, v188, v22
  v_mul_f32 v189, v189, v22
  v_mfma_f32_16x16x32_bf16 v[212:215], v[228:231], v[156:159], 0
  v_mul_f32 v190, v190, v22
  s_waitcnt lgkmcnt(6)
  v_mfma_f32_16x16x32_bf16 v[200:203], v[232:235], v[144:147], v[200:203]
  v_mul_f32 v191, v191, v22
  v_cvt_pk_bf16_f32 v24, v184, v185
  v_mfma_f32_16x16x32_bf16 v[208:211], v[232:235], v[160:163], v[208:211]
  v_cvt_pk_bf16_f32 v25, v186, v187
  v_cvt_pk_bf16_f32 v26, v188, v189
  v_mfma_f32_16x16x32_bf16 v[204:207], v[236:239], v[144:147], v[204:207]
  v_cvt_pk_bf16_f32 v27, v190, v191
  v_mul_f32 v192, v192, v23
  v_mfma_f32_16x16x32_bf16 v[212:215], v[236:239], v[160:163], v[212:215]
  buffer_store_dwordx4 v[24:27], v5, s[16:19], 0 offen offset:256 nt sc1
  v_mul_f32 v193, v193, v23
  s_waitcnt lgkmcnt(5)
  v_mfma_f32_16x16x32_bf16 v[200:203], v[240:243], v[148:151], v[200:203]
  v_mul_f32 v194, v194, v23
  v_mul_f32 v195, v195, v23
  v_mfma_f32_16x16x32_bf16 v[208:211], v[240:243], v[164:167], v[208:211]
  v_mul_f32 v196, v196, v23
  s_waitcnt lgkmcnt(4)
  v_mfma_f32_16x16x32_bf16 v[204:207], v[244:247], v[148:151], v[204:207]
  v_mul_f32 v197, v197, v23
  v_mul_f32 v198, v198, v23
  v_mfma_f32_16x16x32_bf16 v[212:215], v[244:247], v[164:167], v[212:215]
  v_mul_f32 v199, v199, v23
  s_waitcnt lgkmcnt(3)
  v_mfma_f32_16x16x32_bf16 v[200:203], v[248:251], v[168:171], v[200:203]
  v_cvt_pk_bf16_f32 v28, v192, v193
  v_cvt_pk_bf16_f32 v29, v194, v195
  v_mfma_f32_16x16x32_bf16 v[208:211], v[248:251], v[176:179], v[208:211]
  v_cvt_pk_bf16_f32 v30, v196, v197
  s_waitcnt lgkmcnt(2)
  v_mfma_f32_16x16x32_bf16 v[204:207], v[252:255], v[168:171], v[204:207]
  v_cvt_pk_bf16_f32 v31, v198, v199
  v_mfma_f32_16x16x32_bf16 v[212:215], v[252:255], v[176:179], v[212:215]
  buffer_store_dwordx4 v[28:31], v6, s[16:19], 0 offen offset:256 nt sc1
  s_waitcnt lgkmcnt(1)
  v_mfma_f32_16x16x32_bf16 v[200:203], v[216:219], v[172:175], v[200:203]
  v_mfma_f32_16x16x32_bf16 v[208:211], v[216:219], v[180:183], v[208:211]
  s_waitcnt lgkmcnt(0)
  v_mfma_f32_16x16x32_bf16 v[204:207], v[220:223], v[172:175], v[204:207]
  v_mfma_f32_16x16x32_bf16 v[212:215], v[220:223], v[180:183], v[212:215]
  v_mfma_f32_16x16x32_bf16 v[200:203], v[40:43], v[152:155], v[200:203]
  v_mfma_f32_16x16x32_bf16 v[208:211], v[40:43], v[72:75], v[208:211]
  v_mfma_f32_16x16x32_bf16 v[204:207], v[44:47], v[152:155], v[204:207]
  v_mfma_f32_16x16x32_bf16 v[212:215], v[44:47], v[72:75], v[212:215]
  s_nop 4
  v_mul_f32 v200, v200, v22
  v_mul_f32 v201, v201, v22
  v_mul_f32 v202, v202, v22
  v_mul_f32 v203, v203, v22
  v_mul_f32 v204, v204, v22
  v_mul_f32 v205, v205, v22
  v_mul_f32 v206, v206, v22
  v_mul_f32 v207, v207, v22
  v_cvt_pk_bf16_f32 v32, v200, v201
  v_cvt_pk_bf16_f32 v33, v202, v203
  v_cvt_pk_bf16_f32 v34, v204, v205
  v_cvt_pk_bf16_f32 v35, v206, v207
  buffer_store_dwordx4 v[32:35], v5, s[16:19], 0 offen offset:320 nt sc1
  v_mul_f32 v208, v208, v23
  v_mul_f32 v209, v209, v23
  v_mul_f32 v210, v210, v23
  v_mul_f32 v211, v211, v23
  v_mul_f32 v212, v212, v23
  v_mul_f32 v213, v213, v23
  v_mul_f32 v214, v214, v23
  v_mul_f32 v215, v215, v23
  v_cvt_pk_bf16_f32 v36, v208, v209
  v_cvt_pk_bf16_f32 v37, v210, v211
  v_cvt_pk_bf16_f32 v38, v212, v213
  v_cvt_pk_bf16_f32 v39, v214, v215
  buffer_store_dwordx4 v[36:39], v6, s[16:19], 0 offen offset:320 nt sc1
MK_done:
  s_endpgm
FB0:
  s_nop 7
  v_max3_f32 v22, v24, v25, v26
  v_max3_f32 v22, v22, v27, v28
  v_max3_f32 v22, v22, v29, v30
  v_max3_f32 v22, v22, v31, v32
  v_max3_f32 v22, v22, v33, v34
  v_max3_f32 v22, v22, v35, v36
  v_max3_f32 v22, v22, v37, v38
  v_max3_f32 v22, v22, v39, v40
  v_max3_f32 v22, v22, v41, v42
  v_max3_f32 v22, v22, v43, v44
  v_max3_f32 v22, v22, v45, v46
  v_max3_f32 v22, v22, v47, v48
  v_max3_f32 v22, v22, v49, v50
  v_max3_f32 v22, v22, v51, v52
  v_max3_f32 v22, v22, v53, v54
  s_mov_b32 s52, 0xff7fffff
  v_max3_f32 v22, v22, v55, s52
  v_mov_b32 v23, v22
  s_nop 1
  v_permlane32_swap_b32 v22, v23
  s_nop 1
  v_max_f32 v22, v22, v23
  v_mov_b32 v23, v22
  s_nop 1
  v_permlane16_swap_b32 v22, v23
  s_nop 1
  v_max_f32 v22, v22, v23
  v_sub_f32 v24, v24, v22
  v_sub_f32 v25, v25, v22
  v_sub_f32 v26, v26, v22
  v_sub_f32 v27, v27, v22
  v_sub_f32 v28, v28, v22
  v_sub_f32 v29, v29, v22
  v_sub_f32 v30, v30, v22
  v_sub_f32 v31, v31, v22
  v_sub_f32 v32, v32, v22
  v_sub_f32 v33, v33, v22
  v_sub_f32 v34, v34, v22
  v_sub_f32 v35, v35, v22
  v_sub_f32 v36, v36, v22
  v_sub_f32 v37, v37, v22
  v_sub_f32 v38, v38, v22
  v_sub_f32 v39, v39, v22
  v_sub_f32 v40, v40, v22
  v_sub_f32 v41, v41, v22
  v_sub_f32 v42, v42, v22
  v_sub_f32 v43, v43, v22
  v_sub_f32 v44, v44, v22
  v_sub_f32 v45, v45, v22
  v_sub_f32 v46, v46, v22
  v_sub_f32 v47, v47, v22
  v_sub_f32 v48, v48, v22
  v_sub_f32 v49, v49, v22
  v_sub_f32 v50, v50, v22
  v_sub_f32 v51, v51, v22
  v_sub_f32 v52, v52, v22
  v_sub_f32 v53, v53, v22
  v_sub_f32 v54, v54, v22
  v_sub_f32 v55, v55, v22
  v_exp_f32 v24, v24
  v_exp_f32 v25, v25
  v_exp_f32 v26, v26
  v_exp_f32 v27, v27
  v_exp_f32 v28, v28
  v_exp_f32 v29, v29
  v_exp_f32 v30, v30
  v_exp_f32 v31, v31
  v_exp_f32 v32, v32
  v_exp_f32 v33, v33
  v_exp_f32 v34, v34
  v_exp_f32 v35, v35
  v_exp_f32 v36, v36
  v_exp_f32 v37, v37
  v_exp_f32 v38, v38
  v_exp_f32 v39, v39
  v_exp_f32 v40, v40
  v_exp_f32 v41, v41
  v_exp_f32 v42, v42
  v_exp_f32 v43, v43
  v_exp_f32 v44, v44
  v_exp_f32 v45, v45
  v_exp_f32 v46, v46
  v_exp_f32 v47, v47
  v_exp_f32 v48, v48
  v_exp_f32 v49, v49
  v_exp_f32 v50, v50
  v_exp_f32 v51, v51
  v_exp_f32 v52, v52
  v_exp_f32 v53, v53
  v_exp_f32 v54, v54
  v_exp_f32 v55, v55
  s_nop 0
  v_cvt_pk_bf16_f32 v136, v24, v25
  v_cvt_pk_bf16_f32 v137, v26, v27
  v_cvt_pk_bf16_f32 v138, v28, v29
  v_cvt_pk_bf16_f32 v139, v30, v31
  v_cvt_pk_bf16_f32 v140, v32, v33
  v_cvt_pk_bf16_f32 v141, v34, v35
  v_cvt_pk_bf16_f32 v142, v36, v37
  v_cvt_pk_bf16_f32 v143, v38, v39
  v_cvt_pk_bf16_f32 v144, v40, v41
  v_cvt_pk_bf16_f32 v145, v42, v43
  v_cvt_pk_bf16_f32 v146, v44, v45
  v_cvt_pk_bf16_f32 v147, v46, v47
  v_cvt_pk_bf16_f32 v148, v48, v49
  v_cvt_pk_bf16_f32 v149, v50, v51
  v_cvt_pk_bf16_f32 v150, v52, v53
  v_cvt_pk_bf16_f32 v151, v54, v55
  s_nop 1
  v_mfma_f32_16x16x32_bf16 v[184:187], v[192:195], v[136:139], 0
  v_mfma_f32_16x16x32_bf16 v[184:187], v[192:195], v[140:143], v[184:187]
  v_mfma_f32_16x16x32_bf16 v[184:187], v[192:195], v[144:147], v[184:187]
  v_mfma_f32_16x16x32_bf16 v[184:187], v[192:195], v[148:151], v[184:187]
  s_nop 7
  s_branch FBR0
FB1:
  s_nop 7
  v_max3_f32 v22, v56, v57, v58
  v_max3_f32 v22, v22, v59, v60
  v_max3_f32 v22, v22, v61, v62
  v_max3_f32 v22, v22, v63, v64
  v_max3_f32 v22, v22, v65, v66
  v_max3_f32 v22, v22, v67, v68
  v_max3_f32 v22, v22, v69, v70
  v_max3_f32 v22, v22, v71, v72
  v_max3_f32 v22, v22, v73, v74
  v_max3_f32 v22, v22, v75, v76
  v_max3_f32 v22, v22, v77, v78
  v_max3_f32 v22, v22, v79, v80
  v_max3_f32 v22, v22, v81, v82
  v_max3_f32 v22, v22, v83, v84
  v_max3_f32 v22, v22, v85, v86
  s_mov_b32 s52, 0xff7fffff
  v_max3_f32 v22, v22, v87, s52
  v_mov_b32 v23, v22
  s_nop 1
  v_permlane32_swap_b32 v22, v23
  s_nop 1
  v_max_f32 v22, v22, v23
  v_mov_b32 v23, v22
  s_nop 1
  v_permlane16_swap_b32 v22, v23
  s_nop 1
  v_max_f32 v22, v22, v23
  v_sub_f32 v56, v56, v22
  v_sub_f32 v57, v57, v22
  v_sub_f32 v58, v58, v22
  v_sub_f32 v59, v59, v22
  v_sub_f32 v60, v60, v22
  v_sub_f32 v61, v61, v22
  v_sub_f32 v62, v62, v22
  v_sub_f32 v63, v63, v22
  v_sub_f32 v64, v64, v22
  v_sub_f32 v65, v65, v22
  v_sub_f32 v66, v66, v22
  v_sub_f32 v67, v67, v22
  v_sub_f32 v68, v68, v22
  v_sub_f32 v69, v69, v22
  v_sub_f32 v70, v70, v22
  v_sub_f32 v71, v71, v22
  v_sub_f32 v72, v72, v22
  v_sub_f32 v73, v73, v22
  v_sub_f32 v74, v74, v22
  v_sub_f32 v75, v75, v22
  v_sub_f32 v76, v76, v22
  v_sub_f32 v77, v77, v22
  v_sub_f32 v78, v78, v22
  v_sub_f32 v79, v79, v22
  v_sub_f32 v80, v80, v22
  v_sub_f32 v81, v81, v22
  v_sub_f32 v82, v82, v22
  v_sub_f32 v83, v83, v22
  v_sub_f32 v84, v84, v22
  v_sub_f32 v85, v85, v22
  v_sub_f32 v86, v86, v22
  v_sub_f32 v87, v87, v22
  v_exp_f32 v56, v56
  v_exp_f32 v57, v57
  v_exp_f32 v58, v58
  v_exp_f32 v59, v59
  v_exp_f32 v60, v60
  v_exp_f32 v61, v61
  v_exp_f32 v62, v62
  v_exp_f32 v63, v63
  v_exp_f32 v64, v64
  v_exp_f32 v65, v65
  v_exp_f32 v66, v66
  v_exp_f32 v67, v67
  v_exp_f32 v68, v68
  v_exp_f32 v69, v69
  v_exp_f32 v70, v70
  v_exp_f32 v71, v71
  v_exp_f32 v72, v72
  v_exp_f32 v73, v73
  v_exp_f32 v74, v74
  v_exp_f32 v75, v75
  v_exp_f32 v76, v76
  v_exp_f32 v77, v77
  v_exp_f32 v78, v78
  v_exp_f32 v79, v79
  v_exp_f32 v80, v80
  v_exp_f32 v81, v81
  v_exp_f32 v82, v82
  v_exp_f32 v83, v83
  v_exp_f32 v84, v84
  v_exp_f32 v85, v85
  v_exp_f32 v86, v86
  v_exp_f32 v87, v87
  s_nop 0
  v_cvt_pk_bf16_f32 v152, v56, v57
  v_cvt_pk_bf16_f32 v153, v58, v59
  v_cvt_pk_bf16_f32 v154, v60, v61
  v_cvt_pk_bf16_f32 v155, v62, v63
  v_cvt_pk_bf16_f32 v156, v64, v65
  v_cvt_pk_bf16_f32 v157, v66, v67
  v_cvt_pk_bf16_f32 v158, v68, v69
  v_cvt_pk_bf16_f32 v159, v70, v71
  v_cvt_pk_bf16_f32 v160, v72, v73
  v_cvt_pk_bf16_f32 v161, v74, v75
  v_cvt_pk_bf16_f32 v162, v76, v77
  v_cvt_pk_bf16_f32 v163, v78, v79
  v_cvt_pk_bf16_f32 v164, v80, v81
  v_cvt_pk_bf16_f32 v165, v82, v83
  v_cvt_pk_bf16_f32 v166, v84, v85
  v_cvt_pk_bf16_f32 v167, v86, v87
  s_nop 1
  v_mfma_f32_16x16x32_bf16 v[188:191], v[192:195], v[152:155], 0
  v_mfma_f32_16x16x32_bf16 v[188:191], v[192:195], v[156:159], v[188:191]
  v_mfma_f32_16x16x32_bf16 v[188:191], v[192:195], v[160:163], v[188:191]
  v_mfma_f32_16x16x32_bf16 v[188:191], v[192:195], v[164:167], v[188:191]
  s_nop 7
  s_branch FBR1
MK_end:
.section .rodata,"a"
.p2align 6
.amdhsa_kernel standalone__neighborhood_nat__vision_kernel
  .amdhsa_next_free_vgpr 256
  .amdhsa_next_free_sgpr 102
  .amdhsa_accum_offset 256
  .amdhsa_group_segment_fixed_size 0
  .amdhsa_kernarg_size 48
  .amdhsa_user_sgpr_count 2
  .amdhsa_user_sgpr_kernarg_segment_ptr 1
  .amdhsa_system_sgpr_workgroup_id_x 1
.end_amdhsa_kernel
```

```asm
; @launch grid=(256,1,1) block=(512,1,1) lds=163840
.amdgcn_target "amdgcn-amd-amdhsa--gfx950"
.text
.globl standalone__neighborhood_nat__vision_kernel
.p2align 8
.type standalone__neighborhood_nat__vision_kernel,@function
standalone__neighborhood_nat__vision_kernel:
  s_cmp_ge_u32 s2, 256
  s_cbranch_scc1 MK_done
  s_load_dwordx8 s[4:11], s[0:1], 0
  s_load_dwordx4 s[84:87], s[0:1], 32
  s_getpc_b64 s[12:13]
MK_pc:
  s_and_b32 s13, s13, 0xffff
  s_mov_b32 s14, MK_end-MK_pc
  s_mov_b32 s15, 0x00020000
  v_lshlrev_b32 v23, 7, v0
  buffer_load_dword v255, v23, s[12:15], 0 offen
  v_lshrrev_b32 v130, 6, v0
  v_and_b32 v0, 63, v0
  v_readfirstlane_b32 s24, v130
  v_and_b32 v128, 15, v0
  v_lshrrev_b32 v129, 4, v0
  v_lshrrev_b32 v130, 5, v0
  v_bfe_u32 v131, v0, 3, 2
  v_lshl_add_u32 v130, v130, 3, v131
  v_mul_u32_u24 v130, 1152, v130
  s_and_b32 s26, s24, 1
  s_lshl_b32 s46, s26, 2
  v_add_u32 v131, s46, v129
  v_and_b32 v132, 7, v0
  v_xor_b32 v131, v131, v132
  v_lshl_add_u32 v96, v131, 4, v130
  s_lshr_b32 s46, s24, 2
  s_lshl_b32 s46, s46, 5
  s_lshl_b32 s47, s26, 4
  s_add_u32 s46, s46, s47
  s_and_b32 s47, s24, 2
  s_lshl_b32 s47, s47, 1
  s_add_u32 s46, s46, s47
  s_mul_i32 s92, s46, 1152
  s_lshl_b32 s41, s24, 10
  s_cmp_lt_u32 s24, 4
  s_cselect_b64 vcc, -1, 0
  s_bfe_u32 s27, s2, 0x10002
  s_bfe_u32 s28, s2, 0x10001
  s_and_b32 s29, s2, 1
  s_lshl_b32 s29, s29, 2
  s_lshr_b32 s46, s2, 6
  s_add_u32 s29, s29, s46
  s_bfe_u32 s30, s2, 0x30003
  s_mul_i32 s37, s29, 14
  s_add_i32 s37, s37, -6
  s_max_i32 s29, s37, -4
  s_mul_i32 s30, s30, 14
  s_add_i32 s30, s30, -6
  s_lshr_b32 s25, s24, 1
  s_add_u32 s25, s25, 2
  s_and_b32 s25, s25, 3
  s_sub_u32 s56, 0, s27
  s_mul_i32 s57, s27, 224
  s_sub_u32 s58, 0, s28
  s_mul_i32 s59, s28, 224
  v_and_b32 v130, 7, v128
  s_mul_i32 s46, s26, 7
  s_add_i32 s46, s46, s30
  v_cmp_lt_u32 s[48:49], 6, v130
  v_add_u32 v130, s46, v130
  v_max_i32 v19, 0, v130
  v_add3_u32 v130, v130, v19, 6
  v_xor_b32 v130, s58, v130
  v_add_u32 v130, s59, v130
  v_subrev_u32 v19, s30, v19
  v_mul_u32_u24 v130, 384, v130
  v_lshl_add_u32 v130, v129, 4, v130
  s_lshl_b32 s46, s25, 2
  s_add_i32 s46, s46, -2
  s_mov_b32 s47, 86016
  v_lshrrev_b32 v131, 3, v128
  v_add_u32 v131, s46, v131
  v_mov_b32 v132, 0x80000000
  v_cmp_gt_i32 s[42:43], 0, v131
  v_add_u32 v5, s37, v131
  v_max_i32 v21, 0, v5
  v_add3_u32 v5, v5, v21, 6
  s_or_b64 s[42:43], s[42:43], s[48:49]
  v_xor_b32 v5, s56, v5
  v_add_u32 v5, s57, v5
  v_subrev_u32 v21, s29, v21
  v_mad_u32_u24 v5, v5, s47, v130
  v_cndmask_b32 v21, v21, v132, s[42:43]
  v_cndmask_b32 v5, v5, v132, s[42:43]
  v_add_u32 v131, 2, v131
  v_cmp_gt_i32 s[44:45], 0, v131
  v_add_u32 v6, s37, v131
  v_max_i32 v22, 0, v6
  v_add3_u32 v6, v6, v22, 6
  s_or_b64 s[44:45], s[44:45], s[48:49]
  v_xor_b32 v6, s56, v6
  v_add_u32 v6, s57, v6
  v_subrev_u32 v22, s29, v22
  v_mad_u32_u24 v6, v6, s47, v130
  v_cndmask_b32 v22, v22, v132, s[44:45]
  v_cndmask_b32 v6, v6, v132, s[44:45]
  s_waitcnt lgkmcnt(0)
  s_mov_b32 s88, s6
  s_and_b32 s89, s7, 0xffff
  s_mov_b32 s90, 221184
  s_mov_b32 s91, 0x00020000
  s_cmp_lg_u32 s24, 5
  s_cbranch_scc1 MK_ntlb
  s_max_i32 s46, s37, 0
  s_lshl_b32 s46, s46, 1
  s_sub_u32 s47, 184, s46
  s_cmp_eq_u32 s27, 0
  s_cselect_b32 s46, s46, s47
  s_mul_i32 s46, s46, 86016
  s_load_dword s94, s[4:5], s46
  s_load_dword s95, s[10:11], s46
  s_add_u32 s46, s46, 1720256
  s_load_dword s94, s[4:5], s46
  s_load_dword s95, s[10:11], s46
  s_add_u32 s46, s46, 1720256
  s_load_dword s94, s[4:5], s46
  s_load_dword s95, s[10:11], s46
  s_load_dword s94, s[84:85], 128
  s_load_dword s95, s[86:87], 0x20000
MK_ntlb:
  s_lshr_b32 s46, s24, 1
  s_cmp_lg_u32 s46, 1
  s_cbranch_scc1 MK_nwpf
  s_cmp_eq_u32 s24, 2
  s_cselect_b32 s46, 54, 18
  s_cselect_b32 s12, s6, s8
  s_cselect_b32 s13, s7, s9
  s_and_b32 s13, s13, 0xffff
  s_lshr_b32 s47, s2, 3
  s_mul_i32 s47, s47, s46
  s_lshl_b32 s100, s47, 7
  s_lshl_b32 s46, s46, 7
  s_add_u32 s14, s100, s46
  s_mov_b32 s15, 0x00020000
  v_lshlrev_b32 v23, 7, v0
  buffer_load_dword v254, v23, s[12:15], s100 offen
MK_nwpf:
  s_mov_b32 s12, s4
  s_and_b32 s13, s5, 0xffff
  s_mov_b32 s14, 19267584
  s_mov_b32 s15, 0x00020000
  s_movk_i32 s54, 112
  s_cbranch_vccz SL1
  s_add_i32 m0, s41, 0
  s_add_i32 s100, s92, 0
  buffer_load_dwordx4 v96, s[88:91], s100 offen lds
  s_add_i32 m0, s41, 8192
  s_add_i32 s100, s92, 73728
  buffer_load_dwordx4 v96, s[88:91], s100 offen lds
  s_add_i32 m0, s41, 16384
  s_add_i32 s100, s92, 147456
  buffer_load_dwordx4 v96, s[88:91], s100 offen lds
  s_add_i32 m0, s41, 24576
  s_add_i32 s100, s92, 384
  buffer_load_dwordx4 v96, s[88:91], s100 offen lds
  s_add_i32 m0, s41, 32768
  s_add_i32 s100, s92, 74112
  buffer_load_dwordx4 v96, s[88:91], s100 offen lds
  s_add_i32 m0, s41, 40960
  s_add_i32 s100, s92, 147840
  buffer_load_dwordx4 v96, s[88:91], s100 offen lds
SL1:
  s_mov_b32 s16, s10
  s_and_b32 s17, s11, 0xffff
  s_mov_b32 s18, 19267584
  s_mov_b32 s19, 0x00020000
  s_mov_b32 s4, s8
  s_and_b32 s5, s9, 0xffff
  s_mov_b32 s6, 73728
  s_mov_b32 s7, 0x00020000
  s_mov_b32 s8, s84
  s_and_b32 s9, s85, 0xffff
  s_mov_b32 s10, 256
  s_mov_b32 s11, 0x00020000
  s_mov_b32 s20, s86
  s_and_b32 s21, s87, 0xffff
  s_mov_b32 s22, 73728
  s_mov_b32 s23, 0x00020000
  v_lshlrev_b32 v1, 4, v0
  v_add_u32 v2, 36864, v1
  s_and_b32 s40, s24, 3
  s_lshl_b32 s40, s40, 10
  v_bfe_u32 v130, v128, 1, 3
  v_xor_b32 v130, v130, v129
  v_lshlrev_b32 v131, 7, v128
  v_lshl_add_u32 v131, v130, 4, v131
  s_lshr_b32 s46, s24, 2
  s_mul_i32 s47, s46, 12288
  v_add_u32 v97, s47, v131
  v_xor_b32 v98, 64, v97
  s_mul_i32 s47, s40, 6
  s_add_u32 s47, s47, 24576
  v_add_u32 v99, s47, v131
  v_xor_b32 v100, 64, v99
  s_lshr_b32 s46, s24, 2
  s_mul_i32 s46, s46, 6
  s_sub_u32 s46, 67, s46
  s_and_b32 s47, s24, 3
  s_mul_i32 s47, s47, 3
  s_add_u32 s48, s47, 0
  s_lshr_b32 s49, s48, 1
  s_mul_i32 s49, s49, 10
  s_add_u32 s48, s48, s49
  s_sub_u32 s48, s46, s48
  s_lshl_b32 s48, s48, 10
  v_add_u32 v101, s48, v1
  s_add_u32 s48, s47, 1
  s_lshr_b32 s49, s48, 1
  s_mul_i32 s49, s49, 10
  s_add_u32 s48, s48, s49
  s_sub_u32 s48, s46, s48
  s_lshl_b32 s48, s48, 10
  v_add_u32 v102, s48, v1
  s_add_u32 s48, s47, 2
  s_lshr_b32 s49, s48, 1
  s_mul_i32 s49, s49, 10
  s_add_u32 s48, s48, s49
  s_sub_u32 s48, s46, s48
  s_lshl_b32 s48, s48, 10
  v_add_u32 v103, s48, v1
  s_lshl_b32 s46, s29, 1
  s_xor_b32 s46, s46, s56
  s_mul_i32 s47, s27, 222
  s_add_i32 s31, s46, s47
  s_mul_i32 s31, s31, 86016
  s_mul_i32 s32, s27, -688128
  s_add_i32 s32, s32, 344064
  s_lshr_b32 s33, s29, 31
  s_lshl_b32 s33, s33, 1
  s_lshl_b32 s38, s40, 2
  s_add_u32 s39, s38, 3072
  s_min_u32 s39, s39, 14336
  s_mul_i32 s48, s27, 172032
  s_sub_u32 s49, 172032, s48
  v_mov_b32 v132, s48
  v_mov_b32 v133, s49
  s_lshr_b32 s46, s38, 4
  s_add_u32 s46, s46, 0
  v_add_u32 v130, s46, v0
  v_mul_u32_u24 v13, 2731, v130
  v_lshrrev_b32 v13, 16, v13
  v_cmp_le_u32 s[52:53], 20, v13
  v_mul_u32_u24 v131, 24, v13
  v_sub_u32 v130, v130, v131
  v_subrev_u32 v131, 20, v13
  v_cndmask_b32 v13, v13, v131, s[52:53]
  v_bfe_u32 v131, v13, 1, 3
  v_xor_b32 v130, v130, v131
  v_cndmask_b32 v131, v132, v133, s[52:53]
  v_lshl_add_u32 v130, v130, 4, v131
  v_add_u32 v13, s30, v13
  v_max_i32 v13, 0, v13
  v_lshlrev_b32 v13, 1, v13
  v_xor_b32 v13, s58, v13
  v_add_u32 v13, s59, v13
  v_mul_u32_u24 v13, 384, v13
  v_add_u32 v13, v13, v130
  s_lshr_b32 s46, s38, 4
  s_add_u32 s46, s46, 64
  v_add_u32 v130, s46, v0
  v_mul_u32_u24 v14, 2731, v130
  v_lshrrev_b32 v14, 16, v14
  v_cmp_le_u32 s[52:53], 20, v14
  v_mul_u32_u24 v131, 24, v14
  v_sub_u32 v130, v130, v131
  v_subrev_u32 v131, 20, v14
  v_cndmask_b32 v14, v14, v131, s[52:53]
  v_bfe_u32 v131, v14, 1, 3
  v_xor_b32 v130, v130, v131
  v_cndmask_b32 v131, v132, v133, s[52:53]
  v_lshl_add_u32 v130, v130, 4, v131
  v_add_u32 v14, s30, v14
  v_max_i32 v14, 0, v14
  v_lshlrev_b32 v14, 1, v14
  v_xor_b32 v14, s58, v14
  v_add_u32 v14, s59, v14
  v_mul_u32_u24 v14, 384, v14
  v_add_u32 v14, v14, v130
  s_lshr_b32 s46, s38, 4
  s_add_u32 s46, s46, 128
  v_add_u32 v130, s46, v0
  v_mul_u32_u24 v3, 2731, v130
  v_lshrrev_b32 v3, 16, v3
  v_cmp_le_u32 s[52:53], 20, v3
  s_cbranch_vccz SL2
  s_add_i32 m0, s41, 4096
  s_add_i32 s100, s92, 36864
  buffer_load_dwordx4 v96, s[88:91], s100 offen lds
  s_add_i32 m0, s41, 12288
  s_add_i32 s100, s92, 110592
  buffer_load_dwordx4 v96, s[88:91], s100 offen lds
  s_add_i32 m0, s41, 20480
  s_add_i32 s100, s92, 184320
  buffer_load_dwordx4 v96, s[88:91], s100 offen lds
  s_add_i32 m0, s41, 28672
  s_add_i32 s100, s92, 37248
  buffer_load_dwordx4 v96, s[88:91], s100 offen lds
  s_add_i32 m0, s41, 36864
  s_add_i32 s100, s92, 110976
  buffer_load_dwordx4 v96, s[88:91], s100 offen lds
  s_add_i32 m0, s41, 45056
  s_add_i32 s100, s92, 184704
  buffer_load_dwordx4 v96, s[88:91], s100 offen lds
SL2:
  v_mul_u32_u24 v131, 24, v3
  v_sub_u32 v130, v130, v131
  v_subrev_u32 v131, 20, v3
  v_cndmask_b32 v3, v3, v131, s[52:53]
  v_bfe_u32 v131, v3, 1, 3
  v_xor_b32 v130, v130, v131
  v_cndmask_b32 v131, v132, v133, s[52:53]
  v_lshl_add_u32 v130, v130, 4, v131
  v_add_u32 v3, s30, v3
  v_max_i32 v3, 0, v3
  v_lshlrev_b32 v3, 1, v3
  v_xor_b32 v3, s58, v3
  v_add_u32 v3, s59, v3
  v_mul_u32_u24 v3, 384, v3
  v_add_u32 v3, v3, v130
  s_lshr_b32 s46, s39, 4
  v_add_u32 v130, s46, v0
  v_mul_u32_u24 v4, 2731, v130
  v_lshrrev_b32 v4, 16, v4
  v_cmp_le_u32 s[52:53], 20, v4
  v_mul_u32_u24 v131, 24, v4
  v_sub_u32 v130, v130, v131
  v_subrev_u32 v131, 20, v4
  v_cndmask_b32 v4, v4, v131, s[52:53]
  v_bfe_u32 v131, v4, 1, 3
  v_xor_b32 v130, v130, v131
  v_cndmask_b32 v131, v132, v133, s[52:53]
  v_lshl_add_u32 v130, v130, 4, v131
  v_add_u32 v4, s30, v4
  v_max_i32 v4, 0, v4
  v_lshlrev_b32 v4, 1, v4
  v_xor_b32 v4, s58, v4
  v_add_u32 v4, s59, v4
  v_mul_u32_u24 v4, 384, v4
  v_add_u32 v4, v4, v130
  s_add_u32 s38, s38, 10240
  s_add_u32 s39, s39, 10240
  s_lshl_b32 s46, s25, 2
  s_add_i32 s46, s46, -2
  s_max_i32 s46, s46, 0
  s_add_i32 s46, s46, s37
  s_max_i32 s46, s46, 0
  s_sub_i32 s46, s46, s29
  s_lshl_b32 s34, s25, 2
  s_add_i32 s34, s34, s37
  s_max_i32 s34, s34, 0
  s_sub_i32 s34, s34, s29
  s_sub_u32 s46, s34, s46
  s_lshr_b32 s46, s46, 1
  s_mul_i32 s36, s46, -8
  s_add_i32 s36, s36, 7
  s_add_i32 s34, s34, -1
  s_add_i32 s35, s34, s36
  s_mul_i32 s36, s36, 7680
  s_lshl_b32 s47, s26, 2
  s_mul_i32 s46, s34, 7680
  s_add_i32 s46, s46, 10240
  v_add_u32 v130, s47, v128
  v_bfe_u32 v131, v130, 1, 3
  v_xor_b32 v131, v131, v129
  v_mul_u32_u24 v130, 384, v130
  v_lshl_add_u32 v130, v131, 4, v130
  v_add_u32 v7, s46, v130
  v_xor_b32 v8, 64, v7
  v_lshrrev_b32 v130, 2, v128
  v_lshl_add_u32 v130, v129, 2, v130
  v_add_u32 v130, s47, v130
  v_bfe_u32 v131, v130, 1, 3
  v_and_b32 v132, 2, v128
  v_lshlrev_b32 v132, 1, v132
  v_xor_b32 v131, v131, v132
  v_mul_u32_u24 v130, 384, v130
  v_lshl_add_u32 v130, v131, 4, v130
  v_and_b32 v131, 1, v128
  v_lshl_add_u32 v130, v131, 3, v130
  v_add_u32 v9, s46, v130
  v_xor_b32 v10, 16, v9
  v_xor_b32 v11, 32, v9
  v_xor_b32 v12, 48, v9
  v_lshl_add_u32 v130, v129, 2, s47
  v_sub_u32 v19, v130, v19
  v_cndmask_b32 v19, v19, 64, s[44:45]
  v_add_u32 v20, s36, v7
  v_add_u32 v0, s36, v8
  v_add_u32 v15, s36, v9
  v_add_u32 v16, s36, v10
  v_add_u32 v17, s36, v11
  v_add_u32 v18, s36, v12
  s_mov_b32 s93, 1037384597
  s_cbranch_vccnz SL3
  s_add_i32 m0, s41, 49152
  s_add_i32 s100, s92, 128
  buffer_load_dwordx4 v96, s[88:91], s100 offen lds
  s_add_i32 m0, s41, 57344
  s_add_i32 s100, s92, 73856
  buffer_load_dwordx4 v96, s[88:91], s100 offen lds
  s_add_i32 m0, s41, 65536
  s_add_i32 s100, s92, 147584
  buffer_load_dwordx4 v96, s[88:91], s100 offen lds
  s_add_i32 m0, s41, 73728
  s_add_i32 s100, s92, 512
  buffer_load_dwordx4 v96, s[88:91], s100 offen lds
  s_add_i32 m0, s41, 81920
  s_add_i32 s100, s92, 74240
  buffer_load_dwordx4 v96, s[88:91], s100 offen lds
  s_add_i32 m0, s41, 90112
  s_add_i32 s100, s92, 147968
  buffer_load_dwordx4 v96, s[88:91], s100 offen lds
  s_add_i32 m0, s41, 45056
  s_add_i32 s100, s92, -36736
  buffer_load_dwordx4 v96, s[88:91], s100 offen lds
  s_add_i32 m0, s41, 53248
  s_add_i32 s100, s92, 36992
  buffer_load_dwordx4 v96, s[88:91], s100 offen lds
  s_add_i32 m0, s41, 61440
  s_add_i32 s100, s92, 110720
  buffer_load_dwordx4 v96, s[88:91], s100 offen lds
  s_add_i32 m0, s41, 69632
  s_add_i32 s100, s92, -36352
  buffer_load_dwordx4 v96, s[88:91], s100 offen lds
  s_add_i32 m0, s41, 77824
  s_add_i32 s100, s92, 37376
  buffer_load_dwordx4 v96, s[88:91], s100 offen lds
  s_add_i32 m0, s41, 86016
  s_add_i32 s100, s92, 111104
  buffer_load_dwordx4 v96, s[88:91], s100 offen lds
SL3:
  s_cbranch_vccz SL4
  s_waitcnt vmcnt(0)
  s_branch SM4
SL4:
  s_waitcnt vmcnt(12)
SM4:
  s_barrier
  ds_read_b128 v[208:211], v99 offset:0
  ds_read_b128 v[212:215], v99 offset:2048
  ds_read_b128 v[216:219], v99 offset:4096
  ds_read_b128 v[184:187], v97 offset:0
  ds_read_b128 v[188:191], v97 offset:2048
  ds_read_b128 v[192:195], v97 offset:4096
  ds_read_b128 v[196:199], v97 offset:6144
  ds_read_b128 v[200:203], v97 offset:8192
  ds_read_b128 v[204:207], v97 offset:10240
  s_waitcnt lgkmcnt(5)
  v_mfma_f32_16x16x32_bf16 v[24:27], v[184:187], v[208:211], 0
  s_cbranch_vccz SL5
  s_add_i32 m0, s41, 98304
  s_add_i32 s100, s92, 256
  buffer_load_dwordx4 v96, s[88:91], s100 offen lds
SL5:
  v_mfma_f32_16x16x32_bf16 v[28:31], v[184:187], v[212:215], 0
  s_cbranch_vccz SL6
  s_add_i32 m0, s41, 106496
  s_add_i32 s100, s92, 73984
  buffer_load_dwordx4 v96, s[88:91], s100 offen lds
SL6:
  v_mfma_f32_16x16x32_bf16 v[32:35], v[184:187], v[216:219], 0
  s_waitcnt lgkmcnt(4)
  v_mfma_f32_16x16x32_bf16 v[36:39], v[188:191], v[208:211], 0
  ds_read_b128 v[244:247], v100 offset:0
  s_cbranch_vccz SL7
  s_add_i32 m0, s41, 114688
  s_add_i32 s100, s92, 147712
  buffer_load_dwordx4 v96, s[88:91], s100 offen lds
SL7:
  v_mfma_f32_16x16x32_bf16 v[40:43], v[188:191], v[212:215], 0
  ds_read_b128 v[248:251], v100 offset:2048
  s_cbranch_vccz SL8
  s_add_i32 m0, s41, 122880
  s_add_i32 s100, s92, 640
  buffer_load_dwordx4 v96, s[88:91], s100 offen lds
SL8:
  v_mfma_f32_16x16x32_bf16 v[44:47], v[188:191], v[216:219], 0
  s_waitcnt lgkmcnt(5)
  v_mfma_f32_16x16x32_bf16 v[48:51], v[192:195], v[208:211], 0
  ds_read_b128 v[252:255], v100 offset:4096
  s_cbranch_vccz SL9
  s_add_i32 m0, s41, 131072
  s_add_i32 s100, s92, 74368
  buffer_load_dwordx4 v96, s[88:91], s100 offen lds
SL9:
  v_mfma_f32_16x16x32_bf16 v[52:55], v[192:195], v[212:215], 0
  ds_read_b128 v[220:223], v98 offset:0
  s_cbranch_vccz SL10
  s_add_i32 m0, s41, 139264
  s_add_i32 s100, s92, 148096
  buffer_load_dwordx4 v96, s[88:91], s100 offen lds
SL10:
  v_mfma_f32_16x16x32_bf16 v[56:59], v[192:195], v[216:219], 0
  s_waitcnt lgkmcnt(6)
  v_mfma_f32_16x16x32_bf16 v[60:63], v[196:199], v[208:211], 0
  ds_read_b128 v[224:227], v98 offset:2048
  s_cbranch_vccz SL11
  s_add_i32 m0, s41, 102400
  s_add_i32 s100, s92, 37120
  buffer_load_dwordx4 v96, s[88:91], s100 offen lds
SL11:
  v_mfma_f32_16x16x32_bf16 v[64:67], v[196:199], v[212:215], 0
  ds_read_b128 v[228:231], v98 offset:4096
  s_cbranch_vccz SL12
  s_add_i32 m0, s41, 110592
  s_add_i32 s100, s92, 110848
  buffer_load_dwordx4 v96, s[88:91], s100 offen lds
SL12:
  v_mfma_f32_16x16x32_bf16 v[68:71], v[196:199], v[216:219], 0
  s_waitcnt lgkmcnt(7)
  v_mfma_f32_16x16x32_bf16 v[72:75], v[200:203], v[208:211], 0
  ds_read_b128 v[232:235], v98 offset:6144
  s_cbranch_vccz SL13
  s_add_i32 m0, s41, 118784
  s_add_i32 s100, s92, 184576
  buffer_load_dwordx4 v96, s[88:91], s100 offen lds
SL13:
  v_mfma_f32_16x16x32_bf16 v[76:79], v[200:203], v[212:215], 0
  ds_read_b128 v[236:239], v98 offset:8192
  s_cbranch_vccz SL14
  s_add_i32 m0, s41, 126976
  s_add_i32 s100, s92, 37504
  buffer_load_dwordx4 v96, s[88:91], s100 offen lds
SL14:
  v_mfma_f32_16x16x32_bf16 v[80:83], v[200:203], v[216:219], 0
  s_waitcnt lgkmcnt(8)
  v_mfma_f32_16x16x32_bf16 v[84:87], v[204:207], v[208:211], 0
  ds_read_b128 v[240:243], v98 offset:10240
  s_cbranch_vccz SL15
  s_add_i32 m0, s41, 135168
  s_add_i32 s100, s92, 111232
  buffer_load_dwordx4 v96, s[88:91], s100 offen lds
SL15:
  v_mfma_f32_16x16x32_bf16 v[88:91], v[204:207], v[212:215], 0
  s_cbranch_vccz SL16
  s_add_i32 m0, s41, 143360
  s_add_i32 s100, s92, 184960
  buffer_load_dwordx4 v96, s[88:91], s100 offen lds
SL16:
  v_mfma_f32_16x16x32_bf16 v[92:95], v[204:207], v[216:219], 0
  v_lshrrev_b32 v107, 4, v1
  s_cmp_lt_u32 s2, 72
  s_cbranch_scc0 MK_np1
  s_mul_hi_u32 s54, s2, 0x15555556
  s_lshl_b32 s54, s54, 6
  s_mul_i32 s55, s24, 6144
  s_add_u32 s100, s54, s55
  v_lshrrev_b32 v104, 2, v107
  v_mul_u32_u24 v104, 384, v104
  v_and_b32 v105, 3, v107
  v_lshl_add_u32 v104, v105, 4, v104
  s_add_u32 m0, s41, 147456
  s_nop 0
  buffer_load_dwordx4 v104, s[4:7], s100 offen lds
  s_mul_i32 s55, s40, 6
  s_add_u32 s100, s54, s55
  s_add_u32 m0, s40, 155648
  s_add_u32 s100, s100, 49152
  buffer_load_dwordx4 v104, s[4:7], s100 offen lds
MK_np1:
  s_sub_u32 s3, s2, 72
  s_lshr_b32 s3, s3, 31
  s_lshr_b32 s3, s3, s25
  v_mov_b32 v134, 0
  s_cmp_eq_u32 s3, 0
  s_cbranch_scc1 MK_np3
  s_mul_hi_u32 s54, s2, 0x15555556
  s_mul_i32 s55, s54, 12
  s_sub_u32 s55, s2, s55
  s_and_b32 s51, s55, 1
  s_lshr_b32 s55, s55, 1
  v_lshrrev_b32 v106, 2, v128
  v_and_b32 v105, 3, v128
  v_lshl_add_u32 v134, v129, 3, v106
  v_lshlrev_b32 v134, 6, v134
  v_lshl_add_u32 v134, v105, 4, v134
  s_lshl_b32 s51, s51, 3
  s_add_u32 s51, s51, 147456
  v_add_u32 v134, s51, v134
  s_lshr_b32 s54, s55, 1
  s_lshl_b32 s54, s54, 6
  s_and_b32 s55, s55, 1
  s_lshl_b32 s55, s55, 4
  s_add_u32 s54, s54, s55
  v_lshrrev_b32 v104, 1, v106
  v_lshlrev_b32 v104, 5, v104
  v_and_b32 v106, 1, v106
  v_lshl_add_u32 v104, v106, 2, v104
  v_add3_u32 v104, v104, v105, s54
  v_mul_u32_u24 v104, 1152, v104
  v_lshl_add_u32 v135, v129, 4, v104
  s_mul_i32 s100, s26, 9216
  buffer_load_dwordx4 v[136:139], v135, s[88:91], s100 offen offset:768
  buffer_load_dwordx4 v[140:143], v135, s[88:91], s100 offen offset:832
  buffer_load_dwordx4 v[144:147], v135, s[88:91], s100 offen offset:896
  buffer_load_dwordx4 v[148:151], v135, s[88:91], s100 offen offset:960
  buffer_load_dwordx4 v[152:155], v135, s[88:91], s100 offen offset:1024
  buffer_load_dwordx4 v[156:159], v135, s[88:91], s100 offen offset:1088
MK_np3:
  s_cbranch_vccz SL18
  s_waitcnt vmcnt(63) lgkmcnt(0)
  s_branch SM18
SL18:
  s_cmp_lg_u32 s3, 0
  s_cbranch_scc1 CA17
  s_cmp_lt_u32 s2, 72
  s_cbranch_scc1 CB17
  s_waitcnt vmcnt(0)
CB17:
  s_waitcnt vmcnt(2)
CA17:
  s_waitcnt vmcnt(8) lgkmcnt(0)
SM18:
  s_barrier
  v_add_u32 v97, 49152, v97
  v_add_u32 v98, 49152, v98
  v_add_u32 v99, 49152, v99
  v_add_u32 v100, 49152, v100
  v_mfma_f32_16x16x32_bf16 v[24:27], v[220:223], v[244:247], v[24:27]
  ds_read_b128 v[208:211], v99 offset:0
  s_cbranch_vccnz SL19
  buffer_load_dwordx4 v[160:163], v6, s[12:15], 0 offen offset:0
SL19:
  v_mfma_f32_16x16x32_bf16 v[28:31], v[220:223], v[248:251], v[28:31]
  ds_read_b128 v[212:215], v99 offset:2048
  v_mfma_f32_16x16x32_bf16 v[32:35], v[220:223], v[252:255], v[32:35]
  v_mfma_f32_16x16x32_bf16 v[36:39], v[224:227], v[244:247], v[36:39]
  ds_read_b128 v[216:219], v99 offset:4096
  s_cbranch_vccnz SL20
  buffer_load_dwordx4 v[164:167], v6, s[12:15], 0 offen offset:64
SL20:
  v_mfma_f32_16x16x32_bf16 v[40:43], v[224:227], v[248:251], v[40:43]
  ds_read_b128 v[184:187], v97 offset:0
  v_mfma_f32_16x16x32_bf16 v[44:47], v[224:227], v[252:255], v[44:47]
  v_mfma_f32_16x16x32_bf16 v[48:51], v[228:231], v[244:247], v[48:51]
  ds_read_b128 v[188:191], v97 offset:2048
  s_cbranch_vccnz SL21
  buffer_load_dwordx4 v[168:171], v6, s[12:15], 0 offen offset:128
SL21:
  v_mfma_f32_16x16x32_bf16 v[52:55], v[228:231], v[248:251], v[52:55]
  ds_read_b128 v[192:195], v97 offset:4096
  v_mfma_f32_16x16x32_bf16 v[56:59], v[228:231], v[252:255], v[56:59]
  v_mfma_f32_16x16x32_bf16 v[60:63], v[232:235], v[244:247], v[60:63]
  ds_read_b128 v[196:199], v97 offset:6144
  s_cbranch_vccnz SL22
  buffer_load_dwordx4 v[172:175], v6, s[12:15], 0 offen offset:192
SL22:
  v_mfma_f32_16x16x32_bf16 v[64:67], v[232:235], v[248:251], v[64:67]
  ds_read_b128 v[200:203], v97 offset:8192
  v_mfma_f32_16x16x32_bf16 v[68:71], v[232:235], v[252:255], v[68:71]
  v_mfma_f32_16x16x32_bf16 v[72:75], v[236:239], v[244:247], v[72:75]
  ds_read_b128 v[204:207], v97 offset:10240
  s_cbranch_vccnz SL23
  buffer_load_dwordx4 v[176:179], v6, s[12:15], 0 offen offset:256
SL23:
  v_mfma_f32_16x16x32_bf16 v[76:79], v[236:239], v[248:251], v[76:79]
  v_mfma_f32_16x16x32_bf16 v[80:83], v[236:239], v[252:255], v[80:83]
  v_mfma_f32_16x16x32_bf16 v[84:87], v[240:243], v[244:247], v[84:87]
  s_cbranch_vccnz SL24
  buffer_load_dwordx4 v[180:183], v6, s[12:15], 0 offen offset:320
SL24:
  v_mfma_f32_16x16x32_bf16 v[88:91], v[240:243], v[248:251], v[88:91]
  v_mfma_f32_16x16x32_bf16 v[92:95], v[240:243], v[252:255], v[92:95]
  s_waitcnt lgkmcnt(5)
  v_mfma_f32_16x16x32_bf16 v[24:27], v[184:187], v[208:211], v[24:27]
  s_cbranch_vccnz SL25
  s_cmp_eq_u32 s25, 0
  s_cbranch_scc1 QB6
  buffer_load_dwordx4 v[136:139], v5, s[12:15], 0 offen offset:0
QB6:
SL25:
  v_mfma_f32_16x16x32_bf16 v[28:31], v[184:187], v[212:215], v[28:31]
  v_mfma_f32_16x16x32_bf16 v[32:35], v[184:187], v[216:219], v[32:35]
  s_waitcnt lgkmcnt(4)
  v_mfma_f32_16x16x32_bf16 v[36:39], v[188:191], v[208:211], v[36:39]
  ds_read_b128 v[244:247], v100 offset:0
  s_cbranch_vccnz SL26
  s_cmp_eq_u32 s25, 0
  s_cbranch_scc1 QB7
  buffer_load_dwordx4 v[140:143], v5, s[12:15], 0 offen offset:64
QB7:
SL26:
  v_mfma_f32_16x16x32_bf16 v[40:43], v[188:191], v[212:215], v[40:43]
  ds_read_b128 v[248:251], v100 offset:2048
  v_mfma_f32_16x16x32_bf16 v[44:47], v[188:191], v[216:219], v[44:47]
  s_waitcnt lgkmcnt(5)
  v_mfma_f32_16x16x32_bf16 v[48:51], v[192:195], v[208:211], v[48:51]
  ds_read_b128 v[252:255], v100 offset:4096
  s_cbranch_vccnz SL27
  s_cmp_eq_u32 s25, 0
  s_cbranch_scc1 QB8
  buffer_load_dwordx4 v[144:147], v5, s[12:15], 0 offen offset:128
QB8:
SL27:
  v_mfma_f32_16x16x32_bf16 v[52:55], v[192:195], v[212:215], v[52:55]
  ds_read_b128 v[220:223], v98 offset:0
  v_mfma_f32_16x16x32_bf16 v[56:59], v[192:195], v[216:219], v[56:59]
  s_waitcnt lgkmcnt(6)
  v_mfma_f32_16x16x32_bf16 v[60:63], v[196:199], v[208:211], v[60:63]
  ds_read_b128 v[224:227], v98 offset:2048
  s_cbranch_vccnz SL28
  s_cmp_eq_u32 s25, 0
  s_cbranch_scc1 QB9
  buffer_load_dwordx4 v[148:151], v5, s[12:15], 0 offen offset:192
QB9:
SL28:
  v_mfma_f32_16x16x32_bf16 v[64:67], v[196:199], v[212:215], v[64:67]
  ds_read_b128 v[228:231], v98 offset:4096
  v_mfma_f32_16x16x32_bf16 v[68:71], v[196:199], v[216:219], v[68:71]
  s_waitcnt lgkmcnt(7)
  v_mfma_f32_16x16x32_bf16 v[72:75], v[200:203], v[208:211], v[72:75]
  ds_read_b128 v[232:235], v98 offset:6144
  s_cbranch_vccnz SL29
  s_cmp_eq_u32 s25, 0
  s_cbranch_scc1 QB10
  buffer_load_dwordx4 v[152:155], v5, s[12:15], 0 offen offset:256
QB10:
SL29:
  v_mfma_f32_16x16x32_bf16 v[76:79], v[200:203], v[212:215], v[76:79]
  ds_read_b128 v[236:239], v98 offset:8192
  v_mfma_f32_16x16x32_bf16 v[80:83], v[200:203], v[216:219], v[80:83]
  s_waitcnt lgkmcnt(8)
  v_mfma_f32_16x16x32_bf16 v[84:87], v[204:207], v[208:211], v[84:87]
  ds_read_b128 v[240:243], v98 offset:10240
  s_cbranch_vccnz SL30
  s_cmp_eq_u32 s25, 0
  s_cbranch_scc1 QB11
  buffer_load_dwordx4 v[156:159], v5, s[12:15], 0 offen offset:320
QB11:
SL30:
  v_mfma_f32_16x16x32_bf16 v[88:91], v[204:207], v[212:215], v[88:91]
  v_mfma_f32_16x16x32_bf16 v[92:95], v[204:207], v[216:219], v[92:95]
  s_cbranch_vccz SL31
  s_waitcnt vmcnt(0) lgkmcnt(0)
  s_branch SM31
SL31:
  s_cmp_lg_u32 s25, 0
  s_cbranch_scc1 MK_c2
  s_waitcnt vmcnt(6)
MK_c2:
  s_waitcnt vmcnt(12) lgkmcnt(0)
SM31:
  s_barrier
  v_add_u32 v97, 49152, v97
  v_add_u32 v98, 49152, v98
  v_add_u32 v99, 49152, v99
  v_add_u32 v100, 49152, v100
  v_mfma_f32_16x16x32_bf16 v[24:27], v[220:223], v[244:247], v[24:27]
  ds_read_b128 v[208:211], v99 offset:0
  s_cbranch_vccz SL32
  buffer_load_dwordx4 v[160:163], v6, s[12:15], 0 offen offset:0
SL32:
  v_mfma_f32_16x16x32_bf16 v[28:31], v[220:223], v[248:251], v[28:31]
  ds_read_b128 v[212:215], v99 offset:2048
  v_mfma_f32_16x16x32_bf16 v[32:35], v[220:223], v[252:255], v[32:35]
  v_mfma_f32_16x16x32_bf16 v[36:39], v[224:227], v[244:247], v[36:39]
  ds_read_b128 v[216:219], v99 offset:4096
  v_mfma_f32_16x16x32_bf16 v[40:43], v[224:227], v[248:251], v[40:43]
  ds_read_b128 v[184:187], v97 offset:0
  s_cbranch_vccz SL33
  buffer_load_dwordx4 v[164:167], v6, s[12:15], 0 offen offset:64
SL33:
  v_mfma_f32_16x16x32_bf16 v[44:47], v[224:227], v[252:255], v[44:47]
  v_mfma_f32_16x16x32_bf16 v[48:51], v[228:231], v[244:247], v[48:51]
  ds_read_b128 v[188:191], v97 offset:2048
  v_mfma_f32_16x16x32_bf16 v[52:55], v[228:231], v[248:251], v[52:55]
  ds_read_b128 v[192:195], v97 offset:4096
  v_mfma_f32_16x16x32_bf16 v[56:59], v[228:231], v[252:255], v[56:59]
  v_mfma_f32_16x16x32_bf16 v[60:63], v[232:235], v[244:247], v[60:63]
  ds_read_b128 v[196:199], v97 offset:6144
  s_cbranch_vccz SL34
  buffer_load_dwordx4 v[168:171], v6, s[12:15], 0 offen offset:128
SL34:
  v_mfma_f32_16x16x32_bf16 v[64:67], v[232:235], v[248:251], v[64:67]
  ds_read_b128 v[200:203], v97 offset:8192
  v_mfma_f32_16x16x32_bf16 v[68:71], v[232:235], v[252:255], v[68:71]
  v_mfma_f32_16x16x32_bf16 v[72:75], v[236:239], v[244:247], v[72:75]
  ds_read_b128 v[204:207], v97 offset:10240
  v_mfma_f32_16x16x32_bf16 v[76:79], v[236:239], v[248:251], v[76:79]
  s_cbranch_vccz SL35
  buffer_load_dwordx4 v[172:175], v6, s[12:15], 0 offen offset:192
SL35:
  v_mfma_f32_16x16x32_bf16 v[80:83], v[236:239], v[252:255], v[80:83]
  v_mfma_f32_16x16x32_bf16 v[84:87], v[240:243], v[244:247], v[84:87]
  v_mfma_f32_16x16x32_bf16 v[88:91], v[240:243], v[248:251], v[88:91]
  v_mfma_f32_16x16x32_bf16 v[92:95], v[240:243], v[252:255], v[92:95]
  s_cmp_eq_u32 s3, 0
  s_cbranch_scc1 MK_np2
  s_waitcnt lgkmcnt(0)
  ds_read_b64_tr_b16 v[104:105], v134 offset:0
  ds_read_b64_tr_b16 v[106:107], v134 offset:256
  ds_read_b64_tr_b16 v[108:109], v134 offset:2048
  ds_read_b64_tr_b16 v[110:111], v134 offset:2304
  ds_read_b64_tr_b16 v[112:113], v134 offset:4096
  ds_read_b64_tr_b16 v[114:115], v134 offset:4352
  ds_read_b64_tr_b16 v[116:117], v134 offset:6144
  ds_read_b64_tr_b16 v[118:119], v134 offset:6400
  ds_read_b64_tr_b16 v[120:121], v134 offset:8192
  ds_read_b64_tr_b16 v[122:123], v134 offset:8448
  ds_read_b64_tr_b16 v[124:125], v134 offset:10240
  ds_read_b64_tr_b16 v[126:127], v134 offset:10496
  s_setprio 3
  s_waitcnt lgkmcnt(0)
  v_mfma_f32_16x16x32_bf16 v[128:131], v[136:139], v[104:107], 0
  v_mfma_f32_16x16x32_bf16 v[128:131], v[140:143], v[108:111], v[128:131]
  v_mfma_f32_16x16x32_bf16 v[128:131], v[144:147], v[112:115], v[128:131]
  v_mfma_f32_16x16x32_bf16 v[128:131], v[148:151], v[116:119], v[128:131]
  v_mfma_f32_16x16x32_bf16 v[128:131], v[152:155], v[120:123], v[128:131]
  v_mfma_f32_16x16x32_bf16 v[128:131], v[156:159], v[124:127], v[128:131]
  s_lshl_b32 s100, s2, 10
  s_lshl_b32 s54, s26, 3
  s_add_u32 s100, s100, s54
  s_nop 5
  v_cvt_pk_bf16_f32 v132, v128, v129
  v_cvt_pk_bf16_f32 v133, v130, v131
  buffer_store_dwordx2 v[132:133], v1, s[20:23], s100 offen sc1
  s_setprio 0
MK_np2:
  ds_read_b128 v[244:247], v100 offset:0
  ds_read_b128 v[248:251], v100 offset:2048
  ds_read_b128 v[252:255], v100 offset:4096
  ds_read_b128 v[220:223], v98 offset:0
  ds_read_b128 v[224:227], v98 offset:2048
  s_waitcnt lgkmcnt(5)
  v_mfma_f32_16x16x32_bf16 v[24:27], v[184:187], v[208:211], v[24:27]
  ds_read_b128 v[228:231], v98 offset:4096
  s_cbranch_vccz SL36
  buffer_load_dwordx4 v[176:179], v6, s[12:15], 0 offen offset:256
SL36:
  v_mfma_f32_16x16x32_bf16 v[36:39], v[188:191], v[208:211], v[36:39]
  ds_read_b128 v[232:235], v98 offset:6144
  s_waitcnt lgkmcnt(2)
  v_mfma_f32_16x16x32_bf16 v[24:27], v[220:223], v[244:247], v[24:27]
  ds_read_b128 v[236:239], v98 offset:8192
  v_mfma_f32_16x16x32_bf16 v[36:39], v[224:227], v[244:247], v[36:39]
  ds_read_b128 v[240:243], v98 offset:10240
  v_mfma_f32_16x16x32_bf16 v[28:31], v[184:187], v[212:215], v[28:31]
  s_cbranch_vccz SL37
  buffer_load_dwordx4 v[180:183], v6, s[12:15], 0 offen offset:320
SL37:
  v_mfma_f32_16x16x32_bf16 v[40:43], v[188:191], v[212:215], v[40:43]
  v_mfma_f32_16x16x32_bf16 v[28:31], v[220:223], v[248:251], v[28:31]
  v_mfma_f32_16x16x32_bf16 v[40:43], v[224:227], v[248:251], v[40:43]
  v_mfma_f32_16x16x32_bf16 v[32:35], v[184:187], v[216:219], v[32:35]
  v_cvt_pk_bf16_f32 v104, v24, v25
  v_cvt_pk_bf16_f32 v105, v26, v27
  v_mfma_f32_16x16x32_bf16 v[44:47], v[188:191], v[216:219], v[44:47]
  v_cvt_pk_bf16_f32 v106, v36, v37
  v_cvt_pk_bf16_f32 v107, v38, v39
  s_cbranch_vccz SL38
  buffer_load_dwordx4 v[136:139], v5, s[12:15], 0 offen offset:0
SL38:
  v_mfma_f32_16x16x32_bf16 v[32:35], v[220:223], v[252:255], v[32:35]
  ds_write_b128 v101, v[104:107] offset:4096
  v_mfma_f32_16x16x32_bf16 v[44:47], v[224:227], v[252:255], v[44:47]
  v_mfma_f32_16x16x32_bf16 v[48:51], v[192:195], v[208:211], v[48:51]
  v_cvt_pk_bf16_f32 v108, v28, v29
  v_cvt_pk_bf16_f32 v109, v30, v31
  v_mfma_f32_16x16x32_bf16 v[60:63], v[196:199], v[208:211], v[60:63]
  v_cvt_pk_bf16_f32 v110, v40, v41
  v_cvt_pk_bf16_f32 v111, v42, v43
  s_cbranch_vccz SL39
  buffer_load_dwordx4 v[140:143], v5, s[12:15], 0 offen offset:64
SL39:
  s_waitcnt lgkmcnt(1)
  v_mfma_f32_16x16x32_bf16 v[48:51], v[228:231], v[244:247], v[48:51]
  ds_write_b128 v102, v[108:111] offset:4096
  v_mfma_f32_16x16x32_bf16 v[60:63], v[232:235], v[244:247], v[60:63]
  v_mfma_f32_16x16x32_bf16 v[52:55], v[192:195], v[212:215], v[52:55]
  v_cvt_pk_bf16_f32 v112, v32, v33
  v_cvt_pk_bf16_f32 v113, v34, v35
  v_mfma_f32_16x16x32_bf16 v[64:67], v[196:199], v[212:215], v[64:67]
  v_cvt_pk_bf16_f32 v114, v44, v45
  v_cvt_pk_bf16_f32 v115, v46, v47
  v_mfma_f32_16x16x32_bf16 v[52:55], v[228:231], v[248:251], v[52:55]
  ds_write_b128 v103, v[112:115] offset:4096
  s_cbranch_vccz SL40
  buffer_load_dwordx4 v[144:147], v5, s[12:15], 0 offen offset:128
SL40:
  v_mfma_f32_16x16x32_bf16 v[64:67], v[232:235], v[248:251], v[64:67]
  v_mfma_f32_16x16x32_bf16 v[56:59], v[192:195], v[216:219], v[56:59]
  v_cvt_pk_bf16_f32 v116, v48, v49
  v_cvt_pk_bf16_f32 v117, v50, v51
  v_mfma_f32_16x16x32_bf16 v[68:71], v[196:199], v[216:219], v[68:71]
  v_cvt_pk_bf16_f32 v118, v60, v61
  v_cvt_pk_bf16_f32 v119, v62, v63
  v_mfma_f32_16x16x32_bf16 v[56:59], v[228:231], v[252:255], v[56:59]
  ds_write_b128 v101, v[116:119] offset:2048
  s_cbranch_vccz SL41
  buffer_load_dwordx4 v[148:151], v5, s[12:15], 0 offen offset:192
SL41:
  v_mfma_f32_16x16x32_bf16 v[68:71], v[232:235], v[252:255], v[68:71]
  v_mfma_f32_16x16x32_bf16 v[72:75], v[200:203], v[208:211], v[72:75]
  v_cvt_pk_bf16_f32 v120, v52, v53
  v_cvt_pk_bf16_f32 v121, v54, v55
  v_mfma_f32_16x16x32_bf16 v[84:87], v[204:207], v[208:211], v[84:87]
  v_cvt_pk_bf16_f32 v122, v64, v65
  v_cvt_pk_bf16_f32 v123, v66, v67
  v_mfma_f32_16x16x32_bf16 v[72:75], v[236:239], v[244:247], v[72:75]
  ds_write_b128 v102, v[120:123] offset:2048
  v_mfma_f32_16x16x32_bf16 v[84:87], v[240:243], v[244:247], v[84:87]
  s_cbranch_vccz SL42
  buffer_load_dwordx4 v[152:155], v5, s[12:15], 0 offen offset:256
SL42:
  v_mfma_f32_16x16x32_bf16 v[76:79], v[200:203], v[212:215], v[76:79]
  v_cvt_pk_bf16_f32 v124, v56, v57
  v_cvt_pk_bf16_f32 v125, v58, v59
  v_mfma_f32_16x16x32_bf16 v[88:91], v[204:207], v[212:215], v[88:91]
  v_cvt_pk_bf16_f32 v126, v68, v69
  v_cvt_pk_bf16_f32 v127, v70, v71
  v_mfma_f32_16x16x32_bf16 v[76:79], v[236:239], v[248:251], v[76:79]
  ds_write_b128 v103, v[124:127] offset:2048
  v_mfma_f32_16x16x32_bf16 v[88:91], v[240:243], v[248:251], v[88:91]
  s_cbranch_vccz SL43
  buffer_load_dwordx4 v[156:159], v5, s[12:15], 0 offen offset:320
SL43:
  v_mfma_f32_16x16x32_bf16 v[80:83], v[200:203], v[216:219], v[80:83]
  v_cvt_pk_bf16_f32 v104, v72, v73
  v_cvt_pk_bf16_f32 v105, v74, v75
  v_mfma_f32_16x16x32_bf16 v[92:95], v[204:207], v[216:219], v[92:95]
  v_cvt_pk_bf16_f32 v106, v84, v85
  v_cvt_pk_bf16_f32 v107, v86, v87
  v_mfma_f32_16x16x32_bf16 v[80:83], v[236:239], v[252:255], v[80:83]
  ds_write_b128 v101, v[104:107] offset:0
  v_mfma_f32_16x16x32_bf16 v[92:95], v[240:243], v[252:255], v[92:95]
  v_cvt_pk_bf16_f32 v108, v76, v77
  v_cvt_pk_bf16_f32 v109, v78, v79
  v_cvt_pk_bf16_f32 v110, v88, v89
  v_cvt_pk_bf16_f32 v111, v90, v91
  ds_write_b128 v102, v[108:111] offset:0
  s_nop 3
  v_cvt_pk_bf16_f32 v112, v80, v81
  v_cvt_pk_bf16_f32 v113, v82, v83
  v_cvt_pk_bf16_f32 v114, v92, v93
  v_cvt_pk_bf16_f32 v115, v94, v95
  ds_write_b128 v103, v[112:115] offset:0
  s_waitcnt lgkmcnt(0)
  s_barrier
  ds_read_b128 v[216:219], v2 offset:35840
  ds_read_b128 v[220:223], v2 offset:34816
  ds_read_b128 v[224:227], v2 offset:33792
  ds_read_b128 v[228:231], v2 offset:32768
  ds_read_b128 v[232:235], v2 offset:31744
  ds_read_b128 v[236:239], v2 offset:30720
  ds_read_b128 v[240:243], v2 offset:29696
  ds_read_b128 v[244:247], v2 offset:28672
  ds_read_b128 v[248:251], v2 offset:27648
  ds_read_b128 v[252:255], v2 offset:26624
  s_cbranch_vccz SL44
  s_mul_i32 s100, s32, 9
  s_add_i32 s100, s100, s31
  s_add_u32 m0, s38, 138240
  s_nop 0
  buffer_load_dwordx4 v13, s[12:15], s100 offen lds
  s_add_u32 m0, s38, 139264
  s_nop 0
  buffer_load_dwordx4 v14, s[12:15], s100 offen lds
  s_add_u32 m0, s38, 140288
  s_nop 0
  buffer_load_dwordx4 v3, s[12:15], s100 offen lds
  s_add_u32 m0, s39, 138240
  s_nop 0
  buffer_load_dwordx4 v4, s[12:15], s100 offen lds
  s_mul_i32 s100, s32, 8
  s_add_i32 s100, s100, s31
  s_add_u32 m0, s38, 122880
  s_nop 0
  buffer_load_dwordx4 v13, s[12:15], s100 offen lds
  s_add_u32 m0, s38, 123904
  s_nop 0
  buffer_load_dwordx4 v14, s[12:15], s100 offen lds
  s_add_u32 m0, s38, 124928
  s_nop 0
  buffer_load_dwordx4 v3, s[12:15], s100 offen lds
  s_add_u32 m0, s39, 122880
  s_nop 0
  buffer_load_dwordx4 v4, s[12:15], s100 offen lds
  s_waitcnt vmcnt(8)
  s_branch SM44
SL44:
  s_cmp_lg_u32 s25, 0
  s_cbranch_scc1 MK_z1
  v_mov_b32 v136, 0
  v_mov_b32 v137, 0
  v_mov_b32 v138, 0
  v_mov_b32 v139, 0
  v_mov_b32 v140, 0
  v_mov_b32 v141, 0
  v_mov_b32 v142, 0
  v_mov_b32 v143, 0
  v_mov_b32 v144, 0
  v_mov_b32 v145, 0
  v_mov_b32 v146, 0
  v_mov_b32 v147, 0
  v_mov_b32 v148, 0
  v_mov_b32 v149, 0
  v_mov_b32 v150, 0
  v_mov_b32 v151, 0
  v_mov_b32 v152, 0
  v_mov_b32 v153, 0
  v_mov_b32 v154, 0
  v_mov_b32 v155, 0
  v_mov_b32 v156, 0
  v_mov_b32 v157, 0
  v_mov_b32 v158, 0
  v_mov_b32 v159, 0
MK_z1:
  s_cmp_lg_u32 s3, 0
  s_cbranch_scc1 MK_np4
  s_waitcnt vmcnt(0)
MK_np4:
  s_waitcnt vmcnt(1)
  s_setprio 1
SM44:
  s_waitcnt lgkmcnt(8)
  v_mfma_f32_16x16x32_bf16 v[184:187], v[216:219], v[136:139], 0
  v_mov_b32 v64, 0xff800000
  v_add_u32 v65, 0, v19
  v_mfma_f32_16x16x32_bf16 v[192:195], v[216:219], v[160:163], 0
  ds_read_b128 v[216:219], v2 offset:25600
  v_add_u32 v66, 1, v19
  v_mfma_f32_16x16x32_bf16 v[188:191], v[220:223], v[136:139], 0
  v_add_u32 v67, 2, v19
  v_add_u32 v68, 3, v19
  v_mfma_f32_16x16x32_bf16 v[196:199], v[220:223], v[160:163], 0
  ds_read_b128 v[220:223], v2 offset:24576
  s_waitcnt lgkmcnt(8)
  v_mfma_f32_16x16x32_bf16 v[184:187], v[224:227], v[140:143], v[184:187]
  v_cmp_gt_u32 s[48:49], 7, v65
  v_cmp_gt_u32 s[50:51], 7, v66
  v_mfma_f32_16x16x32_bf16 v[192:195], v[224:227], v[164:167], v[192:195]
  ds_read_b128 v[224:227], v2 offset:23552
  v_cmp_gt_u32 s[52:53], 7, v67
  v_mfma_f32_16x16x32_bf16 v[188:191], v[228:231], v[140:143], v[188:191]
  v_cmp_gt_u32 s[54:55], 7, v68
  v_sub_u32 v69, s35, v21
  v_mfma_f32_16x16x32_bf16 v[196:199], v[228:231], v[164:167], v[196:199]
  ds_read_b128 v[228:231], v2 offset:22528
  s_waitcnt lgkmcnt(8)
  v_mfma_f32_16x16x32_bf16 v[184:187], v[232:235], v[144:147], v[184:187]
  s_add_i32 s46, s34, 0
  v_sub_u32 v70, s46, v21
  v_mfma_f32_16x16x32_bf16 v[192:195], v[232:235], v[168:171], v[192:195]
  ds_read_b128 v[232:235], v2 offset:21504
  s_add_i32 s46, s34, 6
  v_mfma_f32_16x16x32_bf16 v[188:191], v[236:239], v[144:147], v[188:191]
  v_sub_u32 v71, s46, v21
  s_add_i32 s46, s34, 1
  v_mfma_f32_16x16x32_bf16 v[196:199], v[236:239], v[168:171], v[196:199]
  ds_read_b128 v[236:239], v2 offset:20480
  s_waitcnt lgkmcnt(8)
  v_mfma_f32_16x16x32_bf16 v[184:187], v[240:243], v[148:151], v[184:187]
  v_sub_u32 v72, s46, v22
  s_add_i32 s46, s34, 8
  v_mfma_f32_16x16x32_bf16 v[192:195], v[240:243], v[172:175], v[192:195]
  ds_read_b128 v[240:243], v2 offset:19456
  v_sub_u32 v73, s46, v22
  v_mfma_f32_16x16x32_bf16 v[188:191], v[244:247], v[148:151], v[188:191]
  v_cndmask_b32 v32, v64, 0, s[48:49]
  v_cndmask_b32 v33, v64, 0, s[50:51]
  v_mfma_f32_16x16x32_bf16 v[196:199], v[244:247], v[172:175], v[196:199]
  ds_read_b128 v[244:247], v2 offset:18432
  s_waitcnt lgkmcnt(8)
  v_mfma_f32_16x16x32_bf16 v[184:187], v[248:251], v[152:155], v[184:187]
  v_cndmask_b32 v34, v64, 0, s[52:53]
  v_cndmask_b32 v35, v64, 0, s[54:55]
  v_mfma_f32_16x16x32_bf16 v[192:195], v[248:251], v[176:179], v[192:195]
  ds_read_b128 v[248:251], v2 offset:17408
  v_cmp_gt_u32 s[46:47], 7, v69
  v_mfma_f32_16x16x32_bf16 v[188:191], v[252:255], v[152:155], v[188:191]
  v_cmp_gt_u32 s[48:49], 7, v70
  v_cmp_gt_u32 s[50:51], 7, v71
  v_mfma_f32_16x16x32_bf16 v[196:199], v[252:255], v[176:179], v[196:199]
  ds_read_b128 v[252:255], v2 offset:16384
  s_waitcnt lgkmcnt(8)
  v_mfma_f32_16x16x32_bf16 v[184:187], v[216:219], v[156:159], v[184:187]
  v_cmp_gt_u32 s[52:53], 7, v72
  v_cmp_gt_u32 s[54:55], 7, v73
  v_mfma_f32_16x16x32_bf16 v[192:195], v[216:219], v[180:183], v[192:195]
  ds_read_b128 v[216:219], v2 offset:15360
  v_cndmask_b32 v24, v64, v32, s[46:47]
  v_mfma_f32_16x16x32_bf16 v[188:191], v[220:223], v[156:159], v[188:191]
  v_cndmask_b32 v25, v64, v33, s[46:47]
  v_cndmask_b32 v26, v64, v34, s[46:47]
  v_mfma_f32_16x16x32_bf16 v[196:199], v[220:223], v[180:183], v[196:199]
  ds_read_b128 v[220:223], v2 offset:14336
  s_waitcnt lgkmcnt(8)
  v_mfma_f32_16x16x32_bf16 v[200:203], v[224:227], v[136:139], 0
  v_mul_f32 v192, s93, v192
  v_mul_f32 v193, s93, v193
  v_mfma_f32_16x16x32_bf16 v[208:211], v[224:227], v[160:163], 0
  ds_read_b128 v[224:227], v2 offset:13312
  v_mul_f32 v194, s93, v194
  v_mfma_f32_16x16x32_bf16 v[204:207], v[228:231], v[136:139], 0
  v_mul_f32 v195, s93, v195
  v_mul_f32 v196, s93, v196
  v_mfma_f32_16x16x32_bf16 v[212:215], v[228:231], v[160:163], 0
  ds_read_b128 v[228:231], v2 offset:12288
  s_waitcnt lgkmcnt(8)
  v_mfma_f32_16x16x32_bf16 v[200:203], v[232:235], v[140:143], v[200:203]
  v_mul_f32 v197, s93, v197
  v_mul_f32 v198, s93, v198
  v_mfma_f32_16x16x32_bf16 v[208:211], v[232:235], v[164:167], v[208:211]
  ds_read_b128 v[232:235], v2 offset:11264
  v_mul_f32 v199, s93, v199
  v_mfma_f32_16x16x32_bf16 v[204:207], v[236:239], v[140:143], v[204:207]
  v_cvt_pk_bf16_f32 v112, v192, v193
  v_cvt_pk_bf16_f32 v113, v194, v195
  v_mfma_f32_16x16x32_bf16 v[212:215], v[236:239], v[164:167], v[212:215]
  ds_read_b128 v[236:239], v2 offset:10240
  s_waitcnt lgkmcnt(8)
  v_mfma_f32_16x16x32_bf16 v[200:203], v[240:243], v[144:147], v[200:203]
  v_cvt_pk_bf16_f32 v114, v196, v197
  v_cvt_pk_bf16_f32 v115, v198, v199
  v_mfma_f32_16x16x32_bf16 v[208:211], v[240:243], v[168:171], v[208:211]
  ds_read_b128 v[240:243], v2 offset:9216
  v_mul_f32 v184, s93, v184
  v_mfma_f32_16x16x32_bf16 v[204:207], v[244:247], v[144:147], v[204:207]
  v_mul_f32 v185, s93, v185
  v_mul_f32 v186, s93, v186
  v_mfma_f32_16x16x32_bf16 v[212:215], v[244:247], v[168:171], v[212:215]
  ds_read_b128 v[244:247], v2 offset:8192
  s_waitcnt lgkmcnt(8)
  v_mfma_f32_16x16x32_bf16 v[200:203], v[248:251], v[148:151], v[200:203]
  v_mul_f32 v187, s93, v187
  v_mul_f32 v188, s93, v188
  v_mfma_f32_16x16x32_bf16 v[208:211], v[248:251], v[172:175], v[208:211]
  ds_read_b128 v[248:251], v2 offset:7168
  v_mul_f32 v189, s93, v189
  v_mfma_f32_16x16x32_bf16 v[204:207], v[252:255], v[148:151], v[204:207]
  v_mul_f32 v190, s93, v190
  v_mul_f32 v191, s93, v191
  v_mfma_f32_16x16x32_bf16 v[212:215], v[252:255], v[172:175], v[212:215]
  ds_read_b128 v[252:255], v2 offset:6144
  s_waitcnt lgkmcnt(8)
  v_mfma_f32_16x16x32_bf16 v[200:203], v[216:219], v[152:155], v[200:203]
  v_cvt_pk_bf16_f32 v88, v184, v185
  v_cvt_pk_bf16_f32 v89, v186, v187
  v_mfma_f32_16x16x32_bf16 v[208:211], v[216:219], v[176:179], v[208:211]
  ds_read_b128 v[216:219], v2 offset:5120
  v_cvt_pk_bf16_f32 v90, v188, v189
  v_mfma_f32_16x16x32_bf16 v[204:207], v[220:223], v[152:155], v[204:207]
  v_cvt_pk_bf16_f32 v91, v190, v191
  v_cndmask_b32 v27, v64, v35, s[46:47]
  v_mfma_f32_16x16x32_bf16 v[212:215], v[220:223], v[176:179], v[212:215]
  ds_read_b128 v[220:223], v2 offset:4096
  s_waitcnt lgkmcnt(8)
  v_mfma_f32_16x16x32_bf16 v[200:203], v[224:227], v[156:159], v[200:203]
  v_cndmask_b32 v28, v64, v32, s[48:49]
  v_cndmask_b32 v29, v64, v33, s[48:49]
  v_mfma_f32_16x16x32_bf16 v[208:211], v[224:227], v[180:183], v[208:211]
  ds_read_b128 v[224:227], v2 offset:3072
  v_cndmask_b32 v30, v64, v34, s[48:49]
  v_mfma_f32_16x16x32_bf16 v[204:207], v[228:231], v[156:159], v[204:207]
  v_cndmask_b32 v31, v64, v35, s[48:49]
  v_mfma_f32_16x16x32_bf16 v[212:215], v[228:231], v[180:183], v[212:215]
  ds_read_b128 v[228:231], v2 offset:2048
  s_waitcnt lgkmcnt(8)
  v_mfma_f32_16x16x32_bf16 v[184:187], v[232:235], v[136:139], 0
  v_mul_f32 v208, s93, v208
  v_mul_f32 v209, s93, v209
  v_mfma_f32_16x16x32_bf16 v[192:195], v[232:235], v[160:163], 0
  ds_read_b128 v[232:235], v2 offset:1024
  v_mul_f32 v210, s93, v210
  v_mfma_f32_16x16x32_bf16 v[188:191], v[236:239], v[136:139], 0
  v_mul_f32 v211, s93, v211
  v_mul_f32 v212, s93, v212
  v_mfma_f32_16x16x32_bf16 v[196:199], v[236:239], v[160:163], 0
  ds_read_b128 v[236:239], v2 offset:0
  s_waitcnt lgkmcnt(8)
  v_mfma_f32_16x16x32_bf16 v[184:187], v[240:243], v[140:143], v[184:187]
  v_mul_f32 v213, s93, v213
  v_mul_f32 v214, s93, v214
  v_mfma_f32_16x16x32_bf16 v[192:195], v[240:243], v[164:167], v[192:195]
  ds_read_b128 v[240:243], v1 offset:35840
  v_mul_f32 v215, s93, v215
  v_mfma_f32_16x16x32_bf16 v[188:191], v[244:247], v[140:143], v[188:191]
  v_cvt_pk_bf16_f32 v116, v208, v209
  v_cvt_pk_bf16_f32 v117, v210, v211
  v_mfma_f32_16x16x32_bf16 v[196:199], v[244:247], v[164:167], v[196:199]
  ds_read_b128 v[244:247], v1 offset:34816
  s_waitcnt lgkmcnt(8)
  v_mfma_f32_16x16x32_bf16 v[184:187], v[248:251], v[144:147], v[184:187]
  v_cvt_pk_bf16_f32 v118, v212, v213
  v_cvt_pk_bf16_f32 v119, v214, v215
  v_mfma_f32_16x16x32_bf16 v[192:195], v[248:251], v[168:171], v[192:195]
  ds_read_b128 v[248:251], v1 offset:33792
  v_mul_f32 v200, s93, v200
  v_mfma_f32_16x16x32_bf16 v[188:191], v[252:255], v[144:147], v[188:191]
  v_mul_f32 v201, s93, v201
  v_mul_f32 v202, s93, v202
  v_mfma_f32_16x16x32_bf16 v[196:199], v[252:255], v[168:171], v[196:199]
  ds_read_b128 v[252:255], v1 offset:32768
  s_waitcnt lgkmcnt(8)
  v_mfma_f32_16x16x32_bf16 v[184:187], v[216:219], v[148:151], v[184:187]
  v_mul_f32 v203, s93, v203
  v_mul_f32 v204, s93, v204
  v_mfma_f32_16x16x32_bf16 v[192:195], v[216:219], v[172:175], v[192:195]
  ds_read_b128 v[216:219], v1 offset:31744
  v_mul_f32 v205, s93, v205
  s_cbranch_vccz SL45
  s_barrier
  s_branch SM45
SL45:
  s_cmp_eq_u32 s3, 0
  s_cbranch_scc1 MK_np5
  s_waitcnt vmcnt(0)
  v_mov_b32 v23, 1
  s_mov_b64 exec, 1
  buffer_atomic_add v23, off, s[8:11], 0 sc1
  s_mov_b64 exec, -1
  s_nop 3
MK_np5:
SM45:
  v_mfma_f32_16x16x32_bf16 v[188:191], v[220:223], v[148:151], v[188:191]
  v_mul_f32 v206, s93, v206
  v_mul_f32 v207, s93, v207
  v_mfma_f32_16x16x32_bf16 v[196:199], v[220:223], v[172:175], v[196:199]
  ds_read_b128 v[220:223], v1 offset:30720
  s_waitcnt lgkmcnt(8)
  v_mfma_f32_16x16x32_bf16 v[184:187], v[224:227], v[152:155], v[184:187]
  v_cvt_pk_bf16_f32 v92, v200, v201
  v_cvt_pk_bf16_f32 v93, v202, v203
  v_mfma_f32_16x16x32_bf16 v[192:195], v[224:227], v[176:179], v[192:195]
  ds_read_b128 v[224:227], v1 offset:29696
  v_cvt_pk_bf16_f32 v94, v204, v205
  v_mfma_f32_16x16x32_bf16 v[188:191], v[228:231], v[152:155], v[188:191]
  v_cvt_pk_bf16_f32 v95, v206, v207
  v_cndmask_b32 v52, v64, v32, s[50:51]
  v_mfma_f32_16x16x32_bf16 v[196:199], v[228:231], v[176:179], v[196:199]
  ds_read_b128 v[228:231], v1 offset:28672
  s_waitcnt lgkmcnt(8)
  v_mfma_f32_16x16x32_bf16 v[184:187], v[232:235], v[156:159], v[184:187]
  v_cndmask_b32 v53, v64, v33, s[50:51]
  v_cndmask_b32 v54, v64, v34, s[50:51]
  v_mfma_f32_16x16x32_bf16 v[192:195], v[232:235], v[180:183], v[192:195]
  ds_read_b128 v[232:235], v1 offset:27648
  v_cndmask_b32 v55, v64, v35, s[50:51]
  v_mfma_f32_16x16x32_bf16 v[188:191], v[236:239], v[156:159], v[188:191]
  v_mfma_f32_16x16x32_bf16 v[196:199], v[236:239], v[180:183], v[196:199]
  ds_read_b128 v[236:239], v1 offset:26624
  s_waitcnt lgkmcnt(8)
  v_mfma_f32_16x16x32_bf16 v[200:203], v[240:243], v[136:139], 0
  v_mul_f32 v184, s93, v184
  v_mul_f32 v192, s93, v192
  v_mfma_f32_16x16x32_bf16 v[208:211], v[240:243], v[160:163], 0
  ds_read_b128 v[240:243], v1 offset:25600
  v_mul_f32 v193, s93, v193
  v_mfma_f32_16x16x32_bf16 v[204:207], v[244:247], v[136:139], 0
  v_mul_f32 v194, s93, v194
  v_mul_f32 v195, s93, v195
  v_mfma_f32_16x16x32_bf16 v[212:215], v[244:247], v[160:163], 0
  ds_read_b128 v[244:247], v1 offset:24576
  s_waitcnt lgkmcnt(8)
  v_mfma_f32_16x16x32_bf16 v[200:203], v[248:251], v[140:143], v[200:203]
  v_mul_f32 v196, s93, v196
  v_mul_f32 v197, s93, v197
  v_mfma_f32_16x16x32_bf16 v[208:211], v[248:251], v[164:167], v[208:211]
  ds_read_b128 v[248:251], v1 offset:23552
  v_mul_f32 v198, s93, v198
  v_mfma_f32_16x16x32_bf16 v[204:207], v[252:255], v[140:143], v[204:207]
  v_mul_f32 v199, s93, v199
  v_cvt_pk_bf16_f32 v120, v192, v193
  v_mfma_f32_16x16x32_bf16 v[212:215], v[252:255], v[164:167], v[212:215]
  ds_read_b128 v[252:255], v1 offset:22528
  s_waitcnt lgkmcnt(8)
  v_mfma_f32_16x16x32_bf16 v[200:203], v[216:219], v[144:147], v[200:203]
  v_cvt_pk_bf16_f32 v121, v194, v195
  v_cvt_pk_bf16_f32 v122, v196, v197
  v_mfma_f32_16x16x32_bf16 v[208:211], v[216:219], v[168:171], v[208:211]
  ds_read_b128 v[216:219], v1 offset:21504
  v_cvt_pk_bf16_f32 v123, v198, v199
  v_mfma_f32_16x16x32_bf16 v[204:207], v[220:223], v[144:147], v[204:207]
  v_mul_f32 v185, s93, v185
  v_mul_f32 v186, s93, v186
  v_mfma_f32_16x16x32_bf16 v[212:215], v[220:223], v[168:171], v[212:215]
  ds_read_b128 v[220:223], v1 offset:20480
  s_waitcnt lgkmcnt(8)
  v_mfma_f32_16x16x32_bf16 v[200:203], v[224:227], v[148:151], v[200:203]
  v_mul_f32 v187, s93, v187
  v_mul_f32 v188, s93, v188
  v_mfma_f32_16x16x32_bf16 v[208:211], v[224:227], v[172:175], v[208:211]
  ds_read_b128 v[224:227], v1 offset:19456
  v_mul_f32 v189, s93, v189
  v_mfma_f32_16x16x32_bf16 v[204:207], v[228:231], v[148:151], v[204:207]
  v_mul_f32 v190, s93, v190
  v_mul_f32 v191, s93, v191
  v_mfma_f32_16x16x32_bf16 v[212:215], v[228:231], v[172:175], v[212:215]
  ds_read_b128 v[228:231], v1 offset:18432
  s_waitcnt lgkmcnt(8)
  v_mfma_f32_16x16x32_bf16 v[200:203], v[232:235], v[152:155], v[200:203]
  v_cvt_pk_bf16_f32 v96, v184, v185
  v_cvt_pk_bf16_f32 v97, v186, v187
  v_mfma_f32_16x16x32_bf16 v[208:211], v[232:235], v[176:179], v[208:211]
  ds_read_b128 v[232:235], v1 offset:17408
  v_cvt_pk_bf16_f32 v98, v188, v189
  v_mfma_f32_16x16x32_bf16 v[204:207], v[236:239], v[152:155], v[204:207]
  v_cvt_pk_bf16_f32 v99, v190, v191
  v_cndmask_b32 v56, v64, v32, s[52:53]
  v_mfma_f32_16x16x32_bf16 v[212:215], v[236:239], v[176:179], v[212:215]
  ds_read_b128 v[236:239], v1 offset:16384
  s_waitcnt lgkmcnt(8)
  v_mfma_f32_16x16x32_bf16 v[200:203], v[240:243], v[156:159], v[200:203]
  v_cndmask_b32 v57, v64, v33, s[52:53]
  v_cndmask_b32 v58, v64, v34, s[52:53]
  v_mfma_f32_16x16x32_bf16 v[208:211], v[240:243], v[180:183], v[208:211]
  ds_read_b128 v[240:243], v1 offset:15360
  v_cndmask_b32 v59, v64, v35, s[52:53]
  v_mfma_f32_16x16x32_bf16 v[204:207], v[244:247], v[156:159], v[204:207]
  v_cndmask_b32 v84, v64, v32, s[54:55]
  v_mfma_f32_16x16x32_bf16 v[212:215], v[244:247], v[180:183], v[212:215]
  ds_read_b128 v[244:247], v1 offset:14336
  s_waitcnt lgkmcnt(8)
  v_mfma_f32_16x16x32_bf16 v[184:187], v[248:251], v[136:139], 0
  v_mul_f32 v208, s93, v208
  v_mul_f32 v209, s93, v209
  v_mfma_f32_16x16x32_bf16 v[192:195], v[248:251], v[160:163], 0
  ds_read_b128 v[248:251], v1 offset:13312
  v_mul_f32 v210, s93, v210
  v_mfma_f32_16x16x32_bf16 v[188:191], v[252:255], v[136:139], 0
  v_mul_f32 v211, s93, v211
  v_mul_f32 v212, s93, v212
  v_mfma_f32_16x16x32_bf16 v[196:199], v[252:255], v[160:163], 0
  ds_read_b128 v[252:255], v1 offset:12288
  s_waitcnt lgkmcnt(8)
  v_mfma_f32_16x16x32_bf16 v[184:187], v[216:219], v[140:143], v[184:187]
  v_mul_f32 v213, s93, v213
  v_mul_f32 v214, s93, v214
  v_mfma_f32_16x16x32_bf16 v[192:195], v[216:219], v[164:167], v[192:195]
  ds_read_b128 v[216:219], v1 offset:11264
  v_mul_f32 v215, s93, v215
  v_mfma_f32_16x16x32_bf16 v[188:191], v[220:223], v[140:143], v[188:191]
  v_cvt_pk_bf16_f32 v124, v208, v209
  v_cvt_pk_bf16_f32 v125, v210, v211
  v_mfma_f32_16x16x32_bf16 v[196:199], v[220:223], v[164:167], v[196:199]
  ds_read_b128 v[220:223], v1 offset:10240
  s_waitcnt lgkmcnt(8)
  v_mfma_f32_16x16x32_bf16 v[184:187], v[224:227], v[144:147], v[184:187]
  v_cvt_pk_bf16_f32 v126, v212, v213
  v_cvt_pk_bf16_f32 v127, v214, v215
  v_mfma_f32_16x16x32_bf16 v[192:195], v[224:227], v[168:171], v[192:195]
  ds_read_b128 v[224:227], v1 offset:9216
  v_mul_f32 v200, s93, v200
  v_mfma_f32_16x16x32_bf16 v[188:191], v[228:231], v[144:147], v[188:191]
  v_mul_f32 v201, s93, v201
  v_mul_f32 v202, s93, v202
  v_mfma_f32_16x16x32_bf16 v[196:199], v[228:231], v[168:171], v[196:199]
  ds_read_b128 v[228:231], v1 offset:8192
  s_waitcnt lgkmcnt(8)
  v_mfma_f32_16x16x32_bf16 v[184:187], v[232:235], v[148:151], v[184:187]
  v_mul_f32 v203, s93, v203
  v_mul_f32 v204, s93, v204
  v_mfma_f32_16x16x32_bf16 v[192:195], v[232:235], v[172:175], v[192:195]
  ds_read_b128 v[232:235], v1 offset:7168
  v_mul_f32 v205, s93, v205
  v_mfma_f32_16x16x32_bf16 v[188:191], v[236:239], v[148:151], v[188:191]
  v_mul_f32 v206, s93, v206
  v_mul_f32 v207, s93, v207
  v_mfma_f32_16x16x32_bf16 v[196:199], v[236:239], v[172:175], v[196:199]
  ds_read_b128 v[236:239], v1 offset:6144
  s_waitcnt lgkmcnt(8)
  v_mfma_f32_16x16x32_bf16 v[184:187], v[240:243], v[152:155], v[184:187]
  v_cvt_pk_bf16_f32 v100, v200, v201
  v_cvt_pk_bf16_f32 v101, v202, v203
  v_mfma_f32_16x16x32_bf16 v[192:195], v[240:243], v[176:179], v[192:195]
  ds_read_b128 v[240:243], v1 offset:5120
  v_cvt_pk_bf16_f32 v102, v204, v205
  v_mfma_f32_16x16x32_bf16 v[188:191], v[244:247], v[152:155], v[188:191]
  v_cvt_pk_bf16_f32 v103, v206, v207
  v_cndmask_b32 v85, v64, v33, s[54:55]
  v_mfma_f32_16x16x32_bf16 v[196:199], v[244:247], v[176:179], v[196:199]
  ds_read_b128 v[244:247], v1 offset:4096
  s_waitcnt lgkmcnt(8)
  v_mfma_f32_16x16x32_bf16 v[184:187], v[248:251], v[156:159], v[184:187]
  v_cndmask_b32 v86, v64, v34, s[54:55]
  v_cndmask_b32 v87, v64, v35, s[54:55]
  v_mfma_f32_16x16x32_bf16 v[192:195], v[248:251], v[180:183], v[192:195]
  ds_read_b128 v[248:251], v1 offset:3072
  v_mfma_f32_16x16x32_bf16 v[188:191], v[252:255], v[156:159], v[188:191]
  v_mfma_f32_16x16x32_bf16 v[196:199], v[252:255], v[180:183], v[196:199]
  ds_read_b128 v[252:255], v1 offset:2048
  s_waitcnt lgkmcnt(8)
  v_mfma_f32_16x16x32_bf16 v[200:203], v[216:219], v[136:139], 0
  v_mul_f32 v184, s93, v184
  v_mul_f32 v185, s93, v185
  v_mfma_f32_16x16x32_bf16 v[208:211], v[216:219], v[160:163], 0
  ds_read_b128 v[216:219], v1 offset:1024
  v_mul_f32 v192, s93, v192
  s_cbranch_vccz SL46
  s_waitcnt vmcnt(0)
  s_barrier
SL46:
  v_mfma_f32_16x16x32_bf16 v[204:207], v[220:223], v[136:139], 0
  v_mul_f32 v193, s93, v193
  v_mul_f32 v194, s93, v194
  v_mfma_f32_16x16x32_bf16 v[212:215], v[220:223], v[160:163], 0
  ds_read_b128 v[220:223], v1 offset:0
  s_waitcnt lgkmcnt(8)
  v_mfma_f32_16x16x32_bf16 v[200:203], v[224:227], v[140:143], v[200:203]
  v_mul_f32 v195, s93, v195
  v_mul_f32 v196, s93, v196
  v_mfma_f32_16x16x32_bf16 v[208:211], v[224:227], v[164:167], v[208:211]
  v_mul_f32 v197, s93, v197
  v_mul_f32 v198, s93, v198
  v_mfma_f32_16x16x32_bf16 v[204:207], v[228:231], v[140:143], v[204:207]
  v_mul_f32 v199, s93, v199
  v_cvt_pk_bf16_f32 v128, v192, v193
  v_mfma_f32_16x16x32_bf16 v[212:215], v[228:231], v[164:167], v[212:215]
  v_cvt_pk_bf16_f32 v129, v194, v195
  s_waitcnt lgkmcnt(6)
  v_mfma_f32_16x16x32_bf16 v[200:203], v[232:235], v[144:147], v[200:203]
  v_cvt_pk_bf16_f32 v130, v196, v197
  v_cvt_pk_bf16_f32 v131, v198, v199
  v_mfma_f32_16x16x32_bf16 v[208:211], v[232:235], v[168:171], v[208:211]
  v_mul_f32 v186, s93, v186
  v_mul_f32 v187, s93, v187
  v_mfma_f32_16x16x32_bf16 v[204:207], v[236:239], v[144:147], v[204:207]
  v_mul_f32 v188, s93, v188
  v_mul_f32 v189, s93, v189
  v_mfma_f32_16x16x32_bf16 v[212:215], v[236:239], v[168:171], v[212:215]
  v_mul_f32 v190, s93, v190
  s_waitcnt lgkmcnt(5)
  v_mfma_f32_16x16x32_bf16 v[200:203], v[240:243], v[148:151], v[200:203]
  v_mul_f32 v191, s93, v191
  v_cvt_pk_bf16_f32 v104, v184, v185
  v_mfma_f32_16x16x32_bf16 v[208:211], v[240:243], v[172:175], v[208:211]
  v_cvt_pk_bf16_f32 v105, v186, v187
  s_waitcnt lgkmcnt(4)
  v_mfma_f32_16x16x32_bf16 v[204:207], v[244:247], v[148:151], v[204:207]
  v_cvt_pk_bf16_f32 v106, v188, v189
  v_cvt_pk_bf16_f32 v107, v190, v191
  v_mfma_f32_16x16x32_bf16 v[212:215], v[244:247], v[172:175], v[212:215]
  s_waitcnt lgkmcnt(3)
  v_mfma_f32_16x16x32_bf16 v[200:203], v[248:251], v[152:155], v[200:203]
  v_mfma_f32_16x16x32_bf16 v[208:211], v[248:251], v[176:179], v[208:211]
  s_waitcnt lgkmcnt(2)
  v_mfma_f32_16x16x32_bf16 v[204:207], v[252:255], v[152:155], v[204:207]
  v_mfma_f32_16x16x32_bf16 v[212:215], v[252:255], v[176:179], v[212:215]
  s_waitcnt lgkmcnt(1)
  v_mfma_f32_16x16x32_bf16 v[200:203], v[216:219], v[156:159], v[200:203]
  v_mfma_f32_16x16x32_bf16 v[208:211], v[216:219], v[180:183], v[208:211]
  s_waitcnt lgkmcnt(0)
  v_mfma_f32_16x16x32_bf16 v[204:207], v[220:223], v[156:159], v[204:207]
  v_mfma_f32_16x16x32_bf16 v[212:215], v[220:223], v[180:183], v[212:215]
  s_cbranch_vccnz SL47
  s_setprio 0
  s_mul_i32 s100, s32, 7
  s_add_i32 s100, s100, s31
  s_add_u32 m0, s38, 107520
  s_nop 0
  buffer_load_dwordx4 v13, s[12:15], s100 offen lds
  s_add_u32 m0, s38, 108544
  s_nop 0
  buffer_load_dwordx4 v14, s[12:15], s100 offen lds
  s_add_u32 m0, s38, 109568
  s_nop 0
  buffer_load_dwordx4 v3, s[12:15], s100 offen lds
  s_add_u32 m0, s39, 107520
  s_nop 0
  buffer_load_dwordx4 v4, s[12:15], s100 offen lds
  s_mul_i32 s100, s32, 6
  s_add_i32 s100, s100, s31
  s_add_u32 m0, s38, 92160
  s_nop 0
  buffer_load_dwordx4 v13, s[12:15], s100 offen lds
  s_add_u32 m0, s38, 93184
  s_nop 0
  buffer_load_dwordx4 v14, s[12:15], s100 offen lds
  s_add_u32 m0, s38, 94208
  s_nop 0
  buffer_load_dwordx4 v3, s[12:15], s100 offen lds
  s_add_u32 m0, s39, 92160
  s_nop 0
  buffer_load_dwordx4 v4, s[12:15], s100 offen lds
  s_mul_i32 s100, s32, 5
  s_add_i32 s100, s100, s31
  s_add_u32 m0, s38, 76800
  s_nop 0
  buffer_load_dwordx4 v13, s[12:15], s100 offen lds
  s_add_u32 m0, s38, 77824
  s_nop 0
  buffer_load_dwordx4 v14, s[12:15], s100 offen lds
  s_add_u32 m0, s38, 78848
  s_nop 0
  buffer_load_dwordx4 v3, s[12:15], s100 offen lds
  s_add_u32 m0, s39, 76800
  s_nop 0
  buffer_load_dwordx4 v4, s[12:15], s100 offen lds
  s_barrier
  s_mul_i32 s100, s32, 4
  s_add_i32 s100, s100, s31
  s_add_u32 m0, s38, 61440
  s_nop 0
  buffer_load_dwordx4 v13, s[12:15], s100 offen lds
  s_add_u32 m0, s38, 62464
  s_nop 0
  buffer_load_dwordx4 v14, s[12:15], s100 offen lds
  s_add_u32 m0, s38, 63488
  s_nop 0
  buffer_load_dwordx4 v3, s[12:15], s100 offen lds
  s_add_u32 m0, s39, 61440
  s_nop 0
  buffer_load_dwordx4 v4, s[12:15], s100 offen lds
  s_mul_i32 s100, s32, 3
  s_add_i32 s100, s100, s31
  s_add_u32 m0, s38, 46080
  s_nop 0
  buffer_load_dwordx4 v13, s[12:15], s100 offen lds
  s_add_u32 m0, s38, 47104
  s_nop 0
  buffer_load_dwordx4 v14, s[12:15], s100 offen lds
  s_add_u32 m0, s38, 48128
  s_nop 0
  buffer_load_dwordx4 v3, s[12:15], s100 offen lds
  s_add_u32 m0, s39, 46080
  s_nop 0
  buffer_load_dwordx4 v4, s[12:15], s100 offen lds
  s_mul_i32 s100, s32, 2
  s_add_i32 s100, s100, s31
  s_add_u32 m0, s38, 30720
  s_nop 0
  buffer_load_dwordx4 v13, s[12:15], s100 offen lds
  s_add_u32 m0, s38, 31744
  s_nop 0
  buffer_load_dwordx4 v14, s[12:15], s100 offen lds
  s_add_u32 m0, s38, 32768
  s_nop 0
  buffer_load_dwordx4 v3, s[12:15], s100 offen lds
  s_add_u32 m0, s39, 30720
  s_nop 0
  buffer_load_dwordx4 v4, s[12:15], s100 offen lds
  s_waitcnt vmcnt(12)
  s_barrier
  s_max_u32 s100, s33, 1
  s_mul_i32 s100, s100, s32
  s_add_i32 s100, s100, s31
  s_add_u32 m0, s38, 15360
  s_nop 0
  buffer_load_dwordx4 v13, s[12:15], s100 offen lds
  s_add_u32 m0, s38, 16384
  s_nop 0
  buffer_load_dwordx4 v14, s[12:15], s100 offen lds
  s_add_u32 m0, s38, 17408
  s_nop 0
  buffer_load_dwordx4 v3, s[12:15], s100 offen lds
  s_add_u32 m0, s39, 15360
  s_nop 0
  buffer_load_dwordx4 v4, s[12:15], s100 offen lds
  s_max_u32 s100, s33, 0
  s_mul_i32 s100, s100, s32
  s_add_i32 s100, s100, s31
  s_add_u32 m0, s38, 0
  s_nop 0
  buffer_load_dwordx4 v13, s[12:15], s100 offen lds
  s_add_u32 m0, s38, 1024
  s_nop 0
  buffer_load_dwordx4 v14, s[12:15], s100 offen lds
  s_add_u32 m0, s38, 2048
  s_nop 0
  buffer_load_dwordx4 v3, s[12:15], s100 offen lds
  s_add_u32 m0, s39, 0
  s_nop 0
  buffer_load_dwordx4 v4, s[12:15], s100 offen lds
  s_waitcnt vmcnt(8)
  s_barrier
SL47:
  ds_read_b128 v[224:227], v7 offset:61440
  ds_read_b128 v[228:231], v8 offset:61440
  ds_read_b128 v[232:235], v7 offset:61568
  ds_read_b128 v[236:239], v8 offset:61568
  ds_read_b128 v[240:243], v7 offset:61696
  ds_read_b128 v[244:247], v8 offset:61696
  ds_read_b128 v[248:251], v7 offset:53760
  ds_read_b128 v[252:255], v8 offset:53760
  ds_read_b128 v[216:219], v7 offset:53888
  ds_read_b128 v[220:223], v8 offset:53888
  s_waitcnt lgkmcnt(8)
  v_mfma_f32_16x16x32_bf16 v[84:87], v[224:227], v[112:115], v[84:87]
  ds_read_b128 v[224:227], v7 offset:54016
  v_mul_f32 v208, s93, v208
  v_mfma_f32_16x16x32_bf16 v[84:87], v[228:231], v[116:119], v[84:87]
  ds_read_b128 v[228:231], v8 offset:54016
  s_waitcnt lgkmcnt(8)
  v_mfma_f32_16x16x32_bf16 v[84:87], v[232:235], v[120:123], v[84:87]
  ds_read_b128 v[232:235], v7 offset:46080
  v_mul_f32 v209, s93, v209
  v_mfma_f32_16x16x32_bf16 v[84:87], v[236:239], v[124:127], v[84:87]
  ds_read_b128 v[236:239], v8 offset:46080
  s_waitcnt lgkmcnt(8)
  v_mfma_f32_16x16x32_bf16 v[84:87], v[240:243], v[128:131], v[84:87]
  ds_read_b128 v[240:243], v7 offset:46208
  v_mul_f32 v210, s93, v210
  v_mul_f32 v211, s93, v211
  v_mul_f32 v212, s93, v212
  v_mul_f32 v213, s93, v213
  v_mul_f32 v214, s93, v214
  v_mul_f32 v215, s93, v215
  v_cvt_pk_bf16_f32 v132, v208, v209
  v_cvt_pk_bf16_f32 v133, v210, v211
  v_cvt_pk_bf16_f32 v134, v212, v213
  v_cvt_pk_bf16_f32 v135, v214, v215
  s_nop 1
  v_mfma_f32_16x16x32_bf16 v[84:87], v[244:247], v[132:135], v[84:87]
  ds_read_b128 v[244:247], v8 offset:46208
  s_waitcnt lgkmcnt(8)
  v_mfma_f32_16x16x32_bf16 v[80:83], v[248:251], v[112:115], v[32:35]
  ds_read_b128 v[248:251], v7 offset:46336
  v_mul_f32 v200, s93, v200
  v_mfma_f32_16x16x32_bf16 v[80:83], v[252:255], v[116:119], v[80:83]
  ds_read_b128 v[252:255], v8 offset:46336
  s_waitcnt lgkmcnt(8)
  v_mfma_f32_16x16x32_bf16 v[80:83], v[216:219], v[120:123], v[80:83]
  ds_read_b128 v[216:219], v7 offset:38400
  v_mul_f32 v201, s93, v201
  v_mfma_f32_16x16x32_bf16 v[80:83], v[220:223], v[124:127], v[80:83]
  ds_read_b128 v[220:223], v8 offset:38400
  s_waitcnt lgkmcnt(8)
  v_mfma_f32_16x16x32_bf16 v[80:83], v[224:227], v[128:131], v[80:83]
  ds_read_b128 v[224:227], v7 offset:38528
  v_mul_f32 v202, s93, v202
  v_mfma_f32_16x16x32_bf16 v[80:83], v[228:231], v[132:135], v[80:83]
  ds_read_b128 v[228:231], v8 offset:38528
  s_cbranch_vccz SL48
  s_barrier
  s_branch SM48
SL48:
  s_waitcnt vmcnt(0)
  s_barrier
SM48:
  s_waitcnt lgkmcnt(8)
  v_mfma_f32_16x16x32_bf16 v[76:79], v[232:235], v[112:115], v[32:35]
  v_exp_f32 v196, v84
  v_mfma_f32_16x16x32_bf16 v[52:55], v[232:235], v[88:91], v[52:55]
  v_exp_f32 v197, v85
  v_mfma_f32_16x16x32_bf16 v[76:79], v[236:239], v[116:119], v[76:79]
  v_exp_f32 v198, v86
  v_mfma_f32_16x16x32_bf16 v[52:55], v[236:239], v[92:95], v[52:55]
  ds_read_b128 v[232:235], v7 offset:38656
  s_waitcnt lgkmcnt(7)
  v_mfma_f32_16x16x32_bf16 v[76:79], v[240:243], v[120:123], v[76:79]
  v_exp_f32 v199, v87
  v_mfma_f32_16x16x32_bf16 v[52:55], v[240:243], v[96:99], v[52:55]
  ds_read_b128 v[236:239], v8 offset:38656
  ds_read_b128 v[240:243], v7 offset:30720
  v_mfma_f32_16x16x32_bf16 v[76:79], v[244:247], v[124:127], v[76:79]
  v_mul_f32 v203, s93, v203
  v_mul_f32 v204, s93, v204
  v_mfma_f32_16x16x32_bf16 v[52:55], v[244:247], v[100:103], v[52:55]
  ds_read_b128 v[244:247], v8 offset:30720
  s_waitcnt lgkmcnt(8)
  v_mfma_f32_16x16x32_bf16 v[76:79], v[248:251], v[128:131], v[76:79]
  v_mul_f32 v205, s93, v205
  v_mul_f32 v206, s93, v206
  v_mfma_f32_16x16x32_bf16 v[52:55], v[248:251], v[104:107], v[52:55]
  ds_read_b128 v[248:251], v7 offset:30848
  v_mul_f32 v207, s93, v207
  v_cvt_pk_bf16_f32 v108, v200, v201
  v_cvt_pk_bf16_f32 v109, v202, v203
  v_cvt_pk_bf16_f32 v110, v204, v205
  v_cvt_pk_bf16_f32 v111, v206, v207
  v_mfma_f32_16x16x32_bf16 v[76:79], v[252:255], v[132:135], v[76:79]
  v_exp_f32 v200, v80
  v_mfma_f32_16x16x32_bf16 v[52:55], v[252:255], v[108:111], v[52:55]
  ds_read_b128 v[252:255], v8 offset:30848
  s_waitcnt lgkmcnt(8)
  v_mfma_f32_16x16x32_bf16 v[72:75], v[216:219], v[112:115], v[32:35]
  v_exp_f32 v201, v81
  v_mfma_f32_16x16x32_bf16 v[48:51], v[216:219], v[88:91], v[32:35]
  v_exp_f32 v202, v82
  v_mfma_f32_16x16x32_bf16 v[72:75], v[220:223], v[116:119], v[72:75]
  v_exp_f32 v203, v83
  v_mfma_f32_16x16x32_bf16 v[48:51], v[220:223], v[92:95], v[48:51]
  ds_read_b128 v[216:219], v7 offset:30976
  v_add_u32 v2, 102400, v1
  s_waitcnt lgkmcnt(7)
  v_mfma_f32_16x16x32_bf16 v[72:75], v[224:227], v[120:123], v[72:75]
  v_exp_f32 v204, v76
  v_mfma_f32_16x16x32_bf16 v[48:51], v[224:227], v[96:99], v[48:51]
  v_exp_f32 v205, v77
  v_mfma_f32_16x16x32_bf16 v[72:75], v[228:231], v[124:127], v[72:75]
  v_exp_f32 v206, v78
  v_mfma_f32_16x16x32_bf16 v[48:51], v[228:231], v[100:103], v[48:51]
  ds_read_b128 v[220:223], v8 offset:30976
  s_waitcnt lgkmcnt(6)
  v_mfma_f32_16x16x32_bf16 v[72:75], v[232:235], v[128:131], v[72:75]
  v_exp_f32 v207, v79
  v_mfma_f32_16x16x32_bf16 v[48:51], v[232:235], v[104:107], v[48:51]
  v_exp_f32 v208, v52
  v_mfma_f32_16x16x32_bf16 v[72:75], v[236:239], v[132:135], v[72:75]
  v_exp_f32 v209, v53
  v_mfma_f32_16x16x32_bf16 v[48:51], v[236:239], v[108:111], v[48:51]
  ds_read_b128 v[224:227], v7 offset:23040
  s_waitcnt lgkmcnt(5)
  v_mfma_f32_16x16x32_bf16 v[68:71], v[240:243], v[112:115], v[32:35]
  v_exp_f32 v210, v54
  v_mfma_f32_16x16x32_bf16 v[44:47], v[240:243], v[88:91], v[32:35]
  v_exp_f32 v211, v55
  v_mfma_f32_16x16x32_bf16 v[68:71], v[244:247], v[116:119], v[68:71]
  ds_read_b128 v[228:231], v8 offset:23040
  ds_read_b128 v[232:235], v7 offset:23168
  v_mov_b32 v192, 0x3f803f80
  v_mfma_f32_16x16x32_bf16 v[44:47], v[244:247], v[92:95], v[44:47]
  ds_read_b128 v[236:239], v8 offset:23168
  v_mov_b32 v193, 0x3f803f80
  s_waitcnt lgkmcnt(6)
  v_mfma_f32_16x16x32_bf16 v[68:71], v[248:251], v[120:123], v[68:71]
  v_exp_f32 v212, v72
  v_mfma_f32_16x16x32_bf16 v[44:47], v[248:251], v[96:99], v[44:47]
  v_exp_f32 v213, v73
  v_mfma_f32_16x16x32_bf16 v[68:71], v[252:255], v[124:127], v[68:71]
  v_exp_f32 v214, v74
  v_mfma_f32_16x16x32_bf16 v[44:47], v[252:255], v[100:103], v[44:47]
  ds_read_b128 v[240:243], v7 offset:23296
  s_waitcnt lgkmcnt(5)
  v_mfma_f32_16x16x32_bf16 v[68:71], v[216:219], v[128:131], v[68:71]
  v_exp_f32 v215, v75
  v_mfma_f32_16x16x32_bf16 v[44:47], v[216:219], v[104:107], v[44:47]
  ds_read_b128 v[244:247], v8 offset:23296
  ds_read_b128 v[248:251], v7 offset:15360
  v_mfma_f32_16x16x32_bf16 v[68:71], v[220:223], v[132:135], v[68:71]
  ds_read_b128 v[252:255], v8 offset:15360
  ds_read_b128 v[216:219], v7 offset:15488
  v_mfma_f32_16x16x32_bf16 v[44:47], v[220:223], v[108:111], v[44:47]
  ds_read_b128 v[220:223], v8 offset:15488
  s_waitcnt lgkmcnt(8)
  v_mfma_f32_16x16x32_bf16 v[64:67], v[224:227], v[112:115], v[32:35]
  v_mov_b32 v194, 0x3f803f80
  v_mov_b32 v195, 0x3f803f80
  v_mfma_f32_16x16x32_bf16 v[40:43], v[224:227], v[88:91], v[32:35]
  ds_read_b128 v[224:227], v7 offset:15616
  v_cvt_pk_bf16_f32 v166, v196, v197
  v_mfma_f32_16x16x32_bf16 v[64:67], v[228:231], v[116:119], v[64:67]
  v_exp_f32 v196, v48
  v_mfma_f32_16x16x32_bf16 v[40:43], v[228:231], v[92:95], v[40:43]
  ds_read_b128 v[228:231], v8 offset:15616
  v_cvt_pk_bf16_f32 v167, v198, v199
  s_waitcnt lgkmcnt(8)
  v_mfma_f32_16x16x32_bf16 v[64:67], v[232:235], v[120:123], v[64:67]
  v_exp_f32 v197, v49
  v_mfma_f32_16x16x32_bf16 v[40:43], v[232:235], v[96:99], v[40:43]
  v_exp_f32 v198, v50
  v_mfma_f32_16x16x32_bf16 v[64:67], v[236:239], v[124:127], v[64:67]
  v_exp_f32 v199, v51
  v_mfma_f32_16x16x32_bf16 v[40:43], v[236:239], v[100:103], v[40:43]
  ds_read_b128 v[232:235], v7 offset:7680
  v_cvt_pk_bf16_f32 v164, v200, v201
  s_waitcnt lgkmcnt(7)
  v_mfma_f32_16x16x32_bf16 v[64:67], v[240:243], v[128:131], v[64:67]
  v_exp_f32 v200, v68
  v_mfma_f32_16x16x32_bf16 v[40:43], v[240:243], v[104:107], v[40:43]
  v_exp_f32 v201, v69
  v_mfma_f32_16x16x32_bf16 v[64:67], v[244:247], v[132:135], v[64:67]
  ds_read_b128 v[236:239], v8 offset:7680
  ds_read_b128 v[240:243], v7 offset:7808
  v_mfma_f32_16x16x32_bf16 v[40:43], v[244:247], v[108:111], v[40:43]
  ds_read_b128 v[244:247], v8 offset:7808
  s_cbranch_vccz SL49
  s_barrier
  buffer_load_dword v13, off, s[8:11], 0
SL49:
  s_waitcnt lgkmcnt(8)
  v_mfma_f32_16x16x32_bf16 v[60:63], v[248:251], v[112:115], v[32:35]
  v_cvt_pk_bf16_f32 v165, v202, v203
  v_cvt_pk_bf16_f32 v162, v204, v205
  v_mfma_f32_16x16x32_bf16 v[36:39], v[248:251], v[88:91], v[32:35]
  v_exp_f32 v202, v70
  v_mfma_f32_16x16x32_bf16 v[60:63], v[252:255], v[116:119], v[60:63]
  v_exp_f32 v203, v71
  v_mfma_f32_16x16x32_bf16 v[36:39], v[252:255], v[92:95], v[36:39]
  ds_read_b128 v[248:251], v7 offset:7936
  v_cvt_pk_bf16_f32 v163, v206, v207
  s_waitcnt lgkmcnt(7)
  v_mfma_f32_16x16x32_bf16 v[60:63], v[216:219], v[120:123], v[60:63]
  v_exp_f32 v204, v44
  v_mfma_f32_16x16x32_bf16 v[36:39], v[216:219], v[96:99], v[36:39]
  v_exp_f32 v205, v45
  v_mfma_f32_16x16x32_bf16 v[60:63], v[220:223], v[124:127], v[60:63]
  v_exp_f32 v206, v46
  v_mfma_f32_16x16x32_bf16 v[36:39], v[220:223], v[100:103], v[36:39]
  ds_read_b128 v[252:255], v8 offset:7936
  v_cvt_pk_bf16_f32 v150, v208, v209
  s_waitcnt lgkmcnt(6)
  v_mfma_f32_16x16x32_bf16 v[60:63], v[224:227], v[128:131], v[60:63]
  v_exp_f32 v207, v47
  v_mfma_f32_16x16x32_bf16 v[36:39], v[224:227], v[104:107], v[36:39]
  v_exp_f32 v208, v64
  v_mfma_f32_16x16x32_bf16 v[60:63], v[228:231], v[132:135], v[60:63]
  v_exp_f32 v209, v65
  v_mfma_f32_16x16x32_bf16 v[36:39], v[228:231], v[108:111], v[36:39]
  ds_read_b128 v[216:219], v7 offset:0
  s_cbranch_vccnz SL50
  s_barrier
SL50:
  s_waitcnt lgkmcnt(5)
  v_mfma_f32_16x16x32_bf16 v[56:59], v[232:235], v[112:115], v[56:59]
  ds_read_b128 v[220:223], v8 offset:0
  ds_read_b128 v[224:227], v7 offset:128
  v_cvt_pk_bf16_f32 v151, v210, v211
  v_mfma_f32_16x16x32_bf16 v[32:35], v[232:235], v[88:91], v[32:35]
  v_exp_f32 v210, v66
  v_mfma_f32_16x16x32_bf16 v[56:59], v[236:239], v[116:119], v[56:59]
  v_exp_f32 v211, v67
  v_mfma_f32_16x16x32_bf16 v[32:35], v[236:239], v[92:95], v[32:35]
  ds_read_b128 v[228:231], v8 offset:128
  v_cvt_pk_bf16_f32 v160, v212, v213
  s_waitcnt lgkmcnt(6)
  v_mfma_f32_16x16x32_bf16 v[56:59], v[240:243], v[120:123], v[56:59]
  v_exp_f32 v212, v40
  v_mfma_f32_16x16x32_bf16 v[32:35], v[240:243], v[96:99], v[32:35]
  v_exp_f32 v213, v41
  v_mfma_f32_16x16x32_bf16 v[56:59], v[244:247], v[124:127], v[56:59]
  ds_read_b128 v[232:235], v7 offset:256
  ds_read_b128 v[236:239], v8 offset:256
  v_cvt_pk_bf16_f32 v161, v214, v215
  v_mfma_f32_16x16x32_bf16 v[32:35], v[244:247], v[100:103], v[32:35]
  ds_read_b128 v[240:243], v20 offset:0
  v_cvt_pk_bf16_f32 v148, v196, v197
  s_waitcnt lgkmcnt(7)
  v_mfma_f32_16x16x32_bf16 v[56:59], v[248:251], v[128:131], v[56:59]
  v_exp_f32 v214, v42
  v_mfma_f32_16x16x32_bf16 v[32:35], v[248:251], v[104:107], v[32:35]
  v_exp_f32 v215, v43
  v_mfma_f32_16x16x32_bf16 v[56:59], v[252:255], v[132:135], v[56:59]
  v_exp_f32 v196, v60
  v_mfma_f32_16x16x32_bf16 v[32:35], v[252:255], v[108:111], v[32:35]
  ds_read_b128 v[244:247], v0 offset:0
  v_cvt_pk_bf16_f32 v149, v198, v199
  s_waitcnt lgkmcnt(6)
  v_mfma_f32_16x16x32_bf16 v[28:31], v[216:219], v[88:91], v[28:31]
  v_exp_f32 v197, v61
  v_mfma_f32_16x16x32_bf16 v[28:31], v[220:223], v[92:95], v[28:31]
  ds_read_b128 v[248:251], v20 offset:128
  v_cvt_pk_bf16_f32 v158, v200, v201
  s_waitcnt lgkmcnt(5)
  v_mfma_f32_16x16x32_bf16 v[28:31], v[224:227], v[96:99], v[28:31]
  v_exp_f32 v198, v62
  v_mfma_f32_16x16x32_bf16 v[28:31], v[228:231], v[100:103], v[28:31]
  ds_read_b128 v[252:255], v0 offset:128
  v_cvt_pk_bf16_f32 v159, v202, v203
  s_waitcnt lgkmcnt(5)
  v_mfma_f32_16x16x32_bf16 v[28:31], v[232:235], v[104:107], v[28:31]
  ds_read_b128 v[216:219], v20 offset:256
  v_cvt_pk_bf16_f32 v146, v204, v205
  s_waitcnt lgkmcnt(5)
  v_mfma_f32_16x16x32_bf16 v[28:31], v[236:239], v[108:111], v[28:31]
  ds_read_b128 v[220:223], v0 offset:256
  v_cvt_pk_bf16_f32 v147, v206, v207
  s_waitcnt lgkmcnt(5)
  v_mfma_f32_16x16x32_bf16 v[24:27], v[240:243], v[88:91], v[24:27]
  ds_read_b64_tr_b16 v[224:225], v9 offset:53760
  ds_read_b64_tr_b16 v[226:227], v9 offset:61440
  v_cvt_pk_bf16_f32 v156, v208, v209
  s_waitcnt lgkmcnt(5)
  v_mfma_f32_16x16x32_bf16 v[24:27], v[244:247], v[92:95], v[24:27]
  ds_read_b64_tr_b16 v[228:229], v10 offset:53760
  ds_read_b64_tr_b16 v[230:231], v10 offset:61440
  v_cvt_pk_bf16_f32 v157, v210, v211
  v_mfma_f32_16x16x32_bf16 v[24:27], v[248:251], v[96:99], v[24:27]
  ds_read_b64_tr_b16 v[232:233], v11 offset:53760
  ds_read_b64_tr_b16 v[234:235], v11 offset:61440
  v_cvt_pk_bf16_f32 v144, v212, v213
  v_cvt_pk_bf16_f32 v145, v214, v215
  v_exp_f32 v199, v63
  v_cvt_pk_bf16_f32 v154, v196, v197
  v_cvt_pk_bf16_f32 v155, v198, v199
  v_exp_f32 v200, v36
  v_exp_f32 v201, v37
  v_exp_f32 v202, v38
  v_exp_f32 v203, v39
  v_cvt_pk_bf16_f32 v142, v200, v201
  v_cvt_pk_bf16_f32 v143, v202, v203
  v_exp_f32 v204, v56
  v_exp_f32 v205, v57
  v_exp_f32 v206, v58
  v_exp_f32 v207, v59
  v_cvt_pk_bf16_f32 v152, v204, v205
  v_cvt_pk_bf16_f32 v153, v206, v207
  v_mfma_f32_16x16x32_bf16 v[188:191], v[192:195], v[164:167], 0
  v_exp_f32 v208, v32
  v_mfma_f32_16x16x32_bf16 v[188:191], v[192:195], v[160:163], v[188:191]
  v_exp_f32 v209, v33
  v_mfma_f32_16x16x32_bf16 v[188:191], v[192:195], v[156:159], v[188:191]
  v_exp_f32 v210, v34
  v_mfma_f32_16x16x32_bf16 v[188:191], v[192:195], v[152:155], v[188:191]
  ds_read_b64_tr_b16 v[236:237], v12 offset:53760
  ds_read_b64_tr_b16 v[238:239], v12 offset:61440
  s_waitcnt lgkmcnt(9)
  v_mfma_f32_16x16x32_bf16 v[24:27], v[252:255], v[100:103], v[24:27]
  v_exp_f32 v211, v35
  v_mfma_f32_16x16x32_bf16 v[24:27], v[216:219], v[104:107], v[24:27]
  ds_read_b64_tr_b16 v[240:241], v9 offset:53888
  ds_read_b64_tr_b16 v[242:243], v9 offset:61568
  s_waitcnt lgkmcnt(8)
  v_mfma_f32_16x16x32_bf16 v[24:27], v[220:223], v[108:111], v[24:27]
  ds_read_b64_tr_b16 v[244:245], v10 offset:53888
  ds_read_b64_tr_b16 v[246:247], v10 offset:61568
  v_subrev_u32 v23, 813694976, v188
  s_mov_b32 s52, 503316480
  v_cmp_gt_u32 s[48:49], s52, v23
  s_or_b64 s[48:49], s[48:49], s[44:45]
  s_cmp_eq_u64 s[48:49], -1
  s_cbranch_scc0 FB1
FBR1:
  s_cbranch_vccnz SL51
  s_barrier
SL51:
  v_mfma_f32_16x16x32_bf16 v[88:91], v[224:227], v[164:167], 0
  ds_read_b64_tr_b16 v[248:249], v11 offset:53888
  ds_read_b64_tr_b16 v[250:251], v11 offset:61568
  v_cvt_pk_bf16_f32 v140, v208, v209
  s_waitcnt lgkmcnt(8)
  v_mfma_f32_16x16x32_bf16 v[92:95], v[228:231], v[164:167], 0
  ds_read_b64_tr_b16 v[252:253], v12 offset:53888
  ds_read_b64_tr_b16 v[254:255], v12 offset:61568
  v_cvt_pk_bf16_f32 v141, v210, v211
  v_mfma_f32_16x16x32_bf16 v[96:99], v[232:235], v[164:167], 0
  ds_read_b64_tr_b16 v[216:217], v9 offset:54016
  ds_read_b64_tr_b16 v[218:219], v9 offset:61696
  v_exp_f32 v212, v28
  s_waitcnt lgkmcnt(8)
  v_mfma_f32_16x16x32_bf16 v[100:103], v[236:239], v[164:167], 0
  ds_read_b64_tr_b16 v[220:221], v10 offset:54016
  ds_read_b64_tr_b16 v[222:223], v10 offset:61696
  v_exp_f32 v213, v29
  v_mfma_f32_16x16x32_bf16 v[104:107], v[240:243], v[164:167], 0
  ds_read_b64_tr_b16 v[224:225], v11 offset:54016
  ds_read_b64_tr_b16 v[226:227], v11 offset:61696
  s_waitcnt lgkmcnt(8)
  v_mfma_f32_16x16x32_bf16 v[108:111], v[244:247], v[164:167], 0
  ds_read_b64_tr_b16 v[228:229], v12 offset:54016
  ds_read_b64_tr_b16 v[230:231], v12 offset:61696
  v_mfma_f32_16x16x32_bf16 v[112:115], v[248:251], v[164:167], 0
  ds_read_b64_tr_b16 v[232:233], v9 offset:38400
  ds_read_b64_tr_b16 v[234:235], v9 offset:46080
  s_waitcnt lgkmcnt(8)
  v_mfma_f32_16x16x32_bf16 v[116:119], v[252:255], v[164:167], 0
  ds_read_b64_tr_b16 v[236:237], v10 offset:38400
  ds_read_b64_tr_b16 v[238:239], v10 offset:46080
  v_mfma_f32_16x16x32_bf16 v[120:123], v[216:219], v[164:167], 0
  ds_read_b64_tr_b16 v[240:241], v11 offset:38400
  ds_read_b64_tr_b16 v[242:243], v11 offset:46080
  s_waitcnt lgkmcnt(8)
  v_mfma_f32_16x16x32_bf16 v[124:127], v[220:223], v[164:167], 0
  ds_read_b64_tr_b16 v[244:245], v12 offset:38400
  ds_read_b64_tr_b16 v[246:247], v12 offset:46080
  v_mfma_f32_16x16x32_bf16 v[128:131], v[224:227], v[164:167], 0
  ds_read_b64_tr_b16 v[248:249], v9 offset:38528
  ds_read_b64_tr_b16 v[250:251], v9 offset:46208
  s_waitcnt lgkmcnt(8)
  v_mfma_f32_16x16x32_bf16 v[132:135], v[228:231], v[164:167], 0
  ds_read_b64_tr_b16 v[252:253], v10 offset:38528
  ds_read_b64_tr_b16 v[254:255], v10 offset:46208
  v_exp_f32 v214, v30
  v_exp_f32 v215, v31
  v_cvt_pk_bf16_f32 v138, v212, v213
  v_cvt_pk_bf16_f32 v139, v214, v215
  v_exp_f32 v196, v24
  v_exp_f32 v197, v25
  v_exp_f32 v198, v26
  v_exp_f32 v199, v27
  v_cvt_pk_bf16_f32 v136, v196, v197
  v_cvt_pk_bf16_f32 v137, v198, v199
  v_mfma_f32_16x16x32_bf16 v[184:187], v[192:195], v[148:151], 0
  ds_read_b64_tr_b16 v[216:217], v11 offset:38528
  ds_read_b64_tr_b16 v[218:219], v11 offset:46208
  v_mfma_f32_16x16x32_bf16 v[184:187], v[192:195], v[144:147], v[184:187]
  ds_read_b64_tr_b16 v[220:221], v12 offset:38528
  ds_read_b64_tr_b16 v[222:223], v12 offset:46208
  v_mfma_f32_16x16x32_bf16 v[184:187], v[192:195], v[140:143], v[184:187]
  v_mfma_f32_16x16x32_bf16 v[184:187], v[192:195], v[136:139], v[184:187]
  s_nop 7
  v_subrev_u32 v23, 813694976, v184
  s_mov_b32 s52, 503316480
  v_cmp_gt_u32 s[48:49], s52, v23
  s_or_b64 s[48:49], s[48:49], s[42:43]
  s_cmp_eq_u64 s[48:49], -1
  s_cbranch_scc0 FB0
FBR0:
  v_mfma_f32_16x16x32_bf16 v[88:91], v[232:235], v[160:163], v[88:91]
  v_rcp_f32 v22, v184
  v_mfma_f32_16x16x32_bf16 v[24:27], v[232:235], v[148:151], 0
  s_waitcnt lgkmcnt(10)
  v_mfma_f32_16x16x32_bf16 v[92:95], v[236:239], v[160:163], v[92:95]
  v_rcp_f32 v23, v188
  v_mfma_f32_16x16x32_bf16 v[28:31], v[236:239], v[148:151], 0
  ds_read_b64_tr_b16 v[224:225], v9 offset:38656
  ds_read_b64_tr_b16 v[226:227], v9 offset:46336
  v_mfma_f32_16x16x32_bf16 v[96:99], v[240:243], v[160:163], v[96:99]
  ds_read_b64_tr_b16 v[228:229], v10 offset:38656
  ds_read_b64_tr_b16 v[230:231], v10 offset:46336
  v_mfma_f32_16x16x32_bf16 v[32:35], v[240:243], v[148:151], 0
  s_waitcnt lgkmcnt(10)
  v_mfma_f32_16x16x32_bf16 v[100:103], v[244:247], v[160:163], v[100:103]
  ds_read_b64_tr_b16 v[232:233], v11 offset:38656
  ds_read_b64_tr_b16 v[234:235], v11 offset:46336
  v_mfma_f32_16x16x32_bf16 v[36:39], v[244:247], v[148:151], 0
  ds_read_b64_tr_b16 v[236:237], v12 offset:38656
  ds_read_b64_tr_b16 v[238:239], v12 offset:46336
  v_mfma_f32_16x16x32_bf16 v[104:107], v[248:251], v[160:163], v[104:107]
  v_mfma_f32_16x16x32_bf16 v[40:43], v[248:251], v[148:151], 0
  s_waitcnt lgkmcnt(10)
  v_mfma_f32_16x16x32_bf16 v[108:111], v[252:255], v[160:163], v[108:111]
  ds_read_b64_tr_b16 v[240:241], v9 offset:23040
  ds_read_b64_tr_b16 v[242:243], v9 offset:30720
  v_mfma_f32_16x16x32_bf16 v[44:47], v[252:255], v[148:151], 0
  ds_read_b64_tr_b16 v[244:245], v10 offset:23040
  ds_read_b64_tr_b16 v[246:247], v10 offset:30720
  v_mfma_f32_16x16x32_bf16 v[112:115], v[216:219], v[160:163], v[112:115]
  v_mfma_f32_16x16x32_bf16 v[48:51], v[216:219], v[148:151], 0
  s_waitcnt lgkmcnt(10)
  v_mfma_f32_16x16x32_bf16 v[116:119], v[220:223], v[160:163], v[116:119]
  ds_read_b64_tr_b16 v[248:249], v11 offset:23040
  ds_read_b64_tr_b16 v[250:251], v11 offset:30720
  v_mfma_f32_16x16x32_bf16 v[52:55], v[220:223], v[148:151], 0
  ds_read_b64_tr_b16 v[252:253], v12 offset:23040
  ds_read_b64_tr_b16 v[254:255], v12 offset:30720
  v_mfma_f32_16x16x32_bf16 v[120:123], v[224:227], v[160:163], v[120:123]
  v_mfma_f32_16x16x32_bf16 v[56:59], v[224:227], v[148:151], 0
  s_waitcnt lgkmcnt(10)
  v_mfma_f32_16x16x32_bf16 v[124:127], v[228:231], v[160:163], v[124:127]
  ds_read_b64_tr_b16 v[216:217], v9 offset:23168
  ds_read_b64_tr_b16 v[218:219], v9 offset:30848
  v_mfma_f32_16x16x32_bf16 v[60:63], v[228:231], v[148:151], 0
  ds_read_b64_tr_b16 v[220:221], v10 offset:23168
  ds_read_b64_tr_b16 v[222:223], v10 offset:30848
  v_mfma_f32_16x16x32_bf16 v[128:131], v[232:235], v[160:163], v[128:131]
  v_mfma_f32_16x16x32_bf16 v[64:67], v[232:235], v[148:151], 0
  s_waitcnt lgkmcnt(10)
  v_mfma_f32_16x16x32_bf16 v[132:135], v[236:239], v[160:163], v[132:135]
  ds_read_b64_tr_b16 v[224:225], v11 offset:23168
  ds_read_b64_tr_b16 v[226:227], v11 offset:30848
  v_mfma_f32_16x16x32_bf16 v[68:71], v[236:239], v[148:151], 0
  ds_read_b64_tr_b16 v[228:229], v12 offset:23168
  ds_read_b64_tr_b16 v[230:231], v12 offset:30848
  s_cbranch_vccz SL52
  s_barrier
  s_mov_b32 s53, 0x400000
NPOLL:
  s_waitcnt vmcnt(0)
  v_readfirstlane_b32 s46, v13
  s_sub_u32 s53, s53, 1
  s_cselect_b32 s46, 144, s46
  s_cmp_ge_u32 s46, 144
  s_cbranch_scc1 NPOLLD
  buffer_load_dword v13, off, s[8:11], 0 sc1
  s_branch NPOLL
NPOLLD:
  s_add_u32 m0, s40, 0
  s_add_u32 s100, s40, 30720
  buffer_load_dwordx4 v1, s[20:23], s100 offen sc1 lds
  s_add_u32 m0, s40, 4096
  s_add_u32 s100, s40, 34816
  buffer_load_dwordx4 v1, s[20:23], s100 offen sc1 lds
  s_min_u32 s51, s40, 1024
  s_add_u32 m0, s51, 8192
  s_add_u32 s100, s51, 38912
  buffer_load_dwordx4 v1, s[20:23], s100 offen sc1 lds
  s_add_u32 m0, s40, 133120
  s_add_u32 s100, s40, 0
  buffer_load_dwordx4 v1, s[20:23], s100 offen sc1 lds
  s_add_u32 m0, s40, 137216
  s_add_u32 s100, s40, 4096
  buffer_load_dwordx4 v1, s[20:23], s100 offen sc1 lds
  s_add_u32 m0, s40, 141312
  s_add_u32 s100, s40, 8192
  buffer_load_dwordx4 v1, s[20:23], s100 offen sc1 lds
  s_add_u32 m0, s40, 145408
  s_add_u32 s100, s40, 12288
  buffer_load_dwordx4 v1, s[20:23], s100 offen sc1 lds
  s_add_u32 m0, s40, 149504
  s_add_u32 s100, s40, 16384
  buffer_load_dwordx4 v1, s[20:23], s100 offen sc1 lds
  s_add_u32 m0, s40, 153600
  s_add_u32 s100, s40, 20480
  buffer_load_dwordx4 v1, s[20:23], s100 offen sc1 lds
  s_add_u32 m0, s40, 157696
  s_add_u32 s100, s40, 24576
  buffer_load_dwordx4 v1, s[20:23], s100 offen sc1 lds
  s_min_u32 s51, s40, 1024
  s_add_u32 m0, s51, 161792
  s_add_u32 s100, s51, 28672
  buffer_load_dwordx4 v1, s[20:23], s100 offen sc1 lds
SL52:
  s_cbranch_vccnz SL53
  s_barrier
SL53:
  v_mfma_f32_16x16x32_bf16 v[88:91], v[240:243], v[156:159], v[88:91]
  v_mfma_f32_16x16x32_bf16 v[24:27], v[240:243], v[144:147], v[24:27]
  s_waitcnt lgkmcnt(10)
  v_mfma_f32_16x16x32_bf16 v[92:95], v[244:247], v[156:159], v[92:95]
  ds_read_b64_tr_b16 v[232:233], v9 offset:23296
  ds_read_b64_tr_b16 v[234:235], v9 offset:30976
  v_mfma_f32_16x16x32_bf16 v[28:31], v[244:247], v[144:147], v[28:31]
  ds_read_b64_tr_b16 v[236:237], v10 offset:23296
  ds_read_b64_tr_b16 v[238:239], v10 offset:30976
  v_mfma_f32_16x16x32_bf16 v[96:99], v[248:251], v[156:159], v[96:99]
  v_mfma_f32_16x16x32_bf16 v[32:35], v[248:251], v[144:147], v[32:35]
  s_waitcnt lgkmcnt(10)
  v_mfma_f32_16x16x32_bf16 v[100:103], v[252:255], v[156:159], v[100:103]
  ds_read_b64_tr_b16 v[240:241], v11 offset:23296
  ds_read_b64_tr_b16 v[242:243], v11 offset:30976
  v_mfma_f32_16x16x32_bf16 v[36:39], v[252:255], v[144:147], v[36:39]
  ds_read_b64_tr_b16 v[244:245], v12 offset:23296
  ds_read_b64_tr_b16 v[246:247], v12 offset:30976
  v_mfma_f32_16x16x32_bf16 v[104:107], v[216:219], v[156:159], v[104:107]
  v_mfma_f32_16x16x32_bf16 v[40:43], v[216:219], v[144:147], v[40:43]
  s_waitcnt lgkmcnt(10)
  v_mfma_f32_16x16x32_bf16 v[108:111], v[220:223], v[156:159], v[108:111]
  ds_read_b64_tr_b16 v[248:249], v9 offset:7680
  ds_read_b64_tr_b16 v[250:251], v9 offset:15360
  v_mfma_f32_16x16x32_bf16 v[44:47], v[220:223], v[144:147], v[44:47]
  ds_read_b64_tr_b16 v[252:253], v10 offset:7680
  ds_read_b64_tr_b16 v[254:255], v10 offset:15360
  v_mfma_f32_16x16x32_bf16 v[112:115], v[224:227], v[156:159], v[112:115]
  v_mfma_f32_16x16x32_bf16 v[48:51], v[224:227], v[144:147], v[48:51]
  s_waitcnt lgkmcnt(10)
  v_mfma_f32_16x16x32_bf16 v[116:119], v[228:231], v[156:159], v[116:119]
  ds_read_b64_tr_b16 v[216:217], v11 offset:7680
  ds_read_b64_tr_b16 v[218:219], v11 offset:15360
  v_mfma_f32_16x16x32_bf16 v[52:55], v[228:231], v[144:147], v[52:55]
  ds_read_b64_tr_b16 v[220:221], v12 offset:7680
  ds_read_b64_tr_b16 v[222:223], v12 offset:15360
  v_mfma_f32_16x16x32_bf16 v[120:123], v[232:235], v[156:159], v[120:123]
  v_mfma_f32_16x16x32_bf16 v[56:59], v[232:235], v[144:147], v[56:59]
  s_waitcnt lgkmcnt(10)
  v_mfma_f32_16x16x32_bf16 v[124:127], v[236:239], v[156:159], v[124:127]
  ds_read_b64_tr_b16 v[224:225], v9 offset:7808
  ds_read_b64_tr_b16 v[226:227], v9 offset:15488
  v_mfma_f32_16x16x32_bf16 v[60:63], v[236:239], v[144:147], v[60:63]
  ds_read_b64_tr_b16 v[228:229], v10 offset:7808
  ds_read_b64_tr_b16 v[230:231], v10 offset:15488
  v_mfma_f32_16x16x32_bf16 v[128:131], v[240:243], v[156:159], v[128:131]
  v_mfma_f32_16x16x32_bf16 v[64:67], v[240:243], v[144:147], v[64:67]
  s_waitcnt lgkmcnt(10)
  v_mfma_f32_16x16x32_bf16 v[132:135], v[244:247], v[156:159], v[132:135]
  ds_read_b64_tr_b16 v[232:233], v11 offset:7808
  ds_read_b64_tr_b16 v[234:235], v11 offset:15488
  v_mfma_f32_16x16x32_bf16 v[68:71], v[244:247], v[144:147], v[68:71]
  ds_read_b64_tr_b16 v[236:237], v12 offset:7808
  ds_read_b64_tr_b16 v[238:239], v12 offset:15488
  v_mfma_f32_16x16x32_bf16 v[88:91], v[248:251], v[152:155], v[88:91]
  v_mfma_f32_16x16x32_bf16 v[24:27], v[248:251], v[140:143], v[24:27]
  s_waitcnt lgkmcnt(10)
  v_mfma_f32_16x16x32_bf16 v[92:95], v[252:255], v[152:155], v[92:95]
  ds_read_b64_tr_b16 v[240:241], v9 offset:7936
  ds_read_b64_tr_b16 v[242:243], v9 offset:15616
  v_mfma_f32_16x16x32_bf16 v[28:31], v[252:255], v[140:143], v[28:31]
  ds_read_b64_tr_b16 v[244:245], v10 offset:7936
  ds_read_b64_tr_b16 v[246:247], v10 offset:15616
  v_mfma_f32_16x16x32_bf16 v[96:99], v[216:219], v[152:155], v[96:99]
  v_cvt_pk_bf16_f32 v156, v88, v89
  v_cvt_pk_bf16_f32 v157, v90, v91
  v_mfma_f32_16x16x32_bf16 v[32:35], v[216:219], v[140:143], v[32:35]
  v_cvt_pk_bf16_f32 v158, v92, v93
  s_waitcnt lgkmcnt(10)
  v_mfma_f32_16x16x32_bf16 v[100:103], v[220:223], v[152:155], v[100:103]
  ds_read_b64_tr_b16 v[248:249], v11 offset:7936
  ds_read_b64_tr_b16 v[250:251], v11 offset:15616
  v_mfma_f32_16x16x32_bf16 v[36:39], v[220:223], v[140:143], v[36:39]
  ds_read_b64_tr_b16 v[252:253], v12 offset:7936
  ds_read_b64_tr_b16 v[254:255], v12 offset:15616
  v_mfma_f32_16x16x32_bf16 v[104:107], v[224:227], v[152:155], v[104:107]
  v_cvt_pk_bf16_f32 v159, v94, v95
  v_cvt_pk_bf16_f32 v160, v96, v97
  v_mfma_f32_16x16x32_bf16 v[40:43], v[224:227], v[140:143], v[40:43]
  v_cvt_pk_bf16_f32 v161, v98, v99
  s_waitcnt lgkmcnt(10)
  v_mfma_f32_16x16x32_bf16 v[108:111], v[228:231], v[152:155], v[108:111]
  ds_read_b64_tr_b16 v[216:217], v15 offset:0
  ds_read_b64_tr_b16 v[218:219], v9 offset:0
  v_mfma_f32_16x16x32_bf16 v[44:47], v[228:231], v[140:143], v[44:47]
  ds_read_b64_tr_b16 v[220:221], v16 offset:0
  ds_read_b64_tr_b16 v[222:223], v10 offset:0
  v_mfma_f32_16x16x32_bf16 v[112:115], v[232:235], v[152:155], v[112:115]
  v_cvt_pk_bf16_f32 v162, v100, v101
  v_cvt_pk_bf16_f32 v163, v102, v103
  v_mfma_f32_16x16x32_bf16 v[48:51], v[232:235], v[140:143], v[48:51]
  v_cvt_pk_bf16_f32 v164, v104, v105
  s_waitcnt lgkmcnt(10)
  v_mfma_f32_16x16x32_bf16 v[116:119], v[236:239], v[152:155], v[116:119]
  ds_read_b64_tr_b16 v[224:225], v17 offset:0
  ds_read_b64_tr_b16 v[226:227], v11 offset:0
  v_mfma_f32_16x16x32_bf16 v[52:55], v[236:239], v[140:143], v[52:55]
  ds_read_b64_tr_b16 v[228:229], v18 offset:0
  ds_read_b64_tr_b16 v[230:231], v12 offset:0
  v_mfma_f32_16x16x32_bf16 v[120:123], v[240:243], v[152:155], v[120:123]
  v_cvt_pk_bf16_f32 v165, v106, v107
  v_cvt_pk_bf16_f32 v166, v108, v109
  v_mfma_f32_16x16x32_bf16 v[56:59], v[240:243], v[140:143], v[56:59]
  v_cvt_pk_bf16_f32 v167, v110, v111
  s_waitcnt lgkmcnt(10)
  v_mfma_f32_16x16x32_bf16 v[124:127], v[244:247], v[152:155], v[124:127]
  ds_read_b64_tr_b16 v[232:233], v15 offset:128
  ds_read_b64_tr_b16 v[234:235], v9 offset:128
  v_mfma_f32_16x16x32_bf16 v[60:63], v[244:247], v[140:143], v[60:63]
  ds_read_b64_tr_b16 v[236:237], v16 offset:128
  ds_read_b64_tr_b16 v[238:239], v10 offset:128
  v_mfma_f32_16x16x32_bf16 v[128:131], v[248:251], v[152:155], v[128:131]
  v_cvt_pk_bf16_f32 v176, v112, v113
  v_cvt_pk_bf16_f32 v177, v114, v115
  v_mfma_f32_16x16x32_bf16 v[64:67], v[248:251], v[140:143], v[64:67]
  v_cvt_pk_bf16_f32 v178, v116, v117
  s_waitcnt lgkmcnt(10)
  v_mfma_f32_16x16x32_bf16 v[132:135], v[252:255], v[152:155], v[132:135]
  ds_read_b64_tr_b16 v[240:241], v17 offset:128
  ds_read_b64_tr_b16 v[242:243], v11 offset:128
  v_mfma_f32_16x16x32_bf16 v[68:71], v[252:255], v[140:143], v[68:71]
  ds_read_b64_tr_b16 v[244:245], v18 offset:128
  ds_read_b64_tr_b16 v[246:247], v12 offset:128
  v_mfma_f32_16x16x32_bf16 v[24:27], v[216:219], v[136:139], v[24:27]
  v_cvt_pk_bf16_f32 v179, v118, v119
  s_waitcnt lgkmcnt(10)
  v_mfma_f32_16x16x32_bf16 v[28:31], v[220:223], v[136:139], v[28:31]
  ds_read_b64_tr_b16 v[248:249], v15 offset:256
  ds_read_b64_tr_b16 v[250:251], v9 offset:256
  v_mfma_f32_16x16x32_bf16 v[32:35], v[224:227], v[136:139], v[32:35]
  ds_read_b64_tr_b16 v[252:253], v16 offset:256
  ds_read_b64_tr_b16 v[254:255], v10 offset:256
  s_waitcnt lgkmcnt(10)
  v_mfma_f32_16x16x32_bf16 v[36:39], v[228:231], v[136:139], v[36:39]
  ds_read_b64_tr_b16 v[216:217], v17 offset:256
  ds_read_b64_tr_b16 v[218:219], v11 offset:256
  v_mfma_f32_16x16x32_bf16 v[40:43], v[232:235], v[136:139], v[40:43]
  ds_read_b64_tr_b16 v[220:221], v18 offset:256
  ds_read_b64_tr_b16 v[222:223], v12 offset:256
  s_waitcnt lgkmcnt(10)
  v_mfma_f32_16x16x32_bf16 v[44:47], v[236:239], v[136:139], v[44:47]
  v_cvt_pk_bf16_f32 v180, v120, v121
  v_cvt_pk_bf16_f32 v181, v122, v123
  s_waitcnt lgkmcnt(0)
  s_cbranch_vccz SL54
  s_waitcnt vmcnt(0)
  s_barrier
  s_add_u32 m0, s40, 102400
  s_add_u32 s100, s40, 40960
  buffer_load_dwordx4 v1, s[20:23], s100 offen sc1 lds
  s_add_u32 m0, s40, 106496
  s_add_u32 s100, s40, 45056
  buffer_load_dwordx4 v1, s[20:23], s100 offen sc1 lds
  s_add_u32 m0, s40, 110592
  s_add_u32 s100, s40, 49152
  buffer_load_dwordx4 v1, s[20:23], s100 offen sc1 lds
  s_add_u32 m0, s40, 114688
  s_add_u32 s100, s40, 53248
  buffer_load_dwordx4 v1, s[20:23], s100 offen sc1 lds
  s_add_u32 m0, s40, 118784
  s_add_u32 s100, s40, 57344
  buffer_load_dwordx4 v1, s[20:23], s100 offen sc1 lds
  s_add_u32 m0, s40, 122880
  s_add_u32 s100, s40, 61440
  buffer_load_dwordx4 v1, s[20:23], s100 offen sc1 lds
  s_add_u32 m0, s40, 126976
  s_add_u32 s100, s40, 65536
  buffer_load_dwordx4 v1, s[20:23], s100 offen sc1 lds
  s_min_u32 s51, s40, 1024
  s_add_u32 m0, s51, 131072
  s_add_u32 s100, s51, 69632
  buffer_load_dwordx4 v1, s[20:23], s100 offen sc1 lds
SL54:
  ds_read_b128 v[224:227], v2 offset:30720
  ds_read_b128 v[228:231], v2 offset:31744
  ds_read_b128 v[232:235], v2 offset:32768
  ds_read_b128 v[236:239], v2 offset:33792
  v_mfma_f32_16x16x32_bf16 v[48:51], v[240:243], v[136:139], v[48:51]
  ds_read_b128 v[240:243], v2 offset:34816
  v_cvt_pk_bf16_f32 v182, v124, v125
  v_mfma_f32_16x16x32_bf16 v[52:55], v[244:247], v[136:139], v[52:55]
  ds_read_b128 v[244:247], v2 offset:35840
  v_cvt_pk_bf16_f32 v183, v126, v127
  v_mfma_f32_16x16x32_bf16 v[56:59], v[248:251], v[136:139], v[56:59]
  ds_read_b128 v[248:251], v2 offset:36864
  v_cvt_pk_bf16_f32 v72, v128, v129
  v_mfma_f32_16x16x32_bf16 v[60:63], v[252:255], v[136:139], v[60:63]
  ds_read_b128 v[252:255], v2 offset:37888
  v_cvt_pk_bf16_f32 v73, v130, v131
  v_mfma_f32_16x16x32_bf16 v[64:67], v[216:219], v[136:139], v[64:67]
  ds_read_b128 v[216:219], v2 offset:38912
  v_cvt_pk_bf16_f32 v74, v132, v133
  v_mfma_f32_16x16x32_bf16 v[68:71], v[220:223], v[136:139], v[68:71]
  ds_read_b128 v[220:223], v2 offset:39936
  v_cvt_pk_bf16_f32 v75, v134, v135
  v_cvt_pk_bf16_f32 v140, v24, v25
  v_cvt_pk_bf16_f32 v141, v26, v27
  v_cvt_pk_bf16_f32 v142, v28, v29
  v_cvt_pk_bf16_f32 v143, v30, v31
  s_waitcnt lgkmcnt(8)
  s_nop 0
  v_mfma_f32_16x16x32_bf16 v[184:187], v[224:227], v[140:143], 0
  v_cvt_pk_bf16_f32 v144, v32, v33
  v_cvt_pk_bf16_f32 v145, v34, v35
  v_mfma_f32_16x16x32_bf16 v[192:195], v[224:227], v[156:159], 0
  ds_read_b128 v[224:227], v2 offset:40960
  v_cvt_pk_bf16_f32 v146, v36, v37
  v_mfma_f32_16x16x32_bf16 v[188:191], v[228:231], v[140:143], 0
  v_cvt_pk_bf16_f32 v147, v38, v39
  v_cvt_pk_bf16_f32 v148, v40, v41
  v_mfma_f32_16x16x32_bf16 v[196:199], v[228:231], v[156:159], 0
  ds_read_b128 v[228:231], v2 offset:41984
  s_waitcnt lgkmcnt(8)
  v_mfma_f32_16x16x32_bf16 v[184:187], v[232:235], v[144:147], v[184:187]
  v_cvt_pk_bf16_f32 v149, v42, v43
  v_cvt_pk_bf16_f32 v150, v44, v45
  v_mfma_f32_16x16x32_bf16 v[192:195], v[232:235], v[160:163], v[192:195]
  ds_read_b128 v[232:235], v2 offset:43008
  v_cvt_pk_bf16_f32 v151, v46, v47
  v_mfma_f32_16x16x32_bf16 v[188:191], v[236:239], v[144:147], v[188:191]
  v_cvt_pk_bf16_f32 v168, v48, v49
  v_cvt_pk_bf16_f32 v169, v50, v51
  v_mfma_f32_16x16x32_bf16 v[196:199], v[236:239], v[160:163], v[196:199]
  ds_read_b128 v[236:239], v2 offset:44032
  s_waitcnt lgkmcnt(8)
  v_mfma_f32_16x16x32_bf16 v[184:187], v[240:243], v[148:151], v[184:187]
  v_cvt_pk_bf16_f32 v170, v52, v53
  v_cvt_pk_bf16_f32 v171, v54, v55
  v_mfma_f32_16x16x32_bf16 v[192:195], v[240:243], v[164:167], v[192:195]
  ds_read_b128 v[240:243], v2 offset:45056
  v_cvt_pk_bf16_f32 v172, v56, v57
  v_mfma_f32_16x16x32_bf16 v[188:191], v[244:247], v[148:151], v[188:191]
  v_cvt_pk_bf16_f32 v173, v58, v59
  v_cvt_pk_bf16_f32 v174, v60, v61
  v_mfma_f32_16x16x32_bf16 v[196:199], v[244:247], v[164:167], v[196:199]
  ds_read_b128 v[244:247], v2 offset:46080
  s_waitcnt lgkmcnt(8)
  v_mfma_f32_16x16x32_bf16 v[184:187], v[248:251], v[168:171], v[184:187]
  v_cvt_pk_bf16_f32 v175, v62, v63
  v_cvt_pk_bf16_f32 v152, v64, v65
  v_mfma_f32_16x16x32_bf16 v[192:195], v[248:251], v[176:179], v[192:195]
  ds_read_b128 v[248:251], v2 offset:47104
  v_cvt_pk_bf16_f32 v153, v66, v67
  v_mfma_f32_16x16x32_bf16 v[188:191], v[252:255], v[168:171], v[188:191]
  v_cvt_pk_bf16_f32 v154, v68, v69
  v_cvt_pk_bf16_f32 v155, v70, v71
  v_mfma_f32_16x16x32_bf16 v[196:199], v[252:255], v[176:179], v[196:199]
  ds_read_b128 v[252:255], v2 offset:48128
  s_waitcnt lgkmcnt(8)
  v_mfma_f32_16x16x32_bf16 v[184:187], v[216:219], v[172:175], v[184:187]
  v_mfma_f32_16x16x32_bf16 v[192:195], v[216:219], v[180:183], v[192:195]
  ds_read_b128 v[216:219], v2 offset:49152
  v_mfma_f32_16x16x32_bf16 v[188:191], v[220:223], v[172:175], v[188:191]
  v_mfma_f32_16x16x32_bf16 v[196:199], v[220:223], v[180:183], v[196:199]
  ds_read_b128 v[220:223], v2 offset:50176
  s_waitcnt lgkmcnt(8)
  v_mfma_f32_16x16x32_bf16 v[184:187], v[224:227], v[152:155], v[184:187]
  v_mfma_f32_16x16x32_bf16 v[192:195], v[224:227], v[72:75], v[192:195]
  ds_read_b128 v[224:227], v2 offset:51200
  v_mfma_f32_16x16x32_bf16 v[188:191], v[228:231], v[152:155], v[188:191]
  v_mfma_f32_16x16x32_bf16 v[196:199], v[228:231], v[72:75], v[196:199]
  ds_read_b128 v[228:231], v2 offset:52224
  s_mov_b32 s100, 71680
  buffer_load_dwordx4 v[40:43], v1, s[20:23], s100 offen offset:0 sc1
  buffer_load_dwordx4 v[44:47], v1, s[20:23], s100 offen offset:1024 sc1
  s_waitcnt lgkmcnt(8)
  v_mfma_f32_16x16x32_bf16 v[200:203], v[232:235], v[140:143], 0
  v_mul_f32 v184, v184, v22
  v_mul_f32 v185, v185, v22
  v_mfma_f32_16x16x32_bf16 v[208:211], v[232:235], v[156:159], 0
  ds_read_b128 v[232:235], v2 offset:53248
  v_mul_f32 v186, v186, v22
  v_mfma_f32_16x16x32_bf16 v[204:207], v[236:239], v[140:143], 0
  v_mul_f32 v187, v187, v22
  v_mul_f32 v188, v188, v22
  v_mfma_f32_16x16x32_bf16 v[212:215], v[236:239], v[156:159], 0
  ds_read_b128 v[236:239], v2 offset:54272
  s_waitcnt lgkmcnt(8)
  v_mfma_f32_16x16x32_bf16 v[200:203], v[240:243], v[144:147], v[200:203]
  v_mul_f32 v189, v189, v22
  v_mul_f32 v190, v190, v22
  v_mfma_f32_16x16x32_bf16 v[208:211], v[240:243], v[160:163], v[208:211]
  ds_read_b128 v[240:243], v2 offset:55296
  v_mul_f32 v191, v191, v22
  v_mfma_f32_16x16x32_bf16 v[204:207], v[244:247], v[144:147], v[204:207]
  v_cvt_pk_bf16_f32 v24, v184, v185
  v_cvt_pk_bf16_f32 v25, v186, v187
  v_mfma_f32_16x16x32_bf16 v[212:215], v[244:247], v[160:163], v[212:215]
  ds_read_b128 v[244:247], v2 offset:56320
  s_waitcnt lgkmcnt(8)
  v_mfma_f32_16x16x32_bf16 v[200:203], v[248:251], v[148:151], v[200:203]
  v_cvt_pk_bf16_f32 v26, v188, v189
  v_cvt_pk_bf16_f32 v27, v190, v191
  v_mfma_f32_16x16x32_bf16 v[208:211], v[248:251], v[164:167], v[208:211]
  buffer_store_dwordx4 v[24:27], v5, s[16:19], 0 offen offset:0 nt sc1
  v_mul_f32 v192, v192, v23
  v_mfma_f32_16x16x32_bf16 v[204:207], v[252:255], v[148:151], v[204:207]
  ds_read_b128 v[248:251], v2 offset:57344
  v_mul_f32 v193, v193, v23
  v_mfma_f32_16x16x32_bf16 v[212:215], v[252:255], v[164:167], v[212:215]
  ds_read_b128 v[252:255], v2 offset:58368
  s_waitcnt lgkmcnt(8)
  v_mfma_f32_16x16x32_bf16 v[200:203], v[216:219], v[168:171], v[200:203]
  v_mul_f32 v194, v194, v23
  v_mul_f32 v195, v195, v23
  v_mfma_f32_16x16x32_bf16 v[208:211], v[216:219], v[176:179], v[208:211]
  ds_read_b128 v[216:219], v2 offset:59392
  v_mul_f32 v196, v196, v23
  v_mfma_f32_16x16x32_bf16 v[204:207], v[220:223], v[168:171], v[204:207]
  v_mul_f32 v197, v197, v23
  v_mul_f32 v198, v198, v23
  v_mfma_f32_16x16x32_bf16 v[212:215], v[220:223], v[176:179], v[212:215]
  ds_read_b128 v[220:223], v2 offset:60416
  s_waitcnt lgkmcnt(8)
  v_mfma_f32_16x16x32_bf16 v[200:203], v[224:227], v[172:175], v[200:203]
  v_mul_f32 v199, v199, v23
  v_cvt_pk_bf16_f32 v28, v192, v193
  v_mfma_f32_16x16x32_bf16 v[208:211], v[224:227], v[180:183], v[208:211]
  ds_read_b128 v[224:227], v1 offset:0
  v_cvt_pk_bf16_f32 v29, v194, v195
  v_mfma_f32_16x16x32_bf16 v[204:207], v[228:231], v[172:175], v[204:207]
  v_cvt_pk_bf16_f32 v30, v196, v197
  v_cvt_pk_bf16_f32 v31, v198, v199
  v_mfma_f32_16x16x32_bf16 v[212:215], v[228:231], v[180:183], v[212:215]
  buffer_store_dwordx4 v[28:31], v6, s[16:19], 0 offen offset:0 nt sc1
  s_waitcnt lgkmcnt(7)
  v_mfma_f32_16x16x32_bf16 v[200:203], v[232:235], v[152:155], v[200:203]
  ds_read_b128 v[228:231], v1 offset:1024
  v_mfma_f32_16x16x32_bf16 v[208:211], v[232:235], v[72:75], v[208:211]
  ds_read_b128 v[232:235], v1 offset:2048
  v_mfma_f32_16x16x32_bf16 v[204:207], v[236:239], v[152:155], v[204:207]
  v_mfma_f32_16x16x32_bf16 v[212:215], v[236:239], v[72:75], v[212:215]
  ds_read_b128 v[236:239], v1 offset:3072
  s_cbranch_vccz SL55
  s_waitcnt vmcnt(4)
  s_barrier
SL55:
  s_waitcnt lgkmcnt(8)
  v_mfma_f32_16x16x32_bf16 v[184:187], v[240:243], v[140:143], 0
  v_mul_f32 v200, v200, v22
  v_mul_f32 v201, v201, v22
  v_mfma_f32_16x16x32_bf16 v[192:195], v[240:243], v[156:159], 0
  ds_read_b128 v[240:243], v1 offset:4096
  v_mul_f32 v202, v202, v22
  v_mfma_f32_16x16x32_bf16 v[188:191], v[244:247], v[140:143], 0
  v_mul_f32 v203, v203, v22
  v_mul_f32 v204, v204, v22
  v_mfma_f32_16x16x32_bf16 v[196:199], v[244:247], v[156:159], 0
  ds_read_b128 v[244:247], v1 offset:5120
  s_waitcnt lgkmcnt(8)
  v_mfma_f32_16x16x32_bf16 v[184:187], v[248:251], v[144:147], v[184:187]
  v_mul_f32 v205, v205, v22
  v_mul_f32 v206, v206, v22
  v_mfma_f32_16x16x32_bf16 v[192:195], v[248:251], v[160:163], v[192:195]
  ds_read_b128 v[248:251], v1 offset:6144
  v_mul_f32 v207, v207, v22
  v_mfma_f32_16x16x32_bf16 v[188:191], v[252:255], v[144:147], v[188:191]
  v_cvt_pk_bf16_f32 v32, v200, v201
  v_cvt_pk_bf16_f32 v33, v202, v203
  v_mfma_f32_16x16x32_bf16 v[196:199], v[252:255], v[160:163], v[196:199]
  ds_read_b128 v[252:255], v1 offset:7168
  s_waitcnt lgkmcnt(8)
  v_mfma_f32_16x16x32_bf16 v[184:187], v[216:219], v[148:151], v[184:187]
  v_cvt_pk_bf16_f32 v34, v204, v205
  v_cvt_pk_bf16_f32 v35, v206, v207
  v_mfma_f32_16x16x32_bf16 v[192:195], v[216:219], v[164:167], v[192:195]
  buffer_store_dwordx4 v[32:35], v5, s[16:19], 0 offen offset:64 nt sc1
  v_mul_f32 v208, v208, v23
  v_mfma_f32_16x16x32_bf16 v[188:191], v[220:223], v[148:151], v[188:191]
  ds_read_b128 v[216:219], v1 offset:8192
  v_mul_f32 v209, v209, v23
  v_mfma_f32_16x16x32_bf16 v[196:199], v[220:223], v[164:167], v[196:199]
  ds_read_b128 v[220:223], v1 offset:9216
  s_waitcnt lgkmcnt(8)
  v_mfma_f32_16x16x32_bf16 v[184:187], v[224:227], v[168:171], v[184:187]
  v_mul_f32 v210, v210, v23
  v_mul_f32 v211, v211, v23
  v_mfma_f32_16x16x32_bf16 v[192:195], v[224:227], v[176:179], v[192:195]
  ds_read_b128 v[224:227], v2 offset:0
  v_mul_f32 v212, v212, v23
  v_mfma_f32_16x16x32_bf16 v[188:191], v[228:231], v[168:171], v[188:191]
  v_mul_f32 v213, v213, v23
  v_mul_f32 v214, v214, v23
  v_mfma_f32_16x16x32_bf16 v[196:199], v[228:231], v[176:179], v[196:199]
  ds_read_b128 v[228:231], v2 offset:1024
  s_waitcnt lgkmcnt(8)
  v_mfma_f32_16x16x32_bf16 v[184:187], v[232:235], v[172:175], v[184:187]
  v_mul_f32 v215, v215, v23
  v_cvt_pk_bf16_f32 v36, v208, v209
  v_mfma_f32_16x16x32_bf16 v[192:195], v[232:235], v[180:183], v[192:195]
  ds_read_b128 v[232:235], v2 offset:2048
  v_cvt_pk_bf16_f32 v37, v210, v211
  v_mfma_f32_16x16x32_bf16 v[188:191], v[236:239], v[172:175], v[188:191]
  v_cvt_pk_bf16_f32 v38, v212, v213
  v_cvt_pk_bf16_f32 v39, v214, v215
  v_mfma_f32_16x16x32_bf16 v[196:199], v[236:239], v[180:183], v[196:199]
  buffer_store_dwordx4 v[36:39], v6, s[16:19], 0 offen offset:64 nt sc1
  s_waitcnt lgkmcnt(7)
  v_mfma_f32_16x16x32_bf16 v[184:187], v[240:243], v[152:155], v[184:187]
  ds_read_b128 v[236:239], v2 offset:3072
  v_mfma_f32_16x16x32_bf16 v[192:195], v[240:243], v[72:75], v[192:195]
  ds_read_b128 v[240:243], v2 offset:4096
  v_mfma_f32_16x16x32_bf16 v[188:191], v[244:247], v[152:155], v[188:191]
  v_mfma_f32_16x16x32_bf16 v[196:199], v[244:247], v[72:75], v[196:199]
  ds_read_b128 v[244:247], v2 offset:5120
  s_waitcnt lgkmcnt(8)
  v_mfma_f32_16x16x32_bf16 v[200:203], v[248:251], v[140:143], 0
  v_mul_f32 v184, v184, v22
  v_mul_f32 v185, v185, v22
  v_mfma_f32_16x16x32_bf16 v[208:211], v[248:251], v[156:159], 0
  ds_read_b128 v[248:251], v2 offset:6144
  v_mul_f32 v186, v186, v22
  v_mfma_f32_16x16x32_bf16 v[204:207], v[252:255], v[140:143], 0
  v_mul_f32 v187, v187, v22
  v_mul_f32 v188, v188, v22
  v_mfma_f32_16x16x32_bf16 v[212:215], v[252:255], v[156:159], 0
  ds_read_b128 v[252:255], v2 offset:7168
  s_waitcnt lgkmcnt(8)
  v_mfma_f32_16x16x32_bf16 v[200:203], v[216:219], v[144:147], v[200:203]
  v_mul_f32 v189, v189, v22
  v_mul_f32 v190, v190, v22
  v_mfma_f32_16x16x32_bf16 v[208:211], v[216:219], v[160:163], v[208:211]
  ds_read_b128 v[216:219], v2 offset:8192
  v_mul_f32 v191, v191, v22
  v_mfma_f32_16x16x32_bf16 v[204:207], v[220:223], v[144:147], v[204:207]
  v_cvt_pk_bf16_f32 v24, v184, v185
  v_cvt_pk_bf16_f32 v25, v186, v187
  v_mfma_f32_16x16x32_bf16 v[212:215], v[220:223], v[160:163], v[212:215]
  ds_read_b128 v[220:223], v2 offset:9216
  s_waitcnt lgkmcnt(8)
  v_mfma_f32_16x16x32_bf16 v[200:203], v[224:227], v[148:151], v[200:203]
  v_cvt_pk_bf16_f32 v26, v188, v189
  v_cvt_pk_bf16_f32 v27, v190, v191
  v_mfma_f32_16x16x32_bf16 v[208:211], v[224:227], v[164:167], v[208:211]
  buffer_store_dwordx4 v[24:27], v5, s[16:19], 0 offen offset:128 nt sc1
  v_mul_f32 v192, v192, v23
  v_mfma_f32_16x16x32_bf16 v[204:207], v[228:231], v[148:151], v[204:207]
  ds_read_b128 v[224:227], v2 offset:10240
  v_mul_f32 v193, v193, v23
  v_mfma_f32_16x16x32_bf16 v[212:215], v[228:231], v[164:167], v[212:215]
  ds_read_b128 v[228:231], v2 offset:11264
  s_waitcnt lgkmcnt(8)
  v_mfma_f32_16x16x32_bf16 v[200:203], v[232:235], v[168:171], v[200:203]
  v_mul_f32 v194, v194, v23
  v_mul_f32 v195, v195, v23
  v_mfma_f32_16x16x32_bf16 v[208:211], v[232:235], v[176:179], v[208:211]
  ds_read_b128 v[232:235], v2 offset:12288
  v_mul_f32 v196, v196, v23
  v_mfma_f32_16x16x32_bf16 v[204:207], v[236:239], v[168:171], v[204:207]
  v_mul_f32 v197, v197, v23
  v_mul_f32 v198, v198, v23
  v_mfma_f32_16x16x32_bf16 v[212:215], v[236:239], v[176:179], v[212:215]
  ds_read_b128 v[236:239], v2 offset:13312
  s_waitcnt lgkmcnt(8)
  v_mfma_f32_16x16x32_bf16 v[200:203], v[240:243], v[172:175], v[200:203]
  v_mul_f32 v199, v199, v23
  v_cvt_pk_bf16_f32 v28, v192, v193
  v_mfma_f32_16x16x32_bf16 v[208:211], v[240:243], v[180:183], v[208:211]
  ds_read_b128 v[240:243], v2 offset:14336
  v_cvt_pk_bf16_f32 v29, v194, v195
  v_mfma_f32_16x16x32_bf16 v[204:207], v[244:247], v[172:175], v[204:207]
  v_cvt_pk_bf16_f32 v30, v196, v197
  v_cvt_pk_bf16_f32 v31, v198, v199
  v_mfma_f32_16x16x32_bf16 v[212:215], v[244:247], v[180:183], v[212:215]
  buffer_store_dwordx4 v[28:31], v6, s[16:19], 0 offen offset:128 nt sc1
  s_waitcnt lgkmcnt(7)
  v_mfma_f32_16x16x32_bf16 v[200:203], v[248:251], v[152:155], v[200:203]
  ds_read_b128 v[244:247], v2 offset:15360
  v_mfma_f32_16x16x32_bf16 v[208:211], v[248:251], v[72:75], v[208:211]
  ds_read_b128 v[248:251], v2 offset:16384
  v_mfma_f32_16x16x32_bf16 v[204:207], v[252:255], v[152:155], v[204:207]
  v_mfma_f32_16x16x32_bf16 v[212:215], v[252:255], v[72:75], v[212:215]
  ds_read_b128 v[252:255], v2 offset:17408
  s_waitcnt lgkmcnt(8)
  v_mfma_f32_16x16x32_bf16 v[184:187], v[216:219], v[140:143], 0
  v_mul_f32 v200, v200, v22
  v_mul_f32 v201, v201, v22
  v_mfma_f32_16x16x32_bf16 v[192:195], v[216:219], v[156:159], 0
  ds_read_b128 v[216:219], v2 offset:18432
  v_mul_f32 v202, v202, v22
  v_mfma_f32_16x16x32_bf16 v[188:191], v[220:223], v[140:143], 0
  v_mul_f32 v203, v203, v22
  v_mul_f32 v204, v204, v22
  v_mfma_f32_16x16x32_bf16 v[196:199], v[220:223], v[156:159], 0
  ds_read_b128 v[220:223], v2 offset:19456
  s_waitcnt lgkmcnt(8)
  v_mfma_f32_16x16x32_bf16 v[184:187], v[224:227], v[144:147], v[184:187]
  v_mul_f32 v205, v205, v22
  v_mul_f32 v206, v206, v22
  v_mfma_f32_16x16x32_bf16 v[192:195], v[224:227], v[160:163], v[192:195]
  ds_read_b128 v[224:227], v2 offset:20480
  v_mul_f32 v207, v207, v22
  v_mfma_f32_16x16x32_bf16 v[188:191], v[228:231], v[144:147], v[188:191]
  v_cvt_pk_bf16_f32 v32, v200, v201
  v_cvt_pk_bf16_f32 v33, v202, v203
  v_mfma_f32_16x16x32_bf16 v[196:199], v[228:231], v[160:163], v[196:199]
  ds_read_b128 v[228:231], v2 offset:21504
  s_waitcnt lgkmcnt(8)
  v_mfma_f32_16x16x32_bf16 v[184:187], v[232:235], v[148:151], v[184:187]
  v_cvt_pk_bf16_f32 v34, v204, v205
  v_cvt_pk_bf16_f32 v35, v206, v207
  v_mfma_f32_16x16x32_bf16 v[192:195], v[232:235], v[164:167], v[192:195]
  buffer_store_dwordx4 v[32:35], v5, s[16:19], 0 offen offset:192 nt sc1
  v_mul_f32 v208, v208, v23
  v_mfma_f32_16x16x32_bf16 v[188:191], v[236:239], v[148:151], v[188:191]
  ds_read_b128 v[232:235], v2 offset:22528
  v_mul_f32 v209, v209, v23
  v_mfma_f32_16x16x32_bf16 v[196:199], v[236:239], v[164:167], v[196:199]
  ds_read_b128 v[236:239], v2 offset:23552
  s_waitcnt lgkmcnt(8)
  v_mfma_f32_16x16x32_bf16 v[184:187], v[240:243], v[168:171], v[184:187]
  v_mul_f32 v210, v210, v23
  v_mul_f32 v211, v211, v23
  v_mfma_f32_16x16x32_bf16 v[192:195], v[240:243], v[176:179], v[192:195]
  ds_read_b128 v[240:243], v2 offset:24576
  v_mul_f32 v212, v212, v23
  v_mfma_f32_16x16x32_bf16 v[188:191], v[244:247], v[168:171], v[188:191]
  v_mul_f32 v213, v213, v23
  v_mul_f32 v214, v214, v23
  v_mfma_f32_16x16x32_bf16 v[196:199], v[244:247], v[176:179], v[196:199]
  ds_read_b128 v[244:247], v2 offset:25600
  s_waitcnt lgkmcnt(8)
  v_mfma_f32_16x16x32_bf16 v[184:187], v[248:251], v[172:175], v[184:187]
  v_mul_f32 v215, v215, v23
  v_cvt_pk_bf16_f32 v36, v208, v209
  v_mfma_f32_16x16x32_bf16 v[192:195], v[248:251], v[180:183], v[192:195]
  ds_read_b128 v[248:251], v2 offset:26624
  v_cvt_pk_bf16_f32 v37, v210, v211
  v_mfma_f32_16x16x32_bf16 v[188:191], v[252:255], v[172:175], v[188:191]
  v_cvt_pk_bf16_f32 v38, v212, v213
  v_cvt_pk_bf16_f32 v39, v214, v215
  v_mfma_f32_16x16x32_bf16 v[196:199], v[252:255], v[180:183], v[196:199]
  buffer_store_dwordx4 v[36:39], v6, s[16:19], 0 offen offset:192 nt sc1
  s_waitcnt lgkmcnt(7)
  v_mfma_f32_16x16x32_bf16 v[184:187], v[216:219], v[152:155], v[184:187]
  ds_read_b128 v[252:255], v2 offset:27648
  v_mfma_f32_16x16x32_bf16 v[192:195], v[216:219], v[72:75], v[192:195]
  ds_read_b128 v[216:219], v2 offset:28672
  v_mfma_f32_16x16x32_bf16 v[188:191], v[220:223], v[152:155], v[188:191]
  v_mfma_f32_16x16x32_bf16 v[196:199], v[220:223], v[72:75], v[196:199]
  ds_read_b128 v[220:223], v2 offset:29696
  s_waitcnt vmcnt(8)
  s_waitcnt lgkmcnt(8)
  v_mfma_f32_16x16x32_bf16 v[200:203], v[224:227], v[140:143], 0
  v_mul_f32 v184, v184, v22
  v_mul_f32 v185, v185, v22
  v_mfma_f32_16x16x32_bf16 v[208:211], v[224:227], v[156:159], 0
  v_mul_f32 v186, v186, v22
  v_mul_f32 v187, v187, v22
  v_mfma_f32_16x16x32_bf16 v[204:207], v[228:231], v[140:143], 0
  v_mul_f32 v188, v188, v22
  v_mul_f32 v189, v189, v22
  v_mfma_f32_16x16x32_bf16 v[212:215], v[228:231], v[156:159], 0
  v_mul_f32 v190, v190, v22
  s_waitcnt lgkmcnt(6)
  v_mfma_f32_16x16x32_bf16 v[200:203], v[232:235], v[144:147], v[200:203]
  v_mul_f32 v191, v191, v22
  v_cvt_pk_bf16_f32 v24, v184, v185
  v_mfma_f32_16x16x32_bf16 v[208:211], v[232:235], v[160:163], v[208:211]
  v_cvt_pk_bf16_f32 v25, v186, v187
  v_cvt_pk_bf16_f32 v26, v188, v189
  v_mfma_f32_16x16x32_bf16 v[204:207], v[236:239], v[144:147], v[204:207]
  v_cvt_pk_bf16_f32 v27, v190, v191
  v_mul_f32 v192, v192, v23
  v_mfma_f32_16x16x32_bf16 v[212:215], v[236:239], v[160:163], v[212:215]
  buffer_store_dwordx4 v[24:27], v5, s[16:19], 0 offen offset:256 nt sc1
  v_mul_f32 v193, v193, v23
  s_waitcnt lgkmcnt(5)
  v_mfma_f32_16x16x32_bf16 v[200:203], v[240:243], v[148:151], v[200:203]
  v_mul_f32 v194, v194, v23
  v_mul_f32 v195, v195, v23
  v_mfma_f32_16x16x32_bf16 v[208:211], v[240:243], v[164:167], v[208:211]
  v_mul_f32 v196, v196, v23
  s_waitcnt lgkmcnt(4)
  v_mfma_f32_16x16x32_bf16 v[204:207], v[244:247], v[148:151], v[204:207]
  v_mul_f32 v197, v197, v23
  v_mul_f32 v198, v198, v23
  v_mfma_f32_16x16x32_bf16 v[212:215], v[244:247], v[164:167], v[212:215]
  v_mul_f32 v199, v199, v23
  s_waitcnt lgkmcnt(3)
  v_mfma_f32_16x16x32_bf16 v[200:203], v[248:251], v[168:171], v[200:203]
  v_cvt_pk_bf16_f32 v28, v192, v193
  v_cvt_pk_bf16_f32 v29, v194, v195
  v_mfma_f32_16x16x32_bf16 v[208:211], v[248:251], v[176:179], v[208:211]
  v_cvt_pk_bf16_f32 v30, v196, v197
  s_waitcnt lgkmcnt(2)
  v_mfma_f32_16x16x32_bf16 v[204:207], v[252:255], v[168:171], v[204:207]
  v_cvt_pk_bf16_f32 v31, v198, v199
  v_mfma_f32_16x16x32_bf16 v[212:215], v[252:255], v[176:179], v[212:215]
  buffer_store_dwordx4 v[28:31], v6, s[16:19], 0 offen offset:256 nt sc1
  s_waitcnt lgkmcnt(1)
  v_mfma_f32_16x16x32_bf16 v[200:203], v[216:219], v[172:175], v[200:203]
  v_mfma_f32_16x16x32_bf16 v[208:211], v[216:219], v[180:183], v[208:211]
  s_waitcnt lgkmcnt(0)
  v_mfma_f32_16x16x32_bf16 v[204:207], v[220:223], v[172:175], v[204:207]
  v_mfma_f32_16x16x32_bf16 v[212:215], v[220:223], v[180:183], v[212:215]
  v_mfma_f32_16x16x32_bf16 v[200:203], v[40:43], v[152:155], v[200:203]
  v_mfma_f32_16x16x32_bf16 v[208:211], v[40:43], v[72:75], v[208:211]
  v_mfma_f32_16x16x32_bf16 v[204:207], v[44:47], v[152:155], v[204:207]
  v_mfma_f32_16x16x32_bf16 v[212:215], v[44:47], v[72:75], v[212:215]
  s_nop 4
  v_mul_f32 v200, v200, v22
  v_mul_f32 v201, v201, v22
  v_mul_f32 v202, v202, v22
  v_mul_f32 v203, v203, v22
  v_mul_f32 v204, v204, v22
  v_mul_f32 v205, v205, v22
  v_mul_f32 v206, v206, v22
  v_mul_f32 v207, v207, v22
  v_cvt_pk_bf16_f32 v32, v200, v201
  v_cvt_pk_bf16_f32 v33, v202, v203
  v_cvt_pk_bf16_f32 v34, v204, v205
  v_cvt_pk_bf16_f32 v35, v206, v207
  buffer_store_dwordx4 v[32:35], v5, s[16:19], 0 offen offset:320 nt sc1
  v_mul_f32 v208, v208, v23
  v_mul_f32 v209, v209, v23
  v_mul_f32 v210, v210, v23
  v_mul_f32 v211, v211, v23
  v_mul_f32 v212, v212, v23
  v_mul_f32 v213, v213, v23
  v_mul_f32 v214, v214, v23
  v_mul_f32 v215, v215, v23
  v_cvt_pk_bf16_f32 v36, v208, v209
  v_cvt_pk_bf16_f32 v37, v210, v211
  v_cvt_pk_bf16_f32 v38, v212, v213
  v_cvt_pk_bf16_f32 v39, v214, v215
  buffer_store_dwordx4 v[36:39], v6, s[16:19], 0 offen offset:320 nt sc1
MK_done:
  s_endpgm
FB0:
  s_nop 7
  v_max3_f32 v22, v24, v25, v26
  v_max3_f32 v22, v22, v27, v28
  v_max3_f32 v22, v22, v29, v30
  v_max3_f32 v22, v22, v31, v32
  v_max3_f32 v22, v22, v33, v34
  v_max3_f32 v22, v22, v35, v36
  v_max3_f32 v22, v22, v37, v38
  v_max3_f32 v22, v22, v39, v40
  v_max3_f32 v22, v22, v41, v42
  v_max3_f32 v22, v22, v43, v44
  v_max3_f32 v22, v22, v45, v46
  v_max3_f32 v22, v22, v47, v48
  v_max3_f32 v22, v22, v49, v50
  v_max3_f32 v22, v22, v51, v52
  v_max3_f32 v22, v22, v53, v54
  s_mov_b32 s52, 0xff7fffff
  v_max3_f32 v22, v22, v55, s52
  v_mov_b32 v23, v22
  s_nop 1
  v_permlane32_swap_b32 v22, v23
  s_nop 1
  v_max_f32 v22, v22, v23
  v_mov_b32 v23, v22
  s_nop 1
  v_permlane16_swap_b32 v22, v23
  s_nop 1
  v_max_f32 v22, v22, v23
  v_sub_f32 v24, v24, v22
  v_sub_f32 v25, v25, v22
  v_sub_f32 v26, v26, v22
  v_sub_f32 v27, v27, v22
  v_sub_f32 v28, v28, v22
  v_sub_f32 v29, v29, v22
  v_sub_f32 v30, v30, v22
  v_sub_f32 v31, v31, v22
  v_sub_f32 v32, v32, v22
  v_sub_f32 v33, v33, v22
  v_sub_f32 v34, v34, v22
  v_sub_f32 v35, v35, v22
  v_sub_f32 v36, v36, v22
  v_sub_f32 v37, v37, v22
  v_sub_f32 v38, v38, v22
  v_sub_f32 v39, v39, v22
  v_sub_f32 v40, v40, v22
  v_sub_f32 v41, v41, v22
  v_sub_f32 v42, v42, v22
  v_sub_f32 v43, v43, v22
  v_sub_f32 v44, v44, v22
  v_sub_f32 v45, v45, v22
  v_sub_f32 v46, v46, v22
  v_sub_f32 v47, v47, v22
  v_sub_f32 v48, v48, v22
  v_sub_f32 v49, v49, v22
  v_sub_f32 v50, v50, v22
  v_sub_f32 v51, v51, v22
  v_sub_f32 v52, v52, v22
  v_sub_f32 v53, v53, v22
  v_sub_f32 v54, v54, v22
  v_sub_f32 v55, v55, v22
  v_exp_f32 v24, v24
  v_exp_f32 v25, v25
  v_exp_f32 v26, v26
  v_exp_f32 v27, v27
  v_exp_f32 v28, v28
  v_exp_f32 v29, v29
  v_exp_f32 v30, v30
  v_exp_f32 v31, v31
  v_exp_f32 v32, v32
  v_exp_f32 v33, v33
  v_exp_f32 v34, v34
  v_exp_f32 v35, v35
  v_exp_f32 v36, v36
  v_exp_f32 v37, v37
  v_exp_f32 v38, v38
  v_exp_f32 v39, v39
  v_exp_f32 v40, v40
  v_exp_f32 v41, v41
  v_exp_f32 v42, v42
  v_exp_f32 v43, v43
  v_exp_f32 v44, v44
  v_exp_f32 v45, v45
  v_exp_f32 v46, v46
  v_exp_f32 v47, v47
  v_exp_f32 v48, v48
  v_exp_f32 v49, v49
  v_exp_f32 v50, v50
  v_exp_f32 v51, v51
  v_exp_f32 v52, v52
  v_exp_f32 v53, v53
  v_exp_f32 v54, v54
  v_exp_f32 v55, v55
  s_nop 0
  v_cvt_pk_bf16_f32 v136, v24, v25
  v_cvt_pk_bf16_f32 v137, v26, v27
  v_cvt_pk_bf16_f32 v138, v28, v29
  v_cvt_pk_bf16_f32 v139, v30, v31
  v_cvt_pk_bf16_f32 v140, v32, v33
  v_cvt_pk_bf16_f32 v141, v34, v35
  v_cvt_pk_bf16_f32 v142, v36, v37
  v_cvt_pk_bf16_f32 v143, v38, v39
  v_cvt_pk_bf16_f32 v144, v40, v41
  v_cvt_pk_bf16_f32 v145, v42, v43
  v_cvt_pk_bf16_f32 v146, v44, v45
  v_cvt_pk_bf16_f32 v147, v46, v47
  v_cvt_pk_bf16_f32 v148, v48, v49
  v_cvt_pk_bf16_f32 v149, v50, v51
  v_cvt_pk_bf16_f32 v150, v52, v53
  v_cvt_pk_bf16_f32 v151, v54, v55
  s_nop 1
  v_mfma_f32_16x16x32_bf16 v[184:187], v[192:195], v[136:139], 0
  v_mfma_f32_16x16x32_bf16 v[184:187], v[192:195], v[140:143], v[184:187]
  v_mfma_f32_16x16x32_bf16 v[184:187], v[192:195], v[144:147], v[184:187]
  v_mfma_f32_16x16x32_bf16 v[184:187], v[192:195], v[148:151], v[184:187]
  s_nop 7
  s_branch FBR0
FB1:
  s_nop 7
  v_max3_f32 v22, v56, v57, v58
  v_max3_f32 v22, v22, v59, v60
  v_max3_f32 v22, v22, v61, v62
  v_max3_f32 v22, v22, v63, v64
  v_max3_f32 v22, v22, v65, v66
  v_max3_f32 v22, v22, v67, v68
  v_max3_f32 v22, v22, v69, v70
  v_max3_f32 v22, v22, v71, v72
  v_max3_f32 v22, v22, v73, v74
  v_max3_f32 v22, v22, v75, v76
  v_max3_f32 v22, v22, v77, v78
  v_max3_f32 v22, v22, v79, v80
  v_max3_f32 v22, v22, v81, v82
  v_max3_f32 v22, v22, v83, v84
  v_max3_f32 v22, v22, v85, v86
  s_mov_b32 s52, 0xff7fffff
  v_max3_f32 v22, v22, v87, s52
  v_mov_b32 v23, v22
  s_nop 1
  v_permlane32_swap_b32 v22, v23
  s_nop 1
  v_max_f32 v22, v22, v23
  v_mov_b32 v23, v22
  s_nop 1
  v_permlane16_swap_b32 v22, v23
  s_nop 1
  v_max_f32 v22, v22, v23
  v_sub_f32 v56, v56, v22
  v_sub_f32 v57, v57, v22
  v_sub_f32 v58, v58, v22
  v_sub_f32 v59, v59, v22
  v_sub_f32 v60, v60, v22
  v_sub_f32 v61, v61, v22
  v_sub_f32 v62, v62, v22
  v_sub_f32 v63, v63, v22
  v_sub_f32 v64, v64, v22
  v_sub_f32 v65, v65, v22
  v_sub_f32 v66, v66, v22
  v_sub_f32 v67, v67, v22
  v_sub_f32 v68, v68, v22
  v_sub_f32 v69, v69, v22
  v_sub_f32 v70, v70, v22
  v_sub_f32 v71, v71, v22
  v_sub_f32 v72, v72, v22
  v_sub_f32 v73, v73, v22
  v_sub_f32 v74, v74, v22
  v_sub_f32 v75, v75, v22
  v_sub_f32 v76, v76, v22
  v_sub_f32 v77, v77, v22
  v_sub_f32 v78, v78, v22
  v_sub_f32 v79, v79, v22
  v_sub_f32 v80, v80, v22
  v_sub_f32 v81, v81, v22
  v_sub_f32 v82, v82, v22
  v_sub_f32 v83, v83, v22
  v_sub_f32 v84, v84, v22
  v_sub_f32 v85, v85, v22
  v_sub_f32 v86, v86, v22
  v_sub_f32 v87, v87, v22
  v_exp_f32 v56, v56
  v_exp_f32 v57, v57
  v_exp_f32 v58, v58
  v_exp_f32 v59, v59
  v_exp_f32 v60, v60
  v_exp_f32 v61, v61
  v_exp_f32 v62, v62
  v_exp_f32 v63, v63
  v_exp_f32 v64, v64
  v_exp_f32 v65, v65
  v_exp_f32 v66, v66
  v_exp_f32 v67, v67
  v_exp_f32 v68, v68
  v_exp_f32 v69, v69
  v_exp_f32 v70, v70
  v_exp_f32 v71, v71
  v_exp_f32 v72, v72
  v_exp_f32 v73, v73
  v_exp_f32 v74, v74
  v_exp_f32 v75, v75
  v_exp_f32 v76, v76
  v_exp_f32 v77, v77
  v_exp_f32 v78, v78
  v_exp_f32 v79, v79
  v_exp_f32 v80, v80
  v_exp_f32 v81, v81
  v_exp_f32 v82, v82
  v_exp_f32 v83, v83
  v_exp_f32 v84, v84
  v_exp_f32 v85, v85
  v_exp_f32 v86, v86
  v_exp_f32 v87, v87
  s_nop 0
  v_cvt_pk_bf16_f32 v152, v56, v57
  v_cvt_pk_bf16_f32 v153, v58, v59
  v_cvt_pk_bf16_f32 v154, v60, v61
  v_cvt_pk_bf16_f32 v155, v62, v63
  v_cvt_pk_bf16_f32 v156, v64, v65
  v_cvt_pk_bf16_f32 v157, v66, v67
  v_cvt_pk_bf16_f32 v158, v68, v69
  v_cvt_pk_bf16_f32 v159, v70, v71
  v_cvt_pk_bf16_f32 v160, v72, v73
  v_cvt_pk_bf16_f32 v161, v74, v75
  v_cvt_pk_bf16_f32 v162, v76, v77
  v_cvt_pk_bf16_f32 v163, v78, v79
  v_cvt_pk_bf16_f32 v164, v80, v81
  v_cvt_pk_bf16_f32 v165, v82, v83
  v_cvt_pk_bf16_f32 v166, v84, v85
  v_cvt_pk_bf16_f32 v167, v86, v87
  s_nop 1
  v_mfma_f32_16x16x32_bf16 v[188:191], v[192:195], v[152:155], 0
  v_mfma_f32_16x16x32_bf16 v[188:191], v[192:195], v[156:159], v[188:191]
  v_mfma_f32_16x16x32_bf16 v[188:191], v[192:195], v[160:163], v[188:191]
  v_mfma_f32_16x16x32_bf16 v[188:191], v[192:195], v[164:167], v[188:191]
  s_nop 7
  s_branch FBR1
MK_end:
.section .rodata,"a"
.p2align 6
.amdhsa_kernel standalone__neighborhood_nat__vision_kernel
  .amdhsa_next_free_vgpr 256
  .amdhsa_next_free_sgpr 102
  .amdhsa_accum_offset 256
  .amdhsa_group_segment_fixed_size 0
  .amdhsa_kernarg_size 48
  .amdhsa_user_sgpr_count 2
  .amdhsa_user_sgpr_kernarg_segment_ptr 1
  .amdhsa_system_sgpr_workgroup_id_x 1
.end_amdhsa_kernel
```

```asm
; @launch grid=(256,1,1) block=(512,1,1) lds=163840
.amdgcn_target "amdgcn-amd-amdhsa--gfx950"
.text
.globl standalone__neighborhood_nat__vision_kernel
.p2align 8
.type standalone__neighborhood_nat__vision_kernel,@function
standalone__neighborhood_nat__vision_kernel:
  s_cmp_ge_u32 s2, 256
  s_cbranch_scc1 MK_done
  s_load_dwordx8 s[4:11], s[0:1], 0
  s_load_dwordx4 s[84:87], s[0:1], 32
  s_getpc_b64 s[12:13]
MK_pc:
  s_and_b32 s13, s13, 0xffff
  s_mov_b32 s14, MK_end-MK_pc
  s_mov_b32 s15, 0x00020000
  v_lshlrev_b32 v23, 7, v0
  buffer_load_dword v255, v23, s[12:15], 0 offen
  v_lshrrev_b32 v130, 6, v0
  v_and_b32 v0, 63, v0
  v_readfirstlane_b32 s24, v130
  v_and_b32 v128, 15, v0
  v_lshrrev_b32 v129, 4, v0
  v_lshrrev_b32 v130, 5, v0
  v_bfe_u32 v131, v0, 3, 2
  v_lshl_add_u32 v130, v130, 3, v131
  v_mul_u32_u24 v130, 1152, v130
  s_and_b32 s26, s24, 1
  s_lshl_b32 s46, s26, 2
  v_add_u32 v131, s46, v129
  v_and_b32 v132, 7, v0
  v_xor_b32 v131, v131, v132
  v_lshl_add_u32 v96, v131, 4, v130
  s_lshr_b32 s46, s24, 2
  s_lshl_b32 s46, s46, 5
  s_lshl_b32 s47, s26, 4
  s_add_u32 s46, s46, s47
  s_and_b32 s47, s24, 2
  s_lshl_b32 s47, s47, 1
  s_add_u32 s46, s46, s47
  s_mul_i32 s92, s46, 1152
  s_lshl_b32 s41, s24, 10
  s_cmp_lt_u32 s24, 4
  s_cselect_b64 vcc, -1, 0
  s_cbranch_vccz SL1
  s_waitcnt lgkmcnt(0)
  s_mov_b32 s88, s6
  s_and_b32 s89, s7, 0xffff
  s_mov_b32 s90, 221184
  s_mov_b32 s91, 0x00020000
  s_add_i32 m0, s41, 0
  s_add_i32 s100, s92, 0
  buffer_load_dwordx4 v96, s[88:91], s100 offen lds
  s_add_i32 m0, s41, 8192
  s_add_i32 s100, s92, 73728
  buffer_load_dwordx4 v96, s[88:91], s100 offen lds
  s_add_i32 m0, s41, 16384
  s_add_i32 s100, s92, 147456
  buffer_load_dwordx4 v96, s[88:91], s100 offen lds
  s_add_i32 m0, s41, 24576
  s_add_i32 s100, s92, 384
  buffer_load_dwordx4 v96, s[88:91], s100 offen lds
  s_add_i32 m0, s41, 32768
  s_add_i32 s100, s92, 74112
  buffer_load_dwordx4 v96, s[88:91], s100 offen lds
  s_add_i32 m0, s41, 40960
  s_add_i32 s100, s92, 147840
  buffer_load_dwordx4 v96, s[88:91], s100 offen lds
SL1:
  s_bfe_u32 s27, s2, 0x10002
  s_bfe_u32 s28, s2, 0x10001
  s_and_b32 s29, s2, 1
  s_lshl_b32 s29, s29, 2
  s_lshr_b32 s46, s2, 6
  s_add_u32 s29, s29, s46
  s_bfe_u32 s30, s2, 0x30003
  s_mul_i32 s37, s29, 14
  s_add_i32 s37, s37, -6
  s_max_i32 s29, s37, -4
  s_mul_i32 s30, s30, 14
  s_add_i32 s30, s30, -6
  s_lshr_b32 s25, s24, 1
  s_add_u32 s25, s25, 2
  s_and_b32 s25, s25, 3
  s_sub_u32 s56, 0, s27
  s_mul_i32 s57, s27, 224
  s_sub_u32 s58, 0, s28
  s_mul_i32 s59, s28, 224
  v_and_b32 v130, 7, v128
  s_mul_i32 s46, s26, 7
  s_add_i32 s46, s46, s30
  v_cmp_lt_u32 s[48:49], 6, v130
  v_add_u32 v130, s46, v130
  v_max_i32 v19, 0, v130
  v_add3_u32 v130, v130, v19, 6
  v_xor_b32 v130, s58, v130
  v_add_u32 v130, s59, v130
  v_subrev_u32 v19, s30, v19
  v_mul_u32_u24 v130, 384, v130
  v_lshl_add_u32 v130, v129, 4, v130
  s_lshl_b32 s46, s25, 2
  s_add_i32 s46, s46, -2
  s_mov_b32 s47, 86016
  v_lshrrev_b32 v131, 3, v128
  v_add_u32 v131, s46, v131
  v_mov_b32 v132, 0x80000000
  v_cmp_gt_i32 s[42:43], 0, v131
  v_add_u32 v5, s37, v131
  v_max_i32 v21, 0, v5
  v_add3_u32 v5, v5, v21, 6
  s_or_b64 s[42:43], s[42:43], s[48:49]
  v_xor_b32 v5, s56, v5
  v_add_u32 v5, s57, v5
  v_subrev_u32 v21, s29, v21
  v_mad_u32_u24 v5, v5, s47, v130
  v_cndmask_b32 v21, v21, v132, s[42:43]
  v_cndmask_b32 v5, v5, v132, s[42:43]
  v_add_u32 v131, 2, v131
  v_cmp_gt_i32 s[44:45], 0, v131
  v_add_u32 v6, s37, v131
  v_max_i32 v22, 0, v6
  v_add3_u32 v6, v6, v22, 6
  s_or_b64 s[44:45], s[44:45], s[48:49]
  v_xor_b32 v6, s56, v6
  v_add_u32 v6, s57, v6
  v_subrev_u32 v22, s29, v22
  v_mad_u32_u24 v6, v6, s47, v130
  v_cndmask_b32 v22, v22, v132, s[44:45]
  v_cndmask_b32 v6, v6, v132, s[44:45]
  s_waitcnt lgkmcnt(0)
  s_mov_b32 s88, s6
  s_and_b32 s89, s7, 0xffff
  s_mov_b32 s90, 221184
  s_mov_b32 s91, 0x00020000
  s_cmp_lg_u32 s24, 5
  s_cbranch_scc1 MK_ntlb
  s_max_i32 s46, s37, 0
  s_lshl_b32 s46, s46, 1
  s_sub_u32 s47, 184, s46
  s_cmp_eq_u32 s27, 0
  s_cselect_b32 s46, s46, s47
  s_mul_i32 s46, s46, 86016
  s_load_dword s94, s[4:5], s46
  s_load_dword s95, s[10:11], s46
  s_add_u32 s46, s46, 1720256
  s_load_dword s94, s[4:5], s46
  s_load_dword s95, s[10:11], s46
  s_add_u32 s46, s46, 1720256
  s_load_dword s94, s[4:5], s46
  s_load_dword s95, s[10:11], s46
  s_load_dword s94, s[84:85], 128
  s_load_dword s95, s[86:87], 0x20000
MK_ntlb:
  s_lshr_b32 s46, s24, 1
  s_cmp_lg_u32 s46, 2
  s_cbranch_scc1 MK_nwpf
  s_cmp_eq_u32 s24, 4
  s_cselect_b32 s46, 54, 18
  s_cselect_b32 s12, s6, s8
  s_cselect_b32 s13, s7, s9
  s_and_b32 s13, s13, 0xffff
  s_lshr_b32 s47, s2, 3
  s_mul_i32 s47, s47, s46
  s_lshl_b32 s100, s47, 7
  s_lshl_b32 s46, s46, 7
  s_add_u32 s14, s100, s46
  s_mov_b32 s15, 0x00020000
  v_lshlrev_b32 v23, 7, v0
  buffer_load_dword v254, v23, s[12:15], s100 offen
MK_nwpf:
  s_mov_b32 s12, s4
  s_and_b32 s13, s5, 0xffff
  s_mov_b32 s14, 19267584
  s_mov_b32 s15, 0x00020000
  s_movk_i32 s54, 112
  s_mov_b32 s16, s10
  s_and_b32 s17, s11, 0xffff
  s_mov_b32 s18, 19267584
  s_mov_b32 s19, 0x00020000
  s_mov_b32 s4, s8
  s_and_b32 s5, s9, 0xffff
  s_mov_b32 s6, 73728
  s_mov_b32 s7, 0x00020000
  s_mov_b32 s8, s84
  s_and_b32 s9, s85, 0xffff
  s_mov_b32 s10, 256
  s_mov_b32 s11, 0x00020000
  s_mov_b32 s20, s86
  s_and_b32 s21, s87, 0xffff
  s_mov_b32 s22, 73728
  s_mov_b32 s23, 0x00020000
  v_lshlrev_b32 v1, 4, v0
  v_add_u32 v2, 36864, v1
  s_and_b32 s40, s24, 3
  s_lshl_b32 s40, s40, 10
  v_bfe_u32 v130, v128, 1, 3
  v_xor_b32 v130, v130, v129
  v_lshlrev_b32 v131, 7, v128
  v_lshl_add_u32 v131, v130, 4, v131
  s_lshr_b32 s46, s24, 2
  s_mul_i32 s47, s46, 12288
  v_add_u32 v97, s47, v131
  v_xor_b32 v98, 64, v97
  s_mul_i32 s47, s40, 6
  s_add_u32 s47, s47, 24576
  v_add_u32 v99, s47, v131
  v_xor_b32 v100, 64, v99
  s_lshr_b32 s46, s24, 2
  s_mul_i32 s46, s46, 6
  s_sub_u32 s46, 67, s46
  s_and_b32 s47, s24, 3
  s_mul_i32 s47, s47, 3
  s_add_u32 s48, s47, 0
  s_lshr_b32 s49, s48, 1
  s_mul_i32 s49, s49, 10
  s_add_u32 s48, s48, s49
  s_sub_u32 s48, s46, s48
  s_lshl_b32 s48, s48, 10
  v_add_u32 v101, s48, v1
  s_add_u32 s48, s47, 1
  s_lshr_b32 s49, s48, 1
  s_mul_i32 s49, s49, 10
  s_add_u32 s48, s48, s49
  s_sub_u32 s48, s46, s48
  s_lshl_b32 s48, s48, 10
  v_add_u32 v102, s48, v1
  s_add_u32 s48, s47, 2
  s_lshr_b32 s49, s48, 1
  s_mul_i32 s49, s49, 10
  s_add_u32 s48, s48, s49
  s_sub_u32 s48, s46, s48
  s_lshl_b32 s48, s48, 10
  v_add_u32 v103, s48, v1
  s_lshl_b32 s46, s29, 1
  s_xor_b32 s46, s46, s56
  s_mul_i32 s47, s27, 222
  s_add_i32 s31, s46, s47
  s_mul_i32 s31, s31, 86016
  s_mul_i32 s32, s27, -688128
  s_add_i32 s32, s32, 344064
  s_lshr_b32 s33, s29, 31
  s_lshl_b32 s33, s33, 1
  s_lshl_b32 s38, s40, 2
  s_add_u32 s39, s38, 3072
  s_min_u32 s39, s39, 14336
  s_mul_i32 s48, s27, 172032
  s_sub_u32 s49, 172032, s48
  s_cbranch_vccz SL2
  s_add_i32 m0, s41, 4096
  s_add_i32 s100, s92, 36864
  buffer_load_dwordx4 v96, s[88:91], s100 offen lds
  s_add_i32 m0, s41, 12288
  s_add_i32 s100, s92, 110592
  buffer_load_dwordx4 v96, s[88:91], s100 offen lds
  s_add_i32 m0, s41, 20480
  s_add_i32 s100, s92, 184320
  buffer_load_dwordx4 v96, s[88:91], s100 offen lds
  s_add_i32 m0, s41, 28672
  s_add_i32 s100, s92, 37248
  buffer_load_dwordx4 v96, s[88:91], s100 offen lds
  s_add_i32 m0, s41, 36864
  s_add_i32 s100, s92, 110976
  buffer_load_dwordx4 v96, s[88:91], s100 offen lds
  s_add_i32 m0, s41, 45056
  s_add_i32 s100, s92, 184704
  buffer_load_dwordx4 v96, s[88:91], s100 offen lds
SL2:
  v_mov_b32 v132, s48
  v_mov_b32 v133, s49
  s_lshr_b32 s46, s38, 4
  s_add_u32 s46, s46, 0
  v_add_u32 v130, s46, v0
  v_mul_u32_u24 v13, 2731, v130
  v_lshrrev_b32 v13, 16, v13
  v_cmp_le_u32 s[52:53], 20, v13
  v_mul_u32_u24 v131, 24, v13
  v_sub_u32 v130, v130, v131
  v_subrev_u32 v131, 20, v13
  v_cndmask_b32 v13, v13, v131, s[52:53]
  v_bfe_u32 v131, v13, 1, 3
  v_xor_b32 v130, v130, v131
  v_cndmask_b32 v131, v132, v133, s[52:53]
  v_lshl_add_u32 v130, v130, 4, v131
  v_add_u32 v13, s30, v13
  v_max_i32 v13, 0, v13
  v_lshlrev_b32 v13, 1, v13
  v_xor_b32 v13, s58, v13
  v_add_u32 v13, s59, v13
  v_mul_u32_u24 v13, 384, v13
  v_add_u32 v13, v13, v130
  s_lshr_b32 s46, s38, 4
  s_add_u32 s46, s46, 64
  v_add_u32 v130, s46, v0
  v_mul_u32_u24 v14, 2731, v130
  v_lshrrev_b32 v14, 16, v14
  v_cmp_le_u32 s[52:53], 20, v14
  v_mul_u32_u24 v131, 24, v14
  v_sub_u32 v130, v130, v131
  v_subrev_u32 v131, 20, v14
  v_cndmask_b32 v14, v14, v131, s[52:53]
  v_bfe_u32 v131, v14, 1, 3
  v_xor_b32 v130, v130, v131
  v_cndmask_b32 v131, v132, v133, s[52:53]
  v_lshl_add_u32 v130, v130, 4, v131
  v_add_u32 v14, s30, v14
  v_max_i32 v14, 0, v14
  v_lshlrev_b32 v14, 1, v14
  v_xor_b32 v14, s58, v14
  v_add_u32 v14, s59, v14
  v_mul_u32_u24 v14, 384, v14
  v_add_u32 v14, v14, v130
  s_lshr_b32 s46, s38, 4
  s_add_u32 s46, s46, 128
  v_add_u32 v130, s46, v0
  v_mul_u32_u24 v3, 2731, v130
  v_lshrrev_b32 v3, 16, v3
  v_cmp_le_u32 s[52:53], 20, v3
  v_mul_u32_u24 v131, 24, v3
  v_sub_u32 v130, v130, v131
  v_subrev_u32 v131, 20, v3
  v_cndmask_b32 v3, v3, v131, s[52:53]
  v_bfe_u32 v131, v3, 1, 3
  v_xor_b32 v130, v130, v131
  v_cndmask_b32 v131, v132, v133, s[52:53]
  v_lshl_add_u32 v130, v130, 4, v131
  v_add_u32 v3, s30, v3
  v_max_i32 v3, 0, v3
  v_lshlrev_b32 v3, 1, v3
  v_xor_b32 v3, s58, v3
  v_add_u32 v3, s59, v3
  v_mul_u32_u24 v3, 384, v3
  v_add_u32 v3, v3, v130
  s_lshr_b32 s46, s39, 4
  v_add_u32 v130, s46, v0
  v_mul_u32_u24 v4, 2731, v130
  v_lshrrev_b32 v4, 16, v4
  v_cmp_le_u32 s[52:53], 20, v4
  v_mul_u32_u24 v131, 24, v4
  v_sub_u32 v130, v130, v131
  v_subrev_u32 v131, 20, v4
  v_cndmask_b32 v4, v4, v131, s[52:53]
  v_bfe_u32 v131, v4, 1, 3
  v_xor_b32 v130, v130, v131
  v_cndmask_b32 v131, v132, v133, s[52:53]
  v_lshl_add_u32 v130, v130, 4, v131
  v_add_u32 v4, s30, v4
  v_max_i32 v4, 0, v4
  v_lshlrev_b32 v4, 1, v4
  v_xor_b32 v4, s58, v4
  v_add_u32 v4, s59, v4
  v_mul_u32_u24 v4, 384, v4
  v_add_u32 v4, v4, v130
  s_add_u32 s38, s38, 10240
  s_add_u32 s39, s39, 10240
  s_lshl_b32 s46, s25, 2
  s_add_i32 s46, s46, -2
  s_max_i32 s46, s46, 0
  s_add_i32 s46, s46, s37
  s_max_i32 s46, s46, 0
  s_sub_i32 s46, s46, s29
  s_lshl_b32 s34, s25, 2
  s_add_i32 s34, s34, s37
  s_max_i32 s34, s34, 0
  s_sub_i32 s34, s34, s29
  s_sub_u32 s46, s34, s46
  s_lshr_b32 s46, s46, 1
  s_mul_i32 s36, s46, -8
  s_add_i32 s36, s36, 7
  s_add_i32 s34, s34, -1
  s_add_i32 s35, s34, s36
  s_mul_i32 s36, s36, 7680
  s_lshl_b32 s47, s26, 2
  s_mul_i32 s46, s34, 7680
  s_add_i32 s46, s46, 10240
  v_add_u32 v130, s47, v128
  v_bfe_u32 v131, v130, 1, 3
  v_xor_b32 v131, v131, v129
  v_mul_u32_u24 v130, 384, v130
  v_lshl_add_u32 v130, v131, 4, v130
  v_add_u32 v7, s46, v130
  v_xor_b32 v8, 64, v7
  v_lshrrev_b32 v130, 2, v128
  v_lshl_add_u32 v130, v129, 2, v130
  v_add_u32 v130, s47, v130
  v_bfe_u32 v131, v130, 1, 3
  v_and_b32 v132, 2, v128
  v_lshlrev_b32 v132, 1, v132
  v_xor_b32 v131, v131, v132
  v_mul_u32_u24 v130, 384, v130
  v_lshl_add_u32 v130, v131, 4, v130
  v_and_b32 v131, 1, v128
  v_lshl_add_u32 v130, v131, 3, v130
  v_add_u32 v9, s46, v130
  v_xor_b32 v10, 16, v9
  v_xor_b32 v11, 32, v9
  v_xor_b32 v12, 48, v9
  v_lshl_add_u32 v130, v129, 2, s47
  v_sub_u32 v19, v130, v19
  v_cndmask_b32 v19, v19, 64, s[44:45]
  v_add_u32 v20, s36, v7
  v_add_u32 v0, s36, v8
  v_add_u32 v15, s36, v9
  v_add_u32 v16, s36, v10
  v_add_u32 v17, s36, v11
  v_add_u32 v18, s36, v12
  s_mov_b32 s93, 1037384597
  s_cbranch_vccnz SL3
  s_add_i32 m0, s41, 49152
  s_add_i32 s100, s92, 128
  buffer_load_dwordx4 v96, s[88:91], s100 offen lds
  s_add_i32 m0, s41, 57344
  s_add_i32 s100, s92, 73856
  buffer_load_dwordx4 v96, s[88:91], s100 offen lds
  s_add_i32 m0, s41, 65536
  s_add_i32 s100, s92, 147584
  buffer_load_dwordx4 v96, s[88:91], s100 offen lds
  s_add_i32 m0, s41, 73728
  s_add_i32 s100, s92, 512
  buffer_load_dwordx4 v96, s[88:91], s100 offen lds
  s_add_i32 m0, s41, 81920
  s_add_i32 s100, s92, 74240
  buffer_load_dwordx4 v96, s[88:91], s100 offen lds
  s_add_i32 m0, s41, 90112
  s_add_i32 s100, s92, 147968
  buffer_load_dwordx4 v96, s[88:91], s100 offen lds
  s_add_i32 m0, s41, 45056
  s_add_i32 s100, s92, -36736
  buffer_load_dwordx4 v96, s[88:91], s100 offen lds
  s_add_i32 m0, s41, 53248
  s_add_i32 s100, s92, 36992
  buffer_load_dwordx4 v96, s[88:91], s100 offen lds
  s_add_i32 m0, s41, 61440
  s_add_i32 s100, s92, 110720
  buffer_load_dwordx4 v96, s[88:91], s100 offen lds
  s_add_i32 m0, s41, 69632
  s_add_i32 s100, s92, -36352
  buffer_load_dwordx4 v96, s[88:91], s100 offen lds
  s_add_i32 m0, s41, 77824
  s_add_i32 s100, s92, 37376
  buffer_load_dwordx4 v96, s[88:91], s100 offen lds
  s_add_i32 m0, s41, 86016
  s_add_i32 s100, s92, 111104
  buffer_load_dwordx4 v96, s[88:91], s100 offen lds
SL3:
  s_cbranch_vccz SL4
  s_waitcnt vmcnt(0)
  s_branch SM4
SL4:
  s_waitcnt vmcnt(12)
SM4:
  s_barrier
  ds_read_b128 v[208:211], v99 offset:0
  ds_read_b128 v[212:215], v99 offset:2048
  ds_read_b128 v[216:219], v99 offset:4096
  ds_read_b128 v[184:187], v97 offset:0
  ds_read_b128 v[188:191], v97 offset:2048
  ds_read_b128 v[192:195], v97 offset:4096
  ds_read_b128 v[196:199], v97 offset:6144
  ds_read_b128 v[200:203], v97 offset:8192
  ds_read_b128 v[204:207], v97 offset:10240
  s_waitcnt lgkmcnt(5)
  v_mfma_f32_16x16x32_bf16 v[24:27], v[184:187], v[208:211], 0
  s_cbranch_vccz SL5
  s_add_i32 m0, s41, 98304
  s_add_i32 s100, s92, 256
  buffer_load_dwordx4 v96, s[88:91], s100 offen lds
SL5:
  v_mfma_f32_16x16x32_bf16 v[28:31], v[184:187], v[212:215], 0
  s_cbranch_vccz SL6
  s_add_i32 m0, s41, 106496
  s_add_i32 s100, s92, 73984
  buffer_load_dwordx4 v96, s[88:91], s100 offen lds
SL6:
  v_mfma_f32_16x16x32_bf16 v[32:35], v[184:187], v[216:219], 0
  s_waitcnt lgkmcnt(4)
  v_mfma_f32_16x16x32_bf16 v[36:39], v[188:191], v[208:211], 0
  ds_read_b128 v[244:247], v100 offset:0
  s_cbranch_vccz SL7
  s_add_i32 m0, s41, 114688
  s_add_i32 s100, s92, 147712
  buffer_load_dwordx4 v96, s[88:91], s100 offen lds
SL7:
  v_mfma_f32_16x16x32_bf16 v[40:43], v[188:191], v[212:215], 0
  ds_read_b128 v[248:251], v100 offset:2048
  s_cbranch_vccz SL8
  s_add_i32 m0, s41, 122880
  s_add_i32 s100, s92, 640
  buffer_load_dwordx4 v96, s[88:91], s100 offen lds
SL8:
  v_mfma_f32_16x16x32_bf16 v[44:47], v[188:191], v[216:219], 0
  s_waitcnt lgkmcnt(5)
  v_mfma_f32_16x16x32_bf16 v[48:51], v[192:195], v[208:211], 0
  ds_read_b128 v[252:255], v100 offset:4096
  s_cbranch_vccz SL9
  s_add_i32 m0, s41, 131072
  s_add_i32 s100, s92, 74368
  buffer_load_dwordx4 v96, s[88:91], s100 offen lds
SL9:
  v_mfma_f32_16x16x32_bf16 v[52:55], v[192:195], v[212:215], 0
  ds_read_b128 v[220:223], v98 offset:0
  s_cbranch_vccz SL10
  s_add_i32 m0, s41, 139264
  s_add_i32 s100, s92, 148096
  buffer_load_dwordx4 v96, s[88:91], s100 offen lds
SL10:
  v_mfma_f32_16x16x32_bf16 v[56:59], v[192:195], v[216:219], 0
  s_waitcnt lgkmcnt(6)
  v_mfma_f32_16x16x32_bf16 v[60:63], v[196:199], v[208:211], 0
  ds_read_b128 v[224:227], v98 offset:2048
  s_cbranch_vccz SL11
  s_add_i32 m0, s41, 102400
  s_add_i32 s100, s92, 37120
  buffer_load_dwordx4 v96, s[88:91], s100 offen lds
SL11:
  v_mfma_f32_16x16x32_bf16 v[64:67], v[196:199], v[212:215], 0
  ds_read_b128 v[228:231], v98 offset:4096
  s_cbranch_vccz SL12
  s_add_i32 m0, s41, 110592
  s_add_i32 s100, s92, 110848
  buffer_load_dwordx4 v96, s[88:91], s100 offen lds
SL12:
  v_mfma_f32_16x16x32_bf16 v[68:71], v[196:199], v[216:219], 0
  s_waitcnt lgkmcnt(7)
  v_mfma_f32_16x16x32_bf16 v[72:75], v[200:203], v[208:211], 0
  ds_read_b128 v[232:235], v98 offset:6144
  s_cbranch_vccz SL13
  s_add_i32 m0, s41, 118784
  s_add_i32 s100, s92, 184576
  buffer_load_dwordx4 v96, s[88:91], s100 offen lds
SL13:
  v_mfma_f32_16x16x32_bf16 v[76:79], v[200:203], v[212:215], 0
  ds_read_b128 v[236:239], v98 offset:8192
  s_cbranch_vccz SL14
  s_add_i32 m0, s41, 126976
  s_add_i32 s100, s92, 37504
  buffer_load_dwordx4 v96, s[88:91], s100 offen lds
SL14:
  v_mfma_f32_16x16x32_bf16 v[80:83], v[200:203], v[216:219], 0
  s_waitcnt lgkmcnt(8)
  v_mfma_f32_16x16x32_bf16 v[84:87], v[204:207], v[208:211], 0
  ds_read_b128 v[240:243], v98 offset:10240
  s_cbranch_vccz SL15
  s_add_i32 m0, s41, 135168
  s_add_i32 s100, s92, 111232
  buffer_load_dwordx4 v96, s[88:91], s100 offen lds
SL15:
  v_mfma_f32_16x16x32_bf16 v[88:91], v[204:207], v[212:215], 0
  s_cbranch_vccz SL16
  s_add_i32 m0, s41, 143360
  s_add_i32 s100, s92, 184960
  buffer_load_dwordx4 v96, s[88:91], s100 offen lds
SL16:
  v_mfma_f32_16x16x32_bf16 v[92:95], v[204:207], v[216:219], 0
  v_lshrrev_b32 v107, 4, v1
  s_cmp_lt_u32 s2, 72
  s_cbranch_scc0 MK_np1
  s_mul_hi_u32 s54, s2, 0x15555556
  s_lshl_b32 s54, s54, 6
  s_mul_i32 s55, s24, 6144
  s_add_u32 s100, s54, s55
  v_lshrrev_b32 v104, 2, v107
  v_mul_u32_u24 v104, 384, v104
  v_and_b32 v105, 3, v107
  v_lshl_add_u32 v104, v105, 4, v104
  s_add_u32 m0, s41, 147456
  s_nop 0
  buffer_load_dwordx4 v104, s[4:7], s100 offen lds
  s_mul_i32 s55, s40, 6
  s_add_u32 s100, s54, s55
  s_add_u32 m0, s40, 155648
  s_add_u32 s100, s100, 49152
  buffer_load_dwordx4 v104, s[4:7], s100 offen lds
MK_np1:
  s_sub_u32 s3, s2, 72
  s_lshr_b32 s3, s3, 31
  s_lshr_b32 s3, s3, s25
  v_mov_b32 v134, 0
  s_cmp_eq_u32 s3, 0
  s_cbranch_scc1 MK_np3
  s_mul_hi_u32 s54, s2, 0x15555556
  s_mul_i32 s55, s54, 12
  s_sub_u32 s55, s2, s55
  s_and_b32 s51, s55, 1
  s_lshr_b32 s55, s55, 1
  v_lshrrev_b32 v106, 2, v128
  v_and_b32 v105, 3, v128
  v_lshl_add_u32 v134, v129, 3, v106
  v_lshlrev_b32 v134, 6, v134
  v_lshl_add_u32 v134, v105, 4, v134
  s_lshl_b32 s51, s51, 3
  s_add_u32 s51, s51, 147456
  v_add_u32 v134, s51, v134
  s_lshr_b32 s54, s55, 1
  s_lshl_b32 s54, s54, 6
  s_and_b32 s55, s55, 1
  s_lshl_b32 s55, s55, 4
  s_add_u32 s54, s54, s55
  v_lshrrev_b32 v104, 1, v106
  v_lshlrev_b32 v104, 5, v104
  v_and_b32 v106, 1, v106
  v_lshl_add_u32 v104, v106, 2, v104
  v_add3_u32 v104, v104, v105, s54
  v_mul_u32_u24 v104, 1152, v104
  v_lshl_add_u32 v135, v129, 4, v104
  s_mul_i32 s100, s26, 9216
  buffer_load_dwordx4 v[136:139], v135, s[88:91], s100 offen offset:768
  buffer_load_dwordx4 v[140:143], v135, s[88:91], s100 offen offset:832
  buffer_load_dwordx4 v[144:147], v135, s[88:91], s100 offen offset:896
  buffer_load_dwordx4 v[148:151], v135, s[88:91], s100 offen offset:960
  buffer_load_dwordx4 v[152:155], v135, s[88:91], s100 offen offset:1024
  buffer_load_dwordx4 v[156:159], v135, s[88:91], s100 offen offset:1088
MK_np3:
  s_cbranch_vccz SL18
  s_waitcnt vmcnt(63) lgkmcnt(0)
  s_branch SM18
SL18:
  s_cmp_lg_u32 s3, 0
  s_cbranch_scc1 CA17
  s_cmp_lt_u32 s2, 72
  s_cbranch_scc1 CB17
  s_waitcnt vmcnt(0)
CB17:
  s_waitcnt vmcnt(2)
CA17:
  s_waitcnt vmcnt(8) lgkmcnt(0)
SM18:
  s_barrier
  v_add_u32 v97, 49152, v97
  v_add_u32 v98, 49152, v98
  v_add_u32 v99, 49152, v99
  v_add_u32 v100, 49152, v100
  v_mfma_f32_16x16x32_bf16 v[24:27], v[220:223], v[244:247], v[24:27]
  ds_read_b128 v[208:211], v99 offset:0
  s_cbranch_vccnz SL19
  buffer_load_dwordx4 v[160:163], v6, s[12:15], 0 offen offset:0
SL19:
  v_mfma_f32_16x16x32_bf16 v[28:31], v[220:223], v[248:251], v[28:31]
  ds_read_b128 v[212:215], v99 offset:2048
  v_mfma_f32_16x16x32_bf16 v[32:35], v[220:223], v[252:255], v[32:35]
  v_mfma_f32_16x16x32_bf16 v[36:39], v[224:227], v[244:247], v[36:39]
  ds_read_b128 v[216:219], v99 offset:4096
  s_cbranch_vccnz SL20
  buffer_load_dwordx4 v[164:167], v6, s[12:15], 0 offen offset:64
SL20:
  v_mfma_f32_16x16x32_bf16 v[40:43], v[224:227], v[248:251], v[40:43]
  ds_read_b128 v[184:187], v97 offset:0
  v_mfma_f32_16x16x32_bf16 v[44:47], v[224:227], v[252:255], v[44:47]
  v_mfma_f32_16x16x32_bf16 v[48:51], v[228:231], v[244:247], v[48:51]
  ds_read_b128 v[188:191], v97 offset:2048
  s_cbranch_vccnz SL21
  buffer_load_dwordx4 v[168:171], v6, s[12:15], 0 offen offset:128
SL21:
  v_mfma_f32_16x16x32_bf16 v[52:55], v[228:231], v[248:251], v[52:55]
  ds_read_b128 v[192:195], v97 offset:4096
  v_mfma_f32_16x16x32_bf16 v[56:59], v[228:231], v[252:255], v[56:59]
  v_mfma_f32_16x16x32_bf16 v[60:63], v[232:235], v[244:247], v[60:63]
  ds_read_b128 v[196:199], v97 offset:6144
  s_cbranch_vccnz SL22
  buffer_load_dwordx4 v[172:175], v6, s[12:15], 0 offen offset:192
SL22:
  v_mfma_f32_16x16x32_bf16 v[64:67], v[232:235], v[248:251], v[64:67]
  ds_read_b128 v[200:203], v97 offset:8192
  v_mfma_f32_16x16x32_bf16 v[68:71], v[232:235], v[252:255], v[68:71]
  v_mfma_f32_16x16x32_bf16 v[72:75], v[236:239], v[244:247], v[72:75]
  ds_read_b128 v[204:207], v97 offset:10240
  s_cbranch_vccnz SL23
  buffer_load_dwordx4 v[176:179], v6, s[12:15], 0 offen offset:256
SL23:
  v_mfma_f32_16x16x32_bf16 v[76:79], v[236:239], v[248:251], v[76:79]
  v_mfma_f32_16x16x32_bf16 v[80:83], v[236:239], v[252:255], v[80:83]
  v_mfma_f32_16x16x32_bf16 v[84:87], v[240:243], v[244:247], v[84:87]
  s_cbranch_vccnz SL24
  buffer_load_dwordx4 v[180:183], v6, s[12:15], 0 offen offset:320
SL24:
  v_mfma_f32_16x16x32_bf16 v[88:91], v[240:243], v[248:251], v[88:91]
  v_mfma_f32_16x16x32_bf16 v[92:95], v[240:243], v[252:255], v[92:95]
  s_waitcnt lgkmcnt(5)
  v_mfma_f32_16x16x32_bf16 v[24:27], v[184:187], v[208:211], v[24:27]
  s_cbranch_vccnz SL25
  s_cmp_eq_u32 s25, 0
  s_cbranch_scc1 QB6
  buffer_load_dwordx4 v[136:139], v5, s[12:15], 0 offen offset:0
QB6:
SL25:
  v_mfma_f32_16x16x32_bf16 v[28:31], v[184:187], v[212:215], v[28:31]
  v_mfma_f32_16x16x32_bf16 v[32:35], v[184:187], v[216:219], v[32:35]
  s_waitcnt lgkmcnt(4)
  v_mfma_f32_16x16x32_bf16 v[36:39], v[188:191], v[208:211], v[36:39]
  ds_read_b128 v[244:247], v100 offset:0
  s_cbranch_vccnz SL26
  s_cmp_eq_u32 s25, 0
  s_cbranch_scc1 QB7
  buffer_load_dwordx4 v[140:143], v5, s[12:15], 0 offen offset:64
QB7:
SL26:
  v_mfma_f32_16x16x32_bf16 v[40:43], v[188:191], v[212:215], v[40:43]
  ds_read_b128 v[248:251], v100 offset:2048
  v_mfma_f32_16x16x32_bf16 v[44:47], v[188:191], v[216:219], v[44:47]
  s_waitcnt lgkmcnt(5)
  v_mfma_f32_16x16x32_bf16 v[48:51], v[192:195], v[208:211], v[48:51]
  ds_read_b128 v[252:255], v100 offset:4096
  s_cbranch_vccnz SL27
  s_cmp_eq_u32 s25, 0
  s_cbranch_scc1 QB8
  buffer_load_dwordx4 v[144:147], v5, s[12:15], 0 offen offset:128
QB8:
SL27:
  v_mfma_f32_16x16x32_bf16 v[52:55], v[192:195], v[212:215], v[52:55]
  ds_read_b128 v[220:223], v98 offset:0
  v_mfma_f32_16x16x32_bf16 v[56:59], v[192:195], v[216:219], v[56:59]
  s_waitcnt lgkmcnt(6)
  v_mfma_f32_16x16x32_bf16 v[60:63], v[196:199], v[208:211], v[60:63]
  ds_read_b128 v[224:227], v98 offset:2048
  s_cbranch_vccnz SL28
  s_cmp_eq_u32 s25, 0
  s_cbranch_scc1 QB9
  buffer_load_dwordx4 v[148:151], v5, s[12:15], 0 offen offset:192
QB9:
SL28:
  v_mfma_f32_16x16x32_bf16 v[64:67], v[196:199], v[212:215], v[64:67]
  ds_read_b128 v[228:231], v98 offset:4096
  v_mfma_f32_16x16x32_bf16 v[68:71], v[196:199], v[216:219], v[68:71]
  s_waitcnt lgkmcnt(7)
  v_mfma_f32_16x16x32_bf16 v[72:75], v[200:203], v[208:211], v[72:75]
  ds_read_b128 v[232:235], v98 offset:6144
  s_cbranch_vccnz SL29
  s_cmp_eq_u32 s25, 0
  s_cbranch_scc1 QB10
  buffer_load_dwordx4 v[152:155], v5, s[12:15], 0 offen offset:256
QB10:
SL29:
  v_mfma_f32_16x16x32_bf16 v[76:79], v[200:203], v[212:215], v[76:79]
  ds_read_b128 v[236:239], v98 offset:8192
  v_mfma_f32_16x16x32_bf16 v[80:83], v[200:203], v[216:219], v[80:83]
  s_waitcnt lgkmcnt(8)
  v_mfma_f32_16x16x32_bf16 v[84:87], v[204:207], v[208:211], v[84:87]
  ds_read_b128 v[240:243], v98 offset:10240
  s_cbranch_vccnz SL30
  s_cmp_eq_u32 s25, 0
  s_cbranch_scc1 QB11
  buffer_load_dwordx4 v[156:159], v5, s[12:15], 0 offen offset:320
QB11:
SL30:
  v_mfma_f32_16x16x32_bf16 v[88:91], v[204:207], v[212:215], v[88:91]
  v_mfma_f32_16x16x32_bf16 v[92:95], v[204:207], v[216:219], v[92:95]
  s_cbranch_vccz SL31
  s_waitcnt vmcnt(0) lgkmcnt(0)
  s_branch SM31
SL31:
  s_cmp_lg_u32 s25, 0
  s_cbranch_scc1 MK_c2
  s_waitcnt vmcnt(6)
MK_c2:
  s_waitcnt vmcnt(12) lgkmcnt(0)
SM31:
  s_barrier
  v_add_u32 v97, 49152, v97
  v_add_u32 v98, 49152, v98
  v_add_u32 v99, 49152, v99
  v_add_u32 v100, 49152, v100
  v_mfma_f32_16x16x32_bf16 v[24:27], v[220:223], v[244:247], v[24:27]
  ds_read_b128 v[208:211], v99 offset:0
  s_cbranch_vccz SL32
  buffer_load_dwordx4 v[160:163], v6, s[12:15], 0 offen offset:0
SL32:
  v_mfma_f32_16x16x32_bf16 v[28:31], v[220:223], v[248:251], v[28:31]
  ds_read_b128 v[212:215], v99 offset:2048
  v_mfma_f32_16x16x32_bf16 v[32:35], v[220:223], v[252:255], v[32:35]
  v_mfma_f32_16x16x32_bf16 v[36:39], v[224:227], v[244:247], v[36:39]
  ds_read_b128 v[216:219], v99 offset:4096
  v_mfma_f32_16x16x32_bf16 v[40:43], v[224:227], v[248:251], v[40:43]
  ds_read_b128 v[184:187], v97 offset:0
  s_cbranch_vccz SL33
  buffer_load_dwordx4 v[164:167], v6, s[12:15], 0 offen offset:64
SL33:
  v_mfma_f32_16x16x32_bf16 v[44:47], v[224:227], v[252:255], v[44:47]
  v_mfma_f32_16x16x32_bf16 v[48:51], v[228:231], v[244:247], v[48:51]
  ds_read_b128 v[188:191], v97 offset:2048
  v_mfma_f32_16x16x32_bf16 v[52:55], v[228:231], v[248:251], v[52:55]
  ds_read_b128 v[192:195], v97 offset:4096
  v_mfma_f32_16x16x32_bf16 v[56:59], v[228:231], v[252:255], v[56:59]
  v_mfma_f32_16x16x32_bf16 v[60:63], v[232:235], v[244:247], v[60:63]
  ds_read_b128 v[196:199], v97 offset:6144
  s_cbranch_vccz SL34
  buffer_load_dwordx4 v[168:171], v6, s[12:15], 0 offen offset:128
SL34:
  v_mfma_f32_16x16x32_bf16 v[64:67], v[232:235], v[248:251], v[64:67]
  ds_read_b128 v[200:203], v97 offset:8192
  v_mfma_f32_16x16x32_bf16 v[68:71], v[232:235], v[252:255], v[68:71]
  v_mfma_f32_16x16x32_bf16 v[72:75], v[236:239], v[244:247], v[72:75]
  ds_read_b128 v[204:207], v97 offset:10240
  v_mfma_f32_16x16x32_bf16 v[76:79], v[236:239], v[248:251], v[76:79]
  s_cbranch_vccz SL35
  buffer_load_dwordx4 v[172:175], v6, s[12:15], 0 offen offset:192
SL35:
  v_mfma_f32_16x16x32_bf16 v[80:83], v[236:239], v[252:255], v[80:83]
  v_mfma_f32_16x16x32_bf16 v[84:87], v[240:243], v[244:247], v[84:87]
  v_mfma_f32_16x16x32_bf16 v[88:91], v[240:243], v[248:251], v[88:91]
  v_mfma_f32_16x16x32_bf16 v[92:95], v[240:243], v[252:255], v[92:95]
  s_cmp_eq_u32 s3, 0
  s_cbranch_scc1 MK_np2
  s_waitcnt lgkmcnt(0)
  ds_read_b64_tr_b16 v[104:105], v134 offset:0
  ds_read_b64_tr_b16 v[106:107], v134 offset:256
  ds_read_b64_tr_b16 v[108:109], v134 offset:2048
  ds_read_b64_tr_b16 v[110:111], v134 offset:2304
  ds_read_b64_tr_b16 v[112:113], v134 offset:4096
  ds_read_b64_tr_b16 v[114:115], v134 offset:4352
  ds_read_b64_tr_b16 v[116:117], v134 offset:6144
  ds_read_b64_tr_b16 v[118:119], v134 offset:6400
  ds_read_b64_tr_b16 v[120:121], v134 offset:8192
  ds_read_b64_tr_b16 v[122:123], v134 offset:8448
  ds_read_b64_tr_b16 v[124:125], v134 offset:10240
  ds_read_b64_tr_b16 v[126:127], v134 offset:10496
  s_setprio 3
  s_waitcnt lgkmcnt(0)
  v_mfma_f32_16x16x32_bf16 v[128:131], v[136:139], v[104:107], 0
  v_mfma_f32_16x16x32_bf16 v[128:131], v[140:143], v[108:111], v[128:131]
  v_mfma_f32_16x16x32_bf16 v[128:131], v[144:147], v[112:115], v[128:131]
  v_mfma_f32_16x16x32_bf16 v[128:131], v[148:151], v[116:119], v[128:131]
  v_mfma_f32_16x16x32_bf16 v[128:131], v[152:155], v[120:123], v[128:131]
  v_mfma_f32_16x16x32_bf16 v[128:131], v[156:159], v[124:127], v[128:131]
  s_lshl_b32 s100, s2, 10
  s_lshl_b32 s54, s26, 3
  s_add_u32 s100, s100, s54
  s_nop 5
  v_cvt_pk_bf16_f32 v132, v128, v129
  v_cvt_pk_bf16_f32 v133, v130, v131
  buffer_store_dwordx2 v[132:133], v1, s[20:23], s100 offen sc1
  s_setprio 0
MK_np2:
  s_cmp_lg_u32 s25, 0
  s_cbranch_scc1 MK_z1
  v_mov_b32 v136, 0
  v_mov_b32 v137, 0
  v_mov_b32 v138, 0
  v_mov_b32 v139, 0
  v_mov_b32 v140, 0
  v_mov_b32 v141, 0
  v_mov_b32 v142, 0
  v_mov_b32 v143, 0
  v_mov_b32 v144, 0
  v_mov_b32 v145, 0
  v_mov_b32 v146, 0
  v_mov_b32 v147, 0
  v_mov_b32 v148, 0
  v_mov_b32 v149, 0
  v_mov_b32 v150, 0
  v_mov_b32 v151, 0
  v_mov_b32 v152, 0
  v_mov_b32 v153, 0
  v_mov_b32 v154, 0
  v_mov_b32 v155, 0
  v_mov_b32 v156, 0
  v_mov_b32 v157, 0
  v_mov_b32 v158, 0
  v_mov_b32 v159, 0
MK_z1:
  ds_read_b128 v[244:247], v100 offset:0
  ds_read_b128 v[248:251], v100 offset:2048
  ds_read_b128 v[252:255], v100 offset:4096
  ds_read_b128 v[220:223], v98 offset:0
  ds_read_b128 v[224:227], v98 offset:2048
  s_waitcnt lgkmcnt(5)
  v_mfma_f32_16x16x32_bf16 v[24:27], v[184:187], v[208:211], v[24:27]
  ds_read_b128 v[228:231], v98 offset:4096
  s_cbranch_vccz SL36
  buffer_load_dwordx4 v[176:179], v6, s[12:15], 0 offen offset:256
SL36:
  v_mfma_f32_16x16x32_bf16 v[36:39], v[188:191], v[208:211], v[36:39]
  ds_read_b128 v[232:235], v98 offset:6144
  s_waitcnt lgkmcnt(2)
  v_mfma_f32_16x16x32_bf16 v[24:27], v[220:223], v[244:247], v[24:27]
  ds_read_b128 v[236:239], v98 offset:8192
  v_mfma_f32_16x16x32_bf16 v[36:39], v[224:227], v[244:247], v[36:39]
  ds_read_b128 v[240:243], v98 offset:10240
  v_mfma_f32_16x16x32_bf16 v[28:31], v[184:187], v[212:215], v[28:31]
  s_cbranch_vccz SL37
  buffer_load_dwordx4 v[180:183], v6, s[12:15], 0 offen offset:320
SL37:
  v_mfma_f32_16x16x32_bf16 v[40:43], v[188:191], v[212:215], v[40:43]
  v_mfma_f32_16x16x32_bf16 v[28:31], v[220:223], v[248:251], v[28:31]
  v_mfma_f32_16x16x32_bf16 v[40:43], v[224:227], v[248:251], v[40:43]
  v_mfma_f32_16x16x32_bf16 v[32:35], v[184:187], v[216:219], v[32:35]
  v_cvt_pk_bf16_f32 v104, v24, v25
  v_cvt_pk_bf16_f32 v105, v26, v27
  v_mfma_f32_16x16x32_bf16 v[44:47], v[188:191], v[216:219], v[44:47]
  v_cvt_pk_bf16_f32 v106, v36, v37
  v_cvt_pk_bf16_f32 v107, v38, v39
  s_cbranch_vccz SL38
  buffer_load_dwordx4 v[136:139], v5, s[12:15], 0 offen offset:0
SL38:
  v_mfma_f32_16x16x32_bf16 v[32:35], v[220:223], v[252:255], v[32:35]
  ds_write_b128 v101, v[104:107] offset:4096
  v_mfma_f32_16x16x32_bf16 v[44:47], v[224:227], v[252:255], v[44:47]
  v_mfma_f32_16x16x32_bf16 v[48:51], v[192:195], v[208:211], v[48:51]
  v_cvt_pk_bf16_f32 v108, v28, v29
  v_cvt_pk_bf16_f32 v109, v30, v31
  v_mfma_f32_16x16x32_bf16 v[60:63], v[196:199], v[208:211], v[60:63]
  v_cvt_pk_bf16_f32 v110, v40, v41
  v_cvt_pk_bf16_f32 v111, v42, v43
  s_cbranch_vccz SL39
  buffer_load_dwordx4 v[140:143], v5, s[12:15], 0 offen offset:64
SL39:
  s_waitcnt lgkmcnt(1)
  v_mfma_f32_16x16x32_bf16 v[48:51], v[228:231], v[244:247], v[48:51]
  ds_write_b128 v102, v[108:111] offset:4096
  v_mfma_f32_16x16x32_bf16 v[60:63], v[232:235], v[244:247], v[60:63]
  v_mfma_f32_16x16x32_bf16 v[52:55], v[192:195], v[212:215], v[52:55]
  v_cvt_pk_bf16_f32 v112, v32, v33
  v_cvt_pk_bf16_f32 v113, v34, v35
  v_mfma_f32_16x16x32_bf16 v[64:67], v[196:199], v[212:215], v[64:67]
  v_cvt_pk_bf16_f32 v114, v44, v45
  v_cvt_pk_bf16_f32 v115, v46, v47
  v_mfma_f32_16x16x32_bf16 v[52:55], v[228:231], v[248:251], v[52:55]
  ds_write_b128 v103, v[112:115] offset:4096
  s_cbranch_vccz SL40
  buffer_load_dwordx4 v[144:147], v5, s[12:15], 0 offen offset:128
SL40:
  v_mfma_f32_16x16x32_bf16 v[64:67], v[232:235], v[248:251], v[64:67]
  v_mfma_f32_16x16x32_bf16 v[56:59], v[192:195], v[216:219], v[56:59]
  v_cvt_pk_bf16_f32 v116, v48, v49
  v_cvt_pk_bf16_f32 v117, v50, v51
  v_mfma_f32_16x16x32_bf16 v[68:71], v[196:199], v[216:219], v[68:71]
  v_cvt_pk_bf16_f32 v118, v60, v61
  v_cvt_pk_bf16_f32 v119, v62, v63
  v_mfma_f32_16x16x32_bf16 v[56:59], v[228:231], v[252:255], v[56:59]
  ds_write_b128 v101, v[116:119] offset:2048
  s_cbranch_vccz SL41
  buffer_load_dwordx4 v[148:151], v5, s[12:15], 0 offen offset:192
SL41:
  v_mfma_f32_16x16x32_bf16 v[68:71], v[232:235], v[252:255], v[68:71]
  v_mfma_f32_16x16x32_bf16 v[72:75], v[200:203], v[208:211], v[72:75]
  v_cvt_pk_bf16_f32 v120, v52, v53
  v_cvt_pk_bf16_f32 v121, v54, v55
  v_mfma_f32_16x16x32_bf16 v[84:87], v[204:207], v[208:211], v[84:87]
  v_cvt_pk_bf16_f32 v122, v64, v65
  v_cvt_pk_bf16_f32 v123, v66, v67
  v_mfma_f32_16x16x32_bf16 v[72:75], v[236:239], v[244:247], v[72:75]
  ds_write_b128 v102, v[120:123] offset:2048
  v_mfma_f32_16x16x32_bf16 v[84:87], v[240:243], v[244:247], v[84:87]
  s_cbranch_vccz SL42
  buffer_load_dwordx4 v[152:155], v5, s[12:15], 0 offen offset:256
SL42:
  v_mfma_f32_16x16x32_bf16 v[76:79], v[200:203], v[212:215], v[76:79]
  v_cvt_pk_bf16_f32 v124, v56, v57
  v_cvt_pk_bf16_f32 v125, v58, v59
  v_mfma_f32_16x16x32_bf16 v[88:91], v[204:207], v[212:215], v[88:91]
  v_cvt_pk_bf16_f32 v126, v68, v69
  v_cvt_pk_bf16_f32 v127, v70, v71
  v_mfma_f32_16x16x32_bf16 v[76:79], v[236:239], v[248:251], v[76:79]
  ds_write_b128 v103, v[124:127] offset:2048
  v_mfma_f32_16x16x32_bf16 v[88:91], v[240:243], v[248:251], v[88:91]
  s_cbranch_vccz SL43
  buffer_load_dwordx4 v[156:159], v5, s[12:15], 0 offen offset:320
SL43:
  v_mfma_f32_16x16x32_bf16 v[80:83], v[200:203], v[216:219], v[80:83]
  v_cvt_pk_bf16_f32 v104, v72, v73
  v_cvt_pk_bf16_f32 v105, v74, v75
  v_mfma_f32_16x16x32_bf16 v[92:95], v[204:207], v[216:219], v[92:95]
  v_cvt_pk_bf16_f32 v106, v84, v85
  v_cvt_pk_bf16_f32 v107, v86, v87
  v_mfma_f32_16x16x32_bf16 v[80:83], v[236:239], v[252:255], v[80:83]
  ds_write_b128 v101, v[104:107] offset:0
  v_mfma_f32_16x16x32_bf16 v[92:95], v[240:243], v[252:255], v[92:95]
  v_cvt_pk_bf16_f32 v108, v76, v77
  v_cvt_pk_bf16_f32 v109, v78, v79
  v_cvt_pk_bf16_f32 v110, v88, v89
  v_cvt_pk_bf16_f32 v111, v90, v91
  ds_write_b128 v102, v[108:111] offset:0
  s_nop 3
  v_cvt_pk_bf16_f32 v112, v80, v81
  v_cvt_pk_bf16_f32 v113, v82, v83
  v_cvt_pk_bf16_f32 v114, v92, v93
  v_cvt_pk_bf16_f32 v115, v94, v95
  ds_write_b128 v103, v[112:115] offset:0
  s_waitcnt lgkmcnt(0)
  s_barrier
  ds_read_b128 v[216:219], v2 offset:35840
  ds_read_b128 v[220:223], v2 offset:34816
  ds_read_b128 v[224:227], v2 offset:33792
  ds_read_b128 v[228:231], v2 offset:32768
  ds_read_b128 v[232:235], v2 offset:31744
  ds_read_b128 v[236:239], v2 offset:30720
  ds_read_b128 v[240:243], v2 offset:29696
  ds_read_b128 v[244:247], v2 offset:28672
  ds_read_b128 v[248:251], v2 offset:27648
  ds_read_b128 v[252:255], v2 offset:26624
  s_cbranch_vccz SL44
  s_mul_i32 s100, s32, 9
  s_add_i32 s100, s100, s31
  s_add_u32 m0, s38, 138240
  s_nop 0
  buffer_load_dwordx4 v13, s[12:15], s100 offen lds
  s_add_u32 m0, s38, 139264
  s_nop 0
  buffer_load_dwordx4 v14, s[12:15], s100 offen lds
  s_add_u32 m0, s38, 140288
  s_nop 0
  buffer_load_dwordx4 v3, s[12:15], s100 offen lds
  s_add_u32 m0, s39, 138240
  s_nop 0
  buffer_load_dwordx4 v4, s[12:15], s100 offen lds
  s_mul_i32 s100, s32, 8
  s_add_i32 s100, s100, s31
  s_add_u32 m0, s38, 122880
  s_nop 0
  buffer_load_dwordx4 v13, s[12:15], s100 offen lds
  s_add_u32 m0, s38, 123904
  s_nop 0
  buffer_load_dwordx4 v14, s[12:15], s100 offen lds
  s_add_u32 m0, s38, 124928
  s_nop 0
  buffer_load_dwordx4 v3, s[12:15], s100 offen lds
  s_add_u32 m0, s39, 122880
  s_nop 0
  buffer_load_dwordx4 v4, s[12:15], s100 offen lds
  s_waitcnt vmcnt(8)
  s_branch SM44
SL44:
  s_cmp_lg_u32 s3, 0
  s_cbranch_scc1 MK_np4
  s_waitcnt vmcnt(0)
MK_np4:
  s_waitcnt vmcnt(1)
  s_setprio 1
SM44:
  s_waitcnt lgkmcnt(8)
  v_mfma_f32_16x16x32_bf16 v[184:187], v[216:219], v[136:139], 0
  v_mov_b32 v64, 0xff800000
  v_add_u32 v65, 0, v19
  v_mfma_f32_16x16x32_bf16 v[192:195], v[216:219], v[160:163], 0
  ds_read_b128 v[216:219], v2 offset:25600
  v_add_u32 v66, 1, v19
  v_mfma_f32_16x16x32_bf16 v[188:191], v[220:223], v[136:139], 0
  v_add_u32 v67, 2, v19
  v_add_u32 v68, 3, v19
  v_mfma_f32_16x16x32_bf16 v[196:199], v[220:223], v[160:163], 0
  ds_read_b128 v[220:223], v2 offset:24576
  s_waitcnt lgkmcnt(8)
  v_mfma_f32_16x16x32_bf16 v[184:187], v[224:227], v[140:143], v[184:187]
  v_cmp_gt_u32 s[48:49], 7, v65
  v_cmp_gt_u32 s[50:51], 7, v66
  v_mfma_f32_16x16x32_bf16 v[192:195], v[224:227], v[164:167], v[192:195]
  ds_read_b128 v[224:227], v2 offset:23552
  v_cmp_gt_u32 s[52:53], 7, v67
  v_mfma_f32_16x16x32_bf16 v[188:191], v[228:231], v[140:143], v[188:191]
  v_cmp_gt_u32 s[54:55], 7, v68
  v_sub_u32 v69, s35, v21
  v_mfma_f32_16x16x32_bf16 v[196:199], v[228:231], v[164:167], v[196:199]
  ds_read_b128 v[228:231], v2 offset:22528
  s_waitcnt lgkmcnt(8)
  v_mfma_f32_16x16x32_bf16 v[184:187], v[232:235], v[144:147], v[184:187]
  s_add_i32 s46, s34, 0
  v_sub_u32 v70, s46, v21
  v_mfma_f32_16x16x32_bf16 v[192:195], v[232:235], v[168:171], v[192:195]
  ds_read_b128 v[232:235], v2 offset:21504
  s_add_i32 s46, s34, 6
  v_mfma_f32_16x16x32_bf16 v[188:191], v[236:239], v[144:147], v[188:191]
  v_sub_u32 v71, s46, v21
  s_add_i32 s46, s34, 1
  v_mfma_f32_16x16x32_bf16 v[196:199], v[236:239], v[168:171], v[196:199]
  ds_read_b128 v[236:239], v2 offset:20480
  s_waitcnt lgkmcnt(8)
  v_mfma_f32_16x16x32_bf16 v[184:187], v[240:243], v[148:151], v[184:187]
  v_sub_u32 v72, s46, v22
  s_add_i32 s46, s34, 8
  v_mfma_f32_16x16x32_bf16 v[192:195], v[240:243], v[172:175], v[192:195]
  ds_read_b128 v[240:243], v2 offset:19456
  v_sub_u32 v73, s46, v22
  v_mfma_f32_16x16x32_bf16 v[188:191], v[244:247], v[148:151], v[188:191]
  v_cndmask_b32 v32, v64, 0, s[48:49]
  v_cndmask_b32 v33, v64, 0, s[50:51]
  v_mfma_f32_16x16x32_bf16 v[196:199], v[244:247], v[172:175], v[196:199]
  ds_read_b128 v[244:247], v2 offset:18432
  s_waitcnt lgkmcnt(8)
  v_mfma_f32_16x16x32_bf16 v[184:187], v[248:251], v[152:155], v[184:187]
  v_cndmask_b32 v34, v64, 0, s[52:53]
  v_cndmask_b32 v35, v64, 0, s[54:55]
  v_mfma_f32_16x16x32_bf16 v[192:195], v[248:251], v[176:179], v[192:195]
  ds_read_b128 v[248:251], v2 offset:17408
  v_cmp_gt_u32 s[46:47], 7, v69
  v_mfma_f32_16x16x32_bf16 v[188:191], v[252:255], v[152:155], v[188:191]
  v_cmp_gt_u32 s[48:49], 7, v70
  v_cmp_gt_u32 s[50:51], 7, v71
  v_mfma_f32_16x16x32_bf16 v[196:199], v[252:255], v[176:179], v[196:199]
  ds_read_b128 v[252:255], v2 offset:16384
  s_waitcnt lgkmcnt(8)
  v_mfma_f32_16x16x32_bf16 v[184:187], v[216:219], v[156:159], v[184:187]
  v_cmp_gt_u32 s[52:53], 7, v72
  v_cmp_gt_u32 s[54:55], 7, v73
  v_mfma_f32_16x16x32_bf16 v[192:195], v[216:219], v[180:183], v[192:195]
  ds_read_b128 v[216:219], v2 offset:15360
  v_cndmask_b32 v24, v64, v32, s[46:47]
  v_mfma_f32_16x16x32_bf16 v[188:191], v[220:223], v[156:159], v[188:191]
  v_cndmask_b32 v25, v64, v33, s[46:47]
  v_cndmask_b32 v26, v64, v34, s[46:47]
  v_mfma_f32_16x16x32_bf16 v[196:199], v[220:223], v[180:183], v[196:199]
  ds_read_b128 v[220:223], v2 offset:14336
  s_waitcnt lgkmcnt(8)
  v_mfma_f32_16x16x32_bf16 v[200:203], v[224:227], v[136:139], 0
  v_mul_f32 v192, s93, v192
  v_mul_f32 v193, s93, v193
  v_mfma_f32_16x16x32_bf16 v[208:211], v[224:227], v[160:163], 0
  ds_read_b128 v[224:227], v2 offset:13312
  v_mul_f32 v194, s93, v194
  v_mfma_f32_16x16x32_bf16 v[204:207], v[228:231], v[136:139], 0
  v_mul_f32 v195, s93, v195
  v_mul_f32 v196, s93, v196
  v_mfma_f32_16x16x32_bf16 v[212:215], v[228:231], v[160:163], 0
  ds_read_b128 v[228:231], v2 offset:12288
  s_waitcnt lgkmcnt(8)
  v_mfma_f32_16x16x32_bf16 v[200:203], v[232:235], v[140:143], v[200:203]
  v_mul_f32 v197, s93, v197
  v_mul_f32 v198, s93, v198
  v_mfma_f32_16x16x32_bf16 v[208:211], v[232:235], v[164:167], v[208:211]
  ds_read_b128 v[232:235], v2 offset:11264
  v_mul_f32 v199, s93, v199
  v_mfma_f32_16x16x32_bf16 v[204:207], v[236:239], v[140:143], v[204:207]
  v_cvt_pk_bf16_f32 v112, v192, v193
  v_cvt_pk_bf16_f32 v113, v194, v195
  v_mfma_f32_16x16x32_bf16 v[212:215], v[236:239], v[164:167], v[212:215]
  ds_read_b128 v[236:239], v2 offset:10240
  s_waitcnt lgkmcnt(8)
  v_mfma_f32_16x16x32_bf16 v[200:203], v[240:243], v[144:147], v[200:203]
  v_cvt_pk_bf16_f32 v114, v196, v197
  v_cvt_pk_bf16_f32 v115, v198, v199
  v_mfma_f32_16x16x32_bf16 v[208:211], v[240:243], v[168:171], v[208:211]
  ds_read_b128 v[240:243], v2 offset:9216
  v_mul_f32 v184, s93, v184
  v_mfma_f32_16x16x32_bf16 v[204:207], v[244:247], v[144:147], v[204:207]
  v_mul_f32 v185, s93, v185
  v_mul_f32 v186, s93, v186
  v_mfma_f32_16x16x32_bf16 v[212:215], v[244:247], v[168:171], v[212:215]
  ds_read_b128 v[244:247], v2 offset:8192
  s_waitcnt lgkmcnt(8)
  v_mfma_f32_16x16x32_bf16 v[200:203], v[248:251], v[148:151], v[200:203]
  v_mul_f32 v187, s93, v187
  v_mul_f32 v188, s93, v188
  v_mfma_f32_16x16x32_bf16 v[208:211], v[248:251], v[172:175], v[208:211]
  ds_read_b128 v[248:251], v2 offset:7168
  v_mul_f32 v189, s93, v189
  v_mfma_f32_16x16x32_bf16 v[204:207], v[252:255], v[148:151], v[204:207]
  v_mul_f32 v190, s93, v190
  v_mul_f32 v191, s93, v191
  v_mfma_f32_16x16x32_bf16 v[212:215], v[252:255], v[172:175], v[212:215]
  ds_read_b128 v[252:255], v2 offset:6144
  s_waitcnt lgkmcnt(8)
  v_mfma_f32_16x16x32_bf16 v[200:203], v[216:219], v[152:155], v[200:203]
  v_cvt_pk_bf16_f32 v88, v184, v185
  v_cvt_pk_bf16_f32 v89, v186, v187
  v_mfma_f32_16x16x32_bf16 v[208:211], v[216:219], v[176:179], v[208:211]
  ds_read_b128 v[216:219], v2 offset:5120
  v_cvt_pk_bf16_f32 v90, v188, v189
  v_mfma_f32_16x16x32_bf16 v[204:207], v[220:223], v[152:155], v[204:207]
  v_cvt_pk_bf16_f32 v91, v190, v191
  v_cndmask_b32 v27, v64, v35, s[46:47]
  v_mfma_f32_16x16x32_bf16 v[212:215], v[220:223], v[176:179], v[212:215]
  ds_read_b128 v[220:223], v2 offset:4096
  s_waitcnt lgkmcnt(8)
  v_mfma_f32_16x16x32_bf16 v[200:203], v[224:227], v[156:159], v[200:203]
  v_cndmask_b32 v28, v64, v32, s[48:49]
  v_cndmask_b32 v29, v64, v33, s[48:49]
  v_mfma_f32_16x16x32_bf16 v[208:211], v[224:227], v[180:183], v[208:211]
  ds_read_b128 v[224:227], v2 offset:3072
  v_cndmask_b32 v30, v64, v34, s[48:49]
  v_mfma_f32_16x16x32_bf16 v[204:207], v[228:231], v[156:159], v[204:207]
  v_cndmask_b32 v31, v64, v35, s[48:49]
  v_mfma_f32_16x16x32_bf16 v[212:215], v[228:231], v[180:183], v[212:215]
  ds_read_b128 v[228:231], v2 offset:2048
  s_waitcnt lgkmcnt(8)
  v_mfma_f32_16x16x32_bf16 v[184:187], v[232:235], v[136:139], 0
  v_mul_f32 v208, s93, v208
  v_mul_f32 v209, s93, v209
  v_mfma_f32_16x16x32_bf16 v[192:195], v[232:235], v[160:163], 0
  ds_read_b128 v[232:235], v2 offset:1024
  v_mul_f32 v210, s93, v210
  v_mfma_f32_16x16x32_bf16 v[188:191], v[236:239], v[136:139], 0
  v_mul_f32 v211, s93, v211
  v_mul_f32 v212, s93, v212
  v_mfma_f32_16x16x32_bf16 v[196:199], v[236:239], v[160:163], 0
  ds_read_b128 v[236:239], v2 offset:0
  s_waitcnt lgkmcnt(8)
  v_mfma_f32_16x16x32_bf16 v[184:187], v[240:243], v[140:143], v[184:187]
  v_mul_f32 v213, s93, v213
  v_mul_f32 v214, s93, v214
  v_mfma_f32_16x16x32_bf16 v[192:195], v[240:243], v[164:167], v[192:195]
  ds_read_b128 v[240:243], v1 offset:35840
  v_mul_f32 v215, s93, v215
  v_mfma_f32_16x16x32_bf16 v[188:191], v[244:247], v[140:143], v[188:191]
  v_cvt_pk_bf16_f32 v116, v208, v209
  v_cvt_pk_bf16_f32 v117, v210, v211
  v_mfma_f32_16x16x32_bf16 v[196:199], v[244:247], v[164:167], v[196:199]
  ds_read_b128 v[244:247], v1 offset:34816
  s_waitcnt lgkmcnt(8)
  v_mfma_f32_16x16x32_bf16 v[184:187], v[248:251], v[144:147], v[184:187]
  v_cvt_pk_bf16_f32 v118, v212, v213
  v_cvt_pk_bf16_f32 v119, v214, v215
  v_mfma_f32_16x16x32_bf16 v[192:195], v[248:251], v[168:171], v[192:195]
  ds_read_b128 v[248:251], v1 offset:33792
  v_mul_f32 v200, s93, v200
  v_mfma_f32_16x16x32_bf16 v[188:191], v[252:255], v[144:147], v[188:191]
  v_mul_f32 v201, s93, v201
  v_mul_f32 v202, s93, v202
  v_mfma_f32_16x16x32_bf16 v[196:199], v[252:255], v[168:171], v[196:199]
  ds_read_b128 v[252:255], v1 offset:32768
  s_waitcnt lgkmcnt(8)
  v_mfma_f32_16x16x32_bf16 v[184:187], v[216:219], v[148:151], v[184:187]
  v_mul_f32 v203, s93, v203
  v_mul_f32 v204, s93, v204
  v_mfma_f32_16x16x32_bf16 v[192:195], v[216:219], v[172:175], v[192:195]
  ds_read_b128 v[216:219], v1 offset:31744
  v_mul_f32 v205, s93, v205
  s_cbranch_vccz SL45
  s_barrier
  s_branch SM45
SL45:
  s_cmp_eq_u32 s3, 0
  s_cbranch_scc1 MK_np5
  s_waitcnt vmcnt(0)
  v_mov_b32 v23, 1
  s_mov_b64 exec, 1
  s_lshl_b32 s100, s26, 7
  buffer_atomic_add v23, off, s[8:11], s100 sc1
  s_mov_b64 exec, -1
  s_nop 3
MK_np5:
SM45:
  v_mfma_f32_16x16x32_bf16 v[188:191], v[220:223], v[148:151], v[188:191]
  v_mul_f32 v206, s93, v206
  v_mul_f32 v207, s93, v207
  v_mfma_f32_16x16x32_bf16 v[196:199], v[220:223], v[172:175], v[196:199]
  ds_read_b128 v[220:223], v1 offset:30720
  s_waitcnt lgkmcnt(8)
  v_mfma_f32_16x16x32_bf16 v[184:187], v[224:227], v[152:155], v[184:187]
  v_cvt_pk_bf16_f32 v92, v200, v201
  v_cvt_pk_bf16_f32 v93, v202, v203
  v_mfma_f32_16x16x32_bf16 v[192:195], v[224:227], v[176:179], v[192:195]
  ds_read_b128 v[224:227], v1 offset:29696
  v_cvt_pk_bf16_f32 v94, v204, v205
  v_mfma_f32_16x16x32_bf16 v[188:191], v[228:231], v[152:155], v[188:191]
  v_cvt_pk_bf16_f32 v95, v206, v207
  v_cndmask_b32 v52, v64, v32, s[50:51]
  v_mfma_f32_16x16x32_bf16 v[196:199], v[228:231], v[176:179], v[196:199]
  ds_read_b128 v[228:231], v1 offset:28672
  s_waitcnt lgkmcnt(8)
  v_mfma_f32_16x16x32_bf16 v[184:187], v[232:235], v[156:159], v[184:187]
  v_cndmask_b32 v53, v64, v33, s[50:51]
  v_cndmask_b32 v54, v64, v34, s[50:51]
  v_mfma_f32_16x16x32_bf16 v[192:195], v[232:235], v[180:183], v[192:195]
  ds_read_b128 v[232:235], v1 offset:27648
  v_cndmask_b32 v55, v64, v35, s[50:51]
  v_mfma_f32_16x16x32_bf16 v[188:191], v[236:239], v[156:159], v[188:191]
  v_mfma_f32_16x16x32_bf16 v[196:199], v[236:239], v[180:183], v[196:199]
  ds_read_b128 v[236:239], v1 offset:26624
  s_waitcnt lgkmcnt(8)
  v_mfma_f32_16x16x32_bf16 v[200:203], v[240:243], v[136:139], 0
  v_mul_f32 v184, s93, v184
  v_mul_f32 v192, s93, v192
  v_mfma_f32_16x16x32_bf16 v[208:211], v[240:243], v[160:163], 0
  ds_read_b128 v[240:243], v1 offset:25600
  v_mul_f32 v193, s93, v193
  v_mfma_f32_16x16x32_bf16 v[204:207], v[244:247], v[136:139], 0
  v_mul_f32 v194, s93, v194
  v_mul_f32 v195, s93, v195
  v_mfma_f32_16x16x32_bf16 v[212:215], v[244:247], v[160:163], 0
  ds_read_b128 v[244:247], v1 offset:24576
  s_waitcnt lgkmcnt(8)
  v_mfma_f32_16x16x32_bf16 v[200:203], v[248:251], v[140:143], v[200:203]
  v_mul_f32 v196, s93, v196
  v_mul_f32 v197, s93, v197
  v_mfma_f32_16x16x32_bf16 v[208:211], v[248:251], v[164:167], v[208:211]
  ds_read_b128 v[248:251], v1 offset:23552
  v_mul_f32 v198, s93, v198
  v_mfma_f32_16x16x32_bf16 v[204:207], v[252:255], v[140:143], v[204:207]
  v_mul_f32 v199, s93, v199
  v_cvt_pk_bf16_f32 v120, v192, v193
  v_mfma_f32_16x16x32_bf16 v[212:215], v[252:255], v[164:167], v[212:215]
  ds_read_b128 v[252:255], v1 offset:22528
  s_waitcnt lgkmcnt(8)
  v_mfma_f32_16x16x32_bf16 v[200:203], v[216:219], v[144:147], v[200:203]
  v_cvt_pk_bf16_f32 v121, v194, v195
  v_cvt_pk_bf16_f32 v122, v196, v197
  v_mfma_f32_16x16x32_bf16 v[208:211], v[216:219], v[168:171], v[208:211]
  ds_read_b128 v[216:219], v1 offset:21504
  v_cvt_pk_bf16_f32 v123, v198, v199
  v_mfma_f32_16x16x32_bf16 v[204:207], v[220:223], v[144:147], v[204:207]
  v_mul_f32 v185, s93, v185
  v_mul_f32 v186, s93, v186
  v_mfma_f32_16x16x32_bf16 v[212:215], v[220:223], v[168:171], v[212:215]
  ds_read_b128 v[220:223], v1 offset:20480
  s_waitcnt lgkmcnt(8)
  v_mfma_f32_16x16x32_bf16 v[200:203], v[224:227], v[148:151], v[200:203]
  v_mul_f32 v187, s93, v187
  v_mul_f32 v188, s93, v188
  v_mfma_f32_16x16x32_bf16 v[208:211], v[224:227], v[172:175], v[208:211]
  ds_read_b128 v[224:227], v1 offset:19456
  v_mul_f32 v189, s93, v189
  v_mfma_f32_16x16x32_bf16 v[204:207], v[228:231], v[148:151], v[204:207]
  v_mul_f32 v190, s93, v190
  v_mul_f32 v191, s93, v191
  v_mfma_f32_16x16x32_bf16 v[212:215], v[228:231], v[172:175], v[212:215]
  ds_read_b128 v[228:231], v1 offset:18432
  s_waitcnt lgkmcnt(8)
  v_mfma_f32_16x16x32_bf16 v[200:203], v[232:235], v[152:155], v[200:203]
  v_cvt_pk_bf16_f32 v96, v184, v185
  v_cvt_pk_bf16_f32 v97, v186, v187
  v_mfma_f32_16x16x32_bf16 v[208:211], v[232:235], v[176:179], v[208:211]
  ds_read_b128 v[232:235], v1 offset:17408
  v_cvt_pk_bf16_f32 v98, v188, v189
  v_mfma_f32_16x16x32_bf16 v[204:207], v[236:239], v[152:155], v[204:207]
  v_cvt_pk_bf16_f32 v99, v190, v191
  v_cndmask_b32 v56, v64, v32, s[52:53]
  v_mfma_f32_16x16x32_bf16 v[212:215], v[236:239], v[176:179], v[212:215]
  ds_read_b128 v[236:239], v1 offset:16384
  s_waitcnt lgkmcnt(8)
  v_mfma_f32_16x16x32_bf16 v[200:203], v[240:243], v[156:159], v[200:203]
  v_cndmask_b32 v57, v64, v33, s[52:53]
  v_cndmask_b32 v58, v64, v34, s[52:53]
  v_mfma_f32_16x16x32_bf16 v[208:211], v[240:243], v[180:183], v[208:211]
  ds_read_b128 v[240:243], v1 offset:15360
  v_cndmask_b32 v59, v64, v35, s[52:53]
  v_mfma_f32_16x16x32_bf16 v[204:207], v[244:247], v[156:159], v[204:207]
  v_cndmask_b32 v84, v64, v32, s[54:55]
  v_mfma_f32_16x16x32_bf16 v[212:215], v[244:247], v[180:183], v[212:215]
  ds_read_b128 v[244:247], v1 offset:14336
  s_waitcnt lgkmcnt(8)
  v_mfma_f32_16x16x32_bf16 v[184:187], v[248:251], v[136:139], 0
  v_mul_f32 v208, s93, v208
  v_mul_f32 v209, s93, v209
  v_mfma_f32_16x16x32_bf16 v[192:195], v[248:251], v[160:163], 0
  ds_read_b128 v[248:251], v1 offset:13312
  v_mul_f32 v210, s93, v210
  v_mfma_f32_16x16x32_bf16 v[188:191], v[252:255], v[136:139], 0
  v_mul_f32 v211, s93, v211
  v_mul_f32 v212, s93, v212
  v_mfma_f32_16x16x32_bf16 v[196:199], v[252:255], v[160:163], 0
  ds_read_b128 v[252:255], v1 offset:12288
  s_waitcnt lgkmcnt(8)
  v_mfma_f32_16x16x32_bf16 v[184:187], v[216:219], v[140:143], v[184:187]
  v_mul_f32 v213, s93, v213
  v_mul_f32 v214, s93, v214
  v_mfma_f32_16x16x32_bf16 v[192:195], v[216:219], v[164:167], v[192:195]
  ds_read_b128 v[216:219], v1 offset:11264
  v_mul_f32 v215, s93, v215
  v_mfma_f32_16x16x32_bf16 v[188:191], v[220:223], v[140:143], v[188:191]
  v_cvt_pk_bf16_f32 v124, v208, v209
  v_cvt_pk_bf16_f32 v125, v210, v211
  v_mfma_f32_16x16x32_bf16 v[196:199], v[220:223], v[164:167], v[196:199]
  ds_read_b128 v[220:223], v1 offset:10240
  s_waitcnt lgkmcnt(8)
  v_mfma_f32_16x16x32_bf16 v[184:187], v[224:227], v[144:147], v[184:187]
  v_cvt_pk_bf16_f32 v126, v212, v213
  v_cvt_pk_bf16_f32 v127, v214, v215
  v_mfma_f32_16x16x32_bf16 v[192:195], v[224:227], v[168:171], v[192:195]
  ds_read_b128 v[224:227], v1 offset:9216
  v_mul_f32 v200, s93, v200
  v_mfma_f32_16x16x32_bf16 v[188:191], v[228:231], v[144:147], v[188:191]
  v_mul_f32 v201, s93, v201
  v_mul_f32 v202, s93, v202
  v_mfma_f32_16x16x32_bf16 v[196:199], v[228:231], v[168:171], v[196:199]
  ds_read_b128 v[228:231], v1 offset:8192
  s_waitcnt lgkmcnt(8)
  v_mfma_f32_16x16x32_bf16 v[184:187], v[232:235], v[148:151], v[184:187]
  v_mul_f32 v203, s93, v203
  v_mul_f32 v204, s93, v204
  v_mfma_f32_16x16x32_bf16 v[192:195], v[232:235], v[172:175], v[192:195]
  ds_read_b128 v[232:235], v1 offset:7168
  v_mul_f32 v205, s93, v205
  v_mfma_f32_16x16x32_bf16 v[188:191], v[236:239], v[148:151], v[188:191]
  v_mul_f32 v206, s93, v206
  v_mul_f32 v207, s93, v207
  v_mfma_f32_16x16x32_bf16 v[196:199], v[236:239], v[172:175], v[196:199]
  ds_read_b128 v[236:239], v1 offset:6144
  s_waitcnt lgkmcnt(8)
  v_mfma_f32_16x16x32_bf16 v[184:187], v[240:243], v[152:155], v[184:187]
  v_cvt_pk_bf16_f32 v100, v200, v201
  v_cvt_pk_bf16_f32 v101, v202, v203
  v_mfma_f32_16x16x32_bf16 v[192:195], v[240:243], v[176:179], v[192:195]
  ds_read_b128 v[240:243], v1 offset:5120
  v_cvt_pk_bf16_f32 v102, v204, v205
  v_mfma_f32_16x16x32_bf16 v[188:191], v[244:247], v[152:155], v[188:191]
  v_cvt_pk_bf16_f32 v103, v206, v207
  v_cndmask_b32 v85, v64, v33, s[54:55]
  v_mfma_f32_16x16x32_bf16 v[196:199], v[244:247], v[176:179], v[196:199]
  ds_read_b128 v[244:247], v1 offset:4096
  s_waitcnt lgkmcnt(8)
  v_mfma_f32_16x16x32_bf16 v[184:187], v[248:251], v[156:159], v[184:187]
  v_cndmask_b32 v86, v64, v34, s[54:55]
  v_cndmask_b32 v87, v64, v35, s[54:55]
  v_mfma_f32_16x16x32_bf16 v[192:195], v[248:251], v[180:183], v[192:195]
  ds_read_b128 v[248:251], v1 offset:3072
  v_mfma_f32_16x16x32_bf16 v[188:191], v[252:255], v[156:159], v[188:191]
  v_mfma_f32_16x16x32_bf16 v[196:199], v[252:255], v[180:183], v[196:199]
  ds_read_b128 v[252:255], v1 offset:2048
  s_waitcnt lgkmcnt(8)
  v_mfma_f32_16x16x32_bf16 v[200:203], v[216:219], v[136:139], 0
  v_mul_f32 v184, s93, v184
  v_mul_f32 v185, s93, v185
  v_mfma_f32_16x16x32_bf16 v[208:211], v[216:219], v[160:163], 0
  ds_read_b128 v[216:219], v1 offset:1024
  v_mul_f32 v192, s93, v192
  s_cbranch_vccz SL46
  s_waitcnt vmcnt(0)
  s_barrier
SL46:
  v_mfma_f32_16x16x32_bf16 v[204:207], v[220:223], v[136:139], 0
  v_mul_f32 v193, s93, v193
  v_mul_f32 v194, s93, v194
  v_mfma_f32_16x16x32_bf16 v[212:215], v[220:223], v[160:163], 0
  ds_read_b128 v[220:223], v1 offset:0
  s_waitcnt lgkmcnt(8)
  v_mfma_f32_16x16x32_bf16 v[200:203], v[224:227], v[140:143], v[200:203]
  v_mul_f32 v195, s93, v195
  v_mul_f32 v196, s93, v196
  v_mfma_f32_16x16x32_bf16 v[208:211], v[224:227], v[164:167], v[208:211]
  v_mul_f32 v197, s93, v197
  v_mul_f32 v198, s93, v198
  v_mfma_f32_16x16x32_bf16 v[204:207], v[228:231], v[140:143], v[204:207]
  v_mul_f32 v199, s93, v199
  v_cvt_pk_bf16_f32 v128, v192, v193
  v_mfma_f32_16x16x32_bf16 v[212:215], v[228:231], v[164:167], v[212:215]
  v_cvt_pk_bf16_f32 v129, v194, v195
  s_waitcnt lgkmcnt(6)
  v_mfma_f32_16x16x32_bf16 v[200:203], v[232:235], v[144:147], v[200:203]
  v_cvt_pk_bf16_f32 v130, v196, v197
  v_cvt_pk_bf16_f32 v131, v198, v199
  v_mfma_f32_16x16x32_bf16 v[208:211], v[232:235], v[168:171], v[208:211]
  v_mul_f32 v186, s93, v186
  v_mul_f32 v187, s93, v187
  v_mfma_f32_16x16x32_bf16 v[204:207], v[236:239], v[144:147], v[204:207]
  v_mul_f32 v188, s93, v188
  v_mul_f32 v189, s93, v189
  v_mfma_f32_16x16x32_bf16 v[212:215], v[236:239], v[168:171], v[212:215]
  v_mul_f32 v190, s93, v190
  s_waitcnt lgkmcnt(5)
  v_mfma_f32_16x16x32_bf16 v[200:203], v[240:243], v[148:151], v[200:203]
  v_mul_f32 v191, s93, v191
  v_cvt_pk_bf16_f32 v104, v184, v185
  v_mfma_f32_16x16x32_bf16 v[208:211], v[240:243], v[172:175], v[208:211]
  v_cvt_pk_bf16_f32 v105, v186, v187
  s_waitcnt lgkmcnt(4)
  v_mfma_f32_16x16x32_bf16 v[204:207], v[244:247], v[148:151], v[204:207]
  v_cvt_pk_bf16_f32 v106, v188, v189
  v_cvt_pk_bf16_f32 v107, v190, v191
  v_mfma_f32_16x16x32_bf16 v[212:215], v[244:247], v[172:175], v[212:215]
  s_waitcnt lgkmcnt(3)
  v_mfma_f32_16x16x32_bf16 v[200:203], v[248:251], v[152:155], v[200:203]
  v_mfma_f32_16x16x32_bf16 v[208:211], v[248:251], v[176:179], v[208:211]
  s_waitcnt lgkmcnt(2)
  v_mfma_f32_16x16x32_bf16 v[204:207], v[252:255], v[152:155], v[204:207]
  v_mfma_f32_16x16x32_bf16 v[212:215], v[252:255], v[176:179], v[212:215]
  s_waitcnt lgkmcnt(1)
  v_mfma_f32_16x16x32_bf16 v[200:203], v[216:219], v[156:159], v[200:203]
  v_mfma_f32_16x16x32_bf16 v[208:211], v[216:219], v[180:183], v[208:211]
  s_waitcnt lgkmcnt(0)
  v_mfma_f32_16x16x32_bf16 v[204:207], v[220:223], v[156:159], v[204:207]
  v_mfma_f32_16x16x32_bf16 v[212:215], v[220:223], v[180:183], v[212:215]
  s_cbranch_vccnz SL47
  s_setprio 0
  s_mul_i32 s100, s32, 7
  s_add_i32 s100, s100, s31
  s_add_u32 m0, s38, 107520
  s_nop 0
  buffer_load_dwordx4 v13, s[12:15], s100 offen lds
  s_add_u32 m0, s38, 108544
  s_nop 0
  buffer_load_dwordx4 v14, s[12:15], s100 offen lds
  s_add_u32 m0, s38, 109568
  s_nop 0
  buffer_load_dwordx4 v3, s[12:15], s100 offen lds
  s_add_u32 m0, s39, 107520
  s_nop 0
  buffer_load_dwordx4 v4, s[12:15], s100 offen lds
  s_mul_i32 s100, s32, 6
  s_add_i32 s100, s100, s31
  s_add_u32 m0, s38, 92160
  s_nop 0
  buffer_load_dwordx4 v13, s[12:15], s100 offen lds
  s_add_u32 m0, s38, 93184
  s_nop 0
  buffer_load_dwordx4 v14, s[12:15], s100 offen lds
  s_add_u32 m0, s38, 94208
  s_nop 0
  buffer_load_dwordx4 v3, s[12:15], s100 offen lds
  s_add_u32 m0, s39, 92160
  s_nop 0
  buffer_load_dwordx4 v4, s[12:15], s100 offen lds
  s_mul_i32 s100, s32, 5
  s_add_i32 s100, s100, s31
  s_add_u32 m0, s38, 76800
  s_nop 0
  buffer_load_dwordx4 v13, s[12:15], s100 offen lds
  s_add_u32 m0, s38, 77824
  s_nop 0
  buffer_load_dwordx4 v14, s[12:15], s100 offen lds
  s_add_u32 m0, s38, 78848
  s_nop 0
  buffer_load_dwordx4 v3, s[12:15], s100 offen lds
  s_add_u32 m0, s39, 76800
  s_nop 0
  buffer_load_dwordx4 v4, s[12:15], s100 offen lds
  s_barrier
  s_mul_i32 s100, s32, 4
  s_add_i32 s100, s100, s31
  s_add_u32 m0, s38, 61440
  s_nop 0
  buffer_load_dwordx4 v13, s[12:15], s100 offen lds
  s_add_u32 m0, s38, 62464
  s_nop 0
  buffer_load_dwordx4 v14, s[12:15], s100 offen lds
  s_add_u32 m0, s38, 63488
  s_nop 0
  buffer_load_dwordx4 v3, s[12:15], s100 offen lds
  s_add_u32 m0, s39, 61440
  s_nop 0
  buffer_load_dwordx4 v4, s[12:15], s100 offen lds
  s_mul_i32 s100, s32, 3
  s_add_i32 s100, s100, s31
  s_add_u32 m0, s38, 46080
  s_nop 0
  buffer_load_dwordx4 v13, s[12:15], s100 offen lds
  s_add_u32 m0, s38, 47104
  s_nop 0
  buffer_load_dwordx4 v14, s[12:15], s100 offen lds
  s_add_u32 m0, s38, 48128
  s_nop 0
  buffer_load_dwordx4 v3, s[12:15], s100 offen lds
  s_add_u32 m0, s39, 46080
  s_nop 0
  buffer_load_dwordx4 v4, s[12:15], s100 offen lds
  s_mul_i32 s100, s32, 2
  s_add_i32 s100, s100, s31
  s_add_u32 m0, s38, 30720
  s_nop 0
  buffer_load_dwordx4 v13, s[12:15], s100 offen lds
  s_add_u32 m0, s38, 31744
  s_nop 0
  buffer_load_dwordx4 v14, s[12:15], s100 offen lds
  s_add_u32 m0, s38, 32768
  s_nop 0
  buffer_load_dwordx4 v3, s[12:15], s100 offen lds
  s_add_u32 m0, s39, 30720
  s_nop 0
  buffer_load_dwordx4 v4, s[12:15], s100 offen lds
  s_waitcnt vmcnt(12)
  s_barrier
  s_max_u32 s100, s33, 1
  s_mul_i32 s100, s100, s32
  s_add_i32 s100, s100, s31
  s_add_u32 m0, s38, 15360
  s_nop 0
  buffer_load_dwordx4 v13, s[12:15], s100 offen lds
  s_add_u32 m0, s38, 16384
  s_nop 0
  buffer_load_dwordx4 v14, s[12:15], s100 offen lds
  s_add_u32 m0, s38, 17408
  s_nop 0
  buffer_load_dwordx4 v3, s[12:15], s100 offen lds
  s_add_u32 m0, s39, 15360
  s_nop 0
  buffer_load_dwordx4 v4, s[12:15], s100 offen lds
  s_max_u32 s100, s33, 0
  s_mul_i32 s100, s100, s32
  s_add_i32 s100, s100, s31
  s_add_u32 m0, s38, 0
  s_nop 0
  buffer_load_dwordx4 v13, s[12:15], s100 offen lds
  s_add_u32 m0, s38, 1024
  s_nop 0
  buffer_load_dwordx4 v14, s[12:15], s100 offen lds
  s_add_u32 m0, s38, 2048
  s_nop 0
  buffer_load_dwordx4 v3, s[12:15], s100 offen lds
  s_add_u32 m0, s39, 0
  s_nop 0
  buffer_load_dwordx4 v4, s[12:15], s100 offen lds
  s_waitcnt vmcnt(8)
  s_barrier
SL47:
  ds_read_b128 v[224:227], v7 offset:61440
  ds_read_b128 v[228:231], v8 offset:61440
  ds_read_b128 v[232:235], v7 offset:61568
  ds_read_b128 v[236:239], v8 offset:61568
  ds_read_b128 v[240:243], v7 offset:61696
  ds_read_b128 v[244:247], v8 offset:61696
  ds_read_b128 v[248:251], v7 offset:53760
  ds_read_b128 v[252:255], v8 offset:53760
  ds_read_b128 v[216:219], v7 offset:53888
  ds_read_b128 v[220:223], v8 offset:53888
  s_waitcnt lgkmcnt(8)
  v_mfma_f32_16x16x32_bf16 v[84:87], v[224:227], v[112:115], v[84:87]
  ds_read_b128 v[224:227], v7 offset:54016
  v_mul_f32 v208, s93, v208
  v_mfma_f32_16x16x32_bf16 v[84:87], v[228:231], v[116:119], v[84:87]
  ds_read_b128 v[228:231], v8 offset:54016
  s_waitcnt lgkmcnt(8)
  v_mfma_f32_16x16x32_bf16 v[84:87], v[232:235], v[120:123], v[84:87]
  ds_read_b128 v[232:235], v7 offset:46080
  v_mul_f32 v209, s93, v209
  v_mfma_f32_16x16x32_bf16 v[84:87], v[236:239], v[124:127], v[84:87]
  ds_read_b128 v[236:239], v8 offset:46080
  s_waitcnt lgkmcnt(8)
  v_mfma_f32_16x16x32_bf16 v[84:87], v[240:243], v[128:131], v[84:87]
  ds_read_b128 v[240:243], v7 offset:46208
  v_mul_f32 v210, s93, v210
  v_mul_f32 v211, s93, v211
  v_mul_f32 v212, s93, v212
  v_mul_f32 v213, s93, v213
  v_mul_f32 v214, s93, v214
  v_mul_f32 v215, s93, v215
  v_cvt_pk_bf16_f32 v132, v208, v209
  v_cvt_pk_bf16_f32 v133, v210, v211
  v_cvt_pk_bf16_f32 v134, v212, v213
  v_cvt_pk_bf16_f32 v135, v214, v215
  s_nop 1
  v_mfma_f32_16x16x32_bf16 v[84:87], v[244:247], v[132:135], v[84:87]
  ds_read_b128 v[244:247], v8 offset:46208
  s_waitcnt lgkmcnt(8)
  v_mfma_f32_16x16x32_bf16 v[80:83], v[248:251], v[112:115], v[32:35]
  ds_read_b128 v[248:251], v7 offset:46336
  v_mul_f32 v200, s93, v200
  v_mfma_f32_16x16x32_bf16 v[80:83], v[252:255], v[116:119], v[80:83]
  ds_read_b128 v[252:255], v8 offset:46336
  s_waitcnt lgkmcnt(8)
  v_mfma_f32_16x16x32_bf16 v[80:83], v[216:219], v[120:123], v[80:83]
  ds_read_b128 v[216:219], v7 offset:38400
  v_mul_f32 v201, s93, v201
  v_mfma_f32_16x16x32_bf16 v[80:83], v[220:223], v[124:127], v[80:83]
  ds_read_b128 v[220:223], v8 offset:38400
  s_waitcnt lgkmcnt(8)
  v_mfma_f32_16x16x32_bf16 v[80:83], v[224:227], v[128:131], v[80:83]
  ds_read_b128 v[224:227], v7 offset:38528
  v_mul_f32 v202, s93, v202
  v_mfma_f32_16x16x32_bf16 v[80:83], v[228:231], v[132:135], v[80:83]
  ds_read_b128 v[228:231], v8 offset:38528
  s_cbranch_vccz SL48
  s_barrier
  s_branch SM48
SL48:
  s_waitcnt vmcnt(0)
  s_barrier
SM48:
  s_waitcnt lgkmcnt(8)
  v_mfma_f32_16x16x32_bf16 v[76:79], v[232:235], v[112:115], v[32:35]
  v_exp_f32 v196, v84
  v_mfma_f32_16x16x32_bf16 v[52:55], v[232:235], v[88:91], v[52:55]
  v_exp_f32 v197, v85
  v_mfma_f32_16x16x32_bf16 v[76:79], v[236:239], v[116:119], v[76:79]
  v_exp_f32 v198, v86
  v_mfma_f32_16x16x32_bf16 v[52:55], v[236:239], v[92:95], v[52:55]
  ds_read_b128 v[232:235], v7 offset:38656
  s_waitcnt lgkmcnt(7)
  v_mfma_f32_16x16x32_bf16 v[76:79], v[240:243], v[120:123], v[76:79]
  v_exp_f32 v199, v87
  v_mfma_f32_16x16x32_bf16 v[52:55], v[240:243], v[96:99], v[52:55]
  ds_read_b128 v[236:239], v8 offset:38656
  ds_read_b128 v[240:243], v7 offset:30720
  v_mfma_f32_16x16x32_bf16 v[76:79], v[244:247], v[124:127], v[76:79]
  v_mul_f32 v203, s93, v203
  v_mul_f32 v204, s93, v204
  v_mfma_f32_16x16x32_bf16 v[52:55], v[244:247], v[100:103], v[52:55]
  ds_read_b128 v[244:247], v8 offset:30720
  s_waitcnt lgkmcnt(8)
  v_mfma_f32_16x16x32_bf16 v[76:79], v[248:251], v[128:131], v[76:79]
  v_mul_f32 v205, s93, v205
  v_mul_f32 v206, s93, v206
  v_mfma_f32_16x16x32_bf16 v[52:55], v[248:251], v[104:107], v[52:55]
  ds_read_b128 v[248:251], v7 offset:30848
  v_mul_f32 v207, s93, v207
  v_cvt_pk_bf16_f32 v108, v200, v201
  v_cvt_pk_bf16_f32 v109, v202, v203
  v_cvt_pk_bf16_f32 v110, v204, v205
  v_cvt_pk_bf16_f32 v111, v206, v207
  v_mfma_f32_16x16x32_bf16 v[76:79], v[252:255], v[132:135], v[76:79]
  v_exp_f32 v200, v80
  v_mfma_f32_16x16x32_bf16 v[52:55], v[252:255], v[108:111], v[52:55]
  ds_read_b128 v[252:255], v8 offset:30848
  s_waitcnt lgkmcnt(8)
  v_mfma_f32_16x16x32_bf16 v[72:75], v[216:219], v[112:115], v[32:35]
  v_exp_f32 v201, v81
  v_mfma_f32_16x16x32_bf16 v[48:51], v[216:219], v[88:91], v[32:35]
  v_exp_f32 v202, v82
  v_mfma_f32_16x16x32_bf16 v[72:75], v[220:223], v[116:119], v[72:75]
  v_exp_f32 v203, v83
  v_mfma_f32_16x16x32_bf16 v[48:51], v[220:223], v[92:95], v[48:51]
  ds_read_b128 v[216:219], v7 offset:30976
  v_add_u32 v2, 102400, v1
  s_waitcnt lgkmcnt(7)
  v_mfma_f32_16x16x32_bf16 v[72:75], v[224:227], v[120:123], v[72:75]
  v_exp_f32 v204, v76
  v_mfma_f32_16x16x32_bf16 v[48:51], v[224:227], v[96:99], v[48:51]
  v_exp_f32 v205, v77
  v_mfma_f32_16x16x32_bf16 v[72:75], v[228:231], v[124:127], v[72:75]
  v_exp_f32 v206, v78
  v_mfma_f32_16x16x32_bf16 v[48:51], v[228:231], v[100:103], v[48:51]
  ds_read_b128 v[220:223], v8 offset:30976
  s_waitcnt lgkmcnt(6)
  v_mfma_f32_16x16x32_bf16 v[72:75], v[232:235], v[128:131], v[72:75]
  v_exp_f32 v207, v79
  v_mfma_f32_16x16x32_bf16 v[48:51], v[232:235], v[104:107], v[48:51]
  v_exp_f32 v208, v52
  v_mfma_f32_16x16x32_bf16 v[72:75], v[236:239], v[132:135], v[72:75]
  v_exp_f32 v209, v53
  v_mfma_f32_16x16x32_bf16 v[48:51], v[236:239], v[108:111], v[48:51]
  ds_read_b128 v[224:227], v7 offset:23040
  s_waitcnt lgkmcnt(5)
  v_mfma_f32_16x16x32_bf16 v[68:71], v[240:243], v[112:115], v[32:35]
  v_exp_f32 v210, v54
  v_mfma_f32_16x16x32_bf16 v[44:47], v[240:243], v[88:91], v[32:35]
  v_exp_f32 v211, v55
  v_mfma_f32_16x16x32_bf16 v[68:71], v[244:247], v[116:119], v[68:71]
  ds_read_b128 v[228:231], v8 offset:23040
  ds_read_b128 v[232:235], v7 offset:23168
  v_mov_b32 v192, 0x3f803f80
  v_mfma_f32_16x16x32_bf16 v[44:47], v[244:247], v[92:95], v[44:47]
  ds_read_b128 v[236:239], v8 offset:23168
  v_mov_b32 v193, 0x3f803f80
  s_waitcnt lgkmcnt(6)
  v_mfma_f32_16x16x32_bf16 v[68:71], v[248:251], v[120:123], v[68:71]
  v_exp_f32 v212, v72
  v_mfma_f32_16x16x32_bf16 v[44:47], v[248:251], v[96:99], v[44:47]
  v_exp_f32 v213, v73
  v_mfma_f32_16x16x32_bf16 v[68:71], v[252:255], v[124:127], v[68:71]
  v_exp_f32 v214, v74
  v_mfma_f32_16x16x32_bf16 v[44:47], v[252:255], v[100:103], v[44:47]
  ds_read_b128 v[240:243], v7 offset:23296
  s_waitcnt lgkmcnt(5)
  v_mfma_f32_16x16x32_bf16 v[68:71], v[216:219], v[128:131], v[68:71]
  v_exp_f32 v215, v75
  v_mfma_f32_16x16x32_bf16 v[44:47], v[216:219], v[104:107], v[44:47]
  ds_read_b128 v[244:247], v8 offset:23296
  ds_read_b128 v[248:251], v7 offset:15360
  v_mfma_f32_16x16x32_bf16 v[68:71], v[220:223], v[132:135], v[68:71]
  ds_read_b128 v[252:255], v8 offset:15360
  ds_read_b128 v[216:219], v7 offset:15488
  v_mfma_f32_16x16x32_bf16 v[44:47], v[220:223], v[108:111], v[44:47]
  ds_read_b128 v[220:223], v8 offset:15488
  s_waitcnt lgkmcnt(8)
  v_mfma_f32_16x16x32_bf16 v[64:67], v[224:227], v[112:115], v[32:35]
  v_mov_b32 v194, 0x3f803f80
  v_mov_b32 v195, 0x3f803f80
  v_mfma_f32_16x16x32_bf16 v[40:43], v[224:227], v[88:91], v[32:35]
  ds_read_b128 v[224:227], v7 offset:15616
  v_cvt_pk_bf16_f32 v166, v196, v197
  v_mfma_f32_16x16x32_bf16 v[64:67], v[228:231], v[116:119], v[64:67]
  v_exp_f32 v196, v48
  v_mfma_f32_16x16x32_bf16 v[40:43], v[228:231], v[92:95], v[40:43]
  ds_read_b128 v[228:231], v8 offset:15616
  v_cvt_pk_bf16_f32 v167, v198, v199
  s_waitcnt lgkmcnt(8)
  v_mfma_f32_16x16x32_bf16 v[64:67], v[232:235], v[120:123], v[64:67]
  v_exp_f32 v197, v49
  v_mfma_f32_16x16x32_bf16 v[40:43], v[232:235], v[96:99], v[40:43]
  v_exp_f32 v198, v50
  v_mfma_f32_16x16x32_bf16 v[64:67], v[236:239], v[124:127], v[64:67]
  v_exp_f32 v199, v51
  v_mfma_f32_16x16x32_bf16 v[40:43], v[236:239], v[100:103], v[40:43]
  ds_read_b128 v[232:235], v7 offset:7680
  v_cvt_pk_bf16_f32 v164, v200, v201
  s_waitcnt lgkmcnt(7)
  v_mfma_f32_16x16x32_bf16 v[64:67], v[240:243], v[128:131], v[64:67]
  v_exp_f32 v200, v68
  v_mfma_f32_16x16x32_bf16 v[40:43], v[240:243], v[104:107], v[40:43]
  v_exp_f32 v201, v69
  v_mfma_f32_16x16x32_bf16 v[64:67], v[244:247], v[132:135], v[64:67]
  ds_read_b128 v[236:239], v8 offset:7680
  ds_read_b128 v[240:243], v7 offset:7808
  v_mfma_f32_16x16x32_bf16 v[40:43], v[244:247], v[108:111], v[40:43]
  ds_read_b128 v[244:247], v8 offset:7808
  s_cbranch_vccz SL49
  s_barrier
  v_and_b32 v14, 128, v1
  buffer_load_dword v13, v14, s[8:11], 0 offen
SL49:
  s_waitcnt lgkmcnt(8)
  v_mfma_f32_16x16x32_bf16 v[60:63], v[248:251], v[112:115], v[32:35]
  v_cvt_pk_bf16_f32 v165, v202, v203
  v_cvt_pk_bf16_f32 v162, v204, v205
  v_mfma_f32_16x16x32_bf16 v[36:39], v[248:251], v[88:91], v[32:35]
  v_exp_f32 v202, v70
  v_mfma_f32_16x16x32_bf16 v[60:63], v[252:255], v[116:119], v[60:63]
  v_exp_f32 v203, v71
  v_mfma_f32_16x16x32_bf16 v[36:39], v[252:255], v[92:95], v[36:39]
  ds_read_b128 v[248:251], v7 offset:7936
  v_cvt_pk_bf16_f32 v163, v206, v207
  s_waitcnt lgkmcnt(7)
  v_mfma_f32_16x16x32_bf16 v[60:63], v[216:219], v[120:123], v[60:63]
  v_exp_f32 v204, v44
  v_mfma_f32_16x16x32_bf16 v[36:39], v[216:219], v[96:99], v[36:39]
  v_exp_f32 v205, v45
  v_mfma_f32_16x16x32_bf16 v[60:63], v[220:223], v[124:127], v[60:63]
  v_exp_f32 v206, v46
  v_mfma_f32_16x16x32_bf16 v[36:39], v[220:223], v[100:103], v[36:39]
  ds_read_b128 v[252:255], v8 offset:7936
  v_cvt_pk_bf16_f32 v150, v208, v209
  s_waitcnt lgkmcnt(6)
  v_mfma_f32_16x16x32_bf16 v[60:63], v[224:227], v[128:131], v[60:63]
  v_exp_f32 v207, v47
  v_mfma_f32_16x16x32_bf16 v[36:39], v[224:227], v[104:107], v[36:39]
  v_exp_f32 v208, v64
  v_mfma_f32_16x16x32_bf16 v[60:63], v[228:231], v[132:135], v[60:63]
  v_exp_f32 v209, v65
  v_mfma_f32_16x16x32_bf16 v[36:39], v[228:231], v[108:111], v[36:39]
  ds_read_b128 v[216:219], v7 offset:0
  s_cbranch_vccnz SL50
  s_barrier
SL50:
  s_waitcnt lgkmcnt(5)
  v_mfma_f32_16x16x32_bf16 v[56:59], v[232:235], v[112:115], v[56:59]
  ds_read_b128 v[220:223], v8 offset:0
  ds_read_b128 v[224:227], v7 offset:128
  v_cvt_pk_bf16_f32 v151, v210, v211
  v_mfma_f32_16x16x32_bf16 v[32:35], v[232:235], v[88:91], v[32:35]
  v_exp_f32 v210, v66
  v_mfma_f32_16x16x32_bf16 v[56:59], v[236:239], v[116:119], v[56:59]
  v_exp_f32 v211, v67
  v_mfma_f32_16x16x32_bf16 v[32:35], v[236:239], v[92:95], v[32:35]
  ds_read_b128 v[228:231], v8 offset:128
  v_cvt_pk_bf16_f32 v160, v212, v213
  s_waitcnt lgkmcnt(6)
  v_mfma_f32_16x16x32_bf16 v[56:59], v[240:243], v[120:123], v[56:59]
  v_exp_f32 v212, v40
  v_mfma_f32_16x16x32_bf16 v[32:35], v[240:243], v[96:99], v[32:35]
  v_exp_f32 v213, v41
  v_mfma_f32_16x16x32_bf16 v[56:59], v[244:247], v[124:127], v[56:59]
  ds_read_b128 v[232:235], v7 offset:256
  ds_read_b128 v[236:239], v8 offset:256
  v_cvt_pk_bf16_f32 v161, v214, v215
  v_mfma_f32_16x16x32_bf16 v[32:35], v[244:247], v[100:103], v[32:35]
  ds_read_b128 v[240:243], v20 offset:0
  v_cvt_pk_bf16_f32 v148, v196, v197
  s_waitcnt lgkmcnt(7)
  v_mfma_f32_16x16x32_bf16 v[56:59], v[248:251], v[128:131], v[56:59]
  v_exp_f32 v214, v42
  v_mfma_f32_16x16x32_bf16 v[32:35], v[248:251], v[104:107], v[32:35]
  v_exp_f32 v215, v43
  v_mfma_f32_16x16x32_bf16 v[56:59], v[252:255], v[132:135], v[56:59]
  v_exp_f32 v196, v60
  v_mfma_f32_16x16x32_bf16 v[32:35], v[252:255], v[108:111], v[32:35]
  ds_read_b128 v[244:247], v0 offset:0
  v_cvt_pk_bf16_f32 v149, v198, v199
  s_waitcnt lgkmcnt(6)
  v_mfma_f32_16x16x32_bf16 v[28:31], v[216:219], v[88:91], v[28:31]
  v_exp_f32 v197, v61
  v_mfma_f32_16x16x32_bf16 v[28:31], v[220:223], v[92:95], v[28:31]
  ds_read_b128 v[248:251], v20 offset:128
  v_cvt_pk_bf16_f32 v158, v200, v201
  s_waitcnt lgkmcnt(5)
  v_mfma_f32_16x16x32_bf16 v[28:31], v[224:227], v[96:99], v[28:31]
  v_exp_f32 v198, v62
  v_mfma_f32_16x16x32_bf16 v[28:31], v[228:231], v[100:103], v[28:31]
  ds_read_b128 v[252:255], v0 offset:128
  v_cvt_pk_bf16_f32 v159, v202, v203
  s_waitcnt lgkmcnt(5)
  v_mfma_f32_16x16x32_bf16 v[28:31], v[232:235], v[104:107], v[28:31]
  ds_read_b128 v[216:219], v20 offset:256
  v_cvt_pk_bf16_f32 v146, v204, v205
  s_waitcnt lgkmcnt(5)
  v_mfma_f32_16x16x32_bf16 v[28:31], v[236:239], v[108:111], v[28:31]
  ds_read_b128 v[220:223], v0 offset:256
  v_cvt_pk_bf16_f32 v147, v206, v207
  s_waitcnt lgkmcnt(5)
  v_mfma_f32_16x16x32_bf16 v[24:27], v[240:243], v[88:91], v[24:27]
  ds_read_b64_tr_b16 v[224:225], v9 offset:53760
  ds_read_b64_tr_b16 v[226:227], v9 offset:61440
  v_cvt_pk_bf16_f32 v156, v208, v209
  s_waitcnt lgkmcnt(5)
  v_mfma_f32_16x16x32_bf16 v[24:27], v[244:247], v[92:95], v[24:27]
  ds_read_b64_tr_b16 v[228:229], v10 offset:53760
  ds_read_b64_tr_b16 v[230:231], v10 offset:61440
  v_cvt_pk_bf16_f32 v157, v210, v211
  v_mfma_f32_16x16x32_bf16 v[24:27], v[248:251], v[96:99], v[24:27]
  ds_read_b64_tr_b16 v[232:233], v11 offset:53760
  ds_read_b64_tr_b16 v[234:235], v11 offset:61440
  v_cvt_pk_bf16_f32 v144, v212, v213
  v_cvt_pk_bf16_f32 v145, v214, v215
  v_exp_f32 v199, v63
  v_cvt_pk_bf16_f32 v154, v196, v197
  v_cvt_pk_bf16_f32 v155, v198, v199
  v_exp_f32 v200, v36
  v_exp_f32 v201, v37
  v_exp_f32 v202, v38
  v_exp_f32 v203, v39
  v_cvt_pk_bf16_f32 v142, v200, v201
  v_cvt_pk_bf16_f32 v143, v202, v203
  v_exp_f32 v204, v56
  v_exp_f32 v205, v57
  v_exp_f32 v206, v58
  v_exp_f32 v207, v59
  v_cvt_pk_bf16_f32 v152, v204, v205
  v_cvt_pk_bf16_f32 v153, v206, v207
  v_mfma_f32_16x16x32_bf16 v[188:191], v[192:195], v[164:167], 0
  v_exp_f32 v208, v32
  v_mfma_f32_16x16x32_bf16 v[188:191], v[192:195], v[160:163], v[188:191]
  v_exp_f32 v209, v33
  v_mfma_f32_16x16x32_bf16 v[188:191], v[192:195], v[156:159], v[188:191]
  v_exp_f32 v210, v34
  v_mfma_f32_16x16x32_bf16 v[188:191], v[192:195], v[152:155], v[188:191]
  ds_read_b64_tr_b16 v[236:237], v12 offset:53760
  ds_read_b64_tr_b16 v[238:239], v12 offset:61440
  s_waitcnt lgkmcnt(9)
  v_mfma_f32_16x16x32_bf16 v[24:27], v[252:255], v[100:103], v[24:27]
  v_exp_f32 v211, v35
  v_mfma_f32_16x16x32_bf16 v[24:27], v[216:219], v[104:107], v[24:27]
  ds_read_b64_tr_b16 v[240:241], v9 offset:53888
  ds_read_b64_tr_b16 v[242:243], v9 offset:61568
  s_waitcnt lgkmcnt(8)
  v_mfma_f32_16x16x32_bf16 v[24:27], v[220:223], v[108:111], v[24:27]
  ds_read_b64_tr_b16 v[244:245], v10 offset:53888
  ds_read_b64_tr_b16 v[246:247], v10 offset:61568
  v_subrev_u32 v23, 813694976, v188
  s_mov_b32 s52, 503316480
  v_cmp_gt_u32 s[48:49], s52, v23
  s_or_b64 s[48:49], s[48:49], s[44:45]
  s_cmp_eq_u64 s[48:49], -1
  s_cbranch_scc0 FB1
FBR1:
  s_cbranch_vccnz SL51
  s_barrier
SL51:
  v_mfma_f32_16x16x32_bf16 v[88:91], v[224:227], v[164:167], 0
  ds_read_b64_tr_b16 v[248:249], v11 offset:53888
  ds_read_b64_tr_b16 v[250:251], v11 offset:61568
  v_cvt_pk_bf16_f32 v140, v208, v209
  s_waitcnt lgkmcnt(8)
  v_mfma_f32_16x16x32_bf16 v[92:95], v[228:231], v[164:167], 0
  ds_read_b64_tr_b16 v[252:253], v12 offset:53888
  ds_read_b64_tr_b16 v[254:255], v12 offset:61568
  v_cvt_pk_bf16_f32 v141, v210, v211
  v_mfma_f32_16x16x32_bf16 v[96:99], v[232:235], v[164:167], 0
  ds_read_b64_tr_b16 v[216:217], v9 offset:54016
  ds_read_b64_tr_b16 v[218:219], v9 offset:61696
  v_exp_f32 v212, v28
  s_waitcnt lgkmcnt(8)
  v_mfma_f32_16x16x32_bf16 v[100:103], v[236:239], v[164:167], 0
  ds_read_b64_tr_b16 v[220:221], v10 offset:54016
  ds_read_b64_tr_b16 v[222:223], v10 offset:61696
  v_exp_f32 v213, v29
  v_mfma_f32_16x16x32_bf16 v[104:107], v[240:243], v[164:167], 0
  ds_read_b64_tr_b16 v[224:225], v11 offset:54016
  ds_read_b64_tr_b16 v[226:227], v11 offset:61696
  s_waitcnt lgkmcnt(8)
  v_mfma_f32_16x16x32_bf16 v[108:111], v[244:247], v[164:167], 0
  ds_read_b64_tr_b16 v[228:229], v12 offset:54016
  ds_read_b64_tr_b16 v[230:231], v12 offset:61696
  v_mfma_f32_16x16x32_bf16 v[112:115], v[248:251], v[164:167], 0
  ds_read_b64_tr_b16 v[232:233], v9 offset:38400
  ds_read_b64_tr_b16 v[234:235], v9 offset:46080
  s_waitcnt lgkmcnt(8)
  v_mfma_f32_16x16x32_bf16 v[116:119], v[252:255], v[164:167], 0
  ds_read_b64_tr_b16 v[236:237], v10 offset:38400
  ds_read_b64_tr_b16 v[238:239], v10 offset:46080
  v_mfma_f32_16x16x32_bf16 v[120:123], v[216:219], v[164:167], 0
  ds_read_b64_tr_b16 v[240:241], v11 offset:38400
  ds_read_b64_tr_b16 v[242:243], v11 offset:46080
  s_waitcnt lgkmcnt(8)
  v_mfma_f32_16x16x32_bf16 v[124:127], v[220:223], v[164:167], 0
  ds_read_b64_tr_b16 v[244:245], v12 offset:38400
  ds_read_b64_tr_b16 v[246:247], v12 offset:46080
  v_mfma_f32_16x16x32_bf16 v[128:131], v[224:227], v[164:167], 0
  ds_read_b64_tr_b16 v[248:249], v9 offset:38528
  ds_read_b64_tr_b16 v[250:251], v9 offset:46208
  s_waitcnt lgkmcnt(8)
  v_mfma_f32_16x16x32_bf16 v[132:135], v[228:231], v[164:167], 0
  ds_read_b64_tr_b16 v[252:253], v10 offset:38528
  ds_read_b64_tr_b16 v[254:255], v10 offset:46208
  v_exp_f32 v214, v30
  v_exp_f32 v215, v31
  v_cvt_pk_bf16_f32 v138, v212, v213
  v_cvt_pk_bf16_f32 v139, v214, v215
  v_exp_f32 v196, v24
  v_exp_f32 v197, v25
  v_exp_f32 v198, v26
  v_exp_f32 v199, v27
  v_cvt_pk_bf16_f32 v136, v196, v197
  v_cvt_pk_bf16_f32 v137, v198, v199
  v_mfma_f32_16x16x32_bf16 v[184:187], v[192:195], v[148:151], 0
  ds_read_b64_tr_b16 v[216:217], v11 offset:38528
  ds_read_b64_tr_b16 v[218:219], v11 offset:46208
  v_mfma_f32_16x16x32_bf16 v[184:187], v[192:195], v[144:147], v[184:187]
  ds_read_b64_tr_b16 v[220:221], v12 offset:38528
  ds_read_b64_tr_b16 v[222:223], v12 offset:46208
  v_mfma_f32_16x16x32_bf16 v[184:187], v[192:195], v[140:143], v[184:187]
  v_mfma_f32_16x16x32_bf16 v[184:187], v[192:195], v[136:139], v[184:187]
  s_nop 7
  v_subrev_u32 v23, 813694976, v184
  s_mov_b32 s52, 503316480
  v_cmp_gt_u32 s[48:49], s52, v23
  s_or_b64 s[48:49], s[48:49], s[42:43]
  s_cmp_eq_u64 s[48:49], -1
  s_cbranch_scc0 FB0
FBR0:
  v_mfma_f32_16x16x32_bf16 v[88:91], v[232:235], v[160:163], v[88:91]
  v_rcp_f32 v22, v184
  v_mfma_f32_16x16x32_bf16 v[24:27], v[232:235], v[148:151], 0
  s_waitcnt lgkmcnt(10)
  v_mfma_f32_16x16x32_bf16 v[92:95], v[236:239], v[160:163], v[92:95]
  v_rcp_f32 v23, v188
  v_mfma_f32_16x16x32_bf16 v[28:31], v[236:239], v[148:151], 0
  ds_read_b64_tr_b16 v[224:225], v9 offset:38656
  ds_read_b64_tr_b16 v[226:227], v9 offset:46336
  v_mfma_f32_16x16x32_bf16 v[96:99], v[240:243], v[160:163], v[96:99]
  ds_read_b64_tr_b16 v[228:229], v10 offset:38656
  ds_read_b64_tr_b16 v[230:231], v10 offset:46336
  v_mfma_f32_16x16x32_bf16 v[32:35], v[240:243], v[148:151], 0
  s_waitcnt lgkmcnt(10)
  v_mfma_f32_16x16x32_bf16 v[100:103], v[244:247], v[160:163], v[100:103]
  ds_read_b64_tr_b16 v[232:233], v11 offset:38656
  ds_read_b64_tr_b16 v[234:235], v11 offset:46336
  v_mfma_f32_16x16x32_bf16 v[36:39], v[244:247], v[148:151], 0
  ds_read_b64_tr_b16 v[236:237], v12 offset:38656
  ds_read_b64_tr_b16 v[238:239], v12 offset:46336
  v_mfma_f32_16x16x32_bf16 v[104:107], v[248:251], v[160:163], v[104:107]
  v_mfma_f32_16x16x32_bf16 v[40:43], v[248:251], v[148:151], 0
  s_waitcnt lgkmcnt(10)
  v_mfma_f32_16x16x32_bf16 v[108:111], v[252:255], v[160:163], v[108:111]
  ds_read_b64_tr_b16 v[240:241], v9 offset:23040
  ds_read_b64_tr_b16 v[242:243], v9 offset:30720
  v_mfma_f32_16x16x32_bf16 v[44:47], v[252:255], v[148:151], 0
  ds_read_b64_tr_b16 v[244:245], v10 offset:23040
  ds_read_b64_tr_b16 v[246:247], v10 offset:30720
  v_mfma_f32_16x16x32_bf16 v[112:115], v[216:219], v[160:163], v[112:115]
  v_mfma_f32_16x16x32_bf16 v[48:51], v[216:219], v[148:151], 0
  s_waitcnt lgkmcnt(10)
  v_mfma_f32_16x16x32_bf16 v[116:119], v[220:223], v[160:163], v[116:119]
  ds_read_b64_tr_b16 v[248:249], v11 offset:23040
  ds_read_b64_tr_b16 v[250:251], v11 offset:30720
  v_mfma_f32_16x16x32_bf16 v[52:55], v[220:223], v[148:151], 0
  ds_read_b64_tr_b16 v[252:253], v12 offset:23040
  ds_read_b64_tr_b16 v[254:255], v12 offset:30720
  v_mfma_f32_16x16x32_bf16 v[120:123], v[224:227], v[160:163], v[120:123]
  v_mfma_f32_16x16x32_bf16 v[56:59], v[224:227], v[148:151], 0
  s_waitcnt lgkmcnt(10)
  v_mfma_f32_16x16x32_bf16 v[124:127], v[228:231], v[160:163], v[124:127]
  ds_read_b64_tr_b16 v[216:217], v9 offset:23168
  ds_read_b64_tr_b16 v[218:219], v9 offset:30848
  v_mfma_f32_16x16x32_bf16 v[60:63], v[228:231], v[148:151], 0
  ds_read_b64_tr_b16 v[220:221], v10 offset:23168
  ds_read_b64_tr_b16 v[222:223], v10 offset:30848
  v_mfma_f32_16x16x32_bf16 v[128:131], v[232:235], v[160:163], v[128:131]
  v_mfma_f32_16x16x32_bf16 v[64:67], v[232:235], v[148:151], 0
  s_waitcnt lgkmcnt(10)
  v_mfma_f32_16x16x32_bf16 v[132:135], v[236:239], v[160:163], v[132:135]
  ds_read_b64_tr_b16 v[224:225], v11 offset:23168
  ds_read_b64_tr_b16 v[226:227], v11 offset:30848
  v_mfma_f32_16x16x32_bf16 v[68:71], v[236:239], v[148:151], 0
  ds_read_b64_tr_b16 v[228:229], v12 offset:23168
  ds_read_b64_tr_b16 v[230:231], v12 offset:30848
  s_cbranch_vccz SL52
  s_barrier
  s_mov_b32 s53, 0x40000
  s_mov_b32 s46, 72
NPOLL:
  s_waitcnt vmcnt(0)
  v_cmp_le_u32 s[48:49], s46, v13
  s_sub_u32 s53, s53, 1
  s_cbranch_scc1 NPOLLD
  s_cmp_eq_u64 s[48:49], -1
  s_cbranch_scc1 NPOLLD
  buffer_load_dword v13, v14, s[8:11], 0 offen sc1
  s_branch NPOLL
NPOLLD:
  s_add_u32 m0, s40, 0
  s_add_u32 s100, s40, 30720
  buffer_load_dwordx4 v1, s[20:23], s100 offen sc1 lds
  s_add_u32 m0, s40, 4096
  s_add_u32 s100, s40, 34816
  buffer_load_dwordx4 v1, s[20:23], s100 offen sc1 lds
  s_min_u32 s51, s40, 1024
  s_add_u32 m0, s51, 8192
  s_add_u32 s100, s51, 38912
  buffer_load_dwordx4 v1, s[20:23], s100 offen sc1 lds
  s_add_u32 m0, s40, 133120
  s_add_u32 s100, s40, 0
  buffer_load_dwordx4 v1, s[20:23], s100 offen sc1 lds
  s_add_u32 m0, s40, 137216
  s_add_u32 s100, s40, 4096
  buffer_load_dwordx4 v1, s[20:23], s100 offen sc1 lds
  s_add_u32 m0, s40, 141312
  s_add_u32 s100, s40, 8192
  buffer_load_dwordx4 v1, s[20:23], s100 offen sc1 lds
  s_add_u32 m0, s40, 145408
  s_add_u32 s100, s40, 12288
  buffer_load_dwordx4 v1, s[20:23], s100 offen sc1 lds
  s_add_u32 m0, s40, 149504
  s_add_u32 s100, s40, 16384
  buffer_load_dwordx4 v1, s[20:23], s100 offen sc1 lds
  s_add_u32 m0, s40, 153600
  s_add_u32 s100, s40, 20480
  buffer_load_dwordx4 v1, s[20:23], s100 offen sc1 lds
  s_add_u32 m0, s40, 157696
  s_add_u32 s100, s40, 24576
  buffer_load_dwordx4 v1, s[20:23], s100 offen sc1 lds
  s_min_u32 s51, s40, 1024
  s_add_u32 m0, s51, 161792
  s_add_u32 s100, s51, 28672
  buffer_load_dwordx4 v1, s[20:23], s100 offen sc1 lds
SL52:
  s_cbranch_vccnz SL53
  s_barrier
SL53:
  v_mfma_f32_16x16x32_bf16 v[88:91], v[240:243], v[156:159], v[88:91]
  v_mfma_f32_16x16x32_bf16 v[24:27], v[240:243], v[144:147], v[24:27]
  s_waitcnt lgkmcnt(10)
  v_mfma_f32_16x16x32_bf16 v[92:95], v[244:247], v[156:159], v[92:95]
  ds_read_b64_tr_b16 v[232:233], v9 offset:23296
  ds_read_b64_tr_b16 v[234:235], v9 offset:30976
  v_mfma_f32_16x16x32_bf16 v[28:31], v[244:247], v[144:147], v[28:31]
  ds_read_b64_tr_b16 v[236:237], v10 offset:23296
  ds_read_b64_tr_b16 v[238:239], v10 offset:30976
  v_mfma_f32_16x16x32_bf16 v[96:99], v[248:251], v[156:159], v[96:99]
  v_mfma_f32_16x16x32_bf16 v[32:35], v[248:251], v[144:147], v[32:35]
  s_waitcnt lgkmcnt(10)
  v_mfma_f32_16x16x32_bf16 v[100:103], v[252:255], v[156:159], v[100:103]
  ds_read_b64_tr_b16 v[240:241], v11 offset:23296
  ds_read_b64_tr_b16 v[242:243], v11 offset:30976
  v_mfma_f32_16x16x32_bf16 v[36:39], v[252:255], v[144:147], v[36:39]
  ds_read_b64_tr_b16 v[244:245], v12 offset:23296
  ds_read_b64_tr_b16 v[246:247], v12 offset:30976
  v_mfma_f32_16x16x32_bf16 v[104:107], v[216:219], v[156:159], v[104:107]
  v_mfma_f32_16x16x32_bf16 v[40:43], v[216:219], v[144:147], v[40:43]
  s_waitcnt lgkmcnt(10)
  v_mfma_f32_16x16x32_bf16 v[108:111], v[220:223], v[156:159], v[108:111]
  ds_read_b64_tr_b16 v[248:249], v9 offset:7680
  ds_read_b64_tr_b16 v[250:251], v9 offset:15360
  v_mfma_f32_16x16x32_bf16 v[44:47], v[220:223], v[144:147], v[44:47]
  ds_read_b64_tr_b16 v[252:253], v10 offset:7680
  ds_read_b64_tr_b16 v[254:255], v10 offset:15360
  v_mfma_f32_16x16x32_bf16 v[112:115], v[224:227], v[156:159], v[112:115]
  v_mfma_f32_16x16x32_bf16 v[48:51], v[224:227], v[144:147], v[48:51]
  s_waitcnt lgkmcnt(10)
  v_mfma_f32_16x16x32_bf16 v[116:119], v[228:231], v[156:159], v[116:119]
  ds_read_b64_tr_b16 v[216:217], v11 offset:7680
  ds_read_b64_tr_b16 v[218:219], v11 offset:15360
  v_mfma_f32_16x16x32_bf16 v[52:55], v[228:231], v[144:147], v[52:55]
  ds_read_b64_tr_b16 v[220:221], v12 offset:7680
  ds_read_b64_tr_b16 v[222:223], v12 offset:15360
  v_mfma_f32_16x16x32_bf16 v[120:123], v[232:235], v[156:159], v[120:123]
  v_mfma_f32_16x16x32_bf16 v[56:59], v[232:235], v[144:147], v[56:59]
  s_waitcnt lgkmcnt(10)
  v_mfma_f32_16x16x32_bf16 v[124:127], v[236:239], v[156:159], v[124:127]
  ds_read_b64_tr_b16 v[224:225], v9 offset:7808
  ds_read_b64_tr_b16 v[226:227], v9 offset:15488
  v_mfma_f32_16x16x32_bf16 v[60:63], v[236:239], v[144:147], v[60:63]
  ds_read_b64_tr_b16 v[228:229], v10 offset:7808
  ds_read_b64_tr_b16 v[230:231], v10 offset:15488
  v_mfma_f32_16x16x32_bf16 v[128:131], v[240:243], v[156:159], v[128:131]
  v_mfma_f32_16x16x32_bf16 v[64:67], v[240:243], v[144:147], v[64:67]
  s_waitcnt lgkmcnt(10)
  v_mfma_f32_16x16x32_bf16 v[132:135], v[244:247], v[156:159], v[132:135]
  ds_read_b64_tr_b16 v[232:233], v11 offset:7808
  ds_read_b64_tr_b16 v[234:235], v11 offset:15488
  v_mfma_f32_16x16x32_bf16 v[68:71], v[244:247], v[144:147], v[68:71]
  ds_read_b64_tr_b16 v[236:237], v12 offset:7808
  ds_read_b64_tr_b16 v[238:239], v12 offset:15488
  v_mfma_f32_16x16x32_bf16 v[88:91], v[248:251], v[152:155], v[88:91]
  v_mfma_f32_16x16x32_bf16 v[24:27], v[248:251], v[140:143], v[24:27]
  s_waitcnt lgkmcnt(10)
  v_mfma_f32_16x16x32_bf16 v[92:95], v[252:255], v[152:155], v[92:95]
  ds_read_b64_tr_b16 v[240:241], v9 offset:7936
  ds_read_b64_tr_b16 v[242:243], v9 offset:15616
  v_mfma_f32_16x16x32_bf16 v[28:31], v[252:255], v[140:143], v[28:31]
  ds_read_b64_tr_b16 v[244:245], v10 offset:7936
  ds_read_b64_tr_b16 v[246:247], v10 offset:15616
  v_mfma_f32_16x16x32_bf16 v[96:99], v[216:219], v[152:155], v[96:99]
  v_cvt_pk_bf16_f32 v156, v88, v89
  v_cvt_pk_bf16_f32 v157, v90, v91
  v_mfma_f32_16x16x32_bf16 v[32:35], v[216:219], v[140:143], v[32:35]
  v_cvt_pk_bf16_f32 v158, v92, v93
  s_waitcnt lgkmcnt(10)
  v_mfma_f32_16x16x32_bf16 v[100:103], v[220:223], v[152:155], v[100:103]
  ds_read_b64_tr_b16 v[248:249], v11 offset:7936
  ds_read_b64_tr_b16 v[250:251], v11 offset:15616
  v_mfma_f32_16x16x32_bf16 v[36:39], v[220:223], v[140:143], v[36:39]
  ds_read_b64_tr_b16 v[252:253], v12 offset:7936
  ds_read_b64_tr_b16 v[254:255], v12 offset:15616
  v_mfma_f32_16x16x32_bf16 v[104:107], v[224:227], v[152:155], v[104:107]
  v_cvt_pk_bf16_f32 v159, v94, v95
  v_cvt_pk_bf16_f32 v160, v96, v97
  v_mfma_f32_16x16x32_bf16 v[40:43], v[224:227], v[140:143], v[40:43]
  v_cvt_pk_bf16_f32 v161, v98, v99
  s_waitcnt lgkmcnt(10)
  v_mfma_f32_16x16x32_bf16 v[108:111], v[228:231], v[152:155], v[108:111]
  ds_read_b64_tr_b16 v[216:217], v15 offset:0
  ds_read_b64_tr_b16 v[218:219], v9 offset:0
  v_mfma_f32_16x16x32_bf16 v[44:47], v[228:231], v[140:143], v[44:47]
  ds_read_b64_tr_b16 v[220:221], v16 offset:0
  ds_read_b64_tr_b16 v[222:223], v10 offset:0
  v_mfma_f32_16x16x32_bf16 v[112:115], v[232:235], v[152:155], v[112:115]
  v_cvt_pk_bf16_f32 v162, v100, v101
  v_cvt_pk_bf16_f32 v163, v102, v103
  v_mfma_f32_16x16x32_bf16 v[48:51], v[232:235], v[140:143], v[48:51]
  v_cvt_pk_bf16_f32 v164, v104, v105
  s_waitcnt lgkmcnt(10)
  v_mfma_f32_16x16x32_bf16 v[116:119], v[236:239], v[152:155], v[116:119]
  ds_read_b64_tr_b16 v[224:225], v17 offset:0
  ds_read_b64_tr_b16 v[226:227], v11 offset:0
  v_mfma_f32_16x16x32_bf16 v[52:55], v[236:239], v[140:143], v[52:55]
  ds_read_b64_tr_b16 v[228:229], v18 offset:0
  ds_read_b64_tr_b16 v[230:231], v12 offset:0
  v_mfma_f32_16x16x32_bf16 v[120:123], v[240:243], v[152:155], v[120:123]
  v_cvt_pk_bf16_f32 v165, v106, v107
  v_cvt_pk_bf16_f32 v166, v108, v109
  v_mfma_f32_16x16x32_bf16 v[56:59], v[240:243], v[140:143], v[56:59]
  v_cvt_pk_bf16_f32 v167, v110, v111
  s_waitcnt lgkmcnt(10)
  v_mfma_f32_16x16x32_bf16 v[124:127], v[244:247], v[152:155], v[124:127]
  ds_read_b64_tr_b16 v[232:233], v15 offset:128
  ds_read_b64_tr_b16 v[234:235], v9 offset:128
  v_mfma_f32_16x16x32_bf16 v[60:63], v[244:247], v[140:143], v[60:63]
  ds_read_b64_tr_b16 v[236:237], v16 offset:128
  ds_read_b64_tr_b16 v[238:239], v10 offset:128
  v_mfma_f32_16x16x32_bf16 v[128:131], v[248:251], v[152:155], v[128:131]
  v_cvt_pk_bf16_f32 v176, v112, v113
  v_cvt_pk_bf16_f32 v177, v114, v115
  v_mfma_f32_16x16x32_bf16 v[64:67], v[248:251], v[140:143], v[64:67]
  v_cvt_pk_bf16_f32 v178, v116, v117
  s_waitcnt lgkmcnt(10)
  v_mfma_f32_16x16x32_bf16 v[132:135], v[252:255], v[152:155], v[132:135]
  ds_read_b64_tr_b16 v[240:241], v17 offset:128
  ds_read_b64_tr_b16 v[242:243], v11 offset:128
  v_mfma_f32_16x16x32_bf16 v[68:71], v[252:255], v[140:143], v[68:71]
  ds_read_b64_tr_b16 v[244:245], v18 offset:128
  ds_read_b64_tr_b16 v[246:247], v12 offset:128
  v_mfma_f32_16x16x32_bf16 v[24:27], v[216:219], v[136:139], v[24:27]
  v_cvt_pk_bf16_f32 v179, v118, v119
  s_waitcnt lgkmcnt(10)
  v_mfma_f32_16x16x32_bf16 v[28:31], v[220:223], v[136:139], v[28:31]
  ds_read_b64_tr_b16 v[248:249], v15 offset:256
  ds_read_b64_tr_b16 v[250:251], v9 offset:256
  v_mfma_f32_16x16x32_bf16 v[32:35], v[224:227], v[136:139], v[32:35]
  ds_read_b64_tr_b16 v[252:253], v16 offset:256
  ds_read_b64_tr_b16 v[254:255], v10 offset:256
  s_waitcnt lgkmcnt(10)
  v_mfma_f32_16x16x32_bf16 v[36:39], v[228:231], v[136:139], v[36:39]
  ds_read_b64_tr_b16 v[216:217], v17 offset:256
  ds_read_b64_tr_b16 v[218:219], v11 offset:256
  v_mfma_f32_16x16x32_bf16 v[40:43], v[232:235], v[136:139], v[40:43]
  ds_read_b64_tr_b16 v[220:221], v18 offset:256
  ds_read_b64_tr_b16 v[222:223], v12 offset:256
  s_waitcnt lgkmcnt(10)
  v_mfma_f32_16x16x32_bf16 v[44:47], v[236:239], v[136:139], v[44:47]
  v_cvt_pk_bf16_f32 v180, v120, v121
  v_cvt_pk_bf16_f32 v181, v122, v123
  s_waitcnt lgkmcnt(0)
  s_cbranch_vccz SL54
  s_waitcnt vmcnt(0)
  s_barrier
  s_add_u32 m0, s40, 102400
  s_add_u32 s100, s40, 40960
  buffer_load_dwordx4 v1, s[20:23], s100 offen sc1 lds
  s_add_u32 m0, s40, 106496
  s_add_u32 s100, s40, 45056
  buffer_load_dwordx4 v1, s[20:23], s100 offen sc1 lds
  s_add_u32 m0, s40, 110592
  s_add_u32 s100, s40, 49152
  buffer_load_dwordx4 v1, s[20:23], s100 offen sc1 lds
  s_add_u32 m0, s40, 114688
  s_add_u32 s100, s40, 53248
  buffer_load_dwordx4 v1, s[20:23], s100 offen sc1 lds
  s_add_u32 m0, s40, 118784
  s_add_u32 s100, s40, 57344
  buffer_load_dwordx4 v1, s[20:23], s100 offen sc1 lds
  s_add_u32 m0, s40, 122880
  s_add_u32 s100, s40, 61440
  buffer_load_dwordx4 v1, s[20:23], s100 offen sc1 lds
  s_add_u32 m0, s40, 126976
  s_add_u32 s100, s40, 65536
  buffer_load_dwordx4 v1, s[20:23], s100 offen sc1 lds
  s_min_u32 s51, s40, 1024
  s_add_u32 m0, s51, 131072
  s_add_u32 s100, s51, 69632
  buffer_load_dwordx4 v1, s[20:23], s100 offen sc1 lds
SL54:
  ds_read_b128 v[224:227], v2 offset:30720
  ds_read_b128 v[228:231], v2 offset:31744
  ds_read_b128 v[232:235], v2 offset:32768
  ds_read_b128 v[236:239], v2 offset:33792
  v_mfma_f32_16x16x32_bf16 v[48:51], v[240:243], v[136:139], v[48:51]
  ds_read_b128 v[240:243], v2 offset:34816
  v_cvt_pk_bf16_f32 v182, v124, v125
  v_mfma_f32_16x16x32_bf16 v[52:55], v[244:247], v[136:139], v[52:55]
  ds_read_b128 v[244:247], v2 offset:35840
  v_cvt_pk_bf16_f32 v183, v126, v127
  v_mfma_f32_16x16x32_bf16 v[56:59], v[248:251], v[136:139], v[56:59]
  ds_read_b128 v[248:251], v2 offset:36864
  v_cvt_pk_bf16_f32 v72, v128, v129
  v_mfma_f32_16x16x32_bf16 v[60:63], v[252:255], v[136:139], v[60:63]
  ds_read_b128 v[252:255], v2 offset:37888
  v_cvt_pk_bf16_f32 v73, v130, v131
  v_mfma_f32_16x16x32_bf16 v[64:67], v[216:219], v[136:139], v[64:67]
  ds_read_b128 v[216:219], v2 offset:38912
  v_cvt_pk_bf16_f32 v74, v132, v133
  v_mfma_f32_16x16x32_bf16 v[68:71], v[220:223], v[136:139], v[68:71]
  ds_read_b128 v[220:223], v2 offset:39936
  v_cvt_pk_bf16_f32 v75, v134, v135
  v_cvt_pk_bf16_f32 v140, v24, v25
  v_cvt_pk_bf16_f32 v141, v26, v27
  v_cvt_pk_bf16_f32 v142, v28, v29
  v_cvt_pk_bf16_f32 v143, v30, v31
  s_waitcnt lgkmcnt(8)
  s_nop 0
  v_mfma_f32_16x16x32_bf16 v[184:187], v[224:227], v[140:143], 0
  v_cvt_pk_bf16_f32 v144, v32, v33
  v_cvt_pk_bf16_f32 v145, v34, v35
  v_mfma_f32_16x16x32_bf16 v[192:195], v[224:227], v[156:159], 0
  ds_read_b128 v[224:227], v2 offset:40960
  v_cvt_pk_bf16_f32 v146, v36, v37
  v_mfma_f32_16x16x32_bf16 v[188:191], v[228:231], v[140:143], 0
  v_cvt_pk_bf16_f32 v147, v38, v39
  v_cvt_pk_bf16_f32 v148, v40, v41
  v_mfma_f32_16x16x32_bf16 v[196:199], v[228:231], v[156:159], 0
  ds_read_b128 v[228:231], v2 offset:41984
  s_waitcnt lgkmcnt(8)
  v_mfma_f32_16x16x32_bf16 v[184:187], v[232:235], v[144:147], v[184:187]
  v_cvt_pk_bf16_f32 v149, v42, v43
  v_cvt_pk_bf16_f32 v150, v44, v45
  v_mfma_f32_16x16x32_bf16 v[192:195], v[232:235], v[160:163], v[192:195]
  ds_read_b128 v[232:235], v2 offset:43008
  v_cvt_pk_bf16_f32 v151, v46, v47
  v_mfma_f32_16x16x32_bf16 v[188:191], v[236:239], v[144:147], v[188:191]
  v_cvt_pk_bf16_f32 v168, v48, v49
  v_cvt_pk_bf16_f32 v169, v50, v51
  v_mfma_f32_16x16x32_bf16 v[196:199], v[236:239], v[160:163], v[196:199]
  ds_read_b128 v[236:239], v2 offset:44032
  s_waitcnt lgkmcnt(8)
  v_mfma_f32_16x16x32_bf16 v[184:187], v[240:243], v[148:151], v[184:187]
  v_cvt_pk_bf16_f32 v170, v52, v53
  v_cvt_pk_bf16_f32 v171, v54, v55
  v_mfma_f32_16x16x32_bf16 v[192:195], v[240:243], v[164:167], v[192:195]
  ds_read_b128 v[240:243], v2 offset:45056
  v_cvt_pk_bf16_f32 v172, v56, v57
  v_mfma_f32_16x16x32_bf16 v[188:191], v[244:247], v[148:151], v[188:191]
  v_cvt_pk_bf16_f32 v173, v58, v59
  v_cvt_pk_bf16_f32 v174, v60, v61
  v_mfma_f32_16x16x32_bf16 v[196:199], v[244:247], v[164:167], v[196:199]
  ds_read_b128 v[244:247], v2 offset:46080
  s_waitcnt lgkmcnt(8)
  v_mfma_f32_16x16x32_bf16 v[184:187], v[248:251], v[168:171], v[184:187]
  v_cvt_pk_bf16_f32 v175, v62, v63
  v_cvt_pk_bf16_f32 v152, v64, v65
  v_mfma_f32_16x16x32_bf16 v[192:195], v[248:251], v[176:179], v[192:195]
  ds_read_b128 v[248:251], v2 offset:47104
  v_cvt_pk_bf16_f32 v153, v66, v67
  v_mfma_f32_16x16x32_bf16 v[188:191], v[252:255], v[168:171], v[188:191]
  v_cvt_pk_bf16_f32 v154, v68, v69
  v_cvt_pk_bf16_f32 v155, v70, v71
  v_mfma_f32_16x16x32_bf16 v[196:199], v[252:255], v[176:179], v[196:199]
  ds_read_b128 v[252:255], v2 offset:48128
  s_waitcnt lgkmcnt(8)
  v_mfma_f32_16x16x32_bf16 v[184:187], v[216:219], v[172:175], v[184:187]
  v_mfma_f32_16x16x32_bf16 v[192:195], v[216:219], v[180:183], v[192:195]
  ds_read_b128 v[216:219], v2 offset:49152
  v_mfma_f32_16x16x32_bf16 v[188:191], v[220:223], v[172:175], v[188:191]
  v_mfma_f32_16x16x32_bf16 v[196:199], v[220:223], v[180:183], v[196:199]
  ds_read_b128 v[220:223], v2 offset:50176
  s_waitcnt lgkmcnt(8)
  v_mfma_f32_16x16x32_bf16 v[184:187], v[224:227], v[152:155], v[184:187]
  v_mfma_f32_16x16x32_bf16 v[192:195], v[224:227], v[72:75], v[192:195]
  ds_read_b128 v[224:227], v2 offset:51200
  v_mfma_f32_16x16x32_bf16 v[188:191], v[228:231], v[152:155], v[188:191]
  v_mfma_f32_16x16x32_bf16 v[196:199], v[228:231], v[72:75], v[196:199]
  ds_read_b128 v[228:231], v2 offset:52224
  s_mov_b32 s100, 71680
  buffer_load_dwordx4 v[40:43], v1, s[20:23], s100 offen offset:0 sc1
  buffer_load_dwordx4 v[44:47], v1, s[20:23], s100 offen offset:1024 sc1
  s_waitcnt lgkmcnt(8)
  v_mfma_f32_16x16x32_bf16 v[200:203], v[232:235], v[140:143], 0
  v_mul_f32 v184, v184, v22
  v_mul_f32 v185, v185, v22
  v_mfma_f32_16x16x32_bf16 v[208:211], v[232:235], v[156:159], 0
  ds_read_b128 v[232:235], v2 offset:53248
  v_mul_f32 v186, v186, v22
  v_mfma_f32_16x16x32_bf16 v[204:207], v[236:239], v[140:143], 0
  v_mul_f32 v187, v187, v22
  v_mul_f32 v188, v188, v22
  v_mfma_f32_16x16x32_bf16 v[212:215], v[236:239], v[156:159], 0
  ds_read_b128 v[236:239], v2 offset:54272
  s_waitcnt lgkmcnt(8)
  v_mfma_f32_16x16x32_bf16 v[200:203], v[240:243], v[144:147], v[200:203]
  v_mul_f32 v189, v189, v22
  v_mul_f32 v190, v190, v22
  v_mfma_f32_16x16x32_bf16 v[208:211], v[240:243], v[160:163], v[208:211]
  ds_read_b128 v[240:243], v2 offset:55296
  v_mul_f32 v191, v191, v22
  v_mfma_f32_16x16x32_bf16 v[204:207], v[244:247], v[144:147], v[204:207]
  v_cvt_pk_bf16_f32 v24, v184, v185
  v_cvt_pk_bf16_f32 v25, v186, v187
  v_mfma_f32_16x16x32_bf16 v[212:215], v[244:247], v[160:163], v[212:215]
  ds_read_b128 v[244:247], v2 offset:56320
  s_waitcnt lgkmcnt(8)
  v_mfma_f32_16x16x32_bf16 v[200:203], v[248:251], v[148:151], v[200:203]
  v_cvt_pk_bf16_f32 v26, v188, v189
  v_cvt_pk_bf16_f32 v27, v190, v191
  v_mfma_f32_16x16x32_bf16 v[208:211], v[248:251], v[164:167], v[208:211]
  buffer_store_dwordx4 v[24:27], v5, s[16:19], 0 offen offset:0 nt sc1
  v_mul_f32 v192, v192, v23
  v_mfma_f32_16x16x32_bf16 v[204:207], v[252:255], v[148:151], v[204:207]
  ds_read_b128 v[248:251], v2 offset:57344
  v_mul_f32 v193, v193, v23
  v_mfma_f32_16x16x32_bf16 v[212:215], v[252:255], v[164:167], v[212:215]
  ds_read_b128 v[252:255], v2 offset:58368
  s_waitcnt lgkmcnt(8)
  v_mfma_f32_16x16x32_bf16 v[200:203], v[216:219], v[168:171], v[200:203]
  v_mul_f32 v194, v194, v23
  v_mul_f32 v195, v195, v23
  v_mfma_f32_16x16x32_bf16 v[208:211], v[216:219], v[176:179], v[208:211]
  ds_read_b128 v[216:219], v2 offset:59392
  v_mul_f32 v196, v196, v23
  v_mfma_f32_16x16x32_bf16 v[204:207], v[220:223], v[168:171], v[204:207]
  v_mul_f32 v197, v197, v23
  v_mul_f32 v198, v198, v23
  v_mfma_f32_16x16x32_bf16 v[212:215], v[220:223], v[176:179], v[212:215]
  ds_read_b128 v[220:223], v2 offset:60416
  s_waitcnt lgkmcnt(8)
  v_mfma_f32_16x16x32_bf16 v[200:203], v[224:227], v[172:175], v[200:203]
  v_mul_f32 v199, v199, v23
  v_cvt_pk_bf16_f32 v28, v192, v193
  v_mfma_f32_16x16x32_bf16 v[208:211], v[224:227], v[180:183], v[208:211]
  ds_read_b128 v[224:227], v1 offset:0
  v_cvt_pk_bf16_f32 v29, v194, v195
  v_mfma_f32_16x16x32_bf16 v[204:207], v[228:231], v[172:175], v[204:207]
  v_cvt_pk_bf16_f32 v30, v196, v197
  v_cvt_pk_bf16_f32 v31, v198, v199
  v_mfma_f32_16x16x32_bf16 v[212:215], v[228:231], v[180:183], v[212:215]
  buffer_store_dwordx4 v[28:31], v6, s[16:19], 0 offen offset:0 nt sc1
  s_waitcnt lgkmcnt(7)
  v_mfma_f32_16x16x32_bf16 v[200:203], v[232:235], v[152:155], v[200:203]
  ds_read_b128 v[228:231], v1 offset:1024
  v_mfma_f32_16x16x32_bf16 v[208:211], v[232:235], v[72:75], v[208:211]
  ds_read_b128 v[232:235], v1 offset:2048
  v_mfma_f32_16x16x32_bf16 v[204:207], v[236:239], v[152:155], v[204:207]
  v_mfma_f32_16x16x32_bf16 v[212:215], v[236:239], v[72:75], v[212:215]
  ds_read_b128 v[236:239], v1 offset:3072
  s_cbranch_vccz SL55
  s_waitcnt vmcnt(4)
  s_barrier
SL55:
  s_waitcnt lgkmcnt(8)
  v_mfma_f32_16x16x32_bf16 v[184:187], v[240:243], v[140:143], 0
  v_mul_f32 v200, v200, v22
  v_mul_f32 v201, v201, v22
  v_mfma_f32_16x16x32_bf16 v[192:195], v[240:243], v[156:159], 0
  ds_read_b128 v[240:243], v1 offset:4096
  v_mul_f32 v202, v202, v22
  v_mfma_f32_16x16x32_bf16 v[188:191], v[244:247], v[140:143], 0
  v_mul_f32 v203, v203, v22
  v_mul_f32 v204, v204, v22
  v_mfma_f32_16x16x32_bf16 v[196:199], v[244:247], v[156:159], 0
  ds_read_b128 v[244:247], v1 offset:5120
  s_waitcnt lgkmcnt(8)
  v_mfma_f32_16x16x32_bf16 v[184:187], v[248:251], v[144:147], v[184:187]
  v_mul_f32 v205, v205, v22
  v_mul_f32 v206, v206, v22
  v_mfma_f32_16x16x32_bf16 v[192:195], v[248:251], v[160:163], v[192:195]
  ds_read_b128 v[248:251], v1 offset:6144
  v_mul_f32 v207, v207, v22
  v_mfma_f32_16x16x32_bf16 v[188:191], v[252:255], v[144:147], v[188:191]
  v_cvt_pk_bf16_f32 v32, v200, v201
  v_cvt_pk_bf16_f32 v33, v202, v203
  v_mfma_f32_16x16x32_bf16 v[196:199], v[252:255], v[160:163], v[196:199]
  ds_read_b128 v[252:255], v1 offset:7168
  s_waitcnt lgkmcnt(8)
  v_mfma_f32_16x16x32_bf16 v[184:187], v[216:219], v[148:151], v[184:187]
  v_cvt_pk_bf16_f32 v34, v204, v205
  v_cvt_pk_bf16_f32 v35, v206, v207
  v_mfma_f32_16x16x32_bf16 v[192:195], v[216:219], v[164:167], v[192:195]
  buffer_store_dwordx4 v[32:35], v5, s[16:19], 0 offen offset:64 nt sc1
  v_mul_f32 v208, v208, v23
  v_mfma_f32_16x16x32_bf16 v[188:191], v[220:223], v[148:151], v[188:191]
  ds_read_b128 v[216:219], v1 offset:8192
  v_mul_f32 v209, v209, v23
  v_mfma_f32_16x16x32_bf16 v[196:199], v[220:223], v[164:167], v[196:199]
  ds_read_b128 v[220:223], v1 offset:9216
  s_waitcnt lgkmcnt(8)
  v_mfma_f32_16x16x32_bf16 v[184:187], v[224:227], v[168:171], v[184:187]
  v_mul_f32 v210, v210, v23
  v_mul_f32 v211, v211, v23
  v_mfma_f32_16x16x32_bf16 v[192:195], v[224:227], v[176:179], v[192:195]
  ds_read_b128 v[224:227], v2 offset:0
  v_mul_f32 v212, v212, v23
  v_mfma_f32_16x16x32_bf16 v[188:191], v[228:231], v[168:171], v[188:191]
  v_mul_f32 v213, v213, v23
  v_mul_f32 v214, v214, v23
  v_mfma_f32_16x16x32_bf16 v[196:199], v[228:231], v[176:179], v[196:199]
  ds_read_b128 v[228:231], v2 offset:1024
  s_waitcnt lgkmcnt(8)
  v_mfma_f32_16x16x32_bf16 v[184:187], v[232:235], v[172:175], v[184:187]
  v_mul_f32 v215, v215, v23
  v_cvt_pk_bf16_f32 v36, v208, v209
  v_mfma_f32_16x16x32_bf16 v[192:195], v[232:235], v[180:183], v[192:195]
  ds_read_b128 v[232:235], v2 offset:2048
  v_cvt_pk_bf16_f32 v37, v210, v211
  v_mfma_f32_16x16x32_bf16 v[188:191], v[236:239], v[172:175], v[188:191]
  v_cvt_pk_bf16_f32 v38, v212, v213
  v_cvt_pk_bf16_f32 v39, v214, v215
  v_mfma_f32_16x16x32_bf16 v[196:199], v[236:239], v[180:183], v[196:199]
  buffer_store_dwordx4 v[36:39], v6, s[16:19], 0 offen offset:64 nt sc1
  s_waitcnt lgkmcnt(7)
  v_mfma_f32_16x16x32_bf16 v[184:187], v[240:243], v[152:155], v[184:187]
  ds_read_b128 v[236:239], v2 offset:3072
  v_mfma_f32_16x16x32_bf16 v[192:195], v[240:243], v[72:75], v[192:195]
  ds_read_b128 v[240:243], v2 offset:4096
  v_mfma_f32_16x16x32_bf16 v[188:191], v[244:247], v[152:155], v[188:191]
  v_mfma_f32_16x16x32_bf16 v[196:199], v[244:247], v[72:75], v[196:199]
  ds_read_b128 v[244:247], v2 offset:5120
  s_waitcnt lgkmcnt(8)
  v_mfma_f32_16x16x32_bf16 v[200:203], v[248:251], v[140:143], 0
  v_mul_f32 v184, v184, v22
  v_mul_f32 v185, v185, v22
  v_mfma_f32_16x16x32_bf16 v[208:211], v[248:251], v[156:159], 0
  ds_read_b128 v[248:251], v2 offset:6144
  v_mul_f32 v186, v186, v22
  v_mfma_f32_16x16x32_bf16 v[204:207], v[252:255], v[140:143], 0
  v_mul_f32 v187, v187, v22
  v_mul_f32 v188, v188, v22
  v_mfma_f32_16x16x32_bf16 v[212:215], v[252:255], v[156:159], 0
  ds_read_b128 v[252:255], v2 offset:7168
  s_waitcnt lgkmcnt(8)
  v_mfma_f32_16x16x32_bf16 v[200:203], v[216:219], v[144:147], v[200:203]
  v_mul_f32 v189, v189, v22
  v_mul_f32 v190, v190, v22
  v_mfma_f32_16x16x32_bf16 v[208:211], v[216:219], v[160:163], v[208:211]
  ds_read_b128 v[216:219], v2 offset:8192
  v_mul_f32 v191, v191, v22
  v_mfma_f32_16x16x32_bf16 v[204:207], v[220:223], v[144:147], v[204:207]
  v_cvt_pk_bf16_f32 v24, v184, v185
  v_cvt_pk_bf16_f32 v25, v186, v187
  v_mfma_f32_16x16x32_bf16 v[212:215], v[220:223], v[160:163], v[212:215]
  ds_read_b128 v[220:223], v2 offset:9216
  s_waitcnt lgkmcnt(8)
  v_mfma_f32_16x16x32_bf16 v[200:203], v[224:227], v[148:151], v[200:203]
  v_cvt_pk_bf16_f32 v26, v188, v189
  v_cvt_pk_bf16_f32 v27, v190, v191
  v_mfma_f32_16x16x32_bf16 v[208:211], v[224:227], v[164:167], v[208:211]
  buffer_store_dwordx4 v[24:27], v5, s[16:19], 0 offen offset:128 nt sc1
  v_mul_f32 v192, v192, v23
  v_mfma_f32_16x16x32_bf16 v[204:207], v[228:231], v[148:151], v[204:207]
  ds_read_b128 v[224:227], v2 offset:10240
  v_mul_f32 v193, v193, v23
  v_mfma_f32_16x16x32_bf16 v[212:215], v[228:231], v[164:167], v[212:215]
  ds_read_b128 v[228:231], v2 offset:11264
  s_waitcnt lgkmcnt(8)
  v_mfma_f32_16x16x32_bf16 v[200:203], v[232:235], v[168:171], v[200:203]
  v_mul_f32 v194, v194, v23
  v_mul_f32 v195, v195, v23
  v_mfma_f32_16x16x32_bf16 v[208:211], v[232:235], v[176:179], v[208:211]
  ds_read_b128 v[232:235], v2 offset:12288
  v_mul_f32 v196, v196, v23
  v_mfma_f32_16x16x32_bf16 v[204:207], v[236:239], v[168:171], v[204:207]
  v_mul_f32 v197, v197, v23
  v_mul_f32 v198, v198, v23
  v_mfma_f32_16x16x32_bf16 v[212:215], v[236:239], v[176:179], v[212:215]
  ds_read_b128 v[236:239], v2 offset:13312
  s_waitcnt lgkmcnt(8)
  v_mfma_f32_16x16x32_bf16 v[200:203], v[240:243], v[172:175], v[200:203]
  v_mul_f32 v199, v199, v23
  v_cvt_pk_bf16_f32 v28, v192, v193
  v_mfma_f32_16x16x32_bf16 v[208:211], v[240:243], v[180:183], v[208:211]
  ds_read_b128 v[240:243], v2 offset:14336
  v_cvt_pk_bf16_f32 v29, v194, v195
  v_mfma_f32_16x16x32_bf16 v[204:207], v[244:247], v[172:175], v[204:207]
  v_cvt_pk_bf16_f32 v30, v196, v197
  v_cvt_pk_bf16_f32 v31, v198, v199
  v_mfma_f32_16x16x32_bf16 v[212:215], v[244:247], v[180:183], v[212:215]
  buffer_store_dwordx4 v[28:31], v6, s[16:19], 0 offen offset:128 nt sc1
  s_waitcnt lgkmcnt(7)
  v_mfma_f32_16x16x32_bf16 v[200:203], v[248:251], v[152:155], v[200:203]
  ds_read_b128 v[244:247], v2 offset:15360
  v_mfma_f32_16x16x32_bf16 v[208:211], v[248:251], v[72:75], v[208:211]
  ds_read_b128 v[248:251], v2 offset:16384
  v_mfma_f32_16x16x32_bf16 v[204:207], v[252:255], v[152:155], v[204:207]
  v_mfma_f32_16x16x32_bf16 v[212:215], v[252:255], v[72:75], v[212:215]
  ds_read_b128 v[252:255], v2 offset:17408
  s_waitcnt lgkmcnt(8)
  v_mfma_f32_16x16x32_bf16 v[184:187], v[216:219], v[140:143], 0
  v_mul_f32 v200, v200, v22
  v_mul_f32 v201, v201, v22
  v_mfma_f32_16x16x32_bf16 v[192:195], v[216:219], v[156:159], 0
  ds_read_b128 v[216:219], v2 offset:18432
  v_mul_f32 v202, v202, v22
  v_mfma_f32_16x16x32_bf16 v[188:191], v[220:223], v[140:143], 0
  v_mul_f32 v203, v203, v22
  v_mul_f32 v204, v204, v22
  v_mfma_f32_16x16x32_bf16 v[196:199], v[220:223], v[156:159], 0
  ds_read_b128 v[220:223], v2 offset:19456
  s_waitcnt lgkmcnt(8)
  v_mfma_f32_16x16x32_bf16 v[184:187], v[224:227], v[144:147], v[184:187]
  v_mul_f32 v205, v205, v22
  v_mul_f32 v206, v206, v22
  v_mfma_f32_16x16x32_bf16 v[192:195], v[224:227], v[160:163], v[192:195]
  ds_read_b128 v[224:227], v2 offset:20480
  v_mul_f32 v207, v207, v22
  v_mfma_f32_16x16x32_bf16 v[188:191], v[228:231], v[144:147], v[188:191]
  v_cvt_pk_bf16_f32 v32, v200, v201
  v_cvt_pk_bf16_f32 v33, v202, v203
  v_mfma_f32_16x16x32_bf16 v[196:199], v[228:231], v[160:163], v[196:199]
  ds_read_b128 v[228:231], v2 offset:21504
  s_waitcnt lgkmcnt(8)
  v_mfma_f32_16x16x32_bf16 v[184:187], v[232:235], v[148:151], v[184:187]
  v_cvt_pk_bf16_f32 v34, v204, v205
  v_cvt_pk_bf16_f32 v35, v206, v207
  v_mfma_f32_16x16x32_bf16 v[192:195], v[232:235], v[164:167], v[192:195]
  buffer_store_dwordx4 v[32:35], v5, s[16:19], 0 offen offset:192 nt sc1
  v_mul_f32 v208, v208, v23
  v_mfma_f32_16x16x32_bf16 v[188:191], v[236:239], v[148:151], v[188:191]
  ds_read_b128 v[232:235], v2 offset:22528
  v_mul_f32 v209, v209, v23
  v_mfma_f32_16x16x32_bf16 v[196:199], v[236:239], v[164:167], v[196:199]
  ds_read_b128 v[236:239], v2 offset:23552
  s_waitcnt lgkmcnt(8)
  v_mfma_f32_16x16x32_bf16 v[184:187], v[240:243], v[168:171], v[184:187]
  v_mul_f32 v210, v210, v23
  v_mul_f32 v211, v211, v23
  v_mfma_f32_16x16x32_bf16 v[192:195], v[240:243], v[176:179], v[192:195]
  ds_read_b128 v[240:243], v2 offset:24576
  v_mul_f32 v212, v212, v23
  v_mfma_f32_16x16x32_bf16 v[188:191], v[244:247], v[168:171], v[188:191]
  v_mul_f32 v213, v213, v23
  v_mul_f32 v214, v214, v23
  v_mfma_f32_16x16x32_bf16 v[196:199], v[244:247], v[176:179], v[196:199]
  ds_read_b128 v[244:247], v2 offset:25600
  s_waitcnt lgkmcnt(8)
  v_mfma_f32_16x16x32_bf16 v[184:187], v[248:251], v[172:175], v[184:187]
  v_mul_f32 v215, v215, v23
  v_cvt_pk_bf16_f32 v36, v208, v209
  v_mfma_f32_16x16x32_bf16 v[192:195], v[248:251], v[180:183], v[192:195]
  ds_read_b128 v[248:251], v2 offset:26624
  v_cvt_pk_bf16_f32 v37, v210, v211
  v_mfma_f32_16x16x32_bf16 v[188:191], v[252:255], v[172:175], v[188:191]
  v_cvt_pk_bf16_f32 v38, v212, v213
  v_cvt_pk_bf16_f32 v39, v214, v215
  v_mfma_f32_16x16x32_bf16 v[196:199], v[252:255], v[180:183], v[196:199]
  buffer_store_dwordx4 v[36:39], v6, s[16:19], 0 offen offset:192 nt sc1
  s_waitcnt lgkmcnt(7)
  v_mfma_f32_16x16x32_bf16 v[184:187], v[216:219], v[152:155], v[184:187]
  ds_read_b128 v[252:255], v2 offset:27648
  v_mfma_f32_16x16x32_bf16 v[192:195], v[216:219], v[72:75], v[192:195]
  ds_read_b128 v[216:219], v2 offset:28672
  v_mfma_f32_16x16x32_bf16 v[188:191], v[220:223], v[152:155], v[188:191]
  v_mfma_f32_16x16x32_bf16 v[196:199], v[220:223], v[72:75], v[196:199]
  ds_read_b128 v[220:223], v2 offset:29696
  s_waitcnt vmcnt(8)
  s_waitcnt lgkmcnt(8)
  v_mfma_f32_16x16x32_bf16 v[200:203], v[224:227], v[140:143], 0
  v_mul_f32 v184, v184, v22
  v_mul_f32 v185, v185, v22
  v_mfma_f32_16x16x32_bf16 v[208:211], v[224:227], v[156:159], 0
  v_mul_f32 v186, v186, v22
  v_mul_f32 v187, v187, v22
  v_mfma_f32_16x16x32_bf16 v[204:207], v[228:231], v[140:143], 0
  v_mul_f32 v188, v188, v22
  v_mul_f32 v189, v189, v22
  v_mfma_f32_16x16x32_bf16 v[212:215], v[228:231], v[156:159], 0
  v_mul_f32 v190, v190, v22
  s_waitcnt lgkmcnt(6)
  v_mfma_f32_16x16x32_bf16 v[200:203], v[232:235], v[144:147], v[200:203]
  v_mul_f32 v191, v191, v22
  v_cvt_pk_bf16_f32 v24, v184, v185
  v_mfma_f32_16x16x32_bf16 v[208:211], v[232:235], v[160:163], v[208:211]
  v_cvt_pk_bf16_f32 v25, v186, v187
  v_cvt_pk_bf16_f32 v26, v188, v189
  v_mfma_f32_16x16x32_bf16 v[204:207], v[236:239], v[144:147], v[204:207]
  v_cvt_pk_bf16_f32 v27, v190, v191
  v_mul_f32 v192, v192, v23
  v_mfma_f32_16x16x32_bf16 v[212:215], v[236:239], v[160:163], v[212:215]
  buffer_store_dwordx4 v[24:27], v5, s[16:19], 0 offen offset:256 nt sc1
  v_mul_f32 v193, v193, v23
  s_waitcnt lgkmcnt(5)
  v_mfma_f32_16x16x32_bf16 v[200:203], v[240:243], v[148:151], v[200:203]
  v_mul_f32 v194, v194, v23
  v_mul_f32 v195, v195, v23
  v_mfma_f32_16x16x32_bf16 v[208:211], v[240:243], v[164:167], v[208:211]
  v_mul_f32 v196, v196, v23
  s_waitcnt lgkmcnt(4)
  v_mfma_f32_16x16x32_bf16 v[204:207], v[244:247], v[148:151], v[204:207]
  v_mul_f32 v197, v197, v23
  v_mul_f32 v198, v198, v23
  v_mfma_f32_16x16x32_bf16 v[212:215], v[244:247], v[164:167], v[212:215]
  v_mul_f32 v199, v199, v23
  s_waitcnt lgkmcnt(3)
  v_mfma_f32_16x16x32_bf16 v[200:203], v[248:251], v[168:171], v[200:203]
  v_cvt_pk_bf16_f32 v28, v192, v193
  v_cvt_pk_bf16_f32 v29, v194, v195
  v_mfma_f32_16x16x32_bf16 v[208:211], v[248:251], v[176:179], v[208:211]
  v_cvt_pk_bf16_f32 v30, v196, v197
  s_waitcnt lgkmcnt(2)
  v_mfma_f32_16x16x32_bf16 v[204:207], v[252:255], v[168:171], v[204:207]
  v_cvt_pk_bf16_f32 v31, v198, v199
  v_mfma_f32_16x16x32_bf16 v[212:215], v[252:255], v[176:179], v[212:215]
  buffer_store_dwordx4 v[28:31], v6, s[16:19], 0 offen offset:256 nt sc1
  s_waitcnt lgkmcnt(1)
  v_mfma_f32_16x16x32_bf16 v[200:203], v[216:219], v[172:175], v[200:203]
  v_mfma_f32_16x16x32_bf16 v[208:211], v[216:219], v[180:183], v[208:211]
  s_waitcnt lgkmcnt(0)
  v_mfma_f32_16x16x32_bf16 v[204:207], v[220:223], v[172:175], v[204:207]
  v_mfma_f32_16x16x32_bf16 v[212:215], v[220:223], v[180:183], v[212:215]
  v_mfma_f32_16x16x32_bf16 v[200:203], v[40:43], v[152:155], v[200:203]
  v_mfma_f32_16x16x32_bf16 v[208:211], v[40:43], v[72:75], v[208:211]
  v_mfma_f32_16x16x32_bf16 v[204:207], v[44:47], v[152:155], v[204:207]
  v_mfma_f32_16x16x32_bf16 v[212:215], v[44:47], v[72:75], v[212:215]
  s_nop 4
  v_mul_f32 v200, v200, v22
  v_mul_f32 v201, v201, v22
  v_mul_f32 v202, v202, v22
  v_mul_f32 v203, v203, v22
  v_mul_f32 v204, v204, v22
  v_mul_f32 v205, v205, v22
  v_mul_f32 v206, v206, v22
  v_mul_f32 v207, v207, v22
  v_cvt_pk_bf16_f32 v32, v200, v201
  v_cvt_pk_bf16_f32 v33, v202, v203
  v_cvt_pk_bf16_f32 v34, v204, v205
  v_cvt_pk_bf16_f32 v35, v206, v207
  buffer_store_dwordx4 v[32:35], v5, s[16:19], 0 offen offset:320 nt sc1
  v_mul_f32 v208, v208, v23
  v_mul_f32 v209, v209, v23
  v_mul_f32 v210, v210, v23
  v_mul_f32 v211, v211, v23
  v_mul_f32 v212, v212, v23
  v_mul_f32 v213, v213, v23
  v_mul_f32 v214, v214, v23
  v_mul_f32 v215, v215, v23
  v_cvt_pk_bf16_f32 v36, v208, v209
  v_cvt_pk_bf16_f32 v37, v210, v211
  v_cvt_pk_bf16_f32 v38, v212, v213
  v_cvt_pk_bf16_f32 v39, v214, v215
  buffer_store_dwordx4 v[36:39], v6, s[16:19], 0 offen offset:320 nt sc1
MK_done:
  s_endpgm
FB0:
  s_nop 7
  v_max3_f32 v22, v24, v25, v26
  v_max3_f32 v22, v22, v27, v28
  v_max3_f32 v22, v22, v29, v30
  v_max3_f32 v22, v22, v31, v32
  v_max3_f32 v22, v22, v33, v34
  v_max3_f32 v22, v22, v35, v36
  v_max3_f32 v22, v22, v37, v38
  v_max3_f32 v22, v22, v39, v40
  v_max3_f32 v22, v22, v41, v42
  v_max3_f32 v22, v22, v43, v44
  v_max3_f32 v22, v22, v45, v46
  v_max3_f32 v22, v22, v47, v48
  v_max3_f32 v22, v22, v49, v50
  v_max3_f32 v22, v22, v51, v52
  v_max3_f32 v22, v22, v53, v54
  s_mov_b32 s52, 0xff7fffff
  v_max3_f32 v22, v22, v55, s52
  v_mov_b32 v23, v22
  s_nop 1
  v_permlane32_swap_b32 v22, v23
  s_nop 1
  v_max_f32 v22, v22, v23
  v_mov_b32 v23, v22
  s_nop 1
  v_permlane16_swap_b32 v22, v23
  s_nop 1
  v_max_f32 v22, v22, v23
  v_sub_f32 v24, v24, v22
  v_sub_f32 v25, v25, v22
  v_sub_f32 v26, v26, v22
  v_sub_f32 v27, v27, v22
  v_sub_f32 v28, v28, v22
  v_sub_f32 v29, v29, v22
  v_sub_f32 v30, v30, v22
  v_sub_f32 v31, v31, v22
  v_sub_f32 v32, v32, v22
  v_sub_f32 v33, v33, v22
  v_sub_f32 v34, v34, v22
  v_sub_f32 v35, v35, v22
  v_sub_f32 v36, v36, v22
  v_sub_f32 v37, v37, v22
  v_sub_f32 v38, v38, v22
  v_sub_f32 v39, v39, v22
  v_sub_f32 v40, v40, v22
  v_sub_f32 v41, v41, v22
  v_sub_f32 v42, v42, v22
  v_sub_f32 v43, v43, v22
  v_sub_f32 v44, v44, v22
  v_sub_f32 v45, v45, v22
  v_sub_f32 v46, v46, v22
  v_sub_f32 v47, v47, v22
  v_sub_f32 v48, v48, v22
  v_sub_f32 v49, v49, v22
  v_sub_f32 v50, v50, v22
  v_sub_f32 v51, v51, v22
  v_sub_f32 v52, v52, v22
  v_sub_f32 v53, v53, v22
  v_sub_f32 v54, v54, v22
  v_sub_f32 v55, v55, v22
  v_exp_f32 v24, v24
  v_exp_f32 v25, v25
  v_exp_f32 v26, v26
  v_exp_f32 v27, v27
  v_exp_f32 v28, v28
  v_exp_f32 v29, v29
  v_exp_f32 v30, v30
  v_exp_f32 v31, v31
  v_exp_f32 v32, v32
  v_exp_f32 v33, v33
  v_exp_f32 v34, v34
  v_exp_f32 v35, v35
  v_exp_f32 v36, v36
  v_exp_f32 v37, v37
  v_exp_f32 v38, v38
  v_exp_f32 v39, v39
  v_exp_f32 v40, v40
  v_exp_f32 v41, v41
  v_exp_f32 v42, v42
  v_exp_f32 v43, v43
  v_exp_f32 v44, v44
  v_exp_f32 v45, v45
  v_exp_f32 v46, v46
  v_exp_f32 v47, v47
  v_exp_f32 v48, v48
  v_exp_f32 v49, v49
  v_exp_f32 v50, v50
  v_exp_f32 v51, v51
  v_exp_f32 v52, v52
  v_exp_f32 v53, v53
  v_exp_f32 v54, v54
  v_exp_f32 v55, v55
  s_nop 0
  v_cvt_pk_bf16_f32 v136, v24, v25
  v_cvt_pk_bf16_f32 v137, v26, v27
  v_cvt_pk_bf16_f32 v138, v28, v29
  v_cvt_pk_bf16_f32 v139, v30, v31
  v_cvt_pk_bf16_f32 v140, v32, v33
  v_cvt_pk_bf16_f32 v141, v34, v35
  v_cvt_pk_bf16_f32 v142, v36, v37
  v_cvt_pk_bf16_f32 v143, v38, v39
  v_cvt_pk_bf16_f32 v144, v40, v41
  v_cvt_pk_bf16_f32 v145, v42, v43
  v_cvt_pk_bf16_f32 v146, v44, v45
  v_cvt_pk_bf16_f32 v147, v46, v47
  v_cvt_pk_bf16_f32 v148, v48, v49
  v_cvt_pk_bf16_f32 v149, v50, v51
  v_cvt_pk_bf16_f32 v150, v52, v53
  v_cvt_pk_bf16_f32 v151, v54, v55
  s_nop 1
  v_mfma_f32_16x16x32_bf16 v[184:187], v[192:195], v[136:139], 0
  v_mfma_f32_16x16x32_bf16 v[184:187], v[192:195], v[140:143], v[184:187]
  v_mfma_f32_16x16x32_bf16 v[184:187], v[192:195], v[144:147], v[184:187]
  v_mfma_f32_16x16x32_bf16 v[184:187], v[192:195], v[148:151], v[184:187]
  s_nop 7
  s_branch FBR0
FB1:
  s_nop 7
  v_max3_f32 v22, v56, v57, v58
  v_max3_f32 v22, v22, v59, v60
  v_max3_f32 v22, v22, v61, v62
  v_max3_f32 v22, v22, v63, v64
  v_max3_f32 v22, v22, v65, v66
  v_max3_f32 v22, v22, v67, v68
  v_max3_f32 v22, v22, v69, v70
  v_max3_f32 v22, v22, v71, v72
  v_max3_f32 v22, v22, v73, v74
  v_max3_f32 v22, v22, v75, v76
  v_max3_f32 v22, v22, v77, v78
  v_max3_f32 v22, v22, v79, v80
  v_max3_f32 v22, v22, v81, v82
  v_max3_f32 v22, v22, v83, v84
  v_max3_f32 v22, v22, v85, v86
  s_mov_b32 s52, 0xff7fffff
  v_max3_f32 v22, v22, v87, s52
  v_mov_b32 v23, v22
  s_nop 1
  v_permlane32_swap_b32 v22, v23
  s_nop 1
  v_max_f32 v22, v22, v23
  v_mov_b32 v23, v22
  s_nop 1
  v_permlane16_swap_b32 v22, v23
  s_nop 1
  v_max_f32 v22, v22, v23
  v_sub_f32 v56, v56, v22
  v_sub_f32 v57, v57, v22
  v_sub_f32 v58, v58, v22
  v_sub_f32 v59, v59, v22
  v_sub_f32 v60, v60, v22
  v_sub_f32 v61, v61, v22
  v_sub_f32 v62, v62, v22
  v_sub_f32 v63, v63, v22
  v_sub_f32 v64, v64, v22
  v_sub_f32 v65, v65, v22
  v_sub_f32 v66, v66, v22
  v_sub_f32 v67, v67, v22
  v_sub_f32 v68, v68, v22
  v_sub_f32 v69, v69, v22
  v_sub_f32 v70, v70, v22
  v_sub_f32 v71, v71, v22
  v_sub_f32 v72, v72, v22
  v_sub_f32 v73, v73, v22
  v_sub_f32 v74, v74, v22
  v_sub_f32 v75, v75, v22
  v_sub_f32 v76, v76, v22
  v_sub_f32 v77, v77, v22
  v_sub_f32 v78, v78, v22
  v_sub_f32 v79, v79, v22
  v_sub_f32 v80, v80, v22
  v_sub_f32 v81, v81, v22
  v_sub_f32 v82, v82, v22
  v_sub_f32 v83, v83, v22
  v_sub_f32 v84, v84, v22
  v_sub_f32 v85, v85, v22
  v_sub_f32 v86, v86, v22
  v_sub_f32 v87, v87, v22
  v_exp_f32 v56, v56
  v_exp_f32 v57, v57
  v_exp_f32 v58, v58
  v_exp_f32 v59, v59
  v_exp_f32 v60, v60
  v_exp_f32 v61, v61
  v_exp_f32 v62, v62
  v_exp_f32 v63, v63
  v_exp_f32 v64, v64
  v_exp_f32 v65, v65
  v_exp_f32 v66, v66
  v_exp_f32 v67, v67
  v_exp_f32 v68, v68
  v_exp_f32 v69, v69
  v_exp_f32 v70, v70
  v_exp_f32 v71, v71
  v_exp_f32 v72, v72
  v_exp_f32 v73, v73
  v_exp_f32 v74, v74
  v_exp_f32 v75, v75
  v_exp_f32 v76, v76
  v_exp_f32 v77, v77
  v_exp_f32 v78, v78
  v_exp_f32 v79, v79
  v_exp_f32 v80, v80
  v_exp_f32 v81, v81
  v_exp_f32 v82, v82
  v_exp_f32 v83, v83
  v_exp_f32 v84, v84
  v_exp_f32 v85, v85
  v_exp_f32 v86, v86
  v_exp_f32 v87, v87
  s_nop 0
  v_cvt_pk_bf16_f32 v152, v56, v57
  v_cvt_pk_bf16_f32 v153, v58, v59
  v_cvt_pk_bf16_f32 v154, v60, v61
  v_cvt_pk_bf16_f32 v155, v62, v63
  v_cvt_pk_bf16_f32 v156, v64, v65
  v_cvt_pk_bf16_f32 v157, v66, v67
  v_cvt_pk_bf16_f32 v158, v68, v69
  v_cvt_pk_bf16_f32 v159, v70, v71
  v_cvt_pk_bf16_f32 v160, v72, v73
  v_cvt_pk_bf16_f32 v161, v74, v75
  v_cvt_pk_bf16_f32 v162, v76, v77
  v_cvt_pk_bf16_f32 v163, v78, v79
  v_cvt_pk_bf16_f32 v164, v80, v81
  v_cvt_pk_bf16_f32 v165, v82, v83
  v_cvt_pk_bf16_f32 v166, v84, v85
  v_cvt_pk_bf16_f32 v167, v86, v87
  s_nop 1
  v_mfma_f32_16x16x32_bf16 v[188:191], v[192:195], v[152:155], 0
  v_mfma_f32_16x16x32_bf16 v[188:191], v[192:195], v[156:159], v[188:191]
  v_mfma_f32_16x16x32_bf16 v[188:191], v[192:195], v[160:163], v[188:191]
  v_mfma_f32_16x16x32_bf16 v[188:191], v[192:195], v[164:167], v[188:191]
  s_nop 7
  s_branch FBR1
MK_end:
.section .rodata,"a"
.p2align 6
.amdhsa_kernel standalone__neighborhood_nat__vision_kernel
  .amdhsa_next_free_vgpr 256
  .amdhsa_next_free_sgpr 102
  .amdhsa_accum_offset 256
  .amdhsa_group_segment_fixed_size 0
  .amdhsa_kernarg_size 48
  .amdhsa_user_sgpr_count 2
  .amdhsa_user_sgpr_kernarg_segment_ptr 1
  .amdhsa_system_sgpr_workgroup_id_x 1
.end_amdhsa_kernel
```

```asm
; @launch grid=(256,1,1) block=(512,1,1) lds=163840
.amdgcn_target "amdgcn-amd-amdhsa--gfx950"
.text
.globl standalone__neighborhood_nat__vision_kernel
.p2align 8
.type standalone__neighborhood_nat__vision_kernel,@function
standalone__neighborhood_nat__vision_kernel:
  s_cmp_ge_u32 s2, 256
  s_cbranch_scc1 MK_done
  s_load_dwordx8 s[4:11], s[0:1], 0
  s_load_dwordx4 s[84:87], s[0:1], 32
  s_getpc_b64 s[12:13]
MK_pc:
  s_and_b32 s13, s13, 0xffff
  s_mov_b32 s14, MK_end-MK_pc
  s_mov_b32 s15, 0x00020000
  v_lshlrev_b32 v23, 7, v0
  buffer_load_dword v255, v23, s[12:15], 0 offen
  v_lshrrev_b32 v130, 6, v0
  v_and_b32 v0, 63, v0
  v_readfirstlane_b32 s24, v130
  v_and_b32 v128, 15, v0
  v_lshrrev_b32 v129, 4, v0
  v_lshrrev_b32 v130, 5, v0
  v_bfe_u32 v131, v0, 3, 2
  v_lshl_add_u32 v130, v130, 3, v131
  v_mul_u32_u24 v130, 1152, v130
  s_and_b32 s26, s24, 1
  s_lshl_b32 s46, s26, 2
  v_add_u32 v131, s46, v129
  v_and_b32 v132, 7, v0
  v_xor_b32 v131, v131, v132
  v_lshl_add_u32 v96, v131, 4, v130
  s_lshr_b32 s46, s24, 2
  s_lshl_b32 s46, s46, 5
  s_lshl_b32 s47, s26, 4
  s_add_u32 s46, s46, s47
  s_and_b32 s47, s24, 2
  s_lshl_b32 s47, s47, 1
  s_add_u32 s46, s46, s47
  s_mul_i32 s92, s46, 1152
  s_lshl_b32 s41, s24, 10
  s_cmp_lt_u32 s24, 4
  s_cselect_b64 vcc, -1, 0
  s_cbranch_vccz SL1
  s_waitcnt lgkmcnt(0)
  s_mov_b32 s88, s6
  s_and_b32 s89, s7, 0xffff
  s_mov_b32 s90, 221184
  s_mov_b32 s91, 0x00020000
  s_add_i32 m0, s41, 0
  s_add_i32 s100, s92, 0
  buffer_load_dwordx4 v96, s[88:91], s100 offen lds
  s_add_i32 m0, s41, 8192
  s_add_i32 s100, s92, 73728
  buffer_load_dwordx4 v96, s[88:91], s100 offen lds
  s_add_i32 m0, s41, 16384
  s_add_i32 s100, s92, 147456
  buffer_load_dwordx4 v96, s[88:91], s100 offen lds
  s_add_i32 m0, s41, 24576
  s_add_i32 s100, s92, 384
  buffer_load_dwordx4 v96, s[88:91], s100 offen lds
  s_add_i32 m0, s41, 32768
  s_add_i32 s100, s92, 74112
  buffer_load_dwordx4 v96, s[88:91], s100 offen lds
  s_add_i32 m0, s41, 40960
  s_add_i32 s100, s92, 147840
  buffer_load_dwordx4 v96, s[88:91], s100 offen lds
SL1:
  s_bfe_u32 s27, s2, 0x10002
  s_bfe_u32 s28, s2, 0x10001
  s_and_b32 s29, s2, 1
  s_lshl_b32 s29, s29, 2
  s_lshr_b32 s46, s2, 6
  s_add_u32 s29, s29, s46
  s_bfe_u32 s30, s2, 0x30003
  s_mul_i32 s37, s29, 14
  s_add_i32 s37, s37, -6
  s_max_i32 s29, s37, -4
  s_mul_i32 s30, s30, 14
  s_add_i32 s30, s30, -6
  s_lshr_b32 s25, s24, 1
  s_add_u32 s25, s25, 2
  s_and_b32 s25, s25, 3
  s_sub_u32 s56, 0, s27
  s_mul_i32 s57, s27, 224
  s_sub_u32 s58, 0, s28
  s_mul_i32 s59, s28, 224
  v_and_b32 v130, 7, v128
  s_mul_i32 s46, s26, 7
  s_add_i32 s46, s46, s30
  v_cmp_lt_u32 s[48:49], 6, v130
  v_add_u32 v130, s46, v130
  v_max_i32 v19, 0, v130
  v_add3_u32 v130, v130, v19, 6
  v_xor_b32 v130, s58, v130
  v_add_u32 v130, s59, v130
  v_subrev_u32 v19, s30, v19
  v_mul_u32_u24 v130, 384, v130
  v_lshl_add_u32 v130, v129, 4, v130
  s_lshl_b32 s46, s25, 2
  s_add_i32 s46, s46, -2
  s_mov_b32 s47, 86016
  v_lshrrev_b32 v131, 3, v128
  v_add_u32 v131, s46, v131
  v_mov_b32 v132, 0x80000000
  v_cmp_gt_i32 s[42:43], 0, v131
  v_add_u32 v5, s37, v131
  v_max_i32 v21, 0, v5
  v_add3_u32 v5, v5, v21, 6
  s_or_b64 s[42:43], s[42:43], s[48:49]
  v_xor_b32 v5, s56, v5
  v_add_u32 v5, s57, v5
  v_subrev_u32 v21, s29, v21
  v_mad_u32_u24 v5, v5, s47, v130
  v_cndmask_b32 v21, v21, v132, s[42:43]
  v_cndmask_b32 v5, v5, v132, s[42:43]
  v_add_u32 v131, 2, v131
  v_cmp_gt_i32 s[44:45], 0, v131
  v_add_u32 v6, s37, v131
  v_max_i32 v22, 0, v6
  v_add3_u32 v6, v6, v22, 6
  s_or_b64 s[44:45], s[44:45], s[48:49]
  v_xor_b32 v6, s56, v6
  v_add_u32 v6, s57, v6
  v_subrev_u32 v22, s29, v22
  v_mad_u32_u24 v6, v6, s47, v130
  v_cndmask_b32 v22, v22, v132, s[44:45]
  v_cndmask_b32 v6, v6, v132, s[44:45]
  s_waitcnt lgkmcnt(0)
  s_mov_b32 s88, s6
  s_and_b32 s89, s7, 0xffff
  s_mov_b32 s90, 221184
  s_mov_b32 s91, 0x00020000
  s_cmp_lg_u32 s24, 5
  s_cbranch_scc1 MK_ntlb
  s_max_i32 s46, s37, 0
  s_lshl_b32 s46, s46, 1
  s_sub_u32 s47, 184, s46
  s_cmp_eq_u32 s27, 0
  s_cselect_b32 s46, s46, s47
  s_mul_i32 s46, s46, 86016
  s_load_dword s94, s[4:5], s46
  s_load_dword s95, s[10:11], s46
  s_add_u32 s46, s46, 1720256
  s_load_dword s94, s[4:5], s46
  s_load_dword s95, s[10:11], s46
  s_add_u32 s46, s46, 1720256
  s_load_dword s94, s[4:5], s46
  s_load_dword s95, s[10:11], s46
  s_load_dword s94, s[84:85], 128
  s_load_dword s95, s[86:87], 0x20000
MK_ntlb:
  s_lshr_b32 s46, s24, 1
  s_cmp_lg_u32 s46, 2
  s_cbranch_scc1 MK_nwpf
  s_cmp_eq_u32 s24, 4
  s_cselect_b32 s46, 54, 18
  s_cselect_b32 s12, s6, s8
  s_cselect_b32 s13, s7, s9
  s_and_b32 s13, s13, 0xffff
  s_lshr_b32 s47, s2, 3
  s_mul_i32 s47, s47, s46
  s_lshl_b32 s100, s47, 7
  s_lshl_b32 s46, s46, 7
  s_add_u32 s14, s100, s46
  s_mov_b32 s15, 0x00020000
  v_lshlrev_b32 v23, 7, v0
  buffer_load_dword v254, v23, s[12:15], s100 offen
MK_nwpf:
  s_mov_b32 s12, s4
  s_and_b32 s13, s5, 0xffff
  s_mov_b32 s14, 19267584
  s_mov_b32 s15, 0x00020000
  s_movk_i32 s54, 112
  s_mov_b32 s16, s10
  s_and_b32 s17, s11, 0xffff
  s_mov_b32 s18, 19267584
  s_mov_b32 s19, 0x00020000
  s_mov_b32 s4, s8
  s_and_b32 s5, s9, 0xffff
  s_mov_b32 s6, 73728
  s_mov_b32 s7, 0x00020000
  s_mov_b32 s8, s84
  s_and_b32 s9, s85, 0xffff
  s_mov_b32 s10, 256
  s_mov_b32 s11, 0x00020000
  s_mov_b32 s20, s86
  s_and_b32 s21, s87, 0xffff
  s_mov_b32 s22, 73728
  s_mov_b32 s23, 0x00020000
  v_lshlrev_b32 v1, 4, v0
  v_add_u32 v2, 36864, v1
  s_and_b32 s40, s24, 3
  s_lshl_b32 s40, s40, 10
  v_bfe_u32 v130, v128, 1, 3
  v_xor_b32 v130, v130, v129
  v_lshlrev_b32 v131, 7, v128
  v_lshl_add_u32 v131, v130, 4, v131
  s_lshr_b32 s46, s24, 2
  s_mul_i32 s47, s46, 12288
  s_add_u32 s47, s47, 0
  v_add_u32 v97, s47, v131
  v_xor_b32 v98, 64, v97
  s_mul_i32 s47, s40, 6
  s_add_u32 s47, s47, 24576
  v_add_u32 v99, s47, v131
  v_xor_b32 v100, 64, v99
  v_mov_b32 v135, 0
  v_mov_b32 v134, 0
  s_lshr_b32 s46, s24, 2
  s_mul_i32 s46, s46, 3072
  s_mul_i32 s47, s40, 18
  s_add_u32 s46, s46, s47
  s_sub_u32 s46, 58368, s46
  v_add_u32 v101, s46, v1
  s_lshl_b32 s46, s29, 1
  s_xor_b32 s46, s46, s56
  s_mul_i32 s47, s27, 222
  s_add_i32 s31, s46, s47
  s_mul_i32 s31, s31, 86016
  s_mul_i32 s32, s27, -688128
  s_add_i32 s32, s32, 344064
  s_lshr_b32 s33, s29, 31
  s_lshl_b32 s33, s33, 1
  s_lshl_b32 s38, s40, 2
  s_add_u32 s39, s38, 3072
  s_min_u32 s39, s39, 14336
  s_mul_i32 s48, s27, 172032
  s_sub_u32 s49, 172032, s48
  v_mov_b32 v132, s48
  v_mov_b32 v133, s49
  s_lshr_b32 s46, s38, 4
  s_add_u32 s46, s46, 0
  v_add_u32 v130, s46, v0
  v_mul_u32_u24 v13, 2731, v130
  v_lshrrev_b32 v13, 16, v13
  v_cmp_le_u32 s[52:53], 20, v13
  v_mul_u32_u24 v131, 24, v13
  v_sub_u32 v130, v130, v131
  v_subrev_u32 v131, 20, v13
  v_cndmask_b32 v13, v13, v131, s[52:53]
  v_bfe_u32 v131, v13, 1, 3
  v_xor_b32 v130, v130, v131
  v_cndmask_b32 v131, v132, v133, s[52:53]
  v_lshl_add_u32 v130, v130, 4, v131
  v_add_u32 v13, s30, v13
  v_max_i32 v13, 0, v13
  s_cbranch_vccz SL2
  s_add_i32 m0, s41, 4096
  s_add_i32 s100, s92, 36864
  buffer_load_dwordx4 v96, s[88:91], s100 offen lds
  s_add_i32 m0, s41, 12288
  s_add_i32 s100, s92, 110592
  buffer_load_dwordx4 v96, s[88:91], s100 offen lds
  s_add_i32 m0, s41, 20480
  s_add_i32 s100, s92, 184320
  buffer_load_dwordx4 v96, s[88:91], s100 offen lds
  s_add_i32 m0, s41, 28672
  s_add_i32 s100, s92, 37248
  buffer_load_dwordx4 v96, s[88:91], s100 offen lds
  s_add_i32 m0, s41, 36864
  s_add_i32 s100, s92, 110976
  buffer_load_dwordx4 v96, s[88:91], s100 offen lds
  s_add_i32 m0, s41, 45056
  s_add_i32 s100, s92, 184704
  buffer_load_dwordx4 v96, s[88:91], s100 offen lds
SL2:
  v_lshlrev_b32 v13, 1, v13
  v_xor_b32 v13, s58, v13
  v_add_u32 v13, s59, v13
  v_mul_u32_u24 v13, 384, v13
  v_add_u32 v13, v13, v130
  s_lshr_b32 s46, s38, 4
  s_add_u32 s46, s46, 64
  v_add_u32 v130, s46, v0
  v_mul_u32_u24 v14, 2731, v130
  v_lshrrev_b32 v14, 16, v14
  v_cmp_le_u32 s[52:53], 20, v14
  v_mul_u32_u24 v131, 24, v14
  v_sub_u32 v130, v130, v131
  v_subrev_u32 v131, 20, v14
  v_cndmask_b32 v14, v14, v131, s[52:53]
  v_bfe_u32 v131, v14, 1, 3
  v_xor_b32 v130, v130, v131
  v_cndmask_b32 v131, v132, v133, s[52:53]
  v_lshl_add_u32 v130, v130, 4, v131
  v_add_u32 v14, s30, v14
  v_max_i32 v14, 0, v14
  v_lshlrev_b32 v14, 1, v14
  v_xor_b32 v14, s58, v14
  v_add_u32 v14, s59, v14
  v_mul_u32_u24 v14, 384, v14
  v_add_u32 v14, v14, v130
  s_lshr_b32 s46, s38, 4
  s_add_u32 s46, s46, 128
  v_add_u32 v130, s46, v0
  v_mul_u32_u24 v3, 2731, v130
  v_lshrrev_b32 v3, 16, v3
  v_cmp_le_u32 s[52:53], 20, v3
  v_mul_u32_u24 v131, 24, v3
  v_sub_u32 v130, v130, v131
  v_subrev_u32 v131, 20, v3
  v_cndmask_b32 v3, v3, v131, s[52:53]
  v_bfe_u32 v131, v3, 1, 3
  v_xor_b32 v130, v130, v131
  v_cndmask_b32 v131, v132, v133, s[52:53]
  v_lshl_add_u32 v130, v130, 4, v131
  v_add_u32 v3, s30, v3
  v_max_i32 v3, 0, v3
  v_lshlrev_b32 v3, 1, v3
  v_xor_b32 v3, s58, v3
  v_add_u32 v3, s59, v3
  v_mul_u32_u24 v3, 384, v3
  v_add_u32 v3, v3, v130
  s_lshr_b32 s46, s39, 4
  v_add_u32 v130, s46, v0
  v_mul_u32_u24 v4, 2731, v130
  v_lshrrev_b32 v4, 16, v4
  v_cmp_le_u32 s[52:53], 20, v4
  v_mul_u32_u24 v131, 24, v4
  v_sub_u32 v130, v130, v131
  v_subrev_u32 v131, 20, v4
  v_cndmask_b32 v4, v4, v131, s[52:53]
  v_bfe_u32 v131, v4, 1, 3
  v_xor_b32 v130, v130, v131
  v_cndmask_b32 v131, v132, v133, s[52:53]
  v_lshl_add_u32 v130, v130, 4, v131
  v_add_u32 v4, s30, v4
  v_max_i32 v4, 0, v4
  v_lshlrev_b32 v4, 1, v4
  v_xor_b32 v4, s58, v4
  v_add_u32 v4, s59, v4
  v_mul_u32_u24 v4, 384, v4
  v_add_u32 v4, v4, v130
  s_add_u32 s38, s38, 10240
  s_add_u32 s39, s39, 10240
  s_lshl_b32 s46, s25, 2
  s_add_i32 s46, s46, -2
  s_max_i32 s46, s46, 0
  s_add_i32 s46, s46, s37
  s_max_i32 s46, s46, 0
  s_sub_i32 s46, s46, s29
  s_lshl_b32 s34, s25, 2
  s_add_i32 s34, s34, s37
  s_max_i32 s34, s34, 0
  s_sub_i32 s34, s34, s29
  s_sub_u32 s46, s34, s46
  s_lshr_b32 s46, s46, 1
  s_mul_i32 s36, s46, -8
  s_add_i32 s36, s36, 7
  s_add_i32 s34, s34, -1
  s_add_i32 s35, s34, s36
  s_mul_i32 s36, s36, 7680
  s_lshl_b32 s47, s26, 2
  s_mul_i32 s46, s34, 7680
  s_add_i32 s46, s46, 10240
  v_add_u32 v130, s47, v128
  v_bfe_u32 v131, v130, 1, 3
  v_xor_b32 v131, v131, v129
  v_mul_u32_u24 v130, 384, v130
  v_lshl_add_u32 v130, v131, 4, v130
  v_add_u32 v7, s46, v130
  v_xor_b32 v8, 64, v7
  v_lshrrev_b32 v130, 2, v128
  v_lshl_add_u32 v130, v129, 2, v130
  v_add_u32 v130, s47, v130
  v_bfe_u32 v131, v130, 1, 3
  v_and_b32 v132, 2, v128
  v_lshlrev_b32 v132, 1, v132
  v_xor_b32 v131, v131, v132
  v_mul_u32_u24 v130, 384, v130
  v_lshl_add_u32 v130, v131, 4, v130
  v_and_b32 v131, 1, v128
  v_lshl_add_u32 v130, v131, 3, v130
  v_add_u32 v9, s46, v130
  v_xor_b32 v10, 16, v9
  v_xor_b32 v11, 32, v9
  v_xor_b32 v12, 48, v9
  v_lshl_add_u32 v130, v129, 2, s47
  v_sub_u32 v19, v130, v19
  v_cndmask_b32 v19, v19, 64, s[44:45]
  v_add_u32 v20, s36, v7
  v_add_u32 v0, s36, v8
  v_add_u32 v15, s36, v9
  v_add_u32 v16, s36, v10
  v_add_u32 v17, s36, v11
  v_add_u32 v18, s36, v12
  s_mov_b32 s93, 1037384597
  s_cbranch_vccnz SL3
  s_add_i32 m0, s41, 49152
  s_add_i32 s100, s92, 128
  buffer_load_dwordx4 v96, s[88:91], s100 offen lds
  s_add_i32 m0, s41, 57344
  s_add_i32 s100, s92, 73856
  buffer_load_dwordx4 v96, s[88:91], s100 offen lds
  s_add_i32 m0, s41, 65536
  s_add_i32 s100, s92, 147584
  buffer_load_dwordx4 v96, s[88:91], s100 offen lds
  s_add_i32 m0, s41, 73728
  s_add_i32 s100, s92, 512
  buffer_load_dwordx4 v96, s[88:91], s100 offen lds
  s_add_i32 m0, s41, 81920
  s_add_i32 s100, s92, 74240
  buffer_load_dwordx4 v96, s[88:91], s100 offen lds
  s_add_i32 m0, s41, 90112
  s_add_i32 s100, s92, 147968
  buffer_load_dwordx4 v96, s[88:91], s100 offen lds
  s_add_i32 m0, s41, 45056
  s_add_i32 s100, s92, -36736
  buffer_load_dwordx4 v96, s[88:91], s100 offen lds
  s_add_i32 m0, s41, 53248
  s_add_i32 s100, s92, 36992
  buffer_load_dwordx4 v96, s[88:91], s100 offen lds
  s_add_i32 m0, s41, 61440
  s_add_i32 s100, s92, 110720
  buffer_load_dwordx4 v96, s[88:91], s100 offen lds
  s_add_i32 m0, s41, 69632
  s_add_i32 s100, s92, -36352
  buffer_load_dwordx4 v96, s[88:91], s100 offen lds
  s_add_i32 m0, s41, 77824
  s_add_i32 s100, s92, 37376
  buffer_load_dwordx4 v96, s[88:91], s100 offen lds
  s_add_i32 m0, s41, 86016
  s_add_i32 s100, s92, 111104
  buffer_load_dwordx4 v96, s[88:91], s100 offen lds
SL3:
  s_cbranch_vccz SL4
  s_waitcnt vmcnt(0)
  s_branch SM4
SL4:
  s_waitcnt vmcnt(12)
SM4:
  s_barrier
  ds_read_b128 v[208:211], v99 offset:0
  ds_read_b128 v[212:215], v99 offset:2048
  ds_read_b128 v[216:219], v99 offset:4096
  ds_read_b128 v[184:187], v97 offset:0
  ds_read_b128 v[188:191], v97 offset:2048
  ds_read_b128 v[192:195], v97 offset:4096
  ds_read_b128 v[196:199], v97 offset:6144
  ds_read_b128 v[200:203], v97 offset:8192
  ds_read_b128 v[204:207], v97 offset:10240
  s_waitcnt lgkmcnt(5)
  v_mfma_f32_16x16x32_bf16 v[24:27], v[184:187], v[208:211], 0
  s_cbranch_vccz SL5
  s_add_i32 m0, s41, 98304
  s_add_i32 s100, s92, 256
  buffer_load_dwordx4 v96, s[88:91], s100 offen lds
SL5:
  v_mfma_f32_16x16x32_bf16 v[28:31], v[184:187], v[212:215], 0
  s_cbranch_vccz SL6
  s_add_i32 m0, s41, 106496
  s_add_i32 s100, s92, 73984
  buffer_load_dwordx4 v96, s[88:91], s100 offen lds
SL6:
  v_mfma_f32_16x16x32_bf16 v[32:35], v[184:187], v[216:219], 0
  s_waitcnt lgkmcnt(4)
  v_mfma_f32_16x16x32_bf16 v[36:39], v[188:191], v[208:211], 0
  ds_read_b128 v[244:247], v100 offset:0
  s_cbranch_vccz SL7
  s_add_i32 m0, s41, 114688
  s_add_i32 s100, s92, 147712
  buffer_load_dwordx4 v96, s[88:91], s100 offen lds
SL7:
  v_mfma_f32_16x16x32_bf16 v[40:43], v[188:191], v[212:215], 0
  ds_read_b128 v[248:251], v100 offset:2048
  s_cbranch_vccz SL8
  s_add_i32 m0, s41, 122880
  s_add_i32 s100, s92, 640
  buffer_load_dwordx4 v96, s[88:91], s100 offen lds
SL8:
  v_mfma_f32_16x16x32_bf16 v[44:47], v[188:191], v[216:219], 0
  s_waitcnt lgkmcnt(5)
  v_mfma_f32_16x16x32_bf16 v[48:51], v[192:195], v[208:211], 0
  ds_read_b128 v[252:255], v100 offset:4096
  s_cbranch_vccz SL9
  s_add_i32 m0, s41, 131072
  s_add_i32 s100, s92, 74368
  buffer_load_dwordx4 v96, s[88:91], s100 offen lds
SL9:
  v_mfma_f32_16x16x32_bf16 v[52:55], v[192:195], v[212:215], 0
  ds_read_b128 v[220:223], v98 offset:0
  s_cbranch_vccz SL10
  s_add_i32 m0, s41, 139264
  s_add_i32 s100, s92, 148096
  buffer_load_dwordx4 v96, s[88:91], s100 offen lds
SL10:
  v_mfma_f32_16x16x32_bf16 v[56:59], v[192:195], v[216:219], 0
  s_waitcnt lgkmcnt(6)
  v_mfma_f32_16x16x32_bf16 v[60:63], v[196:199], v[208:211], 0
  ds_read_b128 v[224:227], v98 offset:2048
  s_cbranch_vccz SL11
  s_add_i32 m0, s41, 102400
  s_add_i32 s100, s92, 37120
  buffer_load_dwordx4 v96, s[88:91], s100 offen lds
SL11:
  v_mfma_f32_16x16x32_bf16 v[64:67], v[196:199], v[212:215], 0
  ds_read_b128 v[228:231], v98 offset:4096
  s_cbranch_vccz SL12
  s_add_i32 m0, s41, 110592
  s_add_i32 s100, s92, 110848
  buffer_load_dwordx4 v96, s[88:91], s100 offen lds
SL12:
  v_mfma_f32_16x16x32_bf16 v[68:71], v[196:199], v[216:219], 0
  s_waitcnt lgkmcnt(7)
  v_mfma_f32_16x16x32_bf16 v[72:75], v[200:203], v[208:211], 0
  ds_read_b128 v[232:235], v98 offset:6144
  s_cbranch_vccz SL13
  s_add_i32 m0, s41, 118784
  s_add_i32 s100, s92, 184576
  buffer_load_dwordx4 v96, s[88:91], s100 offen lds
SL13:
  v_mfma_f32_16x16x32_bf16 v[76:79], v[200:203], v[212:215], 0
  ds_read_b128 v[236:239], v98 offset:8192
  s_cbranch_vccz SL14
  s_add_i32 m0, s41, 126976
  s_add_i32 s100, s92, 37504
  buffer_load_dwordx4 v96, s[88:91], s100 offen lds
SL14:
  v_mfma_f32_16x16x32_bf16 v[80:83], v[200:203], v[216:219], 0
  s_waitcnt lgkmcnt(8)
  v_mfma_f32_16x16x32_bf16 v[84:87], v[204:207], v[208:211], 0
  ds_read_b128 v[240:243], v98 offset:10240
  s_cbranch_vccz SL15
  s_add_i32 m0, s41, 135168
  s_add_i32 s100, s92, 111232
  buffer_load_dwordx4 v96, s[88:91], s100 offen lds
SL15:
  v_mfma_f32_16x16x32_bf16 v[88:91], v[204:207], v[212:215], 0
  s_cbranch_vccz SL16
  s_add_i32 m0, s41, 143360
  s_add_i32 s100, s92, 184960
  buffer_load_dwordx4 v96, s[88:91], s100 offen lds
SL16:
  v_mfma_f32_16x16x32_bf16 v[92:95], v[204:207], v[216:219], 0
  v_lshrrev_b32 v107, 4, v1
  s_cmp_lt_u32 s2, 72
  s_cbranch_scc0 MK_np1
  s_mul_hi_u32 s54, s2, 0x15555556
  s_lshl_b32 s54, s54, 6
  s_mul_i32 s55, s24, 6144
  s_add_u32 s100, s54, s55
  v_lshrrev_b32 v104, 2, v107
  v_mul_u32_u24 v104, 384, v104
  v_and_b32 v105, 3, v107
  v_lshl_add_u32 v104, v105, 4, v104
  s_add_u32 m0, s41, 147456
  s_nop 0
  buffer_load_dwordx4 v104, s[4:7], s100 offen lds
  s_mul_i32 s55, s40, 6
  s_add_u32 s100, s54, s55
  s_add_u32 m0, s40, 155648
  s_add_u32 s100, s100, 49152
  buffer_load_dwordx4 v104, s[4:7], s100 offen lds
MK_np1:
  s_sub_u32 s3, s2, 72
  s_lshr_b32 s3, s3, 31
  s_lshr_b32 s3, s3, s25
  s_cmp_eq_u32 s3, 0
  s_cbranch_scc1 MK_np3
  s_mul_hi_u32 s54, s2, 0x15555556
  s_mul_i32 s55, s54, 12
  s_sub_u32 s55, s2, s55
  s_cmp_ge_u32 s55, 6
  s_cselect_b32 s51, 1, 0
  s_mul_i32 s100, s51, 6
  s_sub_u32 s55, s55, s100
  v_lshrrev_b32 v106, 2, v128
  v_and_b32 v105, 3, v128
  v_lshl_add_u32 v134, v129, 3, v106
  v_lshlrev_b32 v134, 6, v134
  v_lshl_add_u32 v134, v105, 4, v134
  s_lshl_b32 s51, s51, 3
  s_add_u32 s51, s51, 147456
  v_add_u32 v134, s51, v134
  s_lshr_b32 s54, s55, 1
  s_lshl_b32 s54, s54, 6
  s_and_b32 s55, s55, 1
  s_lshl_b32 s55, s55, 4
  s_add_u32 s54, s54, s55
  v_lshrrev_b32 v104, 1, v106
  v_lshlrev_b32 v104, 5, v104
  v_and_b32 v106, 1, v106
  v_lshl_add_u32 v104, v106, 2, v104
  v_add3_u32 v104, v104, v105, s54
  v_mul_u32_u24 v104, 1152, v104
  v_lshl_add_u32 v135, v129, 4, v104
  s_mul_i32 s100, s26, 9216
  buffer_load_dwordx4 v[136:139], v135, s[88:91], s100 offen offset:768
  buffer_load_dwordx4 v[140:143], v135, s[88:91], s100 offen offset:832
  buffer_load_dwordx4 v[144:147], v135, s[88:91], s100 offen offset:896
  buffer_load_dwordx4 v[148:151], v135, s[88:91], s100 offen offset:960
  buffer_load_dwordx4 v[152:155], v135, s[88:91], s100 offen offset:1024
  buffer_load_dwordx4 v[156:159], v135, s[88:91], s100 offen offset:1088
MK_np3:
  s_cbranch_vccz SL18
  s_waitcnt vmcnt(63) lgkmcnt(0)
  s_branch SM18
SL18:
  s_cmp_lg_u32 s3, 0
  s_cbranch_scc1 CA17
  s_cmp_lt_u32 s2, 72
  s_cbranch_scc1 CB17
  s_waitcnt vmcnt(0)
CB17:
  s_waitcnt vmcnt(2)
CA17:
  s_waitcnt vmcnt(8) lgkmcnt(0)
SM18:
  s_barrier
  v_add_u32 v97, 49152, v97
  v_add_u32 v98, 49152, v98
  v_add_u32 v99, 49152, v99
  v_add_u32 v100, 49152, v100
  v_mfma_f32_16x16x32_bf16 v[24:27], v[220:223], v[244:247], v[24:27]
  ds_read_b128 v[208:211], v99 offset:0
  s_cbranch_vccnz SL19
  buffer_load_dwordx4 v[160:163], v6, s[12:15], 0 offen offset:0
SL19:
  v_mfma_f32_16x16x32_bf16 v[28:31], v[220:223], v[248:251], v[28:31]
  ds_read_b128 v[212:215], v99 offset:2048
  v_mfma_f32_16x16x32_bf16 v[32:35], v[220:223], v[252:255], v[32:35]
  v_mfma_f32_16x16x32_bf16 v[36:39], v[224:227], v[244:247], v[36:39]
  ds_read_b128 v[216:219], v99 offset:4096
  s_cbranch_vccnz SL20
  buffer_load_dwordx4 v[164:167], v6, s[12:15], 0 offen offset:64
SL20:
  v_mfma_f32_16x16x32_bf16 v[40:43], v[224:227], v[248:251], v[40:43]
  ds_read_b128 v[184:187], v97 offset:0
  v_mfma_f32_16x16x32_bf16 v[44:47], v[224:227], v[252:255], v[44:47]
  v_mfma_f32_16x16x32_bf16 v[48:51], v[228:231], v[244:247], v[48:51]
  ds_read_b128 v[188:191], v97 offset:2048
  s_cbranch_vccnz SL21
  buffer_load_dwordx4 v[168:171], v6, s[12:15], 0 offen offset:128
SL21:
  v_mfma_f32_16x16x32_bf16 v[52:55], v[228:231], v[248:251], v[52:55]
  ds_read_b128 v[192:195], v97 offset:4096
  v_mfma_f32_16x16x32_bf16 v[56:59], v[228:231], v[252:255], v[56:59]
  v_mfma_f32_16x16x32_bf16 v[60:63], v[232:235], v[244:247], v[60:63]
  ds_read_b128 v[196:199], v97 offset:6144
  s_cbranch_vccnz SL22
  buffer_load_dwordx4 v[172:175], v6, s[12:15], 0 offen offset:192
SL22:
  v_mfma_f32_16x16x32_bf16 v[64:67], v[232:235], v[248:251], v[64:67]
  ds_read_b128 v[200:203], v97 offset:8192
  v_mfma_f32_16x16x32_bf16 v[68:71], v[232:235], v[252:255], v[68:71]
  v_mfma_f32_16x16x32_bf16 v[72:75], v[236:239], v[244:247], v[72:75]
  ds_read_b128 v[204:207], v97 offset:10240
  s_cbranch_vccnz SL23
  buffer_load_dwordx4 v[176:179], v6, s[12:15], 0 offen offset:256
SL23:
  v_mfma_f32_16x16x32_bf16 v[76:79], v[236:239], v[248:251], v[76:79]
  v_mfma_f32_16x16x32_bf16 v[80:83], v[236:239], v[252:255], v[80:83]
  v_mfma_f32_16x16x32_bf16 v[84:87], v[240:243], v[244:247], v[84:87]
  s_cbranch_vccnz SL24
  buffer_load_dwordx4 v[180:183], v6, s[12:15], 0 offen offset:320
SL24:
  v_mfma_f32_16x16x32_bf16 v[88:91], v[240:243], v[248:251], v[88:91]
  v_mfma_f32_16x16x32_bf16 v[92:95], v[240:243], v[252:255], v[92:95]
  s_waitcnt lgkmcnt(5)
  v_mfma_f32_16x16x32_bf16 v[24:27], v[184:187], v[208:211], v[24:27]
  s_cbranch_vccnz SL25
  s_cmp_eq_u32 s25, 0
  s_cbranch_scc1 QB6
  buffer_load_dwordx4 v[136:139], v5, s[12:15], 0 offen offset:0
QB6:
SL25:
  v_mfma_f32_16x16x32_bf16 v[28:31], v[184:187], v[212:215], v[28:31]
  v_mfma_f32_16x16x32_bf16 v[32:35], v[184:187], v[216:219], v[32:35]
  s_waitcnt lgkmcnt(4)
  v_mfma_f32_16x16x32_bf16 v[36:39], v[188:191], v[208:211], v[36:39]
  ds_read_b128 v[244:247], v100 offset:0
  s_cbranch_vccnz SL26
  s_cmp_eq_u32 s25, 0
  s_cbranch_scc1 QB7
  buffer_load_dwordx4 v[140:143], v5, s[12:15], 0 offen offset:64
QB7:
SL26:
  v_mfma_f32_16x16x32_bf16 v[40:43], v[188:191], v[212:215], v[40:43]
  ds_read_b128 v[248:251], v100 offset:2048
  v_mfma_f32_16x16x32_bf16 v[44:47], v[188:191], v[216:219], v[44:47]
  s_waitcnt lgkmcnt(5)
  v_mfma_f32_16x16x32_bf16 v[48:51], v[192:195], v[208:211], v[48:51]
  ds_read_b128 v[252:255], v100 offset:4096
  s_cbranch_vccnz SL27
  s_cmp_eq_u32 s25, 0
  s_cbranch_scc1 QB8
  buffer_load_dwordx4 v[144:147], v5, s[12:15], 0 offen offset:128
QB8:
SL27:
  v_mfma_f32_16x16x32_bf16 v[52:55], v[192:195], v[212:215], v[52:55]
  ds_read_b128 v[220:223], v98 offset:0
  v_mfma_f32_16x16x32_bf16 v[56:59], v[192:195], v[216:219], v[56:59]
  s_waitcnt lgkmcnt(6)
  v_mfma_f32_16x16x32_bf16 v[60:63], v[196:199], v[208:211], v[60:63]
  ds_read_b128 v[224:227], v98 offset:2048
  s_cbranch_vccnz SL28
  s_cmp_eq_u32 s25, 0
  s_cbranch_scc1 QB9
  buffer_load_dwordx4 v[148:151], v5, s[12:15], 0 offen offset:192
QB9:
SL28:
  v_mfma_f32_16x16x32_bf16 v[64:67], v[196:199], v[212:215], v[64:67]
  ds_read_b128 v[228:231], v98 offset:4096
  v_mfma_f32_16x16x32_bf16 v[68:71], v[196:199], v[216:219], v[68:71]
  s_waitcnt lgkmcnt(7)
  v_mfma_f32_16x16x32_bf16 v[72:75], v[200:203], v[208:211], v[72:75]
  ds_read_b128 v[232:235], v98 offset:6144
  s_cbranch_vccnz SL29
  s_cmp_eq_u32 s25, 0
  s_cbranch_scc1 QB10
  buffer_load_dwordx4 v[152:155], v5, s[12:15], 0 offen offset:256
QB10:
SL29:
  v_mfma_f32_16x16x32_bf16 v[76:79], v[200:203], v[212:215], v[76:79]
  ds_read_b128 v[236:239], v98 offset:8192
  v_mfma_f32_16x16x32_bf16 v[80:83], v[200:203], v[216:219], v[80:83]
  s_waitcnt lgkmcnt(8)
  v_mfma_f32_16x16x32_bf16 v[84:87], v[204:207], v[208:211], v[84:87]
  ds_read_b128 v[240:243], v98 offset:10240
  s_cbranch_vccnz SL30
  s_cmp_eq_u32 s25, 0
  s_cbranch_scc1 QB11
  buffer_load_dwordx4 v[156:159], v5, s[12:15], 0 offen offset:320
QB11:
SL30:
  v_mfma_f32_16x16x32_bf16 v[88:91], v[204:207], v[212:215], v[88:91]
  v_mfma_f32_16x16x32_bf16 v[92:95], v[204:207], v[216:219], v[92:95]
  s_cbranch_vccz SL31
  v_lshrrev_b32 v133, 4, v1
  v_lshrrev_b32 v130, 3, v133
  s_mul_i32 s50, s26, 7
  s_add_i32 s50, s50, s30
  v_cmp_lt_u32 s[52:53], 6, v130
  v_add_u32 v130, s50, v130
  v_max_i32 v131, 0, v130
  v_add3_u32 v130, v130, v131, 6
  v_xor_b32 v130, s58, v130
  v_add_u32 v130, s59, v130
  v_mul_u32_u24 v130, 384, v130
  v_and_b32 v131, 7, v133
  v_xor_b32 v131, v131, v129
  v_lshl_add_u32 v130, v131, 4, v130
  v_mov_b32 v131, 0x80000000
  v_cndmask_b32 v134, v130, v131, s[52:53]
  v_xor_b32 v135, 64, v134
  s_lshl_b32 s46, s25, 2
  s_add_i32 s46, s46, s37
  s_lshl_b32 s84, s46, 1
  s_add_i32 s84, s84, 2
  s_xor_b32 s84, s84, s56
  s_add_i32 s84, s84, s57
  s_mul_i32 s84, s84, 86016
  s_lshl_b32 s85, s46, 1
  s_add_i32 s85, s85, 4
  s_xor_b32 s85, s85, s56
  s_add_i32 s85, s85, s57
  s_mul_i32 s85, s85, 86016
  s_lshl_b32 s86, s46, 1
  s_add_i32 s86, s86, 6
  s_xor_b32 s86, s86, s56
  s_add_i32 s86, s86, s57
  s_mul_i32 s86, s86, 86016
  s_lshl_b32 s87, s46, 1
  s_add_i32 s87, s87, 8
  s_xor_b32 s87, s87, s56
  s_add_i32 s87, s87, s57
  s_mul_i32 s87, s87, 86016
  s_mul_i32 s101, s40, 6
  s_add_u32 s101, s101, 73728
  v_bfe_u32 v130, v128, 1, 3
  v_xor_b32 v130, v130, v129
  v_lshlrev_b32 v131, 7, v128
  v_lshl_add_u32 v131, v130, 4, v131
  v_lshrrev_b32 v130, 3, v128
  v_lshl_add_u32 v130, v130, 11, v131
  v_add_u32 v23, s101, v130
SL31:
  s_cbranch_vccz SL32
  s_waitcnt vmcnt(0) lgkmcnt(0)
  s_branch SM32
SL32:
  s_cmp_lg_u32 s25, 0
  s_cbranch_scc1 MK_c2
  s_waitcnt vmcnt(6)
MK_c2:
  s_waitcnt vmcnt(12) lgkmcnt(0)
SM32:
  s_barrier
  v_add_u32 v97, 49152, v97
  v_add_u32 v98, 49152, v98
  v_add_u32 v99, 49152, v99
  v_add_u32 v100, 49152, v100
  v_mfma_f32_16x16x32_bf16 v[24:27], v[220:223], v[244:247], v[24:27]
  ds_read_b128 v[208:211], v99 offset:0
  v_mfma_f32_16x16x32_bf16 v[28:31], v[220:223], v[248:251], v[28:31]
  ds_read_b128 v[212:215], v99 offset:2048
  v_mfma_f32_16x16x32_bf16 v[32:35], v[220:223], v[252:255], v[32:35]
  v_mfma_f32_16x16x32_bf16 v[36:39], v[224:227], v[244:247], v[36:39]
  ds_read_b128 v[216:219], v99 offset:4096
  v_mfma_f32_16x16x32_bf16 v[40:43], v[224:227], v[248:251], v[40:43]
  ds_read_b128 v[184:187], v97 offset:0
  v_mfma_f32_16x16x32_bf16 v[44:47], v[224:227], v[252:255], v[44:47]
  v_mfma_f32_16x16x32_bf16 v[48:51], v[228:231], v[244:247], v[48:51]
  ds_read_b128 v[188:191], v97 offset:2048
  v_mfma_f32_16x16x32_bf16 v[52:55], v[228:231], v[248:251], v[52:55]
  ds_read_b128 v[192:195], v97 offset:4096
  v_mfma_f32_16x16x32_bf16 v[56:59], v[228:231], v[252:255], v[56:59]
  v_mfma_f32_16x16x32_bf16 v[60:63], v[232:235], v[244:247], v[60:63]
  ds_read_b128 v[196:199], v97 offset:6144
  v_mfma_f32_16x16x32_bf16 v[64:67], v[232:235], v[248:251], v[64:67]
  ds_read_b128 v[200:203], v97 offset:8192
  v_mfma_f32_16x16x32_bf16 v[68:71], v[232:235], v[252:255], v[68:71]
  v_mfma_f32_16x16x32_bf16 v[72:75], v[236:239], v[244:247], v[72:75]
  ds_read_b128 v[204:207], v97 offset:10240
  v_mfma_f32_16x16x32_bf16 v[76:79], v[236:239], v[248:251], v[76:79]
  v_mfma_f32_16x16x32_bf16 v[80:83], v[236:239], v[252:255], v[80:83]
  v_mfma_f32_16x16x32_bf16 v[84:87], v[240:243], v[244:247], v[84:87]
  v_mfma_f32_16x16x32_bf16 v[88:91], v[240:243], v[248:251], v[88:91]
  v_mfma_f32_16x16x32_bf16 v[92:95], v[240:243], v[252:255], v[92:95]
  s_cmp_eq_u32 s3, 0
  s_cbranch_scc1 MK_np2
  s_waitcnt lgkmcnt(0)
  ds_read_b64_tr_b16 v[104:105], v134 offset:0
  ds_read_b64_tr_b16 v[106:107], v134 offset:256
  ds_read_b64_tr_b16 v[108:109], v134 offset:2048
  ds_read_b64_tr_b16 v[110:111], v134 offset:2304
  ds_read_b64_tr_b16 v[112:113], v134 offset:4096
  ds_read_b64_tr_b16 v[114:115], v134 offset:4352
  ds_read_b64_tr_b16 v[116:117], v134 offset:6144
  ds_read_b64_tr_b16 v[118:119], v134 offset:6400
  ds_read_b64_tr_b16 v[120:121], v134 offset:8192
  ds_read_b64_tr_b16 v[122:123], v134 offset:8448
  ds_read_b64_tr_b16 v[124:125], v134 offset:10240
  ds_read_b64_tr_b16 v[126:127], v134 offset:10496
  s_setprio 3
  s_waitcnt lgkmcnt(0)
  v_mfma_f32_16x16x32_bf16 v[128:131], v[136:139], v[104:107], 0
  v_mfma_f32_16x16x32_bf16 v[128:131], v[140:143], v[108:111], v[128:131]
  v_mfma_f32_16x16x32_bf16 v[128:131], v[144:147], v[112:115], v[128:131]
  v_mfma_f32_16x16x32_bf16 v[128:131], v[148:151], v[116:119], v[128:131]
  v_mfma_f32_16x16x32_bf16 v[128:131], v[152:155], v[120:123], v[128:131]
  v_mfma_f32_16x16x32_bf16 v[128:131], v[156:159], v[124:127], v[128:131]
  s_lshl_b32 s100, s2, 10
  s_lshl_b32 s54, s26, 3
  s_add_u32 s100, s100, s54
  s_nop 5
  v_cvt_pk_bf16_f32 v132, v128, v129
  v_cvt_pk_bf16_f32 v133, v130, v131
  buffer_store_dwordx2 v[132:133], v1, s[20:23], s100 offen sc1
  s_setprio 0
MK_np2:
  s_cmp_lg_u32 s25, 0
  s_cbranch_scc1 MK_z1
  v_mov_b32 v136, 0
  v_mov_b32 v137, 0
  v_mov_b32 v138, 0
  v_mov_b32 v139, 0
  v_mov_b32 v140, 0
  v_mov_b32 v141, 0
  v_mov_b32 v142, 0
  v_mov_b32 v143, 0
  v_mov_b32 v144, 0
  v_mov_b32 v145, 0
  v_mov_b32 v146, 0
  v_mov_b32 v147, 0
  v_mov_b32 v148, 0
  v_mov_b32 v149, 0
  v_mov_b32 v150, 0
  v_mov_b32 v151, 0
  v_mov_b32 v152, 0
  v_mov_b32 v153, 0
  v_mov_b32 v154, 0
  v_mov_b32 v155, 0
  v_mov_b32 v156, 0
  v_mov_b32 v157, 0
  v_mov_b32 v158, 0
  v_mov_b32 v159, 0
MK_z1:
  ds_read_b128 v[244:247], v100 offset:0
  ds_read_b128 v[248:251], v100 offset:2048
  ds_read_b128 v[252:255], v100 offset:4096
  ds_read_b128 v[220:223], v98 offset:0
  ds_read_b128 v[224:227], v98 offset:2048
  s_waitcnt lgkmcnt(5)
  v_mfma_f32_16x16x32_bf16 v[24:27], v[184:187], v[208:211], v[24:27]
  ds_read_b128 v[228:231], v98 offset:4096
  s_cbranch_vccz SL33
  s_add_u32 m0, s101, 0
  s_nop 0
  buffer_load_dwordx4 v134, s[12:15], s86 offen offset:0 lds
SL33:
  v_mfma_f32_16x16x32_bf16 v[36:39], v[188:191], v[208:211], v[36:39]
  ds_read_b128 v[232:235], v98 offset:6144
  s_waitcnt lgkmcnt(2)
  v_mfma_f32_16x16x32_bf16 v[24:27], v[220:223], v[244:247], v[24:27]
  ds_read_b128 v[236:239], v98 offset:8192
  v_mfma_f32_16x16x32_bf16 v[36:39], v[224:227], v[244:247], v[36:39]
  ds_read_b128 v[240:243], v98 offset:10240
  v_mfma_f32_16x16x32_bf16 v[28:31], v[184:187], v[212:215], v[28:31]
  v_mfma_f32_16x16x32_bf16 v[40:43], v[188:191], v[212:215], v[40:43]
  v_mfma_f32_16x16x32_bf16 v[28:31], v[220:223], v[248:251], v[28:31]
  s_cbranch_vccz SL34
  s_add_u32 m0, s101, 896
  s_nop 0
  buffer_load_dwordx4 v134, s[12:15], s86 offen offset:128 lds
SL34:
  v_mfma_f32_16x16x32_bf16 v[40:43], v[224:227], v[248:251], v[40:43]
  s_waitcnt lgkmcnt(0)
  v_mfma_f32_16x16x32_bf16 v[32:35], v[184:187], v[216:219], v[32:35]
  v_cvt_pk_bf16_f32 v104, v24, v25
  v_cvt_pk_bf16_f32 v105, v26, v27
  v_mfma_f32_16x16x32_bf16 v[44:47], v[188:191], v[216:219], v[44:47]
  v_cvt_pk_bf16_f32 v106, v36, v37
  v_cvt_pk_bf16_f32 v107, v38, v39
  v_mfma_f32_16x16x32_bf16 v[32:35], v[220:223], v[252:255], v[32:35]
  ds_write_b128 v101, v[104:107] offset:14336
  v_mfma_f32_16x16x32_bf16 v[44:47], v[224:227], v[252:255], v[44:47]
  v_mfma_f32_16x16x32_bf16 v[48:51], v[192:195], v[208:211], v[48:51]
  v_cvt_pk_bf16_f32 v108, v28, v29
  v_cvt_pk_bf16_f32 v109, v30, v31
  s_cbranch_vccz SL35
  s_add_u32 m0, s101, 1792
  s_nop 0
  buffer_load_dwordx4 v134, s[12:15], s86 offen offset:256 lds
SL35:
  v_mfma_f32_16x16x32_bf16 v[60:63], v[196:199], v[208:211], v[60:63]
  v_cvt_pk_bf16_f32 v110, v40, v41
  v_cvt_pk_bf16_f32 v111, v42, v43
  v_mfma_f32_16x16x32_bf16 v[48:51], v[228:231], v[244:247], v[48:51]
  ds_write_b128 v101, v[108:111] offset:8192
  v_mfma_f32_16x16x32_bf16 v[60:63], v[232:235], v[244:247], v[60:63]
  v_mfma_f32_16x16x32_bf16 v[52:55], v[192:195], v[212:215], v[52:55]
  v_cvt_pk_bf16_f32 v112, v32, v33
  v_cvt_pk_bf16_f32 v113, v34, v35
  v_mfma_f32_16x16x32_bf16 v[64:67], v[196:199], v[212:215], v[64:67]
  v_cvt_pk_bf16_f32 v114, v44, v45
  v_cvt_pk_bf16_f32 v115, v46, v47
  v_mfma_f32_16x16x32_bf16 v[52:55], v[228:231], v[248:251], v[52:55]
  ds_write_b128 v101, v[112:115] offset:2048
  s_cbranch_vccz SL36
  s_add_u32 m0, s101, 3072
  s_nop 0
  buffer_load_dwordx4 v135, s[12:15], s87 offen offset:0 lds
SL36:
  v_mfma_f32_16x16x32_bf16 v[64:67], v[232:235], v[248:251], v[64:67]
  v_mfma_f32_16x16x32_bf16 v[56:59], v[192:195], v[216:219], v[56:59]
  v_cvt_pk_bf16_f32 v116, v48, v49
  v_cvt_pk_bf16_f32 v117, v50, v51
  v_mfma_f32_16x16x32_bf16 v[68:71], v[196:199], v[216:219], v[68:71]
  v_cvt_pk_bf16_f32 v118, v60, v61
  v_cvt_pk_bf16_f32 v119, v62, v63
  v_mfma_f32_16x16x32_bf16 v[56:59], v[228:231], v[252:255], v[56:59]
  ds_write_b128 v101, v[116:119] offset:13312
  v_mfma_f32_16x16x32_bf16 v[68:71], v[232:235], v[252:255], v[68:71]
  v_mfma_f32_16x16x32_bf16 v[72:75], v[200:203], v[208:211], v[72:75]
  v_cvt_pk_bf16_f32 v120, v52, v53
  v_cvt_pk_bf16_f32 v121, v54, v55
  s_cbranch_vccz SL37
  s_add_u32 m0, s101, 3968
  s_nop 0
  buffer_load_dwordx4 v135, s[12:15], s87 offen offset:128 lds
SL37:
  v_mfma_f32_16x16x32_bf16 v[84:87], v[204:207], v[208:211], v[84:87]
  v_cvt_pk_bf16_f32 v122, v64, v65
  v_cvt_pk_bf16_f32 v123, v66, v67
  v_mfma_f32_16x16x32_bf16 v[72:75], v[236:239], v[244:247], v[72:75]
  ds_write_b128 v101, v[120:123] offset:7168
  v_mfma_f32_16x16x32_bf16 v[84:87], v[240:243], v[244:247], v[84:87]
  v_mfma_f32_16x16x32_bf16 v[76:79], v[200:203], v[212:215], v[76:79]
  v_cvt_pk_bf16_f32 v124, v56, v57
  v_cvt_pk_bf16_f32 v125, v58, v59
  v_mfma_f32_16x16x32_bf16 v[88:91], v[204:207], v[212:215], v[88:91]
  v_cvt_pk_bf16_f32 v126, v68, v69
  v_cvt_pk_bf16_f32 v127, v70, v71
  v_mfma_f32_16x16x32_bf16 v[76:79], v[236:239], v[248:251], v[76:79]
  ds_write_b128 v101, v[124:127] offset:1024
  s_cbranch_vccz SL38
  s_add_u32 m0, s101, 4864
  s_nop 0
  buffer_load_dwordx4 v135, s[12:15], s87 offen offset:256 lds
SL38:
  v_mfma_f32_16x16x32_bf16 v[88:91], v[240:243], v[248:251], v[88:91]
  v_mfma_f32_16x16x32_bf16 v[80:83], v[200:203], v[216:219], v[80:83]
  v_cvt_pk_bf16_f32 v104, v72, v73
  v_cvt_pk_bf16_f32 v105, v74, v75
  v_mfma_f32_16x16x32_bf16 v[92:95], v[204:207], v[216:219], v[92:95]
  v_cvt_pk_bf16_f32 v106, v84, v85
  v_cvt_pk_bf16_f32 v107, v86, v87
  v_mfma_f32_16x16x32_bf16 v[80:83], v[236:239], v[252:255], v[80:83]
  ds_write_b128 v101, v[104:107] offset:12288
  v_mfma_f32_16x16x32_bf16 v[92:95], v[240:243], v[252:255], v[92:95]
  v_cvt_pk_bf16_f32 v108, v76, v77
  v_cvt_pk_bf16_f32 v109, v78, v79
  v_cvt_pk_bf16_f32 v110, v88, v89
  v_cvt_pk_bf16_f32 v111, v90, v91
  ds_write_b128 v101, v[108:111] offset:6144
  s_nop 3
  v_cvt_pk_bf16_f32 v112, v80, v81
  v_cvt_pk_bf16_f32 v113, v82, v83
  v_cvt_pk_bf16_f32 v114, v92, v93
  v_cvt_pk_bf16_f32 v115, v94, v95
  ds_write_b128 v101, v[112:115] offset:0
  s_waitcnt lgkmcnt(0)
  s_barrier
  ds_read_b128 v[216:219], v2 offset:35840
  ds_read_b128 v[220:223], v2 offset:34816
  ds_read_b128 v[224:227], v2 offset:33792
  ds_read_b128 v[228:231], v2 offset:32768
  ds_read_b128 v[232:235], v2 offset:31744
  ds_read_b128 v[236:239], v2 offset:30720
  ds_read_b128 v[240:243], v2 offset:29696
  ds_read_b128 v[244:247], v2 offset:28672
  ds_read_b128 v[248:251], v2 offset:27648
  ds_read_b128 v[252:255], v2 offset:26624
  s_cbranch_vccz SL39
  s_add_u32 m0, s101, 24576
  s_nop 0
  buffer_load_dwordx4 v134, s[12:15], s84 offen offset:0 lds
  s_add_u32 m0, s101, 25472
  s_nop 0
  buffer_load_dwordx4 v134, s[12:15], s84 offen offset:128 lds
  s_add_u32 m0, s101, 26368
  s_nop 0
  buffer_load_dwordx4 v134, s[12:15], s84 offen offset:256 lds
  s_add_u32 m0, s101, 27648
  s_nop 0
  buffer_load_dwordx4 v135, s[12:15], s85 offen offset:0 lds
  s_add_u32 m0, s101, 28544
  s_nop 0
  buffer_load_dwordx4 v135, s[12:15], s85 offen offset:128 lds
  s_add_u32 m0, s101, 29440
  s_nop 0
  buffer_load_dwordx4 v135, s[12:15], s85 offen offset:256 lds
  s_mul_i32 s100, s32, 9
  s_add_i32 s100, s100, s31
  s_add_u32 m0, s38, 138240
  s_nop 0
  buffer_load_dwordx4 v13, s[12:15], s100 offen lds
  s_add_u32 m0, s38, 139264
  s_nop 0
  buffer_load_dwordx4 v14, s[12:15], s100 offen lds
  s_add_u32 m0, s38, 140288
  s_nop 0
  buffer_load_dwordx4 v3, s[12:15], s100 offen lds
  s_add_u32 m0, s39, 138240
  s_nop 0
  buffer_load_dwordx4 v4, s[12:15], s100 offen lds
  s_mul_i32 s100, s32, 8
  s_add_i32 s100, s100, s31
  s_add_u32 m0, s38, 122880
  s_nop 0
  buffer_load_dwordx4 v13, s[12:15], s100 offen lds
  s_add_u32 m0, s38, 123904
  s_nop 0
  buffer_load_dwordx4 v14, s[12:15], s100 offen lds
  s_add_u32 m0, s38, 124928
  s_nop 0
  buffer_load_dwordx4 v3, s[12:15], s100 offen lds
  s_add_u32 m0, s39, 122880
  s_nop 0
  buffer_load_dwordx4 v4, s[12:15], s100 offen lds
  s_waitcnt vmcnt(8) lgkmcnt(0)
  v_xor_b32 v130, 64, v23
  ds_read_b128 v[136:139], v23 offset:24576
  ds_read_b128 v[140:143], v130 offset:24576
  ds_read_b128 v[144:147], v23 offset:25600
  ds_read_b128 v[148:151], v130 offset:25600
  ds_read_b128 v[152:155], v23 offset:26624
  ds_read_b128 v[156:159], v130 offset:26624
  ds_read_b128 v[160:163], v23 offset:0
  ds_read_b128 v[164:167], v130 offset:0
  ds_read_b128 v[168:171], v23 offset:1024
  ds_read_b128 v[172:175], v130 offset:1024
  ds_read_b128 v[176:179], v23 offset:2048
  ds_read_b128 v[180:183], v130 offset:2048
  s_waitcnt lgkmcnt(0)
  s_barrier
  s_branch SM39
SL39:
  s_cmp_lg_u32 s3, 0
  s_cbranch_scc1 MK_np4
  s_waitcnt vmcnt(0)
MK_np4:
  s_waitcnt vmcnt(1)
  s_setprio 1
SM39:
  s_waitcnt lgkmcnt(8)
  v_mfma_f32_16x16x32_bf16 v[184:187], v[216:219], v[136:139], 0
  v_mov_b32 v64, 0xff800000
  v_add_u32 v65, 0, v19
  v_mfma_f32_16x16x32_bf16 v[184:187], v[220:223], v[140:143], v[184:187]
  v_add_u32 v66, 1, v19
  s_waitcnt lgkmcnt(6)
  v_mfma_f32_16x16x32_bf16 v[184:187], v[224:227], v[144:147], v[184:187]
  v_add_u32 v67, 2, v19
  v_add_u32 v68, 3, v19
  v_mfma_f32_16x16x32_bf16 v[192:195], v[216:219], v[160:163], 0
  ds_read_b128 v[216:219], v2 offset:25600
  v_cmp_gt_u32 s[48:49], 7, v65
  v_mfma_f32_16x16x32_bf16 v[192:195], v[220:223], v[164:167], v[192:195]
  ds_read_b128 v[220:223], v2 offset:24576
  v_cmp_gt_u32 s[50:51], 7, v66
  v_mfma_f32_16x16x32_bf16 v[192:195], v[224:227], v[168:171], v[192:195]
  ds_read_b128 v[224:227], v2 offset:23552
  v_cmp_gt_u32 s[52:53], 7, v67
  v_mfma_f32_16x16x32_bf16 v[192:195], v[228:231], v[172:175], v[192:195]
  v_cmp_gt_u32 s[54:55], 7, v68
  s_waitcnt lgkmcnt(7)
  v_mfma_f32_16x16x32_bf16 v[192:195], v[232:235], v[176:179], v[192:195]
  v_sub_u32 v69, s35, v21
  s_add_i32 s46, s34, 0
  v_mfma_f32_16x16x32_bf16 v[192:195], v[236:239], v[180:183], v[192:195]
  v_sub_u32 v70, s46, v21
  s_add_i32 s46, s34, 6
  v_mfma_f32_16x16x32_bf16 v[184:187], v[228:231], v[148:151], v[184:187]
  ds_read_b128 v[228:231], v2 offset:22528
  v_sub_u32 v71, s46, v21
  v_mfma_f32_16x16x32_bf16 v[184:187], v[232:235], v[152:155], v[184:187]
  ds_read_b128 v[232:235], v2 offset:21504
  s_add_i32 s46, s34, 1
  v_mfma_f32_16x16x32_bf16 v[184:187], v[236:239], v[156:159], v[184:187]
  ds_read_b128 v[236:239], v2 offset:20480
  s_waitcnt lgkmcnt(8)
  v_mfma_f32_16x16x32_bf16 v[188:191], v[240:243], v[136:139], 0
  v_sub_u32 v72, s46, v22
  s_add_i32 s46, s34, 8
  v_mfma_f32_16x16x32_bf16 v[188:191], v[244:247], v[140:143], v[188:191]
  v_sub_u32 v73, s46, v22
  s_waitcnt lgkmcnt(6)
  v_mfma_f32_16x16x32_bf16 v[188:191], v[248:251], v[144:147], v[188:191]
  v_cndmask_b32 v60, v64, 0, s[48:49]
  v_cndmask_b32 v61, v64, 0, s[50:51]
  v_mfma_f32_16x16x32_bf16 v[196:199], v[240:243], v[160:163], 0
  ds_read_b128 v[240:243], v2 offset:19456
  v_cndmask_b32 v62, v64, 0, s[52:53]
  v_mfma_f32_16x16x32_bf16 v[196:199], v[244:247], v[164:167], v[196:199]
  ds_read_b128 v[244:247], v2 offset:18432
  v_cndmask_b32 v63, v64, 0, s[54:55]
  v_mfma_f32_16x16x32_bf16 v[196:199], v[248:251], v[168:171], v[196:199]
  ds_read_b128 v[248:251], v2 offset:17408
  v_cmp_gt_u32 s[46:47], 7, v69
  v_mfma_f32_16x16x32_bf16 v[196:199], v[252:255], v[172:175], v[196:199]
  v_cmp_gt_u32 s[48:49], 7, v70
  s_waitcnt lgkmcnt(7)
  v_mfma_f32_16x16x32_bf16 v[196:199], v[216:219], v[176:179], v[196:199]
  v_cmp_gt_u32 s[50:51], 7, v71
  v_cmp_gt_u32 s[52:53], 7, v72
  v_mfma_f32_16x16x32_bf16 v[196:199], v[220:223], v[180:183], v[196:199]
  v_cmp_gt_u32 s[54:55], 7, v73
  v_cndmask_b32 v32, v60, v64, s[42:43]
  v_mfma_f32_16x16x32_bf16 v[188:191], v[252:255], v[148:151], v[188:191]
  ds_read_b128 v[252:255], v2 offset:16384
  v_cndmask_b32 v33, v61, v64, s[42:43]
  v_mfma_f32_16x16x32_bf16 v[188:191], v[216:219], v[152:155], v[188:191]
  ds_read_b128 v[216:219], v2 offset:15360
  v_cndmask_b32 v34, v62, v64, s[42:43]
  v_mfma_f32_16x16x32_bf16 v[188:191], v[220:223], v[156:159], v[188:191]
  ds_read_b128 v[220:223], v2 offset:14336
  s_waitcnt lgkmcnt(8)
  v_mfma_f32_16x16x32_bf16 v[200:203], v[224:227], v[136:139], 0
  v_mul_f32 v192, s93, v192
  v_mul_f32 v193, s93, v193
  v_mfma_f32_16x16x32_bf16 v[200:203], v[228:231], v[140:143], v[200:203]
  v_mul_f32 v194, s93, v194
  s_waitcnt lgkmcnt(6)
  v_mfma_f32_16x16x32_bf16 v[200:203], v[232:235], v[144:147], v[200:203]
  v_mul_f32 v195, s93, v195
  v_cvt_pk_bf16_f32 v112, v192, v193
  v_mfma_f32_16x16x32_bf16 v[208:211], v[224:227], v[160:163], 0
  ds_read_b128 v[224:227], v2 offset:13312
  v_cvt_pk_bf16_f32 v113, v194, v195
  v_mfma_f32_16x16x32_bf16 v[208:211], v[228:231], v[164:167], v[208:211]
  ds_read_b128 v[228:231], v2 offset:12288
  v_mul_f32 v184, s93, v184
  v_mfma_f32_16x16x32_bf16 v[208:211], v[232:235], v[168:171], v[208:211]
  ds_read_b128 v[232:235], v2 offset:11264
  v_mul_f32 v185, s93, v185
  v_mfma_f32_16x16x32_bf16 v[208:211], v[236:239], v[172:175], v[208:211]
  v_mul_f32 v186, s93, v186
  s_waitcnt lgkmcnt(7)
  v_mfma_f32_16x16x32_bf16 v[208:211], v[240:243], v[176:179], v[208:211]
  v_mul_f32 v187, s93, v187
  v_cvt_pk_bf16_f32 v88, v184, v185
  v_mfma_f32_16x16x32_bf16 v[208:211], v[244:247], v[180:183], v[208:211]
  v_cvt_pk_bf16_f32 v89, v186, v187
  v_mul_f32 v196, s93, v196
  v_mfma_f32_16x16x32_bf16 v[200:203], v[236:239], v[148:151], v[200:203]
  ds_read_b128 v[236:239], v2 offset:10240
  v_mul_f32 v197, s93, v197
  v_mfma_f32_16x16x32_bf16 v[200:203], v[240:243], v[152:155], v[200:203]
  ds_read_b128 v[240:243], v2 offset:9216
  v_mul_f32 v198, s93, v198
  v_mfma_f32_16x16x32_bf16 v[200:203], v[244:247], v[156:159], v[200:203]
  ds_read_b128 v[244:247], v2 offset:8192
  s_waitcnt lgkmcnt(8)
  v_mfma_f32_16x16x32_bf16 v[204:207], v[248:251], v[136:139], 0
  v_mul_f32 v199, s93, v199
  v_cvt_pk_bf16_f32 v114, v196, v197
  v_mfma_f32_16x16x32_bf16 v[204:207], v[252:255], v[140:143], v[204:207]
  v_cvt_pk_bf16_f32 v115, v198, v199
  s_waitcnt lgkmcnt(6)
  v_mfma_f32_16x16x32_bf16 v[204:207], v[216:219], v[144:147], v[204:207]
  v_mul_f32 v188, s93, v188
  v_mul_f32 v189, s93, v189
  v_mfma_f32_16x16x32_bf16 v[212:215], v[248:251], v[160:163], 0
  ds_read_b128 v[248:251], v2 offset:7168
  v_mul_f32 v190, s93, v190
  v_mfma_f32_16x16x32_bf16 v[212:215], v[252:255], v[164:167], v[212:215]
  ds_read_b128 v[252:255], v2 offset:6144
  v_mul_f32 v191, s93, v191
  v_mfma_f32_16x16x32_bf16 v[212:215], v[216:219], v[168:171], v[212:215]
  ds_read_b128 v[216:219], v2 offset:5120
  v_cvt_pk_bf16_f32 v90, v188, v189
  v_mfma_f32_16x16x32_bf16 v[212:215], v[220:223], v[172:175], v[212:215]
  v_cvt_pk_bf16_f32 v91, v190, v191
  s_waitcnt lgkmcnt(7)
  v_mfma_f32_16x16x32_bf16 v[212:215], v[224:227], v[176:179], v[212:215]
  v_cndmask_b32 v35, v63, v64, s[42:43]
  v_cndmask_b32 v24, v64, v60, s[46:47]
  v_mfma_f32_16x16x32_bf16 v[212:215], v[228:231], v[180:183], v[212:215]
  v_cndmask_b32 v25, v64, v61, s[46:47]
  v_cndmask_b32 v26, v64, v62, s[46:47]
  v_mfma_f32_16x16x32_bf16 v[204:207], v[220:223], v[148:151], v[204:207]
  ds_read_b128 v[220:223], v2 offset:4096
  v_cndmask_b32 v27, v64, v63, s[46:47]
  v_mfma_f32_16x16x32_bf16 v[204:207], v[224:227], v[152:155], v[204:207]
  ds_read_b128 v[224:227], v2 offset:3072
  v_mul_f32 v208, s93, v208
  v_mfma_f32_16x16x32_bf16 v[204:207], v[228:231], v[156:159], v[204:207]
  ds_read_b128 v[228:231], v2 offset:2048
  s_waitcnt lgkmcnt(8)
  v_mfma_f32_16x16x32_bf16 v[184:187], v[232:235], v[136:139], 0
  v_mul_f32 v209, s93, v209
  v_mul_f32 v210, s93, v210
  v_mfma_f32_16x16x32_bf16 v[184:187], v[236:239], v[140:143], v[184:187]
  v_mul_f32 v211, s93, v211
  s_waitcnt lgkmcnt(6)
  v_mfma_f32_16x16x32_bf16 v[184:187], v[240:243], v[144:147], v[184:187]
  v_cvt_pk_bf16_f32 v116, v208, v209
  v_cvt_pk_bf16_f32 v117, v210, v211
  v_mfma_f32_16x16x32_bf16 v[192:195], v[232:235], v[160:163], 0
  ds_read_b128 v[232:235], v2 offset:1024
  v_mul_f32 v200, s93, v200
  v_mfma_f32_16x16x32_bf16 v[192:195], v[236:239], v[164:167], v[192:195]
  ds_read_b128 v[236:239], v2 offset:0
  v_mul_f32 v201, s93, v201
  v_mfma_f32_16x16x32_bf16 v[192:195], v[240:243], v[168:171], v[192:195]
  ds_read_b128 v[240:243], v1 offset:35840
  v_mul_f32 v202, s93, v202
  v_mfma_f32_16x16x32_bf16 v[192:195], v[244:247], v[172:175], v[192:195]
  v_mul_f32 v203, s93, v203
  s_waitcnt lgkmcnt(7)
  v_mfma_f32_16x16x32_bf16 v[192:195], v[248:251], v[176:179], v[192:195]
  v_cvt_pk_bf16_f32 v92, v200, v201
  v_cvt_pk_bf16_f32 v93, v202, v203
  v_mfma_f32_16x16x32_bf16 v[192:195], v[252:255], v[180:183], v[192:195]
  v_mul_f32 v212, s93, v212
  v_mul_f32 v213, s93, v213
  v_mfma_f32_16x16x32_bf16 v[184:187], v[244:247], v[148:151], v[184:187]
  ds_read_b128 v[244:247], v1 offset:34816
  v_mul_f32 v214, s93, v214
  v_mfma_f32_16x16x32_bf16 v[184:187], v[248:251], v[152:155], v[184:187]
  ds_read_b128 v[248:251], v1 offset:33792
  v_mul_f32 v215, s93, v215
  v_mfma_f32_16x16x32_bf16 v[184:187], v[252:255], v[156:159], v[184:187]
  ds_read_b128 v[252:255], v1 offset:32768
  s_waitcnt lgkmcnt(8)
  v_mfma_f32_16x16x32_bf16 v[188:191], v[216:219], v[136:139], 0
  v_cvt_pk_bf16_f32 v118, v212, v213
  v_cvt_pk_bf16_f32 v119, v214, v215
  s_cbranch_vccz SL40
  s_barrier
  s_branch SM40
SL40:
  s_cmp_eq_u32 s3, 0
  s_cbranch_scc1 MK_np5
  s_waitcnt vmcnt(0)
  v_mov_b32 v23, 1
  s_mov_b64 exec, 1
  s_lshl_b32 s100, s26, 7
  buffer_atomic_add v23, off, s[8:11], s100 sc1
  s_mov_b64 exec, -1
  s_nop 3
MK_np5:
SM40:
  v_mfma_f32_16x16x32_bf16 v[188:191], v[220:223], v[140:143], v[188:191]
  v_mul_f32 v204, s93, v204
  s_waitcnt lgkmcnt(6)
  v_mfma_f32_16x16x32_bf16 v[188:191], v[224:227], v[144:147], v[188:191]
  v_mul_f32 v205, s93, v205
  v_mul_f32 v206, s93, v206
  v_mfma_f32_16x16x32_bf16 v[196:199], v[216:219], v[160:163], 0
  ds_read_b128 v[216:219], v1 offset:31744
  v_mul_f32 v207, s93, v207
  v_mfma_f32_16x16x32_bf16 v[196:199], v[220:223], v[164:167], v[196:199]
  ds_read_b128 v[220:223], v1 offset:30720
  v_cvt_pk_bf16_f32 v94, v204, v205
  v_mfma_f32_16x16x32_bf16 v[196:199], v[224:227], v[168:171], v[196:199]
  ds_read_b128 v[224:227], v1 offset:29696
  v_cvt_pk_bf16_f32 v95, v206, v207
  v_mfma_f32_16x16x32_bf16 v[196:199], v[228:231], v[172:175], v[196:199]
  v_cndmask_b32 v28, v64, v60, s[48:49]
  s_waitcnt lgkmcnt(7)
  v_mfma_f32_16x16x32_bf16 v[196:199], v[232:235], v[176:179], v[196:199]
  v_cndmask_b32 v29, v64, v61, s[48:49]
  v_cndmask_b32 v30, v64, v62, s[48:49]
  v_mfma_f32_16x16x32_bf16 v[196:199], v[236:239], v[180:183], v[196:199]
  v_cndmask_b32 v31, v64, v63, s[48:49]
  v_mul_f32 v192, s93, v192
  v_mfma_f32_16x16x32_bf16 v[188:191], v[228:231], v[148:151], v[188:191]
  ds_read_b128 v[228:231], v1 offset:28672
  v_mul_f32 v193, s93, v193
  v_mfma_f32_16x16x32_bf16 v[188:191], v[232:235], v[152:155], v[188:191]
  ds_read_b128 v[232:235], v1 offset:27648
  v_mul_f32 v194, s93, v194
  v_mfma_f32_16x16x32_bf16 v[188:191], v[236:239], v[156:159], v[188:191]
  ds_read_b128 v[236:239], v1 offset:26624
  s_waitcnt lgkmcnt(8)
  v_mfma_f32_16x16x32_bf16 v[200:203], v[240:243], v[136:139], 0
  v_mul_f32 v195, s93, v195
  v_cvt_pk_bf16_f32 v120, v192, v193
  v_mfma_f32_16x16x32_bf16 v[200:203], v[244:247], v[140:143], v[200:203]
  v_cvt_pk_bf16_f32 v121, v194, v195
  s_waitcnt lgkmcnt(6)
  v_mfma_f32_16x16x32_bf16 v[200:203], v[248:251], v[144:147], v[200:203]
  v_mul_f32 v184, s93, v184
  v_mul_f32 v185, s93, v185
  v_mfma_f32_16x16x32_bf16 v[208:211], v[240:243], v[160:163], 0
  ds_read_b128 v[240:243], v1 offset:25600
  v_mul_f32 v186, s93, v186
  v_mfma_f32_16x16x32_bf16 v[208:211], v[244:247], v[164:167], v[208:211]
  ds_read_b128 v[244:247], v1 offset:24576
  v_mul_f32 v187, s93, v187
  v_mfma_f32_16x16x32_bf16 v[208:211], v[248:251], v[168:171], v[208:211]
  ds_read_b128 v[248:251], v1 offset:23552
  v_cvt_pk_bf16_f32 v96, v184, v185
  v_mfma_f32_16x16x32_bf16 v[208:211], v[252:255], v[172:175], v[208:211]
  v_cvt_pk_bf16_f32 v97, v186, v187
  s_waitcnt lgkmcnt(7)
  v_mfma_f32_16x16x32_bf16 v[208:211], v[216:219], v[176:179], v[208:211]
  v_mul_f32 v196, s93, v196
  v_mul_f32 v197, s93, v197
  v_mfma_f32_16x16x32_bf16 v[208:211], v[220:223], v[180:183], v[208:211]
  v_mul_f32 v198, s93, v198
  v_mul_f32 v199, s93, v199
  v_mfma_f32_16x16x32_bf16 v[200:203], v[252:255], v[148:151], v[200:203]
  ds_read_b128 v[252:255], v1 offset:22528
  v_cvt_pk_bf16_f32 v122, v196, v197
  v_mfma_f32_16x16x32_bf16 v[200:203], v[216:219], v[152:155], v[200:203]
  ds_read_b128 v[216:219], v1 offset:21504
  v_cvt_pk_bf16_f32 v123, v198, v199
  v_mfma_f32_16x16x32_bf16 v[200:203], v[220:223], v[156:159], v[200:203]
  ds_read_b128 v[220:223], v1 offset:20480
  s_waitcnt lgkmcnt(8)
  v_mfma_f32_16x16x32_bf16 v[204:207], v[224:227], v[136:139], 0
  v_mul_f32 v188, s93, v188
  v_mul_f32 v189, s93, v189
  v_mfma_f32_16x16x32_bf16 v[204:207], v[228:231], v[140:143], v[204:207]
  v_mul_f32 v190, s93, v190
  s_waitcnt lgkmcnt(6)
  v_mfma_f32_16x16x32_bf16 v[204:207], v[232:235], v[144:147], v[204:207]
  v_mul_f32 v191, s93, v191
  v_cvt_pk_bf16_f32 v98, v188, v189
  v_mfma_f32_16x16x32_bf16 v[212:215], v[224:227], v[160:163], 0
  ds_read_b128 v[224:227], v1 offset:19456
  v_cvt_pk_bf16_f32 v99, v190, v191
  v_mfma_f32_16x16x32_bf16 v[212:215], v[228:231], v[164:167], v[212:215]
  ds_read_b128 v[228:231], v1 offset:18432
  v_cndmask_b32 v52, v64, v60, s[50:51]
  v_mfma_f32_16x16x32_bf16 v[212:215], v[232:235], v[168:171], v[212:215]
  ds_read_b128 v[232:235], v1 offset:17408
  v_cndmask_b32 v53, v64, v61, s[50:51]
  v_mfma_f32_16x16x32_bf16 v[212:215], v[236:239], v[172:175], v[212:215]
  v_cndmask_b32 v54, v64, v62, s[50:51]
  s_waitcnt lgkmcnt(7)
  v_mfma_f32_16x16x32_bf16 v[212:215], v[240:243], v[176:179], v[212:215]
  v_cndmask_b32 v55, v64, v63, s[50:51]
  v_cndmask_b32 v56, v64, v60, s[52:53]
  v_mfma_f32_16x16x32_bf16 v[212:215], v[244:247], v[180:183], v[212:215]
  v_mul_f32 v208, s93, v208
  v_mul_f32 v209, s93, v209
  v_mfma_f32_16x16x32_bf16 v[204:207], v[236:239], v[148:151], v[204:207]
  ds_read_b128 v[236:239], v1 offset:16384
  v_mul_f32 v210, s93, v210
  v_mfma_f32_16x16x32_bf16 v[204:207], v[240:243], v[152:155], v[204:207]
  ds_read_b128 v[240:243], v1 offset:15360
  v_mul_f32 v211, s93, v211
  v_mfma_f32_16x16x32_bf16 v[204:207], v[244:247], v[156:159], v[204:207]
  ds_read_b128 v[244:247], v1 offset:14336
  s_waitcnt lgkmcnt(8)
  v_mfma_f32_16x16x32_bf16 v[184:187], v[248:251], v[136:139], 0
  v_cvt_pk_bf16_f32 v124, v208, v209
  v_cvt_pk_bf16_f32 v125, v210, v211
  v_mfma_f32_16x16x32_bf16 v[184:187], v[252:255], v[140:143], v[184:187]
  v_mul_f32 v200, s93, v200
  s_waitcnt lgkmcnt(6)
  v_mfma_f32_16x16x32_bf16 v[184:187], v[216:219], v[144:147], v[184:187]
  v_mul_f32 v201, s93, v201
  v_mul_f32 v202, s93, v202
  v_mfma_f32_16x16x32_bf16 v[192:195], v[248:251], v[160:163], 0
  ds_read_b128 v[248:251], v1 offset:13312
  v_mul_f32 v203, s93, v203
  v_mfma_f32_16x16x32_bf16 v[192:195], v[252:255], v[164:167], v[192:195]
  ds_read_b128 v[252:255], v1 offset:12288
  v_cvt_pk_bf16_f32 v100, v200, v201
  v_mfma_f32_16x16x32_bf16 v[192:195], v[216:219], v[168:171], v[192:195]
  ds_read_b128 v[216:219], v1 offset:11264
  v_cvt_pk_bf16_f32 v101, v202, v203
  v_mfma_f32_16x16x32_bf16 v[192:195], v[220:223], v[172:175], v[192:195]
  v_mul_f32 v212, s93, v212
  s_waitcnt lgkmcnt(7)
  v_mfma_f32_16x16x32_bf16 v[192:195], v[224:227], v[176:179], v[192:195]
  v_mul_f32 v213, s93, v213
  v_mul_f32 v214, s93, v214
  v_mfma_f32_16x16x32_bf16 v[192:195], v[228:231], v[180:183], v[192:195]
  v_mul_f32 v215, s93, v215
  v_cvt_pk_bf16_f32 v126, v212, v213
  v_mfma_f32_16x16x32_bf16 v[184:187], v[220:223], v[148:151], v[184:187]
  ds_read_b128 v[220:223], v1 offset:10240
  v_cvt_pk_bf16_f32 v127, v214, v215
  v_mfma_f32_16x16x32_bf16 v[184:187], v[224:227], v[152:155], v[184:187]
  ds_read_b128 v[224:227], v1 offset:9216
  v_mul_f32 v204, s93, v204
  v_mfma_f32_16x16x32_bf16 v[184:187], v[228:231], v[156:159], v[184:187]
  ds_read_b128 v[228:231], v1 offset:8192
  s_waitcnt lgkmcnt(8)
  v_mfma_f32_16x16x32_bf16 v[188:191], v[232:235], v[136:139], 0
  v_mul_f32 v205, s93, v205
  v_mul_f32 v206, s93, v206
  v_mfma_f32_16x16x32_bf16 v[188:191], v[236:239], v[140:143], v[188:191]
  v_mul_f32 v207, s93, v207
  s_waitcnt lgkmcnt(6)
  v_mfma_f32_16x16x32_bf16 v[188:191], v[240:243], v[144:147], v[188:191]
  v_cvt_pk_bf16_f32 v102, v204, v205
  v_cvt_pk_bf16_f32 v103, v206, v207
  v_mfma_f32_16x16x32_bf16 v[196:199], v[232:235], v[160:163], 0
  ds_read_b128 v[232:235], v1 offset:7168
  v_cndmask_b32 v57, v64, v61, s[52:53]
  v_mfma_f32_16x16x32_bf16 v[196:199], v[236:239], v[164:167], v[196:199]
  ds_read_b128 v[236:239], v1 offset:6144
  v_cndmask_b32 v58, v64, v62, s[52:53]
  v_mfma_f32_16x16x32_bf16 v[196:199], v[240:243], v[168:171], v[196:199]
  ds_read_b128 v[240:243], v1 offset:5120
  v_cndmask_b32 v59, v64, v63, s[52:53]
  v_mfma_f32_16x16x32_bf16 v[196:199], v[244:247], v[172:175], v[196:199]
  v_cndmask_b32 v84, v64, v60, s[54:55]
  s_cbranch_vccnz SL41
  s_barrier
SL41:
  s_waitcnt lgkmcnt(7)
  v_mfma_f32_16x16x32_bf16 v[196:199], v[248:251], v[176:179], v[196:199]
  v_mul_f32 v192, s93, v192
  v_mul_f32 v193, s93, v193
  v_mfma_f32_16x16x32_bf16 v[196:199], v[252:255], v[180:183], v[196:199]
  v_mul_f32 v194, s93, v194
  v_mul_f32 v195, s93, v195
  v_mfma_f32_16x16x32_bf16 v[188:191], v[244:247], v[148:151], v[188:191]
  ds_read_b128 v[244:247], v1 offset:4096
  v_cvt_pk_bf16_f32 v128, v192, v193
  v_mfma_f32_16x16x32_bf16 v[188:191], v[248:251], v[152:155], v[188:191]
  ds_read_b128 v[248:251], v1 offset:3072
  v_cvt_pk_bf16_f32 v129, v194, v195
  v_mfma_f32_16x16x32_bf16 v[188:191], v[252:255], v[156:159], v[188:191]
  ds_read_b128 v[252:255], v1 offset:2048
  s_waitcnt lgkmcnt(8)
  v_mfma_f32_16x16x32_bf16 v[200:203], v[216:219], v[136:139], 0
  v_mul_f32 v184, s93, v184
  v_mul_f32 v185, s93, v185
  s_cbranch_vccz SL42
  s_waitcnt vmcnt(0)
  s_barrier
SL42:
  v_mfma_f32_16x16x32_bf16 v[200:203], v[220:223], v[140:143], v[200:203]
  v_mul_f32 v186, s93, v186
  s_waitcnt lgkmcnt(6)
  v_mfma_f32_16x16x32_bf16 v[200:203], v[224:227], v[144:147], v[200:203]
  v_mul_f32 v187, s93, v187
  v_cvt_pk_bf16_f32 v104, v184, v185
  v_mfma_f32_16x16x32_bf16 v[208:211], v[216:219], v[160:163], 0
  ds_read_b128 v[216:219], v1 offset:1024
  v_cvt_pk_bf16_f32 v105, v186, v187
  v_mfma_f32_16x16x32_bf16 v[208:211], v[220:223], v[164:167], v[208:211]
  ds_read_b128 v[220:223], v1 offset:0
  v_mul_f32 v196, s93, v196
  v_mfma_f32_16x16x32_bf16 v[208:211], v[224:227], v[168:171], v[208:211]
  v_mul_f32 v197, s93, v197
  v_mul_f32 v198, s93, v198
  v_mfma_f32_16x16x32_bf16 v[208:211], v[228:231], v[172:175], v[208:211]
  v_mul_f32 v199, s93, v199
  s_waitcnt lgkmcnt(6)
  v_mfma_f32_16x16x32_bf16 v[208:211], v[232:235], v[176:179], v[208:211]
  v_cvt_pk_bf16_f32 v130, v196, v197
  v_cvt_pk_bf16_f32 v131, v198, v199
  v_mfma_f32_16x16x32_bf16 v[208:211], v[236:239], v[180:183], v[208:211]
  v_mul_f32 v188, s93, v188
  v_mul_f32 v189, s93, v189
  v_mfma_f32_16x16x32_bf16 v[200:203], v[228:231], v[148:151], v[200:203]
  v_mul_f32 v190, s93, v190
  v_mul_f32 v191, s93, v191
  v_mfma_f32_16x16x32_bf16 v[200:203], v[232:235], v[152:155], v[200:203]
  v_cvt_pk_bf16_f32 v106, v188, v189
  v_cvt_pk_bf16_f32 v107, v190, v191
  v_mfma_f32_16x16x32_bf16 v[200:203], v[236:239], v[156:159], v[200:203]
  v_cndmask_b32 v85, v64, v61, s[54:55]
  s_waitcnt lgkmcnt(5)
  v_mfma_f32_16x16x32_bf16 v[204:207], v[240:243], v[136:139], 0
  v_cndmask_b32 v86, v64, v62, s[54:55]
  s_waitcnt lgkmcnt(4)
  v_mfma_f32_16x16x32_bf16 v[204:207], v[244:247], v[140:143], v[204:207]
  v_cndmask_b32 v87, v64, v63, s[54:55]
  s_waitcnt lgkmcnt(3)
  v_mfma_f32_16x16x32_bf16 v[204:207], v[248:251], v[144:147], v[204:207]
  v_mul_f32 v208, s93, v208
  v_mul_f32 v209, s93, v209
  v_mfma_f32_16x16x32_bf16 v[212:215], v[240:243], v[160:163], 0
  v_mul_f32 v210, s93, v210
  v_mul_f32 v211, s93, v211
  v_mfma_f32_16x16x32_bf16 v[212:215], v[244:247], v[164:167], v[212:215]
  v_cvt_pk_bf16_f32 v132, v208, v209
  v_cvt_pk_bf16_f32 v133, v210, v211
  v_mfma_f32_16x16x32_bf16 v[212:215], v[248:251], v[168:171], v[212:215]
  v_mul_f32 v200, s93, v200
  s_waitcnt lgkmcnt(2)
  v_mfma_f32_16x16x32_bf16 v[212:215], v[252:255], v[172:175], v[212:215]
  v_mul_f32 v201, s93, v201
  s_waitcnt lgkmcnt(1)
  v_mfma_f32_16x16x32_bf16 v[212:215], v[216:219], v[176:179], v[212:215]
  v_mul_f32 v202, s93, v202
  s_waitcnt lgkmcnt(0)
  v_mfma_f32_16x16x32_bf16 v[212:215], v[220:223], v[180:183], v[212:215]
  v_mul_f32 v203, s93, v203
  v_cvt_pk_bf16_f32 v108, v200, v201
  v_mfma_f32_16x16x32_bf16 v[204:207], v[252:255], v[148:151], v[204:207]
  v_cvt_pk_bf16_f32 v109, v202, v203
  v_mfma_f32_16x16x32_bf16 v[204:207], v[216:219], v[152:155], v[204:207]
  v_mfma_f32_16x16x32_bf16 v[204:207], v[220:223], v[156:159], v[204:207]
  s_cbranch_vccnz SL43
  s_setprio 0
  s_mul_i32 s100, s32, 7
  s_add_i32 s100, s100, s31
  s_add_u32 m0, s38, 107520
  s_nop 0
  buffer_load_dwordx4 v13, s[12:15], s100 offen lds
  s_add_u32 m0, s38, 108544
  s_nop 0
  buffer_load_dwordx4 v14, s[12:15], s100 offen lds
  s_add_u32 m0, s38, 109568
  s_nop 0
  buffer_load_dwordx4 v3, s[12:15], s100 offen lds
  s_add_u32 m0, s39, 107520
  s_nop 0
  buffer_load_dwordx4 v4, s[12:15], s100 offen lds
  s_mul_i32 s100, s32, 6
  s_add_i32 s100, s100, s31
  s_add_u32 m0, s38, 92160
  s_nop 0
  buffer_load_dwordx4 v13, s[12:15], s100 offen lds
  s_add_u32 m0, s38, 93184
  s_nop 0
  buffer_load_dwordx4 v14, s[12:15], s100 offen lds
  s_add_u32 m0, s38, 94208
  s_nop 0
  buffer_load_dwordx4 v3, s[12:15], s100 offen lds
  s_add_u32 m0, s39, 92160
  s_nop 0
  buffer_load_dwordx4 v4, s[12:15], s100 offen lds
  s_mul_i32 s100, s32, 5
  s_add_i32 s100, s100, s31
  s_add_u32 m0, s38, 76800
  s_nop 0
  buffer_load_dwordx4 v13, s[12:15], s100 offen lds
  s_add_u32 m0, s38, 77824
  s_nop 0
  buffer_load_dwordx4 v14, s[12:15], s100 offen lds
  s_add_u32 m0, s38, 78848
  s_nop 0
  buffer_load_dwordx4 v3, s[12:15], s100 offen lds
  s_add_u32 m0, s39, 76800
  s_nop 0
  buffer_load_dwordx4 v4, s[12:15], s100 offen lds
  s_barrier
  s_mul_i32 s100, s32, 4
  s_add_i32 s100, s100, s31
  s_add_u32 m0, s38, 61440
  s_nop 0
  buffer_load_dwordx4 v13, s[12:15], s100 offen lds
  s_add_u32 m0, s38, 62464
  s_nop 0
  buffer_load_dwordx4 v14, s[12:15], s100 offen lds
  s_add_u32 m0, s38, 63488
  s_nop 0
  buffer_load_dwordx4 v3, s[12:15], s100 offen lds
  s_add_u32 m0, s39, 61440
  s_nop 0
  buffer_load_dwordx4 v4, s[12:15], s100 offen lds
  s_mul_i32 s100, s32, 3
  s_add_i32 s100, s100, s31
  s_add_u32 m0, s38, 46080
  s_nop 0
  buffer_load_dwordx4 v13, s[12:15], s100 offen lds
  s_add_u32 m0, s38, 47104
  s_nop 0
  buffer_load_dwordx4 v14, s[12:15], s100 offen lds
  s_add_u32 m0, s38, 48128
  s_nop 0
  buffer_load_dwordx4 v3, s[12:15], s100 offen lds
  s_add_u32 m0, s39, 46080
  s_nop 0
  buffer_load_dwordx4 v4, s[12:15], s100 offen lds
  s_mul_i32 s100, s32, 2
  s_add_i32 s100, s100, s31
  s_add_u32 m0, s38, 30720
  s_nop 0
  buffer_load_dwordx4 v13, s[12:15], s100 offen lds
  s_add_u32 m0, s38, 31744
  s_nop 0
  buffer_load_dwordx4 v14, s[12:15], s100 offen lds
  s_add_u32 m0, s38, 32768
  s_nop 0
  buffer_load_dwordx4 v3, s[12:15], s100 offen lds
  s_add_u32 m0, s39, 30720
  s_nop 0
  buffer_load_dwordx4 v4, s[12:15], s100 offen lds
  s_waitcnt vmcnt(12)
  s_barrier
  s_max_u32 s100, s33, 1
  s_mul_i32 s100, s100, s32
  s_add_i32 s100, s100, s31
  s_add_u32 m0, s38, 15360
  s_nop 0
  buffer_load_dwordx4 v13, s[12:15], s100 offen lds
  s_add_u32 m0, s38, 16384
  s_nop 0
  buffer_load_dwordx4 v14, s[12:15], s100 offen lds
  s_add_u32 m0, s38, 17408
  s_nop 0
  buffer_load_dwordx4 v3, s[12:15], s100 offen lds
  s_add_u32 m0, s39, 15360
  s_nop 0
  buffer_load_dwordx4 v4, s[12:15], s100 offen lds
  s_max_u32 s100, s33, 0
  s_mul_i32 s100, s100, s32
  s_add_i32 s100, s100, s31
  s_add_u32 m0, s38, 0
  s_nop 0
  buffer_load_dwordx4 v13, s[12:15], s100 offen lds
  s_add_u32 m0, s38, 1024
  s_nop 0
  buffer_load_dwordx4 v14, s[12:15], s100 offen lds
  s_add_u32 m0, s38, 2048
  s_nop 0
  buffer_load_dwordx4 v3, s[12:15], s100 offen lds
  s_add_u32 m0, s39, 0
  s_nop 0
  buffer_load_dwordx4 v4, s[12:15], s100 offen lds
  s_waitcnt vmcnt(8)
  s_barrier
SL43:
  ds_read_b128 v[224:227], v7 offset:61440
  ds_read_b128 v[228:231], v8 offset:61440
  ds_read_b128 v[232:235], v7 offset:61568
  ds_read_b128 v[236:239], v8 offset:61568
  ds_read_b128 v[240:243], v7 offset:61696
  ds_read_b128 v[244:247], v8 offset:61696
  ds_read_b128 v[248:251], v7 offset:53760
  ds_read_b128 v[252:255], v8 offset:53760
  ds_read_b128 v[216:219], v7 offset:53888
  ds_read_b128 v[220:223], v8 offset:53888
  s_waitcnt lgkmcnt(8)
  v_mfma_f32_16x16x32_bf16 v[84:87], v[224:227], v[112:115], v[84:87]
  ds_read_b128 v[224:227], v7 offset:54016
  v_mul_f32 v212, s93, v212
  v_mfma_f32_16x16x32_bf16 v[84:87], v[228:231], v[116:119], v[84:87]
  ds_read_b128 v[228:231], v8 offset:54016
  s_waitcnt lgkmcnt(8)
  v_mfma_f32_16x16x32_bf16 v[84:87], v[232:235], v[120:123], v[84:87]
  ds_read_b128 v[232:235], v7 offset:46080
  v_mul_f32 v213, s93, v213
  v_mfma_f32_16x16x32_bf16 v[84:87], v[236:239], v[124:127], v[84:87]
  ds_read_b128 v[236:239], v8 offset:46080
  s_waitcnt lgkmcnt(8)
  v_mfma_f32_16x16x32_bf16 v[84:87], v[240:243], v[128:131], v[84:87]
  ds_read_b128 v[240:243], v7 offset:46208
  v_mul_f32 v214, s93, v214
  v_mul_f32 v215, s93, v215
  v_cvt_pk_bf16_f32 v134, v212, v213
  v_cvt_pk_bf16_f32 v135, v214, v215
  s_nop 1
  v_mfma_f32_16x16x32_bf16 v[84:87], v[244:247], v[132:135], v[84:87]
  ds_read_b128 v[244:247], v8 offset:46208
  s_waitcnt lgkmcnt(8)
  v_mfma_f32_16x16x32_bf16 v[80:83], v[248:251], v[112:115], v[60:63]
  ds_read_b128 v[248:251], v7 offset:46336
  v_mul_f32 v204, s93, v204
  v_mfma_f32_16x16x32_bf16 v[80:83], v[252:255], v[116:119], v[80:83]
  ds_read_b128 v[252:255], v8 offset:46336
  s_waitcnt lgkmcnt(8)
  v_mfma_f32_16x16x32_bf16 v[80:83], v[216:219], v[120:123], v[80:83]
  v_exp_f32 v196, v84
  v_mfma_f32_16x16x32_bf16 v[80:83], v[220:223], v[124:127], v[80:83]
  ds_read_b128 v[216:219], v7 offset:38400
  s_waitcnt lgkmcnt(7)
  v_mfma_f32_16x16x32_bf16 v[80:83], v[224:227], v[128:131], v[80:83]
  v_exp_f32 v197, v85
  v_mfma_f32_16x16x32_bf16 v[80:83], v[228:231], v[132:135], v[80:83]
  ds_read_b128 v[220:223], v8 offset:38400
  s_cbranch_vccz SL44
  s_barrier
  s_branch SM44
SL44:
  s_waitcnt vmcnt(0)
  s_barrier
SM44:
  ds_read_b128 v[224:227], v7 offset:38528
  ds_read_b128 v[228:231], v8 offset:38528
  s_waitcnt lgkmcnt(8)
  v_mfma_f32_16x16x32_bf16 v[52:55], v[232:235], v[88:91], v[52:55]
  v_exp_f32 v198, v86
  v_mfma_f32_16x16x32_bf16 v[52:55], v[236:239], v[92:95], v[52:55]
  v_mul_f32 v205, s93, v205
  s_waitcnt lgkmcnt(6)
  v_mfma_f32_16x16x32_bf16 v[52:55], v[240:243], v[96:99], v[52:55]
  v_exp_f32 v199, v87
  v_mfma_f32_16x16x32_bf16 v[76:79], v[232:235], v[112:115], v[60:63]
  v_exp_f32 v200, v80
  v_mfma_f32_16x16x32_bf16 v[76:79], v[236:239], v[116:119], v[76:79]
  v_exp_f32 v201, v81
  v_mfma_f32_16x16x32_bf16 v[76:79], v[240:243], v[120:123], v[76:79]
  v_exp_f32 v202, v82
  v_mfma_f32_16x16x32_bf16 v[76:79], v[244:247], v[124:127], v[76:79]
  ds_read_b128 v[232:235], v7 offset:38656
  s_waitcnt lgkmcnt(5)
  v_mfma_f32_16x16x32_bf16 v[76:79], v[248:251], v[128:131], v[76:79]
  v_exp_f32 v203, v83
  v_mul_f32 v206, s93, v206
  v_mul_f32 v207, s93, v207
  v_cvt_pk_bf16_f32 v110, v204, v205
  v_cvt_pk_bf16_f32 v111, v206, v207
  v_mfma_f32_16x16x32_bf16 v[76:79], v[252:255], v[132:135], v[76:79]
  ds_read_b128 v[236:239], v8 offset:38656
  v_add_u32 v2, 102400, v1
  v_mfma_f32_16x16x32_bf16 v[52:55], v[244:247], v[100:103], v[52:55]
  ds_read_b128 v[240:243], v7 offset:30720
  v_mov_b32 v192, 0x3f803f80
  v_mfma_f32_16x16x32_bf16 v[52:55], v[248:251], v[104:107], v[52:55]
  ds_read_b128 v[244:247], v8 offset:30720
  v_mov_b32 v193, 0x3f803f80
  v_mfma_f32_16x16x32_bf16 v[52:55], v[252:255], v[108:111], v[52:55]
  ds_read_b128 v[248:251], v7 offset:30848
  s_waitcnt lgkmcnt(7)
  v_mfma_f32_16x16x32_bf16 v[48:51], v[216:219], v[88:91], v[32:35]
  v_exp_f32 v204, v76
  v_mfma_f32_16x16x32_bf16 v[48:51], v[220:223], v[92:95], v[48:51]
  ds_read_b128 v[252:255], v8 offset:30848
  v_mov_b32 v194, 0x3f803f80
  s_waitcnt lgkmcnt(6)
  v_mfma_f32_16x16x32_bf16 v[48:51], v[224:227], v[96:99], v[48:51]
  v_exp_f32 v205, v77
  v_mfma_f32_16x16x32_bf16 v[72:75], v[216:219], v[112:115], v[60:63]
  v_exp_f32 v206, v78
  v_mfma_f32_16x16x32_bf16 v[72:75], v[220:223], v[116:119], v[72:75]
  v_exp_f32 v207, v79
  v_mfma_f32_16x16x32_bf16 v[72:75], v[224:227], v[120:123], v[72:75]
  v_exp_f32 v208, v52
  v_mfma_f32_16x16x32_bf16 v[72:75], v[228:231], v[124:127], v[72:75]
  ds_read_b128 v[216:219], v7 offset:30976
  s_waitcnt lgkmcnt(5)
  v_mfma_f32_16x16x32_bf16 v[72:75], v[232:235], v[128:131], v[72:75]
  v_exp_f32 v209, v53
  v_mfma_f32_16x16x32_bf16 v[72:75], v[236:239], v[132:135], v[72:75]
  ds_read_b128 v[220:223], v8 offset:30976
  ds_read_b128 v[224:227], v7 offset:23040
  v_mfma_f32_16x16x32_bf16 v[48:51], v[228:231], v[100:103], v[48:51]
  v_exp_f32 v210, v54
  v_mfma_f32_16x16x32_bf16 v[48:51], v[232:235], v[104:107], v[48:51]
  v_exp_f32 v211, v55
  v_mfma_f32_16x16x32_bf16 v[48:51], v[236:239], v[108:111], v[48:51]
  ds_read_b128 v[228:231], v8 offset:23040
  s_waitcnt lgkmcnt(6)
  v_mfma_f32_16x16x32_bf16 v[44:47], v[240:243], v[88:91], v[32:35]
  v_exp_f32 v212, v72
  v_mfma_f32_16x16x32_bf16 v[44:47], v[244:247], v[92:95], v[44:47]
  ds_read_b128 v[232:235], v7 offset:23168
  v_mov_b32 v195, 0x3f803f80
  s_waitcnt lgkmcnt(5)
  v_mfma_f32_16x16x32_bf16 v[44:47], v[248:251], v[96:99], v[44:47]
  v_exp_f32 v213, v73
  v_mfma_f32_16x16x32_bf16 v[68:71], v[240:243], v[112:115], v[60:63]
  v_exp_f32 v214, v74
  v_mfma_f32_16x16x32_bf16 v[68:71], v[244:247], v[116:119], v[68:71]
  v_exp_f32 v215, v75
  v_mfma_f32_16x16x32_bf16 v[68:71], v[248:251], v[120:123], v[68:71]
  ds_read_b128 v[236:239], v8 offset:23168
  ds_read_b128 v[240:243], v7 offset:23296
  v_mfma_f32_16x16x32_bf16 v[68:71], v[252:255], v[124:127], v[68:71]
  ds_read_b128 v[244:247], v8 offset:23296
  s_waitcnt lgkmcnt(6)
  v_mfma_f32_16x16x32_bf16 v[68:71], v[216:219], v[128:131], v[68:71]
  ds_read_b128 v[248:251], v7 offset:15360
  v_cvt_pk_bf16_f32 v166, v196, v197
  v_mfma_f32_16x16x32_bf16 v[68:71], v[220:223], v[132:135], v[68:71]
  v_exp_f32 v196, v48
  v_mfma_f32_16x16x32_bf16 v[44:47], v[252:255], v[100:103], v[44:47]
  v_exp_f32 v197, v49
  v_mfma_f32_16x16x32_bf16 v[44:47], v[216:219], v[104:107], v[44:47]
  ds_read_b128 v[252:255], v8 offset:15360
  ds_read_b128 v[216:219], v7 offset:15488
  v_mfma_f32_16x16x32_bf16 v[44:47], v[220:223], v[108:111], v[44:47]
  ds_read_b128 v[220:223], v8 offset:15488
  s_waitcnt lgkmcnt(8)
  v_mfma_f32_16x16x32_bf16 v[40:43], v[224:227], v[88:91], v[32:35]
  v_cvt_pk_bf16_f32 v167, v198, v199
  v_cvt_pk_bf16_f32 v164, v200, v201
  v_mfma_f32_16x16x32_bf16 v[40:43], v[228:231], v[92:95], v[40:43]
  v_cvt_pk_bf16_f32 v165, v202, v203
  s_waitcnt lgkmcnt(6)
  v_mfma_f32_16x16x32_bf16 v[40:43], v[232:235], v[96:99], v[40:43]
  v_exp_f32 v198, v50
  v_mfma_f32_16x16x32_bf16 v[64:67], v[224:227], v[112:115], v[60:63]
  v_exp_f32 v199, v51
  v_mfma_f32_16x16x32_bf16 v[64:67], v[228:231], v[116:119], v[64:67]
  v_exp_f32 v200, v68
  v_mfma_f32_16x16x32_bf16 v[64:67], v[232:235], v[120:123], v[64:67]
  v_exp_f32 v201, v69
  v_mfma_f32_16x16x32_bf16 v[64:67], v[236:239], v[124:127], v[64:67]
  ds_read_b128 v[224:227], v7 offset:15616
  s_waitcnt lgkmcnt(5)
  v_mfma_f32_16x16x32_bf16 v[64:67], v[240:243], v[128:131], v[64:67]
  v_exp_f32 v202, v70
  v_mfma_f32_16x16x32_bf16 v[64:67], v[244:247], v[132:135], v[64:67]
  ds_read_b128 v[228:231], v8 offset:15616
  ds_read_b128 v[232:235], v7 offset:7680
  v_mfma_f32_16x16x32_bf16 v[40:43], v[236:239], v[100:103], v[40:43]
  v_exp_f32 v203, v71
  v_mfma_f32_16x16x32_bf16 v[40:43], v[240:243], v[104:107], v[40:43]
  ds_read_b128 v[236:239], v8 offset:7680
  ds_read_b128 v[240:243], v7 offset:7808
  v_mfma_f32_16x16x32_bf16 v[40:43], v[244:247], v[108:111], v[40:43]
  ds_read_b128 v[244:247], v8 offset:7808
  s_cbranch_vccz SL45
  s_barrier
  v_and_b32 v14, 128, v1
  buffer_load_dword v13, v14, s[8:11], 0 offen
SL45:
  s_waitcnt lgkmcnt(8)
  v_mfma_f32_16x16x32_bf16 v[36:39], v[248:251], v[88:91], v[32:35]
  v_cvt_pk_bf16_f32 v162, v204, v205
  v_cvt_pk_bf16_f32 v163, v206, v207
  v_mfma_f32_16x16x32_bf16 v[36:39], v[252:255], v[92:95], v[36:39]
  v_cvt_pk_bf16_f32 v150, v208, v209
  s_waitcnt lgkmcnt(6)
  v_mfma_f32_16x16x32_bf16 v[36:39], v[216:219], v[96:99], v[36:39]
  v_exp_f32 v204, v44
  v_mfma_f32_16x16x32_bf16 v[60:63], v[248:251], v[112:115], v[60:63]
  v_exp_f32 v205, v45
  v_mfma_f32_16x16x32_bf16 v[60:63], v[252:255], v[116:119], v[60:63]
  v_exp_f32 v206, v46
  v_mfma_f32_16x16x32_bf16 v[60:63], v[216:219], v[120:123], v[60:63]
  v_exp_f32 v207, v47
  v_mfma_f32_16x16x32_bf16 v[60:63], v[220:223], v[124:127], v[60:63]
  ds_read_b128 v[248:251], v7 offset:7936
  v_cvt_pk_bf16_f32 v151, v210, v211
  s_waitcnt lgkmcnt(5)
  v_mfma_f32_16x16x32_bf16 v[60:63], v[224:227], v[128:131], v[60:63]
  v_exp_f32 v208, v64
  v_mfma_f32_16x16x32_bf16 v[60:63], v[228:231], v[132:135], v[60:63]
  ds_read_b128 v[252:255], v8 offset:7936
  ds_read_b128 v[216:219], v7 offset:0
  v_cvt_pk_bf16_f32 v160, v212, v213
  v_mfma_f32_16x16x32_bf16 v[36:39], v[220:223], v[100:103], v[36:39]
  v_exp_f32 v209, v65
  v_mfma_f32_16x16x32_bf16 v[36:39], v[224:227], v[104:107], v[36:39]
  v_exp_f32 v210, v66
  v_mfma_f32_16x16x32_bf16 v[36:39], v[228:231], v[108:111], v[36:39]
  ds_read_b128 v[220:223], v8 offset:0
  s_cbranch_vccnz SL46
  s_barrier
SL46:
  s_waitcnt lgkmcnt(6)
  v_mfma_f32_16x16x32_bf16 v[32:35], v[232:235], v[88:91], v[32:35]
  v_exp_f32 v211, v67
  v_mfma_f32_16x16x32_bf16 v[32:35], v[236:239], v[92:95], v[32:35]
  ds_read_b128 v[224:227], v7 offset:128
  v_cvt_pk_bf16_f32 v161, v214, v215
  s_waitcnt lgkmcnt(5)
  v_mfma_f32_16x16x32_bf16 v[32:35], v[240:243], v[96:99], v[32:35]
  v_exp_f32 v212, v40
  v_mfma_f32_16x16x32_bf16 v[56:59], v[232:235], v[112:115], v[56:59]
  v_exp_f32 v213, v41
  v_mfma_f32_16x16x32_bf16 v[56:59], v[236:239], v[116:119], v[56:59]
  v_exp_f32 v214, v42
  v_mfma_f32_16x16x32_bf16 v[56:59], v[240:243], v[120:123], v[56:59]
  v_exp_f32 v215, v43
  v_mfma_f32_16x16x32_bf16 v[56:59], v[244:247], v[124:127], v[56:59]
  ds_read_b128 v[228:231], v8 offset:128
  v_cvt_pk_bf16_f32 v148, v196, v197
  s_waitcnt lgkmcnt(5)
  v_mfma_f32_16x16x32_bf16 v[56:59], v[248:251], v[128:131], v[56:59]
  ds_read_b128 v[232:235], v7 offset:256
  v_cvt_pk_bf16_f32 v149, v198, v199
  s_waitcnt lgkmcnt(5)
  v_mfma_f32_16x16x32_bf16 v[56:59], v[252:255], v[132:135], v[56:59]
  ds_read_b128 v[236:239], v8 offset:256
  ds_read_b128 v[240:243], v20 offset:0
  v_cvt_pk_bf16_f32 v158, v200, v201
  v_mfma_f32_16x16x32_bf16 v[32:35], v[244:247], v[100:103], v[32:35]
  v_exp_f32 v196, v60
  v_mfma_f32_16x16x32_bf16 v[32:35], v[248:251], v[104:107], v[32:35]
  v_exp_f32 v197, v61
  v_mfma_f32_16x16x32_bf16 v[32:35], v[252:255], v[108:111], v[32:35]
  ds_read_b128 v[244:247], v0 offset:0
  s_waitcnt lgkmcnt(6)
  v_mfma_f32_16x16x32_bf16 v[28:31], v[216:219], v[88:91], v[28:31]
  v_exp_f32 v198, v62
  v_mfma_f32_16x16x32_bf16 v[28:31], v[220:223], v[92:95], v[28:31]
  ds_read_b128 v[248:251], v20 offset:128
  v_cvt_pk_bf16_f32 v159, v202, v203
  s_waitcnt lgkmcnt(5)
  v_mfma_f32_16x16x32_bf16 v[28:31], v[224:227], v[96:99], v[28:31]
  v_exp_f32 v199, v63
  v_mfma_f32_16x16x32_bf16 v[28:31], v[228:231], v[100:103], v[28:31]
  ds_read_b128 v[252:255], v0 offset:128
  v_cvt_pk_bf16_f32 v146, v204, v205
  s_waitcnt lgkmcnt(5)
  v_mfma_f32_16x16x32_bf16 v[28:31], v[232:235], v[104:107], v[28:31]
  ds_read_b128 v[216:219], v20 offset:256
  v_cvt_pk_bf16_f32 v147, v206, v207
  s_waitcnt lgkmcnt(5)
  v_mfma_f32_16x16x32_bf16 v[28:31], v[236:239], v[108:111], v[28:31]
  ds_read_b128 v[220:223], v0 offset:256
  v_cvt_pk_bf16_f32 v156, v208, v209
  s_waitcnt lgkmcnt(5)
  v_mfma_f32_16x16x32_bf16 v[24:27], v[240:243], v[88:91], v[24:27]
  ds_read_b64_tr_b16 v[224:225], v9 offset:53760
  ds_read_b64_tr_b16 v[226:227], v9 offset:61440
  v_cvt_pk_bf16_f32 v157, v210, v211
  s_waitcnt lgkmcnt(5)
  v_mfma_f32_16x16x32_bf16 v[24:27], v[244:247], v[92:95], v[24:27]
  ds_read_b64_tr_b16 v[228:229], v10 offset:53760
  ds_read_b64_tr_b16 v[230:231], v10 offset:61440
  v_cvt_pk_bf16_f32 v144, v212, v213
  v_mfma_f32_16x16x32_bf16 v[24:27], v[248:251], v[96:99], v[24:27]
  ds_read_b64_tr_b16 v[232:233], v11 offset:53760
  ds_read_b64_tr_b16 v[234:235], v11 offset:61440
  v_cvt_pk_bf16_f32 v145, v214, v215
  v_cvt_pk_bf16_f32 v154, v196, v197
  v_cvt_pk_bf16_f32 v155, v198, v199
  v_exp_f32 v200, v36
  v_exp_f32 v201, v37
  v_exp_f32 v202, v38
  v_exp_f32 v203, v39
  v_cvt_pk_bf16_f32 v142, v200, v201
  v_cvt_pk_bf16_f32 v143, v202, v203
  v_exp_f32 v204, v56
  v_exp_f32 v205, v57
  v_exp_f32 v206, v58
  v_exp_f32 v207, v59
  v_cvt_pk_bf16_f32 v152, v204, v205
  v_cvt_pk_bf16_f32 v153, v206, v207
  v_mfma_f32_16x16x32_bf16 v[188:191], v[192:195], v[164:167], 0
  v_exp_f32 v208, v32
  v_mfma_f32_16x16x32_bf16 v[188:191], v[192:195], v[160:163], v[188:191]
  v_exp_f32 v209, v33
  v_mfma_f32_16x16x32_bf16 v[188:191], v[192:195], v[156:159], v[188:191]
  v_exp_f32 v210, v34
  v_mfma_f32_16x16x32_bf16 v[188:191], v[192:195], v[152:155], v[188:191]
  ds_read_b64_tr_b16 v[236:237], v12 offset:53760
  ds_read_b64_tr_b16 v[238:239], v12 offset:61440
  s_waitcnt lgkmcnt(9)
  v_mfma_f32_16x16x32_bf16 v[24:27], v[252:255], v[100:103], v[24:27]
  v_exp_f32 v211, v35
  v_mfma_f32_16x16x32_bf16 v[24:27], v[216:219], v[104:107], v[24:27]
  ds_read_b64_tr_b16 v[240:241], v9 offset:53888
  ds_read_b64_tr_b16 v[242:243], v9 offset:61568
  s_waitcnt lgkmcnt(8)
  v_mfma_f32_16x16x32_bf16 v[24:27], v[220:223], v[108:111], v[24:27]
  ds_read_b64_tr_b16 v[244:245], v10 offset:53888
  ds_read_b64_tr_b16 v[246:247], v10 offset:61568
  v_subrev_u32 v23, 813694976, v188
  s_mov_b32 s52, 503316480
  v_cmp_gt_u32 s[48:49], s52, v23
  s_or_b64 s[48:49], s[48:49], s[44:45]
  s_cmp_eq_u64 s[48:49], -1
  s_cbranch_scc0 FB1
FBR1:
  s_cbranch_vccnz SL47
  s_barrier
SL47:
  v_mfma_f32_16x16x32_bf16 v[88:91], v[224:227], v[164:167], 0
  ds_read_b64_tr_b16 v[248:249], v11 offset:53888
  ds_read_b64_tr_b16 v[250:251], v11 offset:61568
  v_cvt_pk_bf16_f32 v140, v208, v209
  s_waitcnt lgkmcnt(8)
  v_mfma_f32_16x16x32_bf16 v[92:95], v[228:231], v[164:167], 0
  ds_read_b64_tr_b16 v[252:253], v12 offset:53888
  ds_read_b64_tr_b16 v[254:255], v12 offset:61568
  v_cvt_pk_bf16_f32 v141, v210, v211
  v_mfma_f32_16x16x32_bf16 v[96:99], v[232:235], v[164:167], 0
  ds_read_b64_tr_b16 v[216:217], v9 offset:54016
  ds_read_b64_tr_b16 v[218:219], v9 offset:61696
  v_exp_f32 v212, v28
  s_waitcnt lgkmcnt(8)
  v_mfma_f32_16x16x32_bf16 v[100:103], v[236:239], v[164:167], 0
  ds_read_b64_tr_b16 v[220:221], v10 offset:54016
  ds_read_b64_tr_b16 v[222:223], v10 offset:61696
  v_exp_f32 v213, v29
  v_mfma_f32_16x16x32_bf16 v[104:107], v[240:243], v[164:167], 0
  ds_read_b64_tr_b16 v[224:225], v11 offset:54016
  ds_read_b64_tr_b16 v[226:227], v11 offset:61696
  s_waitcnt lgkmcnt(8)
  v_mfma_f32_16x16x32_bf16 v[108:111], v[244:247], v[164:167], 0
  ds_read_b64_tr_b16 v[228:229], v12 offset:54016
  ds_read_b64_tr_b16 v[230:231], v12 offset:61696
  v_mfma_f32_16x16x32_bf16 v[112:115], v[248:251], v[164:167], 0
  ds_read_b64_tr_b16 v[232:233], v9 offset:38400
  ds_read_b64_tr_b16 v[234:235], v9 offset:46080
  s_waitcnt lgkmcnt(8)
  v_mfma_f32_16x16x32_bf16 v[116:119], v[252:255], v[164:167], 0
  ds_read_b64_tr_b16 v[236:237], v10 offset:38400
  ds_read_b64_tr_b16 v[238:239], v10 offset:46080
  v_mfma_f32_16x16x32_bf16 v[120:123], v[216:219], v[164:167], 0
  ds_read_b64_tr_b16 v[240:241], v11 offset:38400
  ds_read_b64_tr_b16 v[242:243], v11 offset:46080
  s_waitcnt lgkmcnt(8)
  v_mfma_f32_16x16x32_bf16 v[124:127], v[220:223], v[164:167], 0
  ds_read_b64_tr_b16 v[244:245], v12 offset:38400
  ds_read_b64_tr_b16 v[246:247], v12 offset:46080
  v_mfma_f32_16x16x32_bf16 v[128:131], v[224:227], v[164:167], 0
  ds_read_b64_tr_b16 v[248:249], v9 offset:38528
  ds_read_b64_tr_b16 v[250:251], v9 offset:46208
  s_waitcnt lgkmcnt(8)
  v_mfma_f32_16x16x32_bf16 v[132:135], v[228:231], v[164:167], 0
  ds_read_b64_tr_b16 v[252:253], v10 offset:38528
  ds_read_b64_tr_b16 v[254:255], v10 offset:46208
  v_exp_f32 v214, v30
  v_exp_f32 v215, v31
  v_cvt_pk_bf16_f32 v138, v212, v213
  v_cvt_pk_bf16_f32 v139, v214, v215
  v_exp_f32 v196, v24
  v_exp_f32 v197, v25
  v_exp_f32 v198, v26
  v_exp_f32 v199, v27
  v_cvt_pk_bf16_f32 v136, v196, v197
  v_cvt_pk_bf16_f32 v137, v198, v199
  v_mfma_f32_16x16x32_bf16 v[184:187], v[192:195], v[148:151], 0
  ds_read_b64_tr_b16 v[216:217], v11 offset:38528
  ds_read_b64_tr_b16 v[218:219], v11 offset:46208
  v_mfma_f32_16x16x32_bf16 v[184:187], v[192:195], v[144:147], v[184:187]
  ds_read_b64_tr_b16 v[220:221], v12 offset:38528
  ds_read_b64_tr_b16 v[222:223], v12 offset:46208
  v_mfma_f32_16x16x32_bf16 v[184:187], v[192:195], v[140:143], v[184:187]
  v_mfma_f32_16x16x32_bf16 v[184:187], v[192:195], v[136:139], v[184:187]
  s_nop 7
  v_subrev_u32 v23, 813694976, v184
  s_mov_b32 s52, 503316480
  v_cmp_gt_u32 s[48:49], s52, v23
  s_or_b64 s[48:49], s[48:49], s[42:43]
  s_cmp_eq_u64 s[48:49], -1
  s_cbranch_scc0 FB0
FBR0:
  v_mfma_f32_16x16x32_bf16 v[88:91], v[232:235], v[160:163], v[88:91]
  v_rcp_f32 v22, v184
  v_mfma_f32_16x16x32_bf16 v[24:27], v[232:235], v[148:151], 0
  s_waitcnt lgkmcnt(10)
  v_mfma_f32_16x16x32_bf16 v[92:95], v[236:239], v[160:163], v[92:95]
  v_rcp_f32 v23, v188
  v_mfma_f32_16x16x32_bf16 v[28:31], v[236:239], v[148:151], 0
  ds_read_b64_tr_b16 v[224:225], v9 offset:38656
  ds_read_b64_tr_b16 v[226:227], v9 offset:46336
  v_mfma_f32_16x16x32_bf16 v[96:99], v[240:243], v[160:163], v[96:99]
  ds_read_b64_tr_b16 v[228:229], v10 offset:38656
  ds_read_b64_tr_b16 v[230:231], v10 offset:46336
  v_mfma_f32_16x16x32_bf16 v[32:35], v[240:243], v[148:151], 0
  s_waitcnt lgkmcnt(10)
  v_mfma_f32_16x16x32_bf16 v[100:103], v[244:247], v[160:163], v[100:103]
  ds_read_b64_tr_b16 v[232:233], v11 offset:38656
  ds_read_b64_tr_b16 v[234:235], v11 offset:46336
  v_mfma_f32_16x16x32_bf16 v[36:39], v[244:247], v[148:151], 0
  ds_read_b64_tr_b16 v[236:237], v12 offset:38656
  ds_read_b64_tr_b16 v[238:239], v12 offset:46336
  v_mfma_f32_16x16x32_bf16 v[104:107], v[248:251], v[160:163], v[104:107]
  v_mfma_f32_16x16x32_bf16 v[40:43], v[248:251], v[148:151], 0
  s_waitcnt lgkmcnt(10)
  v_mfma_f32_16x16x32_bf16 v[108:111], v[252:255], v[160:163], v[108:111]
  ds_read_b64_tr_b16 v[240:241], v9 offset:23040
  ds_read_b64_tr_b16 v[242:243], v9 offset:30720
  v_mfma_f32_16x16x32_bf16 v[44:47], v[252:255], v[148:151], 0
  ds_read_b64_tr_b16 v[244:245], v10 offset:23040
  ds_read_b64_tr_b16 v[246:247], v10 offset:30720
  v_mfma_f32_16x16x32_bf16 v[112:115], v[216:219], v[160:163], v[112:115]
  v_mfma_f32_16x16x32_bf16 v[48:51], v[216:219], v[148:151], 0
  s_waitcnt lgkmcnt(10)
  v_mfma_f32_16x16x32_bf16 v[116:119], v[220:223], v[160:163], v[116:119]
  ds_read_b64_tr_b16 v[248:249], v11 offset:23040
  ds_read_b64_tr_b16 v[250:251], v11 offset:30720
  v_mfma_f32_16x16x32_bf16 v[52:55], v[220:223], v[148:151], 0
  ds_read_b64_tr_b16 v[252:253], v12 offset:23040
  ds_read_b64_tr_b16 v[254:255], v12 offset:30720
  v_mfma_f32_16x16x32_bf16 v[120:123], v[224:227], v[160:163], v[120:123]
  v_mfma_f32_16x16x32_bf16 v[56:59], v[224:227], v[148:151], 0
  s_waitcnt lgkmcnt(10)
  v_mfma_f32_16x16x32_bf16 v[124:127], v[228:231], v[160:163], v[124:127]
  ds_read_b64_tr_b16 v[216:217], v9 offset:23168
  ds_read_b64_tr_b16 v[218:219], v9 offset:30848
  v_mfma_f32_16x16x32_bf16 v[60:63], v[228:231], v[148:151], 0
  ds_read_b64_tr_b16 v[220:221], v10 offset:23168
  ds_read_b64_tr_b16 v[222:223], v10 offset:30848
  v_mfma_f32_16x16x32_bf16 v[128:131], v[232:235], v[160:163], v[128:131]
  v_mfma_f32_16x16x32_bf16 v[64:67], v[232:235], v[148:151], 0
  s_waitcnt lgkmcnt(10)
  v_mfma_f32_16x16x32_bf16 v[132:135], v[236:239], v[160:163], v[132:135]
  ds_read_b64_tr_b16 v[224:225], v11 offset:23168
  ds_read_b64_tr_b16 v[226:227], v11 offset:30848
  v_mfma_f32_16x16x32_bf16 v[68:71], v[236:239], v[148:151], 0
  ds_read_b64_tr_b16 v[228:229], v12 offset:23168
  ds_read_b64_tr_b16 v[230:231], v12 offset:30848
  s_cbranch_vccz SL48
  s_barrier
  s_mov_b32 s53, 0x40000
  s_mov_b32 s46, 72
NPOLL:
  s_waitcnt vmcnt(0)
  v_cmp_le_u32 s[48:49], s46, v13
  s_sub_u32 s53, s53, 1
  s_cbranch_scc1 NPOLLD
  s_cmp_eq_u64 s[48:49], -1
  s_cbranch_scc1 NPOLLD
  buffer_load_dword v13, v14, s[8:11], 0 offen sc1
  s_branch NPOLL
NPOLLD:
  s_add_u32 m0, s40, 0
  s_add_u32 s100, s40, 30720
  buffer_load_dwordx4 v1, s[20:23], s100 offen sc1 lds
  s_add_u32 m0, s40, 4096
  s_add_u32 s100, s40, 34816
  buffer_load_dwordx4 v1, s[20:23], s100 offen sc1 lds
  s_min_u32 s51, s40, 1024
  s_add_u32 m0, s51, 8192
  s_add_u32 s100, s51, 38912
  buffer_load_dwordx4 v1, s[20:23], s100 offen sc1 lds
  s_add_u32 m0, s40, 133120
  s_add_u32 s100, s40, 0
  buffer_load_dwordx4 v1, s[20:23], s100 offen sc1 lds
  s_add_u32 m0, s40, 137216
  s_add_u32 s100, s40, 4096
  buffer_load_dwordx4 v1, s[20:23], s100 offen sc1 lds
  s_add_u32 m0, s40, 141312
  s_add_u32 s100, s40, 8192
  buffer_load_dwordx4 v1, s[20:23], s100 offen sc1 lds
  s_add_u32 m0, s40, 145408
  s_add_u32 s100, s40, 12288
  buffer_load_dwordx4 v1, s[20:23], s100 offen sc1 lds
  s_add_u32 m0, s40, 149504
  s_add_u32 s100, s40, 16384
  buffer_load_dwordx4 v1, s[20:23], s100 offen sc1 lds
  s_add_u32 m0, s40, 153600
  s_add_u32 s100, s40, 20480
  buffer_load_dwordx4 v1, s[20:23], s100 offen sc1 lds
  s_add_u32 m0, s40, 157696
  s_add_u32 s100, s40, 24576
  buffer_load_dwordx4 v1, s[20:23], s100 offen sc1 lds
  s_min_u32 s51, s40, 1024
  s_add_u32 m0, s51, 161792
  s_add_u32 s100, s51, 28672
  buffer_load_dwordx4 v1, s[20:23], s100 offen sc1 lds
SL48:
  s_cbranch_vccnz SL49
  s_barrier
SL49:
  v_mfma_f32_16x16x32_bf16 v[88:91], v[240:243], v[156:159], v[88:91]
  v_mfma_f32_16x16x32_bf16 v[24:27], v[240:243], v[144:147], v[24:27]
  s_waitcnt lgkmcnt(10)
  v_mfma_f32_16x16x32_bf16 v[92:95], v[244:247], v[156:159], v[92:95]
  ds_read_b64_tr_b16 v[232:233], v9 offset:23296
  ds_read_b64_tr_b16 v[234:235], v9 offset:30976
  v_mfma_f32_16x16x32_bf16 v[28:31], v[244:247], v[144:147], v[28:31]
  ds_read_b64_tr_b16 v[236:237], v10 offset:23296
  ds_read_b64_tr_b16 v[238:239], v10 offset:30976
  v_mfma_f32_16x16x32_bf16 v[96:99], v[248:251], v[156:159], v[96:99]
  v_mfma_f32_16x16x32_bf16 v[32:35], v[248:251], v[144:147], v[32:35]
  s_waitcnt lgkmcnt(10)
  v_mfma_f32_16x16x32_bf16 v[100:103], v[252:255], v[156:159], v[100:103]
  ds_read_b64_tr_b16 v[240:241], v11 offset:23296
  ds_read_b64_tr_b16 v[242:243], v11 offset:30976
  v_mfma_f32_16x16x32_bf16 v[36:39], v[252:255], v[144:147], v[36:39]
  ds_read_b64_tr_b16 v[244:245], v12 offset:23296
  ds_read_b64_tr_b16 v[246:247], v12 offset:30976
  v_mfma_f32_16x16x32_bf16 v[104:107], v[216:219], v[156:159], v[104:107]
  v_mfma_f32_16x16x32_bf16 v[40:43], v[216:219], v[144:147], v[40:43]
  s_waitcnt lgkmcnt(10)
  v_mfma_f32_16x16x32_bf16 v[108:111], v[220:223], v[156:159], v[108:111]
  ds_read_b64_tr_b16 v[248:249], v9 offset:7680
  ds_read_b64_tr_b16 v[250:251], v9 offset:15360
  v_mfma_f32_16x16x32_bf16 v[44:47], v[220:223], v[144:147], v[44:47]
  ds_read_b64_tr_b16 v[252:253], v10 offset:7680
  ds_read_b64_tr_b16 v[254:255], v10 offset:15360
  v_mfma_f32_16x16x32_bf16 v[112:115], v[224:227], v[156:159], v[112:115]
  v_mfma_f32_16x16x32_bf16 v[48:51], v[224:227], v[144:147], v[48:51]
  s_waitcnt lgkmcnt(10)
  v_mfma_f32_16x16x32_bf16 v[116:119], v[228:231], v[156:159], v[116:119]
  ds_read_b64_tr_b16 v[216:217], v11 offset:7680
  ds_read_b64_tr_b16 v[218:219], v11 offset:15360
  v_mfma_f32_16x16x32_bf16 v[52:55], v[228:231], v[144:147], v[52:55]
  ds_read_b64_tr_b16 v[220:221], v12 offset:7680
  ds_read_b64_tr_b16 v[222:223], v12 offset:15360
  v_mfma_f32_16x16x32_bf16 v[120:123], v[232:235], v[156:159], v[120:123]
  v_mfma_f32_16x16x32_bf16 v[56:59], v[232:235], v[144:147], v[56:59]
  s_waitcnt lgkmcnt(10)
  v_mfma_f32_16x16x32_bf16 v[124:127], v[236:239], v[156:159], v[124:127]
  ds_read_b64_tr_b16 v[224:225], v9 offset:7808
  ds_read_b64_tr_b16 v[226:227], v9 offset:15488
  v_mfma_f32_16x16x32_bf16 v[60:63], v[236:239], v[144:147], v[60:63]
  ds_read_b64_tr_b16 v[228:229], v10 offset:7808
  ds_read_b64_tr_b16 v[230:231], v10 offset:15488
  v_mfma_f32_16x16x32_bf16 v[128:131], v[240:243], v[156:159], v[128:131]
  v_mfma_f32_16x16x32_bf16 v[64:67], v[240:243], v[144:147], v[64:67]
  s_waitcnt lgkmcnt(10)
  v_mfma_f32_16x16x32_bf16 v[132:135], v[244:247], v[156:159], v[132:135]
  ds_read_b64_tr_b16 v[232:233], v11 offset:7808
  ds_read_b64_tr_b16 v[234:235], v11 offset:15488
  v_mfma_f32_16x16x32_bf16 v[68:71], v[244:247], v[144:147], v[68:71]
  ds_read_b64_tr_b16 v[236:237], v12 offset:7808
  ds_read_b64_tr_b16 v[238:239], v12 offset:15488
  v_mfma_f32_16x16x32_bf16 v[88:91], v[248:251], v[152:155], v[88:91]
  v_mfma_f32_16x16x32_bf16 v[24:27], v[248:251], v[140:143], v[24:27]
  s_waitcnt lgkmcnt(10)
  v_mfma_f32_16x16x32_bf16 v[92:95], v[252:255], v[152:155], v[92:95]
  ds_read_b64_tr_b16 v[240:241], v9 offset:7936
  ds_read_b64_tr_b16 v[242:243], v9 offset:15616
  v_mfma_f32_16x16x32_bf16 v[28:31], v[252:255], v[140:143], v[28:31]
  ds_read_b64_tr_b16 v[244:245], v10 offset:7936
  ds_read_b64_tr_b16 v[246:247], v10 offset:15616
  v_mfma_f32_16x16x32_bf16 v[96:99], v[216:219], v[152:155], v[96:99]
  v_cvt_pk_bf16_f32 v156, v88, v89
  v_cvt_pk_bf16_f32 v157, v90, v91
  v_mfma_f32_16x16x32_bf16 v[32:35], v[216:219], v[140:143], v[32:35]
  v_cvt_pk_bf16_f32 v158, v92, v93
  s_waitcnt lgkmcnt(10)
  v_mfma_f32_16x16x32_bf16 v[100:103], v[220:223], v[152:155], v[100:103]
  ds_read_b64_tr_b16 v[248:249], v11 offset:7936
  ds_read_b64_tr_b16 v[250:251], v11 offset:15616
  v_mfma_f32_16x16x32_bf16 v[36:39], v[220:223], v[140:143], v[36:39]
  ds_read_b64_tr_b16 v[252:253], v12 offset:7936
  ds_read_b64_tr_b16 v[254:255], v12 offset:15616
  v_mfma_f32_16x16x32_bf16 v[104:107], v[224:227], v[152:155], v[104:107]
  v_cvt_pk_bf16_f32 v159, v94, v95
  v_cvt_pk_bf16_f32 v160, v96, v97
  v_mfma_f32_16x16x32_bf16 v[40:43], v[224:227], v[140:143], v[40:43]
  v_cvt_pk_bf16_f32 v161, v98, v99
  s_waitcnt lgkmcnt(10)
  v_mfma_f32_16x16x32_bf16 v[108:111], v[228:231], v[152:155], v[108:111]
  ds_read_b64_tr_b16 v[216:217], v15 offset:0
  ds_read_b64_tr_b16 v[218:219], v9 offset:0
  v_mfma_f32_16x16x32_bf16 v[44:47], v[228:231], v[140:143], v[44:47]
  ds_read_b64_tr_b16 v[220:221], v16 offset:0
  ds_read_b64_tr_b16 v[222:223], v10 offset:0
  v_mfma_f32_16x16x32_bf16 v[112:115], v[232:235], v[152:155], v[112:115]
  v_cvt_pk_bf16_f32 v162, v100, v101
  v_cvt_pk_bf16_f32 v163, v102, v103
  v_mfma_f32_16x16x32_bf16 v[48:51], v[232:235], v[140:143], v[48:51]
  v_cvt_pk_bf16_f32 v164, v104, v105
  s_waitcnt lgkmcnt(10)
  v_mfma_f32_16x16x32_bf16 v[116:119], v[236:239], v[152:155], v[116:119]
  ds_read_b64_tr_b16 v[224:225], v17 offset:0
  ds_read_b64_tr_b16 v[226:227], v11 offset:0
  v_mfma_f32_16x16x32_bf16 v[52:55], v[236:239], v[140:143], v[52:55]
  ds_read_b64_tr_b16 v[228:229], v18 offset:0
  ds_read_b64_tr_b16 v[230:231], v12 offset:0
  v_mfma_f32_16x16x32_bf16 v[120:123], v[240:243], v[152:155], v[120:123]
  v_cvt_pk_bf16_f32 v165, v106, v107
  v_cvt_pk_bf16_f32 v166, v108, v109
  v_mfma_f32_16x16x32_bf16 v[56:59], v[240:243], v[140:143], v[56:59]
  v_cvt_pk_bf16_f32 v167, v110, v111
  s_waitcnt lgkmcnt(10)
  v_mfma_f32_16x16x32_bf16 v[124:127], v[244:247], v[152:155], v[124:127]
  ds_read_b64_tr_b16 v[232:233], v15 offset:128
  ds_read_b64_tr_b16 v[234:235], v9 offset:128
  v_mfma_f32_16x16x32_bf16 v[60:63], v[244:247], v[140:143], v[60:63]
  ds_read_b64_tr_b16 v[236:237], v16 offset:128
  ds_read_b64_tr_b16 v[238:239], v10 offset:128
  v_mfma_f32_16x16x32_bf16 v[128:131], v[248:251], v[152:155], v[128:131]
  v_cvt_pk_bf16_f32 v176, v112, v113
  v_cvt_pk_bf16_f32 v177, v114, v115
  v_mfma_f32_16x16x32_bf16 v[64:67], v[248:251], v[140:143], v[64:67]
  v_cvt_pk_bf16_f32 v178, v116, v117
  s_waitcnt lgkmcnt(10)
  v_mfma_f32_16x16x32_bf16 v[132:135], v[252:255], v[152:155], v[132:135]
  ds_read_b64_tr_b16 v[240:241], v17 offset:128
  ds_read_b64_tr_b16 v[242:243], v11 offset:128
  v_mfma_f32_16x16x32_bf16 v[68:71], v[252:255], v[140:143], v[68:71]
  ds_read_b64_tr_b16 v[244:245], v18 offset:128
  ds_read_b64_tr_b16 v[246:247], v12 offset:128
  v_mfma_f32_16x16x32_bf16 v[24:27], v[216:219], v[136:139], v[24:27]
  v_cvt_pk_bf16_f32 v179, v118, v119
  s_waitcnt lgkmcnt(10)
  v_mfma_f32_16x16x32_bf16 v[28:31], v[220:223], v[136:139], v[28:31]
  ds_read_b64_tr_b16 v[248:249], v15 offset:256
  ds_read_b64_tr_b16 v[250:251], v9 offset:256
  v_mfma_f32_16x16x32_bf16 v[32:35], v[224:227], v[136:139], v[32:35]
  ds_read_b64_tr_b16 v[252:253], v16 offset:256
  ds_read_b64_tr_b16 v[254:255], v10 offset:256
  s_waitcnt lgkmcnt(10)
  v_mfma_f32_16x16x32_bf16 v[36:39], v[228:231], v[136:139], v[36:39]
  ds_read_b64_tr_b16 v[216:217], v17 offset:256
  ds_read_b64_tr_b16 v[218:219], v11 offset:256
  v_mfma_f32_16x16x32_bf16 v[40:43], v[232:235], v[136:139], v[40:43]
  ds_read_b64_tr_b16 v[220:221], v18 offset:256
  ds_read_b64_tr_b16 v[222:223], v12 offset:256
  s_waitcnt lgkmcnt(10)
  v_mfma_f32_16x16x32_bf16 v[44:47], v[236:239], v[136:139], v[44:47]
  v_cvt_pk_bf16_f32 v180, v120, v121
  v_cvt_pk_bf16_f32 v181, v122, v123
  s_waitcnt lgkmcnt(0)
  s_cbranch_vccz SL50
  s_waitcnt vmcnt(0)
  s_barrier
  s_add_u32 m0, s40, 102400
  s_add_u32 s100, s40, 40960
  buffer_load_dwordx4 v1, s[20:23], s100 offen sc1 lds
  s_add_u32 m0, s40, 106496
  s_add_u32 s100, s40, 45056
  buffer_load_dwordx4 v1, s[20:23], s100 offen sc1 lds
  s_add_u32 m0, s40, 110592
  s_add_u32 s100, s40, 49152
  buffer_load_dwordx4 v1, s[20:23], s100 offen sc1 lds
  s_add_u32 m0, s40, 114688
  s_add_u32 s100, s40, 53248
  buffer_load_dwordx4 v1, s[20:23], s100 offen sc1 lds
  s_add_u32 m0, s40, 118784
  s_add_u32 s100, s40, 57344
  buffer_load_dwordx4 v1, s[20:23], s100 offen sc1 lds
  s_add_u32 m0, s40, 122880
  s_add_u32 s100, s40, 61440
  buffer_load_dwordx4 v1, s[20:23], s100 offen sc1 lds
  s_add_u32 m0, s40, 126976
  s_add_u32 s100, s40, 65536
  buffer_load_dwordx4 v1, s[20:23], s100 offen sc1 lds
  s_min_u32 s51, s40, 1024
  s_add_u32 m0, s51, 131072
  s_add_u32 s100, s51, 69632
  buffer_load_dwordx4 v1, s[20:23], s100 offen sc1 lds
SL50:
  ds_read_b128 v[224:227], v2 offset:30720
  ds_read_b128 v[228:231], v2 offset:31744
  ds_read_b128 v[232:235], v2 offset:32768
  ds_read_b128 v[236:239], v2 offset:33792
  v_mfma_f32_16x16x32_bf16 v[48:51], v[240:243], v[136:139], v[48:51]
  ds_read_b128 v[240:243], v2 offset:34816
  v_cvt_pk_bf16_f32 v182, v124, v125
  v_mfma_f32_16x16x32_bf16 v[52:55], v[244:247], v[136:139], v[52:55]
  ds_read_b128 v[244:247], v2 offset:35840
  v_cvt_pk_bf16_f32 v183, v126, v127
  v_mfma_f32_16x16x32_bf16 v[56:59], v[248:251], v[136:139], v[56:59]
  ds_read_b128 v[248:251], v2 offset:36864
  v_cvt_pk_bf16_f32 v72, v128, v129
  v_mfma_f32_16x16x32_bf16 v[60:63], v[252:255], v[136:139], v[60:63]
  ds_read_b128 v[252:255], v2 offset:37888
  v_cvt_pk_bf16_f32 v73, v130, v131
  v_mfma_f32_16x16x32_bf16 v[64:67], v[216:219], v[136:139], v[64:67]
  ds_read_b128 v[216:219], v2 offset:38912
  v_cvt_pk_bf16_f32 v74, v132, v133
  v_mfma_f32_16x16x32_bf16 v[68:71], v[220:223], v[136:139], v[68:71]
  ds_read_b128 v[220:223], v2 offset:39936
  v_cvt_pk_bf16_f32 v75, v134, v135
  v_cvt_pk_bf16_f32 v140, v24, v25
  v_cvt_pk_bf16_f32 v141, v26, v27
  v_cvt_pk_bf16_f32 v142, v28, v29
  v_cvt_pk_bf16_f32 v143, v30, v31
  s_waitcnt lgkmcnt(8)
  s_nop 0
  v_mfma_f32_16x16x32_bf16 v[184:187], v[224:227], v[140:143], 0
  v_cvt_pk_bf16_f32 v144, v32, v33
  v_cvt_pk_bf16_f32 v145, v34, v35
  v_cvt_pk_bf16_f32 v146, v36, v37
  v_cvt_pk_bf16_f32 v147, v38, v39
  s_nop 1
  v_mfma_f32_16x16x32_bf16 v[184:187], v[228:231], v[144:147], v[184:187]
  v_cvt_pk_bf16_f32 v148, v40, v41
  v_cvt_pk_bf16_f32 v149, v42, v43
  v_cvt_pk_bf16_f32 v150, v44, v45
  v_cvt_pk_bf16_f32 v151, v46, v47
  s_waitcnt lgkmcnt(6)
  s_nop 0
  v_mfma_f32_16x16x32_bf16 v[184:187], v[232:235], v[148:151], v[184:187]
  v_cvt_pk_bf16_f32 v168, v48, v49
  v_cvt_pk_bf16_f32 v169, v50, v51
  v_mfma_f32_16x16x32_bf16 v[192:195], v[224:227], v[156:159], 0
  ds_read_b128 v[224:227], v2 offset:40960
  v_cvt_pk_bf16_f32 v170, v52, v53
  v_mfma_f32_16x16x32_bf16 v[192:195], v[228:231], v[160:163], v[192:195]
  ds_read_b128 v[228:231], v2 offset:41984
  v_cvt_pk_bf16_f32 v171, v54, v55
  v_mfma_f32_16x16x32_bf16 v[192:195], v[232:235], v[164:167], v[192:195]
  ds_read_b128 v[232:235], v2 offset:43008
  v_cvt_pk_bf16_f32 v172, v56, v57
  v_mfma_f32_16x16x32_bf16 v[192:195], v[236:239], v[176:179], v[192:195]
  v_cvt_pk_bf16_f32 v173, v58, v59
  v_cvt_pk_bf16_f32 v174, v60, v61
  v_cvt_pk_bf16_f32 v175, v62, v63
  s_waitcnt lgkmcnt(7)
  v_mfma_f32_16x16x32_bf16 v[192:195], v[240:243], v[180:183], v[192:195]
  v_cvt_pk_bf16_f32 v152, v64, v65
  v_cvt_pk_bf16_f32 v153, v66, v67
  v_cvt_pk_bf16_f32 v154, v68, v69
  v_cvt_pk_bf16_f32 v155, v70, v71
  v_mfma_f32_16x16x32_bf16 v[192:195], v[244:247], v[72:75], v[192:195]
  v_mfma_f32_16x16x32_bf16 v[184:187], v[236:239], v[168:171], v[184:187]
  ds_read_b128 v[236:239], v2 offset:44032
  v_mfma_f32_16x16x32_bf16 v[184:187], v[240:243], v[172:175], v[184:187]
  ds_read_b128 v[240:243], v2 offset:45056
  v_mfma_f32_16x16x32_bf16 v[184:187], v[244:247], v[152:155], v[184:187]
  ds_read_b128 v[244:247], v2 offset:46080
  s_waitcnt lgkmcnt(8)
  v_mfma_f32_16x16x32_bf16 v[188:191], v[248:251], v[140:143], 0
  v_mul_f32 v192, v192, v23
  v_mul_f32 v193, v193, v23
  v_mfma_f32_16x16x32_bf16 v[188:191], v[252:255], v[144:147], v[188:191]
  v_mul_f32 v194, v194, v23
  s_waitcnt lgkmcnt(6)
  v_mfma_f32_16x16x32_bf16 v[188:191], v[216:219], v[148:151], v[188:191]
  v_mul_f32 v195, v195, v23
  v_cvt_pk_bf16_f32 v28, v192, v193
  v_mfma_f32_16x16x32_bf16 v[196:199], v[248:251], v[156:159], 0
  ds_read_b128 v[248:251], v2 offset:47104
  v_cvt_pk_bf16_f32 v29, v194, v195
  v_mfma_f32_16x16x32_bf16 v[196:199], v[252:255], v[160:163], v[196:199]
  ds_read_b128 v[252:255], v2 offset:48128
  v_mul_f32 v184, v184, v22
  v_mfma_f32_16x16x32_bf16 v[196:199], v[216:219], v[164:167], v[196:199]
  ds_read_b128 v[216:219], v2 offset:49152
  v_mul_f32 v185, v185, v22
  v_mfma_f32_16x16x32_bf16 v[196:199], v[220:223], v[176:179], v[196:199]
  v_mul_f32 v186, v186, v22
  s_waitcnt lgkmcnt(7)
  v_mfma_f32_16x16x32_bf16 v[196:199], v[224:227], v[180:183], v[196:199]
  v_mul_f32 v187, v187, v22
  v_cvt_pk_bf16_f32 v24, v184, v185
  v_mfma_f32_16x16x32_bf16 v[196:199], v[228:231], v[72:75], v[196:199]
  v_cvt_pk_bf16_f32 v25, v186, v187
  v_mfma_f32_16x16x32_bf16 v[188:191], v[220:223], v[168:171], v[188:191]
  ds_read_b128 v[220:223], v2 offset:50176
  v_mfma_f32_16x16x32_bf16 v[188:191], v[224:227], v[172:175], v[188:191]
  ds_read_b128 v[224:227], v2 offset:51200
  v_mfma_f32_16x16x32_bf16 v[188:191], v[228:231], v[152:155], v[188:191]
  ds_read_b128 v[228:231], v2 offset:52224
  s_mov_b32 s100, 71680
  buffer_load_dwordx4 v[40:43], v1, s[20:23], s100 offen offset:0 sc1
  buffer_load_dwordx4 v[44:47], v1, s[20:23], s100 offen offset:1024 sc1
  s_waitcnt lgkmcnt(8)
  v_mfma_f32_16x16x32_bf16 v[200:203], v[232:235], v[140:143], 0
  v_mul_f32 v196, v196, v23
  v_mul_f32 v197, v197, v23
  v_mfma_f32_16x16x32_bf16 v[200:203], v[236:239], v[144:147], v[200:203]
  v_mul_f32 v198, v198, v23
  s_waitcnt lgkmcnt(6)
  v_mfma_f32_16x16x32_bf16 v[200:203], v[240:243], v[148:151], v[200:203]
  v_mul_f32 v199, v199, v23
  v_cvt_pk_bf16_f32 v30, v196, v197
  v_mfma_f32_16x16x32_bf16 v[208:211], v[232:235], v[156:159], 0
  ds_read_b128 v[232:235], v2 offset:53248
  v_cvt_pk_bf16_f32 v31, v198, v199
  v_mfma_f32_16x16x32_bf16 v[208:211], v[236:239], v[160:163], v[208:211]
  buffer_store_dwordx4 v[28:31], v6, s[16:19], 0 offen offset:0 nt sc1
  v_mul_f32 v188, v188, v22
  v_mfma_f32_16x16x32_bf16 v[208:211], v[240:243], v[164:167], v[208:211]
  ds_read_b128 v[236:239], v2 offset:54272
  v_mul_f32 v189, v189, v22
  v_mfma_f32_16x16x32_bf16 v[208:211], v[244:247], v[176:179], v[208:211]
  ds_read_b128 v[240:243], v2 offset:55296
  s_waitcnt lgkmcnt(7)
  v_mfma_f32_16x16x32_bf16 v[208:211], v[248:251], v[180:183], v[208:211]
  v_mul_f32 v190, v190, v22
  v_mul_f32 v191, v191, v22
  v_mfma_f32_16x16x32_bf16 v[208:211], v[252:255], v[72:75], v[208:211]
  v_cvt_pk_bf16_f32 v26, v188, v189
  v_cvt_pk_bf16_f32 v27, v190, v191
  v_mfma_f32_16x16x32_bf16 v[200:203], v[244:247], v[168:171], v[200:203]
  buffer_store_dwordx4 v[24:27], v5, s[16:19], 0 offen offset:0 nt sc1
  v_mfma_f32_16x16x32_bf16 v[200:203], v[248:251], v[172:175], v[200:203]
  ds_read_b128 v[244:247], v2 offset:56320
  ds_read_b128 v[248:251], v2 offset:57344
  v_mfma_f32_16x16x32_bf16 v[200:203], v[252:255], v[152:155], v[200:203]
  ds_read_b128 v[252:255], v2 offset:58368
  s_waitcnt lgkmcnt(8)
  v_mfma_f32_16x16x32_bf16 v[204:207], v[216:219], v[140:143], 0
  v_mul_f32 v208, v208, v23
  v_mul_f32 v209, v209, v23
  v_mfma_f32_16x16x32_bf16 v[204:207], v[220:223], v[144:147], v[204:207]
  v_mul_f32 v210, v210, v23
  s_waitcnt lgkmcnt(6)
  v_mfma_f32_16x16x32_bf16 v[204:207], v[224:227], v[148:151], v[204:207]
  v_mul_f32 v211, v211, v23
  v_cvt_pk_bf16_f32 v36, v208, v209
  v_mfma_f32_16x16x32_bf16 v[212:215], v[216:219], v[156:159], 0
  ds_read_b128 v[216:219], v2 offset:59392
  v_cvt_pk_bf16_f32 v37, v210, v211
  v_mfma_f32_16x16x32_bf16 v[212:215], v[220:223], v[160:163], v[212:215]
  ds_read_b128 v[220:223], v2 offset:60416
  v_mul_f32 v200, v200, v22
  v_mfma_f32_16x16x32_bf16 v[212:215], v[224:227], v[164:167], v[212:215]
  ds_read_b128 v[224:227], v1 offset:0
  v_mul_f32 v201, v201, v22
  v_mfma_f32_16x16x32_bf16 v[212:215], v[228:231], v[176:179], v[212:215]
  v_mul_f32 v202, v202, v22
  s_waitcnt lgkmcnt(7)
  v_mfma_f32_16x16x32_bf16 v[212:215], v[232:235], v[180:183], v[212:215]
  v_mul_f32 v203, v203, v22
  v_cvt_pk_bf16_f32 v32, v200, v201
  v_mfma_f32_16x16x32_bf16 v[212:215], v[236:239], v[72:75], v[212:215]
  v_cvt_pk_bf16_f32 v33, v202, v203
  v_mfma_f32_16x16x32_bf16 v[204:207], v[228:231], v[168:171], v[204:207]
  ds_read_b128 v[228:231], v1 offset:1024
  v_mfma_f32_16x16x32_bf16 v[204:207], v[232:235], v[172:175], v[204:207]
  ds_read_b128 v[232:235], v1 offset:2048
  v_mfma_f32_16x16x32_bf16 v[204:207], v[236:239], v[152:155], v[204:207]
  ds_read_b128 v[236:239], v1 offset:3072
  s_cbranch_vccz SL51
  s_waitcnt vmcnt(4)
  s_barrier
SL51:
  s_waitcnt lgkmcnt(8)
  v_mfma_f32_16x16x32_bf16 v[184:187], v[240:243], v[140:143], 0
  v_mul_f32 v212, v212, v23
  v_mul_f32 v213, v213, v23
  v_mfma_f32_16x16x32_bf16 v[184:187], v[244:247], v[144:147], v[184:187]
  v_mul_f32 v214, v214, v23
  s_waitcnt lgkmcnt(6)
  v_mfma_f32_16x16x32_bf16 v[184:187], v[248:251], v[148:151], v[184:187]
  v_mul_f32 v215, v215, v23
  v_cvt_pk_bf16_f32 v38, v212, v213
  v_mfma_f32_16x16x32_bf16 v[192:195], v[240:243], v[156:159], 0
  ds_read_b128 v[240:243], v1 offset:4096
  v_cvt_pk_bf16_f32 v39, v214, v215
  v_mfma_f32_16x16x32_bf16 v[192:195], v[244:247], v[160:163], v[192:195]
  buffer_store_dwordx4 v[36:39], v6, s[16:19], 0 offen offset:64 nt sc1
  v_mul_f32 v204, v204, v22
  v_mfma_f32_16x16x32_bf16 v[192:195], v[248:251], v[164:167], v[192:195]
  ds_read_b128 v[244:247], v1 offset:5120
  v_mul_f32 v205, v205, v22
  v_mfma_f32_16x16x32_bf16 v[192:195], v[252:255], v[176:179], v[192:195]
  ds_read_b128 v[248:251], v1 offset:6144
  s_waitcnt lgkmcnt(7)
  v_mfma_f32_16x16x32_bf16 v[192:195], v[216:219], v[180:183], v[192:195]
  v_mul_f32 v206, v206, v22
  v_mul_f32 v207, v207, v22
  v_mfma_f32_16x16x32_bf16 v[192:195], v[220:223], v[72:75], v[192:195]
  v_cvt_pk_bf16_f32 v34, v204, v205
  v_cvt_pk_bf16_f32 v35, v206, v207
  v_mfma_f32_16x16x32_bf16 v[184:187], v[252:255], v[168:171], v[184:187]
  buffer_store_dwordx4 v[32:35], v5, s[16:19], 0 offen offset:64 nt sc1
  v_mfma_f32_16x16x32_bf16 v[184:187], v[216:219], v[172:175], v[184:187]
  ds_read_b128 v[252:255], v1 offset:7168
  ds_read_b128 v[216:219], v1 offset:8192
  v_mfma_f32_16x16x32_bf16 v[184:187], v[220:223], v[152:155], v[184:187]
  ds_read_b128 v[220:223], v1 offset:9216
  s_waitcnt lgkmcnt(8)
  v_mfma_f32_16x16x32_bf16 v[188:191], v[224:227], v[140:143], 0
  v_mul_f32 v192, v192, v23
  v_mul_f32 v193, v193, v23
  v_mfma_f32_16x16x32_bf16 v[188:191], v[228:231], v[144:147], v[188:191]
  v_mul_f32 v194, v194, v23
  s_waitcnt lgkmcnt(6)
  v_mfma_f32_16x16x32_bf16 v[188:191], v[232:235], v[148:151], v[188:191]
  v_mul_f32 v195, v195, v23
  v_cvt_pk_bf16_f32 v28, v192, v193
  v_mfma_f32_16x16x32_bf16 v[196:199], v[224:227], v[156:159], 0
  ds_read_b128 v[224:227], v2 offset:0
  v_cvt_pk_bf16_f32 v29, v194, v195
  v_mfma_f32_16x16x32_bf16 v[196:199], v[228:231], v[160:163], v[196:199]
  ds_read_b128 v[228:231], v2 offset:1024
  v_mul_f32 v184, v184, v22
  v_mfma_f32_16x16x32_bf16 v[196:199], v[232:235], v[164:167], v[196:199]
  ds_read_b128 v[232:235], v2 offset:2048
  v_mul_f32 v185, v185, v22
  v_mfma_f32_16x16x32_bf16 v[196:199], v[236:239], v[176:179], v[196:199]
  v_mul_f32 v186, v186, v22
  s_waitcnt lgkmcnt(7)
  v_mfma_f32_16x16x32_bf16 v[196:199], v[240:243], v[180:183], v[196:199]
  v_mul_f32 v187, v187, v22
  v_cvt_pk_bf16_f32 v24, v184, v185
  v_mfma_f32_16x16x32_bf16 v[196:199], v[244:247], v[72:75], v[196:199]
  v_cvt_pk_bf16_f32 v25, v186, v187
  v_mfma_f32_16x16x32_bf16 v[188:191], v[236:239], v[168:171], v[188:191]
  ds_read_b128 v[236:239], v2 offset:3072
  v_mfma_f32_16x16x32_bf16 v[188:191], v[240:243], v[172:175], v[188:191]
  ds_read_b128 v[240:243], v2 offset:4096
  v_mfma_f32_16x16x32_bf16 v[188:191], v[244:247], v[152:155], v[188:191]
  ds_read_b128 v[244:247], v2 offset:5120
  s_waitcnt lgkmcnt(8)
  v_mfma_f32_16x16x32_bf16 v[200:203], v[248:251], v[140:143], 0
  v_mul_f32 v196, v196, v23
  v_mul_f32 v197, v197, v23
  v_mfma_f32_16x16x32_bf16 v[200:203], v[252:255], v[144:147], v[200:203]
  v_mul_f32 v198, v198, v23
  s_waitcnt lgkmcnt(6)
  v_mfma_f32_16x16x32_bf16 v[200:203], v[216:219], v[148:151], v[200:203]
  v_mul_f32 v199, v199, v23
  v_cvt_pk_bf16_f32 v30, v196, v197
  v_mfma_f32_16x16x32_bf16 v[208:211], v[248:251], v[156:159], 0
  ds_read_b128 v[248:251], v2 offset:6144
  v_cvt_pk_bf16_f32 v31, v198, v199
  v_mfma_f32_16x16x32_bf16 v[208:211], v[252:255], v[160:163], v[208:211]
  buffer_store_dwordx4 v[28:31], v6, s[16:19], 0 offen offset:128 nt sc1
  v_mul_f32 v188, v188, v22
  v_mfma_f32_16x16x32_bf16 v[208:211], v[216:219], v[164:167], v[208:211]
  ds_read_b128 v[252:255], v2 offset:7168
  v_mul_f32 v189, v189, v22
  v_mfma_f32_16x16x32_bf16 v[208:211], v[220:223], v[176:179], v[208:211]
  ds_read_b128 v[216:219], v2 offset:8192
  s_waitcnt lgkmcnt(7)
  v_mfma_f32_16x16x32_bf16 v[208:211], v[224:227], v[180:183], v[208:211]
  v_mul_f32 v190, v190, v22
  v_mul_f32 v191, v191, v22
  v_mfma_f32_16x16x32_bf16 v[208:211], v[228:231], v[72:75], v[208:211]
  v_cvt_pk_bf16_f32 v26, v188, v189
  v_cvt_pk_bf16_f32 v27, v190, v191
  v_mfma_f32_16x16x32_bf16 v[200:203], v[220:223], v[168:171], v[200:203]
  buffer_store_dwordx4 v[24:27], v5, s[16:19], 0 offen offset:128 nt sc1
  v_mfma_f32_16x16x32_bf16 v[200:203], v[224:227], v[172:175], v[200:203]
  ds_read_b128 v[220:223], v2 offset:9216
  ds_read_b128 v[224:227], v2 offset:10240
  v_mfma_f32_16x16x32_bf16 v[200:203], v[228:231], v[152:155], v[200:203]
  ds_read_b128 v[228:231], v2 offset:11264
  s_waitcnt lgkmcnt(8)
  v_mfma_f32_16x16x32_bf16 v[204:207], v[232:235], v[140:143], 0
  v_mul_f32 v208, v208, v23
  v_mul_f32 v209, v209, v23
  v_mfma_f32_16x16x32_bf16 v[204:207], v[236:239], v[144:147], v[204:207]
  v_mul_f32 v210, v210, v23
  s_waitcnt lgkmcnt(6)
  v_mfma_f32_16x16x32_bf16 v[204:207], v[240:243], v[148:151], v[204:207]
  v_mul_f32 v211, v211, v23
  v_cvt_pk_bf16_f32 v36, v208, v209
  v_mfma_f32_16x16x32_bf16 v[212:215], v[232:235], v[156:159], 0
  ds_read_b128 v[232:235], v2 offset:12288
  v_cvt_pk_bf16_f32 v37, v210, v211
  v_mfma_f32_16x16x32_bf16 v[212:215], v[236:239], v[160:163], v[212:215]
  ds_read_b128 v[236:239], v2 offset:13312
  v_mul_f32 v200, v200, v22
  v_mfma_f32_16x16x32_bf16 v[212:215], v[240:243], v[164:167], v[212:215]
  ds_read_b128 v[240:243], v2 offset:14336
  v_mul_f32 v201, v201, v22
  v_mfma_f32_16x16x32_bf16 v[212:215], v[244:247], v[176:179], v[212:215]
  v_mul_f32 v202, v202, v22
  s_waitcnt lgkmcnt(7)
  v_mfma_f32_16x16x32_bf16 v[212:215], v[248:251], v[180:183], v[212:215]
  v_mul_f32 v203, v203, v22
  v_cvt_pk_bf16_f32 v32, v200, v201
  v_mfma_f32_16x16x32_bf16 v[212:215], v[252:255], v[72:75], v[212:215]
  v_cvt_pk_bf16_f32 v33, v202, v203
  v_mfma_f32_16x16x32_bf16 v[204:207], v[244:247], v[168:171], v[204:207]
  ds_read_b128 v[244:247], v2 offset:15360
  v_mfma_f32_16x16x32_bf16 v[204:207], v[248:251], v[172:175], v[204:207]
  ds_read_b128 v[248:251], v2 offset:16384
  v_mfma_f32_16x16x32_bf16 v[204:207], v[252:255], v[152:155], v[204:207]
  ds_read_b128 v[252:255], v2 offset:17408
  s_waitcnt lgkmcnt(8)
  v_mfma_f32_16x16x32_bf16 v[184:187], v[216:219], v[140:143], 0
  v_mul_f32 v212, v212, v23
  v_mul_f32 v213, v213, v23
  v_mfma_f32_16x16x32_bf16 v[184:187], v[220:223], v[144:147], v[184:187]
  v_mul_f32 v214, v214, v23
  s_waitcnt lgkmcnt(6)
  v_mfma_f32_16x16x32_bf16 v[184:187], v[224:227], v[148:151], v[184:187]
  v_mul_f32 v215, v215, v23
  v_cvt_pk_bf16_f32 v38, v212, v213
  v_mfma_f32_16x16x32_bf16 v[192:195], v[216:219], v[156:159], 0
  ds_read_b128 v[216:219], v2 offset:18432
  v_cvt_pk_bf16_f32 v39, v214, v215
  v_mfma_f32_16x16x32_bf16 v[192:195], v[220:223], v[160:163], v[192:195]
  buffer_store_dwordx4 v[36:39], v6, s[16:19], 0 offen offset:192 nt sc1
  v_mul_f32 v204, v204, v22
  v_mfma_f32_16x16x32_bf16 v[192:195], v[224:227], v[164:167], v[192:195]
  ds_read_b128 v[220:223], v2 offset:19456
  v_mul_f32 v205, v205, v22
  v_mfma_f32_16x16x32_bf16 v[192:195], v[228:231], v[176:179], v[192:195]
  ds_read_b128 v[224:227], v2 offset:20480
  s_waitcnt lgkmcnt(7)
  v_mfma_f32_16x16x32_bf16 v[192:195], v[232:235], v[180:183], v[192:195]
  v_mul_f32 v206, v206, v22
  v_mul_f32 v207, v207, v22
  v_mfma_f32_16x16x32_bf16 v[192:195], v[236:239], v[72:75], v[192:195]
  v_cvt_pk_bf16_f32 v34, v204, v205
  v_cvt_pk_bf16_f32 v35, v206, v207
  v_mfma_f32_16x16x32_bf16 v[184:187], v[228:231], v[168:171], v[184:187]
  buffer_store_dwordx4 v[32:35], v5, s[16:19], 0 offen offset:192 nt sc1
  v_mfma_f32_16x16x32_bf16 v[184:187], v[232:235], v[172:175], v[184:187]
  ds_read_b128 v[228:231], v2 offset:21504
  ds_read_b128 v[232:235], v2 offset:22528
  v_mfma_f32_16x16x32_bf16 v[184:187], v[236:239], v[152:155], v[184:187]
  ds_read_b128 v[236:239], v2 offset:23552
  s_waitcnt lgkmcnt(8)
  v_mfma_f32_16x16x32_bf16 v[188:191], v[240:243], v[140:143], 0
  v_mul_f32 v192, v192, v23
  v_mul_f32 v193, v193, v23
  v_mfma_f32_16x16x32_bf16 v[188:191], v[244:247], v[144:147], v[188:191]
  v_mul_f32 v194, v194, v23
  s_waitcnt lgkmcnt(6)
  v_mfma_f32_16x16x32_bf16 v[188:191], v[248:251], v[148:151], v[188:191]
  v_mul_f32 v195, v195, v23
  v_cvt_pk_bf16_f32 v28, v192, v193
  v_mfma_f32_16x16x32_bf16 v[196:199], v[240:243], v[156:159], 0
  ds_read_b128 v[240:243], v2 offset:24576
  v_cvt_pk_bf16_f32 v29, v194, v195
  v_mfma_f32_16x16x32_bf16 v[196:199], v[244:247], v[160:163], v[196:199]
  ds_read_b128 v[244:247], v2 offset:25600
  v_mul_f32 v184, v184, v22
  v_mfma_f32_16x16x32_bf16 v[196:199], v[248:251], v[164:167], v[196:199]
  ds_read_b128 v[248:251], v2 offset:26624
  v_mul_f32 v185, v185, v22
  v_mfma_f32_16x16x32_bf16 v[196:199], v[252:255], v[176:179], v[196:199]
  v_mul_f32 v186, v186, v22
  s_waitcnt lgkmcnt(7)
  v_mfma_f32_16x16x32_bf16 v[196:199], v[216:219], v[180:183], v[196:199]
  v_mul_f32 v187, v187, v22
  v_cvt_pk_bf16_f32 v24, v184, v185
  v_mfma_f32_16x16x32_bf16 v[196:199], v[220:223], v[72:75], v[196:199]
  v_cvt_pk_bf16_f32 v25, v186, v187
  v_mfma_f32_16x16x32_bf16 v[188:191], v[252:255], v[168:171], v[188:191]
  ds_read_b128 v[252:255], v2 offset:27648
  v_mfma_f32_16x16x32_bf16 v[188:191], v[216:219], v[172:175], v[188:191]
  ds_read_b128 v[216:219], v2 offset:28672
  v_mfma_f32_16x16x32_bf16 v[188:191], v[220:223], v[152:155], v[188:191]
  ds_read_b128 v[220:223], v2 offset:29696
  s_waitcnt vmcnt(8)
  s_waitcnt lgkmcnt(8)
  v_mfma_f32_16x16x32_bf16 v[200:203], v[224:227], v[140:143], 0
  v_mul_f32 v196, v196, v23
  v_mul_f32 v197, v197, v23
  v_mfma_f32_16x16x32_bf16 v[200:203], v[228:231], v[144:147], v[200:203]
  v_mul_f32 v198, v198, v23
  s_waitcnt lgkmcnt(6)
  v_mfma_f32_16x16x32_bf16 v[200:203], v[232:235], v[148:151], v[200:203]
  v_mul_f32 v199, v199, v23
  v_cvt_pk_bf16_f32 v30, v196, v197
  v_mfma_f32_16x16x32_bf16 v[208:211], v[224:227], v[156:159], 0
  v_cvt_pk_bf16_f32 v31, v198, v199
  v_mul_f32 v188, v188, v22
  v_mfma_f32_16x16x32_bf16 v[208:211], v[228:231], v[160:163], v[208:211]
  buffer_store_dwordx4 v[28:31], v6, s[16:19], 0 offen offset:256 nt sc1
  v_mul_f32 v189, v189, v22
  v_mfma_f32_16x16x32_bf16 v[208:211], v[232:235], v[164:167], v[208:211]
  v_mul_f32 v190, v190, v22
  v_mul_f32 v191, v191, v22
  v_mfma_f32_16x16x32_bf16 v[208:211], v[236:239], v[176:179], v[208:211]
  v_cvt_pk_bf16_f32 v26, v188, v189
  s_waitcnt lgkmcnt(5)
  v_mfma_f32_16x16x32_bf16 v[208:211], v[240:243], v[180:183], v[208:211]
  v_cvt_pk_bf16_f32 v27, v190, v191
  s_waitcnt lgkmcnt(4)
  v_mfma_f32_16x16x32_bf16 v[208:211], v[244:247], v[72:75], v[208:211]
  buffer_store_dwordx4 v[24:27], v5, s[16:19], 0 offen offset:256 nt sc1
  v_mfma_f32_16x16x32_bf16 v[200:203], v[236:239], v[168:171], v[200:203]
  v_mfma_f32_16x16x32_bf16 v[200:203], v[240:243], v[172:175], v[200:203]
  v_mfma_f32_16x16x32_bf16 v[200:203], v[244:247], v[152:155], v[200:203]
  s_waitcnt lgkmcnt(3)
  v_mfma_f32_16x16x32_bf16 v[204:207], v[248:251], v[140:143], 0
  s_waitcnt lgkmcnt(2)
  v_mfma_f32_16x16x32_bf16 v[204:207], v[252:255], v[144:147], v[204:207]
  v_mul_f32 v208, v208, v23
  s_waitcnt lgkmcnt(1)
  v_mfma_f32_16x16x32_bf16 v[204:207], v[216:219], v[148:151], v[204:207]
  v_mul_f32 v209, v209, v23
  v_mul_f32 v210, v210, v23
  v_mfma_f32_16x16x32_bf16 v[212:215], v[248:251], v[156:159], 0
  v_mul_f32 v211, v211, v23
  v_cvt_pk_bf16_f32 v36, v208, v209
  v_mfma_f32_16x16x32_bf16 v[212:215], v[252:255], v[160:163], v[212:215]
  v_cvt_pk_bf16_f32 v37, v210, v211
  v_mul_f32 v200, v200, v22
  v_mfma_f32_16x16x32_bf16 v[212:215], v[216:219], v[164:167], v[212:215]
  v_mul_f32 v201, v201, v22
  s_waitcnt lgkmcnt(0)
  v_mfma_f32_16x16x32_bf16 v[212:215], v[220:223], v[176:179], v[212:215]
  v_mul_f32 v202, v202, v22
  v_mfma_f32_16x16x32_bf16 v[212:215], v[40:43], v[180:183], v[212:215]
  v_mul_f32 v203, v203, v22
  v_mfma_f32_16x16x32_bf16 v[212:215], v[44:47], v[72:75], v[212:215]
  v_cvt_pk_bf16_f32 v32, v200, v201
  v_cvt_pk_bf16_f32 v33, v202, v203
  v_mfma_f32_16x16x32_bf16 v[204:207], v[220:223], v[168:171], v[204:207]
  v_mfma_f32_16x16x32_bf16 v[204:207], v[40:43], v[172:175], v[204:207]
  v_mfma_f32_16x16x32_bf16 v[204:207], v[44:47], v[152:155], v[204:207]
  s_nop 2
  v_mul_f32 v212, v212, v23
  v_mul_f32 v213, v213, v23
  v_mul_f32 v214, v214, v23
  v_mul_f32 v215, v215, v23
  v_cvt_pk_bf16_f32 v38, v212, v213
  v_cvt_pk_bf16_f32 v39, v214, v215
  buffer_store_dwordx4 v[36:39], v6, s[16:19], 0 offen offset:320 nt sc1
  v_mul_f32 v204, v204, v22
  v_mul_f32 v205, v205, v22
  v_mul_f32 v206, v206, v22
  v_mul_f32 v207, v207, v22
  v_cvt_pk_bf16_f32 v34, v204, v205
  v_cvt_pk_bf16_f32 v35, v206, v207
  buffer_store_dwordx4 v[32:35], v5, s[16:19], 0 offen offset:320 nt sc1
MK_done:
  s_endpgm
FB0:
  s_nop 7
  v_max3_f32 v22, v24, v25, v26
  v_max3_f32 v22, v22, v27, v28
  v_max3_f32 v22, v22, v29, v30
  v_max3_f32 v22, v22, v31, v32
  v_max3_f32 v22, v22, v33, v34
  v_max3_f32 v22, v22, v35, v36
  v_max3_f32 v22, v22, v37, v38
  v_max3_f32 v22, v22, v39, v40
  v_max3_f32 v22, v22, v41, v42
  v_max3_f32 v22, v22, v43, v44
  v_max3_f32 v22, v22, v45, v46
  v_max3_f32 v22, v22, v47, v48
  v_max3_f32 v22, v22, v49, v50
  v_max3_f32 v22, v22, v51, v52
  v_max3_f32 v22, v22, v53, v54
  s_mov_b32 s52, 0xff7fffff
  v_max3_f32 v22, v22, v55, s52
  v_mov_b32 v23, v22
  s_nop 1
  v_permlane32_swap_b32 v22, v23
  s_nop 1
  v_max_f32 v22, v22, v23
  v_mov_b32 v23, v22
  s_nop 1
  v_permlane16_swap_b32 v22, v23
  s_nop 1
  v_max_f32 v22, v22, v23
  v_sub_f32 v24, v24, v22
  v_sub_f32 v25, v25, v22
  v_sub_f32 v26, v26, v22
  v_sub_f32 v27, v27, v22
  v_sub_f32 v28, v28, v22
  v_sub_f32 v29, v29, v22
  v_sub_f32 v30, v30, v22
  v_sub_f32 v31, v31, v22
  v_sub_f32 v32, v32, v22
  v_sub_f32 v33, v33, v22
  v_sub_f32 v34, v34, v22
  v_sub_f32 v35, v35, v22
  v_sub_f32 v36, v36, v22
  v_sub_f32 v37, v37, v22
  v_sub_f32 v38, v38, v22
  v_sub_f32 v39, v39, v22
  v_sub_f32 v40, v40, v22
  v_sub_f32 v41, v41, v22
  v_sub_f32 v42, v42, v22
  v_sub_f32 v43, v43, v22
  v_sub_f32 v44, v44, v22
  v_sub_f32 v45, v45, v22
  v_sub_f32 v46, v46, v22
  v_sub_f32 v47, v47, v22
  v_sub_f32 v48, v48, v22
  v_sub_f32 v49, v49, v22
  v_sub_f32 v50, v50, v22
  v_sub_f32 v51, v51, v22
  v_sub_f32 v52, v52, v22
  v_sub_f32 v53, v53, v22
  v_sub_f32 v54, v54, v22
  v_sub_f32 v55, v55, v22
  v_exp_f32 v24, v24
  v_exp_f32 v25, v25
  v_exp_f32 v26, v26
  v_exp_f32 v27, v27
  v_exp_f32 v28, v28
  v_exp_f32 v29, v29
  v_exp_f32 v30, v30
  v_exp_f32 v31, v31
  v_exp_f32 v32, v32
  v_exp_f32 v33, v33
  v_exp_f32 v34, v34
  v_exp_f32 v35, v35
  v_exp_f32 v36, v36
  v_exp_f32 v37, v37
  v_exp_f32 v38, v38
  v_exp_f32 v39, v39
  v_exp_f32 v40, v40
  v_exp_f32 v41, v41
  v_exp_f32 v42, v42
  v_exp_f32 v43, v43
  v_exp_f32 v44, v44
  v_exp_f32 v45, v45
  v_exp_f32 v46, v46
  v_exp_f32 v47, v47
  v_exp_f32 v48, v48
  v_exp_f32 v49, v49
  v_exp_f32 v50, v50
  v_exp_f32 v51, v51
  v_exp_f32 v52, v52
  v_exp_f32 v53, v53
  v_exp_f32 v54, v54
  v_exp_f32 v55, v55
  s_nop 0
  v_cvt_pk_bf16_f32 v136, v24, v25
  v_cvt_pk_bf16_f32 v137, v26, v27
  v_cvt_pk_bf16_f32 v138, v28, v29
  v_cvt_pk_bf16_f32 v139, v30, v31
  v_cvt_pk_bf16_f32 v140, v32, v33
  v_cvt_pk_bf16_f32 v141, v34, v35
  v_cvt_pk_bf16_f32 v142, v36, v37
  v_cvt_pk_bf16_f32 v143, v38, v39
  v_cvt_pk_bf16_f32 v144, v40, v41
  v_cvt_pk_bf16_f32 v145, v42, v43
  v_cvt_pk_bf16_f32 v146, v44, v45
  v_cvt_pk_bf16_f32 v147, v46, v47
  v_cvt_pk_bf16_f32 v148, v48, v49
  v_cvt_pk_bf16_f32 v149, v50, v51
  v_cvt_pk_bf16_f32 v150, v52, v53
  v_cvt_pk_bf16_f32 v151, v54, v55
  s_nop 1
  v_mfma_f32_16x16x32_bf16 v[184:187], v[192:195], v[136:139], 0
  v_mfma_f32_16x16x32_bf16 v[184:187], v[192:195], v[140:143], v[184:187]
  v_mfma_f32_16x16x32_bf16 v[184:187], v[192:195], v[144:147], v[184:187]
  v_mfma_f32_16x16x32_bf16 v[184:187], v[192:195], v[148:151], v[184:187]
  s_nop 7
  s_branch FBR0
FB1:
  s_nop 7
  v_max3_f32 v22, v56, v57, v58
  v_max3_f32 v22, v22, v59, v60
  v_max3_f32 v22, v22, v61, v62
  v_max3_f32 v22, v22, v63, v64
  v_max3_f32 v22, v22, v65, v66
  v_max3_f32 v22, v22, v67, v68
  v_max3_f32 v22, v22, v69, v70
  v_max3_f32 v22, v22, v71, v72
  v_max3_f32 v22, v22, v73, v74
  v_max3_f32 v22, v22, v75, v76
  v_max3_f32 v22, v22, v77, v78
  v_max3_f32 v22, v22, v79, v80
  v_max3_f32 v22, v22, v81, v82
  v_max3_f32 v22, v22, v83, v84
  v_max3_f32 v22, v22, v85, v86
  s_mov_b32 s52, 0xff7fffff
  v_max3_f32 v22, v22, v87, s52
  v_mov_b32 v23, v22
  s_nop 1
  v_permlane32_swap_b32 v22, v23
  s_nop 1
  v_max_f32 v22, v22, v23
  v_mov_b32 v23, v22
  s_nop 1
  v_permlane16_swap_b32 v22, v23
  s_nop 1
  v_max_f32 v22, v22, v23
  v_sub_f32 v56, v56, v22
  v_sub_f32 v57, v57, v22
  v_sub_f32 v58, v58, v22
  v_sub_f32 v59, v59, v22
  v_sub_f32 v60, v60, v22
  v_sub_f32 v61, v61, v22
  v_sub_f32 v62, v62, v22
  v_sub_f32 v63, v63, v22
  v_sub_f32 v64, v64, v22
  v_sub_f32 v65, v65, v22
  v_sub_f32 v66, v66, v22
  v_sub_f32 v67, v67, v22
  v_sub_f32 v68, v68, v22
  v_sub_f32 v69, v69, v22
  v_sub_f32 v70, v70, v22
  v_sub_f32 v71, v71, v22
  v_sub_f32 v72, v72, v22
  v_sub_f32 v73, v73, v22
  v_sub_f32 v74, v74, v22
  v_sub_f32 v75, v75, v22
  v_sub_f32 v76, v76, v22
  v_sub_f32 v77, v77, v22
  v_sub_f32 v78, v78, v22
  v_sub_f32 v79, v79, v22
  v_sub_f32 v80, v80, v22
  v_sub_f32 v81, v81, v22
  v_sub_f32 v82, v82, v22
  v_sub_f32 v83, v83, v22
  v_sub_f32 v84, v84, v22
  v_sub_f32 v85, v85, v22
  v_sub_f32 v86, v86, v22
  v_sub_f32 v87, v87, v22
  v_exp_f32 v56, v56
  v_exp_f32 v57, v57
  v_exp_f32 v58, v58
  v_exp_f32 v59, v59
  v_exp_f32 v60, v60
  v_exp_f32 v61, v61
  v_exp_f32 v62, v62
  v_exp_f32 v63, v63
  v_exp_f32 v64, v64
  v_exp_f32 v65, v65
  v_exp_f32 v66, v66
  v_exp_f32 v67, v67
  v_exp_f32 v68, v68
  v_exp_f32 v69, v69
  v_exp_f32 v70, v70
  v_exp_f32 v71, v71
  v_exp_f32 v72, v72
  v_exp_f32 v73, v73
  v_exp_f32 v74, v74
  v_exp_f32 v75, v75
  v_exp_f32 v76, v76
  v_exp_f32 v77, v77
  v_exp_f32 v78, v78
  v_exp_f32 v79, v79
  v_exp_f32 v80, v80
  v_exp_f32 v81, v81
  v_exp_f32 v82, v82
  v_exp_f32 v83, v83
  v_exp_f32 v84, v84
  v_exp_f32 v85, v85
  v_exp_f32 v86, v86
  v_exp_f32 v87, v87
  s_nop 0
  v_cvt_pk_bf16_f32 v152, v56, v57
  v_cvt_pk_bf16_f32 v153, v58, v59
  v_cvt_pk_bf16_f32 v154, v60, v61
  v_cvt_pk_bf16_f32 v155, v62, v63
  v_cvt_pk_bf16_f32 v156, v64, v65
  v_cvt_pk_bf16_f32 v157, v66, v67
  v_cvt_pk_bf16_f32 v158, v68, v69
  v_cvt_pk_bf16_f32 v159, v70, v71
  v_cvt_pk_bf16_f32 v160, v72, v73
  v_cvt_pk_bf16_f32 v161, v74, v75
  v_cvt_pk_bf16_f32 v162, v76, v77
  v_cvt_pk_bf16_f32 v163, v78, v79
  v_cvt_pk_bf16_f32 v164, v80, v81
  v_cvt_pk_bf16_f32 v165, v82, v83
  v_cvt_pk_bf16_f32 v166, v84, v85
  v_cvt_pk_bf16_f32 v167, v86, v87
  s_nop 1
  v_mfma_f32_16x16x32_bf16 v[188:191], v[192:195], v[152:155], 0
  v_mfma_f32_16x16x32_bf16 v[188:191], v[192:195], v[156:159], v[188:191]
  v_mfma_f32_16x16x32_bf16 v[188:191], v[192:195], v[160:163], v[188:191]
  v_mfma_f32_16x16x32_bf16 v[188:191], v[192:195], v[164:167], v[188:191]
  s_nop 7
  s_branch FBR1
MK_end:
.section .rodata,"a"
.p2align 6
.amdhsa_kernel standalone__neighborhood_nat__vision_kernel
  .amdhsa_next_free_vgpr 256
  .amdhsa_next_free_sgpr 102
  .amdhsa_accum_offset 256
  .amdhsa_group_segment_fixed_size 0
  .amdhsa_kernarg_size 48
  .amdhsa_user_sgpr_count 2
  .amdhsa_user_sgpr_kernarg_segment_ptr 1
  .amdhsa_system_sgpr_workgroup_id_x 1
.end_amdhsa_kernel
```

```asm
; @launch grid=(256,1,1) block=(512,1,1) lds=163840
.amdgcn_target "amdgcn-amd-amdhsa--gfx950"
.text
.globl standalone__neighborhood_nat__vision_kernel
.p2align 8
.type standalone__neighborhood_nat__vision_kernel,@function
standalone__neighborhood_nat__vision_kernel:
  s_cmp_ge_u32 s2, 256
  s_cbranch_scc1 MK_done
  s_load_dwordx8 s[4:11], s[0:1], 0
  s_load_dwordx4 s[84:87], s[0:1], 32
  s_getpc_b64 s[12:13]
MK_pc:
  s_and_b32 s13, s13, 0xffff
  s_mov_b32 s14, MK_end-MK_pc
  s_mov_b32 s15, 0x00020000
  v_lshlrev_b32 v23, 7, v0
  buffer_load_dword v255, v23, s[12:15], 0 offen
  v_lshrrev_b32 v130, 6, v0
  v_and_b32 v0, 63, v0
  v_readfirstlane_b32 s24, v130
  v_and_b32 v128, 15, v0
  v_lshrrev_b32 v129, 4, v0
  v_lshrrev_b32 v130, 5, v0
  v_bfe_u32 v131, v0, 3, 2
  v_lshl_add_u32 v130, v130, 3, v131
  v_mul_u32_u24 v130, 1152, v130
  s_and_b32 s26, s24, 1
  s_lshl_b32 s46, s26, 2
  v_add_u32 v131, s46, v129
  v_and_b32 v132, 7, v0
  v_xor_b32 v131, v131, v132
  v_lshl_add_u32 v96, v131, 4, v130
  s_lshr_b32 s46, s24, 2
  s_lshl_b32 s46, s46, 5
  s_lshl_b32 s47, s26, 4
  s_add_u32 s46, s46, s47
  s_and_b32 s47, s24, 2
  s_lshl_b32 s47, s47, 1
  s_add_u32 s46, s46, s47
  s_mul_i32 s92, s46, 1152
  s_lshl_b32 s41, s24, 10
  s_cmp_lt_u32 s24, 4
  s_cselect_b64 vcc, -1, 0
  s_cbranch_vccz SL1
  s_waitcnt lgkmcnt(0)
  s_mov_b32 s88, s6
  s_and_b32 s89, s7, 0xffff
  s_mov_b32 s90, 221184
  s_mov_b32 s91, 0x00020000
  s_add_i32 m0, s41, 0
  s_add_i32 s100, s92, 0
  buffer_load_dwordx4 v96, s[88:91], s100 offen lds
  s_add_i32 m0, s41, 8192
  s_add_i32 s100, s92, 73728
  buffer_load_dwordx4 v96, s[88:91], s100 offen lds
  s_add_i32 m0, s41, 16384
  s_add_i32 s100, s92, 147456
  buffer_load_dwordx4 v96, s[88:91], s100 offen lds
  s_add_i32 m0, s41, 24576
  s_add_i32 s100, s92, 384
  buffer_load_dwordx4 v96, s[88:91], s100 offen lds
  s_add_i32 m0, s41, 32768
  s_add_i32 s100, s92, 74112
  buffer_load_dwordx4 v96, s[88:91], s100 offen lds
  s_add_i32 m0, s41, 40960
  s_add_i32 s100, s92, 147840
  buffer_load_dwordx4 v96, s[88:91], s100 offen lds
SL1:
  s_bfe_u32 s27, s2, 0x10002
  s_bfe_u32 s28, s2, 0x10001
  s_and_b32 s29, s2, 1
  s_lshl_b32 s29, s29, 2
  s_lshr_b32 s46, s2, 6
  s_add_u32 s29, s29, s46
  s_bfe_u32 s30, s2, 0x30003
  s_mul_i32 s37, s29, 14
  s_add_i32 s37, s37, -6
  s_max_i32 s29, s37, -4
  s_mul_i32 s30, s30, 14
  s_add_i32 s30, s30, -6
  s_lshr_b32 s25, s24, 1
  s_add_u32 s25, s25, 2
  s_and_b32 s25, s25, 3
  s_sub_u32 s56, 0, s27
  s_mul_i32 s57, s27, 224
  s_sub_u32 s58, 0, s28
  s_mul_i32 s59, s28, 224
  v_and_b32 v130, 7, v128
  s_mul_i32 s46, s26, 7
  s_add_i32 s46, s46, s30
  v_cmp_lt_u32 s[48:49], 6, v130
  v_add_u32 v130, s46, v130
  v_max_i32 v19, 0, v130
  v_add3_u32 v130, v130, v19, 6
  v_xor_b32 v130, s58, v130
  v_add_u32 v130, s59, v130
  v_subrev_u32 v19, s30, v19
  v_mul_u32_u24 v130, 384, v130
  v_lshl_add_u32 v130, v129, 4, v130
  s_lshl_b32 s46, s25, 2
  s_add_i32 s46, s46, -2
  s_mov_b32 s47, 86016
  v_lshrrev_b32 v131, 3, v128
  v_add_u32 v131, s46, v131
  v_mov_b32 v132, 0x80000000
  v_cmp_gt_i32 s[42:43], 0, v131
  v_add_u32 v5, s37, v131
  v_max_i32 v21, 0, v5
  v_add3_u32 v5, v5, v21, 6
  s_or_b64 s[42:43], s[42:43], s[48:49]
  v_xor_b32 v5, s56, v5
  v_add_u32 v5, s57, v5
  v_subrev_u32 v21, s29, v21
  v_mad_u32_u24 v5, v5, s47, v130
  v_cndmask_b32 v21, v21, v132, s[42:43]
  v_cndmask_b32 v5, v5, v132, s[42:43]
  v_add_u32 v131, 2, v131
  v_cmp_gt_i32 s[44:45], 0, v131
  v_add_u32 v6, s37, v131
  v_max_i32 v22, 0, v6
  v_add3_u32 v6, v6, v22, 6
  s_or_b64 s[44:45], s[44:45], s[48:49]
  v_xor_b32 v6, s56, v6
  v_add_u32 v6, s57, v6
  v_subrev_u32 v22, s29, v22
  v_mad_u32_u24 v6, v6, s47, v130
  v_cndmask_b32 v22, v22, v132, s[44:45]
  v_cndmask_b32 v6, v6, v132, s[44:45]
  s_waitcnt lgkmcnt(0)
  s_mov_b32 s88, s6
  s_and_b32 s89, s7, 0xffff
  s_mov_b32 s90, 221184
  s_mov_b32 s91, 0x00020000
  s_cmp_lg_u32 s24, 5
  s_cbranch_scc1 MK_ntlb
  s_max_i32 s46, s37, 0
  s_lshl_b32 s46, s46, 1
  s_sub_u32 s47, 184, s46
  s_cmp_eq_u32 s27, 0
  s_cselect_b32 s46, s46, s47
  s_mul_i32 s46, s46, 86016
  s_load_dword s94, s[4:5], s46
  s_load_dword s95, s[10:11], s46
  s_add_u32 s46, s46, 1720256
  s_load_dword s94, s[4:5], s46
  s_load_dword s95, s[10:11], s46
  s_add_u32 s46, s46, 1720256
  s_load_dword s94, s[4:5], s46
  s_load_dword s95, s[10:11], s46
  s_load_dword s94, s[84:85], 128
  s_load_dword s95, s[86:87], 0x20000
MK_ntlb:
  s_lshr_b32 s46, s24, 1
  s_cmp_lg_u32 s46, 2
  s_cbranch_scc1 MK_nwpf
  s_cmp_eq_u32 s24, 4
  s_cselect_b32 s46, 54, 18
  s_cselect_b32 s12, s6, s8
  s_cselect_b32 s13, s7, s9
  s_and_b32 s13, s13, 0xffff
  s_lshr_b32 s47, s2, 3
  s_mul_i32 s47, s47, s46
  s_lshl_b32 s100, s47, 7
  s_lshl_b32 s46, s46, 7
  s_add_u32 s14, s100, s46
  s_mov_b32 s15, 0x00020000
  v_lshlrev_b32 v23, 7, v0
  buffer_load_dword v254, v23, s[12:15], s100 offen
MK_nwpf:
  s_mov_b32 s12, s4
  s_and_b32 s13, s5, 0xffff
  s_mov_b32 s14, 19267584
  s_mov_b32 s15, 0x00020000
  s_movk_i32 s54, 112
  s_mov_b32 s16, s10
  s_and_b32 s17, s11, 0xffff
  s_mov_b32 s18, 19267584
  s_mov_b32 s19, 0x00020000
  s_mov_b32 s4, s8
  s_and_b32 s5, s9, 0xffff
  s_mov_b32 s6, 73728
  s_mov_b32 s7, 0x00020000
  s_mov_b32 s8, s84
  s_and_b32 s9, s85, 0xffff
  s_mov_b32 s10, 256
  s_mov_b32 s11, 0x00020000
  s_mov_b32 s20, s86
  s_and_b32 s21, s87, 0xffff
  s_mov_b32 s22, 73728
  s_mov_b32 s23, 0x00020000
  v_lshlrev_b32 v1, 4, v0
  v_add_u32 v2, 36864, v1
  s_and_b32 s40, s24, 3
  s_lshl_b32 s40, s40, 10
  v_bfe_u32 v130, v128, 1, 3
  v_xor_b32 v130, v130, v129
  v_lshlrev_b32 v131, 7, v128
  v_lshl_add_u32 v131, v130, 4, v131
  s_lshr_b32 s46, s24, 2
  s_mul_i32 s47, s46, 12288
  s_add_u32 s47, s47, 0
  v_add_u32 v97, s47, v131
  v_xor_b32 v98, 64, v97
  s_mul_i32 s47, s40, 6
  s_add_u32 s47, s47, 24576
  v_add_u32 v99, s47, v131
  v_xor_b32 v100, 64, v99
  v_mov_b32 v135, 0
  v_mov_b32 v134, 0
  s_lshr_b32 s46, s24, 2
  s_mul_i32 s46, s46, 3072
  s_mul_i32 s47, s40, 18
  s_add_u32 s46, s46, s47
  s_sub_u32 s46, 58368, s46
  v_add_u32 v101, s46, v1
  s_lshl_b32 s46, s29, 1
  s_xor_b32 s46, s46, s56
  s_mul_i32 s47, s27, 222
  s_add_i32 s31, s46, s47
  s_mul_i32 s31, s31, 86016
  s_mul_i32 s32, s27, -688128
  s_add_i32 s32, s32, 344064
  s_lshr_b32 s33, s29, 31
  s_lshl_b32 s33, s33, 1
  s_lshl_b32 s38, s40, 2
  s_add_u32 s39, s38, 3072
  s_min_u32 s39, s39, 14336
  s_mul_i32 s48, s27, 172032
  s_sub_u32 s49, 172032, s48
  v_mov_b32 v132, s48
  v_mov_b32 v133, s49
  s_lshr_b32 s46, s38, 4
  s_add_u32 s46, s46, 0
  v_add_u32 v130, s46, v0
  v_mul_u32_u24 v13, 2731, v130
  v_lshrrev_b32 v13, 16, v13
  v_cmp_le_u32 s[52:53], 20, v13
  v_mul_u32_u24 v131, 24, v13
  v_sub_u32 v130, v130, v131
  v_subrev_u32 v131, 20, v13
  v_cndmask_b32 v13, v13, v131, s[52:53]
  v_bfe_u32 v131, v13, 1, 3
  v_xor_b32 v130, v130, v131
  v_cndmask_b32 v131, v132, v133, s[52:53]
  v_lshl_add_u32 v130, v130, 4, v131
  v_add_u32 v13, s30, v13
  v_max_i32 v13, 0, v13
  s_cbranch_vccz SL2
  s_add_i32 m0, s41, 4096
  s_add_i32 s100, s92, 36864
  buffer_load_dwordx4 v96, s[88:91], s100 offen lds
  s_add_i32 m0, s41, 12288
  s_add_i32 s100, s92, 110592
  buffer_load_dwordx4 v96, s[88:91], s100 offen lds
  s_add_i32 m0, s41, 20480
  s_add_i32 s100, s92, 184320
  buffer_load_dwordx4 v96, s[88:91], s100 offen lds
  s_add_i32 m0, s41, 28672
  s_add_i32 s100, s92, 37248
  buffer_load_dwordx4 v96, s[88:91], s100 offen lds
  s_add_i32 m0, s41, 36864
  s_add_i32 s100, s92, 110976
  buffer_load_dwordx4 v96, s[88:91], s100 offen lds
  s_add_i32 m0, s41, 45056
  s_add_i32 s100, s92, 184704
  buffer_load_dwordx4 v96, s[88:91], s100 offen lds
SL2:
  v_lshlrev_b32 v13, 1, v13
  v_xor_b32 v13, s58, v13
  v_add_u32 v13, s59, v13
  v_mul_u32_u24 v13, 384, v13
  v_add_u32 v13, v13, v130
  s_lshr_b32 s46, s38, 4
  s_add_u32 s46, s46, 64
  v_add_u32 v130, s46, v0
  v_mul_u32_u24 v14, 2731, v130
  v_lshrrev_b32 v14, 16, v14
  v_cmp_le_u32 s[52:53], 20, v14
  v_mul_u32_u24 v131, 24, v14
  v_sub_u32 v130, v130, v131
  v_subrev_u32 v131, 20, v14
  v_cndmask_b32 v14, v14, v131, s[52:53]
  v_bfe_u32 v131, v14, 1, 3
  v_xor_b32 v130, v130, v131
  v_cndmask_b32 v131, v132, v133, s[52:53]
  v_lshl_add_u32 v130, v130, 4, v131
  v_add_u32 v14, s30, v14
  v_max_i32 v14, 0, v14
  v_lshlrev_b32 v14, 1, v14
  v_xor_b32 v14, s58, v14
  v_add_u32 v14, s59, v14
  v_mul_u32_u24 v14, 384, v14
  v_add_u32 v14, v14, v130
  s_lshr_b32 s46, s38, 4
  s_add_u32 s46, s46, 128
  v_add_u32 v130, s46, v0
  v_mul_u32_u24 v3, 2731, v130
  v_lshrrev_b32 v3, 16, v3
  v_cmp_le_u32 s[52:53], 20, v3
  v_mul_u32_u24 v131, 24, v3
  v_sub_u32 v130, v130, v131
  v_subrev_u32 v131, 20, v3
  v_cndmask_b32 v3, v3, v131, s[52:53]
  v_bfe_u32 v131, v3, 1, 3
  v_xor_b32 v130, v130, v131
  v_cndmask_b32 v131, v132, v133, s[52:53]
  v_lshl_add_u32 v130, v130, 4, v131
  v_add_u32 v3, s30, v3
  v_max_i32 v3, 0, v3
  v_lshlrev_b32 v3, 1, v3
  v_xor_b32 v3, s58, v3
  v_add_u32 v3, s59, v3
  v_mul_u32_u24 v3, 384, v3
  v_add_u32 v3, v3, v130
  s_lshr_b32 s46, s39, 4
  v_add_u32 v130, s46, v0
  v_mul_u32_u24 v4, 2731, v130
  v_lshrrev_b32 v4, 16, v4
  v_cmp_le_u32 s[52:53], 20, v4
  v_mul_u32_u24 v131, 24, v4
  v_sub_u32 v130, v130, v131
  v_subrev_u32 v131, 20, v4
  v_cndmask_b32 v4, v4, v131, s[52:53]
  v_bfe_u32 v131, v4, 1, 3
  v_xor_b32 v130, v130, v131
  v_cndmask_b32 v131, v132, v133, s[52:53]
  v_lshl_add_u32 v130, v130, 4, v131
  v_add_u32 v4, s30, v4
  v_max_i32 v4, 0, v4
  v_lshlrev_b32 v4, 1, v4
  v_xor_b32 v4, s58, v4
  v_add_u32 v4, s59, v4
  v_mul_u32_u24 v4, 384, v4
  v_add_u32 v4, v4, v130
  s_add_u32 s38, s38, 10240
  s_add_u32 s39, s39, 10240
  s_lshl_b32 s46, s25, 2
  s_add_i32 s46, s46, -2
  s_max_i32 s46, s46, 0
  s_add_i32 s46, s46, s37
  s_max_i32 s46, s46, 0
  s_sub_i32 s46, s46, s29
  s_lshl_b32 s34, s25, 2
  s_add_i32 s34, s34, s37
  s_max_i32 s34, s34, 0
  s_sub_i32 s34, s34, s29
  s_sub_u32 s46, s34, s46
  s_lshr_b32 s46, s46, 1
  s_mul_i32 s36, s46, -8
  s_add_i32 s36, s36, 7
  s_add_i32 s34, s34, -1
  s_add_i32 s35, s34, s36
  s_mul_i32 s36, s36, 7680
  s_lshl_b32 s47, s26, 2
  s_mul_i32 s46, s34, 7680
  s_add_i32 s46, s46, 10240
  v_add_u32 v130, s47, v128
  v_bfe_u32 v131, v130, 1, 3
  v_xor_b32 v131, v131, v129
  v_mul_u32_u24 v130, 384, v130
  v_lshl_add_u32 v130, v131, 4, v130
  v_add_u32 v7, s46, v130
  v_xor_b32 v8, 64, v7
  v_lshrrev_b32 v130, 2, v128
  v_lshl_add_u32 v130, v129, 2, v130
  v_add_u32 v130, s47, v130
  v_bfe_u32 v131, v130, 1, 3
  v_and_b32 v132, 2, v128
  v_lshlrev_b32 v132, 1, v132
  v_xor_b32 v131, v131, v132
  v_mul_u32_u24 v130, 384, v130
  v_lshl_add_u32 v130, v131, 4, v130
  v_and_b32 v131, 1, v128
  v_lshl_add_u32 v130, v131, 3, v130
  v_add_u32 v9, s46, v130
  v_xor_b32 v10, 16, v9
  v_xor_b32 v11, 32, v9
  v_xor_b32 v12, 48, v9
  v_lshl_add_u32 v130, v129, 2, s47
  v_sub_u32 v19, v130, v19
  v_cndmask_b32 v19, v19, 64, s[44:45]
  v_add_u32 v20, s36, v7
  v_add_u32 v0, s36, v8
  v_add_u32 v15, s36, v9
  v_add_u32 v16, s36, v10
  v_add_u32 v17, s36, v11
  v_add_u32 v18, s36, v12
  s_mov_b32 s93, 1037384597
  s_cbranch_vccnz SL3
  s_add_i32 m0, s41, 49152
  s_add_i32 s100, s92, 128
  buffer_load_dwordx4 v96, s[88:91], s100 offen lds
  s_add_i32 m0, s41, 57344
  s_add_i32 s100, s92, 73856
  buffer_load_dwordx4 v96, s[88:91], s100 offen lds
  s_add_i32 m0, s41, 65536
  s_add_i32 s100, s92, 147584
  buffer_load_dwordx4 v96, s[88:91], s100 offen lds
  s_add_i32 m0, s41, 73728
  s_add_i32 s100, s92, 512
  buffer_load_dwordx4 v96, s[88:91], s100 offen lds
  s_add_i32 m0, s41, 81920
  s_add_i32 s100, s92, 74240
  buffer_load_dwordx4 v96, s[88:91], s100 offen lds
  s_add_i32 m0, s41, 90112
  s_add_i32 s100, s92, 147968
  buffer_load_dwordx4 v96, s[88:91], s100 offen lds
  s_add_i32 m0, s41, 45056
  s_add_i32 s100, s92, -36736
  buffer_load_dwordx4 v96, s[88:91], s100 offen lds
  s_add_i32 m0, s41, 53248
  s_add_i32 s100, s92, 36992
  buffer_load_dwordx4 v96, s[88:91], s100 offen lds
  s_add_i32 m0, s41, 61440
  s_add_i32 s100, s92, 110720
  buffer_load_dwordx4 v96, s[88:91], s100 offen lds
  s_add_i32 m0, s41, 69632
  s_add_i32 s100, s92, -36352
  buffer_load_dwordx4 v96, s[88:91], s100 offen lds
  s_add_i32 m0, s41, 77824
  s_add_i32 s100, s92, 37376
  buffer_load_dwordx4 v96, s[88:91], s100 offen lds
  s_add_i32 m0, s41, 86016
  s_add_i32 s100, s92, 111104
  buffer_load_dwordx4 v96, s[88:91], s100 offen lds
SL3:
  s_cbranch_vccz SL4
  s_waitcnt vmcnt(0)
  s_branch SM4
SL4:
  s_waitcnt vmcnt(12)
SM4:
  s_barrier
  ds_read_b128 v[208:211], v99 offset:0
  ds_read_b128 v[212:215], v99 offset:2048
  ds_read_b128 v[216:219], v99 offset:4096
  ds_read_b128 v[184:187], v97 offset:0
  ds_read_b128 v[188:191], v97 offset:2048
  ds_read_b128 v[192:195], v97 offset:4096
  ds_read_b128 v[196:199], v97 offset:6144
  ds_read_b128 v[200:203], v97 offset:8192
  ds_read_b128 v[204:207], v97 offset:10240
  s_waitcnt lgkmcnt(5)
  v_mfma_f32_16x16x32_bf16 v[24:27], v[184:187], v[208:211], 0
  s_cbranch_vccz SL5
  s_add_i32 m0, s41, 98304
  s_add_i32 s100, s92, 256
  buffer_load_dwordx4 v96, s[88:91], s100 offen lds
SL5:
  v_mfma_f32_16x16x32_bf16 v[28:31], v[184:187], v[212:215], 0
  s_cbranch_vccz SL6
  s_add_i32 m0, s41, 106496
  s_add_i32 s100, s92, 73984
  buffer_load_dwordx4 v96, s[88:91], s100 offen lds
SL6:
  v_mfma_f32_16x16x32_bf16 v[32:35], v[184:187], v[216:219], 0
  s_waitcnt lgkmcnt(4)
  v_mfma_f32_16x16x32_bf16 v[36:39], v[188:191], v[208:211], 0
  ds_read_b128 v[244:247], v100 offset:0
  s_cbranch_vccz SL7
  s_add_i32 m0, s41, 114688
  s_add_i32 s100, s92, 147712
  buffer_load_dwordx4 v96, s[88:91], s100 offen lds
SL7:
  v_mfma_f32_16x16x32_bf16 v[40:43], v[188:191], v[212:215], 0
  ds_read_b128 v[248:251], v100 offset:2048
  s_cbranch_vccz SL8
  s_add_i32 m0, s41, 122880
  s_add_i32 s100, s92, 640
  buffer_load_dwordx4 v96, s[88:91], s100 offen lds
SL8:
  v_mfma_f32_16x16x32_bf16 v[44:47], v[188:191], v[216:219], 0
  s_waitcnt lgkmcnt(5)
  v_mfma_f32_16x16x32_bf16 v[48:51], v[192:195], v[208:211], 0
  ds_read_b128 v[252:255], v100 offset:4096
  s_cbranch_vccz SL9
  s_add_i32 m0, s41, 131072
  s_add_i32 s100, s92, 74368
  buffer_load_dwordx4 v96, s[88:91], s100 offen lds
SL9:
  v_mfma_f32_16x16x32_bf16 v[52:55], v[192:195], v[212:215], 0
  ds_read_b128 v[220:223], v98 offset:0
  s_cbranch_vccz SL10
  s_add_i32 m0, s41, 139264
  s_add_i32 s100, s92, 148096
  buffer_load_dwordx4 v96, s[88:91], s100 offen lds
SL10:
  v_mfma_f32_16x16x32_bf16 v[56:59], v[192:195], v[216:219], 0
  s_waitcnt lgkmcnt(6)
  v_mfma_f32_16x16x32_bf16 v[60:63], v[196:199], v[208:211], 0
  ds_read_b128 v[224:227], v98 offset:2048
  s_cbranch_vccz SL11
  s_add_i32 m0, s41, 102400
  s_add_i32 s100, s92, 37120
  buffer_load_dwordx4 v96, s[88:91], s100 offen lds
SL11:
  v_mfma_f32_16x16x32_bf16 v[64:67], v[196:199], v[212:215], 0
  ds_read_b128 v[228:231], v98 offset:4096
  s_cbranch_vccz SL12
  s_add_i32 m0, s41, 110592
  s_add_i32 s100, s92, 110848
  buffer_load_dwordx4 v96, s[88:91], s100 offen lds
SL12:
  v_mfma_f32_16x16x32_bf16 v[68:71], v[196:199], v[216:219], 0
  s_waitcnt lgkmcnt(7)
  v_mfma_f32_16x16x32_bf16 v[72:75], v[200:203], v[208:211], 0
  ds_read_b128 v[232:235], v98 offset:6144
  s_cbranch_vccz SL13
  s_add_i32 m0, s41, 118784
  s_add_i32 s100, s92, 184576
  buffer_load_dwordx4 v96, s[88:91], s100 offen lds
SL13:
  v_mfma_f32_16x16x32_bf16 v[76:79], v[200:203], v[212:215], 0
  ds_read_b128 v[236:239], v98 offset:8192
  s_cbranch_vccz SL14
  s_add_i32 m0, s41, 126976
  s_add_i32 s100, s92, 37504
  buffer_load_dwordx4 v96, s[88:91], s100 offen lds
SL14:
  v_mfma_f32_16x16x32_bf16 v[80:83], v[200:203], v[216:219], 0
  s_waitcnt lgkmcnt(8)
  v_mfma_f32_16x16x32_bf16 v[84:87], v[204:207], v[208:211], 0
  ds_read_b128 v[240:243], v98 offset:10240
  s_cbranch_vccz SL15
  s_add_i32 m0, s41, 135168
  s_add_i32 s100, s92, 111232
  buffer_load_dwordx4 v96, s[88:91], s100 offen lds
SL15:
  v_mfma_f32_16x16x32_bf16 v[88:91], v[204:207], v[212:215], 0
  s_cbranch_vccz SL16
  s_add_i32 m0, s41, 143360
  s_add_i32 s100, s92, 184960
  buffer_load_dwordx4 v96, s[88:91], s100 offen lds
SL16:
  v_mfma_f32_16x16x32_bf16 v[92:95], v[204:207], v[216:219], 0
  v_lshrrev_b32 v107, 4, v1
  s_cmp_lt_u32 s2, 72
  s_cbranch_scc0 MK_np1
  s_mul_hi_u32 s54, s2, 0x15555556
  s_lshl_b32 s54, s54, 6
  s_mul_i32 s55, s24, 6144
  s_add_u32 s100, s54, s55
  v_lshrrev_b32 v104, 2, v107
  v_mul_u32_u24 v104, 384, v104
  v_and_b32 v105, 3, v107
  v_lshl_add_u32 v104, v105, 4, v104
  s_add_u32 m0, s41, 147456
  s_nop 0
  buffer_load_dwordx4 v104, s[4:7], s100 offen lds
  s_mul_i32 s55, s40, 6
  s_add_u32 s100, s54, s55
  s_add_u32 m0, s40, 155648
  s_add_u32 s100, s100, 49152
  buffer_load_dwordx4 v104, s[4:7], s100 offen lds
MK_np1:
  s_sub_u32 s3, s2, 72
  s_lshr_b32 s3, s3, 31
  s_lshr_b32 s3, s3, s25
  s_cmp_eq_u32 s3, 0
  s_cbranch_scc1 MK_np3
  s_mul_hi_u32 s54, s2, 0x15555556
  s_mul_i32 s55, s54, 12
  s_sub_u32 s55, s2, s55
  s_cmp_ge_u32 s55, 6
  s_cselect_b32 s51, 1, 0
  s_mul_i32 s100, s51, 6
  s_sub_u32 s55, s55, s100
  v_lshrrev_b32 v106, 2, v128
  v_and_b32 v105, 3, v128
  v_lshl_add_u32 v134, v129, 3, v106
  v_lshlrev_b32 v134, 6, v134
  v_lshl_add_u32 v134, v105, 4, v134
  s_lshl_b32 s51, s51, 3
  s_add_u32 s51, s51, 147456
  v_add_u32 v134, s51, v134
  s_lshr_b32 s54, s55, 1
  s_lshl_b32 s54, s54, 6
  s_and_b32 s55, s55, 1
  s_lshl_b32 s55, s55, 4
  s_add_u32 s54, s54, s55
  v_lshrrev_b32 v104, 1, v106
  v_lshlrev_b32 v104, 5, v104
  v_and_b32 v106, 1, v106
  v_lshl_add_u32 v104, v106, 2, v104
  v_add3_u32 v104, v104, v105, s54
  v_mul_u32_u24 v104, 1152, v104
  v_lshl_add_u32 v135, v129, 4, v104
  s_mul_i32 s100, s26, 9216
  buffer_load_dwordx4 v[136:139], v135, s[88:91], s100 offen offset:768
  buffer_load_dwordx4 v[140:143], v135, s[88:91], s100 offen offset:832
  buffer_load_dwordx4 v[144:147], v135, s[88:91], s100 offen offset:896
  buffer_load_dwordx4 v[148:151], v135, s[88:91], s100 offen offset:960
  buffer_load_dwordx4 v[152:155], v135, s[88:91], s100 offen offset:1024
  buffer_load_dwordx4 v[156:159], v135, s[88:91], s100 offen offset:1088
MK_np3:
  s_cbranch_vccz SL18
  s_waitcnt vmcnt(63) lgkmcnt(0)
  s_branch SM18
SL18:
  s_cmp_lg_u32 s3, 0
  s_cbranch_scc1 CA17
  s_cmp_lt_u32 s2, 72
  s_cbranch_scc1 CB17
  s_waitcnt vmcnt(0)
CB17:
  s_waitcnt vmcnt(2)
CA17:
  s_waitcnt vmcnt(8) lgkmcnt(0)
SM18:
  s_barrier
  v_add_u32 v97, 49152, v97
  v_add_u32 v98, 49152, v98
  v_add_u32 v99, 49152, v99
  v_add_u32 v100, 49152, v100
  v_mfma_f32_16x16x32_bf16 v[24:27], v[220:223], v[244:247], v[24:27]
  ds_read_b128 v[208:211], v99 offset:0
  s_cbranch_vccnz SL19
  buffer_load_dwordx4 v[160:163], v6, s[12:15], 0 offen offset:0
SL19:
  v_mfma_f32_16x16x32_bf16 v[28:31], v[220:223], v[248:251], v[28:31]
  ds_read_b128 v[212:215], v99 offset:2048
  v_mfma_f32_16x16x32_bf16 v[32:35], v[220:223], v[252:255], v[32:35]
  v_mfma_f32_16x16x32_bf16 v[36:39], v[224:227], v[244:247], v[36:39]
  ds_read_b128 v[216:219], v99 offset:4096
  s_cbranch_vccnz SL20
  buffer_load_dwordx4 v[164:167], v6, s[12:15], 0 offen offset:64
SL20:
  v_mfma_f32_16x16x32_bf16 v[40:43], v[224:227], v[248:251], v[40:43]
  ds_read_b128 v[184:187], v97 offset:0
  v_mfma_f32_16x16x32_bf16 v[44:47], v[224:227], v[252:255], v[44:47]
  v_mfma_f32_16x16x32_bf16 v[48:51], v[228:231], v[244:247], v[48:51]
  ds_read_b128 v[188:191], v97 offset:2048
  s_cbranch_vccnz SL21
  buffer_load_dwordx4 v[168:171], v6, s[12:15], 0 offen offset:128
SL21:
  v_mfma_f32_16x16x32_bf16 v[52:55], v[228:231], v[248:251], v[52:55]
  ds_read_b128 v[192:195], v97 offset:4096
  v_mfma_f32_16x16x32_bf16 v[56:59], v[228:231], v[252:255], v[56:59]
  v_mfma_f32_16x16x32_bf16 v[60:63], v[232:235], v[244:247], v[60:63]
  ds_read_b128 v[196:199], v97 offset:6144
  s_cbranch_vccnz SL22
  buffer_load_dwordx4 v[172:175], v6, s[12:15], 0 offen offset:192
SL22:
  v_mfma_f32_16x16x32_bf16 v[64:67], v[232:235], v[248:251], v[64:67]
  ds_read_b128 v[200:203], v97 offset:8192
  v_mfma_f32_16x16x32_bf16 v[68:71], v[232:235], v[252:255], v[68:71]
  v_mfma_f32_16x16x32_bf16 v[72:75], v[236:239], v[244:247], v[72:75]
  ds_read_b128 v[204:207], v97 offset:10240
  s_cbranch_vccnz SL23
  buffer_load_dwordx4 v[176:179], v6, s[12:15], 0 offen offset:256
SL23:
  v_mfma_f32_16x16x32_bf16 v[76:79], v[236:239], v[248:251], v[76:79]
  v_mfma_f32_16x16x32_bf16 v[80:83], v[236:239], v[252:255], v[80:83]
  v_mfma_f32_16x16x32_bf16 v[84:87], v[240:243], v[244:247], v[84:87]
  s_cbranch_vccnz SL24
  buffer_load_dwordx4 v[180:183], v6, s[12:15], 0 offen offset:320
SL24:
  v_mfma_f32_16x16x32_bf16 v[88:91], v[240:243], v[248:251], v[88:91]
  v_mfma_f32_16x16x32_bf16 v[92:95], v[240:243], v[252:255], v[92:95]
  s_waitcnt lgkmcnt(5)
  v_mfma_f32_16x16x32_bf16 v[24:27], v[184:187], v[208:211], v[24:27]
  s_cbranch_vccnz SL25
  s_cmp_eq_u32 s25, 0
  s_cbranch_scc1 QB6
  buffer_load_dwordx4 v[136:139], v5, s[12:15], 0 offen offset:0
QB6:
SL25:
  v_mfma_f32_16x16x32_bf16 v[28:31], v[184:187], v[212:215], v[28:31]
  v_mfma_f32_16x16x32_bf16 v[32:35], v[184:187], v[216:219], v[32:35]
  s_waitcnt lgkmcnt(4)
  v_mfma_f32_16x16x32_bf16 v[36:39], v[188:191], v[208:211], v[36:39]
  ds_read_b128 v[244:247], v100 offset:0
  s_cbranch_vccnz SL26
  s_cmp_eq_u32 s25, 0
  s_cbranch_scc1 QB7
  buffer_load_dwordx4 v[140:143], v5, s[12:15], 0 offen offset:64
QB7:
SL26:
  v_mfma_f32_16x16x32_bf16 v[40:43], v[188:191], v[212:215], v[40:43]
  ds_read_b128 v[248:251], v100 offset:2048
  v_mfma_f32_16x16x32_bf16 v[44:47], v[188:191], v[216:219], v[44:47]
  s_waitcnt lgkmcnt(5)
  v_mfma_f32_16x16x32_bf16 v[48:51], v[192:195], v[208:211], v[48:51]
  ds_read_b128 v[252:255], v100 offset:4096
  s_cbranch_vccnz SL27
  s_cmp_eq_u32 s25, 0
  s_cbranch_scc1 QB8
  buffer_load_dwordx4 v[144:147], v5, s[12:15], 0 offen offset:128
QB8:
SL27:
  v_mfma_f32_16x16x32_bf16 v[52:55], v[192:195], v[212:215], v[52:55]
  ds_read_b128 v[220:223], v98 offset:0
  v_mfma_f32_16x16x32_bf16 v[56:59], v[192:195], v[216:219], v[56:59]
  s_waitcnt lgkmcnt(6)
  v_mfma_f32_16x16x32_bf16 v[60:63], v[196:199], v[208:211], v[60:63]
  ds_read_b128 v[224:227], v98 offset:2048
  s_cbranch_vccnz SL28
  s_cmp_eq_u32 s25, 0
  s_cbranch_scc1 QB9
  buffer_load_dwordx4 v[148:151], v5, s[12:15], 0 offen offset:192
QB9:
SL28:
  v_mfma_f32_16x16x32_bf16 v[64:67], v[196:199], v[212:215], v[64:67]
  ds_read_b128 v[228:231], v98 offset:4096
  v_mfma_f32_16x16x32_bf16 v[68:71], v[196:199], v[216:219], v[68:71]
  s_waitcnt lgkmcnt(7)
  v_mfma_f32_16x16x32_bf16 v[72:75], v[200:203], v[208:211], v[72:75]
  ds_read_b128 v[232:235], v98 offset:6144
  s_cbranch_vccnz SL29
  s_cmp_eq_u32 s25, 0
  s_cbranch_scc1 QB10
  buffer_load_dwordx4 v[152:155], v5, s[12:15], 0 offen offset:256
QB10:
SL29:
  v_mfma_f32_16x16x32_bf16 v[76:79], v[200:203], v[212:215], v[76:79]
  ds_read_b128 v[236:239], v98 offset:8192
  v_mfma_f32_16x16x32_bf16 v[80:83], v[200:203], v[216:219], v[80:83]
  s_waitcnt lgkmcnt(8)
  v_mfma_f32_16x16x32_bf16 v[84:87], v[204:207], v[208:211], v[84:87]
  ds_read_b128 v[240:243], v98 offset:10240
  s_cbranch_vccnz SL30
  s_cmp_eq_u32 s25, 0
  s_cbranch_scc1 QB11
  buffer_load_dwordx4 v[156:159], v5, s[12:15], 0 offen offset:320
QB11:
SL30:
  v_mfma_f32_16x16x32_bf16 v[88:91], v[204:207], v[212:215], v[88:91]
  v_mfma_f32_16x16x32_bf16 v[92:95], v[204:207], v[216:219], v[92:95]
  s_cbranch_vccz SL31
  v_lshrrev_b32 v133, 4, v1
  v_lshrrev_b32 v130, 3, v133
  s_mul_i32 s50, s26, 7
  s_add_i32 s50, s50, s30
  v_cmp_lt_u32 s[52:53], 6, v130
  v_add_u32 v130, s50, v130
  v_max_i32 v131, 0, v130
  v_add3_u32 v130, v130, v131, 6
  v_xor_b32 v130, s58, v130
  v_add_u32 v130, s59, v130
  v_mul_u32_u24 v130, 384, v130
  v_and_b32 v131, 7, v133
  v_xor_b32 v131, v131, v129
  v_lshl_add_u32 v130, v131, 4, v130
  v_mov_b32 v131, 0x80000000
  v_cndmask_b32 v134, v130, v131, s[52:53]
  v_xor_b32 v135, 64, v134
  s_lshl_b32 s46, s25, 2
  s_add_i32 s46, s46, s37
  s_lshl_b32 s84, s46, 1
  s_add_i32 s84, s84, 2
  s_xor_b32 s84, s84, s56
  s_add_i32 s84, s84, s57
  s_mul_i32 s84, s84, 86016
  s_lshl_b32 s85, s46, 1
  s_add_i32 s85, s85, 4
  s_xor_b32 s85, s85, s56
  s_add_i32 s85, s85, s57
  s_mul_i32 s85, s85, 86016
  s_lshl_b32 s86, s46, 1
  s_add_i32 s86, s86, 6
  s_xor_b32 s86, s86, s56
  s_add_i32 s86, s86, s57
  s_mul_i32 s86, s86, 86016
  s_lshl_b32 s87, s46, 1
  s_add_i32 s87, s87, 8
  s_xor_b32 s87, s87, s56
  s_add_i32 s87, s87, s57
  s_mul_i32 s87, s87, 86016
  s_mul_i32 s101, s40, 6
  s_add_u32 s101, s101, 73728
  v_bfe_u32 v130, v128, 1, 3
  v_xor_b32 v130, v130, v129
  v_lshlrev_b32 v131, 7, v128
  v_lshl_add_u32 v131, v130, 4, v131
  v_lshrrev_b32 v130, 3, v128
  v_lshl_add_u32 v130, v130, 11, v131
  v_add_u32 v23, s101, v130
SL31:
  s_cbranch_vccz SL32
  s_waitcnt vmcnt(0) lgkmcnt(0)
  s_branch SM32
SL32:
  s_cmp_lg_u32 s25, 0
  s_cbranch_scc1 MK_c2
  s_waitcnt vmcnt(6)
MK_c2:
  s_waitcnt vmcnt(12) lgkmcnt(0)
SM32:
  s_barrier
  v_add_u32 v97, 49152, v97
  v_add_u32 v98, 49152, v98
  v_add_u32 v99, 49152, v99
  v_add_u32 v100, 49152, v100
  v_mfma_f32_16x16x32_bf16 v[24:27], v[220:223], v[244:247], v[24:27]
  ds_read_b128 v[208:211], v99 offset:0
  v_mfma_f32_16x16x32_bf16 v[28:31], v[220:223], v[248:251], v[28:31]
  ds_read_b128 v[212:215], v99 offset:2048
  v_mfma_f32_16x16x32_bf16 v[32:35], v[220:223], v[252:255], v[32:35]
  v_mfma_f32_16x16x32_bf16 v[36:39], v[224:227], v[244:247], v[36:39]
  ds_read_b128 v[216:219], v99 offset:4096
  v_mfma_f32_16x16x32_bf16 v[40:43], v[224:227], v[248:251], v[40:43]
  ds_read_b128 v[184:187], v97 offset:0
  v_mfma_f32_16x16x32_bf16 v[44:47], v[224:227], v[252:255], v[44:47]
  v_mfma_f32_16x16x32_bf16 v[48:51], v[228:231], v[244:247], v[48:51]
  ds_read_b128 v[188:191], v97 offset:2048
  v_mfma_f32_16x16x32_bf16 v[52:55], v[228:231], v[248:251], v[52:55]
  ds_read_b128 v[192:195], v97 offset:4096
  v_mfma_f32_16x16x32_bf16 v[56:59], v[228:231], v[252:255], v[56:59]
  v_mfma_f32_16x16x32_bf16 v[60:63], v[232:235], v[244:247], v[60:63]
  ds_read_b128 v[196:199], v97 offset:6144
  v_mfma_f32_16x16x32_bf16 v[64:67], v[232:235], v[248:251], v[64:67]
  ds_read_b128 v[200:203], v97 offset:8192
  v_mfma_f32_16x16x32_bf16 v[68:71], v[232:235], v[252:255], v[68:71]
  v_mfma_f32_16x16x32_bf16 v[72:75], v[236:239], v[244:247], v[72:75]
  ds_read_b128 v[204:207], v97 offset:10240
  v_mfma_f32_16x16x32_bf16 v[76:79], v[236:239], v[248:251], v[76:79]
  v_mfma_f32_16x16x32_bf16 v[80:83], v[236:239], v[252:255], v[80:83]
  v_mfma_f32_16x16x32_bf16 v[84:87], v[240:243], v[244:247], v[84:87]
  v_mfma_f32_16x16x32_bf16 v[88:91], v[240:243], v[248:251], v[88:91]
  v_mfma_f32_16x16x32_bf16 v[92:95], v[240:243], v[252:255], v[92:95]
  s_cmp_eq_u32 s3, 0
  s_cbranch_scc1 MK_np2
  s_waitcnt lgkmcnt(0)
  ds_read_b64_tr_b16 v[104:105], v134 offset:0
  ds_read_b64_tr_b16 v[106:107], v134 offset:256
  ds_read_b64_tr_b16 v[108:109], v134 offset:2048
  ds_read_b64_tr_b16 v[110:111], v134 offset:2304
  ds_read_b64_tr_b16 v[112:113], v134 offset:4096
  ds_read_b64_tr_b16 v[114:115], v134 offset:4352
  ds_read_b64_tr_b16 v[116:117], v134 offset:6144
  ds_read_b64_tr_b16 v[118:119], v134 offset:6400
  ds_read_b64_tr_b16 v[120:121], v134 offset:8192
  ds_read_b64_tr_b16 v[122:123], v134 offset:8448
  ds_read_b64_tr_b16 v[124:125], v134 offset:10240
  ds_read_b64_tr_b16 v[126:127], v134 offset:10496
  s_setprio 3
  s_waitcnt lgkmcnt(0)
  v_mfma_f32_16x16x32_bf16 v[128:131], v[136:139], v[104:107], 0
  v_mfma_f32_16x16x32_bf16 v[128:131], v[140:143], v[108:111], v[128:131]
  v_mfma_f32_16x16x32_bf16 v[128:131], v[144:147], v[112:115], v[128:131]
  v_mfma_f32_16x16x32_bf16 v[128:131], v[148:151], v[116:119], v[128:131]
  v_mfma_f32_16x16x32_bf16 v[128:131], v[152:155], v[120:123], v[128:131]
  v_mfma_f32_16x16x32_bf16 v[128:131], v[156:159], v[124:127], v[128:131]
  s_lshl_b32 s100, s2, 10
  s_lshl_b32 s54, s26, 3
  s_add_u32 s100, s100, s54
  s_nop 5
  v_cvt_pk_bf16_f32 v132, v128, v129
  v_cvt_pk_bf16_f32 v133, v130, v131
  buffer_store_dwordx2 v[132:133], v1, s[20:23], s100 offen sc1
  s_setprio 0
MK_np2:
  ds_read_b128 v[244:247], v100 offset:0
  ds_read_b128 v[248:251], v100 offset:2048
  ds_read_b128 v[252:255], v100 offset:4096
  ds_read_b128 v[220:223], v98 offset:0
  ds_read_b128 v[224:227], v98 offset:2048
  s_waitcnt lgkmcnt(5)
  v_mfma_f32_16x16x32_bf16 v[24:27], v[184:187], v[208:211], v[24:27]
  ds_read_b128 v[228:231], v98 offset:4096
  s_cbranch_vccz SL33
  s_add_u32 m0, s101, 0
  s_nop 0
  buffer_load_dwordx4 v134, s[12:15], s86 offen offset:0 lds
SL33:
  v_mfma_f32_16x16x32_bf16 v[36:39], v[188:191], v[208:211], v[36:39]
  ds_read_b128 v[232:235], v98 offset:6144
  s_waitcnt lgkmcnt(2)
  v_mfma_f32_16x16x32_bf16 v[24:27], v[220:223], v[244:247], v[24:27]
  ds_read_b128 v[236:239], v98 offset:8192
  v_mfma_f32_16x16x32_bf16 v[36:39], v[224:227], v[244:247], v[36:39]
  ds_read_b128 v[240:243], v98 offset:10240
  v_mfma_f32_16x16x32_bf16 v[28:31], v[184:187], v[212:215], v[28:31]
  v_mfma_f32_16x16x32_bf16 v[40:43], v[188:191], v[212:215], v[40:43]
  v_mfma_f32_16x16x32_bf16 v[28:31], v[220:223], v[248:251], v[28:31]
  s_cbranch_vccz SL34
  s_add_u32 m0, s101, 896
  s_nop 0
  buffer_load_dwordx4 v134, s[12:15], s86 offen offset:128 lds
SL34:
  v_mfma_f32_16x16x32_bf16 v[40:43], v[224:227], v[248:251], v[40:43]
  s_waitcnt lgkmcnt(0)
  v_mfma_f32_16x16x32_bf16 v[32:35], v[184:187], v[216:219], v[32:35]
  v_cvt_pk_bf16_f32 v104, v24, v25
  v_cvt_pk_bf16_f32 v105, v26, v27
  v_mfma_f32_16x16x32_bf16 v[44:47], v[188:191], v[216:219], v[44:47]
  v_cvt_pk_bf16_f32 v106, v36, v37
  v_cvt_pk_bf16_f32 v107, v38, v39
  v_mfma_f32_16x16x32_bf16 v[32:35], v[220:223], v[252:255], v[32:35]
  ds_write_b128 v101, v[104:107] offset:14336
  v_mfma_f32_16x16x32_bf16 v[44:47], v[224:227], v[252:255], v[44:47]
  v_mfma_f32_16x16x32_bf16 v[48:51], v[192:195], v[208:211], v[48:51]
  v_cvt_pk_bf16_f32 v108, v28, v29
  v_cvt_pk_bf16_f32 v109, v30, v31
  s_cbranch_vccz SL35
  s_add_u32 m0, s101, 1792
  s_nop 0
  buffer_load_dwordx4 v134, s[12:15], s86 offen offset:256 lds
SL35:
  v_mfma_f32_16x16x32_bf16 v[60:63], v[196:199], v[208:211], v[60:63]
  v_cvt_pk_bf16_f32 v110, v40, v41
  v_cvt_pk_bf16_f32 v111, v42, v43
  v_mfma_f32_16x16x32_bf16 v[48:51], v[228:231], v[244:247], v[48:51]
  ds_write_b128 v101, v[108:111] offset:8192
  v_mfma_f32_16x16x32_bf16 v[60:63], v[232:235], v[244:247], v[60:63]
  v_mfma_f32_16x16x32_bf16 v[52:55], v[192:195], v[212:215], v[52:55]
  v_cvt_pk_bf16_f32 v112, v32, v33
  v_cvt_pk_bf16_f32 v113, v34, v35
  v_mfma_f32_16x16x32_bf16 v[64:67], v[196:199], v[212:215], v[64:67]
  v_cvt_pk_bf16_f32 v114, v44, v45
  v_cvt_pk_bf16_f32 v115, v46, v47
  v_mfma_f32_16x16x32_bf16 v[52:55], v[228:231], v[248:251], v[52:55]
  ds_write_b128 v101, v[112:115] offset:2048
  s_cbranch_vccz SL36
  s_add_u32 m0, s101, 3072
  s_nop 0
  buffer_load_dwordx4 v135, s[12:15], s87 offen offset:0 lds
SL36:
  v_mfma_f32_16x16x32_bf16 v[64:67], v[232:235], v[248:251], v[64:67]
  v_mfma_f32_16x16x32_bf16 v[56:59], v[192:195], v[216:219], v[56:59]
  v_cvt_pk_bf16_f32 v116, v48, v49
  v_cvt_pk_bf16_f32 v117, v50, v51
  v_mfma_f32_16x16x32_bf16 v[68:71], v[196:199], v[216:219], v[68:71]
  v_cvt_pk_bf16_f32 v118, v60, v61
  v_cvt_pk_bf16_f32 v119, v62, v63
  v_mfma_f32_16x16x32_bf16 v[56:59], v[228:231], v[252:255], v[56:59]
  ds_write_b128 v101, v[116:119] offset:13312
  v_mfma_f32_16x16x32_bf16 v[68:71], v[232:235], v[252:255], v[68:71]
  v_mfma_f32_16x16x32_bf16 v[72:75], v[200:203], v[208:211], v[72:75]
  v_cvt_pk_bf16_f32 v120, v52, v53
  v_cvt_pk_bf16_f32 v121, v54, v55
  s_cbranch_vccz SL37
  s_add_u32 m0, s101, 3968
  s_nop 0
  buffer_load_dwordx4 v135, s[12:15], s87 offen offset:128 lds
SL37:
  v_mfma_f32_16x16x32_bf16 v[84:87], v[204:207], v[208:211], v[84:87]
  v_cvt_pk_bf16_f32 v122, v64, v65
  v_cvt_pk_bf16_f32 v123, v66, v67
  v_mfma_f32_16x16x32_bf16 v[72:75], v[236:239], v[244:247], v[72:75]
  ds_write_b128 v101, v[120:123] offset:7168
  v_mfma_f32_16x16x32_bf16 v[84:87], v[240:243], v[244:247], v[84:87]
  v_mfma_f32_16x16x32_bf16 v[76:79], v[200:203], v[212:215], v[76:79]
  v_cvt_pk_bf16_f32 v124, v56, v57
  v_cvt_pk_bf16_f32 v125, v58, v59
  v_mfma_f32_16x16x32_bf16 v[88:91], v[204:207], v[212:215], v[88:91]
  v_cvt_pk_bf16_f32 v126, v68, v69
  v_cvt_pk_bf16_f32 v127, v70, v71
  v_mfma_f32_16x16x32_bf16 v[76:79], v[236:239], v[248:251], v[76:79]
  ds_write_b128 v101, v[124:127] offset:1024
  s_cbranch_vccz SL38
  s_add_u32 m0, s101, 4864
  s_nop 0
  buffer_load_dwordx4 v135, s[12:15], s87 offen offset:256 lds
SL38:
  v_mfma_f32_16x16x32_bf16 v[88:91], v[240:243], v[248:251], v[88:91]
  v_mfma_f32_16x16x32_bf16 v[80:83], v[200:203], v[216:219], v[80:83]
  v_cvt_pk_bf16_f32 v104, v72, v73
  v_cvt_pk_bf16_f32 v105, v74, v75
  v_mfma_f32_16x16x32_bf16 v[92:95], v[204:207], v[216:219], v[92:95]
  v_cvt_pk_bf16_f32 v106, v84, v85
  v_cvt_pk_bf16_f32 v107, v86, v87
  v_mfma_f32_16x16x32_bf16 v[80:83], v[236:239], v[252:255], v[80:83]
  ds_write_b128 v101, v[104:107] offset:12288
  v_mfma_f32_16x16x32_bf16 v[92:95], v[240:243], v[252:255], v[92:95]
  v_cvt_pk_bf16_f32 v108, v76, v77
  v_cvt_pk_bf16_f32 v109, v78, v79
  v_cvt_pk_bf16_f32 v110, v88, v89
  v_cvt_pk_bf16_f32 v111, v90, v91
  ds_write_b128 v101, v[108:111] offset:6144
  s_nop 3
  v_cvt_pk_bf16_f32 v112, v80, v81
  v_cvt_pk_bf16_f32 v113, v82, v83
  v_cvt_pk_bf16_f32 v114, v92, v93
  v_cvt_pk_bf16_f32 v115, v94, v95
  ds_write_b128 v101, v[112:115] offset:0
  s_waitcnt lgkmcnt(0)
  s_barrier
  s_cmp_eq_u32 s25, 0
  s_cbranch_scc1 MK_single
  ds_read_b128 v[216:219], v2 offset:35840
  ds_read_b128 v[220:223], v2 offset:34816
  ds_read_b128 v[224:227], v2 offset:33792
  ds_read_b128 v[228:231], v2 offset:32768
  ds_read_b128 v[232:235], v2 offset:31744
  ds_read_b128 v[236:239], v2 offset:30720
  ds_read_b128 v[240:243], v2 offset:29696
  ds_read_b128 v[244:247], v2 offset:28672
  ds_read_b128 v[248:251], v2 offset:27648
  ds_read_b128 v[252:255], v2 offset:26624
  s_cbranch_vccz SL39
  s_add_u32 m0, s101, 24576
  s_nop 0
  buffer_load_dwordx4 v134, s[12:15], s84 offen offset:0 lds
  s_add_u32 m0, s101, 25472
  s_nop 0
  buffer_load_dwordx4 v134, s[12:15], s84 offen offset:128 lds
  s_add_u32 m0, s101, 26368
  s_nop 0
  buffer_load_dwordx4 v134, s[12:15], s84 offen offset:256 lds
  s_add_u32 m0, s101, 27648
  s_nop 0
  buffer_load_dwordx4 v135, s[12:15], s85 offen offset:0 lds
  s_add_u32 m0, s101, 28544
  s_nop 0
  buffer_load_dwordx4 v135, s[12:15], s85 offen offset:128 lds
  s_add_u32 m0, s101, 29440
  s_nop 0
  buffer_load_dwordx4 v135, s[12:15], s85 offen offset:256 lds
  s_mul_i32 s100, s32, 9
  s_add_i32 s100, s100, s31
  s_add_u32 m0, s38, 138240
  s_nop 0
  buffer_load_dwordx4 v13, s[12:15], s100 offen lds
  s_add_u32 m0, s38, 139264
  s_nop 0
  buffer_load_dwordx4 v14, s[12:15], s100 offen lds
  s_add_u32 m0, s38, 140288
  s_nop 0
  buffer_load_dwordx4 v3, s[12:15], s100 offen lds
  s_add_u32 m0, s39, 138240
  s_nop 0
  buffer_load_dwordx4 v4, s[12:15], s100 offen lds
  s_mul_i32 s100, s32, 8
  s_add_i32 s100, s100, s31
  s_add_u32 m0, s38, 122880
  s_nop 0
  buffer_load_dwordx4 v13, s[12:15], s100 offen lds
  s_add_u32 m0, s38, 123904
  s_nop 0
  buffer_load_dwordx4 v14, s[12:15], s100 offen lds
  s_add_u32 m0, s38, 124928
  s_nop 0
  buffer_load_dwordx4 v3, s[12:15], s100 offen lds
  s_add_u32 m0, s39, 122880
  s_nop 0
  buffer_load_dwordx4 v4, s[12:15], s100 offen lds
  s_waitcnt vmcnt(8) lgkmcnt(0)
  v_xor_b32 v130, 64, v23
  ds_read_b128 v[136:139], v23 offset:24576
  ds_read_b128 v[140:143], v130 offset:24576
  ds_read_b128 v[144:147], v23 offset:25600
  ds_read_b128 v[148:151], v130 offset:25600
  ds_read_b128 v[152:155], v23 offset:26624
  ds_read_b128 v[156:159], v130 offset:26624
  ds_read_b128 v[160:163], v23 offset:0
  ds_read_b128 v[164:167], v130 offset:0
  ds_read_b128 v[168:171], v23 offset:1024
  ds_read_b128 v[172:175], v130 offset:1024
  ds_read_b128 v[176:179], v23 offset:2048
  ds_read_b128 v[180:183], v130 offset:2048
  s_waitcnt lgkmcnt(0)
  s_barrier
  s_branch SM39
SL39:
  s_waitcnt vmcnt(0)
  s_setprio 1
SM39:
BODY:
  s_waitcnt lgkmcnt(8)
  v_mfma_f32_16x16x32_bf16 v[184:187], v[216:219], v[136:139], 0
  v_mov_b32 v64, 0xff800000
  v_add_u32 v65, 0, v19
  v_mfma_f32_16x16x32_bf16 v[184:187], v[220:223], v[140:143], v[184:187]
  v_add_u32 v66, 1, v19
  s_waitcnt lgkmcnt(6)
  v_mfma_f32_16x16x32_bf16 v[184:187], v[224:227], v[144:147], v[184:187]
  v_add_u32 v67, 2, v19
  v_add_u32 v68, 3, v19
  v_mfma_f32_16x16x32_bf16 v[192:195], v[216:219], v[160:163], 0
  ds_read_b128 v[216:219], v2 offset:25600
  v_cmp_gt_u32 s[48:49], 7, v65
  v_mfma_f32_16x16x32_bf16 v[192:195], v[220:223], v[164:167], v[192:195]
  ds_read_b128 v[220:223], v2 offset:24576
  v_cmp_gt_u32 s[50:51], 7, v66
  v_mfma_f32_16x16x32_bf16 v[192:195], v[224:227], v[168:171], v[192:195]
  ds_read_b128 v[224:227], v2 offset:23552
  v_cmp_gt_u32 s[52:53], 7, v67
  v_mfma_f32_16x16x32_bf16 v[192:195], v[228:231], v[172:175], v[192:195]
  v_cmp_gt_u32 s[54:55], 7, v68
  s_waitcnt lgkmcnt(7)
  v_mfma_f32_16x16x32_bf16 v[192:195], v[232:235], v[176:179], v[192:195]
  s_add_i32 s46, s34, 8
  v_sub_u32 v69, s46, v22
  v_mfma_f32_16x16x32_bf16 v[192:195], v[236:239], v[180:183], v[192:195]
  s_add_i32 s46, s34, 1
  v_sub_u32 v70, s46, v22
  v_mfma_f32_16x16x32_bf16 v[184:187], v[228:231], v[148:151], v[184:187]
  ds_read_b128 v[228:231], v2 offset:22528
  s_add_i32 s46, s34, 6
  v_mfma_f32_16x16x32_bf16 v[184:187], v[232:235], v[152:155], v[184:187]
  ds_read_b128 v[232:235], v2 offset:21504
  v_sub_u32 v71, s46, v21
  v_mfma_f32_16x16x32_bf16 v[184:187], v[236:239], v[156:159], v[184:187]
  ds_read_b128 v[236:239], v2 offset:20480
  s_waitcnt lgkmcnt(8)
  v_mfma_f32_16x16x32_bf16 v[188:191], v[240:243], v[136:139], 0
  s_add_i32 s46, s34, 0
  v_sub_u32 v72, s46, v21
  v_mfma_f32_16x16x32_bf16 v[188:191], v[244:247], v[140:143], v[188:191]
  v_sub_u32 v73, s35, v21
  s_waitcnt lgkmcnt(6)
  v_mfma_f32_16x16x32_bf16 v[188:191], v[248:251], v[144:147], v[188:191]
  v_cndmask_b32 v32, v64, 0, s[48:49]
  v_cndmask_b32 v33, v64, 0, s[50:51]
  v_mfma_f32_16x16x32_bf16 v[196:199], v[240:243], v[160:163], 0
  ds_read_b128 v[240:243], v2 offset:19456
  v_cndmask_b32 v34, v64, 0, s[52:53]
  v_mfma_f32_16x16x32_bf16 v[196:199], v[244:247], v[164:167], v[196:199]
  ds_read_b128 v[244:247], v2 offset:18432
  v_cndmask_b32 v35, v64, 0, s[54:55]
  v_mfma_f32_16x16x32_bf16 v[196:199], v[248:251], v[168:171], v[196:199]
  ds_read_b128 v[248:251], v2 offset:17408
  v_cmp_gt_u32 s[46:47], 7, v69
  v_mfma_f32_16x16x32_bf16 v[196:199], v[252:255], v[172:175], v[196:199]
  v_cmp_gt_u32 s[48:49], 7, v70
  s_waitcnt lgkmcnt(7)
  v_mfma_f32_16x16x32_bf16 v[196:199], v[216:219], v[176:179], v[196:199]
  v_cmp_gt_u32 s[50:51], 7, v71
  v_cmp_gt_u32 s[52:53], 7, v72
  v_mfma_f32_16x16x32_bf16 v[196:199], v[220:223], v[180:183], v[196:199]
  v_cmp_gt_u32 s[54:55], 7, v73
  v_cndmask_b32 v84, v64, v32, s[46:47]
  v_mfma_f32_16x16x32_bf16 v[188:191], v[252:255], v[148:151], v[188:191]
  ds_read_b128 v[252:255], v2 offset:16384
  v_cndmask_b32 v85, v64, v33, s[46:47]
  v_mfma_f32_16x16x32_bf16 v[188:191], v[216:219], v[152:155], v[188:191]
  ds_read_b128 v[216:219], v2 offset:15360
  v_cndmask_b32 v86, v64, v34, s[46:47]
  v_mfma_f32_16x16x32_bf16 v[188:191], v[220:223], v[156:159], v[188:191]
  ds_read_b128 v[220:223], v2 offset:14336
  s_waitcnt lgkmcnt(8)
  v_mfma_f32_16x16x32_bf16 v[200:203], v[224:227], v[136:139], 0
  v_mul_f32 v192, s93, v192
  v_mul_f32 v193, s93, v193
  v_mfma_f32_16x16x32_bf16 v[200:203], v[228:231], v[140:143], v[200:203]
  v_mul_f32 v194, s93, v194
  s_waitcnt lgkmcnt(6)
  v_mfma_f32_16x16x32_bf16 v[200:203], v[232:235], v[144:147], v[200:203]
  v_mul_f32 v195, s93, v195
  v_cvt_pk_bf16_f32 v112, v192, v193
  v_mfma_f32_16x16x32_bf16 v[208:211], v[224:227], v[160:163], 0
  ds_read_b128 v[224:227], v2 offset:13312
  v_cvt_pk_bf16_f32 v113, v194, v195
  v_mfma_f32_16x16x32_bf16 v[208:211], v[228:231], v[164:167], v[208:211]
  ds_read_b128 v[228:231], v2 offset:12288
  v_mul_f32 v184, s93, v184
  v_mfma_f32_16x16x32_bf16 v[208:211], v[232:235], v[168:171], v[208:211]
  ds_read_b128 v[232:235], v2 offset:11264
  v_mul_f32 v185, s93, v185
  v_mfma_f32_16x16x32_bf16 v[208:211], v[236:239], v[172:175], v[208:211]
  v_mul_f32 v186, s93, v186
  s_waitcnt lgkmcnt(7)
  v_mfma_f32_16x16x32_bf16 v[208:211], v[240:243], v[176:179], v[208:211]
  v_mul_f32 v187, s93, v187
  v_cvt_pk_bf16_f32 v88, v184, v185
  v_mfma_f32_16x16x32_bf16 v[208:211], v[244:247], v[180:183], v[208:211]
  v_cvt_pk_bf16_f32 v89, v186, v187
  v_mul_f32 v196, s93, v196
  v_mfma_f32_16x16x32_bf16 v[200:203], v[236:239], v[148:151], v[200:203]
  ds_read_b128 v[236:239], v2 offset:10240
  v_mul_f32 v197, s93, v197
  v_mfma_f32_16x16x32_bf16 v[200:203], v[240:243], v[152:155], v[200:203]
  ds_read_b128 v[240:243], v2 offset:9216
  v_mul_f32 v198, s93, v198
  v_mfma_f32_16x16x32_bf16 v[200:203], v[244:247], v[156:159], v[200:203]
  ds_read_b128 v[244:247], v2 offset:8192
  s_waitcnt lgkmcnt(8)
  v_mfma_f32_16x16x32_bf16 v[204:207], v[248:251], v[136:139], 0
  v_mul_f32 v199, s93, v199
  v_cvt_pk_bf16_f32 v114, v196, v197
  v_mfma_f32_16x16x32_bf16 v[204:207], v[252:255], v[140:143], v[204:207]
  v_cvt_pk_bf16_f32 v115, v198, v199
  s_waitcnt lgkmcnt(6)
  v_mfma_f32_16x16x32_bf16 v[204:207], v[216:219], v[144:147], v[204:207]
  v_mul_f32 v188, s93, v188
  v_mul_f32 v189, s93, v189
  v_mfma_f32_16x16x32_bf16 v[212:215], v[248:251], v[160:163], 0
  ds_read_b128 v[248:251], v2 offset:7168
  v_mul_f32 v190, s93, v190
  v_mfma_f32_16x16x32_bf16 v[212:215], v[252:255], v[164:167], v[212:215]
  ds_read_b128 v[252:255], v2 offset:6144
  v_mul_f32 v191, s93, v191
  v_mfma_f32_16x16x32_bf16 v[212:215], v[216:219], v[168:171], v[212:215]
  ds_read_b128 v[216:219], v2 offset:5120
  v_cvt_pk_bf16_f32 v90, v188, v189
  v_mfma_f32_16x16x32_bf16 v[212:215], v[220:223], v[172:175], v[212:215]
  v_cvt_pk_bf16_f32 v91, v190, v191
  s_waitcnt lgkmcnt(7)
  v_mfma_f32_16x16x32_bf16 v[212:215], v[224:227], v[176:179], v[212:215]
  v_cndmask_b32 v87, v64, v35, s[46:47]
  v_cndmask_b32 v56, v64, v32, s[48:49]
  v_mfma_f32_16x16x32_bf16 v[212:215], v[228:231], v[180:183], v[212:215]
  v_cndmask_b32 v57, v64, v33, s[48:49]
  v_cndmask_b32 v58, v64, v34, s[48:49]
  v_mfma_f32_16x16x32_bf16 v[204:207], v[220:223], v[148:151], v[204:207]
  ds_read_b128 v[220:223], v2 offset:4096
  v_cndmask_b32 v59, v64, v35, s[48:49]
  v_mfma_f32_16x16x32_bf16 v[204:207], v[224:227], v[152:155], v[204:207]
  ds_read_b128 v[224:227], v2 offset:3072
  v_mul_f32 v208, s93, v208
  v_mfma_f32_16x16x32_bf16 v[204:207], v[228:231], v[156:159], v[204:207]
  ds_read_b128 v[228:231], v2 offset:2048
  s_waitcnt lgkmcnt(8)
  v_mfma_f32_16x16x32_bf16 v[184:187], v[232:235], v[136:139], 0
  v_mul_f32 v209, s93, v209
  v_mul_f32 v210, s93, v210
  v_mfma_f32_16x16x32_bf16 v[184:187], v[236:239], v[140:143], v[184:187]
  v_mul_f32 v211, s93, v211
  s_waitcnt lgkmcnt(6)
  v_mfma_f32_16x16x32_bf16 v[184:187], v[240:243], v[144:147], v[184:187]
  v_cvt_pk_bf16_f32 v116, v208, v209
  v_cvt_pk_bf16_f32 v117, v210, v211
  v_mfma_f32_16x16x32_bf16 v[192:195], v[232:235], v[160:163], 0
  ds_read_b128 v[232:235], v2 offset:1024
  v_mul_f32 v200, s93, v200
  v_mfma_f32_16x16x32_bf16 v[192:195], v[236:239], v[164:167], v[192:195]
  ds_read_b128 v[236:239], v2 offset:0
  v_mul_f32 v201, s93, v201
  v_mfma_f32_16x16x32_bf16 v[192:195], v[240:243], v[168:171], v[192:195]
  ds_read_b128 v[240:243], v1 offset:35840
  v_mul_f32 v202, s93, v202
  v_mfma_f32_16x16x32_bf16 v[192:195], v[244:247], v[172:175], v[192:195]
  v_mul_f32 v203, s93, v203
  s_waitcnt lgkmcnt(7)
  v_mfma_f32_16x16x32_bf16 v[192:195], v[248:251], v[176:179], v[192:195]
  v_cvt_pk_bf16_f32 v92, v200, v201
  v_cvt_pk_bf16_f32 v93, v202, v203
  v_mfma_f32_16x16x32_bf16 v[192:195], v[252:255], v[180:183], v[192:195]
  v_mul_f32 v212, s93, v212
  v_mul_f32 v213, s93, v213
  v_mfma_f32_16x16x32_bf16 v[184:187], v[244:247], v[148:151], v[184:187]
  ds_read_b128 v[244:247], v1 offset:34816
  v_mul_f32 v214, s93, v214
  v_mfma_f32_16x16x32_bf16 v[184:187], v[248:251], v[152:155], v[184:187]
  ds_read_b128 v[248:251], v1 offset:33792
  v_mul_f32 v215, s93, v215
  v_mfma_f32_16x16x32_bf16 v[184:187], v[252:255], v[156:159], v[184:187]
  ds_read_b128 v[252:255], v1 offset:32768
  s_waitcnt lgkmcnt(8)
  v_mfma_f32_16x16x32_bf16 v[188:191], v[216:219], v[136:139], 0
  v_cvt_pk_bf16_f32 v118, v212, v213
  v_cvt_pk_bf16_f32 v119, v214, v215
  s_cbranch_vccz SL40
  s_barrier
SL40:
  v_mfma_f32_16x16x32_bf16 v[188:191], v[220:223], v[140:143], v[188:191]
  v_mul_f32 v204, s93, v204
  s_waitcnt lgkmcnt(6)
  v_mfma_f32_16x16x32_bf16 v[188:191], v[224:227], v[144:147], v[188:191]
  v_mul_f32 v205, s93, v205
  v_mul_f32 v206, s93, v206
  v_mfma_f32_16x16x32_bf16 v[196:199], v[216:219], v[160:163], 0
  ds_read_b128 v[216:219], v1 offset:31744
  v_mul_f32 v207, s93, v207
  v_mfma_f32_16x16x32_bf16 v[196:199], v[220:223], v[164:167], v[196:199]
  ds_read_b128 v[220:223], v1 offset:30720
  v_cvt_pk_bf16_f32 v94, v204, v205
  v_mfma_f32_16x16x32_bf16 v[196:199], v[224:227], v[168:171], v[196:199]
  ds_read_b128 v[224:227], v1 offset:29696
  v_cvt_pk_bf16_f32 v95, v206, v207
  v_mfma_f32_16x16x32_bf16 v[196:199], v[228:231], v[172:175], v[196:199]
  v_cndmask_b32 v52, v64, v32, s[50:51]
  s_waitcnt lgkmcnt(7)
  v_mfma_f32_16x16x32_bf16 v[196:199], v[232:235], v[176:179], v[196:199]
  v_cndmask_b32 v53, v64, v33, s[50:51]
  v_cndmask_b32 v54, v64, v34, s[50:51]
  v_mfma_f32_16x16x32_bf16 v[196:199], v[236:239], v[180:183], v[196:199]
  v_cndmask_b32 v55, v64, v35, s[50:51]
  v_mul_f32 v192, s93, v192
  v_mfma_f32_16x16x32_bf16 v[188:191], v[228:231], v[148:151], v[188:191]
  ds_read_b128 v[228:231], v1 offset:28672
  v_mul_f32 v193, s93, v193
  v_mfma_f32_16x16x32_bf16 v[188:191], v[232:235], v[152:155], v[188:191]
  ds_read_b128 v[232:235], v1 offset:27648
  v_mul_f32 v194, s93, v194
  v_mfma_f32_16x16x32_bf16 v[188:191], v[236:239], v[156:159], v[188:191]
  ds_read_b128 v[236:239], v1 offset:26624
  s_waitcnt lgkmcnt(8)
  v_mfma_f32_16x16x32_bf16 v[200:203], v[240:243], v[136:139], 0
  v_mul_f32 v195, s93, v195
  v_cvt_pk_bf16_f32 v120, v192, v193
  v_mfma_f32_16x16x32_bf16 v[200:203], v[244:247], v[140:143], v[200:203]
  v_cvt_pk_bf16_f32 v121, v194, v195
  s_waitcnt lgkmcnt(6)
  v_mfma_f32_16x16x32_bf16 v[200:203], v[248:251], v[144:147], v[200:203]
  v_mul_f32 v184, s93, v184
  v_mul_f32 v185, s93, v185
  v_mfma_f32_16x16x32_bf16 v[208:211], v[240:243], v[160:163], 0
  ds_read_b128 v[240:243], v1 offset:25600
  v_mul_f32 v186, s93, v186
  v_mfma_f32_16x16x32_bf16 v[208:211], v[244:247], v[164:167], v[208:211]
  ds_read_b128 v[244:247], v1 offset:24576
  v_mul_f32 v187, s93, v187
  v_mfma_f32_16x16x32_bf16 v[208:211], v[248:251], v[168:171], v[208:211]
  ds_read_b128 v[248:251], v1 offset:23552
  v_cvt_pk_bf16_f32 v96, v184, v185
  v_mfma_f32_16x16x32_bf16 v[208:211], v[252:255], v[172:175], v[208:211]
  v_cvt_pk_bf16_f32 v97, v186, v187
  s_waitcnt lgkmcnt(7)
  v_mfma_f32_16x16x32_bf16 v[208:211], v[216:219], v[176:179], v[208:211]
  v_mul_f32 v196, s93, v196
  v_mul_f32 v197, s93, v197
  v_mfma_f32_16x16x32_bf16 v[208:211], v[220:223], v[180:183], v[208:211]
  v_mul_f32 v198, s93, v198
  v_mul_f32 v199, s93, v199
  v_mfma_f32_16x16x32_bf16 v[200:203], v[252:255], v[148:151], v[200:203]
  ds_read_b128 v[252:255], v1 offset:22528
  v_cvt_pk_bf16_f32 v122, v196, v197
  v_mfma_f32_16x16x32_bf16 v[200:203], v[216:219], v[152:155], v[200:203]
  ds_read_b128 v[216:219], v1 offset:21504
  v_cvt_pk_bf16_f32 v123, v198, v199
  v_mfma_f32_16x16x32_bf16 v[200:203], v[220:223], v[156:159], v[200:203]
  ds_read_b128 v[220:223], v1 offset:20480
  s_waitcnt lgkmcnt(8)
  v_mfma_f32_16x16x32_bf16 v[204:207], v[224:227], v[136:139], 0
  v_mul_f32 v188, s93, v188
  v_mul_f32 v189, s93, v189
  v_mfma_f32_16x16x32_bf16 v[204:207], v[228:231], v[140:143], v[204:207]
  v_mul_f32 v190, s93, v190
  s_waitcnt lgkmcnt(6)
  v_mfma_f32_16x16x32_bf16 v[204:207], v[232:235], v[144:147], v[204:207]
  v_mul_f32 v191, s93, v191
  v_cvt_pk_bf16_f32 v98, v188, v189
  v_mfma_f32_16x16x32_bf16 v[212:215], v[224:227], v[160:163], 0
  ds_read_b128 v[224:227], v1 offset:19456
  v_cvt_pk_bf16_f32 v99, v190, v191
  v_mfma_f32_16x16x32_bf16 v[212:215], v[228:231], v[164:167], v[212:215]
  ds_read_b128 v[228:231], v1 offset:18432
  v_cndmask_b32 v28, v64, v32, s[52:53]
  v_mfma_f32_16x16x32_bf16 v[212:215], v[232:235], v[168:171], v[212:215]
  ds_read_b128 v[232:235], v1 offset:17408
  v_cndmask_b32 v29, v64, v33, s[52:53]
  v_mfma_f32_16x16x32_bf16 v[212:215], v[236:239], v[172:175], v[212:215]
  v_cndmask_b32 v30, v64, v34, s[52:53]
  s_waitcnt lgkmcnt(7)
  v_mfma_f32_16x16x32_bf16 v[212:215], v[240:243], v[176:179], v[212:215]
  v_cndmask_b32 v31, v64, v35, s[52:53]
  v_cndmask_b32 v24, v64, v32, s[54:55]
  v_mfma_f32_16x16x32_bf16 v[212:215], v[244:247], v[180:183], v[212:215]
  v_mul_f32 v208, s93, v208
  v_mul_f32 v209, s93, v209
  v_mfma_f32_16x16x32_bf16 v[204:207], v[236:239], v[148:151], v[204:207]
  ds_read_b128 v[236:239], v1 offset:16384
  v_mul_f32 v210, s93, v210
  v_mfma_f32_16x16x32_bf16 v[204:207], v[240:243], v[152:155], v[204:207]
  ds_read_b128 v[240:243], v1 offset:15360
  v_mul_f32 v211, s93, v211
  v_mfma_f32_16x16x32_bf16 v[204:207], v[244:247], v[156:159], v[204:207]
  ds_read_b128 v[244:247], v1 offset:14336
  s_waitcnt lgkmcnt(8)
  v_mfma_f32_16x16x32_bf16 v[184:187], v[248:251], v[136:139], 0
  v_cvt_pk_bf16_f32 v124, v208, v209
  v_cvt_pk_bf16_f32 v125, v210, v211
  v_mfma_f32_16x16x32_bf16 v[184:187], v[252:255], v[140:143], v[184:187]
  v_mul_f32 v200, s93, v200
  s_waitcnt lgkmcnt(6)
  v_mfma_f32_16x16x32_bf16 v[184:187], v[216:219], v[144:147], v[184:187]
  v_mul_f32 v201, s93, v201
  v_mul_f32 v202, s93, v202
  v_mfma_f32_16x16x32_bf16 v[192:195], v[248:251], v[160:163], 0
  ds_read_b128 v[248:251], v1 offset:13312
  v_mul_f32 v203, s93, v203
  v_mfma_f32_16x16x32_bf16 v[192:195], v[252:255], v[164:167], v[192:195]
  ds_read_b128 v[252:255], v1 offset:12288
  v_cvt_pk_bf16_f32 v100, v200, v201
  v_mfma_f32_16x16x32_bf16 v[192:195], v[216:219], v[168:171], v[192:195]
  ds_read_b128 v[216:219], v1 offset:11264
  v_cvt_pk_bf16_f32 v101, v202, v203
  v_mfma_f32_16x16x32_bf16 v[192:195], v[220:223], v[172:175], v[192:195]
  v_mul_f32 v212, s93, v212
  s_waitcnt lgkmcnt(7)
  v_mfma_f32_16x16x32_bf16 v[192:195], v[224:227], v[176:179], v[192:195]
  v_mul_f32 v213, s93, v213
  v_mul_f32 v214, s93, v214
  v_mfma_f32_16x16x32_bf16 v[192:195], v[228:231], v[180:183], v[192:195]
  v_mul_f32 v215, s93, v215
  v_cvt_pk_bf16_f32 v126, v212, v213
  v_mfma_f32_16x16x32_bf16 v[184:187], v[220:223], v[148:151], v[184:187]
  ds_read_b128 v[220:223], v1 offset:10240
  v_cvt_pk_bf16_f32 v127, v214, v215
  v_mfma_f32_16x16x32_bf16 v[184:187], v[224:227], v[152:155], v[184:187]
  ds_read_b128 v[224:227], v1 offset:9216
  v_mul_f32 v204, s93, v204
  v_mfma_f32_16x16x32_bf16 v[184:187], v[228:231], v[156:159], v[184:187]
  ds_read_b128 v[228:231], v1 offset:8192
  s_waitcnt lgkmcnt(8)
  v_mfma_f32_16x16x32_bf16 v[188:191], v[232:235], v[136:139], 0
  v_mul_f32 v205, s93, v205
  v_mul_f32 v206, s93, v206
  v_mfma_f32_16x16x32_bf16 v[188:191], v[236:239], v[140:143], v[188:191]
  v_mul_f32 v207, s93, v207
  s_waitcnt lgkmcnt(6)
  v_mfma_f32_16x16x32_bf16 v[188:191], v[240:243], v[144:147], v[188:191]
  v_cvt_pk_bf16_f32 v102, v204, v205
  v_cvt_pk_bf16_f32 v103, v206, v207
  v_mfma_f32_16x16x32_bf16 v[196:199], v[232:235], v[160:163], 0
  ds_read_b128 v[232:235], v1 offset:7168
  v_cndmask_b32 v25, v64, v33, s[54:55]
  v_mfma_f32_16x16x32_bf16 v[196:199], v[236:239], v[164:167], v[196:199]
  ds_read_b128 v[236:239], v1 offset:6144
  v_cndmask_b32 v26, v64, v34, s[54:55]
  v_mfma_f32_16x16x32_bf16 v[196:199], v[240:243], v[168:171], v[196:199]
  ds_read_b128 v[240:243], v1 offset:5120
  v_cndmask_b32 v27, v64, v35, s[54:55]
  v_mfma_f32_16x16x32_bf16 v[196:199], v[244:247], v[172:175], v[196:199]
  v_mul_f32 v192, s93, v192
  s_cbranch_vccnz SL41
  s_barrier
SL41:
  s_waitcnt lgkmcnt(7)
  v_mfma_f32_16x16x32_bf16 v[196:199], v[248:251], v[176:179], v[196:199]
  v_mul_f32 v193, s93, v193
  v_mul_f32 v194, s93, v194
  v_mfma_f32_16x16x32_bf16 v[196:199], v[252:255], v[180:183], v[196:199]
  v_mul_f32 v195, s93, v195
  v_cvt_pk_bf16_f32 v128, v192, v193
  v_mfma_f32_16x16x32_bf16 v[188:191], v[244:247], v[148:151], v[188:191]
  ds_read_b128 v[244:247], v1 offset:4096
  v_cvt_pk_bf16_f32 v129, v194, v195
  v_mfma_f32_16x16x32_bf16 v[188:191], v[248:251], v[152:155], v[188:191]
  ds_read_b128 v[248:251], v1 offset:3072
  v_mul_f32 v184, s93, v184
  v_mfma_f32_16x16x32_bf16 v[188:191], v[252:255], v[156:159], v[188:191]
  ds_read_b128 v[252:255], v1 offset:2048
  s_waitcnt lgkmcnt(8)
  v_mfma_f32_16x16x32_bf16 v[200:203], v[216:219], v[136:139], 0
  v_mul_f32 v185, s93, v185
  v_mul_f32 v186, s93, v186
  s_cbranch_vccz SL42
  s_waitcnt vmcnt(0)
  s_barrier
SL42:
  v_mfma_f32_16x16x32_bf16 v[200:203], v[220:223], v[140:143], v[200:203]
  v_mul_f32 v187, s93, v187
  s_waitcnt lgkmcnt(6)
  v_mfma_f32_16x16x32_bf16 v[200:203], v[224:227], v[144:147], v[200:203]
  v_cvt_pk_bf16_f32 v104, v184, v185
  v_cvt_pk_bf16_f32 v105, v186, v187
  v_mfma_f32_16x16x32_bf16 v[208:211], v[216:219], v[160:163], 0
  ds_read_b128 v[216:219], v1 offset:1024
  v_mul_f32 v196, s93, v196
  v_mfma_f32_16x16x32_bf16 v[208:211], v[220:223], v[164:167], v[208:211]
  ds_read_b128 v[220:223], v1 offset:0
  v_mul_f32 v197, s93, v197
  v_mfma_f32_16x16x32_bf16 v[208:211], v[224:227], v[168:171], v[208:211]
  v_mul_f32 v198, s93, v198
  v_mul_f32 v199, s93, v199
  v_mfma_f32_16x16x32_bf16 v[208:211], v[228:231], v[172:175], v[208:211]
  v_cvt_pk_bf16_f32 v130, v196, v197
  s_waitcnt lgkmcnt(6)
  v_mfma_f32_16x16x32_bf16 v[208:211], v[232:235], v[176:179], v[208:211]
  v_cvt_pk_bf16_f32 v131, v198, v199
  v_mul_f32 v188, s93, v188
  v_mfma_f32_16x16x32_bf16 v[208:211], v[236:239], v[180:183], v[208:211]
  v_mul_f32 v189, s93, v189
  v_mul_f32 v190, s93, v190
  v_mfma_f32_16x16x32_bf16 v[200:203], v[228:231], v[148:151], v[200:203]
  v_mul_f32 v191, s93, v191
  v_cvt_pk_bf16_f32 v106, v188, v189
  v_mfma_f32_16x16x32_bf16 v[200:203], v[232:235], v[152:155], v[200:203]
  v_cvt_pk_bf16_f32 v107, v190, v191
  v_mfma_f32_16x16x32_bf16 v[200:203], v[236:239], v[156:159], v[200:203]
  s_waitcnt lgkmcnt(5)
  v_mfma_f32_16x16x32_bf16 v[204:207], v[240:243], v[136:139], 0
  v_mul_f32 v208, s93, v208
  s_waitcnt lgkmcnt(4)
  v_mfma_f32_16x16x32_bf16 v[204:207], v[244:247], v[140:143], v[204:207]
  v_mul_f32 v209, s93, v209
  s_waitcnt lgkmcnt(3)
  v_mfma_f32_16x16x32_bf16 v[204:207], v[248:251], v[144:147], v[204:207]
  v_mul_f32 v210, s93, v210
  v_mul_f32 v211, s93, v211
  v_mfma_f32_16x16x32_bf16 v[212:215], v[240:243], v[160:163], 0
  v_cvt_pk_bf16_f32 v132, v208, v209
  v_cvt_pk_bf16_f32 v133, v210, v211
  v_mfma_f32_16x16x32_bf16 v[212:215], v[244:247], v[164:167], v[212:215]
  v_mul_f32 v200, s93, v200
  v_mul_f32 v201, s93, v201
  v_mfma_f32_16x16x32_bf16 v[212:215], v[248:251], v[168:171], v[212:215]
  v_mul_f32 v202, s93, v202
  s_waitcnt lgkmcnt(2)
  v_mfma_f32_16x16x32_bf16 v[212:215], v[252:255], v[172:175], v[212:215]
  v_mul_f32 v203, s93, v203
  s_waitcnt lgkmcnt(1)
  v_mfma_f32_16x16x32_bf16 v[212:215], v[216:219], v[176:179], v[212:215]
  v_cvt_pk_bf16_f32 v108, v200, v201
  s_waitcnt lgkmcnt(0)
  v_mfma_f32_16x16x32_bf16 v[212:215], v[220:223], v[180:183], v[212:215]
  v_cvt_pk_bf16_f32 v109, v202, v203
  v_mfma_f32_16x16x32_bf16 v[204:207], v[252:255], v[148:151], v[204:207]
  v_mfma_f32_16x16x32_bf16 v[204:207], v[216:219], v[152:155], v[204:207]
  v_mfma_f32_16x16x32_bf16 v[204:207], v[220:223], v[156:159], v[204:207]
  s_cbranch_vccnz SL43
  s_setprio 0
  s_mul_i32 s100, s32, 7
  s_add_i32 s100, s100, s31
  s_add_u32 m0, s38, 107520
  s_nop 0
  buffer_load_dwordx4 v13, s[12:15], s100 offen lds
  s_add_u32 m0, s38, 108544
  s_nop 0
  buffer_load_dwordx4 v14, s[12:15], s100 offen lds
  s_add_u32 m0, s38, 109568
  s_nop 0
  buffer_load_dwordx4 v3, s[12:15], s100 offen lds
  s_add_u32 m0, s39, 107520
  s_nop 0
  buffer_load_dwordx4 v4, s[12:15], s100 offen lds
  s_mul_i32 s100, s32, 6
  s_add_i32 s100, s100, s31
  s_add_u32 m0, s38, 92160
  s_nop 0
  buffer_load_dwordx4 v13, s[12:15], s100 offen lds
  s_add_u32 m0, s38, 93184
  s_nop 0
  buffer_load_dwordx4 v14, s[12:15], s100 offen lds
  s_add_u32 m0, s38, 94208
  s_nop 0
  buffer_load_dwordx4 v3, s[12:15], s100 offen lds
  s_add_u32 m0, s39, 92160
  s_nop 0
  buffer_load_dwordx4 v4, s[12:15], s100 offen lds
  s_mul_i32 s100, s32, 5
  s_add_i32 s100, s100, s31
  s_add_u32 m0, s38, 76800
  s_nop 0
  buffer_load_dwordx4 v13, s[12:15], s100 offen lds
  s_add_u32 m0, s38, 77824
  s_nop 0
  buffer_load_dwordx4 v14, s[12:15], s100 offen lds
  s_add_u32 m0, s38, 78848
  s_nop 0
  buffer_load_dwordx4 v3, s[12:15], s100 offen lds
  s_add_u32 m0, s39, 76800
  s_nop 0
  buffer_load_dwordx4 v4, s[12:15], s100 offen lds
  s_barrier
  s_mul_i32 s100, s32, 4
  s_add_i32 s100, s100, s31
  s_add_u32 m0, s38, 61440
  s_nop 0
  buffer_load_dwordx4 v13, s[12:15], s100 offen lds
  s_add_u32 m0, s38, 62464
  s_nop 0
  buffer_load_dwordx4 v14, s[12:15], s100 offen lds
  s_add_u32 m0, s38, 63488
  s_nop 0
  buffer_load_dwordx4 v3, s[12:15], s100 offen lds
  s_add_u32 m0, s39, 61440
  s_nop 0
  buffer_load_dwordx4 v4, s[12:15], s100 offen lds
  s_mul_i32 s100, s32, 3
  s_add_i32 s100, s100, s31
  s_add_u32 m0, s38, 46080
  s_nop 0
  buffer_load_dwordx4 v13, s[12:15], s100 offen lds
  s_add_u32 m0, s38, 47104
  s_nop 0
  buffer_load_dwordx4 v14, s[12:15], s100 offen lds
  s_add_u32 m0, s38, 48128
  s_nop 0
  buffer_load_dwordx4 v3, s[12:15], s100 offen lds
  s_add_u32 m0, s39, 46080
  s_nop 0
  buffer_load_dwordx4 v4, s[12:15], s100 offen lds
  s_mul_i32 s100, s32, 2
  s_add_i32 s100, s100, s31
  s_add_u32 m0, s38, 30720
  s_nop 0
  buffer_load_dwordx4 v13, s[12:15], s100 offen lds
  s_add_u32 m0, s38, 31744
  s_nop 0
  buffer_load_dwordx4 v14, s[12:15], s100 offen lds
  s_add_u32 m0, s38, 32768
  s_nop 0
  buffer_load_dwordx4 v3, s[12:15], s100 offen lds
  s_add_u32 m0, s39, 30720
  s_nop 0
  buffer_load_dwordx4 v4, s[12:15], s100 offen lds
  s_waitcnt vmcnt(12)
  s_barrier
  s_max_u32 s100, s33, 1
  s_mul_i32 s100, s100, s32
  s_add_i32 s100, s100, s31
  s_add_u32 m0, s38, 15360
  s_nop 0
  buffer_load_dwordx4 v13, s[12:15], s100 offen lds
  s_add_u32 m0, s38, 16384
  s_nop 0
  buffer_load_dwordx4 v14, s[12:15], s100 offen lds
  s_add_u32 m0, s38, 17408
  s_nop 0
  buffer_load_dwordx4 v3, s[12:15], s100 offen lds
  s_add_u32 m0, s39, 15360
  s_nop 0
  buffer_load_dwordx4 v4, s[12:15], s100 offen lds
  s_max_u32 s100, s33, 0
  s_mul_i32 s100, s100, s32
  s_add_i32 s100, s100, s31
  s_add_u32 m0, s38, 0
  s_nop 0
  buffer_load_dwordx4 v13, s[12:15], s100 offen lds
  s_add_u32 m0, s38, 1024
  s_nop 0
  buffer_load_dwordx4 v14, s[12:15], s100 offen lds
  s_add_u32 m0, s38, 2048
  s_nop 0
  buffer_load_dwordx4 v3, s[12:15], s100 offen lds
  s_add_u32 m0, s39, 0
  s_nop 0
  buffer_load_dwordx4 v4, s[12:15], s100 offen lds
  s_waitcnt vmcnt(8)
  s_barrier
SL43:
  ds_read_b128 v[224:227], v7 offset:61440
  ds_read_b128 v[228:231], v8 offset:61440
  ds_read_b128 v[232:235], v7 offset:61568
  ds_read_b128 v[236:239], v8 offset:61568
  ds_read_b128 v[240:243], v7 offset:61696
  ds_read_b128 v[244:247], v8 offset:61696
  ds_read_b128 v[248:251], v7 offset:53760
  ds_read_b128 v[252:255], v8 offset:53760
  ds_read_b128 v[216:219], v7 offset:53888
  ds_read_b128 v[220:223], v8 offset:53888
  s_waitcnt lgkmcnt(8)
  v_mfma_f32_16x16x32_bf16 v[84:87], v[224:227], v[112:115], v[84:87]
  ds_read_b128 v[224:227], v7 offset:54016
  v_mul_f32 v212, s93, v212
  v_mfma_f32_16x16x32_bf16 v[84:87], v[228:231], v[116:119], v[84:87]
  ds_read_b128 v[228:231], v8 offset:54016
  s_waitcnt lgkmcnt(8)
  v_mfma_f32_16x16x32_bf16 v[84:87], v[232:235], v[120:123], v[84:87]
  ds_read_b128 v[232:235], v7 offset:46080
  v_mul_f32 v213, s93, v213
  v_mfma_f32_16x16x32_bf16 v[84:87], v[236:239], v[124:127], v[84:87]
  ds_read_b128 v[236:239], v8 offset:46080
  s_waitcnt lgkmcnt(8)
  v_mfma_f32_16x16x32_bf16 v[84:87], v[240:243], v[128:131], v[84:87]
  ds_read_b128 v[240:243], v7 offset:46208
  v_mul_f32 v214, s93, v214
  v_mul_f32 v215, s93, v215
  v_cvt_pk_bf16_f32 v134, v212, v213
  v_cvt_pk_bf16_f32 v135, v214, v215
  s_nop 1
  v_mfma_f32_16x16x32_bf16 v[84:87], v[244:247], v[132:135], v[84:87]
  ds_read_b128 v[244:247], v8 offset:46208
  s_waitcnt lgkmcnt(8)
  v_mfma_f32_16x16x32_bf16 v[80:83], v[248:251], v[112:115], v[32:35]
  ds_read_b128 v[248:251], v7 offset:46336
  v_mul_f32 v204, s93, v204
  v_mfma_f32_16x16x32_bf16 v[80:83], v[252:255], v[116:119], v[80:83]
  ds_read_b128 v[252:255], v8 offset:46336
  s_waitcnt lgkmcnt(8)
  v_mfma_f32_16x16x32_bf16 v[80:83], v[216:219], v[120:123], v[80:83]
  v_exp_f32 v196, v84
  v_mfma_f32_16x16x32_bf16 v[80:83], v[220:223], v[124:127], v[80:83]
  ds_read_b128 v[216:219], v7 offset:38400
  s_waitcnt lgkmcnt(7)
  v_mfma_f32_16x16x32_bf16 v[80:83], v[224:227], v[128:131], v[80:83]
  v_exp_f32 v197, v85
  v_mfma_f32_16x16x32_bf16 v[80:83], v[228:231], v[132:135], v[80:83]
  ds_read_b128 v[220:223], v8 offset:38400
  s_cbranch_vccz SL44
  s_barrier
  s_branch SM44
SL44:
  s_waitcnt vmcnt(0)
  s_barrier
SM44:
  ds_read_b128 v[224:227], v7 offset:38528
  ds_read_b128 v[228:231], v8 offset:38528
  s_waitcnt lgkmcnt(8)
  v_mfma_f32_16x16x32_bf16 v[52:55], v[232:235], v[88:91], v[52:55]
  v_exp_f32 v198, v86
  v_mfma_f32_16x16x32_bf16 v[52:55], v[236:239], v[92:95], v[52:55]
  v_mul_f32 v205, s93, v205
  s_waitcnt lgkmcnt(6)
  v_mfma_f32_16x16x32_bf16 v[52:55], v[240:243], v[96:99], v[52:55]
  v_exp_f32 v199, v87
  v_mfma_f32_16x16x32_bf16 v[76:79], v[232:235], v[112:115], v[32:35]
  v_exp_f32 v200, v80
  v_mfma_f32_16x16x32_bf16 v[76:79], v[236:239], v[116:119], v[76:79]
  v_exp_f32 v201, v81
  v_mfma_f32_16x16x32_bf16 v[76:79], v[240:243], v[120:123], v[76:79]
  v_exp_f32 v202, v82
  v_mfma_f32_16x16x32_bf16 v[76:79], v[244:247], v[124:127], v[76:79]
  ds_read_b128 v[232:235], v7 offset:38656
  s_waitcnt lgkmcnt(5)
  v_mfma_f32_16x16x32_bf16 v[76:79], v[248:251], v[128:131], v[76:79]
  v_exp_f32 v203, v83
  v_mul_f32 v206, s93, v206
  v_mul_f32 v207, s93, v207
  v_cvt_pk_bf16_f32 v110, v204, v205
  v_cvt_pk_bf16_f32 v111, v206, v207
  v_mfma_f32_16x16x32_bf16 v[76:79], v[252:255], v[132:135], v[76:79]
  ds_read_b128 v[236:239], v8 offset:38656
  v_add_u32 v2, 102400, v1
  v_mfma_f32_16x16x32_bf16 v[52:55], v[244:247], v[100:103], v[52:55]
  ds_read_b128 v[240:243], v7 offset:30720
  v_mov_b32 v192, 0x3f803f80
  v_mfma_f32_16x16x32_bf16 v[52:55], v[248:251], v[104:107], v[52:55]
  ds_read_b128 v[244:247], v8 offset:30720
  v_mov_b32 v193, 0x3f803f80
  v_mfma_f32_16x16x32_bf16 v[52:55], v[252:255], v[108:111], v[52:55]
  ds_read_b128 v[248:251], v7 offset:30848
  s_waitcnt lgkmcnt(7)
  v_mfma_f32_16x16x32_bf16 v[48:51], v[216:219], v[88:91], v[32:35]
  v_exp_f32 v204, v76
  v_mfma_f32_16x16x32_bf16 v[48:51], v[220:223], v[92:95], v[48:51]
  ds_read_b128 v[252:255], v8 offset:30848
  v_mov_b32 v194, 0x3f803f80
  s_waitcnt lgkmcnt(6)
  v_mfma_f32_16x16x32_bf16 v[48:51], v[224:227], v[96:99], v[48:51]
  v_exp_f32 v205, v77
  v_mfma_f32_16x16x32_bf16 v[72:75], v[216:219], v[112:115], v[32:35]
  v_exp_f32 v206, v78
  v_mfma_f32_16x16x32_bf16 v[72:75], v[220:223], v[116:119], v[72:75]
  v_exp_f32 v207, v79
  v_mfma_f32_16x16x32_bf16 v[72:75], v[224:227], v[120:123], v[72:75]
  v_exp_f32 v208, v52
  v_mfma_f32_16x16x32_bf16 v[72:75], v[228:231], v[124:127], v[72:75]
  ds_read_b128 v[216:219], v7 offset:30976
  s_waitcnt lgkmcnt(5)
  v_mfma_f32_16x16x32_bf16 v[72:75], v[232:235], v[128:131], v[72:75]
  v_exp_f32 v209, v53
  v_mfma_f32_16x16x32_bf16 v[72:75], v[236:239], v[132:135], v[72:75]
  ds_read_b128 v[220:223], v8 offset:30976
  ds_read_b128 v[224:227], v7 offset:23040
  v_mfma_f32_16x16x32_bf16 v[48:51], v[228:231], v[100:103], v[48:51]
  v_exp_f32 v210, v54
  v_mfma_f32_16x16x32_bf16 v[48:51], v[232:235], v[104:107], v[48:51]
  v_exp_f32 v211, v55
  v_mfma_f32_16x16x32_bf16 v[48:51], v[236:239], v[108:111], v[48:51]
  ds_read_b128 v[228:231], v8 offset:23040
  s_waitcnt lgkmcnt(6)
  v_mfma_f32_16x16x32_bf16 v[44:47], v[240:243], v[88:91], v[32:35]
  v_exp_f32 v212, v72
  v_mfma_f32_16x16x32_bf16 v[44:47], v[244:247], v[92:95], v[44:47]
  ds_read_b128 v[232:235], v7 offset:23168
  v_mov_b32 v195, 0x3f803f80
  s_waitcnt lgkmcnt(5)
  v_mfma_f32_16x16x32_bf16 v[44:47], v[248:251], v[96:99], v[44:47]
  v_exp_f32 v213, v73
  v_mfma_f32_16x16x32_bf16 v[68:71], v[240:243], v[112:115], v[32:35]
  v_exp_f32 v214, v74
  v_mfma_f32_16x16x32_bf16 v[68:71], v[244:247], v[116:119], v[68:71]
  v_exp_f32 v215, v75
  v_mfma_f32_16x16x32_bf16 v[68:71], v[248:251], v[120:123], v[68:71]
  ds_read_b128 v[236:239], v8 offset:23168
  ds_read_b128 v[240:243], v7 offset:23296
  v_mfma_f32_16x16x32_bf16 v[68:71], v[252:255], v[124:127], v[68:71]
  ds_read_b128 v[244:247], v8 offset:23296
  s_waitcnt lgkmcnt(6)
  v_mfma_f32_16x16x32_bf16 v[68:71], v[216:219], v[128:131], v[68:71]
  ds_read_b128 v[248:251], v7 offset:15360
  v_cvt_pk_bf16_f32 v166, v196, v197
  v_mfma_f32_16x16x32_bf16 v[68:71], v[220:223], v[132:135], v[68:71]
  v_exp_f32 v196, v48
  v_mfma_f32_16x16x32_bf16 v[44:47], v[252:255], v[100:103], v[44:47]
  v_exp_f32 v197, v49
  v_mfma_f32_16x16x32_bf16 v[44:47], v[216:219], v[104:107], v[44:47]
  ds_read_b128 v[252:255], v8 offset:15360
  ds_read_b128 v[216:219], v7 offset:15488
  v_mfma_f32_16x16x32_bf16 v[44:47], v[220:223], v[108:111], v[44:47]
  ds_read_b128 v[220:223], v8 offset:15488
  s_waitcnt lgkmcnt(8)
  v_mfma_f32_16x16x32_bf16 v[40:43], v[224:227], v[88:91], v[32:35]
  v_cvt_pk_bf16_f32 v167, v198, v199
  v_cvt_pk_bf16_f32 v164, v200, v201
  v_mfma_f32_16x16x32_bf16 v[40:43], v[228:231], v[92:95], v[40:43]
  v_cvt_pk_bf16_f32 v165, v202, v203
  s_waitcnt lgkmcnt(6)
  v_mfma_f32_16x16x32_bf16 v[40:43], v[232:235], v[96:99], v[40:43]
  v_exp_f32 v198, v50
  v_mfma_f32_16x16x32_bf16 v[64:67], v[224:227], v[112:115], v[32:35]
  v_exp_f32 v199, v51
  v_mfma_f32_16x16x32_bf16 v[64:67], v[228:231], v[116:119], v[64:67]
  v_exp_f32 v200, v68
  v_mfma_f32_16x16x32_bf16 v[64:67], v[232:235], v[120:123], v[64:67]
  v_exp_f32 v201, v69
  v_mfma_f32_16x16x32_bf16 v[64:67], v[236:239], v[124:127], v[64:67]
  ds_read_b128 v[224:227], v7 offset:15616
  s_waitcnt lgkmcnt(5)
  v_mfma_f32_16x16x32_bf16 v[64:67], v[240:243], v[128:131], v[64:67]
  v_exp_f32 v202, v70
  v_mfma_f32_16x16x32_bf16 v[64:67], v[244:247], v[132:135], v[64:67]
  ds_read_b128 v[228:231], v8 offset:15616
  ds_read_b128 v[232:235], v7 offset:7680
  v_mfma_f32_16x16x32_bf16 v[40:43], v[236:239], v[100:103], v[40:43]
  v_exp_f32 v203, v71
  v_mfma_f32_16x16x32_bf16 v[40:43], v[240:243], v[104:107], v[40:43]
  ds_read_b128 v[236:239], v8 offset:7680
  ds_read_b128 v[240:243], v7 offset:7808
  v_mfma_f32_16x16x32_bf16 v[40:43], v[244:247], v[108:111], v[40:43]
  ds_read_b128 v[244:247], v8 offset:7808
  s_cbranch_vccz SL45
  s_barrier
  v_and_b32 v14, 128, v1
  buffer_load_dword v13, v14, s[8:11], 0 offen
SL45:
  s_waitcnt lgkmcnt(8)
  v_mfma_f32_16x16x32_bf16 v[36:39], v[248:251], v[88:91], v[32:35]
  v_cvt_pk_bf16_f32 v162, v204, v205
  v_cvt_pk_bf16_f32 v163, v206, v207
  v_mfma_f32_16x16x32_bf16 v[36:39], v[252:255], v[92:95], v[36:39]
  v_cvt_pk_bf16_f32 v150, v208, v209
  s_waitcnt lgkmcnt(6)
  v_mfma_f32_16x16x32_bf16 v[36:39], v[216:219], v[96:99], v[36:39]
  v_exp_f32 v204, v44
  v_mfma_f32_16x16x32_bf16 v[60:63], v[248:251], v[112:115], v[32:35]
  v_exp_f32 v205, v45
  v_mfma_f32_16x16x32_bf16 v[60:63], v[252:255], v[116:119], v[60:63]
  v_exp_f32 v206, v46
  v_mfma_f32_16x16x32_bf16 v[60:63], v[216:219], v[120:123], v[60:63]
  v_exp_f32 v207, v47
  v_mfma_f32_16x16x32_bf16 v[60:63], v[220:223], v[124:127], v[60:63]
  ds_read_b128 v[248:251], v7 offset:7936
  v_cvt_pk_bf16_f32 v151, v210, v211
  s_waitcnt lgkmcnt(5)
  v_mfma_f32_16x16x32_bf16 v[60:63], v[224:227], v[128:131], v[60:63]
  v_exp_f32 v208, v64
  v_mfma_f32_16x16x32_bf16 v[60:63], v[228:231], v[132:135], v[60:63]
  ds_read_b128 v[252:255], v8 offset:7936
  ds_read_b128 v[216:219], v7 offset:0
  v_cvt_pk_bf16_f32 v160, v212, v213
  v_mfma_f32_16x16x32_bf16 v[36:39], v[220:223], v[100:103], v[36:39]
  v_exp_f32 v209, v65
  v_mfma_f32_16x16x32_bf16 v[36:39], v[224:227], v[104:107], v[36:39]
  v_exp_f32 v210, v66
  v_mfma_f32_16x16x32_bf16 v[36:39], v[228:231], v[108:111], v[36:39]
  ds_read_b128 v[220:223], v8 offset:0
  s_cbranch_vccnz SL46
  s_barrier
SL46:
  s_waitcnt lgkmcnt(6)
  v_mfma_f32_16x16x32_bf16 v[32:35], v[232:235], v[88:91], v[32:35]
  v_exp_f32 v211, v67
  v_mfma_f32_16x16x32_bf16 v[32:35], v[236:239], v[92:95], v[32:35]
  ds_read_b128 v[224:227], v7 offset:128
  v_cvt_pk_bf16_f32 v161, v214, v215
  s_waitcnt lgkmcnt(5)
  v_mfma_f32_16x16x32_bf16 v[32:35], v[240:243], v[96:99], v[32:35]
  v_exp_f32 v212, v40
  v_mfma_f32_16x16x32_bf16 v[56:59], v[232:235], v[112:115], v[56:59]
  v_exp_f32 v213, v41
  v_mfma_f32_16x16x32_bf16 v[56:59], v[236:239], v[116:119], v[56:59]
  v_exp_f32 v214, v42
  v_mfma_f32_16x16x32_bf16 v[56:59], v[240:243], v[120:123], v[56:59]
  v_exp_f32 v215, v43
  v_mfma_f32_16x16x32_bf16 v[56:59], v[244:247], v[124:127], v[56:59]
  ds_read_b128 v[228:231], v8 offset:128
  v_cvt_pk_bf16_f32 v148, v196, v197
  s_waitcnt lgkmcnt(5)
  v_mfma_f32_16x16x32_bf16 v[56:59], v[248:251], v[128:131], v[56:59]
  ds_read_b128 v[232:235], v7 offset:256
  v_cvt_pk_bf16_f32 v149, v198, v199
  s_waitcnt lgkmcnt(5)
  v_mfma_f32_16x16x32_bf16 v[56:59], v[252:255], v[132:135], v[56:59]
  ds_read_b128 v[236:239], v8 offset:256
  ds_read_b128 v[240:243], v20 offset:0
  v_cvt_pk_bf16_f32 v158, v200, v201
  v_mfma_f32_16x16x32_bf16 v[32:35], v[244:247], v[100:103], v[32:35]
  v_exp_f32 v196, v60
  v_mfma_f32_16x16x32_bf16 v[32:35], v[248:251], v[104:107], v[32:35]
  v_exp_f32 v197, v61
  v_mfma_f32_16x16x32_bf16 v[32:35], v[252:255], v[108:111], v[32:35]
  ds_read_b128 v[244:247], v0 offset:0
  s_waitcnt lgkmcnt(6)
  v_mfma_f32_16x16x32_bf16 v[28:31], v[216:219], v[88:91], v[28:31]
  v_exp_f32 v198, v62
  v_mfma_f32_16x16x32_bf16 v[28:31], v[220:223], v[92:95], v[28:31]
  ds_read_b128 v[248:251], v20 offset:128
  v_cvt_pk_bf16_f32 v159, v202, v203
  s_waitcnt lgkmcnt(5)
  v_mfma_f32_16x16x32_bf16 v[28:31], v[224:227], v[96:99], v[28:31]
  v_exp_f32 v199, v63
  v_mfma_f32_16x16x32_bf16 v[28:31], v[228:231], v[100:103], v[28:31]
  ds_read_b128 v[252:255], v0 offset:128
  v_cvt_pk_bf16_f32 v146, v204, v205
  s_waitcnt lgkmcnt(5)
  v_mfma_f32_16x16x32_bf16 v[28:31], v[232:235], v[104:107], v[28:31]
  ds_read_b128 v[216:219], v20 offset:256
  v_cvt_pk_bf16_f32 v147, v206, v207
  s_waitcnt lgkmcnt(5)
  v_mfma_f32_16x16x32_bf16 v[28:31], v[236:239], v[108:111], v[28:31]
  ds_read_b128 v[220:223], v0 offset:256
  v_cvt_pk_bf16_f32 v156, v208, v209
  s_waitcnt lgkmcnt(5)
  v_mfma_f32_16x16x32_bf16 v[24:27], v[240:243], v[88:91], v[24:27]
  ds_read_b64_tr_b16 v[224:225], v9 offset:53760
  ds_read_b64_tr_b16 v[226:227], v9 offset:61440
  v_cvt_pk_bf16_f32 v157, v210, v211
  s_waitcnt lgkmcnt(5)
  v_mfma_f32_16x16x32_bf16 v[24:27], v[244:247], v[92:95], v[24:27]
  ds_read_b64_tr_b16 v[228:229], v10 offset:53760
  ds_read_b64_tr_b16 v[230:231], v10 offset:61440
  v_cvt_pk_bf16_f32 v144, v212, v213
  v_mfma_f32_16x16x32_bf16 v[24:27], v[248:251], v[96:99], v[24:27]
  ds_read_b64_tr_b16 v[232:233], v11 offset:53760
  ds_read_b64_tr_b16 v[234:235], v11 offset:61440
  v_cvt_pk_bf16_f32 v145, v214, v215
  v_cvt_pk_bf16_f32 v154, v196, v197
  v_cvt_pk_bf16_f32 v155, v198, v199
  v_exp_f32 v200, v36
  v_exp_f32 v201, v37
  v_exp_f32 v202, v38
  v_exp_f32 v203, v39
  v_cvt_pk_bf16_f32 v142, v200, v201
  v_cvt_pk_bf16_f32 v143, v202, v203
  v_exp_f32 v204, v56
  v_exp_f32 v205, v57
  v_exp_f32 v206, v58
  v_exp_f32 v207, v59
  v_cvt_pk_bf16_f32 v152, v204, v205
  v_cvt_pk_bf16_f32 v153, v206, v207
  v_mfma_f32_16x16x32_bf16 v[188:191], v[192:195], v[164:167], 0
  v_exp_f32 v208, v32
  v_mfma_f32_16x16x32_bf16 v[188:191], v[192:195], v[160:163], v[188:191]
  v_exp_f32 v209, v33
  v_mfma_f32_16x16x32_bf16 v[188:191], v[192:195], v[156:159], v[188:191]
  v_exp_f32 v210, v34
  v_mfma_f32_16x16x32_bf16 v[188:191], v[192:195], v[152:155], v[188:191]
  ds_read_b64_tr_b16 v[236:237], v12 offset:53760
  ds_read_b64_tr_b16 v[238:239], v12 offset:61440
  s_waitcnt lgkmcnt(9)
  v_mfma_f32_16x16x32_bf16 v[24:27], v[252:255], v[100:103], v[24:27]
  v_exp_f32 v211, v35
  v_mfma_f32_16x16x32_bf16 v[24:27], v[216:219], v[104:107], v[24:27]
  ds_read_b64_tr_b16 v[240:241], v9 offset:53888
  ds_read_b64_tr_b16 v[242:243], v9 offset:61568
  s_waitcnt lgkmcnt(8)
  v_mfma_f32_16x16x32_bf16 v[24:27], v[220:223], v[108:111], v[24:27]
  ds_read_b64_tr_b16 v[244:245], v10 offset:53888
  ds_read_b64_tr_b16 v[246:247], v10 offset:61568
  v_subrev_u32 v23, 813694976, v188
  s_mov_b32 s52, 503316480
  v_cmp_gt_u32 s[48:49], s52, v23
  s_or_b64 s[48:49], s[48:49], s[44:45]
  s_cmp_eq_u64 s[48:49], -1
  s_cbranch_scc0 FB1
FBR1:
  s_cbranch_vccnz SL47
  s_barrier
SL47:
  v_mfma_f32_16x16x32_bf16 v[88:91], v[224:227], v[164:167], 0
  ds_read_b64_tr_b16 v[248:249], v11 offset:53888
  ds_read_b64_tr_b16 v[250:251], v11 offset:61568
  v_cvt_pk_bf16_f32 v140, v208, v209
  s_waitcnt lgkmcnt(8)
  v_mfma_f32_16x16x32_bf16 v[92:95], v[228:231], v[164:167], 0
  ds_read_b64_tr_b16 v[252:253], v12 offset:53888
  ds_read_b64_tr_b16 v[254:255], v12 offset:61568
  v_cvt_pk_bf16_f32 v141, v210, v211
  v_mfma_f32_16x16x32_bf16 v[96:99], v[232:235], v[164:167], 0
  ds_read_b64_tr_b16 v[216:217], v9 offset:54016
  ds_read_b64_tr_b16 v[218:219], v9 offset:61696
  v_exp_f32 v212, v28
  s_waitcnt lgkmcnt(8)
  v_mfma_f32_16x16x32_bf16 v[100:103], v[236:239], v[164:167], 0
  ds_read_b64_tr_b16 v[220:221], v10 offset:54016
  ds_read_b64_tr_b16 v[222:223], v10 offset:61696
  v_exp_f32 v213, v29
  v_mfma_f32_16x16x32_bf16 v[104:107], v[240:243], v[164:167], 0
  ds_read_b64_tr_b16 v[224:225], v11 offset:54016
  ds_read_b64_tr_b16 v[226:227], v11 offset:61696
  s_waitcnt lgkmcnt(8)
  v_mfma_f32_16x16x32_bf16 v[108:111], v[244:247], v[164:167], 0
  ds_read_b64_tr_b16 v[228:229], v12 offset:54016
  ds_read_b64_tr_b16 v[230:231], v12 offset:61696
  v_mfma_f32_16x16x32_bf16 v[112:115], v[248:251], v[164:167], 0
  ds_read_b64_tr_b16 v[232:233], v9 offset:38400
  ds_read_b64_tr_b16 v[234:235], v9 offset:46080
  s_waitcnt lgkmcnt(8)
  v_mfma_f32_16x16x32_bf16 v[116:119], v[252:255], v[164:167], 0
  ds_read_b64_tr_b16 v[236:237], v10 offset:38400
  ds_read_b64_tr_b16 v[238:239], v10 offset:46080
  v_mfma_f32_16x16x32_bf16 v[120:123], v[216:219], v[164:167], 0
  ds_read_b64_tr_b16 v[240:241], v11 offset:38400
  ds_read_b64_tr_b16 v[242:243], v11 offset:46080
  s_waitcnt lgkmcnt(8)
  v_mfma_f32_16x16x32_bf16 v[124:127], v[220:223], v[164:167], 0
  ds_read_b64_tr_b16 v[244:245], v12 offset:38400
  ds_read_b64_tr_b16 v[246:247], v12 offset:46080
  v_mfma_f32_16x16x32_bf16 v[128:131], v[224:227], v[164:167], 0
  ds_read_b64_tr_b16 v[248:249], v9 offset:38528
  ds_read_b64_tr_b16 v[250:251], v9 offset:46208
  s_waitcnt lgkmcnt(8)
  v_mfma_f32_16x16x32_bf16 v[132:135], v[228:231], v[164:167], 0
  ds_read_b64_tr_b16 v[252:253], v10 offset:38528
  ds_read_b64_tr_b16 v[254:255], v10 offset:46208
  v_exp_f32 v214, v30
  v_exp_f32 v215, v31
  v_cvt_pk_bf16_f32 v138, v212, v213
  v_cvt_pk_bf16_f32 v139, v214, v215
  v_exp_f32 v196, v24
  v_exp_f32 v197, v25
  v_exp_f32 v198, v26
  v_exp_f32 v199, v27
  v_cvt_pk_bf16_f32 v136, v196, v197
  v_cvt_pk_bf16_f32 v137, v198, v199
  v_mfma_f32_16x16x32_bf16 v[184:187], v[192:195], v[148:151], 0
  ds_read_b64_tr_b16 v[216:217], v11 offset:38528
  ds_read_b64_tr_b16 v[218:219], v11 offset:46208
  v_mfma_f32_16x16x32_bf16 v[184:187], v[192:195], v[144:147], v[184:187]
  ds_read_b64_tr_b16 v[220:221], v12 offset:38528
  ds_read_b64_tr_b16 v[222:223], v12 offset:46208
  v_mfma_f32_16x16x32_bf16 v[184:187], v[192:195], v[140:143], v[184:187]
  v_mfma_f32_16x16x32_bf16 v[184:187], v[192:195], v[136:139], v[184:187]
  s_nop 7
  v_subrev_u32 v23, 813694976, v184
  s_mov_b32 s52, 503316480
  v_cmp_gt_u32 s[48:49], s52, v23
  s_or_b64 s[48:49], s[48:49], s[42:43]
  s_cmp_eq_u64 s[48:49], -1
  s_cbranch_scc0 FB0
FBR0:
  v_mfma_f32_16x16x32_bf16 v[88:91], v[232:235], v[160:163], v[88:91]
  v_rcp_f32 v23, v188
  v_mfma_f32_16x16x32_bf16 v[24:27], v[232:235], v[148:151], 0
  s_waitcnt lgkmcnt(10)
  v_mfma_f32_16x16x32_bf16 v[92:95], v[236:239], v[160:163], v[92:95]
  v_rcp_f32 v22, v184
  v_mfma_f32_16x16x32_bf16 v[28:31], v[236:239], v[148:151], 0
  ds_read_b64_tr_b16 v[224:225], v9 offset:38656
  ds_read_b64_tr_b16 v[226:227], v9 offset:46336
  v_mfma_f32_16x16x32_bf16 v[96:99], v[240:243], v[160:163], v[96:99]
  ds_read_b64_tr_b16 v[228:229], v10 offset:38656
  ds_read_b64_tr_b16 v[230:231], v10 offset:46336
  v_mfma_f32_16x16x32_bf16 v[32:35], v[240:243], v[148:151], 0
  s_waitcnt lgkmcnt(10)
  v_mfma_f32_16x16x32_bf16 v[100:103], v[244:247], v[160:163], v[100:103]
  ds_read_b64_tr_b16 v[232:233], v11 offset:38656
  ds_read_b64_tr_b16 v[234:235], v11 offset:46336
  v_mfma_f32_16x16x32_bf16 v[36:39], v[244:247], v[148:151], 0
  ds_read_b64_tr_b16 v[236:237], v12 offset:38656
  ds_read_b64_tr_b16 v[238:239], v12 offset:46336
  v_mfma_f32_16x16x32_bf16 v[104:107], v[248:251], v[160:163], v[104:107]
  v_mfma_f32_16x16x32_bf16 v[40:43], v[248:251], v[148:151], 0
  s_waitcnt lgkmcnt(10)
  v_mfma_f32_16x16x32_bf16 v[108:111], v[252:255], v[160:163], v[108:111]
  ds_read_b64_tr_b16 v[240:241], v9 offset:23040
  ds_read_b64_tr_b16 v[242:243], v9 offset:30720
  v_mfma_f32_16x16x32_bf16 v[44:47], v[252:255], v[148:151], 0
  ds_read_b64_tr_b16 v[244:245], v10 offset:23040
  ds_read_b64_tr_b16 v[246:247], v10 offset:30720
  v_mfma_f32_16x16x32_bf16 v[112:115], v[216:219], v[160:163], v[112:115]
  v_mfma_f32_16x16x32_bf16 v[48:51], v[216:219], v[148:151], 0
  s_waitcnt lgkmcnt(10)
  v_mfma_f32_16x16x32_bf16 v[116:119], v[220:223], v[160:163], v[116:119]
  ds_read_b64_tr_b16 v[248:249], v11 offset:23040
  ds_read_b64_tr_b16 v[250:251], v11 offset:30720
  v_mfma_f32_16x16x32_bf16 v[52:55], v[220:223], v[148:151], 0
  ds_read_b64_tr_b16 v[252:253], v12 offset:23040
  ds_read_b64_tr_b16 v[254:255], v12 offset:30720
  v_mfma_f32_16x16x32_bf16 v[120:123], v[224:227], v[160:163], v[120:123]
  v_mfma_f32_16x16x32_bf16 v[56:59], v[224:227], v[148:151], 0
  s_waitcnt lgkmcnt(10)
  v_mfma_f32_16x16x32_bf16 v[124:127], v[228:231], v[160:163], v[124:127]
  ds_read_b64_tr_b16 v[216:217], v9 offset:23168
  ds_read_b64_tr_b16 v[218:219], v9 offset:30848
  v_mfma_f32_16x16x32_bf16 v[60:63], v[228:231], v[148:151], 0
  ds_read_b64_tr_b16 v[220:221], v10 offset:23168
  ds_read_b64_tr_b16 v[222:223], v10 offset:30848
  v_mfma_f32_16x16x32_bf16 v[128:131], v[232:235], v[160:163], v[128:131]
  v_mfma_f32_16x16x32_bf16 v[64:67], v[232:235], v[148:151], 0
  s_waitcnt lgkmcnt(10)
  v_mfma_f32_16x16x32_bf16 v[132:135], v[236:239], v[160:163], v[132:135]
  ds_read_b64_tr_b16 v[224:225], v11 offset:23168
  ds_read_b64_tr_b16 v[226:227], v11 offset:30848
  v_mfma_f32_16x16x32_bf16 v[68:71], v[236:239], v[148:151], 0
  ds_read_b64_tr_b16 v[228:229], v12 offset:23168
  ds_read_b64_tr_b16 v[230:231], v12 offset:30848
  s_cbranch_vccz SL48
  s_barrier
  s_mov_b32 s53, 0x40000
  s_mov_b32 s46, 72
NPOLL:
  s_waitcnt vmcnt(0)
  v_cmp_le_u32 s[48:49], s46, v13
  s_sub_u32 s53, s53, 1
  s_cbranch_scc1 NPOLLD
  s_cmp_eq_u64 s[48:49], -1
  s_cbranch_scc1 NPOLLD
  buffer_load_dword v13, v14, s[8:11], 0 offen sc1
  s_branch NPOLL
NPOLLD:
  s_add_u32 m0, s40, 0
  s_add_u32 s100, s40, 30720
  buffer_load_dwordx4 v1, s[20:23], s100 offen sc1 lds
  s_add_u32 m0, s40, 4096
  s_add_u32 s100, s40, 34816
  buffer_load_dwordx4 v1, s[20:23], s100 offen sc1 lds
  s_min_u32 s51, s40, 1024
  s_add_u32 m0, s51, 8192
  s_add_u32 s100, s51, 38912
  buffer_load_dwordx4 v1, s[20:23], s100 offen sc1 lds
  s_add_u32 m0, s40, 133120
  s_add_u32 s100, s40, 0
  buffer_load_dwordx4 v1, s[20:23], s100 offen sc1 lds
  s_add_u32 m0, s40, 137216
  s_add_u32 s100, s40, 4096
  buffer_load_dwordx4 v1, s[20:23], s100 offen sc1 lds
  s_add_u32 m0, s40, 141312
  s_add_u32 s100, s40, 8192
  buffer_load_dwordx4 v1, s[20:23], s100 offen sc1 lds
  s_add_u32 m0, s40, 145408
  s_add_u32 s100, s40, 12288
  buffer_load_dwordx4 v1, s[20:23], s100 offen sc1 lds
  s_add_u32 m0, s40, 149504
  s_add_u32 s100, s40, 16384
  buffer_load_dwordx4 v1, s[20:23], s100 offen sc1 lds
  s_add_u32 m0, s40, 153600
  s_add_u32 s100, s40, 20480
  buffer_load_dwordx4 v1, s[20:23], s100 offen sc1 lds
  s_add_u32 m0, s40, 157696
  s_add_u32 s100, s40, 24576
  buffer_load_dwordx4 v1, s[20:23], s100 offen sc1 lds
  s_min_u32 s51, s40, 1024
  s_add_u32 m0, s51, 161792
  s_add_u32 s100, s51, 28672
  buffer_load_dwordx4 v1, s[20:23], s100 offen sc1 lds
SL48:
  s_cbranch_vccnz SL49
  s_barrier
SL49:
  v_mfma_f32_16x16x32_bf16 v[88:91], v[240:243], v[156:159], v[88:91]
  v_mfma_f32_16x16x32_bf16 v[24:27], v[240:243], v[144:147], v[24:27]
  s_waitcnt lgkmcnt(10)
  v_mfma_f32_16x16x32_bf16 v[92:95], v[244:247], v[156:159], v[92:95]
  ds_read_b64_tr_b16 v[232:233], v9 offset:23296
  ds_read_b64_tr_b16 v[234:235], v9 offset:30976
  v_mfma_f32_16x16x32_bf16 v[28:31], v[244:247], v[144:147], v[28:31]
  ds_read_b64_tr_b16 v[236:237], v10 offset:23296
  ds_read_b64_tr_b16 v[238:239], v10 offset:30976
  v_mfma_f32_16x16x32_bf16 v[96:99], v[248:251], v[156:159], v[96:99]
  v_mfma_f32_16x16x32_bf16 v[32:35], v[248:251], v[144:147], v[32:35]
  s_waitcnt lgkmcnt(10)
  v_mfma_f32_16x16x32_bf16 v[100:103], v[252:255], v[156:159], v[100:103]
  ds_read_b64_tr_b16 v[240:241], v11 offset:23296
  ds_read_b64_tr_b16 v[242:243], v11 offset:30976
  v_mfma_f32_16x16x32_bf16 v[36:39], v[252:255], v[144:147], v[36:39]
  ds_read_b64_tr_b16 v[244:245], v12 offset:23296
  ds_read_b64_tr_b16 v[246:247], v12 offset:30976
  v_mfma_f32_16x16x32_bf16 v[104:107], v[216:219], v[156:159], v[104:107]
  v_mfma_f32_16x16x32_bf16 v[40:43], v[216:219], v[144:147], v[40:43]
  s_waitcnt lgkmcnt(10)
  v_mfma_f32_16x16x32_bf16 v[108:111], v[220:223], v[156:159], v[108:111]
  ds_read_b64_tr_b16 v[248:249], v9 offset:7680
  ds_read_b64_tr_b16 v[250:251], v9 offset:15360
  v_mfma_f32_16x16x32_bf16 v[44:47], v[220:223], v[144:147], v[44:47]
  ds_read_b64_tr_b16 v[252:253], v10 offset:7680
  ds_read_b64_tr_b16 v[254:255], v10 offset:15360
  v_mfma_f32_16x16x32_bf16 v[112:115], v[224:227], v[156:159], v[112:115]
  v_mfma_f32_16x16x32_bf16 v[48:51], v[224:227], v[144:147], v[48:51]
  s_waitcnt lgkmcnt(10)
  v_mfma_f32_16x16x32_bf16 v[116:119], v[228:231], v[156:159], v[116:119]
  ds_read_b64_tr_b16 v[216:217], v11 offset:7680
  ds_read_b64_tr_b16 v[218:219], v11 offset:15360
  v_mfma_f32_16x16x32_bf16 v[52:55], v[228:231], v[144:147], v[52:55]
  ds_read_b64_tr_b16 v[220:221], v12 offset:7680
  ds_read_b64_tr_b16 v[222:223], v12 offset:15360
  v_mfma_f32_16x16x32_bf16 v[120:123], v[232:235], v[156:159], v[120:123]
  v_mfma_f32_16x16x32_bf16 v[56:59], v[232:235], v[144:147], v[56:59]
  s_waitcnt lgkmcnt(10)
  v_mfma_f32_16x16x32_bf16 v[124:127], v[236:239], v[156:159], v[124:127]
  ds_read_b64_tr_b16 v[224:225], v9 offset:7808
  ds_read_b64_tr_b16 v[226:227], v9 offset:15488
  v_mfma_f32_16x16x32_bf16 v[60:63], v[236:239], v[144:147], v[60:63]
  ds_read_b64_tr_b16 v[228:229], v10 offset:7808
  ds_read_b64_tr_b16 v[230:231], v10 offset:15488
  v_mfma_f32_16x16x32_bf16 v[128:131], v[240:243], v[156:159], v[128:131]
  v_mfma_f32_16x16x32_bf16 v[64:67], v[240:243], v[144:147], v[64:67]
  s_waitcnt lgkmcnt(10)
  v_mfma_f32_16x16x32_bf16 v[132:135], v[244:247], v[156:159], v[132:135]
  ds_read_b64_tr_b16 v[232:233], v11 offset:7808
  ds_read_b64_tr_b16 v[234:235], v11 offset:15488
  v_mfma_f32_16x16x32_bf16 v[68:71], v[244:247], v[144:147], v[68:71]
  ds_read_b64_tr_b16 v[236:237], v12 offset:7808
  ds_read_b64_tr_b16 v[238:239], v12 offset:15488
  v_mfma_f32_16x16x32_bf16 v[88:91], v[248:251], v[152:155], v[88:91]
  v_mfma_f32_16x16x32_bf16 v[24:27], v[248:251], v[140:143], v[24:27]
  s_waitcnt lgkmcnt(10)
  v_mfma_f32_16x16x32_bf16 v[92:95], v[252:255], v[152:155], v[92:95]
  ds_read_b64_tr_b16 v[240:241], v9 offset:7936
  ds_read_b64_tr_b16 v[242:243], v9 offset:15616
  v_mfma_f32_16x16x32_bf16 v[28:31], v[252:255], v[140:143], v[28:31]
  ds_read_b64_tr_b16 v[244:245], v10 offset:7936
  ds_read_b64_tr_b16 v[246:247], v10 offset:15616
  v_mfma_f32_16x16x32_bf16 v[96:99], v[216:219], v[152:155], v[96:99]
  v_cvt_pk_bf16_f32 v156, v88, v89
  v_cvt_pk_bf16_f32 v157, v90, v91
  v_mfma_f32_16x16x32_bf16 v[32:35], v[216:219], v[140:143], v[32:35]
  v_cvt_pk_bf16_f32 v158, v92, v93
  s_waitcnt lgkmcnt(10)
  v_mfma_f32_16x16x32_bf16 v[100:103], v[220:223], v[152:155], v[100:103]
  ds_read_b64_tr_b16 v[248:249], v11 offset:7936
  ds_read_b64_tr_b16 v[250:251], v11 offset:15616
  v_mfma_f32_16x16x32_bf16 v[36:39], v[220:223], v[140:143], v[36:39]
  ds_read_b64_tr_b16 v[252:253], v12 offset:7936
  ds_read_b64_tr_b16 v[254:255], v12 offset:15616
  v_mfma_f32_16x16x32_bf16 v[104:107], v[224:227], v[152:155], v[104:107]
  v_cvt_pk_bf16_f32 v159, v94, v95
  v_cvt_pk_bf16_f32 v160, v96, v97
  v_mfma_f32_16x16x32_bf16 v[40:43], v[224:227], v[140:143], v[40:43]
  v_cvt_pk_bf16_f32 v161, v98, v99
  s_waitcnt lgkmcnt(10)
  v_mfma_f32_16x16x32_bf16 v[108:111], v[228:231], v[152:155], v[108:111]
  ds_read_b64_tr_b16 v[216:217], v15 offset:0
  ds_read_b64_tr_b16 v[218:219], v9 offset:0
  v_mfma_f32_16x16x32_bf16 v[44:47], v[228:231], v[140:143], v[44:47]
  ds_read_b64_tr_b16 v[220:221], v16 offset:0
  ds_read_b64_tr_b16 v[222:223], v10 offset:0
  v_mfma_f32_16x16x32_bf16 v[112:115], v[232:235], v[152:155], v[112:115]
  v_cvt_pk_bf16_f32 v162, v100, v101
  v_cvt_pk_bf16_f32 v163, v102, v103
  v_mfma_f32_16x16x32_bf16 v[48:51], v[232:235], v[140:143], v[48:51]
  v_cvt_pk_bf16_f32 v164, v104, v105
  s_waitcnt lgkmcnt(10)
  v_mfma_f32_16x16x32_bf16 v[116:119], v[236:239], v[152:155], v[116:119]
  ds_read_b64_tr_b16 v[224:225], v17 offset:0
  ds_read_b64_tr_b16 v[226:227], v11 offset:0
  v_mfma_f32_16x16x32_bf16 v[52:55], v[236:239], v[140:143], v[52:55]
  ds_read_b64_tr_b16 v[228:229], v18 offset:0
  ds_read_b64_tr_b16 v[230:231], v12 offset:0
  v_mfma_f32_16x16x32_bf16 v[120:123], v[240:243], v[152:155], v[120:123]
  v_cvt_pk_bf16_f32 v165, v106, v107
  v_cvt_pk_bf16_f32 v166, v108, v109
  v_mfma_f32_16x16x32_bf16 v[56:59], v[240:243], v[140:143], v[56:59]
  v_cvt_pk_bf16_f32 v167, v110, v111
  s_waitcnt lgkmcnt(10)
  v_mfma_f32_16x16x32_bf16 v[124:127], v[244:247], v[152:155], v[124:127]
  ds_read_b64_tr_b16 v[232:233], v15 offset:128
  ds_read_b64_tr_b16 v[234:235], v9 offset:128
  v_mfma_f32_16x16x32_bf16 v[60:63], v[244:247], v[140:143], v[60:63]
  ds_read_b64_tr_b16 v[236:237], v16 offset:128
  ds_read_b64_tr_b16 v[238:239], v10 offset:128
  v_mfma_f32_16x16x32_bf16 v[128:131], v[248:251], v[152:155], v[128:131]
  v_cvt_pk_bf16_f32 v176, v112, v113
  v_cvt_pk_bf16_f32 v177, v114, v115
  v_mfma_f32_16x16x32_bf16 v[64:67], v[248:251], v[140:143], v[64:67]
  v_cvt_pk_bf16_f32 v178, v116, v117
  s_waitcnt lgkmcnt(10)
  v_mfma_f32_16x16x32_bf16 v[132:135], v[252:255], v[152:155], v[132:135]
  ds_read_b64_tr_b16 v[240:241], v17 offset:128
  ds_read_b64_tr_b16 v[242:243], v11 offset:128
  v_mfma_f32_16x16x32_bf16 v[68:71], v[252:255], v[140:143], v[68:71]
  ds_read_b64_tr_b16 v[244:245], v18 offset:128
  ds_read_b64_tr_b16 v[246:247], v12 offset:128
  v_mfma_f32_16x16x32_bf16 v[24:27], v[216:219], v[136:139], v[24:27]
  v_cvt_pk_bf16_f32 v179, v118, v119
  s_waitcnt lgkmcnt(10)
  v_mfma_f32_16x16x32_bf16 v[28:31], v[220:223], v[136:139], v[28:31]
  ds_read_b64_tr_b16 v[248:249], v15 offset:256
  ds_read_b64_tr_b16 v[250:251], v9 offset:256
  v_mfma_f32_16x16x32_bf16 v[32:35], v[224:227], v[136:139], v[32:35]
  ds_read_b64_tr_b16 v[252:253], v16 offset:256
  ds_read_b64_tr_b16 v[254:255], v10 offset:256
  s_waitcnt lgkmcnt(10)
  v_mfma_f32_16x16x32_bf16 v[36:39], v[228:231], v[136:139], v[36:39]
  ds_read_b64_tr_b16 v[216:217], v17 offset:256
  ds_read_b64_tr_b16 v[218:219], v11 offset:256
  v_mfma_f32_16x16x32_bf16 v[40:43], v[232:235], v[136:139], v[40:43]
  ds_read_b64_tr_b16 v[220:221], v18 offset:256
  ds_read_b64_tr_b16 v[222:223], v12 offset:256
  s_waitcnt lgkmcnt(10)
  v_mfma_f32_16x16x32_bf16 v[44:47], v[236:239], v[136:139], v[44:47]
  v_cvt_pk_bf16_f32 v180, v120, v121
  v_cvt_pk_bf16_f32 v181, v122, v123
  s_waitcnt lgkmcnt(0)
  s_cbranch_vccz SL50
  s_waitcnt vmcnt(0)
  s_barrier
  s_add_u32 m0, s40, 102400
  s_add_u32 s100, s40, 40960
  buffer_load_dwordx4 v1, s[20:23], s100 offen sc1 lds
  s_add_u32 m0, s40, 106496
  s_add_u32 s100, s40, 45056
  buffer_load_dwordx4 v1, s[20:23], s100 offen sc1 lds
  s_add_u32 m0, s40, 110592
  s_add_u32 s100, s40, 49152
  buffer_load_dwordx4 v1, s[20:23], s100 offen sc1 lds
  s_add_u32 m0, s40, 114688
  s_add_u32 s100, s40, 53248
  buffer_load_dwordx4 v1, s[20:23], s100 offen sc1 lds
  s_add_u32 m0, s40, 118784
  s_add_u32 s100, s40, 57344
  buffer_load_dwordx4 v1, s[20:23], s100 offen sc1 lds
  s_add_u32 m0, s40, 122880
  s_add_u32 s100, s40, 61440
  buffer_load_dwordx4 v1, s[20:23], s100 offen sc1 lds
  s_add_u32 m0, s40, 126976
  s_add_u32 s100, s40, 65536
  buffer_load_dwordx4 v1, s[20:23], s100 offen sc1 lds
  s_min_u32 s51, s40, 1024
  s_add_u32 m0, s51, 131072
  s_add_u32 s100, s51, 69632
  buffer_load_dwordx4 v1, s[20:23], s100 offen sc1 lds
SL50:
  ds_read_b128 v[224:227], v2 offset:30720
  ds_read_b128 v[228:231], v2 offset:31744
  ds_read_b128 v[232:235], v2 offset:32768
  ds_read_b128 v[236:239], v2 offset:33792
  v_mfma_f32_16x16x32_bf16 v[48:51], v[240:243], v[136:139], v[48:51]
  ds_read_b128 v[240:243], v2 offset:34816
  v_cvt_pk_bf16_f32 v182, v124, v125
  v_mfma_f32_16x16x32_bf16 v[52:55], v[244:247], v[136:139], v[52:55]
  ds_read_b128 v[244:247], v2 offset:35840
  v_cvt_pk_bf16_f32 v183, v126, v127
  v_mfma_f32_16x16x32_bf16 v[56:59], v[248:251], v[136:139], v[56:59]
  ds_read_b128 v[248:251], v2 offset:36864
  v_cvt_pk_bf16_f32 v72, v128, v129
  v_mfma_f32_16x16x32_bf16 v[60:63], v[252:255], v[136:139], v[60:63]
  ds_read_b128 v[252:255], v2 offset:37888
  v_cvt_pk_bf16_f32 v73, v130, v131
  v_mfma_f32_16x16x32_bf16 v[64:67], v[216:219], v[136:139], v[64:67]
  ds_read_b128 v[216:219], v2 offset:38912
  v_cvt_pk_bf16_f32 v74, v132, v133
  v_mfma_f32_16x16x32_bf16 v[68:71], v[220:223], v[136:139], v[68:71]
  ds_read_b128 v[220:223], v2 offset:39936
  v_cvt_pk_bf16_f32 v75, v134, v135
  v_cvt_pk_bf16_f32 v140, v24, v25
  v_cvt_pk_bf16_f32 v141, v26, v27
  v_cvt_pk_bf16_f32 v142, v28, v29
  v_cvt_pk_bf16_f32 v143, v30, v31
  s_waitcnt lgkmcnt(8)
  s_nop 0
  v_mfma_f32_16x16x32_bf16 v[184:187], v[224:227], v[140:143], 0
  v_cvt_pk_bf16_f32 v144, v32, v33
  v_cvt_pk_bf16_f32 v145, v34, v35
  v_cvt_pk_bf16_f32 v146, v36, v37
  v_cvt_pk_bf16_f32 v147, v38, v39
  s_nop 1
  v_mfma_f32_16x16x32_bf16 v[184:187], v[228:231], v[144:147], v[184:187]
  v_cvt_pk_bf16_f32 v148, v40, v41
  v_cvt_pk_bf16_f32 v149, v42, v43
  v_cvt_pk_bf16_f32 v150, v44, v45
  v_cvt_pk_bf16_f32 v151, v46, v47
  s_waitcnt lgkmcnt(6)
  s_nop 0
  v_mfma_f32_16x16x32_bf16 v[184:187], v[232:235], v[148:151], v[184:187]
  v_cvt_pk_bf16_f32 v168, v48, v49
  v_cvt_pk_bf16_f32 v169, v50, v51
  v_mfma_f32_16x16x32_bf16 v[192:195], v[224:227], v[156:159], 0
  ds_read_b128 v[224:227], v2 offset:40960
  v_cvt_pk_bf16_f32 v170, v52, v53
  v_mfma_f32_16x16x32_bf16 v[192:195], v[228:231], v[160:163], v[192:195]
  ds_read_b128 v[228:231], v2 offset:41984
  v_cvt_pk_bf16_f32 v171, v54, v55
  v_mfma_f32_16x16x32_bf16 v[192:195], v[232:235], v[164:167], v[192:195]
  ds_read_b128 v[232:235], v2 offset:43008
  v_cvt_pk_bf16_f32 v172, v56, v57
  v_mfma_f32_16x16x32_bf16 v[192:195], v[236:239], v[176:179], v[192:195]
  v_cvt_pk_bf16_f32 v173, v58, v59
  v_cvt_pk_bf16_f32 v174, v60, v61
  v_cvt_pk_bf16_f32 v175, v62, v63
  s_waitcnt lgkmcnt(7)
  v_mfma_f32_16x16x32_bf16 v[192:195], v[240:243], v[180:183], v[192:195]
  v_cvt_pk_bf16_f32 v152, v64, v65
  v_cvt_pk_bf16_f32 v153, v66, v67
  v_cvt_pk_bf16_f32 v154, v68, v69
  v_cvt_pk_bf16_f32 v155, v70, v71
  v_mfma_f32_16x16x32_bf16 v[192:195], v[244:247], v[72:75], v[192:195]
  v_mfma_f32_16x16x32_bf16 v[184:187], v[236:239], v[168:171], v[184:187]
  ds_read_b128 v[236:239], v2 offset:44032
  v_mfma_f32_16x16x32_bf16 v[184:187], v[240:243], v[172:175], v[184:187]
  ds_read_b128 v[240:243], v2 offset:45056
  v_mfma_f32_16x16x32_bf16 v[184:187], v[244:247], v[152:155], v[184:187]
  ds_read_b128 v[244:247], v2 offset:46080
  s_waitcnt lgkmcnt(8)
  v_mfma_f32_16x16x32_bf16 v[188:191], v[248:251], v[140:143], 0
  v_mul_f32 v192, v192, v23
  v_mul_f32 v193, v193, v23
  v_mfma_f32_16x16x32_bf16 v[188:191], v[252:255], v[144:147], v[188:191]
  v_mul_f32 v194, v194, v23
  s_waitcnt lgkmcnt(6)
  v_mfma_f32_16x16x32_bf16 v[188:191], v[216:219], v[148:151], v[188:191]
  v_mul_f32 v195, v195, v23
  v_cvt_pk_bf16_f32 v28, v192, v193
  v_mfma_f32_16x16x32_bf16 v[196:199], v[248:251], v[156:159], 0
  ds_read_b128 v[248:251], v2 offset:47104
  v_cvt_pk_bf16_f32 v29, v194, v195
  v_mfma_f32_16x16x32_bf16 v[196:199], v[252:255], v[160:163], v[196:199]
  ds_read_b128 v[252:255], v2 offset:48128
  v_mul_f32 v184, v184, v22
  v_mfma_f32_16x16x32_bf16 v[196:199], v[216:219], v[164:167], v[196:199]
  ds_read_b128 v[216:219], v2 offset:49152
  v_mul_f32 v185, v185, v22
  v_mfma_f32_16x16x32_bf16 v[196:199], v[220:223], v[176:179], v[196:199]
  v_mul_f32 v186, v186, v22
  s_waitcnt lgkmcnt(7)
  v_mfma_f32_16x16x32_bf16 v[196:199], v[224:227], v[180:183], v[196:199]
  v_mul_f32 v187, v187, v22
  v_cvt_pk_bf16_f32 v24, v184, v185
  v_mfma_f32_16x16x32_bf16 v[196:199], v[228:231], v[72:75], v[196:199]
  v_cvt_pk_bf16_f32 v25, v186, v187
  v_mfma_f32_16x16x32_bf16 v[188:191], v[220:223], v[168:171], v[188:191]
  ds_read_b128 v[220:223], v2 offset:50176
  v_mfma_f32_16x16x32_bf16 v[188:191], v[224:227], v[172:175], v[188:191]
  ds_read_b128 v[224:227], v2 offset:51200
  v_mfma_f32_16x16x32_bf16 v[188:191], v[228:231], v[152:155], v[188:191]
  ds_read_b128 v[228:231], v2 offset:52224
  s_mov_b32 s100, 71680
  buffer_load_dwordx4 v[40:43], v1, s[20:23], s100 offen offset:0 sc1
  buffer_load_dwordx4 v[44:47], v1, s[20:23], s100 offen offset:1024 sc1
  s_waitcnt lgkmcnt(8)
  v_mfma_f32_16x16x32_bf16 v[200:203], v[232:235], v[140:143], 0
  v_mul_f32 v196, v196, v23
  v_mul_f32 v197, v197, v23
  v_mfma_f32_16x16x32_bf16 v[200:203], v[236:239], v[144:147], v[200:203]
  v_mul_f32 v198, v198, v23
  s_waitcnt lgkmcnt(6)
  v_mfma_f32_16x16x32_bf16 v[200:203], v[240:243], v[148:151], v[200:203]
  v_mul_f32 v199, v199, v23
  v_cvt_pk_bf16_f32 v30, v196, v197
  v_mfma_f32_16x16x32_bf16 v[208:211], v[232:235], v[156:159], 0
  ds_read_b128 v[232:235], v2 offset:53248
  v_cvt_pk_bf16_f32 v31, v198, v199
  v_mfma_f32_16x16x32_bf16 v[208:211], v[236:239], v[160:163], v[208:211]
  buffer_store_dwordx4 v[28:31], v6, s[16:19], 0 offen offset:0 nt sc1
  v_mul_f32 v188, v188, v22
  v_mfma_f32_16x16x32_bf16 v[208:211], v[240:243], v[164:167], v[208:211]
  ds_read_b128 v[236:239], v2 offset:54272
  v_mul_f32 v189, v189, v22
  v_mfma_f32_16x16x32_bf16 v[208:211], v[244:247], v[176:179], v[208:211]
  ds_read_b128 v[240:243], v2 offset:55296
  s_waitcnt lgkmcnt(7)
  v_mfma_f32_16x16x32_bf16 v[208:211], v[248:251], v[180:183], v[208:211]
  v_mul_f32 v190, v190, v22
  v_mul_f32 v191, v191, v22
  v_mfma_f32_16x16x32_bf16 v[208:211], v[252:255], v[72:75], v[208:211]
  v_cvt_pk_bf16_f32 v26, v188, v189
  v_cvt_pk_bf16_f32 v27, v190, v191
  v_mfma_f32_16x16x32_bf16 v[200:203], v[244:247], v[168:171], v[200:203]
  buffer_store_dwordx4 v[24:27], v5, s[16:19], 0 offen offset:0 nt sc1
  v_mfma_f32_16x16x32_bf16 v[200:203], v[248:251], v[172:175], v[200:203]
  ds_read_b128 v[244:247], v2 offset:56320
  ds_read_b128 v[248:251], v2 offset:57344
  v_mfma_f32_16x16x32_bf16 v[200:203], v[252:255], v[152:155], v[200:203]
  ds_read_b128 v[252:255], v2 offset:58368
  s_waitcnt lgkmcnt(8)
  v_mfma_f32_16x16x32_bf16 v[204:207], v[216:219], v[140:143], 0
  v_mul_f32 v208, v208, v23
  v_mul_f32 v209, v209, v23
  v_mfma_f32_16x16x32_bf16 v[204:207], v[220:223], v[144:147], v[204:207]
  v_mul_f32 v210, v210, v23
  s_waitcnt lgkmcnt(6)
  v_mfma_f32_16x16x32_bf16 v[204:207], v[224:227], v[148:151], v[204:207]
  v_mul_f32 v211, v211, v23
  v_cvt_pk_bf16_f32 v36, v208, v209
  v_mfma_f32_16x16x32_bf16 v[212:215], v[216:219], v[156:159], 0
  ds_read_b128 v[216:219], v2 offset:59392
  v_cvt_pk_bf16_f32 v37, v210, v211
  v_mfma_f32_16x16x32_bf16 v[212:215], v[220:223], v[160:163], v[212:215]
  ds_read_b128 v[220:223], v2 offset:60416
  v_mul_f32 v200, v200, v22
  v_mfma_f32_16x16x32_bf16 v[212:215], v[224:227], v[164:167], v[212:215]
  ds_read_b128 v[224:227], v1 offset:0
  v_mul_f32 v201, v201, v22
  v_mfma_f32_16x16x32_bf16 v[212:215], v[228:231], v[176:179], v[212:215]
  v_mul_f32 v202, v202, v22
  s_waitcnt lgkmcnt(7)
  v_mfma_f32_16x16x32_bf16 v[212:215], v[232:235], v[180:183], v[212:215]
  v_mul_f32 v203, v203, v22
  v_cvt_pk_bf16_f32 v32, v200, v201
  v_mfma_f32_16x16x32_bf16 v[212:215], v[236:239], v[72:75], v[212:215]
  v_cvt_pk_bf16_f32 v33, v202, v203
  v_mfma_f32_16x16x32_bf16 v[204:207], v[228:231], v[168:171], v[204:207]
  ds_read_b128 v[228:231], v1 offset:1024
  v_mfma_f32_16x16x32_bf16 v[204:207], v[232:235], v[172:175], v[204:207]
  ds_read_b128 v[232:235], v1 offset:2048
  v_mfma_f32_16x16x32_bf16 v[204:207], v[236:239], v[152:155], v[204:207]
  ds_read_b128 v[236:239], v1 offset:3072
  s_cbranch_vccz SL51
  s_waitcnt vmcnt(4)
  s_barrier
SL51:
  s_waitcnt lgkmcnt(8)
  v_mfma_f32_16x16x32_bf16 v[184:187], v[240:243], v[140:143], 0
  v_mul_f32 v212, v212, v23
  v_mul_f32 v213, v213, v23
  v_mfma_f32_16x16x32_bf16 v[184:187], v[244:247], v[144:147], v[184:187]
  v_mul_f32 v214, v214, v23
  s_waitcnt lgkmcnt(6)
  v_mfma_f32_16x16x32_bf16 v[184:187], v[248:251], v[148:151], v[184:187]
  v_mul_f32 v215, v215, v23
  v_cvt_pk_bf16_f32 v38, v212, v213
  v_mfma_f32_16x16x32_bf16 v[192:195], v[240:243], v[156:159], 0
  ds_read_b128 v[240:243], v1 offset:4096
  v_cvt_pk_bf16_f32 v39, v214, v215
  v_mfma_f32_16x16x32_bf16 v[192:195], v[244:247], v[160:163], v[192:195]
  buffer_store_dwordx4 v[36:39], v6, s[16:19], 0 offen offset:64 nt sc1
  v_mul_f32 v204, v204, v22
  v_mfma_f32_16x16x32_bf16 v[192:195], v[248:251], v[164:167], v[192:195]
  ds_read_b128 v[244:247], v1 offset:5120
  v_mul_f32 v205, v205, v22
  v_mfma_f32_16x16x32_bf16 v[192:195], v[252:255], v[176:179], v[192:195]
  ds_read_b128 v[248:251], v1 offset:6144
  s_waitcnt lgkmcnt(7)
  v_mfma_f32_16x16x32_bf16 v[192:195], v[216:219], v[180:183], v[192:195]
  v_mul_f32 v206, v206, v22
  v_mul_f32 v207, v207, v22
  v_mfma_f32_16x16x32_bf16 v[192:195], v[220:223], v[72:75], v[192:195]
  v_cvt_pk_bf16_f32 v34, v204, v205
  v_cvt_pk_bf16_f32 v35, v206, v207
  v_mfma_f32_16x16x32_bf16 v[184:187], v[252:255], v[168:171], v[184:187]
  buffer_store_dwordx4 v[32:35], v5, s[16:19], 0 offen offset:64 nt sc1
  v_mfma_f32_16x16x32_bf16 v[184:187], v[216:219], v[172:175], v[184:187]
  ds_read_b128 v[252:255], v1 offset:7168
  ds_read_b128 v[216:219], v1 offset:8192
  v_mfma_f32_16x16x32_bf16 v[184:187], v[220:223], v[152:155], v[184:187]
  ds_read_b128 v[220:223], v1 offset:9216
  s_waitcnt lgkmcnt(8)
  v_mfma_f32_16x16x32_bf16 v[188:191], v[224:227], v[140:143], 0
  v_mul_f32 v192, v192, v23
  v_mul_f32 v193, v193, v23
  v_mfma_f32_16x16x32_bf16 v[188:191], v[228:231], v[144:147], v[188:191]
  v_mul_f32 v194, v194, v23
  s_waitcnt lgkmcnt(6)
  v_mfma_f32_16x16x32_bf16 v[188:191], v[232:235], v[148:151], v[188:191]
  v_mul_f32 v195, v195, v23
  v_cvt_pk_bf16_f32 v28, v192, v193
  v_mfma_f32_16x16x32_bf16 v[196:199], v[224:227], v[156:159], 0
  ds_read_b128 v[224:227], v2 offset:0
  v_cvt_pk_bf16_f32 v29, v194, v195
  v_mfma_f32_16x16x32_bf16 v[196:199], v[228:231], v[160:163], v[196:199]
  ds_read_b128 v[228:231], v2 offset:1024
  v_mul_f32 v184, v184, v22
  v_mfma_f32_16x16x32_bf16 v[196:199], v[232:235], v[164:167], v[196:199]
  ds_read_b128 v[232:235], v2 offset:2048
  v_mul_f32 v185, v185, v22
  v_mfma_f32_16x16x32_bf16 v[196:199], v[236:239], v[176:179], v[196:199]
  v_mul_f32 v186, v186, v22
  s_waitcnt lgkmcnt(7)
  v_mfma_f32_16x16x32_bf16 v[196:199], v[240:243], v[180:183], v[196:199]
  v_mul_f32 v187, v187, v22
  v_cvt_pk_bf16_f32 v24, v184, v185
  v_mfma_f32_16x16x32_bf16 v[196:199], v[244:247], v[72:75], v[196:199]
  v_cvt_pk_bf16_f32 v25, v186, v187
  v_mfma_f32_16x16x32_bf16 v[188:191], v[236:239], v[168:171], v[188:191]
  ds_read_b128 v[236:239], v2 offset:3072
  v_mfma_f32_16x16x32_bf16 v[188:191], v[240:243], v[172:175], v[188:191]
  ds_read_b128 v[240:243], v2 offset:4096
  v_mfma_f32_16x16x32_bf16 v[188:191], v[244:247], v[152:155], v[188:191]
  ds_read_b128 v[244:247], v2 offset:5120
  s_waitcnt lgkmcnt(8)
  v_mfma_f32_16x16x32_bf16 v[200:203], v[248:251], v[140:143], 0
  v_mul_f32 v196, v196, v23
  v_mul_f32 v197, v197, v23
  v_mfma_f32_16x16x32_bf16 v[200:203], v[252:255], v[144:147], v[200:203]
  v_mul_f32 v198, v198, v23
  s_waitcnt lgkmcnt(6)
  v_mfma_f32_16x16x32_bf16 v[200:203], v[216:219], v[148:151], v[200:203]
  v_mul_f32 v199, v199, v23
  v_cvt_pk_bf16_f32 v30, v196, v197
  v_mfma_f32_16x16x32_bf16 v[208:211], v[248:251], v[156:159], 0
  ds_read_b128 v[248:251], v2 offset:6144
  v_cvt_pk_bf16_f32 v31, v198, v199
  v_mfma_f32_16x16x32_bf16 v[208:211], v[252:255], v[160:163], v[208:211]
  buffer_store_dwordx4 v[28:31], v6, s[16:19], 0 offen offset:128 nt sc1
  v_mul_f32 v188, v188, v22
  v_mfma_f32_16x16x32_bf16 v[208:211], v[216:219], v[164:167], v[208:211]
  ds_read_b128 v[252:255], v2 offset:7168
  v_mul_f32 v189, v189, v22
  v_mfma_f32_16x16x32_bf16 v[208:211], v[220:223], v[176:179], v[208:211]
  ds_read_b128 v[216:219], v2 offset:8192
  s_waitcnt lgkmcnt(7)
  v_mfma_f32_16x16x32_bf16 v[208:211], v[224:227], v[180:183], v[208:211]
  v_mul_f32 v190, v190, v22
  v_mul_f32 v191, v191, v22
  v_mfma_f32_16x16x32_bf16 v[208:211], v[228:231], v[72:75], v[208:211]
  v_cvt_pk_bf16_f32 v26, v188, v189
  v_cvt_pk_bf16_f32 v27, v190, v191
  v_mfma_f32_16x16x32_bf16 v[200:203], v[220:223], v[168:171], v[200:203]
  buffer_store_dwordx4 v[24:27], v5, s[16:19], 0 offen offset:128 nt sc1
  v_mfma_f32_16x16x32_bf16 v[200:203], v[224:227], v[172:175], v[200:203]
  ds_read_b128 v[220:223], v2 offset:9216
  ds_read_b128 v[224:227], v2 offset:10240
  v_mfma_f32_16x16x32_bf16 v[200:203], v[228:231], v[152:155], v[200:203]
  ds_read_b128 v[228:231], v2 offset:11264
  s_waitcnt lgkmcnt(8)
  v_mfma_f32_16x16x32_bf16 v[204:207], v[232:235], v[140:143], 0
  v_mul_f32 v208, v208, v23
  v_mul_f32 v209, v209, v23
  v_mfma_f32_16x16x32_bf16 v[204:207], v[236:239], v[144:147], v[204:207]
  v_mul_f32 v210, v210, v23
  s_waitcnt lgkmcnt(6)
  v_mfma_f32_16x16x32_bf16 v[204:207], v[240:243], v[148:151], v[204:207]
  v_mul_f32 v211, v211, v23
  v_cvt_pk_bf16_f32 v36, v208, v209
  v_mfma_f32_16x16x32_bf16 v[212:215], v[232:235], v[156:159], 0
  ds_read_b128 v[232:235], v2 offset:12288
  v_cvt_pk_bf16_f32 v37, v210, v211
  v_mfma_f32_16x16x32_bf16 v[212:215], v[236:239], v[160:163], v[212:215]
  ds_read_b128 v[236:239], v2 offset:13312
  v_mul_f32 v200, v200, v22
  v_mfma_f32_16x16x32_bf16 v[212:215], v[240:243], v[164:167], v[212:215]
  ds_read_b128 v[240:243], v2 offset:14336
  v_mul_f32 v201, v201, v22
  v_mfma_f32_16x16x32_bf16 v[212:215], v[244:247], v[176:179], v[212:215]
  v_mul_f32 v202, v202, v22
  s_waitcnt lgkmcnt(7)
  v_mfma_f32_16x16x32_bf16 v[212:215], v[248:251], v[180:183], v[212:215]
  v_mul_f32 v203, v203, v22
  v_cvt_pk_bf16_f32 v32, v200, v201
  v_mfma_f32_16x16x32_bf16 v[212:215], v[252:255], v[72:75], v[212:215]
  v_cvt_pk_bf16_f32 v33, v202, v203
  v_mfma_f32_16x16x32_bf16 v[204:207], v[244:247], v[168:171], v[204:207]
  ds_read_b128 v[244:247], v2 offset:15360
  v_mfma_f32_16x16x32_bf16 v[204:207], v[248:251], v[172:175], v[204:207]
  ds_read_b128 v[248:251], v2 offset:16384
  v_mfma_f32_16x16x32_bf16 v[204:207], v[252:255], v[152:155], v[204:207]
  ds_read_b128 v[252:255], v2 offset:17408
  s_waitcnt lgkmcnt(8)
  v_mfma_f32_16x16x32_bf16 v[184:187], v[216:219], v[140:143], 0
  v_mul_f32 v212, v212, v23
  v_mul_f32 v213, v213, v23
  v_mfma_f32_16x16x32_bf16 v[184:187], v[220:223], v[144:147], v[184:187]
  v_mul_f32 v214, v214, v23
  s_waitcnt lgkmcnt(6)
  v_mfma_f32_16x16x32_bf16 v[184:187], v[224:227], v[148:151], v[184:187]
  v_mul_f32 v215, v215, v23
  v_cvt_pk_bf16_f32 v38, v212, v213
  v_mfma_f32_16x16x32_bf16 v[192:195], v[216:219], v[156:159], 0
  ds_read_b128 v[216:219], v2 offset:18432
  v_cvt_pk_bf16_f32 v39, v214, v215
  v_mfma_f32_16x16x32_bf16 v[192:195], v[220:223], v[160:163], v[192:195]
  buffer_store_dwordx4 v[36:39], v6, s[16:19], 0 offen offset:192 nt sc1
  v_mul_f32 v204, v204, v22
  v_mfma_f32_16x16x32_bf16 v[192:195], v[224:227], v[164:167], v[192:195]
  ds_read_b128 v[220:223], v2 offset:19456
  v_mul_f32 v205, v205, v22
  v_mfma_f32_16x16x32_bf16 v[192:195], v[228:231], v[176:179], v[192:195]
  ds_read_b128 v[224:227], v2 offset:20480
  s_waitcnt lgkmcnt(7)
  v_mfma_f32_16x16x32_bf16 v[192:195], v[232:235], v[180:183], v[192:195]
  v_mul_f32 v206, v206, v22
  v_mul_f32 v207, v207, v22
  v_mfma_f32_16x16x32_bf16 v[192:195], v[236:239], v[72:75], v[192:195]
  v_cvt_pk_bf16_f32 v34, v204, v205
  v_cvt_pk_bf16_f32 v35, v206, v207
  v_mfma_f32_16x16x32_bf16 v[184:187], v[228:231], v[168:171], v[184:187]
  buffer_store_dwordx4 v[32:35], v5, s[16:19], 0 offen offset:192 nt sc1
  v_mfma_f32_16x16x32_bf16 v[184:187], v[232:235], v[172:175], v[184:187]
  ds_read_b128 v[228:231], v2 offset:21504
  ds_read_b128 v[232:235], v2 offset:22528
  v_mfma_f32_16x16x32_bf16 v[184:187], v[236:239], v[152:155], v[184:187]
  ds_read_b128 v[236:239], v2 offset:23552
  s_waitcnt lgkmcnt(8)
  v_mfma_f32_16x16x32_bf16 v[188:191], v[240:243], v[140:143], 0
  v_mul_f32 v192, v192, v23
  v_mul_f32 v193, v193, v23
  v_mfma_f32_16x16x32_bf16 v[188:191], v[244:247], v[144:147], v[188:191]
  v_mul_f32 v194, v194, v23
  s_waitcnt lgkmcnt(6)
  v_mfma_f32_16x16x32_bf16 v[188:191], v[248:251], v[148:151], v[188:191]
  v_mul_f32 v195, v195, v23
  v_cvt_pk_bf16_f32 v28, v192, v193
  v_mfma_f32_16x16x32_bf16 v[196:199], v[240:243], v[156:159], 0
  ds_read_b128 v[240:243], v2 offset:24576
  v_cvt_pk_bf16_f32 v29, v194, v195
  v_mfma_f32_16x16x32_bf16 v[196:199], v[244:247], v[160:163], v[196:199]
  ds_read_b128 v[244:247], v2 offset:25600
  v_mul_f32 v184, v184, v22
  v_mfma_f32_16x16x32_bf16 v[196:199], v[248:251], v[164:167], v[196:199]
  ds_read_b128 v[248:251], v2 offset:26624
  v_mul_f32 v185, v185, v22
  v_mfma_f32_16x16x32_bf16 v[196:199], v[252:255], v[176:179], v[196:199]
  v_mul_f32 v186, v186, v22
  s_waitcnt lgkmcnt(7)
  v_mfma_f32_16x16x32_bf16 v[196:199], v[216:219], v[180:183], v[196:199]
  v_mul_f32 v187, v187, v22
  v_cvt_pk_bf16_f32 v24, v184, v185
  v_mfma_f32_16x16x32_bf16 v[196:199], v[220:223], v[72:75], v[196:199]
  v_cvt_pk_bf16_f32 v25, v186, v187
  v_mfma_f32_16x16x32_bf16 v[188:191], v[252:255], v[168:171], v[188:191]
  ds_read_b128 v[252:255], v2 offset:27648
  v_mfma_f32_16x16x32_bf16 v[188:191], v[216:219], v[172:175], v[188:191]
  ds_read_b128 v[216:219], v2 offset:28672
  v_mfma_f32_16x16x32_bf16 v[188:191], v[220:223], v[152:155], v[188:191]
  ds_read_b128 v[220:223], v2 offset:29696
  s_waitcnt vmcnt(8)
  s_waitcnt lgkmcnt(8)
  v_mfma_f32_16x16x32_bf16 v[200:203], v[224:227], v[140:143], 0
  v_mul_f32 v196, v196, v23
  v_mul_f32 v197, v197, v23
  v_mfma_f32_16x16x32_bf16 v[200:203], v[228:231], v[144:147], v[200:203]
  v_mul_f32 v198, v198, v23
  s_waitcnt lgkmcnt(6)
  v_mfma_f32_16x16x32_bf16 v[200:203], v[232:235], v[148:151], v[200:203]
  v_mul_f32 v199, v199, v23
  v_cvt_pk_bf16_f32 v30, v196, v197
  v_mfma_f32_16x16x32_bf16 v[208:211], v[224:227], v[156:159], 0
  v_cvt_pk_bf16_f32 v31, v198, v199
  v_mul_f32 v188, v188, v22
  v_mfma_f32_16x16x32_bf16 v[208:211], v[228:231], v[160:163], v[208:211]
  buffer_store_dwordx4 v[28:31], v6, s[16:19], 0 offen offset:256 nt sc1
  v_mul_f32 v189, v189, v22
  v_mfma_f32_16x16x32_bf16 v[208:211], v[232:235], v[164:167], v[208:211]
  v_mul_f32 v190, v190, v22
  v_mul_f32 v191, v191, v22
  v_mfma_f32_16x16x32_bf16 v[208:211], v[236:239], v[176:179], v[208:211]
  v_cvt_pk_bf16_f32 v26, v188, v189
  s_waitcnt lgkmcnt(5)
  v_mfma_f32_16x16x32_bf16 v[208:211], v[240:243], v[180:183], v[208:211]
  v_cvt_pk_bf16_f32 v27, v190, v191
  s_waitcnt lgkmcnt(4)
  v_mfma_f32_16x16x32_bf16 v[208:211], v[244:247], v[72:75], v[208:211]
  buffer_store_dwordx4 v[24:27], v5, s[16:19], 0 offen offset:256 nt sc1
  v_mfma_f32_16x16x32_bf16 v[200:203], v[236:239], v[168:171], v[200:203]
  v_mfma_f32_16x16x32_bf16 v[200:203], v[240:243], v[172:175], v[200:203]
  v_mfma_f32_16x16x32_bf16 v[200:203], v[244:247], v[152:155], v[200:203]
  s_waitcnt lgkmcnt(3)
  v_mfma_f32_16x16x32_bf16 v[204:207], v[248:251], v[140:143], 0
  s_waitcnt lgkmcnt(2)
  v_mfma_f32_16x16x32_bf16 v[204:207], v[252:255], v[144:147], v[204:207]
  v_mul_f32 v208, v208, v23
  s_waitcnt lgkmcnt(1)
  v_mfma_f32_16x16x32_bf16 v[204:207], v[216:219], v[148:151], v[204:207]
  v_mul_f32 v209, v209, v23
  v_mul_f32 v210, v210, v23
  v_mfma_f32_16x16x32_bf16 v[212:215], v[248:251], v[156:159], 0
  v_mul_f32 v211, v211, v23
  v_cvt_pk_bf16_f32 v36, v208, v209
  v_mfma_f32_16x16x32_bf16 v[212:215], v[252:255], v[160:163], v[212:215]
  v_cvt_pk_bf16_f32 v37, v210, v211
  v_mul_f32 v200, v200, v22
  v_mfma_f32_16x16x32_bf16 v[212:215], v[216:219], v[164:167], v[212:215]
  v_mul_f32 v201, v201, v22
  s_waitcnt lgkmcnt(0)
  v_mfma_f32_16x16x32_bf16 v[212:215], v[220:223], v[176:179], v[212:215]
  v_mul_f32 v202, v202, v22
  v_mfma_f32_16x16x32_bf16 v[212:215], v[40:43], v[180:183], v[212:215]
  v_mul_f32 v203, v203, v22
  v_mfma_f32_16x16x32_bf16 v[212:215], v[44:47], v[72:75], v[212:215]
  v_cvt_pk_bf16_f32 v32, v200, v201
  v_cvt_pk_bf16_f32 v33, v202, v203
  v_mfma_f32_16x16x32_bf16 v[204:207], v[220:223], v[168:171], v[204:207]
  v_mfma_f32_16x16x32_bf16 v[204:207], v[40:43], v[172:175], v[204:207]
  v_mfma_f32_16x16x32_bf16 v[204:207], v[44:47], v[152:155], v[204:207]
  s_nop 2
  v_mul_f32 v212, v212, v23
  v_mul_f32 v213, v213, v23
  v_mul_f32 v214, v214, v23
  v_mul_f32 v215, v215, v23
  v_cvt_pk_bf16_f32 v38, v212, v213
  v_cvt_pk_bf16_f32 v39, v214, v215
  buffer_store_dwordx4 v[36:39], v6, s[16:19], 0 offen offset:320 nt sc1
  v_mul_f32 v204, v204, v22
  v_mul_f32 v205, v205, v22
  v_mul_f32 v206, v206, v22
  v_mul_f32 v207, v207, v22
  v_cvt_pk_bf16_f32 v34, v204, v205
  v_cvt_pk_bf16_f32 v35, v206, v207
  buffer_store_dwordx4 v[32:35], v5, s[16:19], 0 offen offset:320 nt sc1
MK_fin:
MK_done:
  s_endpgm
MK_single:
  ds_read_b128 v[216:219], v2 offset:35840
  ds_read_b128 v[220:223], v2 offset:34816
  ds_read_b128 v[224:227], v2 offset:33792
  ds_read_b128 v[228:231], v2 offset:32768
  ds_read_b128 v[232:235], v2 offset:31744
  ds_read_b128 v[236:239], v2 offset:30720
  ds_read_b128 v[240:243], v2 offset:29696
  ds_read_b128 v[244:247], v2 offset:28672
  ds_read_b128 v[248:251], v2 offset:27648
  ds_read_b128 v[252:255], v2 offset:26624
  s_cmp_lg_u32 s3, 0
  s_cbranch_scc1 MK_np4
  s_waitcnt vmcnt(0)
MK_np4:
  s_waitcnt vmcnt(1)
  s_setprio 1
BODYS:
  s_waitcnt lgkmcnt(8)
  v_mfma_f32_16x16x32_bf16 v[192:195], v[216:219], v[160:163], 0
  ds_read_b128 v[216:219], v2 offset:25600
  v_mov_b32 v64, 0xff800000
  v_mfma_f32_16x16x32_bf16 v[192:195], v[220:223], v[164:167], v[192:195]
  ds_read_b128 v[220:223], v2 offset:24576
  s_waitcnt lgkmcnt(8)
  v_mfma_f32_16x16x32_bf16 v[192:195], v[224:227], v[168:171], v[192:195]
  ds_read_b128 v[224:227], v2 offset:23552
  v_add_u32 v65, 0, v19
  v_mfma_f32_16x16x32_bf16 v[192:195], v[228:231], v[172:175], v[192:195]
  ds_read_b128 v[228:231], v2 offset:22528
  s_waitcnt lgkmcnt(8)
  v_mfma_f32_16x16x32_bf16 v[192:195], v[232:235], v[176:179], v[192:195]
  ds_read_b128 v[232:235], v2 offset:21504
  v_add_u32 v66, 1, v19
  v_mfma_f32_16x16x32_bf16 v[192:195], v[236:239], v[180:183], v[192:195]
  ds_read_b128 v[236:239], v2 offset:20480
  s_waitcnt lgkmcnt(8)
  v_mfma_f32_16x16x32_bf16 v[196:199], v[240:243], v[160:163], 0
  ds_read_b128 v[240:243], v2 offset:19456
  v_add_u32 v67, 2, v19
  v_mfma_f32_16x16x32_bf16 v[196:199], v[244:247], v[164:167], v[196:199]
  ds_read_b128 v[244:247], v2 offset:18432
  s_waitcnt lgkmcnt(8)
  v_mfma_f32_16x16x32_bf16 v[196:199], v[248:251], v[168:171], v[196:199]
  ds_read_b128 v[248:251], v2 offset:17408
  v_add_u32 v68, 3, v19
  v_mfma_f32_16x16x32_bf16 v[196:199], v[252:255], v[172:175], v[196:199]
  ds_read_b128 v[252:255], v2 offset:16384
  s_waitcnt lgkmcnt(8)
  v_mfma_f32_16x16x32_bf16 v[196:199], v[216:219], v[176:179], v[196:199]
  ds_read_b128 v[216:219], v2 offset:15360
  v_cmp_gt_u32 s[48:49], 7, v65
  v_mfma_f32_16x16x32_bf16 v[196:199], v[220:223], v[180:183], v[196:199]
  ds_read_b128 v[220:223], v2 offset:14336
  s_waitcnt lgkmcnt(8)
  v_mfma_f32_16x16x32_bf16 v[208:211], v[224:227], v[160:163], 0
  ds_read_b128 v[224:227], v2 offset:13312
  v_cmp_gt_u32 s[50:51], 7, v66
  v_mfma_f32_16x16x32_bf16 v[208:211], v[228:231], v[164:167], v[208:211]
  ds_read_b128 v[228:231], v2 offset:12288
  s_waitcnt lgkmcnt(8)
  v_mfma_f32_16x16x32_bf16 v[208:211], v[232:235], v[168:171], v[208:211]
  ds_read_b128 v[232:235], v2 offset:11264
  v_cmp_gt_u32 s[52:53], 7, v67
  v_mfma_f32_16x16x32_bf16 v[208:211], v[236:239], v[172:175], v[208:211]
  ds_read_b128 v[236:239], v2 offset:10240
  s_waitcnt lgkmcnt(8)
  v_mfma_f32_16x16x32_bf16 v[208:211], v[240:243], v[176:179], v[208:211]
  ds_read_b128 v[240:243], v2 offset:9216
  v_cmp_gt_u32 s[54:55], 7, v68
  v_mfma_f32_16x16x32_bf16 v[208:211], v[244:247], v[180:183], v[208:211]
  ds_read_b128 v[244:247], v2 offset:8192
  s_waitcnt lgkmcnt(8)
  v_mfma_f32_16x16x32_bf16 v[212:215], v[248:251], v[160:163], 0
  ds_read_b128 v[248:251], v2 offset:7168
  s_add_i32 s46, s34, 8
  v_mfma_f32_16x16x32_bf16 v[212:215], v[252:255], v[164:167], v[212:215]
  ds_read_b128 v[252:255], v2 offset:6144
  s_waitcnt lgkmcnt(8)
  v_mfma_f32_16x16x32_bf16 v[212:215], v[216:219], v[168:171], v[212:215]
  ds_read_b128 v[216:219], v2 offset:5120
  v_sub_u32 v69, s46, v22
  v_mfma_f32_16x16x32_bf16 v[212:215], v[220:223], v[172:175], v[212:215]
  ds_read_b128 v[220:223], v2 offset:4096
  s_waitcnt lgkmcnt(8)
  v_mfma_f32_16x16x32_bf16 v[212:215], v[224:227], v[176:179], v[212:215]
  ds_read_b128 v[224:227], v2 offset:3072
  s_add_i32 s46, s34, 1
  v_mfma_f32_16x16x32_bf16 v[212:215], v[228:231], v[180:183], v[212:215]
  ds_read_b128 v[228:231], v2 offset:2048
  v_sub_u32 v70, s46, v22
  v_cndmask_b32 v60, v64, 0, s[48:49]
  v_cndmask_b32 v61, v64, 0, s[50:51]
  v_cndmask_b32 v62, v64, 0, s[52:53]
  v_cndmask_b32 v63, v64, 0, s[54:55]
  v_cmp_gt_u32 s[46:47], 7, v69
  v_cmp_gt_u32 s[48:49], 7, v70
  s_nop 0
  v_cndmask_b32 v84, v64, v60, s[46:47]
  v_cndmask_b32 v85, v64, v61, s[46:47]
  v_cndmask_b32 v86, v64, v62, s[46:47]
  v_cndmask_b32 v87, v64, v63, s[46:47]
  v_cndmask_b32 v56, v64, v60, s[48:49]
  v_cndmask_b32 v57, v64, v61, s[48:49]
  v_cndmask_b32 v58, v64, v62, s[48:49]
  v_cndmask_b32 v59, v64, v63, s[48:49]
  v_mul_f32 v192, s93, v192
  v_mul_f32 v193, s93, v193
  v_mul_f32 v194, s93, v194
  v_mul_f32 v195, s93, v195
  v_cvt_pk_bf16_f32 v112, v192, v193
  v_cvt_pk_bf16_f32 v113, v194, v195
  v_mul_f32 v196, s93, v196
  v_mul_f32 v197, s93, v197
  v_mul_f32 v198, s93, v198
  v_mul_f32 v199, s93, v199
  v_cvt_pk_bf16_f32 v114, v196, v197
  v_cvt_pk_bf16_f32 v115, v198, v199
  s_waitcnt lgkmcnt(8)
  v_mfma_f32_16x16x32_bf16 v[192:195], v[232:235], v[160:163], 0
  ds_read_b128 v[232:235], v2 offset:1024
  v_mul_f32 v208, s93, v208
  v_mfma_f32_16x16x32_bf16 v[192:195], v[236:239], v[164:167], v[192:195]
  ds_read_b128 v[236:239], v2 offset:0
  s_waitcnt lgkmcnt(8)
  v_mfma_f32_16x16x32_bf16 v[192:195], v[240:243], v[168:171], v[192:195]
  ds_read_b128 v[240:243], v1 offset:35840
  v_mul_f32 v209, s93, v209
  v_mfma_f32_16x16x32_bf16 v[192:195], v[244:247], v[172:175], v[192:195]
  ds_read_b128 v[244:247], v1 offset:34816
  s_waitcnt lgkmcnt(8)
  v_mfma_f32_16x16x32_bf16 v[192:195], v[248:251], v[176:179], v[192:195]
  ds_read_b128 v[248:251], v1 offset:33792
  v_mul_f32 v210, s93, v210
  v_mfma_f32_16x16x32_bf16 v[192:195], v[252:255], v[180:183], v[192:195]
  ds_read_b128 v[252:255], v1 offset:32768
  s_waitcnt lgkmcnt(8)
  v_mfma_f32_16x16x32_bf16 v[196:199], v[216:219], v[160:163], 0
  ds_read_b128 v[216:219], v1 offset:31744
  v_mul_f32 v211, s93, v211
  s_cmp_eq_u32 s3, 0
  s_cbranch_scc1 MK_np5
  s_waitcnt vmcnt(0)
  v_mov_b32 v23, 1
  s_mov_b64 exec, 1
  s_lshl_b32 s100, s26, 7
  buffer_atomic_add v23, off, s[8:11], s100 sc1
  s_mov_b64 exec, -1
  s_nop 3
MK_np5:
  v_mfma_f32_16x16x32_bf16 v[196:199], v[220:223], v[164:167], v[196:199]
  ds_read_b128 v[220:223], v1 offset:30720
  s_waitcnt lgkmcnt(8)
  v_mfma_f32_16x16x32_bf16 v[196:199], v[224:227], v[168:171], v[196:199]
  ds_read_b128 v[224:227], v1 offset:29696
  v_cvt_pk_bf16_f32 v116, v208, v209
  v_mfma_f32_16x16x32_bf16 v[196:199], v[228:231], v[172:175], v[196:199]
  ds_read_b128 v[228:231], v1 offset:28672
  s_waitcnt lgkmcnt(8)
  v_mfma_f32_16x16x32_bf16 v[196:199], v[232:235], v[176:179], v[196:199]
  ds_read_b128 v[232:235], v1 offset:27648
  v_cvt_pk_bf16_f32 v117, v210, v211
  v_mfma_f32_16x16x32_bf16 v[196:199], v[236:239], v[180:183], v[196:199]
  ds_read_b128 v[236:239], v1 offset:26624
  v_mul_f32 v212, s93, v212
  v_mul_f32 v213, s93, v213
  v_mul_f32 v214, s93, v214
  v_mul_f32 v215, s93, v215
  v_cvt_pk_bf16_f32 v118, v212, v213
  v_cvt_pk_bf16_f32 v119, v214, v215
  s_waitcnt lgkmcnt(8)
  v_mfma_f32_16x16x32_bf16 v[208:211], v[240:243], v[160:163], 0
  ds_read_b128 v[240:243], v1 offset:25600
  v_mul_f32 v192, s93, v192
  v_mfma_f32_16x16x32_bf16 v[208:211], v[244:247], v[164:167], v[208:211]
  ds_read_b128 v[244:247], v1 offset:24576
  s_waitcnt lgkmcnt(8)
  v_mfma_f32_16x16x32_bf16 v[208:211], v[248:251], v[168:171], v[208:211]
  ds_read_b128 v[248:251], v1 offset:23552
  v_mul_f32 v193, s93, v193
  v_mfma_f32_16x16x32_bf16 v[208:211], v[252:255], v[172:175], v[208:211]
  ds_read_b128 v[252:255], v1 offset:22528
  s_waitcnt lgkmcnt(8)
  v_mfma_f32_16x16x32_bf16 v[208:211], v[216:219], v[176:179], v[208:211]
  ds_read_b128 v[216:219], v1 offset:21504
  v_mul_f32 v194, s93, v194
  v_mfma_f32_16x16x32_bf16 v[208:211], v[220:223], v[180:183], v[208:211]
  ds_read_b128 v[220:223], v1 offset:20480
  s_waitcnt lgkmcnt(8)
  v_mfma_f32_16x16x32_bf16 v[212:215], v[224:227], v[160:163], 0
  ds_read_b128 v[224:227], v1 offset:19456
  v_mul_f32 v195, s93, v195
  v_mfma_f32_16x16x32_bf16 v[212:215], v[228:231], v[164:167], v[212:215]
  ds_read_b128 v[228:231], v1 offset:18432
  s_waitcnt lgkmcnt(8)
  v_mfma_f32_16x16x32_bf16 v[212:215], v[232:235], v[168:171], v[212:215]
  ds_read_b128 v[232:235], v1 offset:17408
  v_cvt_pk_bf16_f32 v120, v192, v193
  v_mfma_f32_16x16x32_bf16 v[212:215], v[236:239], v[172:175], v[212:215]
  ds_read_b128 v[236:239], v1 offset:16384
  s_waitcnt lgkmcnt(8)
  v_mfma_f32_16x16x32_bf16 v[212:215], v[240:243], v[176:179], v[212:215]
  ds_read_b128 v[240:243], v1 offset:15360
  v_cvt_pk_bf16_f32 v121, v194, v195
  v_mfma_f32_16x16x32_bf16 v[212:215], v[244:247], v[180:183], v[212:215]
  ds_read_b128 v[244:247], v1 offset:14336
  v_mul_f32 v196, s93, v196
  v_mul_f32 v197, s93, v197
  v_mul_f32 v198, s93, v198
  v_mul_f32 v199, s93, v199
  v_cvt_pk_bf16_f32 v122, v196, v197
  v_cvt_pk_bf16_f32 v123, v198, v199
  s_waitcnt lgkmcnt(8)
  v_mfma_f32_16x16x32_bf16 v[192:195], v[248:251], v[160:163], 0
  ds_read_b128 v[248:251], v1 offset:13312
  v_mul_f32 v208, s93, v208
  v_mfma_f32_16x16x32_bf16 v[192:195], v[252:255], v[164:167], v[192:195]
  ds_read_b128 v[252:255], v1 offset:12288
  s_waitcnt lgkmcnt(8)
  v_mfma_f32_16x16x32_bf16 v[192:195], v[216:219], v[168:171], v[192:195]
  ds_read_b128 v[216:219], v1 offset:11264
  v_mul_f32 v209, s93, v209
  v_mfma_f32_16x16x32_bf16 v[192:195], v[220:223], v[172:175], v[192:195]
  ds_read_b128 v[220:223], v1 offset:10240
  s_waitcnt lgkmcnt(8)
  v_mfma_f32_16x16x32_bf16 v[192:195], v[224:227], v[176:179], v[192:195]
  ds_read_b128 v[224:227], v1 offset:9216
  v_mul_f32 v210, s93, v210
  v_mfma_f32_16x16x32_bf16 v[192:195], v[228:231], v[180:183], v[192:195]
  ds_read_b128 v[228:231], v1 offset:8192
  s_waitcnt lgkmcnt(8)
  v_mfma_f32_16x16x32_bf16 v[196:199], v[232:235], v[160:163], 0
  ds_read_b128 v[232:235], v1 offset:7168
  v_mul_f32 v211, s93, v211
  v_mfma_f32_16x16x32_bf16 v[196:199], v[236:239], v[164:167], v[196:199]
  ds_read_b128 v[236:239], v1 offset:6144
  s_waitcnt lgkmcnt(8)
  v_mfma_f32_16x16x32_bf16 v[196:199], v[240:243], v[168:171], v[196:199]
  ds_read_b128 v[240:243], v1 offset:5120
  v_cvt_pk_bf16_f32 v124, v208, v209
  v_mfma_f32_16x16x32_bf16 v[196:199], v[244:247], v[172:175], v[196:199]
  ds_read_b128 v[244:247], v1 offset:4096
  s_barrier
  s_waitcnt lgkmcnt(8)
  v_mfma_f32_16x16x32_bf16 v[196:199], v[248:251], v[176:179], v[196:199]
  ds_read_b128 v[248:251], v1 offset:3072
  v_cvt_pk_bf16_f32 v125, v210, v211
  v_mfma_f32_16x16x32_bf16 v[196:199], v[252:255], v[180:183], v[196:199]
  ds_read_b128 v[252:255], v1 offset:2048
  v_mul_f32 v212, s93, v212
  v_mul_f32 v213, s93, v213
  v_mul_f32 v214, s93, v214
  v_mul_f32 v215, s93, v215
  v_cvt_pk_bf16_f32 v126, v212, v213
  v_cvt_pk_bf16_f32 v127, v214, v215
  s_waitcnt lgkmcnt(8)
  v_mfma_f32_16x16x32_bf16 v[208:211], v[216:219], v[160:163], 0
  ds_read_b128 v[216:219], v1 offset:1024
  v_mul_f32 v192, s93, v192
  v_mfma_f32_16x16x32_bf16 v[208:211], v[220:223], v[164:167], v[208:211]
  ds_read_b128 v[220:223], v1 offset:0
  s_waitcnt lgkmcnt(8)
  v_mfma_f32_16x16x32_bf16 v[208:211], v[224:227], v[168:171], v[208:211]
  v_mul_f32 v193, s93, v193
  v_mul_f32 v194, s93, v194
  v_mfma_f32_16x16x32_bf16 v[208:211], v[228:231], v[172:175], v[208:211]
  v_mul_f32 v195, s93, v195
  s_waitcnt lgkmcnt(6)
  v_mfma_f32_16x16x32_bf16 v[208:211], v[232:235], v[176:179], v[208:211]
  v_cvt_pk_bf16_f32 v128, v192, v193
  v_cvt_pk_bf16_f32 v129, v194, v195
  v_mfma_f32_16x16x32_bf16 v[208:211], v[236:239], v[180:183], v[208:211]
  v_mul_f32 v196, s93, v196
  s_waitcnt lgkmcnt(5)
  v_mfma_f32_16x16x32_bf16 v[212:215], v[240:243], v[160:163], 0
  v_mul_f32 v197, s93, v197
  s_waitcnt lgkmcnt(4)
  v_mfma_f32_16x16x32_bf16 v[212:215], v[244:247], v[164:167], v[212:215]
  v_mul_f32 v198, s93, v198
  s_waitcnt lgkmcnt(3)
  v_mfma_f32_16x16x32_bf16 v[212:215], v[248:251], v[168:171], v[212:215]
  v_mul_f32 v199, s93, v199
  s_waitcnt lgkmcnt(2)
  v_mfma_f32_16x16x32_bf16 v[212:215], v[252:255], v[172:175], v[212:215]
  v_cvt_pk_bf16_f32 v130, v196, v197
  s_waitcnt lgkmcnt(1)
  v_mfma_f32_16x16x32_bf16 v[212:215], v[216:219], v[176:179], v[212:215]
  v_cvt_pk_bf16_f32 v131, v198, v199
  s_waitcnt lgkmcnt(0)
  v_mfma_f32_16x16x32_bf16 v[212:215], v[220:223], v[180:183], v[212:215]
  v_mul_f32 v208, s93, v208
  s_setprio 0
  s_mul_i32 s100, s32, 7
  s_add_i32 s100, s100, s31
  s_add_u32 m0, s38, 107520
  s_nop 0
  buffer_load_dwordx4 v13, s[12:15], s100 offen lds
  s_add_u32 m0, s38, 108544
  s_nop 0
  buffer_load_dwordx4 v14, s[12:15], s100 offen lds
  s_add_u32 m0, s38, 109568
  s_nop 0
  buffer_load_dwordx4 v3, s[12:15], s100 offen lds
  s_add_u32 m0, s39, 107520
  s_nop 0
  buffer_load_dwordx4 v4, s[12:15], s100 offen lds
  s_mul_i32 s100, s32, 6
  s_add_i32 s100, s100, s31
  s_add_u32 m0, s38, 92160
  s_nop 0
  buffer_load_dwordx4 v13, s[12:15], s100 offen lds
  s_add_u32 m0, s38, 93184
  s_nop 0
  buffer_load_dwordx4 v14, s[12:15], s100 offen lds
  s_add_u32 m0, s38, 94208
  s_nop 0
  buffer_load_dwordx4 v3, s[12:15], s100 offen lds
  s_add_u32 m0, s39, 92160
  s_nop 0
  buffer_load_dwordx4 v4, s[12:15], s100 offen lds
  s_mul_i32 s100, s32, 5
  s_add_i32 s100, s100, s31
  s_add_u32 m0, s38, 76800
  s_nop 0
  buffer_load_dwordx4 v13, s[12:15], s100 offen lds
  s_add_u32 m0, s38, 77824
  s_nop 0
  buffer_load_dwordx4 v14, s[12:15], s100 offen lds
  s_add_u32 m0, s38, 78848
  s_nop 0
  buffer_load_dwordx4 v3, s[12:15], s100 offen lds
  s_add_u32 m0, s39, 76800
  s_nop 0
  buffer_load_dwordx4 v4, s[12:15], s100 offen lds
  s_barrier
  s_mul_i32 s100, s32, 4
  s_add_i32 s100, s100, s31
  s_add_u32 m0, s38, 61440
  s_nop 0
  buffer_load_dwordx4 v13, s[12:15], s100 offen lds
  s_add_u32 m0, s38, 62464
  s_nop 0
  buffer_load_dwordx4 v14, s[12:15], s100 offen lds
  s_add_u32 m0, s38, 63488
  s_nop 0
  buffer_load_dwordx4 v3, s[12:15], s100 offen lds
  s_add_u32 m0, s39, 61440
  s_nop 0
  buffer_load_dwordx4 v4, s[12:15], s100 offen lds
  s_mul_i32 s100, s32, 3
  s_add_i32 s100, s100, s31
  s_add_u32 m0, s38, 46080
  s_nop 0
  buffer_load_dwordx4 v13, s[12:15], s100 offen lds
  s_add_u32 m0, s38, 47104
  s_nop 0
  buffer_load_dwordx4 v14, s[12:15], s100 offen lds
  s_add_u32 m0, s38, 48128
  s_nop 0
  buffer_load_dwordx4 v3, s[12:15], s100 offen lds
  s_add_u32 m0, s39, 46080
  s_nop 0
  buffer_load_dwordx4 v4, s[12:15], s100 offen lds
  s_mul_i32 s100, s32, 2
  s_add_i32 s100, s100, s31
  s_add_u32 m0, s38, 30720
  s_nop 0
  buffer_load_dwordx4 v13, s[12:15], s100 offen lds
  s_add_u32 m0, s38, 31744
  s_nop 0
  buffer_load_dwordx4 v14, s[12:15], s100 offen lds
  s_add_u32 m0, s38, 32768
  s_nop 0
  buffer_load_dwordx4 v3, s[12:15], s100 offen lds
  s_add_u32 m0, s39, 30720
  s_nop 0
  buffer_load_dwordx4 v4, s[12:15], s100 offen lds
  s_waitcnt vmcnt(12)
  s_barrier
  s_max_u32 s100, s33, 1
  s_mul_i32 s100, s100, s32
  s_add_i32 s100, s100, s31
  s_add_u32 m0, s38, 15360
  s_nop 0
  buffer_load_dwordx4 v13, s[12:15], s100 offen lds
  s_add_u32 m0, s38, 16384
  s_nop 0
  buffer_load_dwordx4 v14, s[12:15], s100 offen lds
  s_add_u32 m0, s38, 17408
  s_nop 0
  buffer_load_dwordx4 v3, s[12:15], s100 offen lds
  s_add_u32 m0, s39, 15360
  s_nop 0
  buffer_load_dwordx4 v4, s[12:15], s100 offen lds
  s_max_u32 s100, s33, 0
  s_mul_i32 s100, s100, s32
  s_add_i32 s100, s100, s31
  s_add_u32 m0, s38, 0
  s_nop 0
  buffer_load_dwordx4 v13, s[12:15], s100 offen lds
  s_add_u32 m0, s38, 1024
  s_nop 0
  buffer_load_dwordx4 v14, s[12:15], s100 offen lds
  s_add_u32 m0, s38, 2048
  s_nop 0
  buffer_load_dwordx4 v3, s[12:15], s100 offen lds
  s_add_u32 m0, s39, 0
  s_nop 0
  buffer_load_dwordx4 v4, s[12:15], s100 offen lds
  s_waitcnt vmcnt(8)
  s_barrier
  ds_read_b128 v[224:227], v7 offset:61440
  ds_read_b128 v[228:231], v8 offset:61440
  ds_read_b128 v[232:235], v7 offset:61568
  ds_read_b128 v[236:239], v8 offset:61568
  ds_read_b128 v[240:243], v7 offset:61696
  ds_read_b128 v[244:247], v8 offset:61696
  ds_read_b128 v[248:251], v7 offset:53760
  ds_read_b128 v[252:255], v8 offset:53760
  ds_read_b128 v[216:219], v7 offset:53888
  ds_read_b128 v[220:223], v8 offset:53888
  s_waitcnt lgkmcnt(8)
  v_mfma_f32_16x16x32_bf16 v[84:87], v[224:227], v[112:115], v[84:87]
  ds_read_b128 v[224:227], v7 offset:54016
  v_mul_f32 v209, s93, v209
  v_mfma_f32_16x16x32_bf16 v[84:87], v[228:231], v[116:119], v[84:87]
  ds_read_b128 v[228:231], v8 offset:54016
  s_waitcnt lgkmcnt(8)
  v_mfma_f32_16x16x32_bf16 v[84:87], v[232:235], v[120:123], v[84:87]
  ds_read_b128 v[232:235], v7 offset:46080
  v_mul_f32 v210, s93, v210
  v_mfma_f32_16x16x32_bf16 v[84:87], v[236:239], v[124:127], v[84:87]
  ds_read_b128 v[236:239], v8 offset:46080
  s_waitcnt lgkmcnt(8)
  v_mfma_f32_16x16x32_bf16 v[84:87], v[240:243], v[128:131], v[84:87]
  ds_read_b128 v[240:243], v7 offset:46208
  v_mul_f32 v211, s93, v211
  v_cvt_pk_bf16_f32 v132, v208, v209
  v_cvt_pk_bf16_f32 v133, v210, v211
  v_mul_f32 v212, s93, v212
  v_mul_f32 v213, s93, v213
  v_mul_f32 v214, s93, v214
  v_mul_f32 v215, s93, v215
  v_cvt_pk_bf16_f32 v134, v212, v213
  v_cvt_pk_bf16_f32 v135, v214, v215
  s_nop 1
  v_mfma_f32_16x16x32_bf16 v[84:87], v[244:247], v[132:135], v[84:87]
  ds_read_b128 v[244:247], v8 offset:46208
  s_waitcnt lgkmcnt(8)
  v_mfma_f32_16x16x32_bf16 v[80:83], v[248:251], v[112:115], v[60:63]
  ds_read_b128 v[248:251], v7 offset:46336
  v_add_u32 v2, 102400, v1
  v_mfma_f32_16x16x32_bf16 v[80:83], v[252:255], v[116:119], v[80:83]
  ds_read_b128 v[252:255], v8 offset:46336
  s_waitcnt lgkmcnt(8)
  v_mfma_f32_16x16x32_bf16 v[80:83], v[216:219], v[120:123], v[80:83]
  v_exp_f32 v196, v84
  v_mfma_f32_16x16x32_bf16 v[80:83], v[220:223], v[124:127], v[80:83]
  ds_read_b128 v[216:219], v7 offset:38400
  s_waitcnt lgkmcnt(7)
  v_mfma_f32_16x16x32_bf16 v[80:83], v[224:227], v[128:131], v[80:83]
  v_exp_f32 v197, v85
  v_mfma_f32_16x16x32_bf16 v[80:83], v[228:231], v[132:135], v[80:83]
  ds_read_b128 v[220:223], v8 offset:38400
  s_waitcnt vmcnt(0)
  s_barrier
  ds_read_b128 v[224:227], v7 offset:38528
  ds_read_b128 v[228:231], v8 offset:38528
  s_waitcnt lgkmcnt(8)
  v_mfma_f32_16x16x32_bf16 v[76:79], v[232:235], v[112:115], v[60:63]
  v_exp_f32 v198, v86
  v_mfma_f32_16x16x32_bf16 v[76:79], v[236:239], v[116:119], v[76:79]
  ds_read_b128 v[232:235], v7 offset:38656
  s_waitcnt lgkmcnt(7)
  v_mfma_f32_16x16x32_bf16 v[76:79], v[240:243], v[120:123], v[76:79]
  v_exp_f32 v199, v87
  v_mfma_f32_16x16x32_bf16 v[76:79], v[244:247], v[124:127], v[76:79]
  ds_read_b128 v[236:239], v8 offset:38656
  s_waitcnt lgkmcnt(6)
  v_mfma_f32_16x16x32_bf16 v[76:79], v[248:251], v[128:131], v[76:79]
  v_exp_f32 v200, v80
  v_mfma_f32_16x16x32_bf16 v[76:79], v[252:255], v[132:135], v[76:79]
  ds_read_b128 v[240:243], v7 offset:30720
  s_waitcnt lgkmcnt(5)
  v_mfma_f32_16x16x32_bf16 v[72:75], v[216:219], v[112:115], v[60:63]
  v_exp_f32 v201, v81
  v_mfma_f32_16x16x32_bf16 v[72:75], v[220:223], v[116:119], v[72:75]
  ds_read_b128 v[244:247], v8 offset:30720
  s_waitcnt lgkmcnt(5)
  v_mfma_f32_16x16x32_bf16 v[72:75], v[224:227], v[120:123], v[72:75]
  ds_read_b128 v[248:251], v7 offset:30848
  s_waitcnt lgkmcnt(5)
  v_mfma_f32_16x16x32_bf16 v[72:75], v[228:231], v[124:127], v[72:75]
  ds_read_b128 v[252:255], v8 offset:30848
  s_waitcnt lgkmcnt(5)
  v_mfma_f32_16x16x32_bf16 v[72:75], v[232:235], v[128:131], v[72:75]
  ds_read_b128 v[216:219], v7 offset:30976
  s_waitcnt lgkmcnt(5)
  v_mfma_f32_16x16x32_bf16 v[72:75], v[236:239], v[132:135], v[72:75]
  ds_read_b128 v[220:223], v8 offset:30976
  s_waitcnt lgkmcnt(5)
  v_mfma_f32_16x16x32_bf16 v[68:71], v[240:243], v[112:115], v[60:63]
  ds_read_b128 v[224:227], v7 offset:23040
  v_mov_b32 v192, 0x3f803f80
  s_waitcnt lgkmcnt(5)
  v_mfma_f32_16x16x32_bf16 v[68:71], v[244:247], v[116:119], v[68:71]
  ds_read_b128 v[228:231], v8 offset:23040
  v_mov_b32 v193, 0x3f803f80
  s_waitcnt lgkmcnt(5)
  v_mfma_f32_16x16x32_bf16 v[68:71], v[248:251], v[120:123], v[68:71]
  ds_read_b128 v[232:235], v7 offset:23168
  v_mov_b32 v194, 0x3f803f80
  s_waitcnt lgkmcnt(5)
  v_mfma_f32_16x16x32_bf16 v[68:71], v[252:255], v[124:127], v[68:71]
  ds_read_b128 v[236:239], v8 offset:23168
  v_mov_b32 v195, 0x3f803f80
  s_waitcnt lgkmcnt(5)
  v_mfma_f32_16x16x32_bf16 v[68:71], v[216:219], v[128:131], v[68:71]
  ds_read_b128 v[240:243], v7 offset:23296
  v_cvt_pk_bf16_f32 v166, v196, v197
  s_waitcnt lgkmcnt(5)
  v_mfma_f32_16x16x32_bf16 v[68:71], v[220:223], v[132:135], v[68:71]
  ds_read_b128 v[244:247], v8 offset:23296
  v_cvt_pk_bf16_f32 v167, v198, v199
  s_waitcnt lgkmcnt(5)
  v_mfma_f32_16x16x32_bf16 v[64:67], v[224:227], v[112:115], v[60:63]
  ds_read_b128 v[248:251], v7 offset:15360
  v_cvt_pk_bf16_f32 v164, v200, v201
  s_waitcnt lgkmcnt(5)
  v_mfma_f32_16x16x32_bf16 v[64:67], v[228:231], v[116:119], v[64:67]
  ds_read_b128 v[252:255], v8 offset:15360
  v_exp_f32 v202, v82
  s_waitcnt lgkmcnt(5)
  v_mfma_f32_16x16x32_bf16 v[64:67], v[232:235], v[120:123], v[64:67]
  ds_read_b128 v[216:219], v7 offset:15488
  v_exp_f32 v203, v83
  s_waitcnt lgkmcnt(5)
  v_mfma_f32_16x16x32_bf16 v[64:67], v[236:239], v[124:127], v[64:67]
  ds_read_b128 v[220:223], v8 offset:15488
  v_cvt_pk_bf16_f32 v165, v202, v203
  s_waitcnt lgkmcnt(5)
  v_mfma_f32_16x16x32_bf16 v[64:67], v[240:243], v[128:131], v[64:67]
  ds_read_b128 v[224:227], v7 offset:15616
  v_exp_f32 v204, v76
  s_waitcnt lgkmcnt(5)
  v_mfma_f32_16x16x32_bf16 v[64:67], v[244:247], v[132:135], v[64:67]
  ds_read_b128 v[228:231], v8 offset:15616
  v_exp_f32 v205, v77
  s_waitcnt lgkmcnt(5)
  v_mfma_f32_16x16x32_bf16 v[60:63], v[248:251], v[112:115], v[60:63]
  ds_read_b128 v[232:235], v7 offset:7680
  v_cvt_pk_bf16_f32 v162, v204, v205
  s_waitcnt lgkmcnt(5)
  v_mfma_f32_16x16x32_bf16 v[60:63], v[252:255], v[116:119], v[60:63]
  ds_read_b128 v[236:239], v8 offset:7680
  v_exp_f32 v206, v78
  s_waitcnt lgkmcnt(5)
  v_mfma_f32_16x16x32_bf16 v[60:63], v[216:219], v[120:123], v[60:63]
  ds_read_b128 v[240:243], v7 offset:7808
  v_exp_f32 v207, v79
  s_waitcnt lgkmcnt(5)
  v_mfma_f32_16x16x32_bf16 v[60:63], v[220:223], v[124:127], v[60:63]
  ds_read_b128 v[244:247], v8 offset:7808
  v_cvt_pk_bf16_f32 v163, v206, v207
  s_waitcnt lgkmcnt(5)
  v_mfma_f32_16x16x32_bf16 v[60:63], v[224:227], v[128:131], v[60:63]
  ds_read_b128 v[248:251], v7 offset:7936
  v_exp_f32 v208, v72
  s_waitcnt lgkmcnt(5)
  v_mfma_f32_16x16x32_bf16 v[60:63], v[228:231], v[132:135], v[60:63]
  ds_read_b128 v[252:255], v8 offset:7936
  v_exp_f32 v209, v73
  s_barrier
  s_waitcnt lgkmcnt(5)
  v_mfma_f32_16x16x32_bf16 v[56:59], v[232:235], v[112:115], v[56:59]
  ds_read_b64_tr_b16 v[216:217], v9 offset:53760
  ds_read_b64_tr_b16 v[218:219], v9 offset:61440
  v_cvt_pk_bf16_f32 v160, v208, v209
  s_waitcnt lgkmcnt(5)
  v_mfma_f32_16x16x32_bf16 v[56:59], v[236:239], v[116:119], v[56:59]
  ds_read_b64_tr_b16 v[220:221], v10 offset:53760
  ds_read_b64_tr_b16 v[222:223], v10 offset:61440
  v_exp_f32 v210, v74
  v_mfma_f32_16x16x32_bf16 v[56:59], v[240:243], v[120:123], v[56:59]
  ds_read_b64_tr_b16 v[224:225], v11 offset:53760
  ds_read_b64_tr_b16 v[226:227], v11 offset:61440
  v_exp_f32 v211, v75
  s_waitcnt lgkmcnt(7)
  v_mfma_f32_16x16x32_bf16 v[56:59], v[244:247], v[124:127], v[56:59]
  ds_read_b64_tr_b16 v[228:229], v12 offset:53760
  ds_read_b64_tr_b16 v[230:231], v12 offset:61440
  v_cvt_pk_bf16_f32 v161, v210, v211
  v_mfma_f32_16x16x32_bf16 v[56:59], v[248:251], v[128:131], v[56:59]
  ds_read_b64_tr_b16 v[232:233], v9 offset:53888
  ds_read_b64_tr_b16 v[234:235], v9 offset:61568
  v_exp_f32 v212, v68
  s_waitcnt lgkmcnt(8)
  v_mfma_f32_16x16x32_bf16 v[56:59], v[252:255], v[132:135], v[56:59]
  ds_read_b64_tr_b16 v[236:237], v10 offset:53888
  ds_read_b64_tr_b16 v[238:239], v10 offset:61568
  v_exp_f32 v213, v69
  v_exp_f32 v214, v70
  v_exp_f32 v215, v71
  v_cvt_pk_bf16_f32 v158, v212, v213
  v_cvt_pk_bf16_f32 v159, v214, v215
  v_exp_f32 v196, v64
  v_exp_f32 v197, v65
  v_exp_f32 v198, v66
  v_exp_f32 v199, v67
  v_cvt_pk_bf16_f32 v156, v196, v197
  v_cvt_pk_bf16_f32 v157, v198, v199
  v_exp_f32 v200, v60
  v_exp_f32 v201, v61
  v_exp_f32 v202, v62
  v_exp_f32 v203, v63
  v_cvt_pk_bf16_f32 v154, v200, v201
  v_cvt_pk_bf16_f32 v155, v202, v203
  v_exp_f32 v204, v56
  v_exp_f32 v205, v57
  v_exp_f32 v206, v58
  v_exp_f32 v207, v59
  v_cvt_pk_bf16_f32 v152, v204, v205
  v_cvt_pk_bf16_f32 v153, v206, v207
  v_mfma_f32_16x16x32_bf16 v[188:191], v[192:195], v[164:167], 0
  ds_read_b64_tr_b16 v[240:241], v11 offset:53888
  ds_read_b64_tr_b16 v[242:243], v11 offset:61568
  v_mfma_f32_16x16x32_bf16 v[188:191], v[192:195], v[160:163], v[188:191]
  ds_read_b64_tr_b16 v[244:245], v12 offset:53888
  ds_read_b64_tr_b16 v[246:247], v12 offset:61568
  v_mfma_f32_16x16x32_bf16 v[188:191], v[192:195], v[156:159], v[188:191]
  v_mfma_f32_16x16x32_bf16 v[188:191], v[192:195], v[152:155], v[188:191]
  s_nop 7
  v_subrev_u32 v23, 813694976, v188
  s_mov_b32 s52, 503316480
  v_cmp_gt_u32 s[48:49], s52, v23
  s_or_b64 s[48:49], s[48:49], s[44:45]
  s_cmp_eq_u64 s[48:49], -1
  s_cbranch_scc0 FB1s
FBR1s:
  s_barrier
  v_mfma_f32_16x16x32_bf16 v[88:91], v[216:219], v[164:167], 0
  s_waitcnt lgkmcnt(10)
  v_mfma_f32_16x16x32_bf16 v[92:95], v[220:223], v[164:167], 0
  ds_read_b64_tr_b16 v[248:249], v9 offset:54016
  ds_read_b64_tr_b16 v[250:251], v9 offset:61696
  v_mfma_f32_16x16x32_bf16 v[96:99], v[224:227], v[164:167], 0
  ds_read_b64_tr_b16 v[252:253], v10 offset:54016
  ds_read_b64_tr_b16 v[254:255], v10 offset:61696
  s_waitcnt lgkmcnt(10)
  v_mfma_f32_16x16x32_bf16 v[100:103], v[228:231], v[164:167], 0
  ds_read_b64_tr_b16 v[216:217], v11 offset:54016
  ds_read_b64_tr_b16 v[218:219], v11 offset:61696
  v_mfma_f32_16x16x32_bf16 v[104:107], v[232:235], v[164:167], 0
  ds_read_b64_tr_b16 v[220:221], v12 offset:54016
  ds_read_b64_tr_b16 v[222:223], v12 offset:61696
  s_waitcnt lgkmcnt(10)
  v_mfma_f32_16x16x32_bf16 v[108:111], v[236:239], v[164:167], 0
  ds_read_b64_tr_b16 v[224:225], v9 offset:38400
  ds_read_b64_tr_b16 v[226:227], v9 offset:46080
  v_mfma_f32_16x16x32_bf16 v[112:115], v[240:243], v[164:167], 0
  ds_read_b64_tr_b16 v[228:229], v10 offset:38400
  ds_read_b64_tr_b16 v[230:231], v10 offset:46080
  s_waitcnt lgkmcnt(10)
  v_mfma_f32_16x16x32_bf16 v[116:119], v[244:247], v[164:167], 0
  ds_read_b64_tr_b16 v[232:233], v11 offset:38400
  ds_read_b64_tr_b16 v[234:235], v11 offset:46080
  v_mfma_f32_16x16x32_bf16 v[120:123], v[248:251], v[164:167], 0
  ds_read_b64_tr_b16 v[236:237], v12 offset:38400
  ds_read_b64_tr_b16 v[238:239], v12 offset:46080
  s_waitcnt lgkmcnt(10)
  v_mfma_f32_16x16x32_bf16 v[124:127], v[252:255], v[164:167], 0
  ds_read_b64_tr_b16 v[240:241], v9 offset:38528
  ds_read_b64_tr_b16 v[242:243], v9 offset:46208
  v_mfma_f32_16x16x32_bf16 v[128:131], v[216:219], v[164:167], 0
  ds_read_b64_tr_b16 v[244:245], v10 offset:38528
  ds_read_b64_tr_b16 v[246:247], v10 offset:46208
  s_waitcnt lgkmcnt(10)
  v_mfma_f32_16x16x32_bf16 v[132:135], v[220:223], v[164:167], 0
  ds_read_b64_tr_b16 v[248:249], v11 offset:38528
  ds_read_b64_tr_b16 v[250:251], v11 offset:46208
  v_mfma_f32_16x16x32_bf16 v[88:91], v[224:227], v[160:163], v[88:91]
  ds_read_b64_tr_b16 v[252:253], v12 offset:38528
  ds_read_b64_tr_b16 v[254:255], v12 offset:46208
  s_waitcnt lgkmcnt(10)
  v_mfma_f32_16x16x32_bf16 v[92:95], v[228:231], v[160:163], v[92:95]
  v_rcp_f32 v23, v188
  v_mfma_f32_16x16x32_bf16 v[96:99], v[232:235], v[160:163], v[96:99]
  ds_read_b64_tr_b16 v[216:217], v9 offset:38656
  ds_read_b64_tr_b16 v[218:219], v9 offset:46336
  s_waitcnt lgkmcnt(8)
  v_mfma_f32_16x16x32_bf16 v[100:103], v[236:239], v[160:163], v[100:103]
  ds_read_b64_tr_b16 v[220:221], v10 offset:38656
  ds_read_b64_tr_b16 v[222:223], v10 offset:46336
  v_mfma_f32_16x16x32_bf16 v[104:107], v[240:243], v[160:163], v[104:107]
  ds_read_b64_tr_b16 v[224:225], v11 offset:38656
  ds_read_b64_tr_b16 v[226:227], v11 offset:46336
  s_waitcnt lgkmcnt(8)
  v_mfma_f32_16x16x32_bf16 v[108:111], v[244:247], v[160:163], v[108:111]
  ds_read_b64_tr_b16 v[228:229], v12 offset:38656
  ds_read_b64_tr_b16 v[230:231], v12 offset:46336
  v_mfma_f32_16x16x32_bf16 v[112:115], v[248:251], v[160:163], v[112:115]
  ds_read_b64_tr_b16 v[232:233], v9 offset:23040
  ds_read_b64_tr_b16 v[234:235], v9 offset:30720
  s_waitcnt lgkmcnt(8)
  v_mfma_f32_16x16x32_bf16 v[116:119], v[252:255], v[160:163], v[116:119]
  ds_read_b64_tr_b16 v[236:237], v10 offset:23040
  ds_read_b64_tr_b16 v[238:239], v10 offset:30720
  v_mfma_f32_16x16x32_bf16 v[120:123], v[216:219], v[160:163], v[120:123]
  ds_read_b64_tr_b16 v[240:241], v11 offset:23040
  ds_read_b64_tr_b16 v[242:243], v11 offset:30720
  s_waitcnt lgkmcnt(8)
  v_mfma_f32_16x16x32_bf16 v[124:127], v[220:223], v[160:163], v[124:127]
  ds_read_b64_tr_b16 v[244:245], v12 offset:23040
  ds_read_b64_tr_b16 v[246:247], v12 offset:30720
  v_mfma_f32_16x16x32_bf16 v[128:131], v[224:227], v[160:163], v[128:131]
  ds_read_b64_tr_b16 v[248:249], v9 offset:23168
  ds_read_b64_tr_b16 v[250:251], v9 offset:30848
  s_waitcnt lgkmcnt(8)
  v_mfma_f32_16x16x32_bf16 v[132:135], v[228:231], v[160:163], v[132:135]
  ds_read_b64_tr_b16 v[252:253], v10 offset:23168
  ds_read_b64_tr_b16 v[254:255], v10 offset:30848
  s_barrier
  v_mfma_f32_16x16x32_bf16 v[88:91], v[232:235], v[156:159], v[88:91]
  ds_read_b64_tr_b16 v[216:217], v11 offset:23168
  ds_read_b64_tr_b16 v[218:219], v11 offset:30848
  s_waitcnt lgkmcnt(8)
  v_mfma_f32_16x16x32_bf16 v[92:95], v[236:239], v[156:159], v[92:95]
  ds_read_b64_tr_b16 v[220:221], v12 offset:23168
  ds_read_b64_tr_b16 v[222:223], v12 offset:30848
  v_mfma_f32_16x16x32_bf16 v[96:99], v[240:243], v[156:159], v[96:99]
  ds_read_b64_tr_b16 v[224:225], v9 offset:23296
  ds_read_b64_tr_b16 v[226:227], v9 offset:30976
  s_waitcnt lgkmcnt(8)
  v_mfma_f32_16x16x32_bf16 v[100:103], v[244:247], v[156:159], v[100:103]
  ds_read_b64_tr_b16 v[228:229], v10 offset:23296
  ds_read_b64_tr_b16 v[230:231], v10 offset:30976
  v_mfma_f32_16x16x32_bf16 v[104:107], v[248:251], v[156:159], v[104:107]
  ds_read_b64_tr_b16 v[232:233], v11 offset:23296
  ds_read_b64_tr_b16 v[234:235], v11 offset:30976
  s_waitcnt lgkmcnt(8)
  v_mfma_f32_16x16x32_bf16 v[108:111], v[252:255], v[156:159], v[108:111]
  ds_read_b64_tr_b16 v[236:237], v12 offset:23296
  ds_read_b64_tr_b16 v[238:239], v12 offset:30976
  v_mfma_f32_16x16x32_bf16 v[112:115], v[216:219], v[156:159], v[112:115]
  ds_read_b64_tr_b16 v[240:241], v9 offset:7680
  ds_read_b64_tr_b16 v[242:243], v9 offset:15360
  s_waitcnt lgkmcnt(8)
  v_mfma_f32_16x16x32_bf16 v[116:119], v[220:223], v[156:159], v[116:119]
  ds_read_b64_tr_b16 v[244:245], v10 offset:7680
  ds_read_b64_tr_b16 v[246:247], v10 offset:15360
  v_mfma_f32_16x16x32_bf16 v[120:123], v[224:227], v[156:159], v[120:123]
  ds_read_b64_tr_b16 v[248:249], v11 offset:7680
  ds_read_b64_tr_b16 v[250:251], v11 offset:15360
  s_waitcnt lgkmcnt(8)
  v_mfma_f32_16x16x32_bf16 v[124:127], v[228:231], v[156:159], v[124:127]
  ds_read_b64_tr_b16 v[252:253], v12 offset:7680
  ds_read_b64_tr_b16 v[254:255], v12 offset:15360
  v_mfma_f32_16x16x32_bf16 v[128:131], v[232:235], v[156:159], v[128:131]
  ds_read_b64_tr_b16 v[216:217], v9 offset:7808
  ds_read_b64_tr_b16 v[218:219], v9 offset:15488
  s_waitcnt lgkmcnt(8)
  v_mfma_f32_16x16x32_bf16 v[132:135], v[236:239], v[156:159], v[132:135]
  ds_read_b64_tr_b16 v[220:221], v10 offset:7808
  ds_read_b64_tr_b16 v[222:223], v10 offset:15488
  v_mfma_f32_16x16x32_bf16 v[88:91], v[240:243], v[152:155], v[88:91]
  ds_read_b64_tr_b16 v[224:225], v11 offset:7808
  ds_read_b64_tr_b16 v[226:227], v11 offset:15488
  s_waitcnt lgkmcnt(8)
  v_mfma_f32_16x16x32_bf16 v[92:95], v[244:247], v[152:155], v[92:95]
  ds_read_b64_tr_b16 v[228:229], v12 offset:7808
  ds_read_b64_tr_b16 v[230:231], v12 offset:15488
  v_mfma_f32_16x16x32_bf16 v[96:99], v[248:251], v[152:155], v[96:99]
  ds_read_b64_tr_b16 v[232:233], v9 offset:7936
  ds_read_b64_tr_b16 v[234:235], v9 offset:15616
  s_waitcnt lgkmcnt(8)
  v_mfma_f32_16x16x32_bf16 v[100:103], v[252:255], v[152:155], v[100:103]
  ds_read_b64_tr_b16 v[236:237], v10 offset:7936
  ds_read_b64_tr_b16 v[238:239], v10 offset:15616
  v_mfma_f32_16x16x32_bf16 v[104:107], v[216:219], v[152:155], v[104:107]
  ds_read_b64_tr_b16 v[240:241], v11 offset:7936
  ds_read_b64_tr_b16 v[242:243], v11 offset:15616
  s_waitcnt lgkmcnt(8)
  v_mfma_f32_16x16x32_bf16 v[108:111], v[220:223], v[152:155], v[108:111]
  ds_read_b64_tr_b16 v[244:245], v12 offset:7936
  ds_read_b64_tr_b16 v[246:247], v12 offset:15616
  v_mfma_f32_16x16x32_bf16 v[112:115], v[224:227], v[152:155], v[112:115]
  v_cvt_pk_bf16_f32 v156, v88, v89
  s_waitcnt lgkmcnt(6)
  v_mfma_f32_16x16x32_bf16 v[116:119], v[228:231], v[152:155], v[116:119]
  v_cvt_pk_bf16_f32 v157, v90, v91
  v_cvt_pk_bf16_f32 v158, v92, v93
  v_mfma_f32_16x16x32_bf16 v[120:123], v[232:235], v[152:155], v[120:123]
  v_cvt_pk_bf16_f32 v159, v94, v95
  s_waitcnt lgkmcnt(4)
  v_mfma_f32_16x16x32_bf16 v[124:127], v[236:239], v[152:155], v[124:127]
  v_cvt_pk_bf16_f32 v160, v96, v97
  s_waitcnt lgkmcnt(2)
  v_mfma_f32_16x16x32_bf16 v[128:131], v[240:243], v[152:155], v[128:131]
  v_cvt_pk_bf16_f32 v161, v98, v99
  s_waitcnt lgkmcnt(0)
  v_mfma_f32_16x16x32_bf16 v[132:135], v[244:247], v[152:155], v[132:135]
  v_cvt_pk_bf16_f32 v162, v100, v101
  ds_read_b128 v[248:251], v2 offset:30720
  ds_read_b128 v[252:255], v2 offset:31744
  ds_read_b128 v[216:219], v2 offset:32768
  ds_read_b128 v[220:223], v2 offset:33792
  ds_read_b128 v[224:227], v2 offset:34816
  ds_read_b128 v[228:231], v2 offset:35840
  ds_read_b128 v[232:235], v2 offset:36864
  ds_read_b128 v[236:239], v2 offset:37888
  ds_read_b128 v[240:243], v2 offset:38912
  ds_read_b128 v[244:247], v2 offset:39936
  s_waitcnt lgkmcnt(8)
  v_mfma_f32_16x16x32_bf16 v[192:195], v[248:251], v[156:159], 0
  ds_read_b128 v[248:251], v2 offset:40960
  v_cvt_pk_bf16_f32 v163, v102, v103
  s_nop 1
  v_mfma_f32_16x16x32_bf16 v[192:195], v[252:255], v[160:163], v[192:195]
  ds_read_b128 v[252:255], v2 offset:41984
  v_cvt_pk_bf16_f32 v164, v104, v105
  v_cvt_pk_bf16_f32 v165, v106, v107
  v_cvt_pk_bf16_f32 v166, v108, v109
  v_cvt_pk_bf16_f32 v167, v110, v111
  s_waitcnt lgkmcnt(8)
  s_nop 0
  v_mfma_f32_16x16x32_bf16 v[192:195], v[216:219], v[164:167], v[192:195]
  ds_read_b128 v[216:219], v2 offset:43008
  v_cvt_pk_bf16_f32 v176, v112, v113
  v_cvt_pk_bf16_f32 v177, v114, v115
  v_cvt_pk_bf16_f32 v178, v116, v117
  v_cvt_pk_bf16_f32 v179, v118, v119
  s_nop 1
  v_mfma_f32_16x16x32_bf16 v[192:195], v[220:223], v[176:179], v[192:195]
  ds_read_b128 v[220:223], v2 offset:44032
  v_cvt_pk_bf16_f32 v180, v120, v121
  v_cvt_pk_bf16_f32 v181, v122, v123
  v_cvt_pk_bf16_f32 v182, v124, v125
  v_cvt_pk_bf16_f32 v183, v126, v127
  s_waitcnt lgkmcnt(8)
  s_nop 0
  v_mfma_f32_16x16x32_bf16 v[192:195], v[224:227], v[180:183], v[192:195]
  ds_read_b128 v[224:227], v2 offset:45056
  v_cvt_pk_bf16_f32 v72, v128, v129
  v_cvt_pk_bf16_f32 v73, v130, v131
  v_cvt_pk_bf16_f32 v74, v132, v133
  v_cvt_pk_bf16_f32 v75, v134, v135
  s_nop 1
  v_mfma_f32_16x16x32_bf16 v[192:195], v[228:231], v[72:75], v[192:195]
  ds_read_b128 v[228:231], v2 offset:46080
  s_waitcnt lgkmcnt(8)
  v_mfma_f32_16x16x32_bf16 v[196:199], v[232:235], v[156:159], 0
  ds_read_b128 v[232:235], v2 offset:47104
  v_mfma_f32_16x16x32_bf16 v[196:199], v[236:239], v[160:163], v[196:199]
  ds_read_b128 v[236:239], v2 offset:48128
  s_waitcnt lgkmcnt(8)
  v_mfma_f32_16x16x32_bf16 v[196:199], v[240:243], v[164:167], v[196:199]
  ds_read_b128 v[240:243], v2 offset:49152
  v_mul_f32 v192, v192, v23
  v_mfma_f32_16x16x32_bf16 v[196:199], v[244:247], v[176:179], v[196:199]
  ds_read_b128 v[244:247], v2 offset:50176
  s_waitcnt lgkmcnt(8)
  v_mfma_f32_16x16x32_bf16 v[196:199], v[248:251], v[180:183], v[196:199]
  ds_read_b128 v[248:251], v2 offset:51200
  v_mul_f32 v193, v193, v23
  v_mfma_f32_16x16x32_bf16 v[196:199], v[252:255], v[72:75], v[196:199]
  ds_read_b128 v[252:255], v2 offset:52224
  s_mov_b32 s100, 71680
  buffer_load_dwordx4 v[40:43], v1, s[20:23], s100 offen offset:0 sc1
  buffer_load_dwordx4 v[44:47], v1, s[20:23], s100 offen offset:1024 sc1
  s_waitcnt lgkmcnt(8)
  v_mfma_f32_16x16x32_bf16 v[208:211], v[216:219], v[156:159], 0
  ds_read_b128 v[216:219], v2 offset:53248
  v_mul_f32 v194, v194, v23
  v_mfma_f32_16x16x32_bf16 v[208:211], v[220:223], v[160:163], v[208:211]
  ds_read_b128 v[220:223], v2 offset:54272
  s_waitcnt lgkmcnt(8)
  v_mfma_f32_16x16x32_bf16 v[208:211], v[224:227], v[164:167], v[208:211]
  ds_read_b128 v[224:227], v2 offset:55296
  v_mul_f32 v195, v195, v23
  v_mfma_f32_16x16x32_bf16 v[208:211], v[228:231], v[176:179], v[208:211]
  ds_read_b128 v[228:231], v2 offset:56320
  s_waitcnt lgkmcnt(8)
  v_mfma_f32_16x16x32_bf16 v[208:211], v[232:235], v[180:183], v[208:211]
  ds_read_b128 v[232:235], v2 offset:57344
  v_cvt_pk_bf16_f32 v28, v192, v193
  v_mfma_f32_16x16x32_bf16 v[208:211], v[236:239], v[72:75], v[208:211]
  ds_read_b128 v[236:239], v2 offset:58368
  s_waitcnt lgkmcnt(8)
  v_mfma_f32_16x16x32_bf16 v[212:215], v[240:243], v[156:159], 0
  ds_read_b128 v[240:243], v2 offset:59392
  v_cvt_pk_bf16_f32 v29, v194, v195
  v_mfma_f32_16x16x32_bf16 v[212:215], v[244:247], v[160:163], v[212:215]
  ds_read_b128 v[244:247], v2 offset:60416
  s_waitcnt lgkmcnt(8)
  v_mfma_f32_16x16x32_bf16 v[212:215], v[248:251], v[164:167], v[212:215]
  ds_read_b128 v[248:251], v1 offset:0
  v_mul_f32 v196, v196, v23
  v_mfma_f32_16x16x32_bf16 v[212:215], v[252:255], v[176:179], v[212:215]
  ds_read_b128 v[252:255], v1 offset:1024
  s_waitcnt lgkmcnt(8)
  v_mfma_f32_16x16x32_bf16 v[212:215], v[216:219], v[180:183], v[212:215]
  ds_read_b128 v[216:219], v1 offset:2048
  v_mul_f32 v197, v197, v23
  v_mfma_f32_16x16x32_bf16 v[212:215], v[220:223], v[72:75], v[212:215]
  ds_read_b128 v[220:223], v1 offset:3072
  v_mul_f32 v198, v198, v23
  v_mul_f32 v199, v199, v23
  v_cvt_pk_bf16_f32 v30, v196, v197
  v_cvt_pk_bf16_f32 v31, v198, v199
  buffer_store_dwordx4 v[28:31], v6, s[16:19], 0 offen offset:0 nt sc1
  s_waitcnt lgkmcnt(8)
  v_mfma_f32_16x16x32_bf16 v[192:195], v[224:227], v[156:159], 0
  ds_read_b128 v[224:227], v1 offset:4096
  v_mul_f32 v208, v208, v23
  v_mfma_f32_16x16x32_bf16 v[192:195], v[228:231], v[160:163], v[192:195]
  ds_read_b128 v[228:231], v1 offset:5120
  s_waitcnt lgkmcnt(8)
  v_mfma_f32_16x16x32_bf16 v[192:195], v[232:235], v[164:167], v[192:195]
  ds_read_b128 v[232:235], v1 offset:6144
  v_mul_f32 v209, v209, v23
  v_mfma_f32_16x16x32_bf16 v[192:195], v[236:239], v[176:179], v[192:195]
  ds_read_b128 v[236:239], v1 offset:7168
  s_waitcnt lgkmcnt(8)
  v_mfma_f32_16x16x32_bf16 v[192:195], v[240:243], v[180:183], v[192:195]
  ds_read_b128 v[240:243], v1 offset:8192
  v_mul_f32 v210, v210, v23
  v_mfma_f32_16x16x32_bf16 v[192:195], v[244:247], v[72:75], v[192:195]
  ds_read_b128 v[244:247], v1 offset:9216
  s_waitcnt lgkmcnt(8)
  v_mfma_f32_16x16x32_bf16 v[196:199], v[248:251], v[156:159], 0
  ds_read_b128 v[248:251], v2 offset:0
  v_mul_f32 v211, v211, v23
  v_mfma_f32_16x16x32_bf16 v[196:199], v[252:255], v[160:163], v[196:199]
  ds_read_b128 v[252:255], v2 offset:1024
  s_waitcnt lgkmcnt(8)
  v_mfma_f32_16x16x32_bf16 v[196:199], v[216:219], v[164:167], v[196:199]
  ds_read_b128 v[216:219], v2 offset:2048
  v_cvt_pk_bf16_f32 v36, v208, v209
  v_mfma_f32_16x16x32_bf16 v[196:199], v[220:223], v[176:179], v[196:199]
  ds_read_b128 v[220:223], v2 offset:3072
  s_waitcnt lgkmcnt(8)
  v_mfma_f32_16x16x32_bf16 v[196:199], v[224:227], v[180:183], v[196:199]
  ds_read_b128 v[224:227], v2 offset:4096
  v_cvt_pk_bf16_f32 v37, v210, v211
  v_mfma_f32_16x16x32_bf16 v[196:199], v[228:231], v[72:75], v[196:199]
  ds_read_b128 v[228:231], v2 offset:5120
  v_mul_f32 v212, v212, v23
  v_mul_f32 v213, v213, v23
  v_mul_f32 v214, v214, v23
  v_mul_f32 v215, v215, v23
  v_cvt_pk_bf16_f32 v38, v212, v213
  v_cvt_pk_bf16_f32 v39, v214, v215
  buffer_store_dwordx4 v[36:39], v6, s[16:19], 0 offen offset:64 nt sc1
  s_waitcnt lgkmcnt(8)
  v_mfma_f32_16x16x32_bf16 v[208:211], v[232:235], v[156:159], 0
  ds_read_b128 v[232:235], v2 offset:6144
  v_mul_f32 v192, v192, v23
  v_mfma_f32_16x16x32_bf16 v[208:211], v[236:239], v[160:163], v[208:211]
  ds_read_b128 v[236:239], v2 offset:7168
  s_waitcnt lgkmcnt(8)
  v_mfma_f32_16x16x32_bf16 v[208:211], v[240:243], v[164:167], v[208:211]
  ds_read_b128 v[240:243], v2 offset:8192
  v_mul_f32 v193, v193, v23
  v_mfma_f32_16x16x32_bf16 v[208:211], v[244:247], v[176:179], v[208:211]
  ds_read_b128 v[244:247], v2 offset:9216
  s_waitcnt lgkmcnt(8)
  v_mfma_f32_16x16x32_bf16 v[208:211], v[248:251], v[180:183], v[208:211]
  ds_read_b128 v[248:251], v2 offset:10240
  v_mul_f32 v194, v194, v23
  v_mfma_f32_16x16x32_bf16 v[208:211], v[252:255], v[72:75], v[208:211]
  ds_read_b128 v[252:255], v2 offset:11264
  s_waitcnt lgkmcnt(8)
  v_mfma_f32_16x16x32_bf16 v[212:215], v[216:219], v[156:159], 0
  ds_read_b128 v[216:219], v2 offset:12288
  v_mul_f32 v195, v195, v23
  v_mfma_f32_16x16x32_bf16 v[212:215], v[220:223], v[160:163], v[212:215]
  ds_read_b128 v[220:223], v2 offset:13312
  s_waitcnt lgkmcnt(8)
  v_mfma_f32_16x16x32_bf16 v[212:215], v[224:227], v[164:167], v[212:215]
  ds_read_b128 v[224:227], v2 offset:14336
  v_cvt_pk_bf16_f32 v28, v192, v193
  v_mfma_f32_16x16x32_bf16 v[212:215], v[228:231], v[176:179], v[212:215]
  ds_read_b128 v[228:231], v2 offset:15360
  s_waitcnt lgkmcnt(8)
  v_mfma_f32_16x16x32_bf16 v[212:215], v[232:235], v[180:183], v[212:215]
  ds_read_b128 v[232:235], v2 offset:16384
  v_cvt_pk_bf16_f32 v29, v194, v195
  v_mfma_f32_16x16x32_bf16 v[212:215], v[236:239], v[72:75], v[212:215]
  ds_read_b128 v[236:239], v2 offset:17408
  v_mul_f32 v196, v196, v23
  v_mul_f32 v197, v197, v23
  v_mul_f32 v198, v198, v23
  v_mul_f32 v199, v199, v23
  v_cvt_pk_bf16_f32 v30, v196, v197
  v_cvt_pk_bf16_f32 v31, v198, v199
  buffer_store_dwordx4 v[28:31], v6, s[16:19], 0 offen offset:128 nt sc1
  s_waitcnt lgkmcnt(8)
  v_mfma_f32_16x16x32_bf16 v[192:195], v[240:243], v[156:159], 0
  ds_read_b128 v[240:243], v2 offset:18432
  v_mul_f32 v208, v208, v23
  v_mfma_f32_16x16x32_bf16 v[192:195], v[244:247], v[160:163], v[192:195]
  ds_read_b128 v[244:247], v2 offset:19456
  s_waitcnt lgkmcnt(8)
  v_mfma_f32_16x16x32_bf16 v[192:195], v[248:251], v[164:167], v[192:195]
  ds_read_b128 v[248:251], v2 offset:20480
  v_mul_f32 v209, v209, v23
  v_mfma_f32_16x16x32_bf16 v[192:195], v[252:255], v[176:179], v[192:195]
  ds_read_b128 v[252:255], v2 offset:21504
  s_waitcnt lgkmcnt(8)
  v_mfma_f32_16x16x32_bf16 v[192:195], v[216:219], v[180:183], v[192:195]
  ds_read_b128 v[216:219], v2 offset:22528
  v_mul_f32 v210, v210, v23
  v_mfma_f32_16x16x32_bf16 v[192:195], v[220:223], v[72:75], v[192:195]
  ds_read_b128 v[220:223], v2 offset:23552
  s_waitcnt lgkmcnt(8)
  v_mfma_f32_16x16x32_bf16 v[196:199], v[224:227], v[156:159], 0
  ds_read_b128 v[224:227], v2 offset:24576
  v_mul_f32 v211, v211, v23
  v_mfma_f32_16x16x32_bf16 v[196:199], v[228:231], v[160:163], v[196:199]
  ds_read_b128 v[228:231], v2 offset:25600
  s_waitcnt lgkmcnt(8)
  v_mfma_f32_16x16x32_bf16 v[196:199], v[232:235], v[164:167], v[196:199]
  ds_read_b128 v[232:235], v2 offset:26624
  v_cvt_pk_bf16_f32 v36, v208, v209
  v_mfma_f32_16x16x32_bf16 v[196:199], v[236:239], v[176:179], v[196:199]
  ds_read_b128 v[236:239], v2 offset:27648
  s_waitcnt lgkmcnt(8)
  v_mfma_f32_16x16x32_bf16 v[196:199], v[240:243], v[180:183], v[196:199]
  ds_read_b128 v[240:243], v2 offset:28672
  v_cvt_pk_bf16_f32 v37, v210, v211
  v_mfma_f32_16x16x32_bf16 v[196:199], v[244:247], v[72:75], v[196:199]
  ds_read_b128 v[244:247], v2 offset:29696
  v_mul_f32 v212, v212, v23
  v_mul_f32 v213, v213, v23
  v_mul_f32 v214, v214, v23
  v_mul_f32 v215, v215, v23
  v_cvt_pk_bf16_f32 v38, v212, v213
  v_cvt_pk_bf16_f32 v39, v214, v215
  buffer_store_dwordx4 v[36:39], v6, s[16:19], 0 offen offset:192 nt sc1
  s_waitcnt vmcnt(4)
  s_waitcnt lgkmcnt(8)
  v_mfma_f32_16x16x32_bf16 v[208:211], v[248:251], v[156:159], 0
  v_mul_f32 v192, v192, v23
  v_mul_f32 v193, v193, v23
  v_mfma_f32_16x16x32_bf16 v[208:211], v[252:255], v[160:163], v[208:211]
  v_mul_f32 v194, v194, v23
  s_waitcnt lgkmcnt(6)
  v_mfma_f32_16x16x32_bf16 v[208:211], v[216:219], v[164:167], v[208:211]
  v_mul_f32 v195, v195, v23
  v_cvt_pk_bf16_f32 v28, v192, v193
  v_mfma_f32_16x16x32_bf16 v[208:211], v[220:223], v[176:179], v[208:211]
  v_cvt_pk_bf16_f32 v29, v194, v195
  s_waitcnt lgkmcnt(5)
  v_mfma_f32_16x16x32_bf16 v[208:211], v[224:227], v[180:183], v[208:211]
  v_mul_f32 v196, v196, v23
  s_waitcnt lgkmcnt(4)
  v_mfma_f32_16x16x32_bf16 v[208:211], v[228:231], v[72:75], v[208:211]
  v_mul_f32 v197, v197, v23
  s_waitcnt lgkmcnt(3)
  v_mfma_f32_16x16x32_bf16 v[212:215], v[232:235], v[156:159], 0
  v_mul_f32 v198, v198, v23
  s_waitcnt lgkmcnt(2)
  v_mfma_f32_16x16x32_bf16 v[212:215], v[236:239], v[160:163], v[212:215]
  v_mul_f32 v199, v199, v23
  s_waitcnt lgkmcnt(1)
  v_mfma_f32_16x16x32_bf16 v[212:215], v[240:243], v[164:167], v[212:215]
  v_cvt_pk_bf16_f32 v30, v196, v197
  s_waitcnt lgkmcnt(0)
  v_mfma_f32_16x16x32_bf16 v[212:215], v[244:247], v[176:179], v[212:215]
  v_cvt_pk_bf16_f32 v31, v198, v199
  v_mfma_f32_16x16x32_bf16 v[212:215], v[40:43], v[180:183], v[212:215]
  v_mul_f32 v208, v208, v23
  v_mfma_f32_16x16x32_bf16 v[212:215], v[44:47], v[72:75], v[212:215]
  v_mul_f32 v209, v209, v23
  v_mul_f32 v210, v210, v23
  buffer_store_dwordx4 v[28:31], v6, s[16:19], 0 offen offset:256 nt sc1
  v_mul_f32 v211, v211, v23
  v_cvt_pk_bf16_f32 v36, v208, v209
  v_cvt_pk_bf16_f32 v37, v210, v211
  s_nop 1
  v_mul_f32 v212, v212, v23
  v_mul_f32 v213, v213, v23
  v_mul_f32 v214, v214, v23
  v_mul_f32 v215, v215, v23
  v_cvt_pk_bf16_f32 v38, v212, v213
  v_cvt_pk_bf16_f32 v39, v214, v215
  buffer_store_dwordx4 v[36:39], v6, s[16:19], 0 offen offset:320 nt sc1
  s_endpgm
FB0:
  s_nop 7
  v_max3_f32 v22, v24, v25, v26
  v_max3_f32 v22, v22, v27, v28
  v_max3_f32 v22, v22, v29, v30
  v_max3_f32 v22, v22, v31, v32
  v_max3_f32 v22, v22, v33, v34
  v_max3_f32 v22, v22, v35, v36
  v_max3_f32 v22, v22, v37, v38
  v_max3_f32 v22, v22, v39, v40
  v_max3_f32 v22, v22, v41, v42
  v_max3_f32 v22, v22, v43, v44
  v_max3_f32 v22, v22, v45, v46
  v_max3_f32 v22, v22, v47, v48
  v_max3_f32 v22, v22, v49, v50
  v_max3_f32 v22, v22, v51, v52
  v_max3_f32 v22, v22, v53, v54
  s_mov_b32 s52, 0xff7fffff
  v_max3_f32 v22, v22, v55, s52
  v_mov_b32 v23, v22
  s_nop 1
  v_permlane32_swap_b32 v22, v23
  s_nop 1
  v_max_f32 v22, v22, v23
  v_mov_b32 v23, v22
  s_nop 1
  v_permlane16_swap_b32 v22, v23
  s_nop 1
  v_max_f32 v22, v22, v23
  v_sub_f32 v24, v24, v22
  v_sub_f32 v25, v25, v22
  v_sub_f32 v26, v26, v22
  v_sub_f32 v27, v27, v22
  v_sub_f32 v28, v28, v22
  v_sub_f32 v29, v29, v22
  v_sub_f32 v30, v30, v22
  v_sub_f32 v31, v31, v22
  v_sub_f32 v32, v32, v22
  v_sub_f32 v33, v33, v22
  v_sub_f32 v34, v34, v22
  v_sub_f32 v35, v35, v22
  v_sub_f32 v36, v36, v22
  v_sub_f32 v37, v37, v22
  v_sub_f32 v38, v38, v22
  v_sub_f32 v39, v39, v22
  v_sub_f32 v40, v40, v22
  v_sub_f32 v41, v41, v22
  v_sub_f32 v42, v42, v22
  v_sub_f32 v43, v43, v22
  v_sub_f32 v44, v44, v22
  v_sub_f32 v45, v45, v22
  v_sub_f32 v46, v46, v22
  v_sub_f32 v47, v47, v22
  v_sub_f32 v48, v48, v22
  v_sub_f32 v49, v49, v22
  v_sub_f32 v50, v50, v22
  v_sub_f32 v51, v51, v22
  v_sub_f32 v52, v52, v22
  v_sub_f32 v53, v53, v22
  v_sub_f32 v54, v54, v22
  v_sub_f32 v55, v55, v22
  v_exp_f32 v24, v24
  v_exp_f32 v25, v25
  v_exp_f32 v26, v26
  v_exp_f32 v27, v27
  v_exp_f32 v28, v28
  v_exp_f32 v29, v29
  v_exp_f32 v30, v30
  v_exp_f32 v31, v31
  v_exp_f32 v32, v32
  v_exp_f32 v33, v33
  v_exp_f32 v34, v34
  v_exp_f32 v35, v35
  v_exp_f32 v36, v36
  v_exp_f32 v37, v37
  v_exp_f32 v38, v38
  v_exp_f32 v39, v39
  v_exp_f32 v40, v40
  v_exp_f32 v41, v41
  v_exp_f32 v42, v42
  v_exp_f32 v43, v43
  v_exp_f32 v44, v44
  v_exp_f32 v45, v45
  v_exp_f32 v46, v46
  v_exp_f32 v47, v47
  v_exp_f32 v48, v48
  v_exp_f32 v49, v49
  v_exp_f32 v50, v50
  v_exp_f32 v51, v51
  v_exp_f32 v52, v52
  v_exp_f32 v53, v53
  v_exp_f32 v54, v54
  v_exp_f32 v55, v55
  s_nop 0
  v_cvt_pk_bf16_f32 v136, v24, v25
  v_cvt_pk_bf16_f32 v137, v26, v27
  v_cvt_pk_bf16_f32 v138, v28, v29
  v_cvt_pk_bf16_f32 v139, v30, v31
  v_cvt_pk_bf16_f32 v140, v32, v33
  v_cvt_pk_bf16_f32 v141, v34, v35
  v_cvt_pk_bf16_f32 v142, v36, v37
  v_cvt_pk_bf16_f32 v143, v38, v39
  v_cvt_pk_bf16_f32 v144, v40, v41
  v_cvt_pk_bf16_f32 v145, v42, v43
  v_cvt_pk_bf16_f32 v146, v44, v45
  v_cvt_pk_bf16_f32 v147, v46, v47
  v_cvt_pk_bf16_f32 v148, v48, v49
  v_cvt_pk_bf16_f32 v149, v50, v51
  v_cvt_pk_bf16_f32 v150, v52, v53
  v_cvt_pk_bf16_f32 v151, v54, v55
  s_nop 1
  v_mfma_f32_16x16x32_bf16 v[184:187], v[192:195], v[136:139], 0
  v_mfma_f32_16x16x32_bf16 v[184:187], v[192:195], v[140:143], v[184:187]
  v_mfma_f32_16x16x32_bf16 v[184:187], v[192:195], v[144:147], v[184:187]
  v_mfma_f32_16x16x32_bf16 v[184:187], v[192:195], v[148:151], v[184:187]
  s_nop 7
  s_branch FBR0
FB1:
  s_nop 7
  v_max3_f32 v22, v56, v57, v58
  v_max3_f32 v22, v22, v59, v60
  v_max3_f32 v22, v22, v61, v62
  v_max3_f32 v22, v22, v63, v64
  v_max3_f32 v22, v22, v65, v66
  v_max3_f32 v22, v22, v67, v68
  v_max3_f32 v22, v22, v69, v70
  v_max3_f32 v22, v22, v71, v72
  v_max3_f32 v22, v22, v73, v74
  v_max3_f32 v22, v22, v75, v76
  v_max3_f32 v22, v22, v77, v78
  v_max3_f32 v22, v22, v79, v80
  v_max3_f32 v22, v22, v81, v82
  v_max3_f32 v22, v22, v83, v84
  v_max3_f32 v22, v22, v85, v86
  s_mov_b32 s52, 0xff7fffff
  v_max3_f32 v22, v22, v87, s52
  v_mov_b32 v23, v22
  s_nop 1
  v_permlane32_swap_b32 v22, v23
  s_nop 1
  v_max_f32 v22, v22, v23
  v_mov_b32 v23, v22
  s_nop 1
  v_permlane16_swap_b32 v22, v23
  s_nop 1
  v_max_f32 v22, v22, v23
  v_sub_f32 v56, v56, v22
  v_sub_f32 v57, v57, v22
  v_sub_f32 v58, v58, v22
  v_sub_f32 v59, v59, v22
  v_sub_f32 v60, v60, v22
  v_sub_f32 v61, v61, v22
  v_sub_f32 v62, v62, v22
  v_sub_f32 v63, v63, v22
  v_sub_f32 v64, v64, v22
  v_sub_f32 v65, v65, v22
  v_sub_f32 v66, v66, v22
  v_sub_f32 v67, v67, v22
  v_sub_f32 v68, v68, v22
  v_sub_f32 v69, v69, v22
  v_sub_f32 v70, v70, v22
  v_sub_f32 v71, v71, v22
  v_sub_f32 v72, v72, v22
  v_sub_f32 v73, v73, v22
  v_sub_f32 v74, v74, v22
  v_sub_f32 v75, v75, v22
  v_sub_f32 v76, v76, v22
  v_sub_f32 v77, v77, v22
  v_sub_f32 v78, v78, v22
  v_sub_f32 v79, v79, v22
  v_sub_f32 v80, v80, v22
  v_sub_f32 v81, v81, v22
  v_sub_f32 v82, v82, v22
  v_sub_f32 v83, v83, v22
  v_sub_f32 v84, v84, v22
  v_sub_f32 v85, v85, v22
  v_sub_f32 v86, v86, v22
  v_sub_f32 v87, v87, v22
  v_exp_f32 v56, v56
  v_exp_f32 v57, v57
  v_exp_f32 v58, v58
  v_exp_f32 v59, v59
  v_exp_f32 v60, v60
  v_exp_f32 v61, v61
  v_exp_f32 v62, v62
  v_exp_f32 v63, v63
  v_exp_f32 v64, v64
  v_exp_f32 v65, v65
  v_exp_f32 v66, v66
  v_exp_f32 v67, v67
  v_exp_f32 v68, v68
  v_exp_f32 v69, v69
  v_exp_f32 v70, v70
  v_exp_f32 v71, v71
  v_exp_f32 v72, v72
  v_exp_f32 v73, v73
  v_exp_f32 v74, v74
  v_exp_f32 v75, v75
  v_exp_f32 v76, v76
  v_exp_f32 v77, v77
  v_exp_f32 v78, v78
  v_exp_f32 v79, v79
  v_exp_f32 v80, v80
  v_exp_f32 v81, v81
  v_exp_f32 v82, v82
  v_exp_f32 v83, v83
  v_exp_f32 v84, v84
  v_exp_f32 v85, v85
  v_exp_f32 v86, v86
  v_exp_f32 v87, v87
  s_nop 0
  v_cvt_pk_bf16_f32 v152, v56, v57
  v_cvt_pk_bf16_f32 v153, v58, v59
  v_cvt_pk_bf16_f32 v154, v60, v61
  v_cvt_pk_bf16_f32 v155, v62, v63
  v_cvt_pk_bf16_f32 v156, v64, v65
  v_cvt_pk_bf16_f32 v157, v66, v67
  v_cvt_pk_bf16_f32 v158, v68, v69
  v_cvt_pk_bf16_f32 v159, v70, v71
  v_cvt_pk_bf16_f32 v160, v72, v73
  v_cvt_pk_bf16_f32 v161, v74, v75
  v_cvt_pk_bf16_f32 v162, v76, v77
  v_cvt_pk_bf16_f32 v163, v78, v79
  v_cvt_pk_bf16_f32 v164, v80, v81
  v_cvt_pk_bf16_f32 v165, v82, v83
  v_cvt_pk_bf16_f32 v166, v84, v85
  v_cvt_pk_bf16_f32 v167, v86, v87
  s_nop 1
  v_mfma_f32_16x16x32_bf16 v[188:191], v[192:195], v[152:155], 0
  v_mfma_f32_16x16x32_bf16 v[188:191], v[192:195], v[156:159], v[188:191]
  v_mfma_f32_16x16x32_bf16 v[188:191], v[192:195], v[160:163], v[188:191]
  v_mfma_f32_16x16x32_bf16 v[188:191], v[192:195], v[164:167], v[188:191]
  s_nop 7
  s_branch FBR1
FB1s:
  s_nop 7
  v_max3_f32 v22, v56, v57, v58
  v_max3_f32 v22, v22, v59, v60
  v_max3_f32 v22, v22, v61, v62
  v_max3_f32 v22, v22, v63, v64
  v_max3_f32 v22, v22, v65, v66
  v_max3_f32 v22, v22, v67, v68
  v_max3_f32 v22, v22, v69, v70
  v_max3_f32 v22, v22, v71, v72
  v_max3_f32 v22, v22, v73, v74
  v_max3_f32 v22, v22, v75, v76
  v_max3_f32 v22, v22, v77, v78
  v_max3_f32 v22, v22, v79, v80
  v_max3_f32 v22, v22, v81, v82
  v_max3_f32 v22, v22, v83, v84
  v_max3_f32 v22, v22, v85, v86
  s_mov_b32 s52, 0xff7fffff
  v_max3_f32 v22, v22, v87, s52
  v_mov_b32 v23, v22
  s_nop 1
  v_permlane32_swap_b32 v22, v23
  s_nop 1
  v_max_f32 v22, v22, v23
  v_mov_b32 v23, v22
  s_nop 1
  v_permlane16_swap_b32 v22, v23
  s_nop 1
  v_max_f32 v22, v22, v23
  v_sub_f32 v56, v56, v22
  v_sub_f32 v57, v57, v22
  v_sub_f32 v58, v58, v22
  v_sub_f32 v59, v59, v22
  v_sub_f32 v60, v60, v22
  v_sub_f32 v61, v61, v22
  v_sub_f32 v62, v62, v22
  v_sub_f32 v63, v63, v22
  v_sub_f32 v64, v64, v22
  v_sub_f32 v65, v65, v22
  v_sub_f32 v66, v66, v22
  v_sub_f32 v67, v67, v22
  v_sub_f32 v68, v68, v22
  v_sub_f32 v69, v69, v22
  v_sub_f32 v70, v70, v22
  v_sub_f32 v71, v71, v22
  v_sub_f32 v72, v72, v22
  v_sub_f32 v73, v73, v22
  v_sub_f32 v74, v74, v22
  v_sub_f32 v75, v75, v22
  v_sub_f32 v76, v76, v22
  v_sub_f32 v77, v77, v22
  v_sub_f32 v78, v78, v22
  v_sub_f32 v79, v79, v22
  v_sub_f32 v80, v80, v22
  v_sub_f32 v81, v81, v22
  v_sub_f32 v82, v82, v22
  v_sub_f32 v83, v83, v22
  v_sub_f32 v84, v84, v22
  v_sub_f32 v85, v85, v22
  v_sub_f32 v86, v86, v22
  v_sub_f32 v87, v87, v22
  v_exp_f32 v56, v56
  v_exp_f32 v57, v57
  v_exp_f32 v58, v58
  v_exp_f32 v59, v59
  v_exp_f32 v60, v60
  v_exp_f32 v61, v61
  v_exp_f32 v62, v62
  v_exp_f32 v63, v63
  v_exp_f32 v64, v64
  v_exp_f32 v65, v65
  v_exp_f32 v66, v66
  v_exp_f32 v67, v67
  v_exp_f32 v68, v68
  v_exp_f32 v69, v69
  v_exp_f32 v70, v70
  v_exp_f32 v71, v71
  v_exp_f32 v72, v72
  v_exp_f32 v73, v73
  v_exp_f32 v74, v74
  v_exp_f32 v75, v75
  v_exp_f32 v76, v76
  v_exp_f32 v77, v77
  v_exp_f32 v78, v78
  v_exp_f32 v79, v79
  v_exp_f32 v80, v80
  v_exp_f32 v81, v81
  v_exp_f32 v82, v82
  v_exp_f32 v83, v83
  v_exp_f32 v84, v84
  v_exp_f32 v85, v85
  v_exp_f32 v86, v86
  v_exp_f32 v87, v87
  s_nop 0
  v_cvt_pk_bf16_f32 v152, v56, v57
  v_cvt_pk_bf16_f32 v153, v58, v59
  v_cvt_pk_bf16_f32 v154, v60, v61
  v_cvt_pk_bf16_f32 v155, v62, v63
  v_cvt_pk_bf16_f32 v156, v64, v65
  v_cvt_pk_bf16_f32 v157, v66, v67
  v_cvt_pk_bf16_f32 v158, v68, v69
  v_cvt_pk_bf16_f32 v159, v70, v71
  v_cvt_pk_bf16_f32 v160, v72, v73
  v_cvt_pk_bf16_f32 v161, v74, v75
  v_cvt_pk_bf16_f32 v162, v76, v77
  v_cvt_pk_bf16_f32 v163, v78, v79
  v_cvt_pk_bf16_f32 v164, v80, v81
  v_cvt_pk_bf16_f32 v165, v82, v83
  v_cvt_pk_bf16_f32 v166, v84, v85
  v_cvt_pk_bf16_f32 v167, v86, v87
  s_nop 1
  v_mfma_f32_16x16x32_bf16 v[188:191], v[192:195], v[152:155], 0
  v_mfma_f32_16x16x32_bf16 v[188:191], v[192:195], v[156:159], v[188:191]
  v_mfma_f32_16x16x32_bf16 v[188:191], v[192:195], v[160:163], v[188:191]
  v_mfma_f32_16x16x32_bf16 v[188:191], v[192:195], v[164:167], v[188:191]
  s_nop 7
  s_branch FBR1s
MK_end:
.section .rodata,"a"
.p2align 6
.amdhsa_kernel standalone__neighborhood_nat__vision_kernel
  .amdhsa_next_free_vgpr 256
  .amdhsa_next_free_sgpr 102
  .amdhsa_accum_offset 256
  .amdhsa_group_segment_fixed_size 0
  .amdhsa_kernarg_size 48
  .amdhsa_user_sgpr_count 2
  .amdhsa_user_sgpr_kernarg_segment_ptr 1
  .amdhsa_system_sgpr_workgroup_id_x 1
.end_amdhsa_kernel
```

```asm
; @launch grid=(256,1,1) block=(512,1,1) lds=163840
.amdgcn_target "amdgcn-amd-amdhsa--gfx950"
.text
.globl standalone__neighborhood_nat__vision_kernel
.p2align 8
.type standalone__neighborhood_nat__vision_kernel,@function
standalone__neighborhood_nat__vision_kernel:
  s_cmp_ge_u32 s2, 256
  s_cbranch_scc1 MK_done
  s_load_dwordx8 s[4:11], s[0:1], 0
  s_load_dwordx4 s[84:87], s[0:1], 32
  s_getpc_b64 s[12:13]
MK_pc:
  s_and_b32 s13, s13, 0xffff
  s_mov_b32 s14, MK_end-MK_pc
  s_mov_b32 s15, 0x00020000
  v_lshlrev_b32 v23, 7, v0
  buffer_load_dword v255, v23, s[12:15], 0 offen
  v_lshrrev_b32 v130, 6, v0
  v_and_b32 v0, 63, v0
  v_readfirstlane_b32 s24, v130
  v_and_b32 v128, 15, v0
  v_lshrrev_b32 v129, 4, v0
  v_lshrrev_b32 v130, 5, v0
  v_bfe_u32 v131, v0, 3, 2
  v_lshl_add_u32 v130, v130, 3, v131
  v_mul_u32_u24 v130, 1152, v130
  s_and_b32 s26, s24, 1
  s_lshl_b32 s46, s26, 2
  v_add_u32 v131, s46, v129
  v_and_b32 v132, 7, v0
  v_xor_b32 v131, v131, v132
  v_lshl_add_u32 v96, v131, 4, v130
  s_lshr_b32 s46, s24, 2
  s_lshl_b32 s46, s46, 5
  s_lshl_b32 s47, s26, 4
  s_add_u32 s46, s46, s47
  s_and_b32 s47, s24, 2
  s_lshl_b32 s47, s47, 1
  s_add_u32 s46, s46, s47
  s_mul_i32 s92, s46, 1152
  s_lshl_b32 s41, s24, 10
  s_cmp_lt_u32 s24, 4
  s_cselect_b64 vcc, -1, 0
  s_cbranch_vccz SL1
  s_waitcnt lgkmcnt(0)
  s_mov_b32 s88, s6
  s_and_b32 s89, s7, 0xffff
  s_mov_b32 s90, 221184
  s_mov_b32 s91, 0x00020000
  s_add_i32 m0, s41, 0
  s_add_i32 s100, s92, 0
  buffer_load_dwordx4 v96, s[88:91], s100 offen lds
  s_add_i32 m0, s41, 8192
  s_add_i32 s100, s92, 73728
  buffer_load_dwordx4 v96, s[88:91], s100 offen lds
  s_add_i32 m0, s41, 16384
  s_add_i32 s100, s92, 147456
  buffer_load_dwordx4 v96, s[88:91], s100 offen lds
  s_add_i32 m0, s41, 24576
  s_add_i32 s100, s92, 384
  buffer_load_dwordx4 v96, s[88:91], s100 offen lds
  s_add_i32 m0, s41, 32768
  s_add_i32 s100, s92, 74112
  buffer_load_dwordx4 v96, s[88:91], s100 offen lds
  s_add_i32 m0, s41, 40960
  s_add_i32 s100, s92, 147840
  buffer_load_dwordx4 v96, s[88:91], s100 offen lds
SL1:
  s_bfe_u32 s27, s2, 0x10002
  s_bfe_u32 s28, s2, 0x10001
  s_and_b32 s29, s2, 1
  s_lshl_b32 s29, s29, 2
  s_lshr_b32 s46, s2, 6
  s_add_u32 s29, s29, s46
  s_bfe_u32 s30, s2, 0x30003
  s_mul_i32 s37, s29, 14
  s_add_i32 s37, s37, -6
  s_max_i32 s29, s37, -4
  s_mul_i32 s30, s30, 14
  s_add_i32 s30, s30, -6
  s_lshr_b32 s25, s24, 1
  s_add_u32 s25, s25, 2
  s_and_b32 s25, s25, 3
  s_sub_u32 s56, 0, s27
  s_mul_i32 s57, s27, 224
  s_sub_u32 s58, 0, s28
  s_mul_i32 s59, s28, 224
  v_and_b32 v130, 7, v128
  s_mul_i32 s46, s26, 7
  s_add_i32 s46, s46, s30
  v_cmp_lt_u32 s[48:49], 6, v130
  v_add_u32 v130, s46, v130
  v_max_i32 v19, 0, v130
  v_add3_u32 v130, v130, v19, 6
  v_xor_b32 v130, s58, v130
  v_add_u32 v130, s59, v130
  v_subrev_u32 v19, s30, v19
  v_mul_u32_u24 v130, 384, v130
  v_lshl_add_u32 v130, v129, 4, v130
  s_lshl_b32 s46, s25, 2
  s_add_i32 s46, s46, -2
  s_mov_b32 s47, 86016
  v_lshrrev_b32 v131, 3, v128
  v_add_u32 v131, s46, v131
  v_mov_b32 v132, 0x80000000
  v_cmp_gt_i32 s[42:43], 0, v131
  v_add_u32 v5, s37, v131
  v_max_i32 v21, 0, v5
  v_add3_u32 v5, v5, v21, 6
  s_or_b64 s[42:43], s[42:43], s[48:49]
  v_xor_b32 v5, s56, v5
  v_add_u32 v5, s57, v5
  v_subrev_u32 v21, s29, v21
  v_mad_u32_u24 v5, v5, s47, v130
  v_cndmask_b32 v21, v21, v132, s[42:43]
  v_cndmask_b32 v5, v5, v132, s[42:43]
  v_add_u32 v131, 2, v131
  v_cmp_gt_i32 s[44:45], 0, v131
  v_add_u32 v6, s37, v131
  v_max_i32 v22, 0, v6
  v_add3_u32 v6, v6, v22, 6
  s_or_b64 s[44:45], s[44:45], s[48:49]
  v_xor_b32 v6, s56, v6
  v_add_u32 v6, s57, v6
  v_subrev_u32 v22, s29, v22
  v_mad_u32_u24 v6, v6, s47, v130
  v_cndmask_b32 v22, v22, v132, s[44:45]
  v_cndmask_b32 v6, v6, v132, s[44:45]
  s_waitcnt lgkmcnt(0)
  s_mov_b32 s88, s6
  s_and_b32 s89, s7, 0xffff
  s_mov_b32 s90, 221184
  s_mov_b32 s91, 0x00020000
  s_cmp_lg_u32 s24, 5
  s_cbranch_scc1 MK_ntlb
  s_max_i32 s46, s37, 0
  s_lshl_b32 s46, s46, 1
  s_sub_u32 s47, 184, s46
  s_cmp_eq_u32 s27, 0
  s_cselect_b32 s46, s46, s47
  s_mul_i32 s46, s46, 86016
  s_load_dword s94, s[4:5], s46
  s_load_dword s95, s[10:11], s46
  s_add_u32 s46, s46, 1720256
  s_load_dword s94, s[4:5], s46
  s_load_dword s95, s[10:11], s46
  s_add_u32 s46, s46, 1720256
  s_load_dword s94, s[4:5], s46
  s_load_dword s95, s[10:11], s46
  s_load_dword s94, s[84:85], 128
  s_load_dword s95, s[86:87], 0x20000
MK_ntlb:
  s_lshr_b32 s46, s24, 1
  s_cmp_lg_u32 s46, 2
  s_cbranch_scc1 MK_nwpf
  s_cmp_eq_u32 s24, 4
  s_cselect_b32 s46, 54, 18
  s_cselect_b32 s12, s6, s8
  s_cselect_b32 s13, s7, s9
  s_and_b32 s13, s13, 0xffff
  s_lshr_b32 s47, s2, 3
  s_mul_i32 s47, s47, s46
  s_lshl_b32 s100, s47, 7
  s_lshl_b32 s46, s46, 7
  s_add_u32 s14, s100, s46
  s_mov_b32 s15, 0x00020000
  v_lshlrev_b32 v23, 7, v0
  buffer_load_dword v254, v23, s[12:15], s100 offen
MK_nwpf:
  s_mov_b32 s12, s4
  s_and_b32 s13, s5, 0xffff
  s_mov_b32 s14, 19267584
  s_mov_b32 s15, 0x00020000
  s_movk_i32 s54, 112
  s_mov_b32 s16, s10
  s_and_b32 s17, s11, 0xffff
  s_mov_b32 s18, 19267584
  s_mov_b32 s19, 0x00020000
  s_mov_b32 s4, s8
  s_and_b32 s5, s9, 0xffff
  s_mov_b32 s6, 73728
  s_mov_b32 s7, 0x00020000
  s_mov_b32 s8, s84
  s_and_b32 s9, s85, 0xffff
  s_mov_b32 s10, 256
  s_mov_b32 s11, 0x00020000
  s_mov_b32 s20, s86
  s_and_b32 s21, s87, 0xffff
  s_mov_b32 s22, 73728
  s_mov_b32 s23, 0x00020000
  v_lshlrev_b32 v1, 4, v0
  v_add_u32 v2, 36864, v1
  s_and_b32 s40, s24, 3
  s_lshl_b32 s40, s40, 10
  v_bfe_u32 v130, v128, 1, 3
  v_xor_b32 v130, v130, v129
  v_lshlrev_b32 v131, 7, v128
  v_lshl_add_u32 v131, v130, 4, v131
  s_lshr_b32 s46, s24, 2
  s_mul_i32 s47, s46, 12288
  s_add_u32 s47, s47, 0
  v_add_u32 v97, s47, v131
  v_xor_b32 v98, 64, v97
  s_mul_i32 s47, s40, 6
  s_add_u32 s47, s47, 24576
  v_add_u32 v99, s47, v131
  v_xor_b32 v100, 64, v99
  v_mov_b32 v135, 0
  v_mov_b32 v134, 0
  s_lshr_b32 s46, s24, 2
  s_mul_i32 s46, s46, 3072
  s_mul_i32 s47, s40, 18
  s_add_u32 s46, s46, s47
  s_sub_u32 s46, 58368, s46
  v_add_u32 v101, s46, v1
  s_lshl_b32 s46, s29, 1
  s_xor_b32 s46, s46, s56
  s_mul_i32 s47, s27, 222
  s_add_i32 s31, s46, s47
  s_mul_i32 s31, s31, 86016
  s_mul_i32 s32, s27, -688128
  s_add_i32 s32, s32, 344064
  s_lshr_b32 s33, s29, 31
  s_lshl_b32 s33, s33, 1
  s_lshl_b32 s38, s40, 2
  s_add_u32 s39, s38, 3072
  s_min_u32 s39, s39, 14336
  s_mul_i32 s48, s27, 172032
  s_sub_u32 s49, 172032, s48
  v_mov_b32 v132, s48
  v_mov_b32 v133, s49
  s_lshr_b32 s46, s38, 4
  s_add_u32 s46, s46, 0
  v_add_u32 v130, s46, v0
  v_mul_u32_u24 v13, 2731, v130
  v_lshrrev_b32 v13, 16, v13
  v_cmp_le_u32 s[52:53], 20, v13
  v_mul_u32_u24 v131, 24, v13
  v_sub_u32 v130, v130, v131
  v_subrev_u32 v131, 20, v13
  v_cndmask_b32 v13, v13, v131, s[52:53]
  v_bfe_u32 v131, v13, 1, 3
  v_xor_b32 v130, v130, v131
  v_cndmask_b32 v131, v132, v133, s[52:53]
  v_lshl_add_u32 v130, v130, 4, v131
  v_add_u32 v13, s30, v13
  v_max_i32 v13, 0, v13
  s_cbranch_vccz SL2
  s_add_i32 m0, s41, 4096
  s_add_i32 s100, s92, 36864
  buffer_load_dwordx4 v96, s[88:91], s100 offen lds
  s_add_i32 m0, s41, 12288
  s_add_i32 s100, s92, 110592
  buffer_load_dwordx4 v96, s[88:91], s100 offen lds
  s_add_i32 m0, s41, 20480
  s_add_i32 s100, s92, 184320
  buffer_load_dwordx4 v96, s[88:91], s100 offen lds
  s_add_i32 m0, s41, 28672
  s_add_i32 s100, s92, 37248
  buffer_load_dwordx4 v96, s[88:91], s100 offen lds
  s_add_i32 m0, s41, 36864
  s_add_i32 s100, s92, 110976
  buffer_load_dwordx4 v96, s[88:91], s100 offen lds
  s_add_i32 m0, s41, 45056
  s_add_i32 s100, s92, 184704
  buffer_load_dwordx4 v96, s[88:91], s100 offen lds
SL2:
  v_lshlrev_b32 v13, 1, v13
  v_xor_b32 v13, s58, v13
  v_add_u32 v13, s59, v13
  v_mul_u32_u24 v13, 384, v13
  v_add_u32 v13, v13, v130
  s_lshr_b32 s46, s38, 4
  s_add_u32 s46, s46, 64
  v_add_u32 v130, s46, v0
  v_mul_u32_u24 v14, 2731, v130
  v_lshrrev_b32 v14, 16, v14
  v_cmp_le_u32 s[52:53], 20, v14
  v_mul_u32_u24 v131, 24, v14
  v_sub_u32 v130, v130, v131
  v_subrev_u32 v131, 20, v14
  v_cndmask_b32 v14, v14, v131, s[52:53]
  v_bfe_u32 v131, v14, 1, 3
  v_xor_b32 v130, v130, v131
  v_cndmask_b32 v131, v132, v133, s[52:53]
  v_lshl_add_u32 v130, v130, 4, v131
  v_add_u32 v14, s30, v14
  v_max_i32 v14, 0, v14
  v_lshlrev_b32 v14, 1, v14
  v_xor_b32 v14, s58, v14
  v_add_u32 v14, s59, v14
  v_mul_u32_u24 v14, 384, v14
  v_add_u32 v14, v14, v130
  s_lshr_b32 s46, s38, 4
  s_add_u32 s46, s46, 128
  v_add_u32 v130, s46, v0
  v_mul_u32_u24 v3, 2731, v130
  v_lshrrev_b32 v3, 16, v3
  v_cmp_le_u32 s[52:53], 20, v3
  v_mul_u32_u24 v131, 24, v3
  v_sub_u32 v130, v130, v131
  v_subrev_u32 v131, 20, v3
  v_cndmask_b32 v3, v3, v131, s[52:53]
  v_bfe_u32 v131, v3, 1, 3
  v_xor_b32 v130, v130, v131
  v_cndmask_b32 v131, v132, v133, s[52:53]
  v_lshl_add_u32 v130, v130, 4, v131
  v_add_u32 v3, s30, v3
  v_max_i32 v3, 0, v3
  v_lshlrev_b32 v3, 1, v3
  v_xor_b32 v3, s58, v3
  v_add_u32 v3, s59, v3
  v_mul_u32_u24 v3, 384, v3
  v_add_u32 v3, v3, v130
  s_lshr_b32 s46, s39, 4
  v_add_u32 v130, s46, v0
  v_mul_u32_u24 v4, 2731, v130
  v_lshrrev_b32 v4, 16, v4
  v_cmp_le_u32 s[52:53], 20, v4
  v_mul_u32_u24 v131, 24, v4
  v_sub_u32 v130, v130, v131
  v_subrev_u32 v131, 20, v4
  v_cndmask_b32 v4, v4, v131, s[52:53]
  v_bfe_u32 v131, v4, 1, 3
  v_xor_b32 v130, v130, v131
  v_cndmask_b32 v131, v132, v133, s[52:53]
  v_lshl_add_u32 v130, v130, 4, v131
  v_add_u32 v4, s30, v4
  v_max_i32 v4, 0, v4
  v_lshlrev_b32 v4, 1, v4
  v_xor_b32 v4, s58, v4
  v_add_u32 v4, s59, v4
  v_mul_u32_u24 v4, 384, v4
  v_add_u32 v4, v4, v130
  s_add_u32 s38, s38, 10240
  s_add_u32 s39, s39, 10240
  s_lshl_b32 s46, s25, 2
  s_add_i32 s46, s46, -2
  s_max_i32 s46, s46, 0
  s_add_i32 s46, s46, s37
  s_max_i32 s46, s46, 0
  s_sub_i32 s46, s46, s29
  s_lshl_b32 s34, s25, 2
  s_add_i32 s34, s34, s37
  s_max_i32 s34, s34, 0
  s_sub_i32 s34, s34, s29
  s_sub_u32 s46, s34, s46
  s_lshr_b32 s46, s46, 1
  s_mul_i32 s36, s46, -8
  s_add_i32 s36, s36, 7
  s_add_i32 s34, s34, -1
  s_add_i32 s35, s34, s36
  s_mul_i32 s36, s36, 7680
  s_lshl_b32 s47, s26, 2
  s_mul_i32 s46, s34, 7680
  s_add_i32 s46, s46, 10240
  v_add_u32 v130, s47, v128
  v_bfe_u32 v131, v130, 1, 3
  v_xor_b32 v131, v131, v129
  v_mul_u32_u24 v130, 384, v130
  v_lshl_add_u32 v130, v131, 4, v130
  v_add_u32 v7, s46, v130
  v_xor_b32 v8, 64, v7
  v_lshrrev_b32 v130, 2, v128
  v_lshl_add_u32 v130, v129, 2, v130
  v_add_u32 v130, s47, v130
  v_bfe_u32 v131, v130, 1, 3
  v_and_b32 v132, 2, v128
  v_lshlrev_b32 v132, 1, v132
  v_xor_b32 v131, v131, v132
  v_mul_u32_u24 v130, 384, v130
  v_lshl_add_u32 v130, v131, 4, v130
  v_and_b32 v131, 1, v128
  v_lshl_add_u32 v130, v131, 3, v130
  v_add_u32 v9, s46, v130
  v_xor_b32 v10, 16, v9
  v_xor_b32 v11, 32, v9
  v_xor_b32 v12, 48, v9
  v_lshl_add_u32 v130, v129, 2, s47
  v_sub_u32 v19, v130, v19
  v_cndmask_b32 v19, v19, 64, s[44:45]
  v_add_u32 v20, s36, v7
  v_add_u32 v0, s36, v8
  v_add_u32 v15, s36, v9
  v_add_u32 v16, s36, v10
  v_add_u32 v17, s36, v11
  v_add_u32 v18, s36, v12
  s_mov_b32 s93, 1037384597
  s_cbranch_vccnz SL3
  s_add_i32 m0, s41, 49152
  s_add_i32 s100, s92, 128
  buffer_load_dwordx4 v96, s[88:91], s100 offen lds
  s_add_i32 m0, s41, 57344
  s_add_i32 s100, s92, 73856
  buffer_load_dwordx4 v96, s[88:91], s100 offen lds
  s_add_i32 m0, s41, 65536
  s_add_i32 s100, s92, 147584
  buffer_load_dwordx4 v96, s[88:91], s100 offen lds
  s_add_i32 m0, s41, 73728
  s_add_i32 s100, s92, 512
  buffer_load_dwordx4 v96, s[88:91], s100 offen lds
  s_add_i32 m0, s41, 81920
  s_add_i32 s100, s92, 74240
  buffer_load_dwordx4 v96, s[88:91], s100 offen lds
  s_add_i32 m0, s41, 90112
  s_add_i32 s100, s92, 147968
  buffer_load_dwordx4 v96, s[88:91], s100 offen lds
  s_add_i32 m0, s41, 45056
  s_add_i32 s100, s92, -36736
  buffer_load_dwordx4 v96, s[88:91], s100 offen lds
  s_add_i32 m0, s41, 53248
  s_add_i32 s100, s92, 36992
  buffer_load_dwordx4 v96, s[88:91], s100 offen lds
  s_add_i32 m0, s41, 61440
  s_add_i32 s100, s92, 110720
  buffer_load_dwordx4 v96, s[88:91], s100 offen lds
  s_add_i32 m0, s41, 69632
  s_add_i32 s100, s92, -36352
  buffer_load_dwordx4 v96, s[88:91], s100 offen lds
  s_add_i32 m0, s41, 77824
  s_add_i32 s100, s92, 37376
  buffer_load_dwordx4 v96, s[88:91], s100 offen lds
  s_add_i32 m0, s41, 86016
  s_add_i32 s100, s92, 111104
  buffer_load_dwordx4 v96, s[88:91], s100 offen lds
SL3:
  s_cbranch_vccz SL4
  s_waitcnt vmcnt(0)
  s_branch SM4
SL4:
  s_waitcnt vmcnt(12)
SM4:
  s_barrier
  ds_read_b128 v[208:211], v99 offset:0
  ds_read_b128 v[212:215], v99 offset:2048
  ds_read_b128 v[216:219], v99 offset:4096
  ds_read_b128 v[184:187], v97 offset:0
  ds_read_b128 v[188:191], v97 offset:2048
  ds_read_b128 v[192:195], v97 offset:4096
  ds_read_b128 v[196:199], v97 offset:6144
  ds_read_b128 v[200:203], v97 offset:8192
  ds_read_b128 v[204:207], v97 offset:10240
  s_waitcnt lgkmcnt(5)
  v_mfma_f32_16x16x32_bf16 v[24:27], v[184:187], v[208:211], 0
  s_cbranch_vccz SL5
  s_add_i32 m0, s41, 98304
  s_add_i32 s100, s92, 256
  buffer_load_dwordx4 v96, s[88:91], s100 offen lds
SL5:
  v_mfma_f32_16x16x32_bf16 v[28:31], v[184:187], v[212:215], 0
  s_cbranch_vccz SL6
  s_add_i32 m0, s41, 106496
  s_add_i32 s100, s92, 73984
  buffer_load_dwordx4 v96, s[88:91], s100 offen lds
SL6:
  v_mfma_f32_16x16x32_bf16 v[32:35], v[184:187], v[216:219], 0
  s_waitcnt lgkmcnt(4)
  v_mfma_f32_16x16x32_bf16 v[36:39], v[188:191], v[208:211], 0
  ds_read_b128 v[244:247], v100 offset:0
  s_cbranch_vccz SL7
  s_add_i32 m0, s41, 114688
  s_add_i32 s100, s92, 147712
  buffer_load_dwordx4 v96, s[88:91], s100 offen lds
SL7:
  v_mfma_f32_16x16x32_bf16 v[40:43], v[188:191], v[212:215], 0
  ds_read_b128 v[248:251], v100 offset:2048
  s_cbranch_vccz SL8
  s_add_i32 m0, s41, 122880
  s_add_i32 s100, s92, 640
  buffer_load_dwordx4 v96, s[88:91], s100 offen lds
SL8:
  v_mfma_f32_16x16x32_bf16 v[44:47], v[188:191], v[216:219], 0
  s_waitcnt lgkmcnt(5)
  v_mfma_f32_16x16x32_bf16 v[48:51], v[192:195], v[208:211], 0
  ds_read_b128 v[252:255], v100 offset:4096
  s_cbranch_vccz SL9
  s_add_i32 m0, s41, 131072
  s_add_i32 s100, s92, 74368
  buffer_load_dwordx4 v96, s[88:91], s100 offen lds
SL9:
  v_mfma_f32_16x16x32_bf16 v[52:55], v[192:195], v[212:215], 0
  ds_read_b128 v[220:223], v98 offset:0
  s_cbranch_vccz SL10
  s_add_i32 m0, s41, 139264
  s_add_i32 s100, s92, 148096
  buffer_load_dwordx4 v96, s[88:91], s100 offen lds
SL10:
  v_mfma_f32_16x16x32_bf16 v[56:59], v[192:195], v[216:219], 0
  s_waitcnt lgkmcnt(6)
  v_mfma_f32_16x16x32_bf16 v[60:63], v[196:199], v[208:211], 0
  ds_read_b128 v[224:227], v98 offset:2048
  s_cbranch_vccz SL11
  s_add_i32 m0, s41, 102400
  s_add_i32 s100, s92, 37120
  buffer_load_dwordx4 v96, s[88:91], s100 offen lds
SL11:
  v_mfma_f32_16x16x32_bf16 v[64:67], v[196:199], v[212:215], 0
  ds_read_b128 v[228:231], v98 offset:4096
  s_cbranch_vccz SL12
  s_add_i32 m0, s41, 110592
  s_add_i32 s100, s92, 110848
  buffer_load_dwordx4 v96, s[88:91], s100 offen lds
SL12:
  v_mfma_f32_16x16x32_bf16 v[68:71], v[196:199], v[216:219], 0
  s_waitcnt lgkmcnt(7)
  v_mfma_f32_16x16x32_bf16 v[72:75], v[200:203], v[208:211], 0
  ds_read_b128 v[232:235], v98 offset:6144
  s_cbranch_vccz SL13
  s_add_i32 m0, s41, 118784
  s_add_i32 s100, s92, 184576
  buffer_load_dwordx4 v96, s[88:91], s100 offen lds
SL13:
  v_mfma_f32_16x16x32_bf16 v[76:79], v[200:203], v[212:215], 0
  ds_read_b128 v[236:239], v98 offset:8192
  s_cbranch_vccz SL14
  s_add_i32 m0, s41, 126976
  s_add_i32 s100, s92, 37504
  buffer_load_dwordx4 v96, s[88:91], s100 offen lds
SL14:
  v_mfma_f32_16x16x32_bf16 v[80:83], v[200:203], v[216:219], 0
  s_waitcnt lgkmcnt(8)
  v_mfma_f32_16x16x32_bf16 v[84:87], v[204:207], v[208:211], 0
  ds_read_b128 v[240:243], v98 offset:10240
  s_cbranch_vccz SL15
  s_add_i32 m0, s41, 135168
  s_add_i32 s100, s92, 111232
  buffer_load_dwordx4 v96, s[88:91], s100 offen lds
SL15:
  v_mfma_f32_16x16x32_bf16 v[88:91], v[204:207], v[212:215], 0
  s_cbranch_vccz SL16
  s_add_i32 m0, s41, 143360
  s_add_i32 s100, s92, 184960
  buffer_load_dwordx4 v96, s[88:91], s100 offen lds
SL16:
  v_mfma_f32_16x16x32_bf16 v[92:95], v[204:207], v[216:219], 0
  v_lshrrev_b32 v107, 4, v1
  s_cmp_lt_u32 s2, 72
  s_cbranch_scc0 MK_np1
  s_mul_hi_u32 s54, s2, 0x15555556
  s_lshl_b32 s54, s54, 6
  s_mul_i32 s55, s24, 6144
  s_add_u32 s100, s54, s55
  v_lshrrev_b32 v104, 2, v107
  v_mul_u32_u24 v104, 384, v104
  v_and_b32 v105, 3, v107
  v_lshl_add_u32 v104, v105, 4, v104
  s_add_u32 m0, s41, 147456
  s_nop 0
  buffer_load_dwordx4 v104, s[4:7], s100 offen lds
  s_mul_i32 s55, s40, 6
  s_add_u32 s100, s54, s55
  s_add_u32 m0, s40, 155648
  s_add_u32 s100, s100, 49152
  buffer_load_dwordx4 v104, s[4:7], s100 offen lds
MK_np1:
  s_sub_u32 s3, s2, 72
  s_lshr_b32 s3, s3, 31
  s_lshr_b32 s3, s3, s25
  s_cmp_eq_u32 s3, 0
  s_cbranch_scc1 MK_np3
  s_mul_hi_u32 s54, s2, 0x15555556
  s_mul_i32 s55, s54, 12
  s_sub_u32 s55, s2, s55
  s_cmp_ge_u32 s55, 6
  s_cselect_b32 s51, 1, 0
  s_mul_i32 s100, s51, 6
  s_sub_u32 s55, s55, s100
  v_lshrrev_b32 v106, 2, v128
  v_and_b32 v105, 3, v128
  v_lshl_add_u32 v134, v129, 3, v106
  v_lshlrev_b32 v134, 6, v134
  v_lshl_add_u32 v134, v105, 4, v134
  s_lshl_b32 s51, s51, 3
  s_add_u32 s51, s51, 147456
  v_add_u32 v134, s51, v134
  s_lshr_b32 s54, s55, 1
  s_lshl_b32 s54, s54, 6
  s_and_b32 s55, s55, 1
  s_lshl_b32 s55, s55, 4
  s_add_u32 s54, s54, s55
  v_lshrrev_b32 v104, 1, v106
  v_lshlrev_b32 v104, 5, v104
  v_and_b32 v106, 1, v106
  v_lshl_add_u32 v104, v106, 2, v104
  v_add3_u32 v104, v104, v105, s54
  v_mul_u32_u24 v104, 1152, v104
  v_lshl_add_u32 v135, v129, 4, v104
  s_mul_i32 s100, s26, 9216
  buffer_load_dwordx4 v[136:139], v135, s[88:91], s100 offen offset:768
  buffer_load_dwordx4 v[140:143], v135, s[88:91], s100 offen offset:832
  buffer_load_dwordx4 v[144:147], v135, s[88:91], s100 offen offset:896
  buffer_load_dwordx4 v[148:151], v135, s[88:91], s100 offen offset:960
  buffer_load_dwordx4 v[152:155], v135, s[88:91], s100 offen offset:1024
  buffer_load_dwordx4 v[156:159], v135, s[88:91], s100 offen offset:1088
MK_np3:
  s_cbranch_vccz SL18
  s_waitcnt vmcnt(63) lgkmcnt(0)
  s_branch SM18
SL18:
  s_cmp_lg_u32 s3, 0
  s_cbranch_scc1 CA17
  s_cmp_lt_u32 s2, 72
  s_cbranch_scc1 CB17
  s_waitcnt vmcnt(0)
CB17:
  s_waitcnt vmcnt(2)
CA17:
  s_waitcnt vmcnt(8) lgkmcnt(0)
SM18:
  s_barrier
  v_add_u32 v97, 49152, v97
  v_add_u32 v98, 49152, v98
  v_add_u32 v99, 49152, v99
  v_add_u32 v100, 49152, v100
  v_mfma_f32_16x16x32_bf16 v[24:27], v[220:223], v[244:247], v[24:27]
  ds_read_b128 v[208:211], v99 offset:0
  s_cbranch_vccnz SL19
  buffer_load_dwordx4 v[160:163], v6, s[12:15], 0 offen offset:0
SL19:
  v_mfma_f32_16x16x32_bf16 v[28:31], v[220:223], v[248:251], v[28:31]
  ds_read_b128 v[212:215], v99 offset:2048
  v_mfma_f32_16x16x32_bf16 v[32:35], v[220:223], v[252:255], v[32:35]
  v_mfma_f32_16x16x32_bf16 v[36:39], v[224:227], v[244:247], v[36:39]
  ds_read_b128 v[216:219], v99 offset:4096
  s_cbranch_vccnz SL20
  buffer_load_dwordx4 v[164:167], v6, s[12:15], 0 offen offset:64
SL20:
  v_mfma_f32_16x16x32_bf16 v[40:43], v[224:227], v[248:251], v[40:43]
  ds_read_b128 v[184:187], v97 offset:0
  v_mfma_f32_16x16x32_bf16 v[44:47], v[224:227], v[252:255], v[44:47]
  v_mfma_f32_16x16x32_bf16 v[48:51], v[228:231], v[244:247], v[48:51]
  ds_read_b128 v[188:191], v97 offset:2048
  s_cbranch_vccnz SL21
  buffer_load_dwordx4 v[168:171], v6, s[12:15], 0 offen offset:128
SL21:
  v_mfma_f32_16x16x32_bf16 v[52:55], v[228:231], v[248:251], v[52:55]
  ds_read_b128 v[192:195], v97 offset:4096
  v_mfma_f32_16x16x32_bf16 v[56:59], v[228:231], v[252:255], v[56:59]
  v_mfma_f32_16x16x32_bf16 v[60:63], v[232:235], v[244:247], v[60:63]
  ds_read_b128 v[196:199], v97 offset:6144
  s_cbranch_vccnz SL22
  buffer_load_dwordx4 v[172:175], v6, s[12:15], 0 offen offset:192
SL22:
  v_mfma_f32_16x16x32_bf16 v[64:67], v[232:235], v[248:251], v[64:67]
  ds_read_b128 v[200:203], v97 offset:8192
  v_mfma_f32_16x16x32_bf16 v[68:71], v[232:235], v[252:255], v[68:71]
  v_mfma_f32_16x16x32_bf16 v[72:75], v[236:239], v[244:247], v[72:75]
  ds_read_b128 v[204:207], v97 offset:10240
  s_cbranch_vccnz SL23
  buffer_load_dwordx4 v[176:179], v6, s[12:15], 0 offen offset:256
SL23:
  v_mfma_f32_16x16x32_bf16 v[76:79], v[236:239], v[248:251], v[76:79]
  v_mfma_f32_16x16x32_bf16 v[80:83], v[236:239], v[252:255], v[80:83]
  v_mfma_f32_16x16x32_bf16 v[84:87], v[240:243], v[244:247], v[84:87]
  s_cbranch_vccnz SL24
  buffer_load_dwordx4 v[180:183], v6, s[12:15], 0 offen offset:320
SL24:
  v_mfma_f32_16x16x32_bf16 v[88:91], v[240:243], v[248:251], v[88:91]
  v_mfma_f32_16x16x32_bf16 v[92:95], v[240:243], v[252:255], v[92:95]
  s_waitcnt lgkmcnt(5)
  v_mfma_f32_16x16x32_bf16 v[24:27], v[184:187], v[208:211], v[24:27]
  s_cbranch_vccnz SL25
  s_cmp_eq_u32 s25, 0
  s_cbranch_scc1 QB6
  buffer_load_dwordx4 v[136:139], v5, s[12:15], 0 offen offset:0
QB6:
SL25:
  v_mfma_f32_16x16x32_bf16 v[28:31], v[184:187], v[212:215], v[28:31]
  v_mfma_f32_16x16x32_bf16 v[32:35], v[184:187], v[216:219], v[32:35]
  s_waitcnt lgkmcnt(4)
  v_mfma_f32_16x16x32_bf16 v[36:39], v[188:191], v[208:211], v[36:39]
  ds_read_b128 v[244:247], v100 offset:0
  s_cbranch_vccnz SL26
  s_cmp_eq_u32 s25, 0
  s_cbranch_scc1 QB7
  buffer_load_dwordx4 v[140:143], v5, s[12:15], 0 offen offset:64
QB7:
SL26:
  v_mfma_f32_16x16x32_bf16 v[40:43], v[188:191], v[212:215], v[40:43]
  ds_read_b128 v[248:251], v100 offset:2048
  v_mfma_f32_16x16x32_bf16 v[44:47], v[188:191], v[216:219], v[44:47]
  s_waitcnt lgkmcnt(5)
  v_mfma_f32_16x16x32_bf16 v[48:51], v[192:195], v[208:211], v[48:51]
  ds_read_b128 v[252:255], v100 offset:4096
  s_cbranch_vccnz SL27
  s_cmp_eq_u32 s25, 0
  s_cbranch_scc1 QB8
  buffer_load_dwordx4 v[144:147], v5, s[12:15], 0 offen offset:128
QB8:
SL27:
  v_mfma_f32_16x16x32_bf16 v[52:55], v[192:195], v[212:215], v[52:55]
  ds_read_b128 v[220:223], v98 offset:0
  v_mfma_f32_16x16x32_bf16 v[56:59], v[192:195], v[216:219], v[56:59]
  s_waitcnt lgkmcnt(6)
  v_mfma_f32_16x16x32_bf16 v[60:63], v[196:199], v[208:211], v[60:63]
  ds_read_b128 v[224:227], v98 offset:2048
  s_cbranch_vccnz SL28
  s_cmp_eq_u32 s25, 0
  s_cbranch_scc1 QB9
  buffer_load_dwordx4 v[148:151], v5, s[12:15], 0 offen offset:192
QB9:
SL28:
  v_mfma_f32_16x16x32_bf16 v[64:67], v[196:199], v[212:215], v[64:67]
  ds_read_b128 v[228:231], v98 offset:4096
  v_mfma_f32_16x16x32_bf16 v[68:71], v[196:199], v[216:219], v[68:71]
  s_waitcnt lgkmcnt(7)
  v_mfma_f32_16x16x32_bf16 v[72:75], v[200:203], v[208:211], v[72:75]
  ds_read_b128 v[232:235], v98 offset:6144
  s_cbranch_vccnz SL29
  s_cmp_eq_u32 s25, 0
  s_cbranch_scc1 QB10
  buffer_load_dwordx4 v[152:155], v5, s[12:15], 0 offen offset:256
QB10:
SL29:
  v_mfma_f32_16x16x32_bf16 v[76:79], v[200:203], v[212:215], v[76:79]
  ds_read_b128 v[236:239], v98 offset:8192
  v_mfma_f32_16x16x32_bf16 v[80:83], v[200:203], v[216:219], v[80:83]
  s_waitcnt lgkmcnt(8)
  v_mfma_f32_16x16x32_bf16 v[84:87], v[204:207], v[208:211], v[84:87]
  ds_read_b128 v[240:243], v98 offset:10240
  s_cbranch_vccnz SL30
  s_cmp_eq_u32 s25, 0
  s_cbranch_scc1 QB11
  buffer_load_dwordx4 v[156:159], v5, s[12:15], 0 offen offset:320
QB11:
SL30:
  v_mfma_f32_16x16x32_bf16 v[88:91], v[204:207], v[212:215], v[88:91]
  v_mfma_f32_16x16x32_bf16 v[92:95], v[204:207], v[216:219], v[92:95]
  s_cbranch_vccz SL31
  v_lshrrev_b32 v133, 4, v1
  v_lshrrev_b32 v130, 3, v133
  s_mul_i32 s50, s26, 7
  s_add_i32 s50, s50, s30
  v_cmp_lt_u32 s[52:53], 6, v130
  v_add_u32 v130, s50, v130
  v_max_i32 v131, 0, v130
  v_add3_u32 v130, v130, v131, 6
  v_xor_b32 v130, s58, v130
  v_add_u32 v130, s59, v130
  v_mul_u32_u24 v130, 384, v130
  v_and_b32 v131, 7, v133
  v_xor_b32 v131, v131, v129
  v_lshl_add_u32 v130, v131, 4, v130
  v_mov_b32 v131, 0x80000000
  v_cndmask_b32 v134, v130, v131, s[52:53]
  v_xor_b32 v135, 64, v134
  s_lshl_b32 s46, s25, 2
  s_add_i32 s46, s46, s37
  s_lshl_b32 s84, s46, 1
  s_add_i32 s84, s84, 2
  s_xor_b32 s84, s84, s56
  s_add_i32 s84, s84, s57
  s_mul_i32 s84, s84, 86016
  s_lshl_b32 s85, s46, 1
  s_add_i32 s85, s85, 4
  s_xor_b32 s85, s85, s56
  s_add_i32 s85, s85, s57
  s_mul_i32 s85, s85, 86016
  s_lshl_b32 s86, s46, 1
  s_add_i32 s86, s86, 6
  s_xor_b32 s86, s86, s56
  s_add_i32 s86, s86, s57
  s_mul_i32 s86, s86, 86016
  s_lshl_b32 s87, s46, 1
  s_add_i32 s87, s87, 8
  s_xor_b32 s87, s87, s56
  s_add_i32 s87, s87, s57
  s_mul_i32 s87, s87, 86016
  s_mul_i32 s101, s40, 6
  s_add_u32 s101, s101, 73728
  v_bfe_u32 v130, v128, 1, 3
  v_xor_b32 v130, v130, v129
  v_lshlrev_b32 v131, 7, v128
  v_lshl_add_u32 v131, v130, 4, v131
  v_lshrrev_b32 v130, 3, v128
  v_lshl_add_u32 v130, v130, 11, v131
  v_add_u32 v23, s101, v130
SL31:
  s_cbranch_vccz SL32
  s_waitcnt vmcnt(0) lgkmcnt(0)
  s_branch SM32
SL32:
  s_cmp_lg_u32 s25, 0
  s_cbranch_scc1 MK_c2
  s_waitcnt vmcnt(6)
MK_c2:
  s_waitcnt vmcnt(12) lgkmcnt(0)
SM32:
  s_barrier
  v_add_u32 v97, 49152, v97
  v_add_u32 v98, 49152, v98
  v_add_u32 v99, 49152, v99
  v_add_u32 v100, 49152, v100
  v_mfma_f32_16x16x32_bf16 v[24:27], v[220:223], v[244:247], v[24:27]
  ds_read_b128 v[208:211], v99 offset:0
  v_mfma_f32_16x16x32_bf16 v[28:31], v[220:223], v[248:251], v[28:31]
  ds_read_b128 v[212:215], v99 offset:2048
  v_mfma_f32_16x16x32_bf16 v[32:35], v[220:223], v[252:255], v[32:35]
  v_mfma_f32_16x16x32_bf16 v[36:39], v[224:227], v[244:247], v[36:39]
  ds_read_b128 v[216:219], v99 offset:4096
  v_mfma_f32_16x16x32_bf16 v[40:43], v[224:227], v[248:251], v[40:43]
  ds_read_b128 v[184:187], v97 offset:0
  v_mfma_f32_16x16x32_bf16 v[44:47], v[224:227], v[252:255], v[44:47]
  v_mfma_f32_16x16x32_bf16 v[48:51], v[228:231], v[244:247], v[48:51]
  ds_read_b128 v[188:191], v97 offset:2048
  v_mfma_f32_16x16x32_bf16 v[52:55], v[228:231], v[248:251], v[52:55]
  ds_read_b128 v[192:195], v97 offset:4096
  v_mfma_f32_16x16x32_bf16 v[56:59], v[228:231], v[252:255], v[56:59]
  v_mfma_f32_16x16x32_bf16 v[60:63], v[232:235], v[244:247], v[60:63]
  ds_read_b128 v[196:199], v97 offset:6144
  v_mfma_f32_16x16x32_bf16 v[64:67], v[232:235], v[248:251], v[64:67]
  ds_read_b128 v[200:203], v97 offset:8192
  v_mfma_f32_16x16x32_bf16 v[68:71], v[232:235], v[252:255], v[68:71]
  v_mfma_f32_16x16x32_bf16 v[72:75], v[236:239], v[244:247], v[72:75]
  ds_read_b128 v[204:207], v97 offset:10240
  v_mfma_f32_16x16x32_bf16 v[76:79], v[236:239], v[248:251], v[76:79]
  v_mfma_f32_16x16x32_bf16 v[80:83], v[236:239], v[252:255], v[80:83]
  v_mfma_f32_16x16x32_bf16 v[84:87], v[240:243], v[244:247], v[84:87]
  v_mfma_f32_16x16x32_bf16 v[88:91], v[240:243], v[248:251], v[88:91]
  v_mfma_f32_16x16x32_bf16 v[92:95], v[240:243], v[252:255], v[92:95]
  s_cmp_eq_u32 s3, 0
  s_cbranch_scc1 MK_np2
  s_waitcnt lgkmcnt(0)
  ds_read_b64_tr_b16 v[104:105], v134 offset:0
  ds_read_b64_tr_b16 v[106:107], v134 offset:256
  ds_read_b64_tr_b16 v[108:109], v134 offset:2048
  ds_read_b64_tr_b16 v[110:111], v134 offset:2304
  ds_read_b64_tr_b16 v[112:113], v134 offset:4096
  ds_read_b64_tr_b16 v[114:115], v134 offset:4352
  ds_read_b64_tr_b16 v[116:117], v134 offset:6144
  ds_read_b64_tr_b16 v[118:119], v134 offset:6400
  ds_read_b64_tr_b16 v[120:121], v134 offset:8192
  ds_read_b64_tr_b16 v[122:123], v134 offset:8448
  ds_read_b64_tr_b16 v[124:125], v134 offset:10240
  ds_read_b64_tr_b16 v[126:127], v134 offset:10496
  s_setprio 3
  s_waitcnt lgkmcnt(0)
  v_mfma_f32_16x16x32_bf16 v[128:131], v[136:139], v[104:107], 0
  v_mfma_f32_16x16x32_bf16 v[128:131], v[140:143], v[108:111], v[128:131]
  v_mfma_f32_16x16x32_bf16 v[128:131], v[144:147], v[112:115], v[128:131]
  v_mfma_f32_16x16x32_bf16 v[128:131], v[148:151], v[116:119], v[128:131]
  v_mfma_f32_16x16x32_bf16 v[128:131], v[152:155], v[120:123], v[128:131]
  v_mfma_f32_16x16x32_bf16 v[128:131], v[156:159], v[124:127], v[128:131]
  s_lshl_b32 s100, s2, 10
  s_lshl_b32 s54, s26, 3
  s_add_u32 s100, s100, s54
  s_nop 5
  v_cvt_pk_bf16_f32 v132, v128, v129
  v_cvt_pk_bf16_f32 v133, v130, v131
  buffer_store_dwordx2 v[132:133], v1, s[20:23], s100 offen sc1
  s_setprio 0
MK_np2:
  ds_read_b128 v[244:247], v100 offset:0
  ds_read_b128 v[248:251], v100 offset:2048
  ds_read_b128 v[252:255], v100 offset:4096
  ds_read_b128 v[220:223], v98 offset:0
  ds_read_b128 v[224:227], v98 offset:2048
  s_waitcnt lgkmcnt(5)
  v_mfma_f32_16x16x32_bf16 v[24:27], v[184:187], v[208:211], v[24:27]
  ds_read_b128 v[228:231], v98 offset:4096
  s_cbranch_vccz SL33
  s_add_u32 m0, s101, 0
  s_nop 0
  buffer_load_dwordx4 v134, s[12:15], s86 offen offset:0 lds
SL33:
  v_mfma_f32_16x16x32_bf16 v[36:39], v[188:191], v[208:211], v[36:39]
  ds_read_b128 v[232:235], v98 offset:6144
  s_waitcnt lgkmcnt(2)
  v_mfma_f32_16x16x32_bf16 v[24:27], v[220:223], v[244:247], v[24:27]
  ds_read_b128 v[236:239], v98 offset:8192
  v_mfma_f32_16x16x32_bf16 v[36:39], v[224:227], v[244:247], v[36:39]
  ds_read_b128 v[240:243], v98 offset:10240
  v_mfma_f32_16x16x32_bf16 v[28:31], v[184:187], v[212:215], v[28:31]
  v_mfma_f32_16x16x32_bf16 v[40:43], v[188:191], v[212:215], v[40:43]
  v_mfma_f32_16x16x32_bf16 v[28:31], v[220:223], v[248:251], v[28:31]
  s_cbranch_vccz SL34
  s_add_u32 m0, s101, 896
  s_nop 0
  buffer_load_dwordx4 v134, s[12:15], s86 offen offset:128 lds
SL34:
  v_mfma_f32_16x16x32_bf16 v[40:43], v[224:227], v[248:251], v[40:43]
  s_waitcnt lgkmcnt(0)
  v_mfma_f32_16x16x32_bf16 v[32:35], v[184:187], v[216:219], v[32:35]
  v_cvt_pk_bf16_f32 v104, v24, v25
  v_cvt_pk_bf16_f32 v105, v26, v27
  v_mfma_f32_16x16x32_bf16 v[44:47], v[188:191], v[216:219], v[44:47]
  v_cvt_pk_bf16_f32 v106, v36, v37
  v_cvt_pk_bf16_f32 v107, v38, v39
  v_mfma_f32_16x16x32_bf16 v[32:35], v[220:223], v[252:255], v[32:35]
  ds_write_b128 v101, v[104:107] offset:14336
  v_mfma_f32_16x16x32_bf16 v[44:47], v[224:227], v[252:255], v[44:47]
  v_mfma_f32_16x16x32_bf16 v[48:51], v[192:195], v[208:211], v[48:51]
  v_cvt_pk_bf16_f32 v108, v28, v29
  v_cvt_pk_bf16_f32 v109, v30, v31
  s_cbranch_vccz SL35
  s_add_u32 m0, s101, 1792
  s_nop 0
  buffer_load_dwordx4 v134, s[12:15], s86 offen offset:256 lds
SL35:
  v_mfma_f32_16x16x32_bf16 v[60:63], v[196:199], v[208:211], v[60:63]
  v_cvt_pk_bf16_f32 v110, v40, v41
  v_cvt_pk_bf16_f32 v111, v42, v43
  v_mfma_f32_16x16x32_bf16 v[48:51], v[228:231], v[244:247], v[48:51]
  ds_write_b128 v101, v[108:111] offset:8192
  v_mfma_f32_16x16x32_bf16 v[60:63], v[232:235], v[244:247], v[60:63]
  v_mfma_f32_16x16x32_bf16 v[52:55], v[192:195], v[212:215], v[52:55]
  v_cvt_pk_bf16_f32 v112, v32, v33
  v_cvt_pk_bf16_f32 v113, v34, v35
  v_mfma_f32_16x16x32_bf16 v[64:67], v[196:199], v[212:215], v[64:67]
  v_cvt_pk_bf16_f32 v114, v44, v45
  v_cvt_pk_bf16_f32 v115, v46, v47
  v_mfma_f32_16x16x32_bf16 v[52:55], v[228:231], v[248:251], v[52:55]
  ds_write_b128 v101, v[112:115] offset:2048
  s_cbranch_vccz SL36
  s_add_u32 m0, s101, 3072
  s_nop 0
  buffer_load_dwordx4 v135, s[12:15], s87 offen offset:0 lds
SL36:
  v_mfma_f32_16x16x32_bf16 v[64:67], v[232:235], v[248:251], v[64:67]
  v_mfma_f32_16x16x32_bf16 v[56:59], v[192:195], v[216:219], v[56:59]
  v_cvt_pk_bf16_f32 v116, v48, v49
  v_cvt_pk_bf16_f32 v117, v50, v51
  v_mfma_f32_16x16x32_bf16 v[68:71], v[196:199], v[216:219], v[68:71]
  v_cvt_pk_bf16_f32 v118, v60, v61
  v_cvt_pk_bf16_f32 v119, v62, v63
  v_mfma_f32_16x16x32_bf16 v[56:59], v[228:231], v[252:255], v[56:59]
  ds_write_b128 v101, v[116:119] offset:13312
  v_mfma_f32_16x16x32_bf16 v[68:71], v[232:235], v[252:255], v[68:71]
  v_mfma_f32_16x16x32_bf16 v[72:75], v[200:203], v[208:211], v[72:75]
  v_cvt_pk_bf16_f32 v120, v52, v53
  v_cvt_pk_bf16_f32 v121, v54, v55
  s_cbranch_vccz SL37
  s_add_u32 m0, s101, 3968
  s_nop 0
  buffer_load_dwordx4 v135, s[12:15], s87 offen offset:128 lds
SL37:
  v_mfma_f32_16x16x32_bf16 v[84:87], v[204:207], v[208:211], v[84:87]
  v_cvt_pk_bf16_f32 v122, v64, v65
  v_cvt_pk_bf16_f32 v123, v66, v67
  v_mfma_f32_16x16x32_bf16 v[72:75], v[236:239], v[244:247], v[72:75]
  ds_write_b128 v101, v[120:123] offset:7168
  v_mfma_f32_16x16x32_bf16 v[84:87], v[240:243], v[244:247], v[84:87]
  v_mfma_f32_16x16x32_bf16 v[76:79], v[200:203], v[212:215], v[76:79]
  v_cvt_pk_bf16_f32 v124, v56, v57
  v_cvt_pk_bf16_f32 v125, v58, v59
  v_mfma_f32_16x16x32_bf16 v[88:91], v[204:207], v[212:215], v[88:91]
  v_cvt_pk_bf16_f32 v126, v68, v69
  v_cvt_pk_bf16_f32 v127, v70, v71
  v_mfma_f32_16x16x32_bf16 v[76:79], v[236:239], v[248:251], v[76:79]
  ds_write_b128 v101, v[124:127] offset:1024
  s_cbranch_vccz SL38
  s_add_u32 m0, s101, 4864
  s_nop 0
  buffer_load_dwordx4 v135, s[12:15], s87 offen offset:256 lds
SL38:
  v_mfma_f32_16x16x32_bf16 v[88:91], v[240:243], v[248:251], v[88:91]
  v_mfma_f32_16x16x32_bf16 v[80:83], v[200:203], v[216:219], v[80:83]
  v_cvt_pk_bf16_f32 v104, v72, v73
  v_cvt_pk_bf16_f32 v105, v74, v75
  v_mfma_f32_16x16x32_bf16 v[92:95], v[204:207], v[216:219], v[92:95]
  v_cvt_pk_bf16_f32 v106, v84, v85
  v_cvt_pk_bf16_f32 v107, v86, v87
  v_mfma_f32_16x16x32_bf16 v[80:83], v[236:239], v[252:255], v[80:83]
  ds_write_b128 v101, v[104:107] offset:12288
  v_mfma_f32_16x16x32_bf16 v[92:95], v[240:243], v[252:255], v[92:95]
  v_cvt_pk_bf16_f32 v108, v76, v77
  v_cvt_pk_bf16_f32 v109, v78, v79
  v_cvt_pk_bf16_f32 v110, v88, v89
  v_cvt_pk_bf16_f32 v111, v90, v91
  ds_write_b128 v101, v[108:111] offset:6144
  s_nop 3
  v_cvt_pk_bf16_f32 v112, v80, v81
  v_cvt_pk_bf16_f32 v113, v82, v83
  v_cvt_pk_bf16_f32 v114, v92, v93
  v_cvt_pk_bf16_f32 v115, v94, v95
  ds_write_b128 v101, v[112:115] offset:0
  s_waitcnt lgkmcnt(0)
  s_barrier
  s_cmp_eq_u32 s25, 0
  s_cbranch_scc1 MK_single
  ds_read_b128 v[216:219], v2 offset:35840
  ds_read_b128 v[220:223], v2 offset:34816
  ds_read_b128 v[224:227], v2 offset:33792
  ds_read_b128 v[228:231], v2 offset:32768
  ds_read_b128 v[232:235], v2 offset:31744
  ds_read_b128 v[236:239], v2 offset:30720
  ds_read_b128 v[240:243], v2 offset:29696
  ds_read_b128 v[244:247], v2 offset:28672
  ds_read_b128 v[248:251], v2 offset:27648
  ds_read_b128 v[252:255], v2 offset:26624
  s_cbranch_vccz SL39
  s_add_u32 m0, s101, 24576
  s_nop 0
  buffer_load_dwordx4 v134, s[12:15], s84 offen offset:0 lds
  s_add_u32 m0, s101, 25472
  s_nop 0
  buffer_load_dwordx4 v134, s[12:15], s84 offen offset:128 lds
  s_add_u32 m0, s101, 26368
  s_nop 0
  buffer_load_dwordx4 v134, s[12:15], s84 offen offset:256 lds
  s_add_u32 m0, s101, 27648
  s_nop 0
  buffer_load_dwordx4 v135, s[12:15], s85 offen offset:0 lds
  s_add_u32 m0, s101, 28544
  s_nop 0
  buffer_load_dwordx4 v135, s[12:15], s85 offen offset:128 lds
  s_add_u32 m0, s101, 29440
  s_nop 0
  buffer_load_dwordx4 v135, s[12:15], s85 offen offset:256 lds
  s_mul_i32 s100, s32, 9
  s_add_i32 s100, s100, s31
  s_add_u32 m0, s38, 138240
  s_nop 0
  buffer_load_dwordx4 v13, s[12:15], s100 offen lds
  s_add_u32 m0, s38, 139264
  s_nop 0
  buffer_load_dwordx4 v14, s[12:15], s100 offen lds
  s_add_u32 m0, s38, 140288
  s_nop 0
  buffer_load_dwordx4 v3, s[12:15], s100 offen lds
  s_add_u32 m0, s39, 138240
  s_nop 0
  buffer_load_dwordx4 v4, s[12:15], s100 offen lds
  s_mul_i32 s100, s32, 8
  s_add_i32 s100, s100, s31
  s_add_u32 m0, s38, 122880
  s_nop 0
  buffer_load_dwordx4 v13, s[12:15], s100 offen lds
  s_add_u32 m0, s38, 123904
  s_nop 0
  buffer_load_dwordx4 v14, s[12:15], s100 offen lds
  s_add_u32 m0, s38, 124928
  s_nop 0
  buffer_load_dwordx4 v3, s[12:15], s100 offen lds
  s_add_u32 m0, s39, 122880
  s_nop 0
  buffer_load_dwordx4 v4, s[12:15], s100 offen lds
  s_waitcnt vmcnt(8) lgkmcnt(0)
  v_xor_b32 v130, 64, v23
  ds_read_b128 v[136:139], v23 offset:24576
  ds_read_b128 v[140:143], v130 offset:24576
  ds_read_b128 v[144:147], v23 offset:25600
  ds_read_b128 v[148:151], v130 offset:25600
  ds_read_b128 v[152:155], v23 offset:26624
  ds_read_b128 v[156:159], v130 offset:26624
  ds_read_b128 v[160:163], v23 offset:0
  ds_read_b128 v[164:167], v130 offset:0
  ds_read_b128 v[168:171], v23 offset:1024
  ds_read_b128 v[172:175], v130 offset:1024
  ds_read_b128 v[176:179], v23 offset:2048
  ds_read_b128 v[180:183], v130 offset:2048
  s_waitcnt lgkmcnt(0)
  s_barrier
  s_branch SM39
SL39:
  s_waitcnt vmcnt(0)
  s_setprio 1
SM39:
BODY:
  s_waitcnt lgkmcnt(8)
  v_mfma_f32_16x16x32_bf16 v[184:187], v[216:219], v[136:139], 0
  v_mov_b32 v64, 0xff800000
  v_add_u32 v65, 0, v19
  v_mfma_f32_16x16x32_bf16 v[184:187], v[220:223], v[140:143], v[184:187]
  v_add_u32 v66, 1, v19
  s_waitcnt lgkmcnt(6)
  v_mfma_f32_16x16x32_bf16 v[184:187], v[224:227], v[144:147], v[184:187]
  v_add_u32 v67, 2, v19
  v_add_u32 v68, 3, v19
  v_mfma_f32_16x16x32_bf16 v[192:195], v[216:219], v[160:163], 0
  ds_read_b128 v[216:219], v2 offset:25600
  v_cmp_gt_u32 s[48:49], 7, v65
  v_mfma_f32_16x16x32_bf16 v[192:195], v[220:223], v[164:167], v[192:195]
  ds_read_b128 v[220:223], v2 offset:24576
  v_cmp_gt_u32 s[50:51], 7, v66
  v_mfma_f32_16x16x32_bf16 v[192:195], v[224:227], v[168:171], v[192:195]
  ds_read_b128 v[224:227], v2 offset:23552
  v_cmp_gt_u32 s[52:53], 7, v67
  v_mfma_f32_16x16x32_bf16 v[192:195], v[228:231], v[172:175], v[192:195]
  v_cmp_gt_u32 s[54:55], 7, v68
  s_waitcnt lgkmcnt(7)
  v_mfma_f32_16x16x32_bf16 v[192:195], v[232:235], v[176:179], v[192:195]
  s_add_i32 s46, s34, 8
  v_sub_u32 v69, s46, v22
  v_mfma_f32_16x16x32_bf16 v[192:195], v[236:239], v[180:183], v[192:195]
  s_add_i32 s46, s34, 1
  v_sub_u32 v70, s46, v22
  v_mfma_f32_16x16x32_bf16 v[184:187], v[228:231], v[148:151], v[184:187]
  ds_read_b128 v[228:231], v2 offset:22528
  s_add_i32 s46, s34, 6
  v_mfma_f32_16x16x32_bf16 v[184:187], v[232:235], v[152:155], v[184:187]
  ds_read_b128 v[232:235], v2 offset:21504
  v_sub_u32 v71, s46, v21
  v_mfma_f32_16x16x32_bf16 v[184:187], v[236:239], v[156:159], v[184:187]
  ds_read_b128 v[236:239], v2 offset:20480
  s_waitcnt lgkmcnt(8)
  v_mfma_f32_16x16x32_bf16 v[188:191], v[240:243], v[136:139], 0
  s_add_i32 s46, s34, 0
  v_sub_u32 v72, s46, v21
  v_mfma_f32_16x16x32_bf16 v[188:191], v[244:247], v[140:143], v[188:191]
  v_sub_u32 v73, s35, v21
  s_waitcnt lgkmcnt(6)
  v_mfma_f32_16x16x32_bf16 v[188:191], v[248:251], v[144:147], v[188:191]
  v_cndmask_b32 v32, v64, 0, s[48:49]
  v_cndmask_b32 v33, v64, 0, s[50:51]
  v_mfma_f32_16x16x32_bf16 v[196:199], v[240:243], v[160:163], 0
  ds_read_b128 v[240:243], v2 offset:19456
  v_cndmask_b32 v34, v64, 0, s[52:53]
  v_mfma_f32_16x16x32_bf16 v[196:199], v[244:247], v[164:167], v[196:199]
  ds_read_b128 v[244:247], v2 offset:18432
  v_cndmask_b32 v35, v64, 0, s[54:55]
  v_mfma_f32_16x16x32_bf16 v[196:199], v[248:251], v[168:171], v[196:199]
  ds_read_b128 v[248:251], v2 offset:17408
  v_cmp_gt_u32 s[46:47], 7, v69
  v_mfma_f32_16x16x32_bf16 v[196:199], v[252:255], v[172:175], v[196:199]
  v_cmp_gt_u32 s[48:49], 7, v70
  s_waitcnt lgkmcnt(7)
  v_mfma_f32_16x16x32_bf16 v[196:199], v[216:219], v[176:179], v[196:199]
  v_cmp_gt_u32 s[50:51], 7, v71
  v_cmp_gt_u32 s[52:53], 7, v72
  v_mfma_f32_16x16x32_bf16 v[196:199], v[220:223], v[180:183], v[196:199]
  v_cmp_gt_u32 s[54:55], 7, v73
  v_cndmask_b32 v84, v64, v32, s[46:47]
  v_mfma_f32_16x16x32_bf16 v[188:191], v[252:255], v[148:151], v[188:191]
  ds_read_b128 v[252:255], v2 offset:16384
  v_cndmask_b32 v85, v64, v33, s[46:47]
  v_mfma_f32_16x16x32_bf16 v[188:191], v[216:219], v[152:155], v[188:191]
  ds_read_b128 v[216:219], v2 offset:15360
  v_cndmask_b32 v86, v64, v34, s[46:47]
  v_mfma_f32_16x16x32_bf16 v[188:191], v[220:223], v[156:159], v[188:191]
  ds_read_b128 v[220:223], v2 offset:14336
  s_waitcnt lgkmcnt(8)
  v_mfma_f32_16x16x32_bf16 v[200:203], v[224:227], v[136:139], 0
  v_mul_f32 v192, s93, v192
  v_mul_f32 v193, s93, v193
  v_mfma_f32_16x16x32_bf16 v[200:203], v[228:231], v[140:143], v[200:203]
  v_mul_f32 v194, s93, v194
  s_waitcnt lgkmcnt(6)
  v_mfma_f32_16x16x32_bf16 v[200:203], v[232:235], v[144:147], v[200:203]
  v_mul_f32 v195, s93, v195
  v_cvt_pk_bf16_f32 v112, v192, v193
  v_mfma_f32_16x16x32_bf16 v[208:211], v[224:227], v[160:163], 0
  ds_read_b128 v[224:227], v2 offset:13312
  v_cvt_pk_bf16_f32 v113, v194, v195
  v_mfma_f32_16x16x32_bf16 v[208:211], v[228:231], v[164:167], v[208:211]
  ds_read_b128 v[228:231], v2 offset:12288
  v_mul_f32 v184, s93, v184
  v_mfma_f32_16x16x32_bf16 v[208:211], v[232:235], v[168:171], v[208:211]
  ds_read_b128 v[232:235], v2 offset:11264
  v_mul_f32 v185, s93, v185
  v_mfma_f32_16x16x32_bf16 v[208:211], v[236:239], v[172:175], v[208:211]
  v_mul_f32 v186, s93, v186
  s_waitcnt lgkmcnt(7)
  v_mfma_f32_16x16x32_bf16 v[208:211], v[240:243], v[176:179], v[208:211]
  v_mul_f32 v187, s93, v187
  v_cvt_pk_bf16_f32 v88, v184, v185
  v_mfma_f32_16x16x32_bf16 v[208:211], v[244:247], v[180:183], v[208:211]
  v_cvt_pk_bf16_f32 v89, v186, v187
  v_mul_f32 v196, s93, v196
  v_mfma_f32_16x16x32_bf16 v[200:203], v[236:239], v[148:151], v[200:203]
  ds_read_b128 v[236:239], v2 offset:10240
  v_mul_f32 v197, s93, v197
  v_mfma_f32_16x16x32_bf16 v[200:203], v[240:243], v[152:155], v[200:203]
  ds_read_b128 v[240:243], v2 offset:9216
  v_mul_f32 v198, s93, v198
  v_mfma_f32_16x16x32_bf16 v[200:203], v[244:247], v[156:159], v[200:203]
  ds_read_b128 v[244:247], v2 offset:8192
  s_waitcnt lgkmcnt(8)
  v_mfma_f32_16x16x32_bf16 v[204:207], v[248:251], v[136:139], 0
  v_mul_f32 v199, s93, v199
  v_cvt_pk_bf16_f32 v114, v196, v197
  v_mfma_f32_16x16x32_bf16 v[204:207], v[252:255], v[140:143], v[204:207]
  v_cvt_pk_bf16_f32 v115, v198, v199
  s_waitcnt lgkmcnt(6)
  v_mfma_f32_16x16x32_bf16 v[204:207], v[216:219], v[144:147], v[204:207]
  v_mul_f32 v188, s93, v188
  v_mul_f32 v189, s93, v189
  v_mfma_f32_16x16x32_bf16 v[212:215], v[248:251], v[160:163], 0
  ds_read_b128 v[248:251], v2 offset:7168
  v_mul_f32 v190, s93, v190
  v_mfma_f32_16x16x32_bf16 v[212:215], v[252:255], v[164:167], v[212:215]
  ds_read_b128 v[252:255], v2 offset:6144
  v_mul_f32 v191, s93, v191
  v_mfma_f32_16x16x32_bf16 v[212:215], v[216:219], v[168:171], v[212:215]
  ds_read_b128 v[216:219], v2 offset:5120
  v_cvt_pk_bf16_f32 v90, v188, v189
  v_mfma_f32_16x16x32_bf16 v[212:215], v[220:223], v[172:175], v[212:215]
  v_cvt_pk_bf16_f32 v91, v190, v191
  s_waitcnt lgkmcnt(7)
  v_mfma_f32_16x16x32_bf16 v[212:215], v[224:227], v[176:179], v[212:215]
  v_cndmask_b32 v87, v64, v35, s[46:47]
  v_cndmask_b32 v56, v64, v32, s[48:49]
  v_mfma_f32_16x16x32_bf16 v[212:215], v[228:231], v[180:183], v[212:215]
  v_cndmask_b32 v57, v64, v33, s[48:49]
  v_cndmask_b32 v58, v64, v34, s[48:49]
  v_mfma_f32_16x16x32_bf16 v[204:207], v[220:223], v[148:151], v[204:207]
  ds_read_b128 v[220:223], v2 offset:4096
  v_cndmask_b32 v59, v64, v35, s[48:49]
  v_mfma_f32_16x16x32_bf16 v[204:207], v[224:227], v[152:155], v[204:207]
  ds_read_b128 v[224:227], v2 offset:3072
  v_mul_f32 v208, s93, v208
  v_mfma_f32_16x16x32_bf16 v[204:207], v[228:231], v[156:159], v[204:207]
  ds_read_b128 v[228:231], v2 offset:2048
  s_waitcnt lgkmcnt(8)
  v_mfma_f32_16x16x32_bf16 v[184:187], v[232:235], v[136:139], 0
  v_mul_f32 v209, s93, v209
  v_mul_f32 v210, s93, v210
  v_mfma_f32_16x16x32_bf16 v[184:187], v[236:239], v[140:143], v[184:187]
  v_mul_f32 v211, s93, v211
  s_waitcnt lgkmcnt(6)
  v_mfma_f32_16x16x32_bf16 v[184:187], v[240:243], v[144:147], v[184:187]
  v_cvt_pk_bf16_f32 v116, v208, v209
  v_cvt_pk_bf16_f32 v117, v210, v211
  v_mfma_f32_16x16x32_bf16 v[192:195], v[232:235], v[160:163], 0
  ds_read_b128 v[232:235], v2 offset:1024
  v_mul_f32 v200, s93, v200
  v_mfma_f32_16x16x32_bf16 v[192:195], v[236:239], v[164:167], v[192:195]
  ds_read_b128 v[236:239], v2 offset:0
  v_mul_f32 v201, s93, v201
  v_mfma_f32_16x16x32_bf16 v[192:195], v[240:243], v[168:171], v[192:195]
  ds_read_b128 v[240:243], v1 offset:35840
  v_mul_f32 v202, s93, v202
  v_mfma_f32_16x16x32_bf16 v[192:195], v[244:247], v[172:175], v[192:195]
  v_mul_f32 v203, s93, v203
  s_waitcnt lgkmcnt(7)
  v_mfma_f32_16x16x32_bf16 v[192:195], v[248:251], v[176:179], v[192:195]
  v_cvt_pk_bf16_f32 v92, v200, v201
  v_cvt_pk_bf16_f32 v93, v202, v203
  v_mfma_f32_16x16x32_bf16 v[192:195], v[252:255], v[180:183], v[192:195]
  v_mul_f32 v212, s93, v212
  v_mul_f32 v213, s93, v213
  v_mfma_f32_16x16x32_bf16 v[184:187], v[244:247], v[148:151], v[184:187]
  ds_read_b128 v[244:247], v1 offset:34816
  v_mul_f32 v214, s93, v214
  v_mfma_f32_16x16x32_bf16 v[184:187], v[248:251], v[152:155], v[184:187]
  ds_read_b128 v[248:251], v1 offset:33792
  v_mul_f32 v215, s93, v215
  v_mfma_f32_16x16x32_bf16 v[184:187], v[252:255], v[156:159], v[184:187]
  ds_read_b128 v[252:255], v1 offset:32768
  s_waitcnt lgkmcnt(8)
  v_mfma_f32_16x16x32_bf16 v[188:191], v[216:219], v[136:139], 0
  v_cvt_pk_bf16_f32 v118, v212, v213
  v_cvt_pk_bf16_f32 v119, v214, v215
  s_cbranch_vccz SL40
  s_barrier
SL40:
  v_mfma_f32_16x16x32_bf16 v[188:191], v[220:223], v[140:143], v[188:191]
  v_mul_f32 v204, s93, v204
  s_waitcnt lgkmcnt(6)
  v_mfma_f32_16x16x32_bf16 v[188:191], v[224:227], v[144:147], v[188:191]
  v_mul_f32 v205, s93, v205
  v_mul_f32 v206, s93, v206
  v_mfma_f32_16x16x32_bf16 v[196:199], v[216:219], v[160:163], 0
  ds_read_b128 v[216:219], v1 offset:31744
  v_mul_f32 v207, s93, v207
  v_mfma_f32_16x16x32_bf16 v[196:199], v[220:223], v[164:167], v[196:199]
  ds_read_b128 v[220:223], v1 offset:30720
  v_cvt_pk_bf16_f32 v94, v204, v205
  v_mfma_f32_16x16x32_bf16 v[196:199], v[224:227], v[168:171], v[196:199]
  ds_read_b128 v[224:227], v1 offset:29696
  v_cvt_pk_bf16_f32 v95, v206, v207
  v_mfma_f32_16x16x32_bf16 v[196:199], v[228:231], v[172:175], v[196:199]
  v_cndmask_b32 v52, v64, v32, s[50:51]
  s_waitcnt lgkmcnt(7)
  v_mfma_f32_16x16x32_bf16 v[196:199], v[232:235], v[176:179], v[196:199]
  v_cndmask_b32 v53, v64, v33, s[50:51]
  v_cndmask_b32 v54, v64, v34, s[50:51]
  v_mfma_f32_16x16x32_bf16 v[196:199], v[236:239], v[180:183], v[196:199]
  v_cndmask_b32 v55, v64, v35, s[50:51]
  v_mul_f32 v192, s93, v192
  v_mfma_f32_16x16x32_bf16 v[188:191], v[228:231], v[148:151], v[188:191]
  ds_read_b128 v[228:231], v1 offset:28672
  v_mul_f32 v193, s93, v193
  v_mfma_f32_16x16x32_bf16 v[188:191], v[232:235], v[152:155], v[188:191]
  ds_read_b128 v[232:235], v1 offset:27648
  v_mul_f32 v194, s93, v194
  v_mfma_f32_16x16x32_bf16 v[188:191], v[236:239], v[156:159], v[188:191]
  ds_read_b128 v[236:239], v1 offset:26624
  s_waitcnt lgkmcnt(8)
  v_mfma_f32_16x16x32_bf16 v[200:203], v[240:243], v[136:139], 0
  v_mul_f32 v195, s93, v195
  v_cvt_pk_bf16_f32 v120, v192, v193
  v_mfma_f32_16x16x32_bf16 v[200:203], v[244:247], v[140:143], v[200:203]
  v_cvt_pk_bf16_f32 v121, v194, v195
  s_waitcnt lgkmcnt(6)
  v_mfma_f32_16x16x32_bf16 v[200:203], v[248:251], v[144:147], v[200:203]
  v_mul_f32 v184, s93, v184
  v_mul_f32 v185, s93, v185
  v_mfma_f32_16x16x32_bf16 v[208:211], v[240:243], v[160:163], 0
  ds_read_b128 v[240:243], v1 offset:25600
  v_mul_f32 v186, s93, v186
  v_mfma_f32_16x16x32_bf16 v[208:211], v[244:247], v[164:167], v[208:211]
  ds_read_b128 v[244:247], v1 offset:24576
  v_mul_f32 v187, s93, v187
  v_mfma_f32_16x16x32_bf16 v[208:211], v[248:251], v[168:171], v[208:211]
  ds_read_b128 v[248:251], v1 offset:23552
  v_cvt_pk_bf16_f32 v96, v184, v185
  v_mfma_f32_16x16x32_bf16 v[208:211], v[252:255], v[172:175], v[208:211]
  v_cvt_pk_bf16_f32 v97, v186, v187
  s_waitcnt lgkmcnt(7)
  v_mfma_f32_16x16x32_bf16 v[208:211], v[216:219], v[176:179], v[208:211]
  v_mul_f32 v196, s93, v196
  v_mul_f32 v197, s93, v197
  v_mfma_f32_16x16x32_bf16 v[208:211], v[220:223], v[180:183], v[208:211]
  v_mul_f32 v198, s93, v198
  v_mul_f32 v199, s93, v199
  v_mfma_f32_16x16x32_bf16 v[200:203], v[252:255], v[148:151], v[200:203]
  ds_read_b128 v[252:255], v1 offset:22528
  v_cvt_pk_bf16_f32 v122, v196, v197
  v_mfma_f32_16x16x32_bf16 v[200:203], v[216:219], v[152:155], v[200:203]
  ds_read_b128 v[216:219], v1 offset:21504
  v_cvt_pk_bf16_f32 v123, v198, v199
  v_mfma_f32_16x16x32_bf16 v[200:203], v[220:223], v[156:159], v[200:203]
  ds_read_b128 v[220:223], v1 offset:20480
  s_waitcnt lgkmcnt(8)
  v_mfma_f32_16x16x32_bf16 v[204:207], v[224:227], v[136:139], 0
  v_mul_f32 v188, s93, v188
  v_mul_f32 v189, s93, v189
  v_mfma_f32_16x16x32_bf16 v[204:207], v[228:231], v[140:143], v[204:207]
  v_mul_f32 v190, s93, v190
  s_waitcnt lgkmcnt(6)
  v_mfma_f32_16x16x32_bf16 v[204:207], v[232:235], v[144:147], v[204:207]
  v_mul_f32 v191, s93, v191
  v_cvt_pk_bf16_f32 v98, v188, v189
  v_mfma_f32_16x16x32_bf16 v[212:215], v[224:227], v[160:163], 0
  ds_read_b128 v[224:227], v1 offset:19456
  v_cvt_pk_bf16_f32 v99, v190, v191
  v_mfma_f32_16x16x32_bf16 v[212:215], v[228:231], v[164:167], v[212:215]
  ds_read_b128 v[228:231], v1 offset:18432
  v_cndmask_b32 v28, v64, v32, s[52:53]
  v_mfma_f32_16x16x32_bf16 v[212:215], v[232:235], v[168:171], v[212:215]
  ds_read_b128 v[232:235], v1 offset:17408
  v_cndmask_b32 v29, v64, v33, s[52:53]
  v_mfma_f32_16x16x32_bf16 v[212:215], v[236:239], v[172:175], v[212:215]
  v_cndmask_b32 v30, v64, v34, s[52:53]
  s_waitcnt lgkmcnt(7)
  v_mfma_f32_16x16x32_bf16 v[212:215], v[240:243], v[176:179], v[212:215]
  v_cndmask_b32 v31, v64, v35, s[52:53]
  v_cndmask_b32 v24, v64, v32, s[54:55]
  v_mfma_f32_16x16x32_bf16 v[212:215], v[244:247], v[180:183], v[212:215]
  v_mul_f32 v208, s93, v208
  v_mul_f32 v209, s93, v209
  v_mfma_f32_16x16x32_bf16 v[204:207], v[236:239], v[148:151], v[204:207]
  ds_read_b128 v[236:239], v1 offset:16384
  v_mul_f32 v210, s93, v210
  v_mfma_f32_16x16x32_bf16 v[204:207], v[240:243], v[152:155], v[204:207]
  ds_read_b128 v[240:243], v1 offset:15360
  v_mul_f32 v211, s93, v211
  v_mfma_f32_16x16x32_bf16 v[204:207], v[244:247], v[156:159], v[204:207]
  ds_read_b128 v[244:247], v1 offset:14336
  s_waitcnt lgkmcnt(8)
  v_mfma_f32_16x16x32_bf16 v[184:187], v[248:251], v[136:139], 0
  v_cvt_pk_bf16_f32 v124, v208, v209
  v_cvt_pk_bf16_f32 v125, v210, v211
  v_mfma_f32_16x16x32_bf16 v[184:187], v[252:255], v[140:143], v[184:187]
  v_mul_f32 v200, s93, v200
  s_waitcnt lgkmcnt(6)
  v_mfma_f32_16x16x32_bf16 v[184:187], v[216:219], v[144:147], v[184:187]
  v_mul_f32 v201, s93, v201
  v_mul_f32 v202, s93, v202
  v_mfma_f32_16x16x32_bf16 v[192:195], v[248:251], v[160:163], 0
  ds_read_b128 v[248:251], v1 offset:13312
  v_mul_f32 v203, s93, v203
  v_mfma_f32_16x16x32_bf16 v[192:195], v[252:255], v[164:167], v[192:195]
  ds_read_b128 v[252:255], v1 offset:12288
  v_cvt_pk_bf16_f32 v100, v200, v201
  v_mfma_f32_16x16x32_bf16 v[192:195], v[216:219], v[168:171], v[192:195]
  ds_read_b128 v[216:219], v1 offset:11264
  v_cvt_pk_bf16_f32 v101, v202, v203
  v_mfma_f32_16x16x32_bf16 v[192:195], v[220:223], v[172:175], v[192:195]
  v_mul_f32 v212, s93, v212
  s_waitcnt lgkmcnt(7)
  v_mfma_f32_16x16x32_bf16 v[192:195], v[224:227], v[176:179], v[192:195]
  v_mul_f32 v213, s93, v213
  v_mul_f32 v214, s93, v214
  v_mfma_f32_16x16x32_bf16 v[192:195], v[228:231], v[180:183], v[192:195]
  v_mul_f32 v215, s93, v215
  v_cvt_pk_bf16_f32 v126, v212, v213
  v_mfma_f32_16x16x32_bf16 v[184:187], v[220:223], v[148:151], v[184:187]
  ds_read_b128 v[220:223], v1 offset:10240
  v_cvt_pk_bf16_f32 v127, v214, v215
  v_mfma_f32_16x16x32_bf16 v[184:187], v[224:227], v[152:155], v[184:187]
  ds_read_b128 v[224:227], v1 offset:9216
  v_mul_f32 v204, s93, v204
  v_mfma_f32_16x16x32_bf16 v[184:187], v[228:231], v[156:159], v[184:187]
  ds_read_b128 v[228:231], v1 offset:8192
  s_waitcnt lgkmcnt(8)
  v_mfma_f32_16x16x32_bf16 v[188:191], v[232:235], v[136:139], 0
  v_mul_f32 v205, s93, v205
  v_mul_f32 v206, s93, v206
  v_mfma_f32_16x16x32_bf16 v[188:191], v[236:239], v[140:143], v[188:191]
  v_mul_f32 v207, s93, v207
  s_waitcnt lgkmcnt(6)
  v_mfma_f32_16x16x32_bf16 v[188:191], v[240:243], v[144:147], v[188:191]
  v_cvt_pk_bf16_f32 v102, v204, v205
  v_cvt_pk_bf16_f32 v103, v206, v207
  v_mfma_f32_16x16x32_bf16 v[196:199], v[232:235], v[160:163], 0
  ds_read_b128 v[232:235], v1 offset:7168
  v_cndmask_b32 v25, v64, v33, s[54:55]
  v_mfma_f32_16x16x32_bf16 v[196:199], v[236:239], v[164:167], v[196:199]
  ds_read_b128 v[236:239], v1 offset:6144
  v_cndmask_b32 v26, v64, v34, s[54:55]
  v_mfma_f32_16x16x32_bf16 v[196:199], v[240:243], v[168:171], v[196:199]
  ds_read_b128 v[240:243], v1 offset:5120
  v_cndmask_b32 v27, v64, v35, s[54:55]
  v_mfma_f32_16x16x32_bf16 v[196:199], v[244:247], v[172:175], v[196:199]
  v_mul_f32 v192, s93, v192
  s_cbranch_vccnz SL41
  s_barrier
SL41:
  s_waitcnt lgkmcnt(7)
  v_mfma_f32_16x16x32_bf16 v[196:199], v[248:251], v[176:179], v[196:199]
  v_mul_f32 v193, s93, v193
  v_mul_f32 v194, s93, v194
  v_mfma_f32_16x16x32_bf16 v[196:199], v[252:255], v[180:183], v[196:199]
  v_mul_f32 v195, s93, v195
  v_cvt_pk_bf16_f32 v128, v192, v193
  v_mfma_f32_16x16x32_bf16 v[188:191], v[244:247], v[148:151], v[188:191]
  ds_read_b128 v[244:247], v1 offset:4096
  v_cvt_pk_bf16_f32 v129, v194, v195
  v_mfma_f32_16x16x32_bf16 v[188:191], v[248:251], v[152:155], v[188:191]
  ds_read_b128 v[248:251], v1 offset:3072
  v_mul_f32 v184, s93, v184
  v_mfma_f32_16x16x32_bf16 v[188:191], v[252:255], v[156:159], v[188:191]
  ds_read_b128 v[252:255], v1 offset:2048
  s_waitcnt lgkmcnt(8)
  v_mfma_f32_16x16x32_bf16 v[200:203], v[216:219], v[136:139], 0
  v_mul_f32 v185, s93, v185
  v_mul_f32 v186, s93, v186
  s_cbranch_vccz SL42
  s_waitcnt vmcnt(0)
  s_barrier
SL42:
  v_mfma_f32_16x16x32_bf16 v[200:203], v[220:223], v[140:143], v[200:203]
  v_mul_f32 v187, s93, v187
  s_waitcnt lgkmcnt(6)
  v_mfma_f32_16x16x32_bf16 v[200:203], v[224:227], v[144:147], v[200:203]
  v_cvt_pk_bf16_f32 v104, v184, v185
  v_cvt_pk_bf16_f32 v105, v186, v187
  v_mfma_f32_16x16x32_bf16 v[208:211], v[216:219], v[160:163], 0
  ds_read_b128 v[216:219], v1 offset:1024
  v_mul_f32 v196, s93, v196
  v_mfma_f32_16x16x32_bf16 v[208:211], v[220:223], v[164:167], v[208:211]
  ds_read_b128 v[220:223], v1 offset:0
  v_mul_f32 v197, s93, v197
  v_mfma_f32_16x16x32_bf16 v[208:211], v[224:227], v[168:171], v[208:211]
  v_mul_f32 v198, s93, v198
  v_mul_f32 v199, s93, v199
  v_mfma_f32_16x16x32_bf16 v[208:211], v[228:231], v[172:175], v[208:211]
  v_cvt_pk_bf16_f32 v130, v196, v197
  s_waitcnt lgkmcnt(6)
  v_mfma_f32_16x16x32_bf16 v[208:211], v[232:235], v[176:179], v[208:211]
  v_cvt_pk_bf16_f32 v131, v198, v199
  v_mul_f32 v188, s93, v188
  v_mfma_f32_16x16x32_bf16 v[208:211], v[236:239], v[180:183], v[208:211]
  v_mul_f32 v189, s93, v189
  v_mul_f32 v190, s93, v190
  v_mfma_f32_16x16x32_bf16 v[200:203], v[228:231], v[148:151], v[200:203]
  v_mul_f32 v191, s93, v191
  v_cvt_pk_bf16_f32 v106, v188, v189
  v_mfma_f32_16x16x32_bf16 v[200:203], v[232:235], v[152:155], v[200:203]
  v_cvt_pk_bf16_f32 v107, v190, v191
  v_mfma_f32_16x16x32_bf16 v[200:203], v[236:239], v[156:159], v[200:203]
  s_waitcnt lgkmcnt(5)
  v_mfma_f32_16x16x32_bf16 v[204:207], v[240:243], v[136:139], 0
  v_mul_f32 v208, s93, v208
  s_waitcnt lgkmcnt(4)
  v_mfma_f32_16x16x32_bf16 v[204:207], v[244:247], v[140:143], v[204:207]
  v_mul_f32 v209, s93, v209
  s_waitcnt lgkmcnt(3)
  v_mfma_f32_16x16x32_bf16 v[204:207], v[248:251], v[144:147], v[204:207]
  v_mul_f32 v210, s93, v210
  v_mul_f32 v211, s93, v211
  v_mfma_f32_16x16x32_bf16 v[212:215], v[240:243], v[160:163], 0
  v_cvt_pk_bf16_f32 v132, v208, v209
  v_cvt_pk_bf16_f32 v133, v210, v211
  v_mfma_f32_16x16x32_bf16 v[212:215], v[244:247], v[164:167], v[212:215]
  v_mul_f32 v200, s93, v200
  v_mul_f32 v201, s93, v201
  v_mfma_f32_16x16x32_bf16 v[212:215], v[248:251], v[168:171], v[212:215]
  v_mul_f32 v202, s93, v202
  s_waitcnt lgkmcnt(2)
  v_mfma_f32_16x16x32_bf16 v[212:215], v[252:255], v[172:175], v[212:215]
  v_mul_f32 v203, s93, v203
  s_waitcnt lgkmcnt(1)
  v_mfma_f32_16x16x32_bf16 v[212:215], v[216:219], v[176:179], v[212:215]
  v_cvt_pk_bf16_f32 v108, v200, v201
  s_waitcnt lgkmcnt(0)
  v_mfma_f32_16x16x32_bf16 v[212:215], v[220:223], v[180:183], v[212:215]
  v_cvt_pk_bf16_f32 v109, v202, v203
  v_mfma_f32_16x16x32_bf16 v[204:207], v[252:255], v[148:151], v[204:207]
  v_mfma_f32_16x16x32_bf16 v[204:207], v[216:219], v[152:155], v[204:207]
  v_mfma_f32_16x16x32_bf16 v[204:207], v[220:223], v[156:159], v[204:207]
  s_cbranch_vccnz SL43
  s_setprio 0
  s_mul_i32 s100, s32, 7
  s_add_i32 s100, s100, s31
  s_add_u32 m0, s38, 107520
  s_nop 0
  buffer_load_dwordx4 v13, s[12:15], s100 offen lds
  s_add_u32 m0, s38, 108544
  s_nop 0
  buffer_load_dwordx4 v14, s[12:15], s100 offen lds
  s_add_u32 m0, s38, 109568
  s_nop 0
  buffer_load_dwordx4 v3, s[12:15], s100 offen lds
  s_add_u32 m0, s39, 107520
  s_nop 0
  buffer_load_dwordx4 v4, s[12:15], s100 offen lds
  s_mul_i32 s100, s32, 6
  s_add_i32 s100, s100, s31
  s_add_u32 m0, s38, 92160
  s_nop 0
  buffer_load_dwordx4 v13, s[12:15], s100 offen lds
  s_add_u32 m0, s38, 93184
  s_nop 0
  buffer_load_dwordx4 v14, s[12:15], s100 offen lds
  s_add_u32 m0, s38, 94208
  s_nop 0
  buffer_load_dwordx4 v3, s[12:15], s100 offen lds
  s_add_u32 m0, s39, 92160
  s_nop 0
  buffer_load_dwordx4 v4, s[12:15], s100 offen lds
  s_mul_i32 s100, s32, 5
  s_add_i32 s100, s100, s31
  s_add_u32 m0, s38, 76800
  s_nop 0
  buffer_load_dwordx4 v13, s[12:15], s100 offen lds
  s_add_u32 m0, s38, 77824
  s_nop 0
  buffer_load_dwordx4 v14, s[12:15], s100 offen lds
  s_add_u32 m0, s38, 78848
  s_nop 0
  buffer_load_dwordx4 v3, s[12:15], s100 offen lds
  s_add_u32 m0, s39, 76800
  s_nop 0
  buffer_load_dwordx4 v4, s[12:15], s100 offen lds
  s_barrier
  s_mul_i32 s100, s32, 4
  s_add_i32 s100, s100, s31
  s_add_u32 m0, s38, 61440
  s_nop 0
  buffer_load_dwordx4 v13, s[12:15], s100 offen lds
  s_add_u32 m0, s38, 62464
  s_nop 0
  buffer_load_dwordx4 v14, s[12:15], s100 offen lds
  s_add_u32 m0, s38, 63488
  s_nop 0
  buffer_load_dwordx4 v3, s[12:15], s100 offen lds
  s_add_u32 m0, s39, 61440
  s_nop 0
  buffer_load_dwordx4 v4, s[12:15], s100 offen lds
  s_mul_i32 s100, s32, 3
  s_add_i32 s100, s100, s31
  s_add_u32 m0, s38, 46080
  s_nop 0
  buffer_load_dwordx4 v13, s[12:15], s100 offen lds
  s_add_u32 m0, s38, 47104
  s_nop 0
  buffer_load_dwordx4 v14, s[12:15], s100 offen lds
  s_add_u32 m0, s38, 48128
  s_nop 0
  buffer_load_dwordx4 v3, s[12:15], s100 offen lds
  s_add_u32 m0, s39, 46080
  s_nop 0
  buffer_load_dwordx4 v4, s[12:15], s100 offen lds
  s_mul_i32 s100, s32, 2
  s_add_i32 s100, s100, s31
  s_add_u32 m0, s38, 30720
  s_nop 0
  buffer_load_dwordx4 v13, s[12:15], s100 offen lds
  s_add_u32 m0, s38, 31744
  s_nop 0
  buffer_load_dwordx4 v14, s[12:15], s100 offen lds
  s_add_u32 m0, s38, 32768
  s_nop 0
  buffer_load_dwordx4 v3, s[12:15], s100 offen lds
  s_add_u32 m0, s39, 30720
  s_nop 0
  buffer_load_dwordx4 v4, s[12:15], s100 offen lds
  s_waitcnt vmcnt(12)
  s_barrier
  s_max_u32 s100, s33, 1
  s_mul_i32 s100, s100, s32
  s_add_i32 s100, s100, s31
  s_add_u32 m0, s38, 15360
  s_nop 0
  buffer_load_dwordx4 v13, s[12:15], s100 offen lds
  s_add_u32 m0, s38, 16384
  s_nop 0
  buffer_load_dwordx4 v14, s[12:15], s100 offen lds
  s_add_u32 m0, s38, 17408
  s_nop 0
  buffer_load_dwordx4 v3, s[12:15], s100 offen lds
  s_add_u32 m0, s39, 15360
  s_nop 0
  buffer_load_dwordx4 v4, s[12:15], s100 offen lds
  s_max_u32 s100, s33, 0
  s_mul_i32 s100, s100, s32
  s_add_i32 s100, s100, s31
  s_add_u32 m0, s38, 0
  s_nop 0
  buffer_load_dwordx4 v13, s[12:15], s100 offen lds
  s_add_u32 m0, s38, 1024
  s_nop 0
  buffer_load_dwordx4 v14, s[12:15], s100 offen lds
  s_add_u32 m0, s38, 2048
  s_nop 0
  buffer_load_dwordx4 v3, s[12:15], s100 offen lds
  s_add_u32 m0, s39, 0
  s_nop 0
  buffer_load_dwordx4 v4, s[12:15], s100 offen lds
  s_waitcnt vmcnt(8)
  s_barrier
SL43:
  ds_read_b128 v[224:227], v7 offset:61440
  ds_read_b128 v[228:231], v8 offset:61440
  ds_read_b128 v[232:235], v7 offset:61568
  ds_read_b128 v[236:239], v8 offset:61568
  ds_read_b128 v[240:243], v7 offset:61696
  ds_read_b128 v[244:247], v8 offset:61696
  ds_read_b128 v[248:251], v7 offset:53760
  ds_read_b128 v[252:255], v8 offset:53760
  ds_read_b128 v[216:219], v7 offset:53888
  ds_read_b128 v[220:223], v8 offset:53888
  s_waitcnt lgkmcnt(8)
  v_mfma_f32_16x16x32_bf16 v[84:87], v[224:227], v[112:115], v[84:87]
  ds_read_b128 v[224:227], v7 offset:54016
  v_mul_f32 v212, s93, v212
  v_mfma_f32_16x16x32_bf16 v[84:87], v[228:231], v[116:119], v[84:87]
  ds_read_b128 v[228:231], v8 offset:54016
  s_waitcnt lgkmcnt(8)
  v_mfma_f32_16x16x32_bf16 v[84:87], v[232:235], v[120:123], v[84:87]
  ds_read_b128 v[232:235], v7 offset:46080
  v_mul_f32 v213, s93, v213
  v_mfma_f32_16x16x32_bf16 v[84:87], v[236:239], v[124:127], v[84:87]
  ds_read_b128 v[236:239], v8 offset:46080
  s_waitcnt lgkmcnt(8)
  v_mfma_f32_16x16x32_bf16 v[84:87], v[240:243], v[128:131], v[84:87]
  ds_read_b128 v[240:243], v7 offset:46208
  v_mul_f32 v214, s93, v214
  v_mul_f32 v215, s93, v215
  v_cvt_pk_bf16_f32 v134, v212, v213
  v_cvt_pk_bf16_f32 v135, v214, v215
  s_nop 1
  v_mfma_f32_16x16x32_bf16 v[84:87], v[244:247], v[132:135], v[84:87]
  ds_read_b128 v[244:247], v8 offset:46208
  s_waitcnt lgkmcnt(8)
  v_mfma_f32_16x16x32_bf16 v[80:83], v[248:251], v[112:115], v[32:35]
  ds_read_b128 v[248:251], v7 offset:46336
  v_mul_f32 v204, s93, v204
  v_mfma_f32_16x16x32_bf16 v[80:83], v[252:255], v[116:119], v[80:83]
  ds_read_b128 v[252:255], v8 offset:46336
  s_waitcnt lgkmcnt(8)
  v_mfma_f32_16x16x32_bf16 v[80:83], v[216:219], v[120:123], v[80:83]
  v_exp_f32 v196, v84
  v_mfma_f32_16x16x32_bf16 v[80:83], v[220:223], v[124:127], v[80:83]
  ds_read_b128 v[216:219], v7 offset:38400
  s_waitcnt lgkmcnt(7)
  v_mfma_f32_16x16x32_bf16 v[80:83], v[224:227], v[128:131], v[80:83]
  v_exp_f32 v197, v85
  v_mfma_f32_16x16x32_bf16 v[80:83], v[228:231], v[132:135], v[80:83]
  ds_read_b128 v[220:223], v8 offset:38400
  s_cbranch_vccz SL44
  s_barrier
  s_branch SM44
SL44:
  s_waitcnt vmcnt(0)
  s_barrier
SM44:
  ds_read_b128 v[224:227], v7 offset:38528
  ds_read_b128 v[228:231], v8 offset:38528
  s_waitcnt lgkmcnt(8)
  v_mfma_f32_16x16x32_bf16 v[52:55], v[232:235], v[88:91], v[52:55]
  v_exp_f32 v198, v86
  v_mfma_f32_16x16x32_bf16 v[52:55], v[236:239], v[92:95], v[52:55]
  v_mul_f32 v205, s93, v205
  s_waitcnt lgkmcnt(6)
  v_mfma_f32_16x16x32_bf16 v[52:55], v[240:243], v[96:99], v[52:55]
  v_exp_f32 v199, v87
  v_mfma_f32_16x16x32_bf16 v[76:79], v[232:235], v[112:115], v[32:35]
  v_exp_f32 v200, v80
  v_mfma_f32_16x16x32_bf16 v[76:79], v[236:239], v[116:119], v[76:79]
  v_exp_f32 v201, v81
  v_mfma_f32_16x16x32_bf16 v[76:79], v[240:243], v[120:123], v[76:79]
  v_exp_f32 v202, v82
  v_mfma_f32_16x16x32_bf16 v[76:79], v[244:247], v[124:127], v[76:79]
  ds_read_b128 v[232:235], v7 offset:38656
  s_waitcnt lgkmcnt(5)
  v_mfma_f32_16x16x32_bf16 v[76:79], v[248:251], v[128:131], v[76:79]
  v_exp_f32 v203, v83
  v_mul_f32 v206, s93, v206
  v_mul_f32 v207, s93, v207
  v_cvt_pk_bf16_f32 v110, v204, v205
  v_cvt_pk_bf16_f32 v111, v206, v207
  v_mfma_f32_16x16x32_bf16 v[76:79], v[252:255], v[132:135], v[76:79]
  ds_read_b128 v[236:239], v8 offset:38656
  v_add_u32 v2, 102400, v1
  v_mfma_f32_16x16x32_bf16 v[52:55], v[244:247], v[100:103], v[52:55]
  ds_read_b128 v[240:243], v7 offset:30720
  v_mov_b32 v192, 0x3f803f80
  v_mfma_f32_16x16x32_bf16 v[52:55], v[248:251], v[104:107], v[52:55]
  ds_read_b128 v[244:247], v8 offset:30720
  v_mov_b32 v193, 0x3f803f80
  v_mfma_f32_16x16x32_bf16 v[52:55], v[252:255], v[108:111], v[52:55]
  ds_read_b128 v[248:251], v7 offset:30848
  s_waitcnt lgkmcnt(7)
  v_mfma_f32_16x16x32_bf16 v[48:51], v[216:219], v[88:91], v[32:35]
  v_exp_f32 v204, v76
  v_mfma_f32_16x16x32_bf16 v[48:51], v[220:223], v[92:95], v[48:51]
  ds_read_b128 v[252:255], v8 offset:30848
  v_mov_b32 v194, 0x3f803f80
  s_waitcnt lgkmcnt(6)
  v_mfma_f32_16x16x32_bf16 v[48:51], v[224:227], v[96:99], v[48:51]
  v_exp_f32 v205, v77
  v_mfma_f32_16x16x32_bf16 v[72:75], v[216:219], v[112:115], v[32:35]
  v_exp_f32 v206, v78
  v_mfma_f32_16x16x32_bf16 v[72:75], v[220:223], v[116:119], v[72:75]
  v_exp_f32 v207, v79
  v_mfma_f32_16x16x32_bf16 v[72:75], v[224:227], v[120:123], v[72:75]
  v_exp_f32 v208, v52
  v_mfma_f32_16x16x32_bf16 v[72:75], v[228:231], v[124:127], v[72:75]
  ds_read_b128 v[216:219], v7 offset:30976
  s_waitcnt lgkmcnt(5)
  v_mfma_f32_16x16x32_bf16 v[72:75], v[232:235], v[128:131], v[72:75]
  v_exp_f32 v209, v53
  v_mfma_f32_16x16x32_bf16 v[72:75], v[236:239], v[132:135], v[72:75]
  ds_read_b128 v[220:223], v8 offset:30976
  ds_read_b128 v[224:227], v7 offset:23040
  v_mfma_f32_16x16x32_bf16 v[48:51], v[228:231], v[100:103], v[48:51]
  v_exp_f32 v210, v54
  v_mfma_f32_16x16x32_bf16 v[48:51], v[232:235], v[104:107], v[48:51]
  v_exp_f32 v211, v55
  v_mfma_f32_16x16x32_bf16 v[48:51], v[236:239], v[108:111], v[48:51]
  ds_read_b128 v[228:231], v8 offset:23040
  s_waitcnt lgkmcnt(6)
  v_mfma_f32_16x16x32_bf16 v[44:47], v[240:243], v[88:91], v[32:35]
  v_exp_f32 v212, v72
  v_mfma_f32_16x16x32_bf16 v[44:47], v[244:247], v[92:95], v[44:47]
  ds_read_b128 v[232:235], v7 offset:23168
  v_mov_b32 v195, 0x3f803f80
  s_waitcnt lgkmcnt(5)
  v_mfma_f32_16x16x32_bf16 v[44:47], v[248:251], v[96:99], v[44:47]
  v_exp_f32 v213, v73
  v_mfma_f32_16x16x32_bf16 v[68:71], v[240:243], v[112:115], v[32:35]
  v_exp_f32 v214, v74
  v_mfma_f32_16x16x32_bf16 v[68:71], v[244:247], v[116:119], v[68:71]
  v_exp_f32 v215, v75
  v_mfma_f32_16x16x32_bf16 v[68:71], v[248:251], v[120:123], v[68:71]
  ds_read_b128 v[236:239], v8 offset:23168
  ds_read_b128 v[240:243], v7 offset:23296
  v_mfma_f32_16x16x32_bf16 v[68:71], v[252:255], v[124:127], v[68:71]
  ds_read_b128 v[244:247], v8 offset:23296
  s_waitcnt lgkmcnt(6)
  v_mfma_f32_16x16x32_bf16 v[68:71], v[216:219], v[128:131], v[68:71]
  ds_read_b128 v[248:251], v7 offset:15360
  v_cvt_pk_bf16_f32 v166, v196, v197
  v_mfma_f32_16x16x32_bf16 v[68:71], v[220:223], v[132:135], v[68:71]
  v_exp_f32 v196, v48
  v_mfma_f32_16x16x32_bf16 v[44:47], v[252:255], v[100:103], v[44:47]
  v_exp_f32 v197, v49
  v_mfma_f32_16x16x32_bf16 v[44:47], v[216:219], v[104:107], v[44:47]
  ds_read_b128 v[252:255], v8 offset:15360
  ds_read_b128 v[216:219], v7 offset:15488
  v_mfma_f32_16x16x32_bf16 v[44:47], v[220:223], v[108:111], v[44:47]
  ds_read_b128 v[220:223], v8 offset:15488
  s_waitcnt lgkmcnt(8)
  v_mfma_f32_16x16x32_bf16 v[40:43], v[224:227], v[88:91], v[32:35]
  v_cvt_pk_bf16_f32 v167, v198, v199
  v_cvt_pk_bf16_f32 v164, v200, v201
  v_mfma_f32_16x16x32_bf16 v[40:43], v[228:231], v[92:95], v[40:43]
  v_cvt_pk_bf16_f32 v165, v202, v203
  s_waitcnt lgkmcnt(6)
  v_mfma_f32_16x16x32_bf16 v[40:43], v[232:235], v[96:99], v[40:43]
  v_exp_f32 v198, v50
  v_mfma_f32_16x16x32_bf16 v[64:67], v[224:227], v[112:115], v[32:35]
  v_exp_f32 v199, v51
  v_mfma_f32_16x16x32_bf16 v[64:67], v[228:231], v[116:119], v[64:67]
  v_exp_f32 v200, v68
  v_mfma_f32_16x16x32_bf16 v[64:67], v[232:235], v[120:123], v[64:67]
  v_exp_f32 v201, v69
  v_mfma_f32_16x16x32_bf16 v[64:67], v[236:239], v[124:127], v[64:67]
  ds_read_b128 v[224:227], v7 offset:15616
  s_waitcnt lgkmcnt(5)
  v_mfma_f32_16x16x32_bf16 v[64:67], v[240:243], v[128:131], v[64:67]
  v_exp_f32 v202, v70
  v_mfma_f32_16x16x32_bf16 v[64:67], v[244:247], v[132:135], v[64:67]
  ds_read_b128 v[228:231], v8 offset:15616
  ds_read_b128 v[232:235], v7 offset:7680
  v_mfma_f32_16x16x32_bf16 v[40:43], v[236:239], v[100:103], v[40:43]
  v_exp_f32 v203, v71
  v_mfma_f32_16x16x32_bf16 v[40:43], v[240:243], v[104:107], v[40:43]
  ds_read_b128 v[236:239], v8 offset:7680
  ds_read_b128 v[240:243], v7 offset:7808
  v_mfma_f32_16x16x32_bf16 v[40:43], v[244:247], v[108:111], v[40:43]
  ds_read_b128 v[244:247], v8 offset:7808
  s_cbranch_vccz SL45
  s_barrier
SL45:
  s_cbranch_vccnz SL46
  s_barrier
SL46:
  s_waitcnt lgkmcnt(8)
  v_mfma_f32_16x16x32_bf16 v[36:39], v[248:251], v[88:91], v[32:35]
  v_cvt_pk_bf16_f32 v162, v204, v205
  v_cvt_pk_bf16_f32 v163, v206, v207
  v_mfma_f32_16x16x32_bf16 v[36:39], v[252:255], v[92:95], v[36:39]
  v_cvt_pk_bf16_f32 v150, v208, v209
  s_waitcnt lgkmcnt(6)
  v_mfma_f32_16x16x32_bf16 v[36:39], v[216:219], v[96:99], v[36:39]
  v_exp_f32 v204, v44
  v_mfma_f32_16x16x32_bf16 v[60:63], v[248:251], v[112:115], v[32:35]
  v_exp_f32 v205, v45
  v_mfma_f32_16x16x32_bf16 v[60:63], v[252:255], v[116:119], v[60:63]
  v_exp_f32 v206, v46
  v_mfma_f32_16x16x32_bf16 v[60:63], v[216:219], v[120:123], v[60:63]
  v_exp_f32 v207, v47
  v_mfma_f32_16x16x32_bf16 v[60:63], v[220:223], v[124:127], v[60:63]
  ds_read_b128 v[248:251], v7 offset:7936
  v_cvt_pk_bf16_f32 v151, v210, v211
  s_waitcnt lgkmcnt(5)
  v_mfma_f32_16x16x32_bf16 v[60:63], v[224:227], v[128:131], v[60:63]
  v_exp_f32 v208, v64
  v_mfma_f32_16x16x32_bf16 v[60:63], v[228:231], v[132:135], v[60:63]
  ds_read_b128 v[252:255], v8 offset:7936
  ds_read_b128 v[216:219], v7 offset:0
  v_cvt_pk_bf16_f32 v160, v212, v213
  v_mfma_f32_16x16x32_bf16 v[36:39], v[220:223], v[100:103], v[36:39]
  v_exp_f32 v209, v65
  v_mfma_f32_16x16x32_bf16 v[36:39], v[224:227], v[104:107], v[36:39]
  v_exp_f32 v210, v66
  v_mfma_f32_16x16x32_bf16 v[36:39], v[228:231], v[108:111], v[36:39]
  ds_read_b128 v[220:223], v8 offset:0
  s_waitcnt lgkmcnt(6)
  v_mfma_f32_16x16x32_bf16 v[32:35], v[232:235], v[88:91], v[32:35]
  v_exp_f32 v211, v67
  v_mfma_f32_16x16x32_bf16 v[32:35], v[236:239], v[92:95], v[32:35]
  ds_read_b128 v[224:227], v7 offset:128
  v_cvt_pk_bf16_f32 v161, v214, v215
  s_waitcnt lgkmcnt(5)
  v_mfma_f32_16x16x32_bf16 v[32:35], v[240:243], v[96:99], v[32:35]
  v_exp_f32 v212, v40
  v_mfma_f32_16x16x32_bf16 v[56:59], v[232:235], v[112:115], v[56:59]
  v_exp_f32 v213, v41
  v_mfma_f32_16x16x32_bf16 v[56:59], v[236:239], v[116:119], v[56:59]
  v_exp_f32 v214, v42
  v_mfma_f32_16x16x32_bf16 v[56:59], v[240:243], v[120:123], v[56:59]
  v_exp_f32 v215, v43
  v_mfma_f32_16x16x32_bf16 v[56:59], v[244:247], v[124:127], v[56:59]
  ds_read_b128 v[228:231], v8 offset:128
  v_cvt_pk_bf16_f32 v148, v196, v197
  s_waitcnt lgkmcnt(5)
  v_mfma_f32_16x16x32_bf16 v[56:59], v[248:251], v[128:131], v[56:59]
  ds_read_b128 v[232:235], v7 offset:256
  v_cvt_pk_bf16_f32 v149, v198, v199
  s_waitcnt lgkmcnt(5)
  v_mfma_f32_16x16x32_bf16 v[56:59], v[252:255], v[132:135], v[56:59]
  ds_read_b128 v[236:239], v8 offset:256
  ds_read_b128 v[240:243], v20 offset:0
  v_cvt_pk_bf16_f32 v158, v200, v201
  v_mfma_f32_16x16x32_bf16 v[32:35], v[244:247], v[100:103], v[32:35]
  v_exp_f32 v196, v60
  v_mfma_f32_16x16x32_bf16 v[32:35], v[248:251], v[104:107], v[32:35]
  v_exp_f32 v197, v61
  v_mfma_f32_16x16x32_bf16 v[32:35], v[252:255], v[108:111], v[32:35]
  ds_read_b128 v[244:247], v0 offset:0
  s_cbranch_vccnz SL47
  s_barrier
SL47:
  s_waitcnt lgkmcnt(6)
  v_mfma_f32_16x16x32_bf16 v[28:31], v[216:219], v[88:91], v[28:31]
  v_exp_f32 v198, v62
  v_mfma_f32_16x16x32_bf16 v[28:31], v[220:223], v[92:95], v[28:31]
  ds_read_b128 v[248:251], v20 offset:128
  v_cvt_pk_bf16_f32 v159, v202, v203
  s_waitcnt lgkmcnt(5)
  v_mfma_f32_16x16x32_bf16 v[28:31], v[224:227], v[96:99], v[28:31]
  v_exp_f32 v199, v63
  v_mfma_f32_16x16x32_bf16 v[28:31], v[228:231], v[100:103], v[28:31]
  ds_read_b128 v[252:255], v0 offset:128
  v_cvt_pk_bf16_f32 v146, v204, v205
  s_waitcnt lgkmcnt(5)
  v_mfma_f32_16x16x32_bf16 v[28:31], v[232:235], v[104:107], v[28:31]
  ds_read_b128 v[216:219], v20 offset:256
  v_cvt_pk_bf16_f32 v147, v206, v207
  s_waitcnt lgkmcnt(5)
  v_mfma_f32_16x16x32_bf16 v[28:31], v[236:239], v[108:111], v[28:31]
  ds_read_b128 v[220:223], v0 offset:256
  v_cvt_pk_bf16_f32 v156, v208, v209
  s_waitcnt lgkmcnt(5)
  v_mfma_f32_16x16x32_bf16 v[24:27], v[240:243], v[88:91], v[24:27]
  ds_read_b64_tr_b16 v[224:225], v9 offset:53760
  ds_read_b64_tr_b16 v[226:227], v9 offset:61440
  v_cvt_pk_bf16_f32 v157, v210, v211
  s_waitcnt lgkmcnt(5)
  v_mfma_f32_16x16x32_bf16 v[24:27], v[244:247], v[92:95], v[24:27]
  ds_read_b64_tr_b16 v[228:229], v10 offset:53760
  ds_read_b64_tr_b16 v[230:231], v10 offset:61440
  v_cvt_pk_bf16_f32 v144, v212, v213
  v_mfma_f32_16x16x32_bf16 v[24:27], v[248:251], v[96:99], v[24:27]
  ds_read_b64_tr_b16 v[232:233], v11 offset:53760
  ds_read_b64_tr_b16 v[234:235], v11 offset:61440
  v_cvt_pk_bf16_f32 v145, v214, v215
  v_cvt_pk_bf16_f32 v154, v196, v197
  v_cvt_pk_bf16_f32 v155, v198, v199
  v_exp_f32 v200, v36
  v_exp_f32 v201, v37
  v_exp_f32 v202, v38
  v_exp_f32 v203, v39
  v_cvt_pk_bf16_f32 v142, v200, v201
  v_cvt_pk_bf16_f32 v143, v202, v203
  v_exp_f32 v204, v56
  v_exp_f32 v205, v57
  v_exp_f32 v206, v58
  v_exp_f32 v207, v59
  v_cvt_pk_bf16_f32 v152, v204, v205
  v_cvt_pk_bf16_f32 v153, v206, v207
  v_mfma_f32_16x16x32_bf16 v[188:191], v[192:195], v[164:167], 0
  v_exp_f32 v208, v32
  v_mfma_f32_16x16x32_bf16 v[188:191], v[192:195], v[160:163], v[188:191]
  v_exp_f32 v209, v33
  v_mfma_f32_16x16x32_bf16 v[188:191], v[192:195], v[156:159], v[188:191]
  v_exp_f32 v210, v34
  v_mfma_f32_16x16x32_bf16 v[188:191], v[192:195], v[152:155], v[188:191]
  ds_read_b64_tr_b16 v[236:237], v12 offset:53760
  ds_read_b64_tr_b16 v[238:239], v12 offset:61440
  s_waitcnt lgkmcnt(9)
  v_mfma_f32_16x16x32_bf16 v[24:27], v[252:255], v[100:103], v[24:27]
  v_exp_f32 v211, v35
  v_mfma_f32_16x16x32_bf16 v[24:27], v[216:219], v[104:107], v[24:27]
  ds_read_b64_tr_b16 v[240:241], v9 offset:53888
  ds_read_b64_tr_b16 v[242:243], v9 offset:61568
  s_waitcnt lgkmcnt(8)
  v_mfma_f32_16x16x32_bf16 v[24:27], v[220:223], v[108:111], v[24:27]
  ds_read_b64_tr_b16 v[244:245], v10 offset:53888
  ds_read_b64_tr_b16 v[246:247], v10 offset:61568
  v_subrev_u32 v23, 813694976, v188
  s_mov_b32 s52, 503316480
  v_cmp_gt_u32 s[48:49], s52, v23
  s_or_b64 s[48:49], s[48:49], s[44:45]
  s_cmp_eq_u64 s[48:49], -1
  s_cbranch_scc0 FB1
FBR1:
  s_cbranch_vccnz SL48
  s_barrier
SL48:
  v_mfma_f32_16x16x32_bf16 v[88:91], v[224:227], v[164:167], 0
  ds_read_b64_tr_b16 v[248:249], v11 offset:53888
  ds_read_b64_tr_b16 v[250:251], v11 offset:61568
  v_cvt_pk_bf16_f32 v140, v208, v209
  s_waitcnt lgkmcnt(8)
  v_mfma_f32_16x16x32_bf16 v[92:95], v[228:231], v[164:167], 0
  ds_read_b64_tr_b16 v[252:253], v12 offset:53888
  ds_read_b64_tr_b16 v[254:255], v12 offset:61568
  v_cvt_pk_bf16_f32 v141, v210, v211
  v_mfma_f32_16x16x32_bf16 v[96:99], v[232:235], v[164:167], 0
  ds_read_b64_tr_b16 v[216:217], v9 offset:54016
  ds_read_b64_tr_b16 v[218:219], v9 offset:61696
  v_exp_f32 v212, v28
  s_waitcnt lgkmcnt(8)
  v_mfma_f32_16x16x32_bf16 v[100:103], v[236:239], v[164:167], 0
  ds_read_b64_tr_b16 v[220:221], v10 offset:54016
  ds_read_b64_tr_b16 v[222:223], v10 offset:61696
  v_exp_f32 v213, v29
  v_mfma_f32_16x16x32_bf16 v[104:107], v[240:243], v[164:167], 0
  ds_read_b64_tr_b16 v[224:225], v11 offset:54016
  ds_read_b64_tr_b16 v[226:227], v11 offset:61696
  s_waitcnt lgkmcnt(8)
  v_mfma_f32_16x16x32_bf16 v[108:111], v[244:247], v[164:167], 0
  ds_read_b64_tr_b16 v[228:229], v12 offset:54016
  ds_read_b64_tr_b16 v[230:231], v12 offset:61696
  v_mfma_f32_16x16x32_bf16 v[112:115], v[248:251], v[164:167], 0
  ds_read_b64_tr_b16 v[232:233], v9 offset:38400
  ds_read_b64_tr_b16 v[234:235], v9 offset:46080
  s_waitcnt lgkmcnt(8)
  v_mfma_f32_16x16x32_bf16 v[116:119], v[252:255], v[164:167], 0
  ds_read_b64_tr_b16 v[236:237], v10 offset:38400
  ds_read_b64_tr_b16 v[238:239], v10 offset:46080
  v_mfma_f32_16x16x32_bf16 v[120:123], v[216:219], v[164:167], 0
  ds_read_b64_tr_b16 v[240:241], v11 offset:38400
  ds_read_b64_tr_b16 v[242:243], v11 offset:46080
  s_waitcnt lgkmcnt(8)
  v_mfma_f32_16x16x32_bf16 v[124:127], v[220:223], v[164:167], 0
  ds_read_b64_tr_b16 v[244:245], v12 offset:38400
  ds_read_b64_tr_b16 v[246:247], v12 offset:46080
  v_mfma_f32_16x16x32_bf16 v[128:131], v[224:227], v[164:167], 0
  ds_read_b64_tr_b16 v[248:249], v9 offset:38528
  ds_read_b64_tr_b16 v[250:251], v9 offset:46208
  s_waitcnt lgkmcnt(8)
  v_mfma_f32_16x16x32_bf16 v[132:135], v[228:231], v[164:167], 0
  ds_read_b64_tr_b16 v[252:253], v10 offset:38528
  ds_read_b64_tr_b16 v[254:255], v10 offset:46208
  v_exp_f32 v214, v30
  v_exp_f32 v215, v31
  v_cvt_pk_bf16_f32 v138, v212, v213
  v_cvt_pk_bf16_f32 v139, v214, v215
  v_exp_f32 v196, v24
  v_exp_f32 v197, v25
  v_exp_f32 v198, v26
  v_exp_f32 v199, v27
  v_cvt_pk_bf16_f32 v136, v196, v197
  v_cvt_pk_bf16_f32 v137, v198, v199
  v_mfma_f32_16x16x32_bf16 v[184:187], v[192:195], v[148:151], 0
  ds_read_b64_tr_b16 v[216:217], v11 offset:38528
  ds_read_b64_tr_b16 v[218:219], v11 offset:46208
  v_mfma_f32_16x16x32_bf16 v[184:187], v[192:195], v[144:147], v[184:187]
  ds_read_b64_tr_b16 v[220:221], v12 offset:38528
  ds_read_b64_tr_b16 v[222:223], v12 offset:46208
  v_mfma_f32_16x16x32_bf16 v[184:187], v[192:195], v[140:143], v[184:187]
  v_mfma_f32_16x16x32_bf16 v[184:187], v[192:195], v[136:139], v[184:187]
  s_nop 7
  v_subrev_u32 v23, 813694976, v184
  s_mov_b32 s52, 503316480
  v_cmp_gt_u32 s[48:49], s52, v23
  s_or_b64 s[48:49], s[48:49], s[42:43]
  s_cmp_eq_u64 s[48:49], -1
  s_cbranch_scc0 FB0
FBR0:
  v_mfma_f32_16x16x32_bf16 v[88:91], v[232:235], v[160:163], v[88:91]
  v_rcp_f32 v23, v188
  v_mfma_f32_16x16x32_bf16 v[24:27], v[232:235], v[148:151], 0
  s_waitcnt lgkmcnt(10)
  v_mfma_f32_16x16x32_bf16 v[92:95], v[236:239], v[160:163], v[92:95]
  v_rcp_f32 v22, v184
  v_mfma_f32_16x16x32_bf16 v[28:31], v[236:239], v[148:151], 0
  ds_read_b64_tr_b16 v[224:225], v9 offset:38656
  ds_read_b64_tr_b16 v[226:227], v9 offset:46336
  v_mfma_f32_16x16x32_bf16 v[96:99], v[240:243], v[160:163], v[96:99]
  ds_read_b64_tr_b16 v[228:229], v10 offset:38656
  ds_read_b64_tr_b16 v[230:231], v10 offset:46336
  v_mfma_f32_16x16x32_bf16 v[32:35], v[240:243], v[148:151], 0
  s_waitcnt lgkmcnt(10)
  v_mfma_f32_16x16x32_bf16 v[100:103], v[244:247], v[160:163], v[100:103]
  ds_read_b64_tr_b16 v[232:233], v11 offset:38656
  ds_read_b64_tr_b16 v[234:235], v11 offset:46336
  v_mfma_f32_16x16x32_bf16 v[36:39], v[244:247], v[148:151], 0
  ds_read_b64_tr_b16 v[236:237], v12 offset:38656
  ds_read_b64_tr_b16 v[238:239], v12 offset:46336
  v_mfma_f32_16x16x32_bf16 v[104:107], v[248:251], v[160:163], v[104:107]
  v_mfma_f32_16x16x32_bf16 v[40:43], v[248:251], v[148:151], 0
  s_waitcnt lgkmcnt(10)
  v_mfma_f32_16x16x32_bf16 v[108:111], v[252:255], v[160:163], v[108:111]
  ds_read_b64_tr_b16 v[240:241], v9 offset:23040
  ds_read_b64_tr_b16 v[242:243], v9 offset:30720
  v_mfma_f32_16x16x32_bf16 v[44:47], v[252:255], v[148:151], 0
  ds_read_b64_tr_b16 v[244:245], v10 offset:23040
  ds_read_b64_tr_b16 v[246:247], v10 offset:30720
  v_mfma_f32_16x16x32_bf16 v[112:115], v[216:219], v[160:163], v[112:115]
  v_mfma_f32_16x16x32_bf16 v[48:51], v[216:219], v[148:151], 0
  s_waitcnt lgkmcnt(10)
  v_mfma_f32_16x16x32_bf16 v[116:119], v[220:223], v[160:163], v[116:119]
  ds_read_b64_tr_b16 v[248:249], v11 offset:23040
  ds_read_b64_tr_b16 v[250:251], v11 offset:30720
  v_mfma_f32_16x16x32_bf16 v[52:55], v[220:223], v[148:151], 0
  ds_read_b64_tr_b16 v[252:253], v12 offset:23040
  ds_read_b64_tr_b16 v[254:255], v12 offset:30720
  v_mfma_f32_16x16x32_bf16 v[120:123], v[224:227], v[160:163], v[120:123]
  v_mfma_f32_16x16x32_bf16 v[56:59], v[224:227], v[148:151], 0
  s_waitcnt lgkmcnt(10)
  v_mfma_f32_16x16x32_bf16 v[124:127], v[228:231], v[160:163], v[124:127]
  ds_read_b64_tr_b16 v[216:217], v9 offset:23168
  ds_read_b64_tr_b16 v[218:219], v9 offset:30848
  v_mfma_f32_16x16x32_bf16 v[60:63], v[228:231], v[148:151], 0
  ds_read_b64_tr_b16 v[220:221], v10 offset:23168
  ds_read_b64_tr_b16 v[222:223], v10 offset:30848
  v_mfma_f32_16x16x32_bf16 v[128:131], v[232:235], v[160:163], v[128:131]
  v_mfma_f32_16x16x32_bf16 v[64:67], v[232:235], v[148:151], 0
  s_waitcnt lgkmcnt(10)
  v_mfma_f32_16x16x32_bf16 v[132:135], v[236:239], v[160:163], v[132:135]
  ds_read_b64_tr_b16 v[224:225], v11 offset:23168
  ds_read_b64_tr_b16 v[226:227], v11 offset:30848
  v_mfma_f32_16x16x32_bf16 v[68:71], v[236:239], v[148:151], 0
  ds_read_b64_tr_b16 v[228:229], v12 offset:23168
  ds_read_b64_tr_b16 v[230:231], v12 offset:30848
  s_cbranch_vccz SL49
  s_barrier
SL49:
  v_mfma_f32_16x16x32_bf16 v[88:91], v[240:243], v[156:159], v[88:91]
  v_mfma_f32_16x16x32_bf16 v[24:27], v[240:243], v[144:147], v[24:27]
  s_waitcnt lgkmcnt(10)
  v_mfma_f32_16x16x32_bf16 v[92:95], v[244:247], v[156:159], v[92:95]
  ds_read_b64_tr_b16 v[232:233], v9 offset:23296
  ds_read_b64_tr_b16 v[234:235], v9 offset:30976
  v_mfma_f32_16x16x32_bf16 v[28:31], v[244:247], v[144:147], v[28:31]
  ds_read_b64_tr_b16 v[236:237], v10 offset:23296
  ds_read_b64_tr_b16 v[238:239], v10 offset:30976
  v_mfma_f32_16x16x32_bf16 v[96:99], v[248:251], v[156:159], v[96:99]
  v_mfma_f32_16x16x32_bf16 v[32:35], v[248:251], v[144:147], v[32:35]
  s_waitcnt lgkmcnt(10)
  v_mfma_f32_16x16x32_bf16 v[100:103], v[252:255], v[156:159], v[100:103]
  ds_read_b64_tr_b16 v[240:241], v11 offset:23296
  ds_read_b64_tr_b16 v[242:243], v11 offset:30976
  v_mfma_f32_16x16x32_bf16 v[36:39], v[252:255], v[144:147], v[36:39]
  ds_read_b64_tr_b16 v[244:245], v12 offset:23296
  ds_read_b64_tr_b16 v[246:247], v12 offset:30976
  v_mfma_f32_16x16x32_bf16 v[104:107], v[216:219], v[156:159], v[104:107]
  v_mfma_f32_16x16x32_bf16 v[40:43], v[216:219], v[144:147], v[40:43]
  s_waitcnt lgkmcnt(10)
  v_mfma_f32_16x16x32_bf16 v[108:111], v[220:223], v[156:159], v[108:111]
  ds_read_b64_tr_b16 v[248:249], v9 offset:7680
  ds_read_b64_tr_b16 v[250:251], v9 offset:15360
  v_mfma_f32_16x16x32_bf16 v[44:47], v[220:223], v[144:147], v[44:47]
  ds_read_b64_tr_b16 v[252:253], v10 offset:7680
  ds_read_b64_tr_b16 v[254:255], v10 offset:15360
  v_mfma_f32_16x16x32_bf16 v[112:115], v[224:227], v[156:159], v[112:115]
  v_mfma_f32_16x16x32_bf16 v[48:51], v[224:227], v[144:147], v[48:51]
  s_waitcnt lgkmcnt(10)
  v_mfma_f32_16x16x32_bf16 v[116:119], v[228:231], v[156:159], v[116:119]
  ds_read_b64_tr_b16 v[216:217], v11 offset:7680
  ds_read_b64_tr_b16 v[218:219], v11 offset:15360
  v_mfma_f32_16x16x32_bf16 v[52:55], v[228:231], v[144:147], v[52:55]
  ds_read_b64_tr_b16 v[220:221], v12 offset:7680
  ds_read_b64_tr_b16 v[222:223], v12 offset:15360
  v_mfma_f32_16x16x32_bf16 v[120:123], v[232:235], v[156:159], v[120:123]
  v_mfma_f32_16x16x32_bf16 v[56:59], v[232:235], v[144:147], v[56:59]
  s_waitcnt lgkmcnt(10)
  v_mfma_f32_16x16x32_bf16 v[124:127], v[236:239], v[156:159], v[124:127]
  ds_read_b64_tr_b16 v[224:225], v9 offset:7808
  ds_read_b64_tr_b16 v[226:227], v9 offset:15488
  v_mfma_f32_16x16x32_bf16 v[60:63], v[236:239], v[144:147], v[60:63]
  ds_read_b64_tr_b16 v[228:229], v10 offset:7808
  ds_read_b64_tr_b16 v[230:231], v10 offset:15488
  v_mfma_f32_16x16x32_bf16 v[128:131], v[240:243], v[156:159], v[128:131]
  v_mfma_f32_16x16x32_bf16 v[64:67], v[240:243], v[144:147], v[64:67]
  s_waitcnt lgkmcnt(10)
  v_mfma_f32_16x16x32_bf16 v[132:135], v[244:247], v[156:159], v[132:135]
  ds_read_b64_tr_b16 v[232:233], v11 offset:7808
  ds_read_b64_tr_b16 v[234:235], v11 offset:15488
  v_mfma_f32_16x16x32_bf16 v[68:71], v[244:247], v[144:147], v[68:71]
  ds_read_b64_tr_b16 v[236:237], v12 offset:7808
  ds_read_b64_tr_b16 v[238:239], v12 offset:15488
  v_mfma_f32_16x16x32_bf16 v[88:91], v[248:251], v[152:155], v[88:91]
  v_mfma_f32_16x16x32_bf16 v[24:27], v[248:251], v[140:143], v[24:27]
  s_waitcnt lgkmcnt(10)
  v_mfma_f32_16x16x32_bf16 v[92:95], v[252:255], v[152:155], v[92:95]
  ds_read_b64_tr_b16 v[240:241], v9 offset:7936
  ds_read_b64_tr_b16 v[242:243], v9 offset:15616
  v_mfma_f32_16x16x32_bf16 v[28:31], v[252:255], v[140:143], v[28:31]
  ds_read_b64_tr_b16 v[244:245], v10 offset:7936
  ds_read_b64_tr_b16 v[246:247], v10 offset:15616
  v_mfma_f32_16x16x32_bf16 v[96:99], v[216:219], v[152:155], v[96:99]
  v_cvt_pk_bf16_f32 v156, v88, v89
  v_cvt_pk_bf16_f32 v157, v90, v91
  v_mfma_f32_16x16x32_bf16 v[32:35], v[216:219], v[140:143], v[32:35]
  v_cvt_pk_bf16_f32 v158, v92, v93
  s_waitcnt lgkmcnt(10)
  v_mfma_f32_16x16x32_bf16 v[100:103], v[220:223], v[152:155], v[100:103]
  ds_read_b64_tr_b16 v[248:249], v11 offset:7936
  ds_read_b64_tr_b16 v[250:251], v11 offset:15616
  v_mfma_f32_16x16x32_bf16 v[36:39], v[220:223], v[140:143], v[36:39]
  ds_read_b64_tr_b16 v[252:253], v12 offset:7936
  ds_read_b64_tr_b16 v[254:255], v12 offset:15616
  v_mfma_f32_16x16x32_bf16 v[104:107], v[224:227], v[152:155], v[104:107]
  v_cvt_pk_bf16_f32 v159, v94, v95
  v_cvt_pk_bf16_f32 v160, v96, v97
  v_mfma_f32_16x16x32_bf16 v[40:43], v[224:227], v[140:143], v[40:43]
  v_cvt_pk_bf16_f32 v161, v98, v99
  s_waitcnt lgkmcnt(10)
  v_mfma_f32_16x16x32_bf16 v[108:111], v[228:231], v[152:155], v[108:111]
  ds_read_b64_tr_b16 v[216:217], v15 offset:0
  ds_read_b64_tr_b16 v[218:219], v9 offset:0
  v_mfma_f32_16x16x32_bf16 v[44:47], v[228:231], v[140:143], v[44:47]
  ds_read_b64_tr_b16 v[220:221], v16 offset:0
  ds_read_b64_tr_b16 v[222:223], v10 offset:0
  v_mfma_f32_16x16x32_bf16 v[112:115], v[232:235], v[152:155], v[112:115]
  v_cvt_pk_bf16_f32 v162, v100, v101
  v_cvt_pk_bf16_f32 v163, v102, v103
  v_mfma_f32_16x16x32_bf16 v[48:51], v[232:235], v[140:143], v[48:51]
  v_cvt_pk_bf16_f32 v164, v104, v105
  s_waitcnt lgkmcnt(10)
  v_mfma_f32_16x16x32_bf16 v[116:119], v[236:239], v[152:155], v[116:119]
  ds_read_b64_tr_b16 v[224:225], v17 offset:0
  ds_read_b64_tr_b16 v[226:227], v11 offset:0
  v_mfma_f32_16x16x32_bf16 v[52:55], v[236:239], v[140:143], v[52:55]
  ds_read_b64_tr_b16 v[228:229], v18 offset:0
  ds_read_b64_tr_b16 v[230:231], v12 offset:0
  v_mfma_f32_16x16x32_bf16 v[120:123], v[240:243], v[152:155], v[120:123]
  v_cvt_pk_bf16_f32 v165, v106, v107
  v_cvt_pk_bf16_f32 v166, v108, v109
  v_mfma_f32_16x16x32_bf16 v[56:59], v[240:243], v[140:143], v[56:59]
  v_cvt_pk_bf16_f32 v167, v110, v111
  s_waitcnt lgkmcnt(10)
  v_mfma_f32_16x16x32_bf16 v[124:127], v[244:247], v[152:155], v[124:127]
  ds_read_b64_tr_b16 v[232:233], v15 offset:128
  ds_read_b64_tr_b16 v[234:235], v9 offset:128
  v_mfma_f32_16x16x32_bf16 v[60:63], v[244:247], v[140:143], v[60:63]
  ds_read_b64_tr_b16 v[236:237], v16 offset:128
  ds_read_b64_tr_b16 v[238:239], v10 offset:128
  v_mfma_f32_16x16x32_bf16 v[128:131], v[248:251], v[152:155], v[128:131]
  v_cvt_pk_bf16_f32 v176, v112, v113
  v_cvt_pk_bf16_f32 v177, v114, v115
  v_mfma_f32_16x16x32_bf16 v[64:67], v[248:251], v[140:143], v[64:67]
  v_cvt_pk_bf16_f32 v178, v116, v117
  s_waitcnt lgkmcnt(10)
  v_mfma_f32_16x16x32_bf16 v[132:135], v[252:255], v[152:155], v[132:135]
  ds_read_b64_tr_b16 v[240:241], v17 offset:128
  ds_read_b64_tr_b16 v[242:243], v11 offset:128
  v_mfma_f32_16x16x32_bf16 v[68:71], v[252:255], v[140:143], v[68:71]
  ds_read_b64_tr_b16 v[244:245], v18 offset:128
  ds_read_b64_tr_b16 v[246:247], v12 offset:128
  v_mfma_f32_16x16x32_bf16 v[24:27], v[216:219], v[136:139], v[24:27]
  v_cvt_pk_bf16_f32 v179, v118, v119
  s_waitcnt lgkmcnt(10)
  v_mfma_f32_16x16x32_bf16 v[28:31], v[220:223], v[136:139], v[28:31]
  ds_read_b64_tr_b16 v[248:249], v15 offset:256
  ds_read_b64_tr_b16 v[250:251], v9 offset:256
  v_mfma_f32_16x16x32_bf16 v[32:35], v[224:227], v[136:139], v[32:35]
  ds_read_b64_tr_b16 v[252:253], v16 offset:256
  ds_read_b64_tr_b16 v[254:255], v10 offset:256
  s_waitcnt lgkmcnt(10)
  v_mfma_f32_16x16x32_bf16 v[36:39], v[228:231], v[136:139], v[36:39]
  ds_read_b64_tr_b16 v[216:217], v17 offset:256
  ds_read_b64_tr_b16 v[218:219], v11 offset:256
  v_mfma_f32_16x16x32_bf16 v[40:43], v[232:235], v[136:139], v[40:43]
  ds_read_b64_tr_b16 v[220:221], v18 offset:256
  ds_read_b64_tr_b16 v[222:223], v12 offset:256
  s_waitcnt lgkmcnt(10)
  v_mfma_f32_16x16x32_bf16 v[44:47], v[236:239], v[136:139], v[44:47]
  v_cvt_pk_bf16_f32 v180, v120, v121
  v_cvt_pk_bf16_f32 v181, v122, v123
  s_waitcnt lgkmcnt(0)
  s_cbranch_vccz SL50
  s_barrier
SL50:
  ds_read_b128 v[224:227], v2 offset:30720
  ds_read_b128 v[228:231], v2 offset:31744
  ds_read_b128 v[232:235], v2 offset:32768
  ds_read_b128 v[236:239], v2 offset:33792
  v_mfma_f32_16x16x32_bf16 v[48:51], v[240:243], v[136:139], v[48:51]
  ds_read_b128 v[240:243], v2 offset:34816
  v_cvt_pk_bf16_f32 v182, v124, v125
  v_mfma_f32_16x16x32_bf16 v[52:55], v[244:247], v[136:139], v[52:55]
  ds_read_b128 v[244:247], v2 offset:35840
  v_cvt_pk_bf16_f32 v183, v126, v127
  v_mfma_f32_16x16x32_bf16 v[56:59], v[248:251], v[136:139], v[56:59]
  ds_read_b128 v[248:251], v2 offset:36864
  v_cvt_pk_bf16_f32 v72, v128, v129
  v_mfma_f32_16x16x32_bf16 v[60:63], v[252:255], v[136:139], v[60:63]
  ds_read_b128 v[252:255], v2 offset:37888
  v_cvt_pk_bf16_f32 v73, v130, v131
  v_mfma_f32_16x16x32_bf16 v[64:67], v[216:219], v[136:139], v[64:67]
  ds_read_b128 v[216:219], v2 offset:38912
  v_cvt_pk_bf16_f32 v74, v132, v133
  v_mfma_f32_16x16x32_bf16 v[68:71], v[220:223], v[136:139], v[68:71]
  ds_read_b128 v[220:223], v2 offset:39936
  v_cvt_pk_bf16_f32 v75, v134, v135
  v_cvt_pk_bf16_f32 v140, v24, v25
  v_cvt_pk_bf16_f32 v141, v26, v27
  v_cvt_pk_bf16_f32 v142, v28, v29
  v_cvt_pk_bf16_f32 v143, v30, v31
  s_waitcnt lgkmcnt(8)
  s_nop 0
  v_mfma_f32_16x16x32_bf16 v[184:187], v[224:227], v[140:143], 0
  v_cvt_pk_bf16_f32 v144, v32, v33
  v_cvt_pk_bf16_f32 v145, v34, v35
  v_cvt_pk_bf16_f32 v146, v36, v37
  v_cvt_pk_bf16_f32 v147, v38, v39
  s_nop 1
  v_mfma_f32_16x16x32_bf16 v[184:187], v[228:231], v[144:147], v[184:187]
  v_cvt_pk_bf16_f32 v148, v40, v41
  v_cvt_pk_bf16_f32 v149, v42, v43
  v_cvt_pk_bf16_f32 v150, v44, v45
  v_cvt_pk_bf16_f32 v151, v46, v47
  s_waitcnt lgkmcnt(6)
  s_nop 0
  v_mfma_f32_16x16x32_bf16 v[184:187], v[232:235], v[148:151], v[184:187]
  v_cvt_pk_bf16_f32 v168, v48, v49
  v_cvt_pk_bf16_f32 v169, v50, v51
  v_mfma_f32_16x16x32_bf16 v[192:195], v[224:227], v[156:159], 0
  ds_read_b128 v[224:227], v2 offset:40960
  v_cvt_pk_bf16_f32 v170, v52, v53
  v_mfma_f32_16x16x32_bf16 v[192:195], v[228:231], v[160:163], v[192:195]
  ds_read_b128 v[228:231], v2 offset:41984
  v_cvt_pk_bf16_f32 v171, v54, v55
  v_mfma_f32_16x16x32_bf16 v[192:195], v[232:235], v[164:167], v[192:195]
  ds_read_b128 v[232:235], v2 offset:43008
  v_cvt_pk_bf16_f32 v172, v56, v57
  v_mfma_f32_16x16x32_bf16 v[192:195], v[236:239], v[176:179], v[192:195]
  v_cvt_pk_bf16_f32 v173, v58, v59
  v_cvt_pk_bf16_f32 v174, v60, v61
  v_cvt_pk_bf16_f32 v175, v62, v63
  s_waitcnt lgkmcnt(7)
  v_mfma_f32_16x16x32_bf16 v[192:195], v[240:243], v[180:183], v[192:195]
  v_cvt_pk_bf16_f32 v152, v64, v65
  v_cvt_pk_bf16_f32 v153, v66, v67
  v_cvt_pk_bf16_f32 v154, v68, v69
  v_cvt_pk_bf16_f32 v155, v70, v71
  v_mfma_f32_16x16x32_bf16 v[192:195], v[244:247], v[72:75], v[192:195]
  v_mfma_f32_16x16x32_bf16 v[184:187], v[236:239], v[168:171], v[184:187]
  ds_read_b128 v[236:239], v2 offset:44032
  v_mfma_f32_16x16x32_bf16 v[184:187], v[240:243], v[172:175], v[184:187]
  ds_read_b128 v[240:243], v2 offset:45056
  v_mfma_f32_16x16x32_bf16 v[184:187], v[244:247], v[152:155], v[184:187]
  ds_read_b128 v[244:247], v2 offset:46080
  s_waitcnt lgkmcnt(8)
  v_mfma_f32_16x16x32_bf16 v[188:191], v[248:251], v[140:143], 0
  v_mul_f32 v192, v192, v23
  v_mul_f32 v193, v193, v23
  v_mfma_f32_16x16x32_bf16 v[188:191], v[252:255], v[144:147], v[188:191]
  v_mul_f32 v194, v194, v23
  s_waitcnt lgkmcnt(6)
  v_mfma_f32_16x16x32_bf16 v[188:191], v[216:219], v[148:151], v[188:191]
  v_mul_f32 v195, v195, v23
  v_cvt_pk_bf16_f32 v28, v192, v193
  v_mfma_f32_16x16x32_bf16 v[196:199], v[248:251], v[156:159], 0
  ds_read_b128 v[248:251], v2 offset:47104
  v_cvt_pk_bf16_f32 v29, v194, v195
  v_mfma_f32_16x16x32_bf16 v[196:199], v[252:255], v[160:163], v[196:199]
  ds_read_b128 v[252:255], v2 offset:48128
  v_mul_f32 v184, v184, v22
  v_mfma_f32_16x16x32_bf16 v[196:199], v[216:219], v[164:167], v[196:199]
  ds_read_b128 v[216:219], v2 offset:49152
  v_mul_f32 v185, v185, v22
  v_mfma_f32_16x16x32_bf16 v[196:199], v[220:223], v[176:179], v[196:199]
  v_mul_f32 v186, v186, v22
  s_waitcnt lgkmcnt(7)
  v_mfma_f32_16x16x32_bf16 v[196:199], v[224:227], v[180:183], v[196:199]
  v_mul_f32 v187, v187, v22
  v_cvt_pk_bf16_f32 v24, v184, v185
  v_mfma_f32_16x16x32_bf16 v[196:199], v[228:231], v[72:75], v[196:199]
  v_cvt_pk_bf16_f32 v25, v186, v187
  v_mfma_f32_16x16x32_bf16 v[188:191], v[220:223], v[168:171], v[188:191]
  ds_read_b128 v[220:223], v2 offset:50176
  v_mfma_f32_16x16x32_bf16 v[188:191], v[224:227], v[172:175], v[188:191]
  ds_read_b128 v[224:227], v2 offset:51200
  v_mfma_f32_16x16x32_bf16 v[188:191], v[228:231], v[152:155], v[188:191]
  ds_read_b128 v[228:231], v2 offset:52224
  s_mov_b32 s100, 71680
  buffer_load_dwordx4 v[40:43], v1, s[20:23], s100 offen offset:0 sc1
  buffer_load_dwordx4 v[44:47], v1, s[20:23], s100 offen offset:1024 sc1
  s_waitcnt lgkmcnt(8)
  v_mfma_f32_16x16x32_bf16 v[200:203], v[232:235], v[140:143], 0
  v_mul_f32 v196, v196, v23
  v_mul_f32 v197, v197, v23
  v_mfma_f32_16x16x32_bf16 v[200:203], v[236:239], v[144:147], v[200:203]
  v_mul_f32 v198, v198, v23
  s_waitcnt lgkmcnt(6)
  v_mfma_f32_16x16x32_bf16 v[200:203], v[240:243], v[148:151], v[200:203]
  v_mul_f32 v199, v199, v23
  v_cvt_pk_bf16_f32 v30, v196, v197
  v_mfma_f32_16x16x32_bf16 v[208:211], v[232:235], v[156:159], 0
  ds_read_b128 v[232:235], v2 offset:53248
  v_cvt_pk_bf16_f32 v31, v198, v199
  v_mfma_f32_16x16x32_bf16 v[208:211], v[236:239], v[160:163], v[208:211]
  buffer_store_dwordx4 v[28:31], v6, s[16:19], 0 offen offset:0 nt sc1
  v_mul_f32 v188, v188, v22
  v_mfma_f32_16x16x32_bf16 v[208:211], v[240:243], v[164:167], v[208:211]
  ds_read_b128 v[236:239], v2 offset:54272
  v_mul_f32 v189, v189, v22
  v_mfma_f32_16x16x32_bf16 v[208:211], v[244:247], v[176:179], v[208:211]
  ds_read_b128 v[240:243], v2 offset:55296
  s_waitcnt lgkmcnt(7)
  v_mfma_f32_16x16x32_bf16 v[208:211], v[248:251], v[180:183], v[208:211]
  v_mul_f32 v190, v190, v22
  v_mul_f32 v191, v191, v22
  v_mfma_f32_16x16x32_bf16 v[208:211], v[252:255], v[72:75], v[208:211]
  v_cvt_pk_bf16_f32 v26, v188, v189
  v_cvt_pk_bf16_f32 v27, v190, v191
  v_mfma_f32_16x16x32_bf16 v[200:203], v[244:247], v[168:171], v[200:203]
  buffer_store_dwordx4 v[24:27], v5, s[16:19], 0 offen offset:0 nt sc1
  v_mfma_f32_16x16x32_bf16 v[200:203], v[248:251], v[172:175], v[200:203]
  ds_read_b128 v[244:247], v2 offset:56320
  ds_read_b128 v[248:251], v2 offset:57344
  v_mfma_f32_16x16x32_bf16 v[200:203], v[252:255], v[152:155], v[200:203]
  ds_read_b128 v[252:255], v2 offset:58368
  s_waitcnt lgkmcnt(8)
  v_mfma_f32_16x16x32_bf16 v[204:207], v[216:219], v[140:143], 0
  v_mul_f32 v208, v208, v23
  v_mul_f32 v209, v209, v23
  v_mfma_f32_16x16x32_bf16 v[204:207], v[220:223], v[144:147], v[204:207]
  v_mul_f32 v210, v210, v23
  s_waitcnt lgkmcnt(6)
  v_mfma_f32_16x16x32_bf16 v[204:207], v[224:227], v[148:151], v[204:207]
  v_mul_f32 v211, v211, v23
  v_cvt_pk_bf16_f32 v36, v208, v209
  v_mfma_f32_16x16x32_bf16 v[212:215], v[216:219], v[156:159], 0
  ds_read_b128 v[216:219], v2 offset:59392
  v_cvt_pk_bf16_f32 v37, v210, v211
  v_mfma_f32_16x16x32_bf16 v[212:215], v[220:223], v[160:163], v[212:215]
  ds_read_b128 v[220:223], v2 offset:60416
  v_mul_f32 v200, v200, v22
  v_mfma_f32_16x16x32_bf16 v[212:215], v[224:227], v[164:167], v[212:215]
  ds_read_b128 v[224:227], v1 offset:0
  v_mul_f32 v201, v201, v22
  v_mfma_f32_16x16x32_bf16 v[212:215], v[228:231], v[176:179], v[212:215]
  v_mul_f32 v202, v202, v22
  s_waitcnt lgkmcnt(7)
  v_mfma_f32_16x16x32_bf16 v[212:215], v[232:235], v[180:183], v[212:215]
  v_mul_f32 v203, v203, v22
  v_cvt_pk_bf16_f32 v32, v200, v201
  v_mfma_f32_16x16x32_bf16 v[212:215], v[236:239], v[72:75], v[212:215]
  v_cvt_pk_bf16_f32 v33, v202, v203
  v_mfma_f32_16x16x32_bf16 v[204:207], v[228:231], v[168:171], v[204:207]
  ds_read_b128 v[228:231], v1 offset:1024
  v_mfma_f32_16x16x32_bf16 v[204:207], v[232:235], v[172:175], v[204:207]
  ds_read_b128 v[232:235], v1 offset:2048
  v_mfma_f32_16x16x32_bf16 v[204:207], v[236:239], v[152:155], v[204:207]
  ds_read_b128 v[236:239], v1 offset:3072
  s_cbranch_vccz SL51
  s_barrier
SL51:
  s_waitcnt lgkmcnt(8)
  v_mfma_f32_16x16x32_bf16 v[184:187], v[240:243], v[140:143], 0
  v_mul_f32 v212, v212, v23
  v_mul_f32 v213, v213, v23
  v_mfma_f32_16x16x32_bf16 v[184:187], v[244:247], v[144:147], v[184:187]
  v_mul_f32 v214, v214, v23
  s_waitcnt lgkmcnt(6)
  v_mfma_f32_16x16x32_bf16 v[184:187], v[248:251], v[148:151], v[184:187]
  v_mul_f32 v215, v215, v23
  v_cvt_pk_bf16_f32 v38, v212, v213
  v_mfma_f32_16x16x32_bf16 v[192:195], v[240:243], v[156:159], 0
  ds_read_b128 v[240:243], v1 offset:4096
  v_cvt_pk_bf16_f32 v39, v214, v215
  v_mfma_f32_16x16x32_bf16 v[192:195], v[244:247], v[160:163], v[192:195]
  buffer_store_dwordx4 v[36:39], v6, s[16:19], 0 offen offset:64 nt sc1
  v_mul_f32 v204, v204, v22
  v_mfma_f32_16x16x32_bf16 v[192:195], v[248:251], v[164:167], v[192:195]
  ds_read_b128 v[244:247], v1 offset:5120
  v_mul_f32 v205, v205, v22
  v_mfma_f32_16x16x32_bf16 v[192:195], v[252:255], v[176:179], v[192:195]
  ds_read_b128 v[248:251], v1 offset:6144
  s_waitcnt lgkmcnt(7)
  v_mfma_f32_16x16x32_bf16 v[192:195], v[216:219], v[180:183], v[192:195]
  v_mul_f32 v206, v206, v22
  v_mul_f32 v207, v207, v22
  v_mfma_f32_16x16x32_bf16 v[192:195], v[220:223], v[72:75], v[192:195]
  v_cvt_pk_bf16_f32 v34, v204, v205
  v_cvt_pk_bf16_f32 v35, v206, v207
  v_mfma_f32_16x16x32_bf16 v[184:187], v[252:255], v[168:171], v[184:187]
  buffer_store_dwordx4 v[32:35], v5, s[16:19], 0 offen offset:64 nt sc1
  v_mfma_f32_16x16x32_bf16 v[184:187], v[216:219], v[172:175], v[184:187]
  ds_read_b128 v[252:255], v1 offset:7168
  ds_read_b128 v[216:219], v1 offset:8192
  v_mfma_f32_16x16x32_bf16 v[184:187], v[220:223], v[152:155], v[184:187]
  ds_read_b128 v[220:223], v1 offset:9216
  s_waitcnt lgkmcnt(8)
  v_mfma_f32_16x16x32_bf16 v[188:191], v[224:227], v[140:143], 0
  v_mul_f32 v192, v192, v23
  v_mul_f32 v193, v193, v23
  v_mfma_f32_16x16x32_bf16 v[188:191], v[228:231], v[144:147], v[188:191]
  v_mul_f32 v194, v194, v23
  s_waitcnt lgkmcnt(6)
  v_mfma_f32_16x16x32_bf16 v[188:191], v[232:235], v[148:151], v[188:191]
  v_mul_f32 v195, v195, v23
  v_cvt_pk_bf16_f32 v28, v192, v193
  v_mfma_f32_16x16x32_bf16 v[196:199], v[224:227], v[156:159], 0
  ds_read_b128 v[224:227], v2 offset:0
  v_cvt_pk_bf16_f32 v29, v194, v195
  v_mfma_f32_16x16x32_bf16 v[196:199], v[228:231], v[160:163], v[196:199]
  ds_read_b128 v[228:231], v2 offset:1024
  v_mul_f32 v184, v184, v22
  v_mfma_f32_16x16x32_bf16 v[196:199], v[232:235], v[164:167], v[196:199]
  ds_read_b128 v[232:235], v2 offset:2048
  v_mul_f32 v185, v185, v22
  v_mfma_f32_16x16x32_bf16 v[196:199], v[236:239], v[176:179], v[196:199]
  v_mul_f32 v186, v186, v22
  s_waitcnt lgkmcnt(7)
  v_mfma_f32_16x16x32_bf16 v[196:199], v[240:243], v[180:183], v[196:199]
  v_mul_f32 v187, v187, v22
  v_cvt_pk_bf16_f32 v24, v184, v185
  v_mfma_f32_16x16x32_bf16 v[196:199], v[244:247], v[72:75], v[196:199]
  v_cvt_pk_bf16_f32 v25, v186, v187
  v_mfma_f32_16x16x32_bf16 v[188:191], v[236:239], v[168:171], v[188:191]
  ds_read_b128 v[236:239], v2 offset:3072
  v_mfma_f32_16x16x32_bf16 v[188:191], v[240:243], v[172:175], v[188:191]
  ds_read_b128 v[240:243], v2 offset:4096
  v_mfma_f32_16x16x32_bf16 v[188:191], v[244:247], v[152:155], v[188:191]
  ds_read_b128 v[244:247], v2 offset:5120
  s_waitcnt lgkmcnt(8)
  v_mfma_f32_16x16x32_bf16 v[200:203], v[248:251], v[140:143], 0
  v_mul_f32 v196, v196, v23
  v_mul_f32 v197, v197, v23
  v_mfma_f32_16x16x32_bf16 v[200:203], v[252:255], v[144:147], v[200:203]
  v_mul_f32 v198, v198, v23
  s_waitcnt lgkmcnt(6)
  v_mfma_f32_16x16x32_bf16 v[200:203], v[216:219], v[148:151], v[200:203]
  v_mul_f32 v199, v199, v23
  v_cvt_pk_bf16_f32 v30, v196, v197
  v_mfma_f32_16x16x32_bf16 v[208:211], v[248:251], v[156:159], 0
  ds_read_b128 v[248:251], v2 offset:6144
  v_cvt_pk_bf16_f32 v31, v198, v199
  v_mfma_f32_16x16x32_bf16 v[208:211], v[252:255], v[160:163], v[208:211]
  buffer_store_dwordx4 v[28:31], v6, s[16:19], 0 offen offset:128 nt sc1
  v_mul_f32 v188, v188, v22
  v_mfma_f32_16x16x32_bf16 v[208:211], v[216:219], v[164:167], v[208:211]
  ds_read_b128 v[252:255], v2 offset:7168
  v_mul_f32 v189, v189, v22
  v_mfma_f32_16x16x32_bf16 v[208:211], v[220:223], v[176:179], v[208:211]
  ds_read_b128 v[216:219], v2 offset:8192
  s_waitcnt lgkmcnt(7)
  v_mfma_f32_16x16x32_bf16 v[208:211], v[224:227], v[180:183], v[208:211]
  v_mul_f32 v190, v190, v22
  v_mul_f32 v191, v191, v22
  v_mfma_f32_16x16x32_bf16 v[208:211], v[228:231], v[72:75], v[208:211]
  v_cvt_pk_bf16_f32 v26, v188, v189
  v_cvt_pk_bf16_f32 v27, v190, v191
  v_mfma_f32_16x16x32_bf16 v[200:203], v[220:223], v[168:171], v[200:203]
  buffer_store_dwordx4 v[24:27], v5, s[16:19], 0 offen offset:128 nt sc1
  v_mfma_f32_16x16x32_bf16 v[200:203], v[224:227], v[172:175], v[200:203]
  ds_read_b128 v[220:223], v2 offset:9216
  ds_read_b128 v[224:227], v2 offset:10240
  v_mfma_f32_16x16x32_bf16 v[200:203], v[228:231], v[152:155], v[200:203]
  ds_read_b128 v[228:231], v2 offset:11264
  s_waitcnt lgkmcnt(8)
  v_mfma_f32_16x16x32_bf16 v[204:207], v[232:235], v[140:143], 0
  v_mul_f32 v208, v208, v23
  v_mul_f32 v209, v209, v23
  v_mfma_f32_16x16x32_bf16 v[204:207], v[236:239], v[144:147], v[204:207]
  v_mul_f32 v210, v210, v23
  s_waitcnt lgkmcnt(6)
  v_mfma_f32_16x16x32_bf16 v[204:207], v[240:243], v[148:151], v[204:207]
  v_mul_f32 v211, v211, v23
  v_cvt_pk_bf16_f32 v36, v208, v209
  v_mfma_f32_16x16x32_bf16 v[212:215], v[232:235], v[156:159], 0
  ds_read_b128 v[232:235], v2 offset:12288
  v_cvt_pk_bf16_f32 v37, v210, v211
  v_mfma_f32_16x16x32_bf16 v[212:215], v[236:239], v[160:163], v[212:215]
  ds_read_b128 v[236:239], v2 offset:13312
  v_mul_f32 v200, v200, v22
  v_mfma_f32_16x16x32_bf16 v[212:215], v[240:243], v[164:167], v[212:215]
  ds_read_b128 v[240:243], v2 offset:14336
  v_mul_f32 v201, v201, v22
  v_mfma_f32_16x16x32_bf16 v[212:215], v[244:247], v[176:179], v[212:215]
  v_mul_f32 v202, v202, v22
  s_waitcnt lgkmcnt(7)
  v_mfma_f32_16x16x32_bf16 v[212:215], v[248:251], v[180:183], v[212:215]
  v_mul_f32 v203, v203, v22
  v_cvt_pk_bf16_f32 v32, v200, v201
  v_mfma_f32_16x16x32_bf16 v[212:215], v[252:255], v[72:75], v[212:215]
  v_cvt_pk_bf16_f32 v33, v202, v203
  v_mfma_f32_16x16x32_bf16 v[204:207], v[244:247], v[168:171], v[204:207]
  ds_read_b128 v[244:247], v2 offset:15360
  v_mfma_f32_16x16x32_bf16 v[204:207], v[248:251], v[172:175], v[204:207]
  ds_read_b128 v[248:251], v2 offset:16384
  v_mfma_f32_16x16x32_bf16 v[204:207], v[252:255], v[152:155], v[204:207]
  ds_read_b128 v[252:255], v2 offset:17408
  s_waitcnt lgkmcnt(8)
  v_mfma_f32_16x16x32_bf16 v[184:187], v[216:219], v[140:143], 0
  v_mul_f32 v212, v212, v23
  v_mul_f32 v213, v213, v23
  v_mfma_f32_16x16x32_bf16 v[184:187], v[220:223], v[144:147], v[184:187]
  v_mul_f32 v214, v214, v23
  s_waitcnt lgkmcnt(6)
  v_mfma_f32_16x16x32_bf16 v[184:187], v[224:227], v[148:151], v[184:187]
  v_mul_f32 v215, v215, v23
  v_cvt_pk_bf16_f32 v38, v212, v213
  v_mfma_f32_16x16x32_bf16 v[192:195], v[216:219], v[156:159], 0
  ds_read_b128 v[216:219], v2 offset:18432
  v_cvt_pk_bf16_f32 v39, v214, v215
  v_mfma_f32_16x16x32_bf16 v[192:195], v[220:223], v[160:163], v[192:195]
  buffer_store_dwordx4 v[36:39], v6, s[16:19], 0 offen offset:192 nt sc1
  v_mul_f32 v204, v204, v22
  v_mfma_f32_16x16x32_bf16 v[192:195], v[224:227], v[164:167], v[192:195]
  ds_read_b128 v[220:223], v2 offset:19456
  v_mul_f32 v205, v205, v22
  v_mfma_f32_16x16x32_bf16 v[192:195], v[228:231], v[176:179], v[192:195]
  ds_read_b128 v[224:227], v2 offset:20480
  s_waitcnt lgkmcnt(7)
  v_mfma_f32_16x16x32_bf16 v[192:195], v[232:235], v[180:183], v[192:195]
  v_mul_f32 v206, v206, v22
  v_mul_f32 v207, v207, v22
  v_mfma_f32_16x16x32_bf16 v[192:195], v[236:239], v[72:75], v[192:195]
  v_cvt_pk_bf16_f32 v34, v204, v205
  v_cvt_pk_bf16_f32 v35, v206, v207
  v_mfma_f32_16x16x32_bf16 v[184:187], v[228:231], v[168:171], v[184:187]
  buffer_store_dwordx4 v[32:35], v5, s[16:19], 0 offen offset:192 nt sc1
  v_mfma_f32_16x16x32_bf16 v[184:187], v[232:235], v[172:175], v[184:187]
  ds_read_b128 v[228:231], v2 offset:21504
  ds_read_b128 v[232:235], v2 offset:22528
  v_mfma_f32_16x16x32_bf16 v[184:187], v[236:239], v[152:155], v[184:187]
  ds_read_b128 v[236:239], v2 offset:23552
  s_waitcnt lgkmcnt(8)
  v_mfma_f32_16x16x32_bf16 v[188:191], v[240:243], v[140:143], 0
  v_mul_f32 v192, v192, v23
  v_mul_f32 v193, v193, v23
  v_mfma_f32_16x16x32_bf16 v[188:191], v[244:247], v[144:147], v[188:191]
  v_mul_f32 v194, v194, v23
  s_waitcnt lgkmcnt(6)
  v_mfma_f32_16x16x32_bf16 v[188:191], v[248:251], v[148:151], v[188:191]
  v_mul_f32 v195, v195, v23
  v_cvt_pk_bf16_f32 v28, v192, v193
  v_mfma_f32_16x16x32_bf16 v[196:199], v[240:243], v[156:159], 0
  ds_read_b128 v[240:243], v2 offset:24576
  v_cvt_pk_bf16_f32 v29, v194, v195
  v_mfma_f32_16x16x32_bf16 v[196:199], v[244:247], v[160:163], v[196:199]
  ds_read_b128 v[244:247], v2 offset:25600
  v_mul_f32 v184, v184, v22
  v_mfma_f32_16x16x32_bf16 v[196:199], v[248:251], v[164:167], v[196:199]
  ds_read_b128 v[248:251], v2 offset:26624
  v_mul_f32 v185, v185, v22
  v_mfma_f32_16x16x32_bf16 v[196:199], v[252:255], v[176:179], v[196:199]
  v_mul_f32 v186, v186, v22
  s_waitcnt lgkmcnt(7)
  v_mfma_f32_16x16x32_bf16 v[196:199], v[216:219], v[180:183], v[196:199]
  v_mul_f32 v187, v187, v22
  v_cvt_pk_bf16_f32 v24, v184, v185
  v_mfma_f32_16x16x32_bf16 v[196:199], v[220:223], v[72:75], v[196:199]
  v_cvt_pk_bf16_f32 v25, v186, v187
  v_mfma_f32_16x16x32_bf16 v[188:191], v[252:255], v[168:171], v[188:191]
  ds_read_b128 v[252:255], v2 offset:27648
  v_mfma_f32_16x16x32_bf16 v[188:191], v[216:219], v[172:175], v[188:191]
  ds_read_b128 v[216:219], v2 offset:28672
  v_mfma_f32_16x16x32_bf16 v[188:191], v[220:223], v[152:155], v[188:191]
  ds_read_b128 v[220:223], v2 offset:29696
  s_waitcnt vmcnt(8)
  s_waitcnt lgkmcnt(8)
  v_mfma_f32_16x16x32_bf16 v[200:203], v[224:227], v[140:143], 0
  v_mul_f32 v196, v196, v23
  v_mul_f32 v197, v197, v23
  v_mfma_f32_16x16x32_bf16 v[200:203], v[228:231], v[144:147], v[200:203]
  v_mul_f32 v198, v198, v23
  s_waitcnt lgkmcnt(6)
  v_mfma_f32_16x16x32_bf16 v[200:203], v[232:235], v[148:151], v[200:203]
  v_mul_f32 v199, v199, v23
  v_cvt_pk_bf16_f32 v30, v196, v197
  v_mfma_f32_16x16x32_bf16 v[208:211], v[224:227], v[156:159], 0
  v_cvt_pk_bf16_f32 v31, v198, v199
  v_mul_f32 v188, v188, v22
  v_mfma_f32_16x16x32_bf16 v[208:211], v[228:231], v[160:163], v[208:211]
  buffer_store_dwordx4 v[28:31], v6, s[16:19], 0 offen offset:256 nt sc1
  v_mul_f32 v189, v189, v22
  v_mfma_f32_16x16x32_bf16 v[208:211], v[232:235], v[164:167], v[208:211]
  v_mul_f32 v190, v190, v22
  v_mul_f32 v191, v191, v22
  v_mfma_f32_16x16x32_bf16 v[208:211], v[236:239], v[176:179], v[208:211]
  v_cvt_pk_bf16_f32 v26, v188, v189
  s_waitcnt lgkmcnt(5)
  v_mfma_f32_16x16x32_bf16 v[208:211], v[240:243], v[180:183], v[208:211]
  v_cvt_pk_bf16_f32 v27, v190, v191
  s_waitcnt lgkmcnt(4)
  v_mfma_f32_16x16x32_bf16 v[208:211], v[244:247], v[72:75], v[208:211]
  buffer_store_dwordx4 v[24:27], v5, s[16:19], 0 offen offset:256 nt sc1
  v_mfma_f32_16x16x32_bf16 v[200:203], v[236:239], v[168:171], v[200:203]
  v_mfma_f32_16x16x32_bf16 v[200:203], v[240:243], v[172:175], v[200:203]
  v_mfma_f32_16x16x32_bf16 v[200:203], v[244:247], v[152:155], v[200:203]
  s_waitcnt lgkmcnt(3)
  v_mfma_f32_16x16x32_bf16 v[204:207], v[248:251], v[140:143], 0
  s_waitcnt lgkmcnt(2)
  v_mfma_f32_16x16x32_bf16 v[204:207], v[252:255], v[144:147], v[204:207]
  v_mul_f32 v208, v208, v23
  s_waitcnt lgkmcnt(1)
  v_mfma_f32_16x16x32_bf16 v[204:207], v[216:219], v[148:151], v[204:207]
  v_mul_f32 v209, v209, v23
  v_mul_f32 v210, v210, v23
  v_mfma_f32_16x16x32_bf16 v[212:215], v[248:251], v[156:159], 0
  v_mul_f32 v211, v211, v23
  v_cvt_pk_bf16_f32 v36, v208, v209
  v_mfma_f32_16x16x32_bf16 v[212:215], v[252:255], v[160:163], v[212:215]
  v_cvt_pk_bf16_f32 v37, v210, v211
  v_mul_f32 v200, v200, v22
  v_mfma_f32_16x16x32_bf16 v[212:215], v[216:219], v[164:167], v[212:215]
  v_mul_f32 v201, v201, v22
  s_waitcnt lgkmcnt(0)
  v_mfma_f32_16x16x32_bf16 v[212:215], v[220:223], v[176:179], v[212:215]
  v_mul_f32 v202, v202, v22
  v_mfma_f32_16x16x32_bf16 v[212:215], v[40:43], v[180:183], v[212:215]
  v_mul_f32 v203, v203, v22
  v_mfma_f32_16x16x32_bf16 v[212:215], v[44:47], v[72:75], v[212:215]
  v_cvt_pk_bf16_f32 v32, v200, v201
  v_cvt_pk_bf16_f32 v33, v202, v203
  v_mfma_f32_16x16x32_bf16 v[204:207], v[220:223], v[168:171], v[204:207]
  v_mfma_f32_16x16x32_bf16 v[204:207], v[40:43], v[172:175], v[204:207]
  v_mfma_f32_16x16x32_bf16 v[204:207], v[44:47], v[152:155], v[204:207]
  s_nop 2
  v_mul_f32 v212, v212, v23
  v_mul_f32 v213, v213, v23
  v_mul_f32 v214, v214, v23
  v_mul_f32 v215, v215, v23
  v_cvt_pk_bf16_f32 v38, v212, v213
  v_cvt_pk_bf16_f32 v39, v214, v215
  buffer_store_dwordx4 v[36:39], v6, s[16:19], 0 offen offset:320 nt sc1
  v_mul_f32 v204, v204, v22
  v_mul_f32 v205, v205, v22
  v_mul_f32 v206, v206, v22
  v_mul_f32 v207, v207, v22
  v_cvt_pk_bf16_f32 v34, v204, v205
  v_cvt_pk_bf16_f32 v35, v206, v207
  buffer_store_dwordx4 v[32:35], v5, s[16:19], 0 offen offset:320 nt sc1
MK_fin:
MK_done:
  s_endpgm
MK_single:
  ds_read_b128 v[216:219], v2 offset:35840
  ds_read_b128 v[220:223], v2 offset:34816
  ds_read_b128 v[224:227], v2 offset:33792
  ds_read_b128 v[228:231], v2 offset:32768
  ds_read_b128 v[232:235], v2 offset:31744
  ds_read_b128 v[236:239], v2 offset:30720
  ds_read_b128 v[240:243], v2 offset:29696
  ds_read_b128 v[244:247], v2 offset:28672
  ds_read_b128 v[248:251], v2 offset:27648
  ds_read_b128 v[252:255], v2 offset:26624
  s_cmp_lg_u32 s3, 0
  s_cbranch_scc1 MK_np4
  s_waitcnt vmcnt(0)
MK_np4:
  s_waitcnt vmcnt(1)
  s_setprio 1
BODYS:
  s_waitcnt lgkmcnt(8)
  v_mfma_f32_16x16x32_bf16 v[192:195], v[216:219], v[160:163], 0
  ds_read_b128 v[216:219], v2 offset:25600
  v_mov_b32 v64, 0xff800000
  v_mfma_f32_16x16x32_bf16 v[192:195], v[220:223], v[164:167], v[192:195]
  ds_read_b128 v[220:223], v2 offset:24576
  s_waitcnt lgkmcnt(8)
  v_mfma_f32_16x16x32_bf16 v[192:195], v[224:227], v[168:171], v[192:195]
  ds_read_b128 v[224:227], v2 offset:23552
  v_add_u32 v65, 0, v19
  v_mfma_f32_16x16x32_bf16 v[192:195], v[228:231], v[172:175], v[192:195]
  ds_read_b128 v[228:231], v2 offset:22528
  s_waitcnt lgkmcnt(8)
  v_mfma_f32_16x16x32_bf16 v[192:195], v[232:235], v[176:179], v[192:195]
  ds_read_b128 v[232:235], v2 offset:21504
  v_add_u32 v66, 1, v19
  v_mfma_f32_16x16x32_bf16 v[192:195], v[236:239], v[180:183], v[192:195]
  ds_read_b128 v[236:239], v2 offset:20480
  s_waitcnt lgkmcnt(8)
  v_mfma_f32_16x16x32_bf16 v[196:199], v[240:243], v[160:163], 0
  ds_read_b128 v[240:243], v2 offset:19456
  v_add_u32 v67, 2, v19
  v_mfma_f32_16x16x32_bf16 v[196:199], v[244:247], v[164:167], v[196:199]
  ds_read_b128 v[244:247], v2 offset:18432
  s_waitcnt lgkmcnt(8)
  v_mfma_f32_16x16x32_bf16 v[196:199], v[248:251], v[168:171], v[196:199]
  ds_read_b128 v[248:251], v2 offset:17408
  v_add_u32 v68, 3, v19
  v_mfma_f32_16x16x32_bf16 v[196:199], v[252:255], v[172:175], v[196:199]
  ds_read_b128 v[252:255], v2 offset:16384
  s_waitcnt lgkmcnt(8)
  v_mfma_f32_16x16x32_bf16 v[196:199], v[216:219], v[176:179], v[196:199]
  ds_read_b128 v[216:219], v2 offset:15360
  v_cmp_gt_u32 s[48:49], 7, v65
  v_mfma_f32_16x16x32_bf16 v[196:199], v[220:223], v[180:183], v[196:199]
  ds_read_b128 v[220:223], v2 offset:14336
  s_waitcnt lgkmcnt(8)
  v_mfma_f32_16x16x32_bf16 v[208:211], v[224:227], v[160:163], 0
  ds_read_b128 v[224:227], v2 offset:13312
  v_cmp_gt_u32 s[50:51], 7, v66
  v_mfma_f32_16x16x32_bf16 v[208:211], v[228:231], v[164:167], v[208:211]
  ds_read_b128 v[228:231], v2 offset:12288
  s_waitcnt lgkmcnt(8)
  v_mfma_f32_16x16x32_bf16 v[208:211], v[232:235], v[168:171], v[208:211]
  ds_read_b128 v[232:235], v2 offset:11264
  v_cmp_gt_u32 s[52:53], 7, v67
  v_mfma_f32_16x16x32_bf16 v[208:211], v[236:239], v[172:175], v[208:211]
  ds_read_b128 v[236:239], v2 offset:10240
  s_waitcnt lgkmcnt(8)
  v_mfma_f32_16x16x32_bf16 v[208:211], v[240:243], v[176:179], v[208:211]
  ds_read_b128 v[240:243], v2 offset:9216
  v_cmp_gt_u32 s[54:55], 7, v68
  v_mfma_f32_16x16x32_bf16 v[208:211], v[244:247], v[180:183], v[208:211]
  ds_read_b128 v[244:247], v2 offset:8192
  s_waitcnt lgkmcnt(8)
  v_mfma_f32_16x16x32_bf16 v[212:215], v[248:251], v[160:163], 0
  ds_read_b128 v[248:251], v2 offset:7168
  s_add_i32 s46, s34, 8
  v_mfma_f32_16x16x32_bf16 v[212:215], v[252:255], v[164:167], v[212:215]
  ds_read_b128 v[252:255], v2 offset:6144
  s_waitcnt lgkmcnt(8)
  v_mfma_f32_16x16x32_bf16 v[212:215], v[216:219], v[168:171], v[212:215]
  ds_read_b128 v[216:219], v2 offset:5120
  v_sub_u32 v69, s46, v22
  v_mfma_f32_16x16x32_bf16 v[212:215], v[220:223], v[172:175], v[212:215]
  ds_read_b128 v[220:223], v2 offset:4096
  s_waitcnt lgkmcnt(8)
  v_mfma_f32_16x16x32_bf16 v[212:215], v[224:227], v[176:179], v[212:215]
  ds_read_b128 v[224:227], v2 offset:3072
  s_add_i32 s46, s34, 1
  v_mfma_f32_16x16x32_bf16 v[212:215], v[228:231], v[180:183], v[212:215]
  ds_read_b128 v[228:231], v2 offset:2048
  v_sub_u32 v70, s46, v22
  v_cndmask_b32 v60, v64, 0, s[48:49]
  v_cndmask_b32 v61, v64, 0, s[50:51]
  v_cndmask_b32 v62, v64, 0, s[52:53]
  v_cndmask_b32 v63, v64, 0, s[54:55]
  v_cmp_gt_u32 s[46:47], 7, v69
  v_cmp_gt_u32 s[48:49], 7, v70
  s_nop 0
  v_cndmask_b32 v84, v64, v60, s[46:47]
  v_cndmask_b32 v85, v64, v61, s[46:47]
  v_cndmask_b32 v86, v64, v62, s[46:47]
  v_cndmask_b32 v87, v64, v63, s[46:47]
  v_cndmask_b32 v56, v64, v60, s[48:49]
  v_cndmask_b32 v57, v64, v61, s[48:49]
  v_cndmask_b32 v58, v64, v62, s[48:49]
  v_cndmask_b32 v59, v64, v63, s[48:49]
  v_mul_f32 v192, s93, v192
  v_mul_f32 v193, s93, v193
  v_mul_f32 v194, s93, v194
  v_mul_f32 v195, s93, v195
  v_cvt_pk_bf16_f32 v112, v192, v193
  v_cvt_pk_bf16_f32 v113, v194, v195
  v_mul_f32 v196, s93, v196
  v_mul_f32 v197, s93, v197
  v_mul_f32 v198, s93, v198
  v_mul_f32 v199, s93, v199
  v_cvt_pk_bf16_f32 v114, v196, v197
  v_cvt_pk_bf16_f32 v115, v198, v199
  s_waitcnt lgkmcnt(8)
  v_mfma_f32_16x16x32_bf16 v[192:195], v[232:235], v[160:163], 0
  ds_read_b128 v[232:235], v2 offset:1024
  v_mul_f32 v208, s93, v208
  v_mfma_f32_16x16x32_bf16 v[192:195], v[236:239], v[164:167], v[192:195]
  ds_read_b128 v[236:239], v2 offset:0
  s_waitcnt lgkmcnt(8)
  v_mfma_f32_16x16x32_bf16 v[192:195], v[240:243], v[168:171], v[192:195]
  ds_read_b128 v[240:243], v1 offset:35840
  v_mul_f32 v209, s93, v209
  v_mfma_f32_16x16x32_bf16 v[192:195], v[244:247], v[172:175], v[192:195]
  ds_read_b128 v[244:247], v1 offset:34816
  s_waitcnt lgkmcnt(8)
  v_mfma_f32_16x16x32_bf16 v[192:195], v[248:251], v[176:179], v[192:195]
  ds_read_b128 v[248:251], v1 offset:33792
  v_mul_f32 v210, s93, v210
  v_mfma_f32_16x16x32_bf16 v[192:195], v[252:255], v[180:183], v[192:195]
  ds_read_b128 v[252:255], v1 offset:32768
  s_waitcnt lgkmcnt(8)
  v_mfma_f32_16x16x32_bf16 v[196:199], v[216:219], v[160:163], 0
  ds_read_b128 v[216:219], v1 offset:31744
  v_mul_f32 v211, s93, v211
  s_cmp_eq_u32 s3, 0
  s_cbranch_scc1 MK_np5
  s_waitcnt vmcnt(0)
  v_mov_b32 v23, 1
  s_mov_b64 exec, 1
  s_lshl_b32 s100, s26, 7
  buffer_atomic_add v23, off, s[8:11], s100 sc1
  s_mov_b64 exec, -1
  s_nop 3
MK_np5:
  v_mfma_f32_16x16x32_bf16 v[196:199], v[220:223], v[164:167], v[196:199]
  ds_read_b128 v[220:223], v1 offset:30720
  s_waitcnt lgkmcnt(8)
  v_mfma_f32_16x16x32_bf16 v[196:199], v[224:227], v[168:171], v[196:199]
  ds_read_b128 v[224:227], v1 offset:29696
  v_cvt_pk_bf16_f32 v116, v208, v209
  v_mfma_f32_16x16x32_bf16 v[196:199], v[228:231], v[172:175], v[196:199]
  ds_read_b128 v[228:231], v1 offset:28672
  s_waitcnt lgkmcnt(8)
  v_mfma_f32_16x16x32_bf16 v[196:199], v[232:235], v[176:179], v[196:199]
  ds_read_b128 v[232:235], v1 offset:27648
  v_cvt_pk_bf16_f32 v117, v210, v211
  v_mfma_f32_16x16x32_bf16 v[196:199], v[236:239], v[180:183], v[196:199]
  ds_read_b128 v[236:239], v1 offset:26624
  v_mul_f32 v212, s93, v212
  v_mul_f32 v213, s93, v213
  v_mul_f32 v214, s93, v214
  v_mul_f32 v215, s93, v215
  v_cvt_pk_bf16_f32 v118, v212, v213
  v_cvt_pk_bf16_f32 v119, v214, v215
  s_waitcnt lgkmcnt(8)
  v_mfma_f32_16x16x32_bf16 v[208:211], v[240:243], v[160:163], 0
  ds_read_b128 v[240:243], v1 offset:25600
  v_mul_f32 v192, s93, v192
  v_mfma_f32_16x16x32_bf16 v[208:211], v[244:247], v[164:167], v[208:211]
  ds_read_b128 v[244:247], v1 offset:24576
  s_waitcnt lgkmcnt(8)
  v_mfma_f32_16x16x32_bf16 v[208:211], v[248:251], v[168:171], v[208:211]
  ds_read_b128 v[248:251], v1 offset:23552
  v_mul_f32 v193, s93, v193
  v_mfma_f32_16x16x32_bf16 v[208:211], v[252:255], v[172:175], v[208:211]
  ds_read_b128 v[252:255], v1 offset:22528
  s_waitcnt lgkmcnt(8)
  v_mfma_f32_16x16x32_bf16 v[208:211], v[216:219], v[176:179], v[208:211]
  ds_read_b128 v[216:219], v1 offset:21504
  v_mul_f32 v194, s93, v194
  v_mfma_f32_16x16x32_bf16 v[208:211], v[220:223], v[180:183], v[208:211]
  ds_read_b128 v[220:223], v1 offset:20480
  s_waitcnt lgkmcnt(8)
  v_mfma_f32_16x16x32_bf16 v[212:215], v[224:227], v[160:163], 0
  ds_read_b128 v[224:227], v1 offset:19456
  v_mul_f32 v195, s93, v195
  v_mfma_f32_16x16x32_bf16 v[212:215], v[228:231], v[164:167], v[212:215]
  ds_read_b128 v[228:231], v1 offset:18432
  s_waitcnt lgkmcnt(8)
  v_mfma_f32_16x16x32_bf16 v[212:215], v[232:235], v[168:171], v[212:215]
  ds_read_b128 v[232:235], v1 offset:17408
  v_cvt_pk_bf16_f32 v120, v192, v193
  v_mfma_f32_16x16x32_bf16 v[212:215], v[236:239], v[172:175], v[212:215]
  ds_read_b128 v[236:239], v1 offset:16384
  s_waitcnt lgkmcnt(8)
  v_mfma_f32_16x16x32_bf16 v[212:215], v[240:243], v[176:179], v[212:215]
  ds_read_b128 v[240:243], v1 offset:15360
  v_cvt_pk_bf16_f32 v121, v194, v195
  v_mfma_f32_16x16x32_bf16 v[212:215], v[244:247], v[180:183], v[212:215]
  ds_read_b128 v[244:247], v1 offset:14336
  v_mul_f32 v196, s93, v196
  v_mul_f32 v197, s93, v197
  v_mul_f32 v198, s93, v198
  v_mul_f32 v199, s93, v199
  v_cvt_pk_bf16_f32 v122, v196, v197
  v_cvt_pk_bf16_f32 v123, v198, v199
  s_waitcnt lgkmcnt(8)
  v_mfma_f32_16x16x32_bf16 v[192:195], v[248:251], v[160:163], 0
  ds_read_b128 v[248:251], v1 offset:13312
  v_mul_f32 v208, s93, v208
  v_mfma_f32_16x16x32_bf16 v[192:195], v[252:255], v[164:167], v[192:195]
  ds_read_b128 v[252:255], v1 offset:12288
  s_waitcnt lgkmcnt(8)
  v_mfma_f32_16x16x32_bf16 v[192:195], v[216:219], v[168:171], v[192:195]
  ds_read_b128 v[216:219], v1 offset:11264
  v_mul_f32 v209, s93, v209
  v_mfma_f32_16x16x32_bf16 v[192:195], v[220:223], v[172:175], v[192:195]
  ds_read_b128 v[220:223], v1 offset:10240
  s_waitcnt lgkmcnt(8)
  v_mfma_f32_16x16x32_bf16 v[192:195], v[224:227], v[176:179], v[192:195]
  ds_read_b128 v[224:227], v1 offset:9216
  v_mul_f32 v210, s93, v210
  v_mfma_f32_16x16x32_bf16 v[192:195], v[228:231], v[180:183], v[192:195]
  ds_read_b128 v[228:231], v1 offset:8192
  s_waitcnt lgkmcnt(8)
  v_mfma_f32_16x16x32_bf16 v[196:199], v[232:235], v[160:163], 0
  ds_read_b128 v[232:235], v1 offset:7168
  v_mul_f32 v211, s93, v211
  v_mfma_f32_16x16x32_bf16 v[196:199], v[236:239], v[164:167], v[196:199]
  ds_read_b128 v[236:239], v1 offset:6144
  s_waitcnt lgkmcnt(8)
  v_mfma_f32_16x16x32_bf16 v[196:199], v[240:243], v[168:171], v[196:199]
  ds_read_b128 v[240:243], v1 offset:5120
  v_cvt_pk_bf16_f32 v124, v208, v209
  v_mfma_f32_16x16x32_bf16 v[196:199], v[244:247], v[172:175], v[196:199]
  ds_read_b128 v[244:247], v1 offset:4096
  s_barrier
  s_waitcnt lgkmcnt(8)
  v_mfma_f32_16x16x32_bf16 v[196:199], v[248:251], v[176:179], v[196:199]
  ds_read_b128 v[248:251], v1 offset:3072
  v_cvt_pk_bf16_f32 v125, v210, v211
  v_mfma_f32_16x16x32_bf16 v[196:199], v[252:255], v[180:183], v[196:199]
  ds_read_b128 v[252:255], v1 offset:2048
  v_mul_f32 v212, s93, v212
  v_mul_f32 v213, s93, v213
  v_mul_f32 v214, s93, v214
  v_mul_f32 v215, s93, v215
  v_cvt_pk_bf16_f32 v126, v212, v213
  v_cvt_pk_bf16_f32 v127, v214, v215
  s_waitcnt lgkmcnt(8)
  v_mfma_f32_16x16x32_bf16 v[208:211], v[216:219], v[160:163], 0
  ds_read_b128 v[216:219], v1 offset:1024
  v_mul_f32 v192, s93, v192
  v_mfma_f32_16x16x32_bf16 v[208:211], v[220:223], v[164:167], v[208:211]
  ds_read_b128 v[220:223], v1 offset:0
  s_waitcnt lgkmcnt(8)
  v_mfma_f32_16x16x32_bf16 v[208:211], v[224:227], v[168:171], v[208:211]
  v_mul_f32 v193, s93, v193
  v_mul_f32 v194, s93, v194
  v_mfma_f32_16x16x32_bf16 v[208:211], v[228:231], v[172:175], v[208:211]
  v_mul_f32 v195, s93, v195
  s_waitcnt lgkmcnt(6)
  v_mfma_f32_16x16x32_bf16 v[208:211], v[232:235], v[176:179], v[208:211]
  v_cvt_pk_bf16_f32 v128, v192, v193
  v_cvt_pk_bf16_f32 v129, v194, v195
  v_mfma_f32_16x16x32_bf16 v[208:211], v[236:239], v[180:183], v[208:211]
  v_mul_f32 v196, s93, v196
  s_waitcnt lgkmcnt(5)
  v_mfma_f32_16x16x32_bf16 v[212:215], v[240:243], v[160:163], 0
  v_mul_f32 v197, s93, v197
  s_waitcnt lgkmcnt(4)
  v_mfma_f32_16x16x32_bf16 v[212:215], v[244:247], v[164:167], v[212:215]
  v_mul_f32 v198, s93, v198
  s_waitcnt lgkmcnt(3)
  v_mfma_f32_16x16x32_bf16 v[212:215], v[248:251], v[168:171], v[212:215]
  v_mul_f32 v199, s93, v199
  s_waitcnt lgkmcnt(2)
  v_mfma_f32_16x16x32_bf16 v[212:215], v[252:255], v[172:175], v[212:215]
  v_cvt_pk_bf16_f32 v130, v196, v197
  s_waitcnt lgkmcnt(1)
  v_mfma_f32_16x16x32_bf16 v[212:215], v[216:219], v[176:179], v[212:215]
  v_cvt_pk_bf16_f32 v131, v198, v199
  s_waitcnt lgkmcnt(0)
  v_mfma_f32_16x16x32_bf16 v[212:215], v[220:223], v[180:183], v[212:215]
  v_mul_f32 v208, s93, v208
  s_setprio 0
  s_mul_i32 s100, s32, 7
  s_add_i32 s100, s100, s31
  s_add_u32 m0, s38, 107520
  s_nop 0
  buffer_load_dwordx4 v13, s[12:15], s100 offen lds
  s_add_u32 m0, s38, 108544
  s_nop 0
  buffer_load_dwordx4 v14, s[12:15], s100 offen lds
  s_add_u32 m0, s38, 109568
  s_nop 0
  buffer_load_dwordx4 v3, s[12:15], s100 offen lds
  s_add_u32 m0, s39, 107520
  s_nop 0
  buffer_load_dwordx4 v4, s[12:15], s100 offen lds
  s_mul_i32 s100, s32, 6
  s_add_i32 s100, s100, s31
  s_add_u32 m0, s38, 92160
  s_nop 0
  buffer_load_dwordx4 v13, s[12:15], s100 offen lds
  s_add_u32 m0, s38, 93184
  s_nop 0
  buffer_load_dwordx4 v14, s[12:15], s100 offen lds
  s_add_u32 m0, s38, 94208
  s_nop 0
  buffer_load_dwordx4 v3, s[12:15], s100 offen lds
  s_add_u32 m0, s39, 92160
  s_nop 0
  buffer_load_dwordx4 v4, s[12:15], s100 offen lds
  s_mul_i32 s100, s32, 5
  s_add_i32 s100, s100, s31
  s_add_u32 m0, s38, 76800
  s_nop 0
  buffer_load_dwordx4 v13, s[12:15], s100 offen lds
  s_add_u32 m0, s38, 77824
  s_nop 0
  buffer_load_dwordx4 v14, s[12:15], s100 offen lds
  s_add_u32 m0, s38, 78848
  s_nop 0
  buffer_load_dwordx4 v3, s[12:15], s100 offen lds
  s_add_u32 m0, s39, 76800
  s_nop 0
  buffer_load_dwordx4 v4, s[12:15], s100 offen lds
  s_barrier
  s_mul_i32 s100, s32, 4
  s_add_i32 s100, s100, s31
  s_add_u32 m0, s38, 61440
  s_nop 0
  buffer_load_dwordx4 v13, s[12:15], s100 offen lds
  s_add_u32 m0, s38, 62464
  s_nop 0
  buffer_load_dwordx4 v14, s[12:15], s100 offen lds
  s_add_u32 m0, s38, 63488
  s_nop 0
  buffer_load_dwordx4 v3, s[12:15], s100 offen lds
  s_add_u32 m0, s39, 61440
  s_nop 0
  buffer_load_dwordx4 v4, s[12:15], s100 offen lds
  s_mul_i32 s100, s32, 3
  s_add_i32 s100, s100, s31
  s_add_u32 m0, s38, 46080
  s_nop 0
  buffer_load_dwordx4 v13, s[12:15], s100 offen lds
  s_add_u32 m0, s38, 47104
  s_nop 0
  buffer_load_dwordx4 v14, s[12:15], s100 offen lds
  s_add_u32 m0, s38, 48128
  s_nop 0
  buffer_load_dwordx4 v3, s[12:15], s100 offen lds
  s_add_u32 m0, s39, 46080
  s_nop 0
  buffer_load_dwordx4 v4, s[12:15], s100 offen lds
  s_mul_i32 s100, s32, 2
  s_add_i32 s100, s100, s31
  s_add_u32 m0, s38, 30720
  s_nop 0
  buffer_load_dwordx4 v13, s[12:15], s100 offen lds
  s_add_u32 m0, s38, 31744
  s_nop 0
  buffer_load_dwordx4 v14, s[12:15], s100 offen lds
  s_add_u32 m0, s38, 32768
  s_nop 0
  buffer_load_dwordx4 v3, s[12:15], s100 offen lds
  s_add_u32 m0, s39, 30720
  s_nop 0
  buffer_load_dwordx4 v4, s[12:15], s100 offen lds
  s_waitcnt vmcnt(12)
  s_barrier
  s_max_u32 s100, s33, 1
  s_mul_i32 s100, s100, s32
  s_add_i32 s100, s100, s31
  s_add_u32 m0, s38, 15360
  s_nop 0
  buffer_load_dwordx4 v13, s[12:15], s100 offen lds
  s_add_u32 m0, s38, 16384
  s_nop 0
  buffer_load_dwordx4 v14, s[12:15], s100 offen lds
  s_add_u32 m0, s38, 17408
  s_nop 0
  buffer_load_dwordx4 v3, s[12:15], s100 offen lds
  s_add_u32 m0, s39, 15360
  s_nop 0
  buffer_load_dwordx4 v4, s[12:15], s100 offen lds
  s_max_u32 s100, s33, 0
  s_mul_i32 s100, s100, s32
  s_add_i32 s100, s100, s31
  s_add_u32 m0, s38, 0
  s_nop 0
  buffer_load_dwordx4 v13, s[12:15], s100 offen lds
  s_add_u32 m0, s38, 1024
  s_nop 0
  buffer_load_dwordx4 v14, s[12:15], s100 offen lds
  s_add_u32 m0, s38, 2048
  s_nop 0
  buffer_load_dwordx4 v3, s[12:15], s100 offen lds
  s_add_u32 m0, s39, 0
  s_nop 0
  buffer_load_dwordx4 v4, s[12:15], s100 offen lds
  s_waitcnt vmcnt(8)
  s_barrier
  ds_read_b128 v[224:227], v7 offset:61440
  ds_read_b128 v[228:231], v8 offset:61440
  ds_read_b128 v[232:235], v7 offset:61568
  ds_read_b128 v[236:239], v8 offset:61568
  ds_read_b128 v[240:243], v7 offset:61696
  ds_read_b128 v[244:247], v8 offset:61696
  ds_read_b128 v[248:251], v7 offset:53760
  ds_read_b128 v[252:255], v8 offset:53760
  ds_read_b128 v[216:219], v7 offset:53888
  ds_read_b128 v[220:223], v8 offset:53888
  s_waitcnt lgkmcnt(8)
  v_mfma_f32_16x16x32_bf16 v[84:87], v[224:227], v[112:115], v[84:87]
  ds_read_b128 v[224:227], v7 offset:54016
  v_mul_f32 v209, s93, v209
  v_mfma_f32_16x16x32_bf16 v[84:87], v[228:231], v[116:119], v[84:87]
  ds_read_b128 v[228:231], v8 offset:54016
  s_waitcnt lgkmcnt(8)
  v_mfma_f32_16x16x32_bf16 v[84:87], v[232:235], v[120:123], v[84:87]
  ds_read_b128 v[232:235], v7 offset:46080
  v_mul_f32 v210, s93, v210
  v_mfma_f32_16x16x32_bf16 v[84:87], v[236:239], v[124:127], v[84:87]
  ds_read_b128 v[236:239], v8 offset:46080
  s_waitcnt lgkmcnt(8)
  v_mfma_f32_16x16x32_bf16 v[84:87], v[240:243], v[128:131], v[84:87]
  ds_read_b128 v[240:243], v7 offset:46208
  v_mul_f32 v211, s93, v211
  v_cvt_pk_bf16_f32 v132, v208, v209
  v_cvt_pk_bf16_f32 v133, v210, v211
  v_mul_f32 v212, s93, v212
  v_mul_f32 v213, s93, v213
  v_mul_f32 v214, s93, v214
  v_mul_f32 v215, s93, v215
  v_cvt_pk_bf16_f32 v134, v212, v213
  v_cvt_pk_bf16_f32 v135, v214, v215
  s_nop 1
  v_mfma_f32_16x16x32_bf16 v[84:87], v[244:247], v[132:135], v[84:87]
  ds_read_b128 v[244:247], v8 offset:46208
  s_waitcnt lgkmcnt(8)
  v_mfma_f32_16x16x32_bf16 v[80:83], v[248:251], v[112:115], v[60:63]
  ds_read_b128 v[248:251], v7 offset:46336
  v_add_u32 v2, 102400, v1
  v_mfma_f32_16x16x32_bf16 v[80:83], v[252:255], v[116:119], v[80:83]
  ds_read_b128 v[252:255], v8 offset:46336
  s_waitcnt lgkmcnt(8)
  v_mfma_f32_16x16x32_bf16 v[80:83], v[216:219], v[120:123], v[80:83]
  v_exp_f32 v196, v84
  v_mfma_f32_16x16x32_bf16 v[80:83], v[220:223], v[124:127], v[80:83]
  ds_read_b128 v[216:219], v7 offset:38400
  s_waitcnt lgkmcnt(7)
  v_mfma_f32_16x16x32_bf16 v[80:83], v[224:227], v[128:131], v[80:83]
  v_exp_f32 v197, v85
  v_mfma_f32_16x16x32_bf16 v[80:83], v[228:231], v[132:135], v[80:83]
  ds_read_b128 v[220:223], v8 offset:38400
  s_waitcnt vmcnt(0)
  s_barrier
  ds_read_b128 v[224:227], v7 offset:38528
  ds_read_b128 v[228:231], v8 offset:38528
  s_waitcnt lgkmcnt(8)
  v_mfma_f32_16x16x32_bf16 v[76:79], v[232:235], v[112:115], v[60:63]
  v_exp_f32 v198, v86
  v_mfma_f32_16x16x32_bf16 v[76:79], v[236:239], v[116:119], v[76:79]
  ds_read_b128 v[232:235], v7 offset:38656
  s_waitcnt lgkmcnt(7)
  v_mfma_f32_16x16x32_bf16 v[76:79], v[240:243], v[120:123], v[76:79]
  v_exp_f32 v199, v87
  v_mfma_f32_16x16x32_bf16 v[76:79], v[244:247], v[124:127], v[76:79]
  ds_read_b128 v[236:239], v8 offset:38656
  s_waitcnt lgkmcnt(6)
  v_mfma_f32_16x16x32_bf16 v[76:79], v[248:251], v[128:131], v[76:79]
  v_exp_f32 v200, v80
  v_mfma_f32_16x16x32_bf16 v[76:79], v[252:255], v[132:135], v[76:79]
  ds_read_b128 v[240:243], v7 offset:30720
  s_waitcnt lgkmcnt(5)
  v_mfma_f32_16x16x32_bf16 v[72:75], v[216:219], v[112:115], v[60:63]
  v_exp_f32 v201, v81
  v_mfma_f32_16x16x32_bf16 v[72:75], v[220:223], v[116:119], v[72:75]
  ds_read_b128 v[244:247], v8 offset:30720
  s_waitcnt lgkmcnt(5)
  v_mfma_f32_16x16x32_bf16 v[72:75], v[224:227], v[120:123], v[72:75]
  ds_read_b128 v[248:251], v7 offset:30848
  s_waitcnt lgkmcnt(5)
  v_mfma_f32_16x16x32_bf16 v[72:75], v[228:231], v[124:127], v[72:75]
  ds_read_b128 v[252:255], v8 offset:30848
  s_waitcnt lgkmcnt(5)
  v_mfma_f32_16x16x32_bf16 v[72:75], v[232:235], v[128:131], v[72:75]
  ds_read_b128 v[216:219], v7 offset:30976
  s_waitcnt lgkmcnt(5)
  v_mfma_f32_16x16x32_bf16 v[72:75], v[236:239], v[132:135], v[72:75]
  ds_read_b128 v[220:223], v8 offset:30976
  s_waitcnt lgkmcnt(5)
  v_mfma_f32_16x16x32_bf16 v[68:71], v[240:243], v[112:115], v[60:63]
  ds_read_b128 v[224:227], v7 offset:23040
  v_mov_b32 v192, 0x3f803f80
  s_waitcnt lgkmcnt(5)
  v_mfma_f32_16x16x32_bf16 v[68:71], v[244:247], v[116:119], v[68:71]
  ds_read_b128 v[228:231], v8 offset:23040
  v_mov_b32 v193, 0x3f803f80
  s_waitcnt lgkmcnt(5)
  v_mfma_f32_16x16x32_bf16 v[68:71], v[248:251], v[120:123], v[68:71]
  ds_read_b128 v[232:235], v7 offset:23168
  v_mov_b32 v194, 0x3f803f80
  s_waitcnt lgkmcnt(5)
  v_mfma_f32_16x16x32_bf16 v[68:71], v[252:255], v[124:127], v[68:71]
  ds_read_b128 v[236:239], v8 offset:23168
  v_mov_b32 v195, 0x3f803f80
  s_waitcnt lgkmcnt(5)
  v_mfma_f32_16x16x32_bf16 v[68:71], v[216:219], v[128:131], v[68:71]
  ds_read_b128 v[240:243], v7 offset:23296
  v_cvt_pk_bf16_f32 v166, v196, v197
  s_waitcnt lgkmcnt(5)
  v_mfma_f32_16x16x32_bf16 v[68:71], v[220:223], v[132:135], v[68:71]
  ds_read_b128 v[244:247], v8 offset:23296
  v_cvt_pk_bf16_f32 v167, v198, v199
  v_and_b32 v14, 128, v1
  buffer_load_dword v13, v14, s[8:11], 0 offen
  s_waitcnt lgkmcnt(5)
  v_mfma_f32_16x16x32_bf16 v[64:67], v[224:227], v[112:115], v[60:63]
  ds_read_b128 v[248:251], v7 offset:15360
  v_cvt_pk_bf16_f32 v164, v200, v201
  s_waitcnt lgkmcnt(5)
  v_mfma_f32_16x16x32_bf16 v[64:67], v[228:231], v[116:119], v[64:67]
  ds_read_b128 v[252:255], v8 offset:15360
  v_exp_f32 v202, v82
  s_waitcnt lgkmcnt(5)
  v_mfma_f32_16x16x32_bf16 v[64:67], v[232:235], v[120:123], v[64:67]
  ds_read_b128 v[216:219], v7 offset:15488
  v_exp_f32 v203, v83
  s_waitcnt lgkmcnt(5)
  v_mfma_f32_16x16x32_bf16 v[64:67], v[236:239], v[124:127], v[64:67]
  ds_read_b128 v[220:223], v8 offset:15488
  v_cvt_pk_bf16_f32 v165, v202, v203
  s_waitcnt lgkmcnt(5)
  v_mfma_f32_16x16x32_bf16 v[64:67], v[240:243], v[128:131], v[64:67]
  ds_read_b128 v[224:227], v7 offset:15616
  v_exp_f32 v204, v76
  s_waitcnt lgkmcnt(5)
  v_mfma_f32_16x16x32_bf16 v[64:67], v[244:247], v[132:135], v[64:67]
  ds_read_b128 v[228:231], v8 offset:15616
  v_exp_f32 v205, v77
  s_waitcnt lgkmcnt(5)
  v_mfma_f32_16x16x32_bf16 v[60:63], v[248:251], v[112:115], v[60:63]
  ds_read_b128 v[232:235], v7 offset:7680
  v_cvt_pk_bf16_f32 v162, v204, v205
  s_waitcnt lgkmcnt(5)
  v_mfma_f32_16x16x32_bf16 v[60:63], v[252:255], v[116:119], v[60:63]
  ds_read_b128 v[236:239], v8 offset:7680
  v_exp_f32 v206, v78
  s_waitcnt lgkmcnt(5)
  v_mfma_f32_16x16x32_bf16 v[60:63], v[216:219], v[120:123], v[60:63]
  ds_read_b128 v[240:243], v7 offset:7808
  v_exp_f32 v207, v79
  s_waitcnt lgkmcnt(5)
  v_mfma_f32_16x16x32_bf16 v[60:63], v[220:223], v[124:127], v[60:63]
  ds_read_b128 v[244:247], v8 offset:7808
  v_cvt_pk_bf16_f32 v163, v206, v207
  s_waitcnt lgkmcnt(5)
  v_mfma_f32_16x16x32_bf16 v[60:63], v[224:227], v[128:131], v[60:63]
  ds_read_b128 v[248:251], v7 offset:7936
  v_exp_f32 v208, v72
  s_waitcnt lgkmcnt(5)
  v_mfma_f32_16x16x32_bf16 v[60:63], v[228:231], v[132:135], v[60:63]
  ds_read_b128 v[252:255], v8 offset:7936
  v_exp_f32 v209, v73
  s_mov_b32 s53, 0x40000
  s_mov_b32 s46, 72
NPOLL:
  s_waitcnt vmcnt(0)
  v_cmp_le_u32 s[48:49], s46, v13
  s_sub_u32 s53, s53, 1
  s_cbranch_scc1 NPOLLD
  s_cmp_eq_u64 s[48:49], -1
  s_cbranch_scc1 NPOLLD
  buffer_load_dword v13, v14, s[8:11], 0 offen sc1
  s_branch NPOLL
NPOLLD:
  s_add_u32 m0, s40, 0
  s_add_u32 s100, s40, 30720
  buffer_load_dwordx4 v1, s[20:23], s100 offen sc1 lds
  s_add_u32 m0, s40, 2048
  s_add_u32 s100, s40, 32768
  buffer_load_dwordx4 v1, s[20:23], s100 offen sc1 lds
  s_add_u32 m0, s40, 4096
  s_add_u32 s100, s40, 34816
  buffer_load_dwordx4 v1, s[20:23], s100 offen sc1 lds
  s_add_u32 m0, s40, 6144
  s_add_u32 s100, s40, 36864
  buffer_load_dwordx4 v1, s[20:23], s100 offen sc1 lds
  s_add_u32 m0, s40, 8192
  s_add_u32 s100, s40, 38912
  buffer_load_dwordx4 v1, s[20:23], s100 offen sc1 lds
  s_barrier
  s_add_u32 m0, s40, 133120
  s_add_u32 s100, s40, 0
  buffer_load_dwordx4 v1, s[20:23], s100 offen sc1 lds
  s_add_u32 m0, s40, 135168
  s_add_u32 s100, s40, 2048
  buffer_load_dwordx4 v1, s[20:23], s100 offen sc1 lds
  s_add_u32 m0, s40, 137216
  s_add_u32 s100, s40, 4096
  buffer_load_dwordx4 v1, s[20:23], s100 offen sc1 lds
  s_add_u32 m0, s40, 139264
  s_add_u32 s100, s40, 6144
  buffer_load_dwordx4 v1, s[20:23], s100 offen sc1 lds
  s_add_u32 m0, s40, 141312
  s_add_u32 s100, s40, 8192
  buffer_load_dwordx4 v1, s[20:23], s100 offen sc1 lds
  s_add_u32 m0, s40, 143360
  s_add_u32 s100, s40, 10240
  buffer_load_dwordx4 v1, s[20:23], s100 offen sc1 lds
  s_add_u32 m0, s40, 145408
  s_add_u32 s100, s40, 12288
  buffer_load_dwordx4 v1, s[20:23], s100 offen sc1 lds
  s_add_u32 m0, s40, 147456
  s_add_u32 s100, s40, 14336
  buffer_load_dwordx4 v1, s[20:23], s100 offen sc1 lds
  s_add_u32 m0, s40, 149504
  s_add_u32 s100, s40, 16384
  buffer_load_dwordx4 v1, s[20:23], s100 offen sc1 lds
  s_add_u32 m0, s40, 151552
  s_add_u32 s100, s40, 18432
  buffer_load_dwordx4 v1, s[20:23], s100 offen sc1 lds
  s_add_u32 m0, s40, 153600
  s_add_u32 s100, s40, 20480
  buffer_load_dwordx4 v1, s[20:23], s100 offen sc1 lds
  s_add_u32 m0, s40, 155648
  s_add_u32 s100, s40, 22528
  buffer_load_dwordx4 v1, s[20:23], s100 offen sc1 lds
  s_add_u32 m0, s40, 157696
  s_add_u32 s100, s40, 24576
  buffer_load_dwordx4 v1, s[20:23], s100 offen sc1 lds
  s_add_u32 m0, s40, 159744
  s_add_u32 s100, s40, 26624
  buffer_load_dwordx4 v1, s[20:23], s100 offen sc1 lds
  s_add_u32 m0, s40, 161792
  s_add_u32 s100, s40, 28672
  buffer_load_dwordx4 v1, s[20:23], s100 offen sc1 lds
  s_waitcnt lgkmcnt(5)
  v_mfma_f32_16x16x32_bf16 v[56:59], v[232:235], v[112:115], v[56:59]
  ds_read_b64_tr_b16 v[216:217], v9 offset:53760
  ds_read_b64_tr_b16 v[218:219], v9 offset:61440
  v_cvt_pk_bf16_f32 v160, v208, v209
  s_waitcnt lgkmcnt(5)
  v_mfma_f32_16x16x32_bf16 v[56:59], v[236:239], v[116:119], v[56:59]
  ds_read_b64_tr_b16 v[220:221], v10 offset:53760
  ds_read_b64_tr_b16 v[222:223], v10 offset:61440
  v_exp_f32 v210, v74
  v_mfma_f32_16x16x32_bf16 v[56:59], v[240:243], v[120:123], v[56:59]
  ds_read_b64_tr_b16 v[224:225], v11 offset:53760
  ds_read_b64_tr_b16 v[226:227], v11 offset:61440
  v_exp_f32 v211, v75
  s_waitcnt lgkmcnt(7)
  v_mfma_f32_16x16x32_bf16 v[56:59], v[244:247], v[124:127], v[56:59]
  ds_read_b64_tr_b16 v[228:229], v12 offset:53760
  ds_read_b64_tr_b16 v[230:231], v12 offset:61440
  v_cvt_pk_bf16_f32 v161, v210, v211
  v_mfma_f32_16x16x32_bf16 v[56:59], v[248:251], v[128:131], v[56:59]
  ds_read_b64_tr_b16 v[232:233], v9 offset:53888
  ds_read_b64_tr_b16 v[234:235], v9 offset:61568
  v_exp_f32 v212, v68
  s_waitcnt lgkmcnt(8)
  v_mfma_f32_16x16x32_bf16 v[56:59], v[252:255], v[132:135], v[56:59]
  ds_read_b64_tr_b16 v[236:237], v10 offset:53888
  ds_read_b64_tr_b16 v[238:239], v10 offset:61568
  v_exp_f32 v213, v69
  s_waitcnt vmcnt(0)
  s_barrier
  s_add_u32 m0, s40, 102400
  s_add_u32 s100, s40, 40960
  buffer_load_dwordx4 v1, s[20:23], s100 offen sc1 lds
  s_add_u32 m0, s40, 104448
  s_add_u32 s100, s40, 43008
  buffer_load_dwordx4 v1, s[20:23], s100 offen sc1 lds
  s_add_u32 m0, s40, 106496
  s_add_u32 s100, s40, 45056
  buffer_load_dwordx4 v1, s[20:23], s100 offen sc1 lds
  s_add_u32 m0, s40, 108544
  s_add_u32 s100, s40, 47104
  buffer_load_dwordx4 v1, s[20:23], s100 offen sc1 lds
  s_add_u32 m0, s40, 110592
  s_add_u32 s100, s40, 49152
  buffer_load_dwordx4 v1, s[20:23], s100 offen sc1 lds
  s_add_u32 m0, s40, 112640
  s_add_u32 s100, s40, 51200
  buffer_load_dwordx4 v1, s[20:23], s100 offen sc1 lds
  s_add_u32 m0, s40, 114688
  s_add_u32 s100, s40, 53248
  buffer_load_dwordx4 v1, s[20:23], s100 offen sc1 lds
  s_add_u32 m0, s40, 116736
  s_add_u32 s100, s40, 55296
  buffer_load_dwordx4 v1, s[20:23], s100 offen sc1 lds
  s_add_u32 m0, s40, 118784
  s_add_u32 s100, s40, 57344
  buffer_load_dwordx4 v1, s[20:23], s100 offen sc1 lds
  s_add_u32 m0, s40, 120832
  s_add_u32 s100, s40, 59392
  buffer_load_dwordx4 v1, s[20:23], s100 offen sc1 lds
  s_add_u32 m0, s40, 122880
  s_add_u32 s100, s40, 61440
  buffer_load_dwordx4 v1, s[20:23], s100 offen sc1 lds
  s_add_u32 m0, s40, 124928
  s_add_u32 s100, s40, 63488
  buffer_load_dwordx4 v1, s[20:23], s100 offen sc1 lds
  s_add_u32 m0, s40, 126976
  s_add_u32 s100, s40, 65536
  buffer_load_dwordx4 v1, s[20:23], s100 offen sc1 lds
  s_add_u32 m0, s40, 129024
  s_add_u32 s100, s40, 67584
  buffer_load_dwordx4 v1, s[20:23], s100 offen sc1 lds
  s_add_u32 m0, s40, 131072
  s_add_u32 s100, s40, 69632
  buffer_load_dwordx4 v1, s[20:23], s100 offen sc1 lds
  s_waitcnt vmcnt(0)
  s_barrier
  v_exp_f32 v214, v70
  v_exp_f32 v215, v71
  v_cvt_pk_bf16_f32 v158, v212, v213
  v_cvt_pk_bf16_f32 v159, v214, v215
  v_exp_f32 v196, v64
  v_exp_f32 v197, v65
  v_exp_f32 v198, v66
  v_exp_f32 v199, v67
  v_cvt_pk_bf16_f32 v156, v196, v197
  v_cvt_pk_bf16_f32 v157, v198, v199
  v_exp_f32 v200, v60
  v_exp_f32 v201, v61
  v_exp_f32 v202, v62
  v_exp_f32 v203, v63
  v_cvt_pk_bf16_f32 v154, v200, v201
  v_cvt_pk_bf16_f32 v155, v202, v203
  v_exp_f32 v204, v56
  v_exp_f32 v205, v57
  v_exp_f32 v206, v58
  v_exp_f32 v207, v59
  v_cvt_pk_bf16_f32 v152, v204, v205
  v_cvt_pk_bf16_f32 v153, v206, v207
  v_mfma_f32_16x16x32_bf16 v[188:191], v[192:195], v[164:167], 0
  ds_read_b64_tr_b16 v[240:241], v11 offset:53888
  ds_read_b64_tr_b16 v[242:243], v11 offset:61568
  v_mfma_f32_16x16x32_bf16 v[188:191], v[192:195], v[160:163], v[188:191]
  ds_read_b64_tr_b16 v[244:245], v12 offset:53888
  ds_read_b64_tr_b16 v[246:247], v12 offset:61568
  v_mfma_f32_16x16x32_bf16 v[188:191], v[192:195], v[156:159], v[188:191]
  v_mfma_f32_16x16x32_bf16 v[188:191], v[192:195], v[152:155], v[188:191]
  s_nop 7
  v_subrev_u32 v23, 813694976, v188
  s_mov_b32 s52, 503316480
  v_cmp_gt_u32 s[48:49], s52, v23
  s_or_b64 s[48:49], s[48:49], s[44:45]
  s_cmp_eq_u64 s[48:49], -1
  s_cbranch_scc0 FB1s
FBR1s:
  v_mfma_f32_16x16x32_bf16 v[88:91], v[216:219], v[164:167], 0
  s_waitcnt lgkmcnt(10)
  v_mfma_f32_16x16x32_bf16 v[92:95], v[220:223], v[164:167], 0
  ds_read_b64_tr_b16 v[248:249], v9 offset:54016
  ds_read_b64_tr_b16 v[250:251], v9 offset:61696
  v_mfma_f32_16x16x32_bf16 v[96:99], v[224:227], v[164:167], 0
  ds_read_b64_tr_b16 v[252:253], v10 offset:54016
  ds_read_b64_tr_b16 v[254:255], v10 offset:61696
  s_waitcnt lgkmcnt(10)
  v_mfma_f32_16x16x32_bf16 v[100:103], v[228:231], v[164:167], 0
  ds_read_b64_tr_b16 v[216:217], v11 offset:54016
  ds_read_b64_tr_b16 v[218:219], v11 offset:61696
  v_mfma_f32_16x16x32_bf16 v[104:107], v[232:235], v[164:167], 0
  ds_read_b64_tr_b16 v[220:221], v12 offset:54016
  ds_read_b64_tr_b16 v[222:223], v12 offset:61696
  s_waitcnt lgkmcnt(10)
  v_mfma_f32_16x16x32_bf16 v[108:111], v[236:239], v[164:167], 0
  ds_read_b64_tr_b16 v[224:225], v9 offset:38400
  ds_read_b64_tr_b16 v[226:227], v9 offset:46080
  v_mfma_f32_16x16x32_bf16 v[112:115], v[240:243], v[164:167], 0
  ds_read_b64_tr_b16 v[228:229], v10 offset:38400
  ds_read_b64_tr_b16 v[230:231], v10 offset:46080
  s_waitcnt lgkmcnt(10)
  v_mfma_f32_16x16x32_bf16 v[116:119], v[244:247], v[164:167], 0
  ds_read_b64_tr_b16 v[232:233], v11 offset:38400
  ds_read_b64_tr_b16 v[234:235], v11 offset:46080
  v_mfma_f32_16x16x32_bf16 v[120:123], v[248:251], v[164:167], 0
  ds_read_b64_tr_b16 v[236:237], v12 offset:38400
  ds_read_b64_tr_b16 v[238:239], v12 offset:46080
  s_waitcnt lgkmcnt(10)
  v_mfma_f32_16x16x32_bf16 v[124:127], v[252:255], v[164:167], 0
  ds_read_b64_tr_b16 v[240:241], v9 offset:38528
  ds_read_b64_tr_b16 v[242:243], v9 offset:46208
  v_mfma_f32_16x16x32_bf16 v[128:131], v[216:219], v[164:167], 0
  ds_read_b64_tr_b16 v[244:245], v10 offset:38528
  ds_read_b64_tr_b16 v[246:247], v10 offset:46208
  s_waitcnt lgkmcnt(10)
  v_mfma_f32_16x16x32_bf16 v[132:135], v[220:223], v[164:167], 0
  ds_read_b64_tr_b16 v[248:249], v11 offset:38528
  ds_read_b64_tr_b16 v[250:251], v11 offset:46208
  v_mfma_f32_16x16x32_bf16 v[88:91], v[224:227], v[160:163], v[88:91]
  ds_read_b64_tr_b16 v[252:253], v12 offset:38528
  ds_read_b64_tr_b16 v[254:255], v12 offset:46208
  s_waitcnt lgkmcnt(10)
  v_mfma_f32_16x16x32_bf16 v[92:95], v[228:231], v[160:163], v[92:95]
  v_rcp_f32 v23, v188
  v_mfma_f32_16x16x32_bf16 v[96:99], v[232:235], v[160:163], v[96:99]
  ds_read_b64_tr_b16 v[216:217], v9 offset:38656
  ds_read_b64_tr_b16 v[218:219], v9 offset:46336
  s_waitcnt lgkmcnt(8)
  v_mfma_f32_16x16x32_bf16 v[100:103], v[236:239], v[160:163], v[100:103]
  ds_read_b64_tr_b16 v[220:221], v10 offset:38656
  ds_read_b64_tr_b16 v[222:223], v10 offset:46336
  v_mfma_f32_16x16x32_bf16 v[104:107], v[240:243], v[160:163], v[104:107]
  ds_read_b64_tr_b16 v[224:225], v11 offset:38656
  ds_read_b64_tr_b16 v[226:227], v11 offset:46336
  s_waitcnt lgkmcnt(8)
  v_mfma_f32_16x16x32_bf16 v[108:111], v[244:247], v[160:163], v[108:111]
  ds_read_b64_tr_b16 v[228:229], v12 offset:38656
  ds_read_b64_tr_b16 v[230:231], v12 offset:46336
  v_mfma_f32_16x16x32_bf16 v[112:115], v[248:251], v[160:163], v[112:115]
  ds_read_b64_tr_b16 v[232:233], v9 offset:23040
  ds_read_b64_tr_b16 v[234:235], v9 offset:30720
  s_waitcnt lgkmcnt(8)
  v_mfma_f32_16x16x32_bf16 v[116:119], v[252:255], v[160:163], v[116:119]
  ds_read_b64_tr_b16 v[236:237], v10 offset:23040
  ds_read_b64_tr_b16 v[238:239], v10 offset:30720
  v_mfma_f32_16x16x32_bf16 v[120:123], v[216:219], v[160:163], v[120:123]
  ds_read_b64_tr_b16 v[240:241], v11 offset:23040
  ds_read_b64_tr_b16 v[242:243], v11 offset:30720
  s_waitcnt lgkmcnt(8)
  v_mfma_f32_16x16x32_bf16 v[124:127], v[220:223], v[160:163], v[124:127]
  ds_read_b64_tr_b16 v[244:245], v12 offset:23040
  ds_read_b64_tr_b16 v[246:247], v12 offset:30720
  v_mfma_f32_16x16x32_bf16 v[128:131], v[224:227], v[160:163], v[128:131]
  ds_read_b64_tr_b16 v[248:249], v9 offset:23168
  ds_read_b64_tr_b16 v[250:251], v9 offset:30848
  s_waitcnt lgkmcnt(8)
  v_mfma_f32_16x16x32_bf16 v[132:135], v[228:231], v[160:163], v[132:135]
  ds_read_b64_tr_b16 v[252:253], v10 offset:23168
  ds_read_b64_tr_b16 v[254:255], v10 offset:30848
  v_mfma_f32_16x16x32_bf16 v[88:91], v[232:235], v[156:159], v[88:91]
  ds_read_b64_tr_b16 v[216:217], v11 offset:23168
  ds_read_b64_tr_b16 v[218:219], v11 offset:30848
  s_waitcnt lgkmcnt(8)
  v_mfma_f32_16x16x32_bf16 v[92:95], v[236:239], v[156:159], v[92:95]
  ds_read_b64_tr_b16 v[220:221], v12 offset:23168
  ds_read_b64_tr_b16 v[222:223], v12 offset:30848
  v_mfma_f32_16x16x32_bf16 v[96:99], v[240:243], v[156:159], v[96:99]
  ds_read_b64_tr_b16 v[224:225], v9 offset:23296
  ds_read_b64_tr_b16 v[226:227], v9 offset:30976
  s_waitcnt lgkmcnt(8)
  v_mfma_f32_16x16x32_bf16 v[100:103], v[244:247], v[156:159], v[100:103]
  ds_read_b64_tr_b16 v[228:229], v10 offset:23296
  ds_read_b64_tr_b16 v[230:231], v10 offset:30976
  v_mfma_f32_16x16x32_bf16 v[104:107], v[248:251], v[156:159], v[104:107]
  ds_read_b64_tr_b16 v[232:233], v11 offset:23296
  ds_read_b64_tr_b16 v[234:235], v11 offset:30976
  s_waitcnt lgkmcnt(8)
  v_mfma_f32_16x16x32_bf16 v[108:111], v[252:255], v[156:159], v[108:111]
  ds_read_b64_tr_b16 v[236:237], v12 offset:23296
  ds_read_b64_tr_b16 v[238:239], v12 offset:30976
  v_mfma_f32_16x16x32_bf16 v[112:115], v[216:219], v[156:159], v[112:115]
  ds_read_b64_tr_b16 v[240:241], v9 offset:7680
  ds_read_b64_tr_b16 v[242:243], v9 offset:15360
  s_waitcnt lgkmcnt(8)
  v_mfma_f32_16x16x32_bf16 v[116:119], v[220:223], v[156:159], v[116:119]
  ds_read_b64_tr_b16 v[244:245], v10 offset:7680
  ds_read_b64_tr_b16 v[246:247], v10 offset:15360
  v_mfma_f32_16x16x32_bf16 v[120:123], v[224:227], v[156:159], v[120:123]
  ds_read_b64_tr_b16 v[248:249], v11 offset:7680
  ds_read_b64_tr_b16 v[250:251], v11 offset:15360
  s_waitcnt lgkmcnt(8)
  v_mfma_f32_16x16x32_bf16 v[124:127], v[228:231], v[156:159], v[124:127]
  ds_read_b64_tr_b16 v[252:253], v12 offset:7680
  ds_read_b64_tr_b16 v[254:255], v12 offset:15360
  v_mfma_f32_16x16x32_bf16 v[128:131], v[232:235], v[156:159], v[128:131]
  ds_read_b64_tr_b16 v[216:217], v9 offset:7808
  ds_read_b64_tr_b16 v[218:219], v9 offset:15488
  s_waitcnt lgkmcnt(8)
  v_mfma_f32_16x16x32_bf16 v[132:135], v[236:239], v[156:159], v[132:135]
  ds_read_b64_tr_b16 v[220:221], v10 offset:7808
  ds_read_b64_tr_b16 v[222:223], v10 offset:15488
  v_mfma_f32_16x16x32_bf16 v[88:91], v[240:243], v[152:155], v[88:91]
  ds_read_b64_tr_b16 v[224:225], v11 offset:7808
  ds_read_b64_tr_b16 v[226:227], v11 offset:15488
  s_waitcnt lgkmcnt(8)
  v_mfma_f32_16x16x32_bf16 v[92:95], v[244:247], v[152:155], v[92:95]
  ds_read_b64_tr_b16 v[228:229], v12 offset:7808
  ds_read_b64_tr_b16 v[230:231], v12 offset:15488
  v_mfma_f32_16x16x32_bf16 v[96:99], v[248:251], v[152:155], v[96:99]
  ds_read_b64_tr_b16 v[232:233], v9 offset:7936
  ds_read_b64_tr_b16 v[234:235], v9 offset:15616
  s_waitcnt lgkmcnt(8)
  v_mfma_f32_16x16x32_bf16 v[100:103], v[252:255], v[152:155], v[100:103]
  ds_read_b64_tr_b16 v[236:237], v10 offset:7936
  ds_read_b64_tr_b16 v[238:239], v10 offset:15616
  v_mfma_f32_16x16x32_bf16 v[104:107], v[216:219], v[152:155], v[104:107]
  ds_read_b64_tr_b16 v[240:241], v11 offset:7936
  ds_read_b64_tr_b16 v[242:243], v11 offset:15616
  s_waitcnt lgkmcnt(8)
  v_mfma_f32_16x16x32_bf16 v[108:111], v[220:223], v[152:155], v[108:111]
  ds_read_b64_tr_b16 v[244:245], v12 offset:7936
  ds_read_b64_tr_b16 v[246:247], v12 offset:15616
  v_mfma_f32_16x16x32_bf16 v[112:115], v[224:227], v[152:155], v[112:115]
  v_cvt_pk_bf16_f32 v156, v88, v89
  s_waitcnt lgkmcnt(6)
  v_mfma_f32_16x16x32_bf16 v[116:119], v[228:231], v[152:155], v[116:119]
  v_cvt_pk_bf16_f32 v157, v90, v91
  v_cvt_pk_bf16_f32 v158, v92, v93
  v_mfma_f32_16x16x32_bf16 v[120:123], v[232:235], v[152:155], v[120:123]
  v_cvt_pk_bf16_f32 v159, v94, v95
  s_waitcnt lgkmcnt(4)
  v_mfma_f32_16x16x32_bf16 v[124:127], v[236:239], v[152:155], v[124:127]
  v_cvt_pk_bf16_f32 v160, v96, v97
  s_waitcnt lgkmcnt(2)
  v_mfma_f32_16x16x32_bf16 v[128:131], v[240:243], v[152:155], v[128:131]
  v_cvt_pk_bf16_f32 v161, v98, v99
  s_waitcnt lgkmcnt(0)
  v_mfma_f32_16x16x32_bf16 v[132:135], v[244:247], v[152:155], v[132:135]
  v_cvt_pk_bf16_f32 v162, v100, v101
  ds_read_b128 v[248:251], v2 offset:30720
  ds_read_b128 v[252:255], v2 offset:31744
  ds_read_b128 v[216:219], v2 offset:32768
  ds_read_b128 v[220:223], v2 offset:33792
  ds_read_b128 v[224:227], v2 offset:34816
  ds_read_b128 v[228:231], v2 offset:35840
  ds_read_b128 v[232:235], v2 offset:36864
  ds_read_b128 v[236:239], v2 offset:37888
  ds_read_b128 v[240:243], v2 offset:38912
  ds_read_b128 v[244:247], v2 offset:39936
  s_waitcnt lgkmcnt(8)
  v_mfma_f32_16x16x32_bf16 v[192:195], v[248:251], v[156:159], 0
  ds_read_b128 v[248:251], v2 offset:40960
  v_cvt_pk_bf16_f32 v163, v102, v103
  s_nop 1
  v_mfma_f32_16x16x32_bf16 v[192:195], v[252:255], v[160:163], v[192:195]
  ds_read_b128 v[252:255], v2 offset:41984
  v_cvt_pk_bf16_f32 v164, v104, v105
  v_cvt_pk_bf16_f32 v165, v106, v107
  v_cvt_pk_bf16_f32 v166, v108, v109
  v_cvt_pk_bf16_f32 v167, v110, v111
  s_waitcnt lgkmcnt(8)
  s_nop 0
  v_mfma_f32_16x16x32_bf16 v[192:195], v[216:219], v[164:167], v[192:195]
  ds_read_b128 v[216:219], v2 offset:43008
  v_cvt_pk_bf16_f32 v176, v112, v113
  v_cvt_pk_bf16_f32 v177, v114, v115
  v_cvt_pk_bf16_f32 v178, v116, v117
  v_cvt_pk_bf16_f32 v179, v118, v119
  s_nop 1
  v_mfma_f32_16x16x32_bf16 v[192:195], v[220:223], v[176:179], v[192:195]
  ds_read_b128 v[220:223], v2 offset:44032
  v_cvt_pk_bf16_f32 v180, v120, v121
  v_cvt_pk_bf16_f32 v181, v122, v123
  v_cvt_pk_bf16_f32 v182, v124, v125
  v_cvt_pk_bf16_f32 v183, v126, v127
  s_waitcnt lgkmcnt(8)
  s_nop 0
  v_mfma_f32_16x16x32_bf16 v[192:195], v[224:227], v[180:183], v[192:195]
  ds_read_b128 v[224:227], v2 offset:45056
  v_cvt_pk_bf16_f32 v72, v128, v129
  v_cvt_pk_bf16_f32 v73, v130, v131
  v_cvt_pk_bf16_f32 v74, v132, v133
  v_cvt_pk_bf16_f32 v75, v134, v135
  s_nop 1
  v_mfma_f32_16x16x32_bf16 v[192:195], v[228:231], v[72:75], v[192:195]
  ds_read_b128 v[228:231], v2 offset:46080
  s_waitcnt lgkmcnt(8)
  v_mfma_f32_16x16x32_bf16 v[196:199], v[232:235], v[156:159], 0
  ds_read_b128 v[232:235], v2 offset:47104
  v_mfma_f32_16x16x32_bf16 v[196:199], v[236:239], v[160:163], v[196:199]
  ds_read_b128 v[236:239], v2 offset:48128
  s_waitcnt lgkmcnt(8)
  v_mfma_f32_16x16x32_bf16 v[196:199], v[240:243], v[164:167], v[196:199]
  ds_read_b128 v[240:243], v2 offset:49152
  v_mul_f32 v192, v192, v23
  v_mfma_f32_16x16x32_bf16 v[196:199], v[244:247], v[176:179], v[196:199]
  ds_read_b128 v[244:247], v2 offset:50176
  s_waitcnt lgkmcnt(8)
  v_mfma_f32_16x16x32_bf16 v[196:199], v[248:251], v[180:183], v[196:199]
  ds_read_b128 v[248:251], v2 offset:51200
  v_mul_f32 v193, v193, v23
  v_mfma_f32_16x16x32_bf16 v[196:199], v[252:255], v[72:75], v[196:199]
  ds_read_b128 v[252:255], v2 offset:52224
  s_mov_b32 s100, 71680
  buffer_load_dwordx4 v[40:43], v1, s[20:23], s100 offen offset:0 sc1
  buffer_load_dwordx4 v[44:47], v1, s[20:23], s100 offen offset:1024 sc1
  s_waitcnt lgkmcnt(8)
  v_mfma_f32_16x16x32_bf16 v[208:211], v[216:219], v[156:159], 0
  ds_read_b128 v[216:219], v2 offset:53248
  v_mul_f32 v194, v194, v23
  v_mfma_f32_16x16x32_bf16 v[208:211], v[220:223], v[160:163], v[208:211]
  ds_read_b128 v[220:223], v2 offset:54272
  s_waitcnt lgkmcnt(8)
  v_mfma_f32_16x16x32_bf16 v[208:211], v[224:227], v[164:167], v[208:211]
  ds_read_b128 v[224:227], v2 offset:55296
  v_mul_f32 v195, v195, v23
  v_mfma_f32_16x16x32_bf16 v[208:211], v[228:231], v[176:179], v[208:211]
  ds_read_b128 v[228:231], v2 offset:56320
  s_waitcnt lgkmcnt(8)
  v_mfma_f32_16x16x32_bf16 v[208:211], v[232:235], v[180:183], v[208:211]
  ds_read_b128 v[232:235], v2 offset:57344
  v_cvt_pk_bf16_f32 v28, v192, v193
  v_mfma_f32_16x16x32_bf16 v[208:211], v[236:239], v[72:75], v[208:211]
  ds_read_b128 v[236:239], v2 offset:58368
  s_waitcnt lgkmcnt(8)
  v_mfma_f32_16x16x32_bf16 v[212:215], v[240:243], v[156:159], 0
  ds_read_b128 v[240:243], v2 offset:59392
  v_cvt_pk_bf16_f32 v29, v194, v195
  v_mfma_f32_16x16x32_bf16 v[212:215], v[244:247], v[160:163], v[212:215]
  ds_read_b128 v[244:247], v2 offset:60416
  s_waitcnt lgkmcnt(8)
  v_mfma_f32_16x16x32_bf16 v[212:215], v[248:251], v[164:167], v[212:215]
  ds_read_b128 v[248:251], v1 offset:0
  v_mul_f32 v196, v196, v23
  v_mfma_f32_16x16x32_bf16 v[212:215], v[252:255], v[176:179], v[212:215]
  ds_read_b128 v[252:255], v1 offset:1024
  s_waitcnt lgkmcnt(8)
  v_mfma_f32_16x16x32_bf16 v[212:215], v[216:219], v[180:183], v[212:215]
  ds_read_b128 v[216:219], v1 offset:2048
  v_mul_f32 v197, v197, v23
  v_mfma_f32_16x16x32_bf16 v[212:215], v[220:223], v[72:75], v[212:215]
  ds_read_b128 v[220:223], v1 offset:3072
  v_mul_f32 v198, v198, v23
  v_mul_f32 v199, v199, v23
  v_cvt_pk_bf16_f32 v30, v196, v197
  v_cvt_pk_bf16_f32 v31, v198, v199
  buffer_store_dwordx4 v[28:31], v6, s[16:19], 0 offen offset:0 nt sc1
  s_waitcnt lgkmcnt(8)
  v_mfma_f32_16x16x32_bf16 v[192:195], v[224:227], v[156:159], 0
  ds_read_b128 v[224:227], v1 offset:4096
  v_mul_f32 v208, v208, v23
  v_mfma_f32_16x16x32_bf16 v[192:195], v[228:231], v[160:163], v[192:195]
  ds_read_b128 v[228:231], v1 offset:5120
  s_waitcnt lgkmcnt(8)
  v_mfma_f32_16x16x32_bf16 v[192:195], v[232:235], v[164:167], v[192:195]
  ds_read_b128 v[232:235], v1 offset:6144
  v_mul_f32 v209, v209, v23
  v_mfma_f32_16x16x32_bf16 v[192:195], v[236:239], v[176:179], v[192:195]
  ds_read_b128 v[236:239], v1 offset:7168
  s_waitcnt lgkmcnt(8)
  v_mfma_f32_16x16x32_bf16 v[192:195], v[240:243], v[180:183], v[192:195]
  ds_read_b128 v[240:243], v1 offset:8192
  v_mul_f32 v210, v210, v23
  v_mfma_f32_16x16x32_bf16 v[192:195], v[244:247], v[72:75], v[192:195]
  ds_read_b128 v[244:247], v1 offset:9216
  s_waitcnt lgkmcnt(8)
  v_mfma_f32_16x16x32_bf16 v[196:199], v[248:251], v[156:159], 0
  ds_read_b128 v[248:251], v2 offset:0
  v_mul_f32 v211, v211, v23
  v_mfma_f32_16x16x32_bf16 v[196:199], v[252:255], v[160:163], v[196:199]
  ds_read_b128 v[252:255], v2 offset:1024
  s_waitcnt lgkmcnt(8)
  v_mfma_f32_16x16x32_bf16 v[196:199], v[216:219], v[164:167], v[196:199]
  ds_read_b128 v[216:219], v2 offset:2048
  v_cvt_pk_bf16_f32 v36, v208, v209
  v_mfma_f32_16x16x32_bf16 v[196:199], v[220:223], v[176:179], v[196:199]
  ds_read_b128 v[220:223], v2 offset:3072
  s_waitcnt lgkmcnt(8)
  v_mfma_f32_16x16x32_bf16 v[196:199], v[224:227], v[180:183], v[196:199]
  ds_read_b128 v[224:227], v2 offset:4096
  v_cvt_pk_bf16_f32 v37, v210, v211
  v_mfma_f32_16x16x32_bf16 v[196:199], v[228:231], v[72:75], v[196:199]
  ds_read_b128 v[228:231], v2 offset:5120
  v_mul_f32 v212, v212, v23
  v_mul_f32 v213, v213, v23
  v_mul_f32 v214, v214, v23
  v_mul_f32 v215, v215, v23
  v_cvt_pk_bf16_f32 v38, v212, v213
  v_cvt_pk_bf16_f32 v39, v214, v215
  buffer_store_dwordx4 v[36:39], v6, s[16:19], 0 offen offset:64 nt sc1
  s_waitcnt lgkmcnt(8)
  v_mfma_f32_16x16x32_bf16 v[208:211], v[232:235], v[156:159], 0
  ds_read_b128 v[232:235], v2 offset:6144
  v_mul_f32 v192, v192, v23
  v_mfma_f32_16x16x32_bf16 v[208:211], v[236:239], v[160:163], v[208:211]
  ds_read_b128 v[236:239], v2 offset:7168
  s_waitcnt lgkmcnt(8)
  v_mfma_f32_16x16x32_bf16 v[208:211], v[240:243], v[164:167], v[208:211]
  ds_read_b128 v[240:243], v2 offset:8192
  v_mul_f32 v193, v193, v23
  v_mfma_f32_16x16x32_bf16 v[208:211], v[244:247], v[176:179], v[208:211]
  ds_read_b128 v[244:247], v2 offset:9216
  s_waitcnt lgkmcnt(8)
  v_mfma_f32_16x16x32_bf16 v[208:211], v[248:251], v[180:183], v[208:211]
  ds_read_b128 v[248:251], v2 offset:10240
  v_mul_f32 v194, v194, v23
  v_mfma_f32_16x16x32_bf16 v[208:211], v[252:255], v[72:75], v[208:211]
  ds_read_b128 v[252:255], v2 offset:11264
  s_waitcnt lgkmcnt(8)
  v_mfma_f32_16x16x32_bf16 v[212:215], v[216:219], v[156:159], 0
  ds_read_b128 v[216:219], v2 offset:12288
  v_mul_f32 v195, v195, v23
  v_mfma_f32_16x16x32_bf16 v[212:215], v[220:223], v[160:163], v[212:215]
  ds_read_b128 v[220:223], v2 offset:13312
  s_waitcnt lgkmcnt(8)
  v_mfma_f32_16x16x32_bf16 v[212:215], v[224:227], v[164:167], v[212:215]
  ds_read_b128 v[224:227], v2 offset:14336
  v_cvt_pk_bf16_f32 v28, v192, v193
  v_mfma_f32_16x16x32_bf16 v[212:215], v[228:231], v[176:179], v[212:215]
  ds_read_b128 v[228:231], v2 offset:15360
  s_waitcnt lgkmcnt(8)
  v_mfma_f32_16x16x32_bf16 v[212:215], v[232:235], v[180:183], v[212:215]
  ds_read_b128 v[232:235], v2 offset:16384
  v_cvt_pk_bf16_f32 v29, v194, v195
  v_mfma_f32_16x16x32_bf16 v[212:215], v[236:239], v[72:75], v[212:215]
  ds_read_b128 v[236:239], v2 offset:17408
  v_mul_f32 v196, v196, v23
  v_mul_f32 v197, v197, v23
  v_mul_f32 v198, v198, v23
  v_mul_f32 v199, v199, v23
  v_cvt_pk_bf16_f32 v30, v196, v197
  v_cvt_pk_bf16_f32 v31, v198, v199
  buffer_store_dwordx4 v[28:31], v6, s[16:19], 0 offen offset:128 nt sc1
  s_waitcnt lgkmcnt(8)
  v_mfma_f32_16x16x32_bf16 v[192:195], v[240:243], v[156:159], 0
  ds_read_b128 v[240:243], v2 offset:18432
  v_mul_f32 v208, v208, v23
  v_mfma_f32_16x16x32_bf16 v[192:195], v[244:247], v[160:163], v[192:195]
  ds_read_b128 v[244:247], v2 offset:19456
  s_waitcnt lgkmcnt(8)
  v_mfma_f32_16x16x32_bf16 v[192:195], v[248:251], v[164:167], v[192:195]
  ds_read_b128 v[248:251], v2 offset:20480
  v_mul_f32 v209, v209, v23
  v_mfma_f32_16x16x32_bf16 v[192:195], v[252:255], v[176:179], v[192:195]
  ds_read_b128 v[252:255], v2 offset:21504
  s_waitcnt lgkmcnt(8)
  v_mfma_f32_16x16x32_bf16 v[192:195], v[216:219], v[180:183], v[192:195]
  ds_read_b128 v[216:219], v2 offset:22528
  v_mul_f32 v210, v210, v23
  v_mfma_f32_16x16x32_bf16 v[192:195], v[220:223], v[72:75], v[192:195]
  ds_read_b128 v[220:223], v2 offset:23552
  s_waitcnt lgkmcnt(8)
  v_mfma_f32_16x16x32_bf16 v[196:199], v[224:227], v[156:159], 0
  ds_read_b128 v[224:227], v2 offset:24576
  v_mul_f32 v211, v211, v23
  v_mfma_f32_16x16x32_bf16 v[196:199], v[228:231], v[160:163], v[196:199]
  ds_read_b128 v[228:231], v2 offset:25600
  s_waitcnt lgkmcnt(8)
  v_mfma_f32_16x16x32_bf16 v[196:199], v[232:235], v[164:167], v[196:199]
  ds_read_b128 v[232:235], v2 offset:26624
  v_cvt_pk_bf16_f32 v36, v208, v209
  v_mfma_f32_16x16x32_bf16 v[196:199], v[236:239], v[176:179], v[196:199]
  ds_read_b128 v[236:239], v2 offset:27648
  s_waitcnt lgkmcnt(8)
  v_mfma_f32_16x16x32_bf16 v[196:199], v[240:243], v[180:183], v[196:199]
  ds_read_b128 v[240:243], v2 offset:28672
  v_cvt_pk_bf16_f32 v37, v210, v211
  v_mfma_f32_16x16x32_bf16 v[196:199], v[244:247], v[72:75], v[196:199]
  ds_read_b128 v[244:247], v2 offset:29696
  v_mul_f32 v212, v212, v23
  v_mul_f32 v213, v213, v23
  v_mul_f32 v214, v214, v23
  v_mul_f32 v215, v215, v23
  v_cvt_pk_bf16_f32 v38, v212, v213
  v_cvt_pk_bf16_f32 v39, v214, v215
  buffer_store_dwordx4 v[36:39], v6, s[16:19], 0 offen offset:192 nt sc1
  s_waitcnt vmcnt(4)
  s_waitcnt lgkmcnt(8)
  v_mfma_f32_16x16x32_bf16 v[208:211], v[248:251], v[156:159], 0
  v_mul_f32 v192, v192, v23
  v_mul_f32 v193, v193, v23
  v_mfma_f32_16x16x32_bf16 v[208:211], v[252:255], v[160:163], v[208:211]
  v_mul_f32 v194, v194, v23
  s_waitcnt lgkmcnt(6)
  v_mfma_f32_16x16x32_bf16 v[208:211], v[216:219], v[164:167], v[208:211]
  v_mul_f32 v195, v195, v23
  v_cvt_pk_bf16_f32 v28, v192, v193
  v_mfma_f32_16x16x32_bf16 v[208:211], v[220:223], v[176:179], v[208:211]
  v_cvt_pk_bf16_f32 v29, v194, v195
  s_waitcnt lgkmcnt(5)
  v_mfma_f32_16x16x32_bf16 v[208:211], v[224:227], v[180:183], v[208:211]
  v_mul_f32 v196, v196, v23
  s_waitcnt lgkmcnt(4)
  v_mfma_f32_16x16x32_bf16 v[208:211], v[228:231], v[72:75], v[208:211]
  v_mul_f32 v197, v197, v23
  s_waitcnt lgkmcnt(3)
  v_mfma_f32_16x16x32_bf16 v[212:215], v[232:235], v[156:159], 0
  v_mul_f32 v198, v198, v23
  s_waitcnt lgkmcnt(2)
  v_mfma_f32_16x16x32_bf16 v[212:215], v[236:239], v[160:163], v[212:215]
  v_mul_f32 v199, v199, v23
  s_waitcnt lgkmcnt(1)
  v_mfma_f32_16x16x32_bf16 v[212:215], v[240:243], v[164:167], v[212:215]
  v_cvt_pk_bf16_f32 v30, v196, v197
  s_waitcnt lgkmcnt(0)
  v_mfma_f32_16x16x32_bf16 v[212:215], v[244:247], v[176:179], v[212:215]
  v_cvt_pk_bf16_f32 v31, v198, v199
  v_mfma_f32_16x16x32_bf16 v[212:215], v[40:43], v[180:183], v[212:215]
  v_mul_f32 v208, v208, v23
  v_mfma_f32_16x16x32_bf16 v[212:215], v[44:47], v[72:75], v[212:215]
  v_mul_f32 v209, v209, v23
  v_mul_f32 v210, v210, v23
  buffer_store_dwordx4 v[28:31], v6, s[16:19], 0 offen offset:256 nt sc1
  v_mul_f32 v211, v211, v23
  v_cvt_pk_bf16_f32 v36, v208, v209
  v_cvt_pk_bf16_f32 v37, v210, v211
  s_nop 1
  v_mul_f32 v212, v212, v23
  v_mul_f32 v213, v213, v23
  v_mul_f32 v214, v214, v23
  v_mul_f32 v215, v215, v23
  v_cvt_pk_bf16_f32 v38, v212, v213
  v_cvt_pk_bf16_f32 v39, v214, v215
  buffer_store_dwordx4 v[36:39], v6, s[16:19], 0 offen offset:320 nt sc1
  s_endpgm
FB0:
  s_nop 7
  v_max3_f32 v22, v24, v25, v26
  v_max3_f32 v22, v22, v27, v28
  v_max3_f32 v22, v22, v29, v30
  v_max3_f32 v22, v22, v31, v32
  v_max3_f32 v22, v22, v33, v34
  v_max3_f32 v22, v22, v35, v36
  v_max3_f32 v22, v22, v37, v38
  v_max3_f32 v22, v22, v39, v40
  v_max3_f32 v22, v22, v41, v42
  v_max3_f32 v22, v22, v43, v44
  v_max3_f32 v22, v22, v45, v46
  v_max3_f32 v22, v22, v47, v48
  v_max3_f32 v22, v22, v49, v50
  v_max3_f32 v22, v22, v51, v52
  v_max3_f32 v22, v22, v53, v54
  s_mov_b32 s52, 0xff7fffff
  v_max3_f32 v22, v22, v55, s52
  v_mov_b32 v23, v22
  s_nop 1
  v_permlane32_swap_b32 v22, v23
  s_nop 1
  v_max_f32 v22, v22, v23
  v_mov_b32 v23, v22
  s_nop 1
  v_permlane16_swap_b32 v22, v23
  s_nop 1
  v_max_f32 v22, v22, v23
  v_sub_f32 v24, v24, v22
  v_sub_f32 v25, v25, v22
  v_sub_f32 v26, v26, v22
  v_sub_f32 v27, v27, v22
  v_sub_f32 v28, v28, v22
  v_sub_f32 v29, v29, v22
  v_sub_f32 v30, v30, v22
  v_sub_f32 v31, v31, v22
  v_sub_f32 v32, v32, v22
  v_sub_f32 v33, v33, v22
  v_sub_f32 v34, v34, v22
  v_sub_f32 v35, v35, v22
  v_sub_f32 v36, v36, v22
  v_sub_f32 v37, v37, v22
  v_sub_f32 v38, v38, v22
  v_sub_f32 v39, v39, v22
  v_sub_f32 v40, v40, v22
  v_sub_f32 v41, v41, v22
  v_sub_f32 v42, v42, v22
  v_sub_f32 v43, v43, v22
  v_sub_f32 v44, v44, v22
  v_sub_f32 v45, v45, v22
  v_sub_f32 v46, v46, v22
  v_sub_f32 v47, v47, v22
  v_sub_f32 v48, v48, v22
  v_sub_f32 v49, v49, v22
  v_sub_f32 v50, v50, v22
  v_sub_f32 v51, v51, v22
  v_sub_f32 v52, v52, v22
  v_sub_f32 v53, v53, v22
  v_sub_f32 v54, v54, v22
  v_sub_f32 v55, v55, v22
  v_exp_f32 v24, v24
  v_exp_f32 v25, v25
  v_exp_f32 v26, v26
  v_exp_f32 v27, v27
  v_exp_f32 v28, v28
  v_exp_f32 v29, v29
  v_exp_f32 v30, v30
  v_exp_f32 v31, v31
  v_exp_f32 v32, v32
  v_exp_f32 v33, v33
  v_exp_f32 v34, v34
  v_exp_f32 v35, v35
  v_exp_f32 v36, v36
  v_exp_f32 v37, v37
  v_exp_f32 v38, v38
  v_exp_f32 v39, v39
  v_exp_f32 v40, v40
  v_exp_f32 v41, v41
  v_exp_f32 v42, v42
  v_exp_f32 v43, v43
  v_exp_f32 v44, v44
  v_exp_f32 v45, v45
  v_exp_f32 v46, v46
  v_exp_f32 v47, v47
  v_exp_f32 v48, v48
  v_exp_f32 v49, v49
  v_exp_f32 v50, v50
  v_exp_f32 v51, v51
  v_exp_f32 v52, v52
  v_exp_f32 v53, v53
  v_exp_f32 v54, v54
  v_exp_f32 v55, v55
  s_nop 0
  v_cvt_pk_bf16_f32 v136, v24, v25
  v_cvt_pk_bf16_f32 v137, v26, v27
  v_cvt_pk_bf16_f32 v138, v28, v29
  v_cvt_pk_bf16_f32 v139, v30, v31
  v_cvt_pk_bf16_f32 v140, v32, v33
  v_cvt_pk_bf16_f32 v141, v34, v35
  v_cvt_pk_bf16_f32 v142, v36, v37
  v_cvt_pk_bf16_f32 v143, v38, v39
  v_cvt_pk_bf16_f32 v144, v40, v41
  v_cvt_pk_bf16_f32 v145, v42, v43
  v_cvt_pk_bf16_f32 v146, v44, v45
  v_cvt_pk_bf16_f32 v147, v46, v47
  v_cvt_pk_bf16_f32 v148, v48, v49
  v_cvt_pk_bf16_f32 v149, v50, v51
  v_cvt_pk_bf16_f32 v150, v52, v53
  v_cvt_pk_bf16_f32 v151, v54, v55
  s_nop 1
  v_mfma_f32_16x16x32_bf16 v[184:187], v[192:195], v[136:139], 0
  v_mfma_f32_16x16x32_bf16 v[184:187], v[192:195], v[140:143], v[184:187]
  v_mfma_f32_16x16x32_bf16 v[184:187], v[192:195], v[144:147], v[184:187]
  v_mfma_f32_16x16x32_bf16 v[184:187], v[192:195], v[148:151], v[184:187]
  s_nop 7
  s_branch FBR0
FB1:
  s_nop 7
  v_max3_f32 v22, v56, v57, v58
  v_max3_f32 v22, v22, v59, v60
  v_max3_f32 v22, v22, v61, v62
  v_max3_f32 v22, v22, v63, v64
  v_max3_f32 v22, v22, v65, v66
  v_max3_f32 v22, v22, v67, v68
  v_max3_f32 v22, v22, v69, v70
  v_max3_f32 v22, v22, v71, v72
  v_max3_f32 v22, v22, v73, v74
  v_max3_f32 v22, v22, v75, v76
  v_max3_f32 v22, v22, v77, v78
  v_max3_f32 v22, v22, v79, v80
  v_max3_f32 v22, v22, v81, v82
  v_max3_f32 v22, v22, v83, v84
  v_max3_f32 v22, v22, v85, v86
  s_mov_b32 s52, 0xff7fffff
  v_max3_f32 v22, v22, v87, s52
  v_mov_b32 v23, v22
  s_nop 1
  v_permlane32_swap_b32 v22, v23
  s_nop 1
  v_max_f32 v22, v22, v23
  v_mov_b32 v23, v22
  s_nop 1
  v_permlane16_swap_b32 v22, v23
  s_nop 1
  v_max_f32 v22, v22, v23
  v_sub_f32 v56, v56, v22
  v_sub_f32 v57, v57, v22
  v_sub_f32 v58, v58, v22
  v_sub_f32 v59, v59, v22
  v_sub_f32 v60, v60, v22
  v_sub_f32 v61, v61, v22
  v_sub_f32 v62, v62, v22
  v_sub_f32 v63, v63, v22
  v_sub_f32 v64, v64, v22
  v_sub_f32 v65, v65, v22
  v_sub_f32 v66, v66, v22
  v_sub_f32 v67, v67, v22
  v_sub_f32 v68, v68, v22
  v_sub_f32 v69, v69, v22
  v_sub_f32 v70, v70, v22
  v_sub_f32 v71, v71, v22
  v_sub_f32 v72, v72, v22
  v_sub_f32 v73, v73, v22
  v_sub_f32 v74, v74, v22
  v_sub_f32 v75, v75, v22
  v_sub_f32 v76, v76, v22
  v_sub_f32 v77, v77, v22
  v_sub_f32 v78, v78, v22
  v_sub_f32 v79, v79, v22
  v_sub_f32 v80, v80, v22
  v_sub_f32 v81, v81, v22
  v_sub_f32 v82, v82, v22
  v_sub_f32 v83, v83, v22
  v_sub_f32 v84, v84, v22
  v_sub_f32 v85, v85, v22
  v_sub_f32 v86, v86, v22
  v_sub_f32 v87, v87, v22
  v_exp_f32 v56, v56
  v_exp_f32 v57, v57
  v_exp_f32 v58, v58
  v_exp_f32 v59, v59
  v_exp_f32 v60, v60
  v_exp_f32 v61, v61
  v_exp_f32 v62, v62
  v_exp_f32 v63, v63
  v_exp_f32 v64, v64
  v_exp_f32 v65, v65
  v_exp_f32 v66, v66
  v_exp_f32 v67, v67
  v_exp_f32 v68, v68
  v_exp_f32 v69, v69
  v_exp_f32 v70, v70
  v_exp_f32 v71, v71
  v_exp_f32 v72, v72
  v_exp_f32 v73, v73
  v_exp_f32 v74, v74
  v_exp_f32 v75, v75
  v_exp_f32 v76, v76
  v_exp_f32 v77, v77
  v_exp_f32 v78, v78
  v_exp_f32 v79, v79
  v_exp_f32 v80, v80
  v_exp_f32 v81, v81
  v_exp_f32 v82, v82
  v_exp_f32 v83, v83
  v_exp_f32 v84, v84
  v_exp_f32 v85, v85
  v_exp_f32 v86, v86
  v_exp_f32 v87, v87
  s_nop 0
  v_cvt_pk_bf16_f32 v152, v56, v57
  v_cvt_pk_bf16_f32 v153, v58, v59
  v_cvt_pk_bf16_f32 v154, v60, v61
  v_cvt_pk_bf16_f32 v155, v62, v63
  v_cvt_pk_bf16_f32 v156, v64, v65
  v_cvt_pk_bf16_f32 v157, v66, v67
  v_cvt_pk_bf16_f32 v158, v68, v69
  v_cvt_pk_bf16_f32 v159, v70, v71
  v_cvt_pk_bf16_f32 v160, v72, v73
  v_cvt_pk_bf16_f32 v161, v74, v75
  v_cvt_pk_bf16_f32 v162, v76, v77
  v_cvt_pk_bf16_f32 v163, v78, v79
  v_cvt_pk_bf16_f32 v164, v80, v81
  v_cvt_pk_bf16_f32 v165, v82, v83
  v_cvt_pk_bf16_f32 v166, v84, v85
  v_cvt_pk_bf16_f32 v167, v86, v87
  s_nop 1
  v_mfma_f32_16x16x32_bf16 v[188:191], v[192:195], v[152:155], 0
  v_mfma_f32_16x16x32_bf16 v[188:191], v[192:195], v[156:159], v[188:191]
  v_mfma_f32_16x16x32_bf16 v[188:191], v[192:195], v[160:163], v[188:191]
  v_mfma_f32_16x16x32_bf16 v[188:191], v[192:195], v[164:167], v[188:191]
  s_nop 7
  s_branch FBR1
FB1s:
  s_nop 7
  v_max3_f32 v22, v56, v57, v58
  v_max3_f32 v22, v22, v59, v60
  v_max3_f32 v22, v22, v61, v62
  v_max3_f32 v22, v22, v63, v64
  v_max3_f32 v22, v22, v65, v66
  v_max3_f32 v22, v22, v67, v68
  v_max3_f32 v22, v22, v69, v70
  v_max3_f32 v22, v22, v71, v72
  v_max3_f32 v22, v22, v73, v74
  v_max3_f32 v22, v22, v75, v76
  v_max3_f32 v22, v22, v77, v78
  v_max3_f32 v22, v22, v79, v80
  v_max3_f32 v22, v22, v81, v82
  v_max3_f32 v22, v22, v83, v84
  v_max3_f32 v22, v22, v85, v86
  s_mov_b32 s52, 0xff7fffff
  v_max3_f32 v22, v22, v87, s52
  v_mov_b32 v23, v22
  s_nop 1
  v_permlane32_swap_b32 v22, v23
  s_nop 1
  v_max_f32 v22, v22, v23
  v_mov_b32 v23, v22
  s_nop 1
  v_permlane16_swap_b32 v22, v23
  s_nop 1
  v_max_f32 v22, v22, v23
  v_sub_f32 v56, v56, v22
  v_sub_f32 v57, v57, v22
  v_sub_f32 v58, v58, v22
  v_sub_f32 v59, v59, v22
  v_sub_f32 v60, v60, v22
  v_sub_f32 v61, v61, v22
  v_sub_f32 v62, v62, v22
  v_sub_f32 v63, v63, v22
  v_sub_f32 v64, v64, v22
  v_sub_f32 v65, v65, v22
  v_sub_f32 v66, v66, v22
  v_sub_f32 v67, v67, v22
  v_sub_f32 v68, v68, v22
  v_sub_f32 v69, v69, v22
  v_sub_f32 v70, v70, v22
  v_sub_f32 v71, v71, v22
  v_sub_f32 v72, v72, v22
  v_sub_f32 v73, v73, v22
  v_sub_f32 v74, v74, v22
  v_sub_f32 v75, v75, v22
  v_sub_f32 v76, v76, v22
  v_sub_f32 v77, v77, v22
  v_sub_f32 v78, v78, v22
  v_sub_f32 v79, v79, v22
  v_sub_f32 v80, v80, v22
  v_sub_f32 v81, v81, v22
  v_sub_f32 v82, v82, v22
  v_sub_f32 v83, v83, v22
  v_sub_f32 v84, v84, v22
  v_sub_f32 v85, v85, v22
  v_sub_f32 v86, v86, v22
  v_sub_f32 v87, v87, v22
  v_exp_f32 v56, v56
  v_exp_f32 v57, v57
  v_exp_f32 v58, v58
  v_exp_f32 v59, v59
  v_exp_f32 v60, v60
  v_exp_f32 v61, v61
  v_exp_f32 v62, v62
  v_exp_f32 v63, v63
  v_exp_f32 v64, v64
  v_exp_f32 v65, v65
  v_exp_f32 v66, v66
  v_exp_f32 v67, v67
  v_exp_f32 v68, v68
  v_exp_f32 v69, v69
  v_exp_f32 v70, v70
  v_exp_f32 v71, v71
  v_exp_f32 v72, v72
  v_exp_f32 v73, v73
  v_exp_f32 v74, v74
  v_exp_f32 v75, v75
  v_exp_f32 v76, v76
  v_exp_f32 v77, v77
  v_exp_f32 v78, v78
  v_exp_f32 v79, v79
  v_exp_f32 v80, v80
  v_exp_f32 v81, v81
  v_exp_f32 v82, v82
  v_exp_f32 v83, v83
  v_exp_f32 v84, v84
  v_exp_f32 v85, v85
  v_exp_f32 v86, v86
  v_exp_f32 v87, v87
  s_nop 0
  v_cvt_pk_bf16_f32 v152, v56, v57
  v_cvt_pk_bf16_f32 v153, v58, v59
  v_cvt_pk_bf16_f32 v154, v60, v61
  v_cvt_pk_bf16_f32 v155, v62, v63
  v_cvt_pk_bf16_f32 v156, v64, v65
  v_cvt_pk_bf16_f32 v157, v66, v67
  v_cvt_pk_bf16_f32 v158, v68, v69
  v_cvt_pk_bf16_f32 v159, v70, v71
  v_cvt_pk_bf16_f32 v160, v72, v73
  v_cvt_pk_bf16_f32 v161, v74, v75
  v_cvt_pk_bf16_f32 v162, v76, v77
  v_cvt_pk_bf16_f32 v163, v78, v79
  v_cvt_pk_bf16_f32 v164, v80, v81
  v_cvt_pk_bf16_f32 v165, v82, v83
  v_cvt_pk_bf16_f32 v166, v84, v85
  v_cvt_pk_bf16_f32 v167, v86, v87
  s_nop 1
  v_mfma_f32_16x16x32_bf16 v[188:191], v[192:195], v[152:155], 0
  v_mfma_f32_16x16x32_bf16 v[188:191], v[192:195], v[156:159], v[188:191]
  v_mfma_f32_16x16x32_bf16 v[188:191], v[192:195], v[160:163], v[188:191]
  v_mfma_f32_16x16x32_bf16 v[188:191], v[192:195], v[164:167], v[188:191]
  s_nop 7
  s_branch FBR1s
MK_end:
.section .rodata,"a"
.p2align 6
.amdhsa_kernel standalone__neighborhood_nat__vision_kernel
  .amdhsa_next_free_vgpr 256
  .amdhsa_next_free_sgpr 102
  .amdhsa_accum_offset 256
  .amdhsa_group_segment_fixed_size 0
  .amdhsa_kernarg_size 48
  .amdhsa_user_sgpr_count 2
  .amdhsa_user_sgpr_kernarg_segment_ptr 1
  .amdhsa_system_sgpr_workgroup_id_x 1
.end_amdhsa_kernel
```

```asm
; @launch grid=(256,1,1) block=(512,1,1) lds=163840
.amdgcn_target "amdgcn-amd-amdhsa--gfx950"
.text
.globl standalone__neighborhood_nat__vision_kernel
.p2align 8
.type standalone__neighborhood_nat__vision_kernel,@function
standalone__neighborhood_nat__vision_kernel:
  s_cmp_ge_u32 s2, 256
  s_cbranch_scc1 MK_done
  s_load_dwordx8 s[4:11], s[0:1], 0
  s_load_dwordx4 s[84:87], s[0:1], 32
  s_getpc_b64 s[12:13]
MK_pc:
  s_and_b32 s13, s13, 0xffff
  s_mov_b32 s14, MK_end-MK_pc
  s_mov_b32 s15, 0x00020000
  v_lshlrev_b32 v23, 7, v0
  buffer_load_dword v255, v23, s[12:15], 0 offen
  v_lshrrev_b32 v130, 6, v0
  v_and_b32 v0, 63, v0
  v_readfirstlane_b32 s24, v130
  v_and_b32 v128, 15, v0
  v_lshrrev_b32 v129, 4, v0
  v_lshrrev_b32 v130, 5, v0
  v_bfe_u32 v131, v0, 3, 2
  v_lshl_add_u32 v130, v130, 3, v131
  v_mul_u32_u24 v130, 1152, v130
  s_and_b32 s26, s24, 1
  s_lshl_b32 s46, s26, 2
  v_add_u32 v131, s46, v129
  v_and_b32 v132, 7, v0
  v_xor_b32 v131, v131, v132
  v_lshl_add_u32 v96, v131, 4, v130
  s_lshr_b32 s46, s24, 2
  s_lshl_b32 s46, s46, 5
  s_lshl_b32 s47, s26, 4
  s_add_u32 s46, s46, s47
  s_and_b32 s47, s24, 2
  s_lshl_b32 s47, s47, 1
  s_add_u32 s46, s46, s47
  s_mul_i32 s92, s46, 1152
  s_lshl_b32 s41, s24, 10
  s_cmp_lt_u32 s24, 4
  s_cselect_b64 vcc, -1, 0
  s_cbranch_vccz SL1
  s_waitcnt lgkmcnt(0)
  s_mov_b32 s88, s6
  s_and_b32 s89, s7, 0xffff
  s_mov_b32 s90, 221184
  s_mov_b32 s91, 0x00020000
  s_add_i32 m0, s41, 0
  s_add_i32 s100, s92, 0
  buffer_load_dwordx4 v96, s[88:91], s100 offen lds
  s_add_i32 m0, s41, 8192
  s_add_i32 s100, s92, 73728
  buffer_load_dwordx4 v96, s[88:91], s100 offen lds
  s_add_i32 m0, s41, 16384
  s_add_i32 s100, s92, 147456
  buffer_load_dwordx4 v96, s[88:91], s100 offen lds
  s_add_i32 m0, s41, 24576
  s_add_i32 s100, s92, 384
  buffer_load_dwordx4 v96, s[88:91], s100 offen lds
  s_add_i32 m0, s41, 32768
  s_add_i32 s100, s92, 74112
  buffer_load_dwordx4 v96, s[88:91], s100 offen lds
  s_add_i32 m0, s41, 40960
  s_add_i32 s100, s92, 147840
  buffer_load_dwordx4 v96, s[88:91], s100 offen lds
SL1:
  s_bfe_u32 s27, s2, 0x10002
  s_bfe_u32 s28, s2, 0x10001
  s_and_b32 s29, s2, 1
  s_lshl_b32 s29, s29, 2
  s_lshr_b32 s46, s2, 6
  s_add_u32 s29, s29, s46
  s_bfe_u32 s30, s2, 0x30003
  s_mul_i32 s37, s29, 14
  s_add_i32 s37, s37, -6
  s_max_i32 s29, s37, -4
  s_mul_i32 s30, s30, 14
  s_add_i32 s30, s30, -6
  s_lshr_b32 s25, s24, 1
  s_add_u32 s25, s25, 2
  s_and_b32 s25, s25, 3
  s_sub_u32 s56, 0, s27
  s_mul_i32 s57, s27, 224
  s_sub_u32 s58, 0, s28
  s_mul_i32 s59, s28, 224
  v_and_b32 v130, 7, v128
  s_mul_i32 s46, s26, 7
  s_add_i32 s46, s46, s30
  v_cmp_lt_u32 s[48:49], 6, v130
  v_add_u32 v130, s46, v130
  v_max_i32 v19, 0, v130
  v_add3_u32 v130, v130, v19, 6
  v_xor_b32 v130, s58, v130
  v_add_u32 v130, s59, v130
  v_subrev_u32 v19, s30, v19
  v_mul_u32_u24 v130, 384, v130
  v_lshl_add_u32 v130, v129, 4, v130
  s_lshl_b32 s46, s25, 2
  s_add_i32 s46, s46, -2
  s_mov_b32 s47, 86016
  v_lshrrev_b32 v131, 3, v128
  v_add_u32 v131, s46, v131
  v_mov_b32 v132, 0x80000000
  v_cmp_gt_i32 s[42:43], 0, v131
  v_add_u32 v5, s37, v131
  v_max_i32 v21, 0, v5
  v_add3_u32 v5, v5, v21, 6
  s_or_b64 s[42:43], s[42:43], s[48:49]
  v_xor_b32 v5, s56, v5
  v_add_u32 v5, s57, v5
  v_subrev_u32 v21, s29, v21
  v_mad_u32_u24 v5, v5, s47, v130
  v_cndmask_b32 v21, v21, v132, s[42:43]
  v_cndmask_b32 v5, v5, v132, s[42:43]
  v_add_u32 v131, 2, v131
  v_cmp_gt_i32 s[44:45], 0, v131
  v_add_u32 v6, s37, v131
  v_max_i32 v22, 0, v6
  v_add3_u32 v6, v6, v22, 6
  s_or_b64 s[44:45], s[44:45], s[48:49]
  v_xor_b32 v6, s56, v6
  v_add_u32 v6, s57, v6
  v_subrev_u32 v22, s29, v22
  v_mad_u32_u24 v6, v6, s47, v130
  v_cndmask_b32 v22, v22, v132, s[44:45]
  v_cndmask_b32 v6, v6, v132, s[44:45]
  s_waitcnt lgkmcnt(0)
  s_mov_b32 s88, s6
  s_and_b32 s89, s7, 0xffff
  s_mov_b32 s90, 221184
  s_mov_b32 s91, 0x00020000
  s_cmp_lg_u32 s24, 5
  s_cbranch_scc1 MK_ntlb
  s_max_i32 s46, s37, 0
  s_lshl_b32 s46, s46, 1
  s_sub_u32 s47, 184, s46
  s_cmp_eq_u32 s27, 0
  s_cselect_b32 s46, s46, s47
  s_mul_i32 s46, s46, 86016
  s_load_dword s94, s[4:5], s46
  s_load_dword s95, s[10:11], s46
  s_add_u32 s46, s46, 1720256
  s_load_dword s94, s[4:5], s46
  s_load_dword s95, s[10:11], s46
  s_add_u32 s46, s46, 1720256
  s_load_dword s94, s[4:5], s46
  s_load_dword s95, s[10:11], s46
  s_load_dword s94, s[84:85], 128
  s_load_dword s95, s[86:87], 0x20000
MK_ntlb:
  s_lshr_b32 s46, s24, 1
  s_cmp_lg_u32 s46, 2
  s_cbranch_scc1 MK_nwpf
  s_cmp_eq_u32 s24, 4
  s_cselect_b32 s46, 54, 18
  s_cselect_b32 s12, s6, s8
  s_cselect_b32 s13, s7, s9
  s_and_b32 s13, s13, 0xffff
  s_lshr_b32 s47, s2, 3
  s_mul_i32 s47, s47, s46
  s_lshl_b32 s100, s47, 7
  s_lshl_b32 s46, s46, 7
  s_add_u32 s14, s100, s46
  s_mov_b32 s15, 0x00020000
  v_lshlrev_b32 v23, 7, v0
  buffer_load_dword v254, v23, s[12:15], s100 offen
MK_nwpf:
  s_mov_b32 s12, s4
  s_and_b32 s13, s5, 0xffff
  s_mov_b32 s14, 19267584
  s_mov_b32 s15, 0x00020000
  s_movk_i32 s54, 112
  s_mov_b32 s16, s10
  s_and_b32 s17, s11, 0xffff
  s_mov_b32 s18, 19267584
  s_mov_b32 s19, 0x00020000
  s_mov_b32 s4, s8
  s_and_b32 s5, s9, 0xffff
  s_mov_b32 s6, 73728
  s_mov_b32 s7, 0x00020000
  s_mov_b32 s8, s84
  s_and_b32 s9, s85, 0xffff
  s_mov_b32 s10, 256
  s_mov_b32 s11, 0x00020000
  s_mov_b32 s20, s86
  s_and_b32 s21, s87, 0xffff
  s_mov_b32 s22, 73728
  s_mov_b32 s23, 0x00020000
  v_lshlrev_b32 v1, 4, v0
  v_add_u32 v2, 36864, v1
  s_and_b32 s40, s24, 3
  s_lshl_b32 s40, s40, 10
  v_bfe_u32 v130, v128, 1, 3
  v_xor_b32 v130, v130, v129
  v_lshlrev_b32 v131, 7, v128
  v_lshl_add_u32 v131, v130, 4, v131
  s_lshr_b32 s46, s24, 2
  s_mul_i32 s47, s46, 12288
  s_add_u32 s47, s47, 0
  v_add_u32 v97, s47, v131
  v_xor_b32 v98, 64, v97
  s_mul_i32 s47, s40, 6
  s_add_u32 s47, s47, 24576
  v_add_u32 v99, s47, v131
  v_xor_b32 v100, 64, v99
  v_mov_b32 v135, 0
  v_mov_b32 v134, 0
  s_lshr_b32 s46, s24, 2
  s_mul_i32 s46, s46, 3072
  s_mul_i32 s47, s40, 18
  s_add_u32 s46, s46, s47
  s_sub_u32 s46, 58368, s46
  v_add_u32 v101, s46, v1
  s_lshl_b32 s46, s29, 1
  s_xor_b32 s46, s46, s56
  s_mul_i32 s47, s27, 222
  s_add_i32 s31, s46, s47
  s_mul_i32 s31, s31, 86016
  s_mul_i32 s32, s27, -688128
  s_add_i32 s32, s32, 344064
  s_lshr_b32 s33, s29, 31
  s_lshl_b32 s33, s33, 1
  s_lshl_b32 s38, s40, 2
  s_add_u32 s39, s38, 3072
  s_min_u32 s39, s39, 14336
  s_mul_i32 s48, s27, 172032
  s_sub_u32 s49, 172032, s48
  v_mov_b32 v132, s48
  v_mov_b32 v133, s49
  s_lshr_b32 s46, s38, 4
  s_add_u32 s46, s46, 0
  v_add_u32 v130, s46, v0
  v_mul_u32_u24 v13, 2731, v130
  v_lshrrev_b32 v13, 16, v13
  v_cmp_le_u32 s[52:53], 20, v13
  v_mul_u32_u24 v131, 24, v13
  v_sub_u32 v130, v130, v131
  v_subrev_u32 v131, 20, v13
  v_cndmask_b32 v13, v13, v131, s[52:53]
  v_bfe_u32 v131, v13, 1, 3
  v_xor_b32 v130, v130, v131
  v_cndmask_b32 v131, v132, v133, s[52:53]
  v_lshl_add_u32 v130, v130, 4, v131
  v_add_u32 v13, s30, v13
  v_max_i32 v13, 0, v13
  s_cbranch_vccz SL2
  s_add_i32 m0, s41, 4096
  s_add_i32 s100, s92, 36864
  buffer_load_dwordx4 v96, s[88:91], s100 offen lds
  s_add_i32 m0, s41, 12288
  s_add_i32 s100, s92, 110592
  buffer_load_dwordx4 v96, s[88:91], s100 offen lds
  s_add_i32 m0, s41, 20480
  s_add_i32 s100, s92, 184320
  buffer_load_dwordx4 v96, s[88:91], s100 offen lds
  s_add_i32 m0, s41, 28672
  s_add_i32 s100, s92, 37248
  buffer_load_dwordx4 v96, s[88:91], s100 offen lds
  s_add_i32 m0, s41, 36864
  s_add_i32 s100, s92, 110976
  buffer_load_dwordx4 v96, s[88:91], s100 offen lds
  s_add_i32 m0, s41, 45056
  s_add_i32 s100, s92, 184704
  buffer_load_dwordx4 v96, s[88:91], s100 offen lds
SL2:
  v_lshlrev_b32 v13, 1, v13
  v_xor_b32 v13, s58, v13
  v_add_u32 v13, s59, v13
  v_mul_u32_u24 v13, 384, v13
  v_add_u32 v13, v13, v130
  s_lshr_b32 s46, s38, 4
  s_add_u32 s46, s46, 64
  v_add_u32 v130, s46, v0
  v_mul_u32_u24 v14, 2731, v130
  v_lshrrev_b32 v14, 16, v14
  v_cmp_le_u32 s[52:53], 20, v14
  v_mul_u32_u24 v131, 24, v14
  v_sub_u32 v130, v130, v131
  v_subrev_u32 v131, 20, v14
  v_cndmask_b32 v14, v14, v131, s[52:53]
  v_bfe_u32 v131, v14, 1, 3
  v_xor_b32 v130, v130, v131
  v_cndmask_b32 v131, v132, v133, s[52:53]
  v_lshl_add_u32 v130, v130, 4, v131
  v_add_u32 v14, s30, v14
  v_max_i32 v14, 0, v14
  v_lshlrev_b32 v14, 1, v14
  v_xor_b32 v14, s58, v14
  v_add_u32 v14, s59, v14
  v_mul_u32_u24 v14, 384, v14
  v_add_u32 v14, v14, v130
  s_lshr_b32 s46, s38, 4
  s_add_u32 s46, s46, 128
  v_add_u32 v130, s46, v0
  v_mul_u32_u24 v3, 2731, v130
  v_lshrrev_b32 v3, 16, v3
  v_cmp_le_u32 s[52:53], 20, v3
  v_mul_u32_u24 v131, 24, v3
  v_sub_u32 v130, v130, v131
  v_subrev_u32 v131, 20, v3
  v_cndmask_b32 v3, v3, v131, s[52:53]
  v_bfe_u32 v131, v3, 1, 3
  v_xor_b32 v130, v130, v131
  v_cndmask_b32 v131, v132, v133, s[52:53]
  v_lshl_add_u32 v130, v130, 4, v131
  v_add_u32 v3, s30, v3
  v_max_i32 v3, 0, v3
  v_lshlrev_b32 v3, 1, v3
  v_xor_b32 v3, s58, v3
  v_add_u32 v3, s59, v3
  v_mul_u32_u24 v3, 384, v3
  v_add_u32 v3, v3, v130
  s_lshr_b32 s46, s39, 4
  v_add_u32 v130, s46, v0
  v_mul_u32_u24 v4, 2731, v130
  v_lshrrev_b32 v4, 16, v4
  v_cmp_le_u32 s[52:53], 20, v4
  v_mul_u32_u24 v131, 24, v4
  v_sub_u32 v130, v130, v131
  v_subrev_u32 v131, 20, v4
  v_cndmask_b32 v4, v4, v131, s[52:53]
  v_bfe_u32 v131, v4, 1, 3
  v_xor_b32 v130, v130, v131
  v_cndmask_b32 v131, v132, v133, s[52:53]
  v_lshl_add_u32 v130, v130, 4, v131
  v_add_u32 v4, s30, v4
  v_max_i32 v4, 0, v4
  v_lshlrev_b32 v4, 1, v4
  v_xor_b32 v4, s58, v4
  v_add_u32 v4, s59, v4
  v_mul_u32_u24 v4, 384, v4
  v_add_u32 v4, v4, v130
  s_add_u32 s38, s38, 10240
  s_add_u32 s39, s39, 10240
  s_lshl_b32 s46, s25, 2
  s_add_i32 s46, s46, -2
  s_max_i32 s46, s46, 0
  s_add_i32 s46, s46, s37
  s_max_i32 s46, s46, 0
  s_sub_i32 s46, s46, s29
  s_lshl_b32 s34, s25, 2
  s_add_i32 s34, s34, s37
  s_max_i32 s34, s34, 0
  s_sub_i32 s34, s34, s29
  s_sub_u32 s46, s34, s46
  s_lshr_b32 s46, s46, 1
  s_mul_i32 s36, s46, -8
  s_add_i32 s36, s36, 7
  s_add_i32 s34, s34, -1
  s_add_i32 s35, s34, s36
  s_mul_i32 s36, s36, 7680
  s_lshl_b32 s47, s26, 2
  s_mul_i32 s46, s34, 7680
  s_add_i32 s46, s46, 10240
  v_add_u32 v130, s47, v128
  v_bfe_u32 v131, v130, 1, 3
  v_xor_b32 v131, v131, v129
  v_mul_u32_u24 v130, 384, v130
  v_lshl_add_u32 v130, v131, 4, v130
  v_add_u32 v7, s46, v130
  v_xor_b32 v8, 64, v7
  v_lshrrev_b32 v130, 2, v128
  v_lshl_add_u32 v130, v129, 2, v130
  v_add_u32 v130, s47, v130
  v_bfe_u32 v131, v130, 1, 3
  v_and_b32 v132, 2, v128
  v_lshlrev_b32 v132, 1, v132
  v_xor_b32 v131, v131, v132
  v_mul_u32_u24 v130, 384, v130
  v_lshl_add_u32 v130, v131, 4, v130
  v_and_b32 v131, 1, v128
  v_lshl_add_u32 v130, v131, 3, v130
  v_add_u32 v9, s46, v130
  v_xor_b32 v10, 16, v9
  v_xor_b32 v11, 32, v9
  v_xor_b32 v12, 48, v9
  v_lshl_add_u32 v130, v129, 2, s47
  v_sub_u32 v19, v130, v19
  v_cndmask_b32 v19, v19, 64, s[44:45]
  v_add_u32 v20, s36, v7
  v_add_u32 v0, s36, v8
  v_add_u32 v15, s36, v9
  v_add_u32 v16, s36, v10
  v_add_u32 v17, s36, v11
  v_add_u32 v18, s36, v12
  s_mov_b32 s93, 1037384597
  s_cbranch_vccnz SL3
  s_add_i32 m0, s41, 49152
  s_add_i32 s100, s92, 128
  buffer_load_dwordx4 v96, s[88:91], s100 offen lds
  s_add_i32 m0, s41, 57344
  s_add_i32 s100, s92, 73856
  buffer_load_dwordx4 v96, s[88:91], s100 offen lds
  s_add_i32 m0, s41, 65536
  s_add_i32 s100, s92, 147584
  buffer_load_dwordx4 v96, s[88:91], s100 offen lds
  s_add_i32 m0, s41, 73728
  s_add_i32 s100, s92, 512
  buffer_load_dwordx4 v96, s[88:91], s100 offen lds
  s_add_i32 m0, s41, 81920
  s_add_i32 s100, s92, 74240
  buffer_load_dwordx4 v96, s[88:91], s100 offen lds
  s_add_i32 m0, s41, 90112
  s_add_i32 s100, s92, 147968
  buffer_load_dwordx4 v96, s[88:91], s100 offen lds
  s_add_i32 m0, s41, 45056
  s_add_i32 s100, s92, -36736
  buffer_load_dwordx4 v96, s[88:91], s100 offen lds
  s_add_i32 m0, s41, 53248
  s_add_i32 s100, s92, 36992
  buffer_load_dwordx4 v96, s[88:91], s100 offen lds
  s_add_i32 m0, s41, 61440
  s_add_i32 s100, s92, 110720
  buffer_load_dwordx4 v96, s[88:91], s100 offen lds
  s_add_i32 m0, s41, 69632
  s_add_i32 s100, s92, -36352
  buffer_load_dwordx4 v96, s[88:91], s100 offen lds
  s_add_i32 m0, s41, 77824
  s_add_i32 s100, s92, 37376
  buffer_load_dwordx4 v96, s[88:91], s100 offen lds
  s_add_i32 m0, s41, 86016
  s_add_i32 s100, s92, 111104
  buffer_load_dwordx4 v96, s[88:91], s100 offen lds
SL3:
  s_cbranch_vccz SL4
  s_waitcnt vmcnt(0)
  s_branch SM4
SL4:
  s_waitcnt vmcnt(12)
SM4:
  s_barrier
  ds_read_b128 v[208:211], v99 offset:0
  ds_read_b128 v[212:215], v99 offset:2048
  ds_read_b128 v[216:219], v99 offset:4096
  ds_read_b128 v[184:187], v97 offset:0
  ds_read_b128 v[188:191], v97 offset:2048
  ds_read_b128 v[192:195], v97 offset:4096
  ds_read_b128 v[196:199], v97 offset:6144
  ds_read_b128 v[200:203], v97 offset:8192
  ds_read_b128 v[204:207], v97 offset:10240
  s_waitcnt lgkmcnt(5)
  v_mfma_f32_16x16x32_bf16 v[24:27], v[184:187], v[208:211], 0
  s_cbranch_vccz SL5
  s_add_i32 m0, s41, 98304
  s_add_i32 s100, s92, 256
  buffer_load_dwordx4 v96, s[88:91], s100 offen lds
SL5:
  v_mfma_f32_16x16x32_bf16 v[28:31], v[184:187], v[212:215], 0
  s_cbranch_vccz SL6
  s_add_i32 m0, s41, 106496
  s_add_i32 s100, s92, 73984
  buffer_load_dwordx4 v96, s[88:91], s100 offen lds
SL6:
  v_mfma_f32_16x16x32_bf16 v[32:35], v[184:187], v[216:219], 0
  s_waitcnt lgkmcnt(4)
  v_mfma_f32_16x16x32_bf16 v[36:39], v[188:191], v[208:211], 0
  ds_read_b128 v[244:247], v100 offset:0
  s_cbranch_vccz SL7
  s_add_i32 m0, s41, 114688
  s_add_i32 s100, s92, 147712
  buffer_load_dwordx4 v96, s[88:91], s100 offen lds
SL7:
  v_mfma_f32_16x16x32_bf16 v[40:43], v[188:191], v[212:215], 0
  ds_read_b128 v[248:251], v100 offset:2048
  s_cbranch_vccz SL8
  s_add_i32 m0, s41, 122880
  s_add_i32 s100, s92, 640
  buffer_load_dwordx4 v96, s[88:91], s100 offen lds
SL8:
  v_mfma_f32_16x16x32_bf16 v[44:47], v[188:191], v[216:219], 0
  s_waitcnt lgkmcnt(5)
  v_mfma_f32_16x16x32_bf16 v[48:51], v[192:195], v[208:211], 0
  ds_read_b128 v[252:255], v100 offset:4096
  s_cbranch_vccz SL9
  s_add_i32 m0, s41, 131072
  s_add_i32 s100, s92, 74368
  buffer_load_dwordx4 v96, s[88:91], s100 offen lds
SL9:
  v_mfma_f32_16x16x32_bf16 v[52:55], v[192:195], v[212:215], 0
  ds_read_b128 v[220:223], v98 offset:0
  s_cbranch_vccz SL10
  s_add_i32 m0, s41, 139264
  s_add_i32 s100, s92, 148096
  buffer_load_dwordx4 v96, s[88:91], s100 offen lds
SL10:
  v_mfma_f32_16x16x32_bf16 v[56:59], v[192:195], v[216:219], 0
  s_waitcnt lgkmcnt(6)
  v_mfma_f32_16x16x32_bf16 v[60:63], v[196:199], v[208:211], 0
  ds_read_b128 v[224:227], v98 offset:2048
  s_cbranch_vccz SL11
  s_add_i32 m0, s41, 102400
  s_add_i32 s100, s92, 37120
  buffer_load_dwordx4 v96, s[88:91], s100 offen lds
SL11:
  v_mfma_f32_16x16x32_bf16 v[64:67], v[196:199], v[212:215], 0
  ds_read_b128 v[228:231], v98 offset:4096
  s_cbranch_vccz SL12
  s_add_i32 m0, s41, 110592
  s_add_i32 s100, s92, 110848
  buffer_load_dwordx4 v96, s[88:91], s100 offen lds
SL12:
  v_mfma_f32_16x16x32_bf16 v[68:71], v[196:199], v[216:219], 0
  s_waitcnt lgkmcnt(7)
  v_mfma_f32_16x16x32_bf16 v[72:75], v[200:203], v[208:211], 0
  ds_read_b128 v[232:235], v98 offset:6144
  s_cbranch_vccz SL13
  s_add_i32 m0, s41, 118784
  s_add_i32 s100, s92, 184576
  buffer_load_dwordx4 v96, s[88:91], s100 offen lds
SL13:
  v_mfma_f32_16x16x32_bf16 v[76:79], v[200:203], v[212:215], 0
  ds_read_b128 v[236:239], v98 offset:8192
  s_cbranch_vccz SL14
  s_add_i32 m0, s41, 126976
  s_add_i32 s100, s92, 37504
  buffer_load_dwordx4 v96, s[88:91], s100 offen lds
SL14:
  v_mfma_f32_16x16x32_bf16 v[80:83], v[200:203], v[216:219], 0
  s_waitcnt lgkmcnt(8)
  v_mfma_f32_16x16x32_bf16 v[84:87], v[204:207], v[208:211], 0
  ds_read_b128 v[240:243], v98 offset:10240
  s_cbranch_vccz SL15
  s_add_i32 m0, s41, 135168
  s_add_i32 s100, s92, 111232
  buffer_load_dwordx4 v96, s[88:91], s100 offen lds
SL15:
  v_mfma_f32_16x16x32_bf16 v[88:91], v[204:207], v[212:215], 0
  s_cbranch_vccz SL16
  s_add_i32 m0, s41, 143360
  s_add_i32 s100, s92, 184960
  buffer_load_dwordx4 v96, s[88:91], s100 offen lds
SL16:
  v_mfma_f32_16x16x32_bf16 v[92:95], v[204:207], v[216:219], 0
  v_lshrrev_b32 v107, 4, v1
  s_cmp_lt_u32 s2, 72
  s_cbranch_scc0 MK_np1
  s_mul_hi_u32 s54, s2, 0x15555556
  s_lshl_b32 s54, s54, 6
  s_mul_i32 s55, s24, 6144
  s_add_u32 s100, s54, s55
  v_lshrrev_b32 v104, 2, v107
  v_mul_u32_u24 v104, 384, v104
  v_and_b32 v105, 3, v107
  v_lshl_add_u32 v104, v105, 4, v104
  s_add_u32 m0, s41, 147456
  s_nop 0
  buffer_load_dwordx4 v104, s[4:7], s100 offen lds
  s_mul_i32 s55, s40, 6
  s_add_u32 s100, s54, s55
  s_add_u32 m0, s40, 155648
  s_add_u32 s100, s100, 49152
  buffer_load_dwordx4 v104, s[4:7], s100 offen lds
MK_np1:
  s_sub_u32 s3, s2, 72
  s_lshr_b32 s3, s3, 31
  s_lshr_b32 s3, s3, s25
  s_cmp_eq_u32 s3, 0
  s_cbranch_scc1 MK_np3
  s_mul_hi_u32 s54, s2, 0x15555556
  s_mul_i32 s55, s54, 12
  s_sub_u32 s55, s2, s55
  s_cmp_ge_u32 s55, 6
  s_cselect_b32 s51, 1, 0
  s_mul_i32 s100, s51, 6
  s_sub_u32 s55, s55, s100
  v_lshrrev_b32 v106, 2, v128
  v_and_b32 v105, 3, v128
  v_lshl_add_u32 v134, v129, 3, v106
  v_lshlrev_b32 v134, 6, v134
  v_lshl_add_u32 v134, v105, 4, v134
  s_lshl_b32 s51, s51, 3
  s_add_u32 s51, s51, 147456
  v_add_u32 v134, s51, v134
  s_lshr_b32 s54, s55, 1
  s_lshl_b32 s54, s54, 6
  s_and_b32 s55, s55, 1
  s_lshl_b32 s55, s55, 4
  s_add_u32 s54, s54, s55
  v_lshrrev_b32 v104, 1, v106
  v_lshlrev_b32 v104, 5, v104
  v_and_b32 v106, 1, v106
  v_lshl_add_u32 v104, v106, 2, v104
  v_add3_u32 v104, v104, v105, s54
  v_mul_u32_u24 v104, 1152, v104
  v_lshl_add_u32 v135, v129, 4, v104
  s_mul_i32 s100, s26, 9216
  buffer_load_dwordx4 v[136:139], v135, s[88:91], s100 offen offset:768
  buffer_load_dwordx4 v[140:143], v135, s[88:91], s100 offen offset:832
  buffer_load_dwordx4 v[144:147], v135, s[88:91], s100 offen offset:896
  buffer_load_dwordx4 v[148:151], v135, s[88:91], s100 offen offset:960
  buffer_load_dwordx4 v[152:155], v135, s[88:91], s100 offen offset:1024
  buffer_load_dwordx4 v[156:159], v135, s[88:91], s100 offen offset:1088
MK_np3:
  s_cbranch_vccz SL18
  s_waitcnt vmcnt(63) lgkmcnt(0)
  s_branch SM18
SL18:
  s_cmp_lg_u32 s3, 0
  s_cbranch_scc1 CA17
  s_cmp_lt_u32 s2, 72
  s_cbranch_scc1 CB17
  s_waitcnt vmcnt(0)
CB17:
  s_waitcnt vmcnt(2)
CA17:
  s_waitcnt vmcnt(8) lgkmcnt(0)
SM18:
  s_barrier
  v_add_u32 v97, 49152, v97
  v_add_u32 v98, 49152, v98
  v_add_u32 v99, 49152, v99
  v_add_u32 v100, 49152, v100
  v_mfma_f32_16x16x32_bf16 v[24:27], v[220:223], v[244:247], v[24:27]
  ds_read_b128 v[208:211], v99 offset:0
  s_cbranch_vccnz SL19
  buffer_load_dwordx4 v[160:163], v6, s[12:15], 0 offen offset:0
SL19:
  v_mfma_f32_16x16x32_bf16 v[28:31], v[220:223], v[248:251], v[28:31]
  ds_read_b128 v[212:215], v99 offset:2048
  v_mfma_f32_16x16x32_bf16 v[32:35], v[220:223], v[252:255], v[32:35]
  v_mfma_f32_16x16x32_bf16 v[36:39], v[224:227], v[244:247], v[36:39]
  ds_read_b128 v[216:219], v99 offset:4096
  s_cbranch_vccnz SL20
  buffer_load_dwordx4 v[164:167], v6, s[12:15], 0 offen offset:64
SL20:
  v_mfma_f32_16x16x32_bf16 v[40:43], v[224:227], v[248:251], v[40:43]
  ds_read_b128 v[184:187], v97 offset:0
  v_mfma_f32_16x16x32_bf16 v[44:47], v[224:227], v[252:255], v[44:47]
  v_mfma_f32_16x16x32_bf16 v[48:51], v[228:231], v[244:247], v[48:51]
  ds_read_b128 v[188:191], v97 offset:2048
  s_cbranch_vccnz SL21
  buffer_load_dwordx4 v[168:171], v6, s[12:15], 0 offen offset:128
SL21:
  v_mfma_f32_16x16x32_bf16 v[52:55], v[228:231], v[248:251], v[52:55]
  ds_read_b128 v[192:195], v97 offset:4096
  v_mfma_f32_16x16x32_bf16 v[56:59], v[228:231], v[252:255], v[56:59]
  v_mfma_f32_16x16x32_bf16 v[60:63], v[232:235], v[244:247], v[60:63]
  ds_read_b128 v[196:199], v97 offset:6144
  s_cbranch_vccnz SL22
  buffer_load_dwordx4 v[172:175], v6, s[12:15], 0 offen offset:192
SL22:
  v_mfma_f32_16x16x32_bf16 v[64:67], v[232:235], v[248:251], v[64:67]
  ds_read_b128 v[200:203], v97 offset:8192
  v_mfma_f32_16x16x32_bf16 v[68:71], v[232:235], v[252:255], v[68:71]
  v_mfma_f32_16x16x32_bf16 v[72:75], v[236:239], v[244:247], v[72:75]
  ds_read_b128 v[204:207], v97 offset:10240
  s_cbranch_vccnz SL23
  buffer_load_dwordx4 v[176:179], v6, s[12:15], 0 offen offset:256
SL23:
  v_mfma_f32_16x16x32_bf16 v[76:79], v[236:239], v[248:251], v[76:79]
  v_mfma_f32_16x16x32_bf16 v[80:83], v[236:239], v[252:255], v[80:83]
  v_mfma_f32_16x16x32_bf16 v[84:87], v[240:243], v[244:247], v[84:87]
  s_cbranch_vccnz SL24
  buffer_load_dwordx4 v[180:183], v6, s[12:15], 0 offen offset:320
SL24:
  v_mfma_f32_16x16x32_bf16 v[88:91], v[240:243], v[248:251], v[88:91]
  v_mfma_f32_16x16x32_bf16 v[92:95], v[240:243], v[252:255], v[92:95]
  s_waitcnt lgkmcnt(5)
  v_mfma_f32_16x16x32_bf16 v[24:27], v[184:187], v[208:211], v[24:27]
  s_cbranch_vccnz SL25
  s_cmp_eq_u32 s25, 0
  s_cbranch_scc1 QB6
  buffer_load_dwordx4 v[136:139], v5, s[12:15], 0 offen offset:0
QB6:
SL25:
  v_mfma_f32_16x16x32_bf16 v[28:31], v[184:187], v[212:215], v[28:31]
  v_mfma_f32_16x16x32_bf16 v[32:35], v[184:187], v[216:219], v[32:35]
  s_waitcnt lgkmcnt(4)
  v_mfma_f32_16x16x32_bf16 v[36:39], v[188:191], v[208:211], v[36:39]
  ds_read_b128 v[244:247], v100 offset:0
  s_cbranch_vccnz SL26
  s_cmp_eq_u32 s25, 0
  s_cbranch_scc1 QB7
  buffer_load_dwordx4 v[140:143], v5, s[12:15], 0 offen offset:64
QB7:
SL26:
  v_mfma_f32_16x16x32_bf16 v[40:43], v[188:191], v[212:215], v[40:43]
  ds_read_b128 v[248:251], v100 offset:2048
  v_mfma_f32_16x16x32_bf16 v[44:47], v[188:191], v[216:219], v[44:47]
  s_waitcnt lgkmcnt(5)
  v_mfma_f32_16x16x32_bf16 v[48:51], v[192:195], v[208:211], v[48:51]
  ds_read_b128 v[252:255], v100 offset:4096
  s_cbranch_vccnz SL27
  s_cmp_eq_u32 s25, 0
  s_cbranch_scc1 QB8
  buffer_load_dwordx4 v[144:147], v5, s[12:15], 0 offen offset:128
QB8:
SL27:
  v_mfma_f32_16x16x32_bf16 v[52:55], v[192:195], v[212:215], v[52:55]
  ds_read_b128 v[220:223], v98 offset:0
  v_mfma_f32_16x16x32_bf16 v[56:59], v[192:195], v[216:219], v[56:59]
  s_waitcnt lgkmcnt(6)
  v_mfma_f32_16x16x32_bf16 v[60:63], v[196:199], v[208:211], v[60:63]
  ds_read_b128 v[224:227], v98 offset:2048
  s_cbranch_vccnz SL28
  s_cmp_eq_u32 s25, 0
  s_cbranch_scc1 QB9
  buffer_load_dwordx4 v[148:151], v5, s[12:15], 0 offen offset:192
QB9:
SL28:
  v_mfma_f32_16x16x32_bf16 v[64:67], v[196:199], v[212:215], v[64:67]
  ds_read_b128 v[228:231], v98 offset:4096
  v_mfma_f32_16x16x32_bf16 v[68:71], v[196:199], v[216:219], v[68:71]
  s_waitcnt lgkmcnt(7)
  v_mfma_f32_16x16x32_bf16 v[72:75], v[200:203], v[208:211], v[72:75]
  ds_read_b128 v[232:235], v98 offset:6144
  s_cbranch_vccnz SL29
  s_cmp_eq_u32 s25, 0
  s_cbranch_scc1 QB10
  buffer_load_dwordx4 v[152:155], v5, s[12:15], 0 offen offset:256
QB10:
SL29:
  v_mfma_f32_16x16x32_bf16 v[76:79], v[200:203], v[212:215], v[76:79]
  ds_read_b128 v[236:239], v98 offset:8192
  v_mfma_f32_16x16x32_bf16 v[80:83], v[200:203], v[216:219], v[80:83]
  s_waitcnt lgkmcnt(8)
  v_mfma_f32_16x16x32_bf16 v[84:87], v[204:207], v[208:211], v[84:87]
  ds_read_b128 v[240:243], v98 offset:10240
  s_cbranch_vccnz SL30
  s_cmp_eq_u32 s25, 0
  s_cbranch_scc1 QB11
  buffer_load_dwordx4 v[156:159], v5, s[12:15], 0 offen offset:320
QB11:
SL30:
  v_mfma_f32_16x16x32_bf16 v[88:91], v[204:207], v[212:215], v[88:91]
  v_mfma_f32_16x16x32_bf16 v[92:95], v[204:207], v[216:219], v[92:95]
  s_cbranch_vccz SL31
  v_lshrrev_b32 v133, 4, v1
  v_lshrrev_b32 v130, 3, v133
  s_mul_i32 s50, s26, 7
  s_add_i32 s50, s50, s30
  v_cmp_lt_u32 s[52:53], 6, v130
  v_add_u32 v130, s50, v130
  v_max_i32 v131, 0, v130
  v_add3_u32 v130, v130, v131, 6
  v_xor_b32 v130, s58, v130
  v_add_u32 v130, s59, v130
  v_mul_u32_u24 v130, 384, v130
  v_and_b32 v131, 7, v133
  v_xor_b32 v131, v131, v129
  v_lshl_add_u32 v130, v131, 4, v130
  v_mov_b32 v131, 0x80000000
  v_cndmask_b32 v134, v130, v131, s[52:53]
  v_xor_b32 v135, 64, v134
  s_lshl_b32 s46, s25, 2
  s_add_i32 s46, s46, s37
  s_lshl_b32 s84, s46, 1
  s_add_i32 s84, s84, 2
  s_xor_b32 s84, s84, s56
  s_add_i32 s84, s84, s57
  s_mul_i32 s84, s84, 86016
  s_lshl_b32 s85, s46, 1
  s_add_i32 s85, s85, 4
  s_xor_b32 s85, s85, s56
  s_add_i32 s85, s85, s57
  s_mul_i32 s85, s85, 86016
  s_lshl_b32 s86, s46, 1
  s_add_i32 s86, s86, 6
  s_xor_b32 s86, s86, s56
  s_add_i32 s86, s86, s57
  s_mul_i32 s86, s86, 86016
  s_lshl_b32 s87, s46, 1
  s_add_i32 s87, s87, 8
  s_xor_b32 s87, s87, s56
  s_add_i32 s87, s87, s57
  s_mul_i32 s87, s87, 86016
  s_mul_i32 s101, s40, 6
  s_add_u32 s101, s101, 73728
  v_bfe_u32 v130, v128, 1, 3
  v_xor_b32 v130, v130, v129
  v_lshlrev_b32 v131, 7, v128
  v_lshl_add_u32 v131, v130, 4, v131
  v_lshrrev_b32 v130, 3, v128
  v_lshl_add_u32 v130, v130, 11, v131
  v_add_u32 v23, s101, v130
SL31:
  s_cbranch_vccz SL32
  s_waitcnt vmcnt(0) lgkmcnt(0)
  s_branch SM32
SL32:
  s_cmp_lg_u32 s25, 0
  s_cbranch_scc1 MK_c2
  s_waitcnt vmcnt(6)
MK_c2:
  s_waitcnt vmcnt(12) lgkmcnt(0)
SM32:
  s_barrier
  v_add_u32 v97, 49152, v97
  v_add_u32 v98, 49152, v98
  v_add_u32 v99, 49152, v99
  v_add_u32 v100, 49152, v100
  v_mfma_f32_16x16x32_bf16 v[24:27], v[220:223], v[244:247], v[24:27]
  ds_read_b128 v[208:211], v99 offset:0
  v_mfma_f32_16x16x32_bf16 v[28:31], v[220:223], v[248:251], v[28:31]
  ds_read_b128 v[212:215], v99 offset:2048
  v_mfma_f32_16x16x32_bf16 v[32:35], v[220:223], v[252:255], v[32:35]
  v_mfma_f32_16x16x32_bf16 v[36:39], v[224:227], v[244:247], v[36:39]
  ds_read_b128 v[216:219], v99 offset:4096
  v_mfma_f32_16x16x32_bf16 v[40:43], v[224:227], v[248:251], v[40:43]
  ds_read_b128 v[184:187], v97 offset:0
  v_mfma_f32_16x16x32_bf16 v[44:47], v[224:227], v[252:255], v[44:47]
  v_mfma_f32_16x16x32_bf16 v[48:51], v[228:231], v[244:247], v[48:51]
  ds_read_b128 v[188:191], v97 offset:2048
  v_mfma_f32_16x16x32_bf16 v[52:55], v[228:231], v[248:251], v[52:55]
  ds_read_b128 v[192:195], v97 offset:4096
  v_mfma_f32_16x16x32_bf16 v[56:59], v[228:231], v[252:255], v[56:59]
  v_mfma_f32_16x16x32_bf16 v[60:63], v[232:235], v[244:247], v[60:63]
  ds_read_b128 v[196:199], v97 offset:6144
  v_mfma_f32_16x16x32_bf16 v[64:67], v[232:235], v[248:251], v[64:67]
  ds_read_b128 v[200:203], v97 offset:8192
  v_mfma_f32_16x16x32_bf16 v[68:71], v[232:235], v[252:255], v[68:71]
  v_mfma_f32_16x16x32_bf16 v[72:75], v[236:239], v[244:247], v[72:75]
  ds_read_b128 v[204:207], v97 offset:10240
  v_mfma_f32_16x16x32_bf16 v[76:79], v[236:239], v[248:251], v[76:79]
  v_mfma_f32_16x16x32_bf16 v[80:83], v[236:239], v[252:255], v[80:83]
  v_mfma_f32_16x16x32_bf16 v[84:87], v[240:243], v[244:247], v[84:87]
  v_mfma_f32_16x16x32_bf16 v[88:91], v[240:243], v[248:251], v[88:91]
  v_mfma_f32_16x16x32_bf16 v[92:95], v[240:243], v[252:255], v[92:95]
  s_cmp_eq_u32 s3, 0
  s_cbranch_scc1 MK_np2
  s_waitcnt lgkmcnt(0)
  ds_read_b64_tr_b16 v[104:105], v134 offset:0
  ds_read_b64_tr_b16 v[106:107], v134 offset:256
  ds_read_b64_tr_b16 v[108:109], v134 offset:2048
  ds_read_b64_tr_b16 v[110:111], v134 offset:2304
  ds_read_b64_tr_b16 v[112:113], v134 offset:4096
  ds_read_b64_tr_b16 v[114:115], v134 offset:4352
  ds_read_b64_tr_b16 v[116:117], v134 offset:6144
  ds_read_b64_tr_b16 v[118:119], v134 offset:6400
  ds_read_b64_tr_b16 v[120:121], v134 offset:8192
  ds_read_b64_tr_b16 v[122:123], v134 offset:8448
  ds_read_b64_tr_b16 v[124:125], v134 offset:10240
  ds_read_b64_tr_b16 v[126:127], v134 offset:10496
  s_setprio 3
  s_waitcnt lgkmcnt(0)
  v_mfma_f32_16x16x32_bf16 v[128:131], v[136:139], v[104:107], 0
  v_mfma_f32_16x16x32_bf16 v[128:131], v[140:143], v[108:111], v[128:131]
  v_mfma_f32_16x16x32_bf16 v[128:131], v[144:147], v[112:115], v[128:131]
  v_mfma_f32_16x16x32_bf16 v[128:131], v[148:151], v[116:119], v[128:131]
  v_mfma_f32_16x16x32_bf16 v[128:131], v[152:155], v[120:123], v[128:131]
  v_mfma_f32_16x16x32_bf16 v[128:131], v[156:159], v[124:127], v[128:131]
  s_lshl_b32 s100, s2, 10
  s_lshl_b32 s54, s26, 3
  s_add_u32 s100, s100, s54
  s_nop 5
  v_cvt_pk_bf16_f32 v132, v128, v129
  v_cvt_pk_bf16_f32 v133, v130, v131
  buffer_store_dwordx2 v[132:133], v1, s[20:23], s100 offen sc1
  s_setprio 0
MK_np2:
  ds_read_b128 v[244:247], v100 offset:0
  ds_read_b128 v[248:251], v100 offset:2048
  ds_read_b128 v[252:255], v100 offset:4096
  ds_read_b128 v[220:223], v98 offset:0
  ds_read_b128 v[224:227], v98 offset:2048
  s_waitcnt lgkmcnt(5)
  v_mfma_f32_16x16x32_bf16 v[24:27], v[184:187], v[208:211], v[24:27]
  ds_read_b128 v[228:231], v98 offset:4096
  s_cbranch_vccz SL33
  s_add_u32 m0, s101, 0
  s_nop 0
  buffer_load_dwordx4 v134, s[12:15], s86 offen offset:0 lds
SL33:
  v_mfma_f32_16x16x32_bf16 v[36:39], v[188:191], v[208:211], v[36:39]
  ds_read_b128 v[232:235], v98 offset:6144
  s_waitcnt lgkmcnt(2)
  v_mfma_f32_16x16x32_bf16 v[24:27], v[220:223], v[244:247], v[24:27]
  ds_read_b128 v[236:239], v98 offset:8192
  v_mfma_f32_16x16x32_bf16 v[36:39], v[224:227], v[244:247], v[36:39]
  ds_read_b128 v[240:243], v98 offset:10240
  v_mfma_f32_16x16x32_bf16 v[28:31], v[184:187], v[212:215], v[28:31]
  v_mfma_f32_16x16x32_bf16 v[40:43], v[188:191], v[212:215], v[40:43]
  v_mfma_f32_16x16x32_bf16 v[28:31], v[220:223], v[248:251], v[28:31]
  s_cbranch_vccz SL34
  s_add_u32 m0, s101, 896
  s_nop 0
  buffer_load_dwordx4 v134, s[12:15], s86 offen offset:128 lds
SL34:
  v_mfma_f32_16x16x32_bf16 v[40:43], v[224:227], v[248:251], v[40:43]
  s_waitcnt lgkmcnt(0)
  v_mfma_f32_16x16x32_bf16 v[32:35], v[184:187], v[216:219], v[32:35]
  v_cvt_pk_bf16_f32 v104, v24, v25
  v_cvt_pk_bf16_f32 v105, v26, v27
  v_mfma_f32_16x16x32_bf16 v[44:47], v[188:191], v[216:219], v[44:47]
  v_cvt_pk_bf16_f32 v106, v36, v37
  v_cvt_pk_bf16_f32 v107, v38, v39
  v_mfma_f32_16x16x32_bf16 v[32:35], v[220:223], v[252:255], v[32:35]
  ds_write_b128 v101, v[104:107] offset:14336
  v_mfma_f32_16x16x32_bf16 v[44:47], v[224:227], v[252:255], v[44:47]
  v_mfma_f32_16x16x32_bf16 v[48:51], v[192:195], v[208:211], v[48:51]
  v_cvt_pk_bf16_f32 v108, v28, v29
  v_cvt_pk_bf16_f32 v109, v30, v31
  s_cbranch_vccz SL35
  s_add_u32 m0, s101, 1792
  s_nop 0
  buffer_load_dwordx4 v134, s[12:15], s86 offen offset:256 lds
SL35:
  v_mfma_f32_16x16x32_bf16 v[60:63], v[196:199], v[208:211], v[60:63]
  v_cvt_pk_bf16_f32 v110, v40, v41
  v_cvt_pk_bf16_f32 v111, v42, v43
  v_mfma_f32_16x16x32_bf16 v[48:51], v[228:231], v[244:247], v[48:51]
  ds_write_b128 v101, v[108:111] offset:8192
  v_mfma_f32_16x16x32_bf16 v[60:63], v[232:235], v[244:247], v[60:63]
  v_mfma_f32_16x16x32_bf16 v[52:55], v[192:195], v[212:215], v[52:55]
  v_cvt_pk_bf16_f32 v112, v32, v33
  v_cvt_pk_bf16_f32 v113, v34, v35
  v_mfma_f32_16x16x32_bf16 v[64:67], v[196:199], v[212:215], v[64:67]
  v_cvt_pk_bf16_f32 v114, v44, v45
  v_cvt_pk_bf16_f32 v115, v46, v47
  v_mfma_f32_16x16x32_bf16 v[52:55], v[228:231], v[248:251], v[52:55]
  ds_write_b128 v101, v[112:115] offset:2048
  s_cbranch_vccz SL36
  s_add_u32 m0, s101, 3072
  s_nop 0
  buffer_load_dwordx4 v135, s[12:15], s87 offen offset:0 lds
SL36:
  v_mfma_f32_16x16x32_bf16 v[64:67], v[232:235], v[248:251], v[64:67]
  v_mfma_f32_16x16x32_bf16 v[56:59], v[192:195], v[216:219], v[56:59]
  v_cvt_pk_bf16_f32 v116, v48, v49
  v_cvt_pk_bf16_f32 v117, v50, v51
  v_mfma_f32_16x16x32_bf16 v[68:71], v[196:199], v[216:219], v[68:71]
  v_cvt_pk_bf16_f32 v118, v60, v61
  v_cvt_pk_bf16_f32 v119, v62, v63
  v_mfma_f32_16x16x32_bf16 v[56:59], v[228:231], v[252:255], v[56:59]
  ds_write_b128 v101, v[116:119] offset:13312
  v_mfma_f32_16x16x32_bf16 v[68:71], v[232:235], v[252:255], v[68:71]
  v_mfma_f32_16x16x32_bf16 v[72:75], v[200:203], v[208:211], v[72:75]
  v_cvt_pk_bf16_f32 v120, v52, v53
  v_cvt_pk_bf16_f32 v121, v54, v55
  s_cbranch_vccz SL37
  s_add_u32 m0, s101, 3968
  s_nop 0
  buffer_load_dwordx4 v135, s[12:15], s87 offen offset:128 lds
SL37:
  v_mfma_f32_16x16x32_bf16 v[84:87], v[204:207], v[208:211], v[84:87]
  v_cvt_pk_bf16_f32 v122, v64, v65
  v_cvt_pk_bf16_f32 v123, v66, v67
  v_mfma_f32_16x16x32_bf16 v[72:75], v[236:239], v[244:247], v[72:75]
  ds_write_b128 v101, v[120:123] offset:7168
  v_mfma_f32_16x16x32_bf16 v[84:87], v[240:243], v[244:247], v[84:87]
  v_mfma_f32_16x16x32_bf16 v[76:79], v[200:203], v[212:215], v[76:79]
  v_cvt_pk_bf16_f32 v124, v56, v57
  v_cvt_pk_bf16_f32 v125, v58, v59
  v_mfma_f32_16x16x32_bf16 v[88:91], v[204:207], v[212:215], v[88:91]
  v_cvt_pk_bf16_f32 v126, v68, v69
  v_cvt_pk_bf16_f32 v127, v70, v71
  v_mfma_f32_16x16x32_bf16 v[76:79], v[236:239], v[248:251], v[76:79]
  ds_write_b128 v101, v[124:127] offset:1024
  s_cbranch_vccz SL38
  s_add_u32 m0, s101, 4864
  s_nop 0
  buffer_load_dwordx4 v135, s[12:15], s87 offen offset:256 lds
SL38:
  v_mfma_f32_16x16x32_bf16 v[88:91], v[240:243], v[248:251], v[88:91]
  v_mfma_f32_16x16x32_bf16 v[80:83], v[200:203], v[216:219], v[80:83]
  v_cvt_pk_bf16_f32 v104, v72, v73
  v_cvt_pk_bf16_f32 v105, v74, v75
  v_mfma_f32_16x16x32_bf16 v[92:95], v[204:207], v[216:219], v[92:95]
  v_cvt_pk_bf16_f32 v106, v84, v85
  v_cvt_pk_bf16_f32 v107, v86, v87
  v_mfma_f32_16x16x32_bf16 v[80:83], v[236:239], v[252:255], v[80:83]
  ds_write_b128 v101, v[104:107] offset:12288
  v_mfma_f32_16x16x32_bf16 v[92:95], v[240:243], v[252:255], v[92:95]
  v_cvt_pk_bf16_f32 v108, v76, v77
  v_cvt_pk_bf16_f32 v109, v78, v79
  v_cvt_pk_bf16_f32 v110, v88, v89
  v_cvt_pk_bf16_f32 v111, v90, v91
  ds_write_b128 v101, v[108:111] offset:6144
  s_nop 3
  v_cvt_pk_bf16_f32 v112, v80, v81
  v_cvt_pk_bf16_f32 v113, v82, v83
  v_cvt_pk_bf16_f32 v114, v92, v93
  v_cvt_pk_bf16_f32 v115, v94, v95
  ds_write_b128 v101, v[112:115] offset:0
  s_waitcnt lgkmcnt(0)
  s_barrier
  s_cmp_eq_u32 s25, 0
  s_cbranch_scc1 MK_single
  ds_read_b128 v[216:219], v2 offset:35840
  ds_read_b128 v[220:223], v2 offset:34816
  ds_read_b128 v[224:227], v2 offset:33792
  ds_read_b128 v[228:231], v2 offset:32768
  ds_read_b128 v[232:235], v2 offset:31744
  ds_read_b128 v[236:239], v2 offset:30720
  ds_read_b128 v[240:243], v2 offset:29696
  ds_read_b128 v[244:247], v2 offset:28672
  ds_read_b128 v[248:251], v2 offset:27648
  ds_read_b128 v[252:255], v2 offset:26624
  s_cbranch_vccz SL39
  s_add_u32 m0, s101, 24576
  s_nop 0
  buffer_load_dwordx4 v134, s[12:15], s84 offen offset:0 lds
  s_add_u32 m0, s101, 25472
  s_nop 0
  buffer_load_dwordx4 v134, s[12:15], s84 offen offset:128 lds
  s_add_u32 m0, s101, 26368
  s_nop 0
  buffer_load_dwordx4 v134, s[12:15], s84 offen offset:256 lds
  s_add_u32 m0, s101, 27648
  s_nop 0
  buffer_load_dwordx4 v135, s[12:15], s85 offen offset:0 lds
  s_add_u32 m0, s101, 28544
  s_nop 0
  buffer_load_dwordx4 v135, s[12:15], s85 offen offset:128 lds
  s_add_u32 m0, s101, 29440
  s_nop 0
  buffer_load_dwordx4 v135, s[12:15], s85 offen offset:256 lds
  s_mul_i32 s100, s32, 9
  s_add_i32 s100, s100, s31
  s_add_u32 m0, s38, 138240
  s_nop 0
  buffer_load_dwordx4 v13, s[12:15], s100 offen lds
  s_add_u32 m0, s38, 139264
  s_nop 0
  buffer_load_dwordx4 v14, s[12:15], s100 offen lds
  s_add_u32 m0, s38, 140288
  s_nop 0
  buffer_load_dwordx4 v3, s[12:15], s100 offen lds
  s_add_u32 m0, s39, 138240
  s_nop 0
  buffer_load_dwordx4 v4, s[12:15], s100 offen lds
  s_mul_i32 s100, s32, 8
  s_add_i32 s100, s100, s31
  s_add_u32 m0, s38, 122880
  s_nop 0
  buffer_load_dwordx4 v13, s[12:15], s100 offen lds
  s_add_u32 m0, s38, 123904
  s_nop 0
  buffer_load_dwordx4 v14, s[12:15], s100 offen lds
  s_add_u32 m0, s38, 124928
  s_nop 0
  buffer_load_dwordx4 v3, s[12:15], s100 offen lds
  s_add_u32 m0, s39, 122880
  s_nop 0
  buffer_load_dwordx4 v4, s[12:15], s100 offen lds
  s_waitcnt vmcnt(8) lgkmcnt(0)
  v_xor_b32 v130, 64, v23
  ds_read_b128 v[136:139], v23 offset:24576
  ds_read_b128 v[140:143], v130 offset:24576
  ds_read_b128 v[144:147], v23 offset:25600
  ds_read_b128 v[148:151], v130 offset:25600
  ds_read_b128 v[152:155], v23 offset:26624
  ds_read_b128 v[156:159], v130 offset:26624
  ds_read_b128 v[160:163], v23 offset:0
  ds_read_b128 v[164:167], v130 offset:0
  ds_read_b128 v[168:171], v23 offset:1024
  ds_read_b128 v[172:175], v130 offset:1024
  ds_read_b128 v[176:179], v23 offset:2048
  ds_read_b128 v[180:183], v130 offset:2048
  s_waitcnt lgkmcnt(0)
  s_barrier
  s_branch SM39
SL39:
  s_waitcnt vmcnt(0)
  s_setprio 1
SM39:
BODY:
  s_waitcnt lgkmcnt(6)
  v_mfma_f32_16x16x32_bf16 v[184:187], v[216:219], v[136:139], 0
  v_mov_b32 v64, 0xff800000
  v_add_u32 v65, 0, v19
  v_mfma_f32_16x16x32_bf16 v[184:187], v[220:223], v[140:143], v[184:187]
  v_add_u32 v66, 1, v19
  v_add_u32 v67, 2, v19
  v_mfma_f32_16x16x32_bf16 v[184:187], v[224:227], v[144:147], v[184:187]
  v_add_u32 v68, 3, v19
  v_cmp_gt_u32 s[48:49], 7, v65
  v_mfma_f32_16x16x32_bf16 v[192:195], v[216:219], v[160:163], 0
  ds_read_b128 v[216:219], v2 offset:25600
  v_cmp_gt_u32 s[50:51], 7, v66
  v_mfma_f32_16x16x32_bf16 v[192:195], v[220:223], v[164:167], v[192:195]
  ds_read_b128 v[220:223], v2 offset:24576
  v_cmp_gt_u32 s[52:53], 7, v67
  v_mfma_f32_16x16x32_bf16 v[192:195], v[224:227], v[168:171], v[192:195]
  ds_read_b128 v[224:227], v2 offset:23552
  v_cmp_gt_u32 s[54:55], 7, v68
  v_mfma_f32_16x16x32_bf16 v[192:195], v[228:231], v[172:175], v[192:195]
  s_add_i32 s46, s34, 8
  s_waitcnt lgkmcnt(5)
  v_mfma_f32_16x16x32_bf16 v[192:195], v[232:235], v[176:179], v[192:195]
  v_sub_u32 v69, s46, v22
  s_add_i32 s46, s34, 1
  v_mfma_f32_16x16x32_bf16 v[192:195], v[236:239], v[180:183], v[192:195]
  v_sub_u32 v70, s46, v22
  s_add_i32 s46, s34, 6
  v_mfma_f32_16x16x32_bf16 v[184:187], v[228:231], v[148:151], v[184:187]
  ds_read_b128 v[228:231], v2 offset:22528
  v_sub_u32 v71, s46, v21
  v_mfma_f32_16x16x32_bf16 v[184:187], v[232:235], v[152:155], v[184:187]
  ds_read_b128 v[232:235], v2 offset:21504
  s_add_i32 s46, s34, 0
  v_mfma_f32_16x16x32_bf16 v[184:187], v[236:239], v[156:159], v[184:187]
  ds_read_b128 v[236:239], v2 offset:20480
  v_sub_u32 v72, s46, v21
  v_mfma_f32_16x16x32_bf16 v[188:191], v[240:243], v[136:139], 0
  v_sub_u32 v73, s35, v21
  v_cndmask_b32 v32, v64, 0, s[48:49]
  v_mfma_f32_16x16x32_bf16 v[188:191], v[244:247], v[140:143], v[188:191]
  v_cndmask_b32 v33, v64, 0, s[50:51]
  s_waitcnt lgkmcnt(4)
  v_mfma_f32_16x16x32_bf16 v[188:191], v[248:251], v[144:147], v[188:191]
  v_cndmask_b32 v34, v64, 0, s[52:53]
  v_cndmask_b32 v35, v64, 0, s[54:55]
  v_mfma_f32_16x16x32_bf16 v[196:199], v[240:243], v[160:163], 0
  ds_read_b128 v[240:243], v2 offset:19456
  v_cmp_gt_u32 s[46:47], 7, v69
  v_mfma_f32_16x16x32_bf16 v[196:199], v[244:247], v[164:167], v[196:199]
  ds_read_b128 v[244:247], v2 offset:18432
  v_cmp_gt_u32 s[48:49], 7, v70
  v_mfma_f32_16x16x32_bf16 v[196:199], v[248:251], v[168:171], v[196:199]
  ds_read_b128 v[248:251], v2 offset:17408
  v_cmp_gt_u32 s[50:51], 7, v71
  v_mfma_f32_16x16x32_bf16 v[196:199], v[252:255], v[172:175], v[196:199]
  v_cmp_gt_u32 s[52:53], 7, v72
  v_cmp_gt_u32 s[54:55], 7, v73
  v_mfma_f32_16x16x32_bf16 v[196:199], v[216:219], v[176:179], v[196:199]
  v_cndmask_b32 v84, v64, v32, s[46:47]
  v_cndmask_b32 v85, v64, v33, s[46:47]
  v_mfma_f32_16x16x32_bf16 v[196:199], v[220:223], v[180:183], v[196:199]
  v_cndmask_b32 v86, v64, v34, s[46:47]
  v_mul_f32 v192, s93, v192
  v_mfma_f32_16x16x32_bf16 v[188:191], v[252:255], v[148:151], v[188:191]
  ds_read_b128 v[252:255], v2 offset:16384
  v_mul_f32 v193, s93, v193
  v_mfma_f32_16x16x32_bf16 v[188:191], v[216:219], v[152:155], v[188:191]
  ds_read_b128 v[216:219], v2 offset:15360
  v_mul_f32 v194, s93, v194
  v_mfma_f32_16x16x32_bf16 v[188:191], v[220:223], v[156:159], v[188:191]
  ds_read_b128 v[220:223], v2 offset:14336
  s_waitcnt lgkmcnt(6)
  v_mfma_f32_16x16x32_bf16 v[200:203], v[224:227], v[136:139], 0
  v_mul_f32 v195, s93, v195
  v_cvt_pk_bf16_f32 v112, v192, v193
  v_mfma_f32_16x16x32_bf16 v[200:203], v[228:231], v[140:143], v[200:203]
  v_cvt_pk_bf16_f32 v113, v194, v195
  v_mul_f32 v184, s93, v184
  v_mfma_f32_16x16x32_bf16 v[200:203], v[232:235], v[144:147], v[200:203]
  v_mul_f32 v185, s93, v185
  v_mul_f32 v186, s93, v186
  v_mfma_f32_16x16x32_bf16 v[208:211], v[224:227], v[160:163], 0
  ds_read_b128 v[224:227], v2 offset:13312
  v_mul_f32 v187, s93, v187
  v_mfma_f32_16x16x32_bf16 v[208:211], v[228:231], v[164:167], v[208:211]
  ds_read_b128 v[228:231], v2 offset:12288
  v_cvt_pk_bf16_f32 v88, v184, v185
  v_mfma_f32_16x16x32_bf16 v[208:211], v[232:235], v[168:171], v[208:211]
  ds_read_b128 v[232:235], v2 offset:11264
  v_cvt_pk_bf16_f32 v89, v186, v187
  v_mfma_f32_16x16x32_bf16 v[208:211], v[236:239], v[172:175], v[208:211]
  v_mul_f32 v196, s93, v196
  s_waitcnt lgkmcnt(5)
  v_mfma_f32_16x16x32_bf16 v[208:211], v[240:243], v[176:179], v[208:211]
  v_mul_f32 v197, s93, v197
  v_mul_f32 v198, s93, v198
  v_mfma_f32_16x16x32_bf16 v[208:211], v[244:247], v[180:183], v[208:211]
  v_mul_f32 v199, s93, v199
  v_cvt_pk_bf16_f32 v114, v196, v197
  v_mfma_f32_16x16x32_bf16 v[200:203], v[236:239], v[148:151], v[200:203]
  ds_read_b128 v[236:239], v2 offset:10240
  v_cvt_pk_bf16_f32 v115, v198, v199
  v_mfma_f32_16x16x32_bf16 v[200:203], v[240:243], v[152:155], v[200:203]
  ds_read_b128 v[240:243], v2 offset:9216
  v_mul_f32 v188, s93, v188
  v_mfma_f32_16x16x32_bf16 v[200:203], v[244:247], v[156:159], v[200:203]
  ds_read_b128 v[244:247], v2 offset:8192
  v_mul_f32 v189, s93, v189
  v_mfma_f32_16x16x32_bf16 v[204:207], v[248:251], v[136:139], 0
  v_mul_f32 v190, s93, v190
  v_mul_f32 v191, s93, v191
  v_mfma_f32_16x16x32_bf16 v[204:207], v[252:255], v[140:143], v[204:207]
  v_cvt_pk_bf16_f32 v90, v188, v189
  s_waitcnt lgkmcnt(4)
  v_mfma_f32_16x16x32_bf16 v[204:207], v[216:219], v[144:147], v[204:207]
  v_cvt_pk_bf16_f32 v91, v190, v191
  v_cndmask_b32 v87, v64, v35, s[46:47]
  v_mfma_f32_16x16x32_bf16 v[212:215], v[248:251], v[160:163], 0
  ds_read_b128 v[248:251], v2 offset:7168
  v_cndmask_b32 v56, v64, v32, s[48:49]
  v_mfma_f32_16x16x32_bf16 v[212:215], v[252:255], v[164:167], v[212:215]
  ds_read_b128 v[252:255], v2 offset:6144
  v_cndmask_b32 v57, v64, v33, s[48:49]
  v_mfma_f32_16x16x32_bf16 v[212:215], v[216:219], v[168:171], v[212:215]
  ds_read_b128 v[216:219], v2 offset:5120
  v_cndmask_b32 v58, v64, v34, s[48:49]
  v_mfma_f32_16x16x32_bf16 v[212:215], v[220:223], v[172:175], v[212:215]
  v_cndmask_b32 v59, v64, v35, s[48:49]
  v_mul_f32 v208, s93, v208
  v_mfma_f32_16x16x32_bf16 v[212:215], v[224:227], v[176:179], v[212:215]
  v_mul_f32 v209, s93, v209
  v_mul_f32 v210, s93, v210
  v_mfma_f32_16x16x32_bf16 v[212:215], v[228:231], v[180:183], v[212:215]
  v_mul_f32 v211, s93, v211
  v_cvt_pk_bf16_f32 v116, v208, v209
  v_mfma_f32_16x16x32_bf16 v[204:207], v[220:223], v[148:151], v[204:207]
  ds_read_b128 v[220:223], v2 offset:4096
  v_cvt_pk_bf16_f32 v117, v210, v211
  v_mfma_f32_16x16x32_bf16 v[204:207], v[224:227], v[152:155], v[204:207]
  ds_read_b128 v[224:227], v2 offset:3072
  v_mul_f32 v200, s93, v200
  v_mfma_f32_16x16x32_bf16 v[204:207], v[228:231], v[156:159], v[204:207]
  ds_read_b128 v[228:231], v2 offset:2048
  s_waitcnt lgkmcnt(6)
  v_mfma_f32_16x16x32_bf16 v[184:187], v[232:235], v[136:139], 0
  v_mul_f32 v201, s93, v201
  v_mul_f32 v202, s93, v202
  v_mfma_f32_16x16x32_bf16 v[184:187], v[236:239], v[140:143], v[184:187]
  v_mul_f32 v203, s93, v203
  v_cvt_pk_bf16_f32 v92, v200, v201
  v_mfma_f32_16x16x32_bf16 v[184:187], v[240:243], v[144:147], v[184:187]
  v_cvt_pk_bf16_f32 v93, v202, v203
  v_mul_f32 v212, s93, v212
  v_mfma_f32_16x16x32_bf16 v[192:195], v[232:235], v[160:163], 0
  ds_read_b128 v[232:235], v2 offset:1024
  v_mul_f32 v213, s93, v213
  v_mfma_f32_16x16x32_bf16 v[192:195], v[236:239], v[164:167], v[192:195]
  ds_read_b128 v[236:239], v2 offset:0
  v_mul_f32 v214, s93, v214
  v_mfma_f32_16x16x32_bf16 v[192:195], v[240:243], v[168:171], v[192:195]
  ds_read_b128 v[240:243], v1 offset:35840
  v_mul_f32 v215, s93, v215
  v_mfma_f32_16x16x32_bf16 v[192:195], v[244:247], v[172:175], v[192:195]
  v_cvt_pk_bf16_f32 v118, v212, v213
  s_waitcnt lgkmcnt(5)
  v_mfma_f32_16x16x32_bf16 v[192:195], v[248:251], v[176:179], v[192:195]
  v_cvt_pk_bf16_f32 v119, v214, v215
  v_mul_f32 v204, s93, v204
  v_mfma_f32_16x16x32_bf16 v[192:195], v[252:255], v[180:183], v[192:195]
  v_mul_f32 v205, s93, v205
  v_mul_f32 v206, s93, v206
  v_mfma_f32_16x16x32_bf16 v[184:187], v[244:247], v[148:151], v[184:187]
  ds_read_b128 v[244:247], v1 offset:34816
  v_mul_f32 v207, s93, v207
  v_mfma_f32_16x16x32_bf16 v[184:187], v[248:251], v[152:155], v[184:187]
  ds_read_b128 v[248:251], v1 offset:33792
  v_cvt_pk_bf16_f32 v94, v204, v205
  v_mfma_f32_16x16x32_bf16 v[184:187], v[252:255], v[156:159], v[184:187]
  ds_read_b128 v[252:255], v1 offset:32768
  v_cvt_pk_bf16_f32 v95, v206, v207
  v_mfma_f32_16x16x32_bf16 v[188:191], v[216:219], v[136:139], 0
  v_cndmask_b32 v52, v64, v32, s[50:51]
  v_cndmask_b32 v53, v64, v33, s[50:51]
  s_cbranch_vccz SL40
  s_barrier
SL40:
  v_mfma_f32_16x16x32_bf16 v[188:191], v[220:223], v[140:143], v[188:191]
  v_cndmask_b32 v54, v64, v34, s[50:51]
  s_waitcnt lgkmcnt(4)
  v_mfma_f32_16x16x32_bf16 v[188:191], v[224:227], v[144:147], v[188:191]
  v_cndmask_b32 v55, v64, v35, s[50:51]
  v_mul_f32 v192, s93, v192
  v_mfma_f32_16x16x32_bf16 v[196:199], v[216:219], v[160:163], 0
  ds_read_b128 v[216:219], v1 offset:31744
  v_mul_f32 v193, s93, v193
  v_mfma_f32_16x16x32_bf16 v[196:199], v[220:223], v[164:167], v[196:199]
  ds_read_b128 v[220:223], v1 offset:30720
  v_mul_f32 v194, s93, v194
  v_mfma_f32_16x16x32_bf16 v[196:199], v[224:227], v[168:171], v[196:199]
  ds_read_b128 v[224:227], v1 offset:29696
  v_mul_f32 v195, s93, v195
  v_mfma_f32_16x16x32_bf16 v[196:199], v[228:231], v[172:175], v[196:199]
  v_cvt_pk_bf16_f32 v120, v192, v193
  v_cvt_pk_bf16_f32 v121, v194, v195
  v_mfma_f32_16x16x32_bf16 v[196:199], v[232:235], v[176:179], v[196:199]
  v_mul_f32 v184, s93, v184
  v_mul_f32 v185, s93, v185
  v_mfma_f32_16x16x32_bf16 v[196:199], v[236:239], v[180:183], v[196:199]
  v_mul_f32 v186, s93, v186
  v_mul_f32 v187, s93, v187
  v_mfma_f32_16x16x32_bf16 v[188:191], v[228:231], v[148:151], v[188:191]
  ds_read_b128 v[228:231], v1 offset:28672
  v_cvt_pk_bf16_f32 v96, v184, v185
  v_mfma_f32_16x16x32_bf16 v[188:191], v[232:235], v[152:155], v[188:191]
  ds_read_b128 v[232:235], v1 offset:27648
  v_cvt_pk_bf16_f32 v97, v186, v187
  v_mfma_f32_16x16x32_bf16 v[188:191], v[236:239], v[156:159], v[188:191]
  ds_read_b128 v[236:239], v1 offset:26624
  s_waitcnt lgkmcnt(6)
  v_mfma_f32_16x16x32_bf16 v[200:203], v[240:243], v[136:139], 0
  v_mul_f32 v196, s93, v196
  v_mul_f32 v197, s93, v197
  v_mfma_f32_16x16x32_bf16 v[200:203], v[244:247], v[140:143], v[200:203]
  v_mul_f32 v198, s93, v198
  v_mul_f32 v199, s93, v199
  v_mfma_f32_16x16x32_bf16 v[200:203], v[248:251], v[144:147], v[200:203]
  v_cvt_pk_bf16_f32 v122, v196, v197
  v_cvt_pk_bf16_f32 v123, v198, v199
  v_mfma_f32_16x16x32_bf16 v[208:211], v[240:243], v[160:163], 0
  ds_read_b128 v[240:243], v1 offset:25600
  v_mul_f32 v188, s93, v188
  v_mfma_f32_16x16x32_bf16 v[208:211], v[244:247], v[164:167], v[208:211]
  ds_read_b128 v[244:247], v1 offset:24576
  v_mul_f32 v189, s93, v189
  v_mfma_f32_16x16x32_bf16 v[208:211], v[248:251], v[168:171], v[208:211]
  ds_read_b128 v[248:251], v1 offset:23552
  v_mul_f32 v190, s93, v190
  v_mfma_f32_16x16x32_bf16 v[208:211], v[252:255], v[172:175], v[208:211]
  v_mul_f32 v191, s93, v191
  s_waitcnt lgkmcnt(5)
  v_mfma_f32_16x16x32_bf16 v[208:211], v[216:219], v[176:179], v[208:211]
  v_cvt_pk_bf16_f32 v98, v188, v189
  v_cvt_pk_bf16_f32 v99, v190, v191
  v_mfma_f32_16x16x32_bf16 v[208:211], v[220:223], v[180:183], v[208:211]
  v_cndmask_b32 v28, v64, v32, s[52:53]
  v_cndmask_b32 v29, v64, v33, s[52:53]
  v_mfma_f32_16x16x32_bf16 v[200:203], v[252:255], v[148:151], v[200:203]
  ds_read_b128 v[252:255], v1 offset:22528
  v_cndmask_b32 v30, v64, v34, s[52:53]
  v_mfma_f32_16x16x32_bf16 v[200:203], v[216:219], v[152:155], v[200:203]
  ds_read_b128 v[216:219], v1 offset:21504
  v_cndmask_b32 v31, v64, v35, s[52:53]
  v_mfma_f32_16x16x32_bf16 v[200:203], v[220:223], v[156:159], v[200:203]
  ds_read_b128 v[220:223], v1 offset:20480
  v_cndmask_b32 v24, v64, v32, s[54:55]
  v_mfma_f32_16x16x32_bf16 v[204:207], v[224:227], v[136:139], 0
  v_mul_f32 v208, s93, v208
  v_mul_f32 v209, s93, v209
  v_mfma_f32_16x16x32_bf16 v[204:207], v[228:231], v[140:143], v[204:207]
  v_mul_f32 v210, s93, v210
  s_waitcnt lgkmcnt(4)
  v_mfma_f32_16x16x32_bf16 v[204:207], v[232:235], v[144:147], v[204:207]
  v_mul_f32 v211, s93, v211
  v_cvt_pk_bf16_f32 v124, v208, v209
  v_mfma_f32_16x16x32_bf16 v[212:215], v[224:227], v[160:163], 0
  ds_read_b128 v[224:227], v1 offset:19456
  v_cvt_pk_bf16_f32 v125, v210, v211
  v_mfma_f32_16x16x32_bf16 v[212:215], v[228:231], v[164:167], v[212:215]
  ds_read_b128 v[228:231], v1 offset:18432
  v_mul_f32 v200, s93, v200
  v_mfma_f32_16x16x32_bf16 v[212:215], v[232:235], v[168:171], v[212:215]
  ds_read_b128 v[232:235], v1 offset:17408
  v_mul_f32 v201, s93, v201
  v_mfma_f32_16x16x32_bf16 v[212:215], v[236:239], v[172:175], v[212:215]
  v_mul_f32 v202, s93, v202
  v_mul_f32 v203, s93, v203
  v_mfma_f32_16x16x32_bf16 v[212:215], v[240:243], v[176:179], v[212:215]
  v_cvt_pk_bf16_f32 v100, v200, v201
  v_cvt_pk_bf16_f32 v101, v202, v203
  v_mfma_f32_16x16x32_bf16 v[212:215], v[244:247], v[180:183], v[212:215]
  v_mfma_f32_16x16x32_bf16 v[204:207], v[236:239], v[148:151], v[204:207]
  ds_read_b128 v[236:239], v1 offset:16384
  v_mfma_f32_16x16x32_bf16 v[204:207], v[240:243], v[152:155], v[204:207]
  ds_read_b128 v[240:243], v1 offset:15360
  v_mfma_f32_16x16x32_bf16 v[204:207], v[244:247], v[156:159], v[204:207]
  ds_read_b128 v[244:247], v1 offset:14336
  s_waitcnt lgkmcnt(6)
  v_mfma_f32_16x16x32_bf16 v[184:187], v[248:251], v[136:139], 0
  v_mul_f32 v212, s93, v212
  v_mul_f32 v213, s93, v213
  v_mfma_f32_16x16x32_bf16 v[184:187], v[252:255], v[140:143], v[184:187]
  v_mul_f32 v214, s93, v214
  v_mul_f32 v215, s93, v215
  v_mfma_f32_16x16x32_bf16 v[184:187], v[216:219], v[144:147], v[184:187]
  v_cvt_pk_bf16_f32 v126, v212, v213
  v_cvt_pk_bf16_f32 v127, v214, v215
  v_mfma_f32_16x16x32_bf16 v[192:195], v[248:251], v[160:163], 0
  ds_read_b128 v[248:251], v1 offset:13312
  v_mul_f32 v204, s93, v204
  v_mfma_f32_16x16x32_bf16 v[192:195], v[252:255], v[164:167], v[192:195]
  ds_read_b128 v[252:255], v1 offset:12288
  v_mul_f32 v205, s93, v205
  v_mfma_f32_16x16x32_bf16 v[192:195], v[216:219], v[168:171], v[192:195]
  ds_read_b128 v[216:219], v1 offset:11264
  v_mul_f32 v206, s93, v206
  v_mfma_f32_16x16x32_bf16 v[192:195], v[220:223], v[172:175], v[192:195]
  v_mul_f32 v207, s93, v207
  s_waitcnt lgkmcnt(5)
  v_mfma_f32_16x16x32_bf16 v[192:195], v[224:227], v[176:179], v[192:195]
  v_cvt_pk_bf16_f32 v102, v204, v205
  v_cvt_pk_bf16_f32 v103, v206, v207
  v_mfma_f32_16x16x32_bf16 v[192:195], v[228:231], v[180:183], v[192:195]
  v_cndmask_b32 v25, v64, v33, s[54:55]
  v_cndmask_b32 v26, v64, v34, s[54:55]
  v_mfma_f32_16x16x32_bf16 v[184:187], v[220:223], v[148:151], v[184:187]
  ds_read_b128 v[220:223], v1 offset:10240
  v_cndmask_b32 v27, v64, v35, s[54:55]
  v_mfma_f32_16x16x32_bf16 v[184:187], v[224:227], v[152:155], v[184:187]
  ds_read_b128 v[224:227], v1 offset:9216
  v_mfma_f32_16x16x32_bf16 v[184:187], v[228:231], v[156:159], v[184:187]
  ds_read_b128 v[228:231], v1 offset:8192
  v_mfma_f32_16x16x32_bf16 v[188:191], v[232:235], v[136:139], 0
  v_mul_f32 v192, s93, v192
  v_mul_f32 v193, s93, v193
  v_mfma_f32_16x16x32_bf16 v[188:191], v[236:239], v[140:143], v[188:191]
  v_mul_f32 v194, s93, v194
  s_waitcnt lgkmcnt(4)
  v_mfma_f32_16x16x32_bf16 v[188:191], v[240:243], v[144:147], v[188:191]
  v_mul_f32 v195, s93, v195
  v_cvt_pk_bf16_f32 v128, v192, v193
  v_mfma_f32_16x16x32_bf16 v[196:199], v[232:235], v[160:163], 0
  ds_read_b128 v[232:235], v1 offset:7168
  v_cvt_pk_bf16_f32 v129, v194, v195
  v_mfma_f32_16x16x32_bf16 v[196:199], v[236:239], v[164:167], v[196:199]
  ds_read_b128 v[236:239], v1 offset:6144
  v_mul_f32 v184, s93, v184
  v_mfma_f32_16x16x32_bf16 v[196:199], v[240:243], v[168:171], v[196:199]
  ds_read_b128 v[240:243], v1 offset:5120
  v_mul_f32 v185, s93, v185
  v_mfma_f32_16x16x32_bf16 v[196:199], v[244:247], v[172:175], v[196:199]
  v_mul_f32 v186, s93, v186
  v_mul_f32 v187, s93, v187
  s_cbranch_vccnz SL41
  s_barrier
SL41:
  v_mfma_f32_16x16x32_bf16 v[196:199], v[248:251], v[176:179], v[196:199]
  v_cvt_pk_bf16_f32 v104, v184, v185
  v_cvt_pk_bf16_f32 v105, v186, v187
  v_mfma_f32_16x16x32_bf16 v[196:199], v[252:255], v[180:183], v[196:199]
  v_mfma_f32_16x16x32_bf16 v[188:191], v[244:247], v[148:151], v[188:191]
  ds_read_b128 v[244:247], v1 offset:4096
  v_mfma_f32_16x16x32_bf16 v[188:191], v[248:251], v[152:155], v[188:191]
  ds_read_b128 v[248:251], v1 offset:3072
  v_mfma_f32_16x16x32_bf16 v[188:191], v[252:255], v[156:159], v[188:191]
  ds_read_b128 v[252:255], v1 offset:2048
  s_waitcnt lgkmcnt(6)
  v_mfma_f32_16x16x32_bf16 v[200:203], v[216:219], v[136:139], 0
  v_mul_f32 v196, s93, v196
  v_mul_f32 v197, s93, v197
  s_cbranch_vccz SL42
  s_waitcnt vmcnt(0)
  s_barrier
SL42:
  v_mfma_f32_16x16x32_bf16 v[200:203], v[220:223], v[140:143], v[200:203]
  v_mul_f32 v198, s93, v198
  v_mul_f32 v199, s93, v199
  v_mfma_f32_16x16x32_bf16 v[200:203], v[224:227], v[144:147], v[200:203]
  v_cvt_pk_bf16_f32 v130, v196, v197
  v_cvt_pk_bf16_f32 v131, v198, v199
  v_mfma_f32_16x16x32_bf16 v[208:211], v[216:219], v[160:163], 0
  ds_read_b128 v[216:219], v1 offset:1024
  v_mul_f32 v188, s93, v188
  v_mfma_f32_16x16x32_bf16 v[208:211], v[220:223], v[164:167], v[208:211]
  ds_read_b128 v[220:223], v1 offset:0
  v_mul_f32 v189, s93, v189
  v_mfma_f32_16x16x32_bf16 v[208:211], v[224:227], v[168:171], v[208:211]
  v_mul_f32 v190, s93, v190
  v_mul_f32 v191, s93, v191
  v_mfma_f32_16x16x32_bf16 v[208:211], v[228:231], v[172:175], v[208:211]
  v_cvt_pk_bf16_f32 v106, v188, v189
  s_waitcnt lgkmcnt(4)
  v_mfma_f32_16x16x32_bf16 v[208:211], v[232:235], v[176:179], v[208:211]
  v_cvt_pk_bf16_f32 v107, v190, v191
  v_mfma_f32_16x16x32_bf16 v[208:211], v[236:239], v[180:183], v[208:211]
  v_mfma_f32_16x16x32_bf16 v[200:203], v[228:231], v[148:151], v[200:203]
  v_mfma_f32_16x16x32_bf16 v[200:203], v[232:235], v[152:155], v[200:203]
  v_mfma_f32_16x16x32_bf16 v[200:203], v[236:239], v[156:159], v[200:203]
  v_mfma_f32_16x16x32_bf16 v[204:207], v[240:243], v[136:139], 0
  v_mfma_f32_16x16x32_bf16 v[204:207], v[244:247], v[140:143], v[204:207]
  s_waitcnt lgkmcnt(3)
  v_mfma_f32_16x16x32_bf16 v[204:207], v[248:251], v[144:147], v[204:207]
  v_mfma_f32_16x16x32_bf16 v[212:215], v[240:243], v[160:163], 0
  v_mul_f32 v208, s93, v208
  v_mul_f32 v209, s93, v209
  v_mfma_f32_16x16x32_bf16 v[212:215], v[244:247], v[164:167], v[212:215]
  v_mul_f32 v210, s93, v210
  v_mul_f32 v211, s93, v211
  v_mfma_f32_16x16x32_bf16 v[212:215], v[248:251], v[168:171], v[212:215]
  v_cvt_pk_bf16_f32 v132, v208, v209
  s_waitcnt lgkmcnt(2)
  v_mfma_f32_16x16x32_bf16 v[212:215], v[252:255], v[172:175], v[212:215]
  v_cvt_pk_bf16_f32 v133, v210, v211
  s_waitcnt lgkmcnt(1)
  v_mfma_f32_16x16x32_bf16 v[212:215], v[216:219], v[176:179], v[212:215]
  v_mul_f32 v200, s93, v200
  s_waitcnt lgkmcnt(0)
  v_mfma_f32_16x16x32_bf16 v[212:215], v[220:223], v[180:183], v[212:215]
  v_mul_f32 v201, s93, v201
  v_mul_f32 v202, s93, v202
  v_mfma_f32_16x16x32_bf16 v[204:207], v[252:255], v[148:151], v[204:207]
  v_mul_f32 v203, s93, v203
  v_cvt_pk_bf16_f32 v108, v200, v201
  v_mfma_f32_16x16x32_bf16 v[204:207], v[216:219], v[152:155], v[204:207]
  v_cvt_pk_bf16_f32 v109, v202, v203
  v_mfma_f32_16x16x32_bf16 v[204:207], v[220:223], v[156:159], v[204:207]
  s_cbranch_vccnz SL43
  s_setprio 0
  s_mul_i32 s100, s32, 7
  s_add_i32 s100, s100, s31
  s_add_u32 m0, s38, 107520
  s_nop 0
  buffer_load_dwordx4 v13, s[12:15], s100 offen lds
  s_add_u32 m0, s38, 108544
  s_nop 0
  buffer_load_dwordx4 v14, s[12:15], s100 offen lds
  s_add_u32 m0, s38, 109568
  s_nop 0
  buffer_load_dwordx4 v3, s[12:15], s100 offen lds
  s_add_u32 m0, s39, 107520
  s_nop 0
  buffer_load_dwordx4 v4, s[12:15], s100 offen lds
  s_mul_i32 s100, s32, 6
  s_add_i32 s100, s100, s31
  s_add_u32 m0, s38, 92160
  s_nop 0
  buffer_load_dwordx4 v13, s[12:15], s100 offen lds
  s_add_u32 m0, s38, 93184
  s_nop 0
  buffer_load_dwordx4 v14, s[12:15], s100 offen lds
  s_add_u32 m0, s38, 94208
  s_nop 0
  buffer_load_dwordx4 v3, s[12:15], s100 offen lds
  s_add_u32 m0, s39, 92160
  s_nop 0
  buffer_load_dwordx4 v4, s[12:15], s100 offen lds
  s_mul_i32 s100, s32, 5
  s_add_i32 s100, s100, s31
  s_add_u32 m0, s38, 76800
  s_nop 0
  buffer_load_dwordx4 v13, s[12:15], s100 offen lds
  s_add_u32 m0, s38, 77824
  s_nop 0
  buffer_load_dwordx4 v14, s[12:15], s100 offen lds
  s_add_u32 m0, s38, 78848
  s_nop 0
  buffer_load_dwordx4 v3, s[12:15], s100 offen lds
  s_add_u32 m0, s39, 76800
  s_nop 0
  buffer_load_dwordx4 v4, s[12:15], s100 offen lds
  s_barrier
  s_mul_i32 s100, s32, 4
  s_add_i32 s100, s100, s31
  s_add_u32 m0, s38, 61440
  s_nop 0
  buffer_load_dwordx4 v13, s[12:15], s100 offen lds
  s_add_u32 m0, s38, 62464
  s_nop 0
  buffer_load_dwordx4 v14, s[12:15], s100 offen lds
  s_add_u32 m0, s38, 63488
  s_nop 0
  buffer_load_dwordx4 v3, s[12:15], s100 offen lds
  s_add_u32 m0, s39, 61440
  s_nop 0
  buffer_load_dwordx4 v4, s[12:15], s100 offen lds
  s_mul_i32 s100, s32, 3
  s_add_i32 s100, s100, s31
  s_add_u32 m0, s38, 46080
  s_nop 0
  buffer_load_dwordx4 v13, s[12:15], s100 offen lds
  s_add_u32 m0, s38, 47104
  s_nop 0
  buffer_load_dwordx4 v14, s[12:15], s100 offen lds
  s_add_u32 m0, s38, 48128
  s_nop 0
  buffer_load_dwordx4 v3, s[12:15], s100 offen lds
  s_add_u32 m0, s39, 46080
  s_nop 0
  buffer_load_dwordx4 v4, s[12:15], s100 offen lds
  s_mul_i32 s100, s32, 2
  s_add_i32 s100, s100, s31
  s_add_u32 m0, s38, 30720
  s_nop 0
  buffer_load_dwordx4 v13, s[12:15], s100 offen lds
  s_add_u32 m0, s38, 31744
  s_nop 0
  buffer_load_dwordx4 v14, s[12:15], s100 offen lds
  s_add_u32 m0, s38, 32768
  s_nop 0
  buffer_load_dwordx4 v3, s[12:15], s100 offen lds
  s_add_u32 m0, s39, 30720
  s_nop 0
  buffer_load_dwordx4 v4, s[12:15], s100 offen lds
  s_waitcnt vmcnt(12)
  s_barrier
  s_max_u32 s100, s33, 1
  s_mul_i32 s100, s100, s32
  s_add_i32 s100, s100, s31
  s_add_u32 m0, s38, 15360
  s_nop 0
  buffer_load_dwordx4 v13, s[12:15], s100 offen lds
  s_add_u32 m0, s38, 16384
  s_nop 0
  buffer_load_dwordx4 v14, s[12:15], s100 offen lds
  s_add_u32 m0, s38, 17408
  s_nop 0
  buffer_load_dwordx4 v3, s[12:15], s100 offen lds
  s_add_u32 m0, s39, 15360
  s_nop 0
  buffer_load_dwordx4 v4, s[12:15], s100 offen lds
  s_max_u32 s100, s33, 0
  s_mul_i32 s100, s100, s32
  s_add_i32 s100, s100, s31
  s_add_u32 m0, s38, 0
  s_nop 0
  buffer_load_dwordx4 v13, s[12:15], s100 offen lds
  s_add_u32 m0, s38, 1024
  s_nop 0
  buffer_load_dwordx4 v14, s[12:15], s100 offen lds
  s_add_u32 m0, s38, 2048
  s_nop 0
  buffer_load_dwordx4 v3, s[12:15], s100 offen lds
  s_add_u32 m0, s39, 0
  s_nop 0
  buffer_load_dwordx4 v4, s[12:15], s100 offen lds
  s_waitcnt vmcnt(8)
  s_barrier
SL43:
  ds_read_b128 v[224:227], v7 offset:61440
  ds_read_b128 v[228:231], v8 offset:61440
  ds_read_b128 v[232:235], v7 offset:61568
  ds_read_b128 v[236:239], v8 offset:61568
  ds_read_b128 v[240:243], v7 offset:61696
  ds_read_b128 v[244:247], v8 offset:61696
  ds_read_b128 v[248:251], v7 offset:53760
  ds_read_b128 v[252:255], v8 offset:53760
  ds_read_b128 v[216:219], v7 offset:53888
  ds_read_b128 v[220:223], v8 offset:53888
  s_waitcnt lgkmcnt(6)
  v_mfma_f32_16x16x32_bf16 v[84:87], v[224:227], v[112:115], v[84:87]
  ds_read_b128 v[224:227], v7 offset:54016
  v_mul_f32 v212, s93, v212
  v_mfma_f32_16x16x32_bf16 v[84:87], v[228:231], v[116:119], v[84:87]
  ds_read_b128 v[228:231], v8 offset:54016
  v_mul_f32 v213, s93, v213
  v_mfma_f32_16x16x32_bf16 v[84:87], v[232:235], v[120:123], v[84:87]
  ds_read_b128 v[232:235], v7 offset:46080
  v_mul_f32 v214, s93, v214
  v_mfma_f32_16x16x32_bf16 v[84:87], v[236:239], v[124:127], v[84:87]
  ds_read_b128 v[236:239], v8 offset:46080
  s_waitcnt lgkmcnt(6)
  v_mfma_f32_16x16x32_bf16 v[84:87], v[240:243], v[128:131], v[84:87]
  ds_read_b128 v[240:243], v7 offset:46208
  v_mul_f32 v215, s93, v215
  v_cvt_pk_bf16_f32 v134, v212, v213
  v_cvt_pk_bf16_f32 v135, v214, v215
  s_nop 1
  v_mfma_f32_16x16x32_bf16 v[84:87], v[244:247], v[132:135], v[84:87]
  ds_read_b128 v[244:247], v8 offset:46208
  v_mul_f32 v204, s93, v204
  v_mfma_f32_16x16x32_bf16 v[80:83], v[248:251], v[112:115], v[32:35]
  ds_read_b128 v[248:251], v7 offset:46336
  v_mul_f32 v205, s93, v205
  v_mfma_f32_16x16x32_bf16 v[80:83], v[252:255], v[116:119], v[80:83]
  ds_read_b128 v[252:255], v8 offset:46336
  s_waitcnt lgkmcnt(6)
  v_mfma_f32_16x16x32_bf16 v[80:83], v[216:219], v[120:123], v[80:83]
  ds_read_b128 v[216:219], v7 offset:38400
  v_mul_f32 v206, s93, v206
  v_mfma_f32_16x16x32_bf16 v[80:83], v[220:223], v[124:127], v[80:83]
  ds_read_b128 v[220:223], v8 offset:38400
  v_mul_f32 v207, s93, v207
  v_mfma_f32_16x16x32_bf16 v[80:83], v[224:227], v[128:131], v[80:83]
  ds_read_b128 v[224:227], v7 offset:38528
  v_cvt_pk_bf16_f32 v110, v204, v205
  v_mfma_f32_16x16x32_bf16 v[80:83], v[228:231], v[132:135], v[80:83]
  ds_read_b128 v[228:231], v8 offset:38528
  s_waitcnt vmcnt(0)
  s_barrier
  s_waitcnt lgkmcnt(6)
  v_mfma_f32_16x16x32_bf16 v[52:55], v[232:235], v[88:91], v[52:55]
  v_exp_f32 v204, v84
  v_mfma_f32_16x16x32_bf16 v[52:55], v[236:239], v[92:95], v[52:55]
  v_exp_f32 v205, v85
  v_mfma_f32_16x16x32_bf16 v[52:55], v[240:243], v[96:99], v[52:55]
  v_exp_f32 v208, v80
  v_mfma_f32_16x16x32_bf16 v[76:79], v[232:235], v[112:115], v[32:35]
  ds_read_b128 v[232:235], v7 offset:38656
  v_cvt_pk_bf16_f32 v111, v206, v207
  v_mfma_f32_16x16x32_bf16 v[76:79], v[236:239], v[116:119], v[76:79]
  v_exp_f32 v206, v86
  v_mfma_f32_16x16x32_bf16 v[76:79], v[240:243], v[120:123], v[76:79]
  v_exp_f32 v207, v87
  v_mfma_f32_16x16x32_bf16 v[76:79], v[244:247], v[124:127], v[76:79]
  ds_read_b128 v[236:239], v8 offset:38656
  s_waitcnt lgkmcnt(4)
  v_mfma_f32_16x16x32_bf16 v[76:79], v[248:251], v[128:131], v[76:79]
  ds_read_b128 v[240:243], v7 offset:30720
  v_add_u32 v2, 102400, v1
  v_mfma_f32_16x16x32_bf16 v[76:79], v[252:255], v[132:135], v[76:79]
  v_exp_f32 v209, v81
  v_mfma_f32_16x16x32_bf16 v[52:55], v[244:247], v[100:103], v[52:55]
  ds_read_b128 v[244:247], v8 offset:30720
  v_mov_b32 v192, 0x3f803f80
  v_mfma_f32_16x16x32_bf16 v[52:55], v[248:251], v[104:107], v[52:55]
  ds_read_b128 v[248:251], v7 offset:30848
  v_mov_b32 v193, 0x3f803f80
  v_mfma_f32_16x16x32_bf16 v[52:55], v[252:255], v[108:111], v[52:55]
  v_exp_f32 v210, v82
  v_mfma_f32_16x16x32_bf16 v[48:51], v[216:219], v[88:91], v[32:35]
  v_exp_f32 v211, v83
  v_mfma_f32_16x16x32_bf16 v[48:51], v[220:223], v[92:95], v[48:51]
  ds_read_b128 v[252:255], v8 offset:30848
  v_mov_b32 v194, 0x3f803f80
  s_waitcnt lgkmcnt(4)
  v_mfma_f32_16x16x32_bf16 v[48:51], v[224:227], v[96:99], v[48:51]
  v_exp_f32 v212, v76
  v_mfma_f32_16x16x32_bf16 v[72:75], v[216:219], v[112:115], v[32:35]
  ds_read_b128 v[216:219], v7 offset:30976
  v_mov_b32 v195, 0x3f803f80
  v_mfma_f32_16x16x32_bf16 v[72:75], v[220:223], v[116:119], v[72:75]
  ds_read_b128 v[220:223], v8 offset:30976
  v_cvt_pk_bf16_f32 v166, v204, v205
  v_mfma_f32_16x16x32_bf16 v[72:75], v[224:227], v[120:123], v[72:75]
  v_exp_f32 v213, v77
  v_mfma_f32_16x16x32_bf16 v[72:75], v[228:231], v[124:127], v[72:75]
  v_exp_f32 v214, v78
  v_mfma_f32_16x16x32_bf16 v[72:75], v[232:235], v[128:131], v[72:75]
  v_exp_f32 v215, v79
  v_mfma_f32_16x16x32_bf16 v[72:75], v[236:239], v[132:135], v[72:75]
  ds_read_b128 v[224:227], v7 offset:23040
  v_cvt_pk_bf16_f32 v167, v206, v207
  v_mfma_f32_16x16x32_bf16 v[48:51], v[228:231], v[100:103], v[48:51]
  ds_read_b128 v[228:231], v8 offset:23040
  v_cvt_pk_bf16_f32 v164, v208, v209
  v_mfma_f32_16x16x32_bf16 v[48:51], v[232:235], v[104:107], v[48:51]
  v_exp_f32 v196, v52
  v_mfma_f32_16x16x32_bf16 v[48:51], v[236:239], v[108:111], v[48:51]
  ds_read_b128 v[232:235], v7 offset:23168
  s_waitcnt lgkmcnt(5)
  v_mfma_f32_16x16x32_bf16 v[44:47], v[240:243], v[88:91], v[32:35]
  v_exp_f32 v197, v53
  v_mfma_f32_16x16x32_bf16 v[44:47], v[244:247], v[92:95], v[44:47]
  v_exp_f32 v198, v54
  v_mfma_f32_16x16x32_bf16 v[44:47], v[248:251], v[96:99], v[44:47]
  v_exp_f32 v199, v55
  v_mfma_f32_16x16x32_bf16 v[68:71], v[240:243], v[112:115], v[32:35]
  ds_read_b128 v[236:239], v8 offset:23168
  ds_read_b128 v[240:243], v7 offset:23296
  v_cvt_pk_bf16_f32 v165, v210, v211
  v_mfma_f32_16x16x32_bf16 v[68:71], v[244:247], v[116:119], v[68:71]
  ds_read_b128 v[244:247], v8 offset:23296
  v_cvt_pk_bf16_f32 v162, v212, v213
  v_mfma_f32_16x16x32_bf16 v[68:71], v[248:251], v[120:123], v[68:71]
  v_exp_f32 v204, v72
  v_mfma_f32_16x16x32_bf16 v[68:71], v[252:255], v[124:127], v[68:71]
  ds_read_b128 v[248:251], v7 offset:15360
  v_cvt_pk_bf16_f32 v163, v214, v215
  s_waitcnt lgkmcnt(5)
  v_mfma_f32_16x16x32_bf16 v[68:71], v[216:219], v[128:131], v[68:71]
  v_exp_f32 v205, v73
  v_mfma_f32_16x16x32_bf16 v[68:71], v[220:223], v[132:135], v[68:71]
  v_exp_f32 v206, v74
  v_mfma_f32_16x16x32_bf16 v[44:47], v[252:255], v[100:103], v[44:47]
  v_exp_f32 v207, v75
  v_mfma_f32_16x16x32_bf16 v[44:47], v[216:219], v[104:107], v[44:47]
  ds_read_b128 v[252:255], v8 offset:15360
  ds_read_b128 v[216:219], v7 offset:15488
  v_mfma_f32_16x16x32_bf16 v[44:47], v[220:223], v[108:111], v[44:47]
  ds_read_b128 v[220:223], v8 offset:15488
  v_cvt_pk_bf16_f32 v150, v196, v197
  v_mfma_f32_16x16x32_bf16 v[40:43], v[224:227], v[88:91], v[32:35]
  v_exp_f32 v200, v48
  v_mfma_f32_16x16x32_bf16 v[40:43], v[228:231], v[92:95], v[40:43]
  v_cvt_pk_bf16_f32 v151, v198, v199
  s_waitcnt lgkmcnt(4)
  v_mfma_f32_16x16x32_bf16 v[40:43], v[232:235], v[96:99], v[40:43]
  v_exp_f32 v201, v49
  v_mfma_f32_16x16x32_bf16 v[64:67], v[224:227], v[112:115], v[32:35]
  v_exp_f32 v202, v50
  v_mfma_f32_16x16x32_bf16 v[64:67], v[228:231], v[116:119], v[64:67]
  v_exp_f32 v203, v51
  v_mfma_f32_16x16x32_bf16 v[64:67], v[232:235], v[120:123], v[64:67]
  ds_read_b128 v[224:227], v7 offset:15616
  ds_read_b128 v[228:231], v8 offset:15616
  v_cvt_pk_bf16_f32 v160, v204, v205
  v_mfma_f32_16x16x32_bf16 v[64:67], v[236:239], v[124:127], v[64:67]
  v_exp_f32 v208, v68
  v_mfma_f32_16x16x32_bf16 v[64:67], v[240:243], v[128:131], v[64:67]
  v_exp_f32 v209, v69
  v_mfma_f32_16x16x32_bf16 v[64:67], v[244:247], v[132:135], v[64:67]
  v_exp_f32 v210, v70
  v_mfma_f32_16x16x32_bf16 v[40:43], v[236:239], v[100:103], v[40:43]
  v_exp_f32 v211, v71
  v_mfma_f32_16x16x32_bf16 v[40:43], v[240:243], v[104:107], v[40:43]
  ds_read_b128 v[232:235], v7 offset:7680
  ds_read_b128 v[236:239], v8 offset:7680
  v_mfma_f32_16x16x32_bf16 v[40:43], v[244:247], v[108:111], v[40:43]
  ds_read_b128 v[240:243], v7 offset:7808
  s_barrier
  s_waitcnt lgkmcnt(5)
  v_mfma_f32_16x16x32_bf16 v[36:39], v[248:251], v[88:91], v[32:35]
  v_exp_f32 v212, v64
  v_mfma_f32_16x16x32_bf16 v[36:39], v[252:255], v[92:95], v[36:39]
  v_exp_f32 v213, v65
  v_mfma_f32_16x16x32_bf16 v[36:39], v[216:219], v[96:99], v[36:39]
  v_exp_f32 v214, v66
  v_mfma_f32_16x16x32_bf16 v[60:63], v[248:251], v[112:115], v[32:35]
  v_exp_f32 v215, v67
  v_mfma_f32_16x16x32_bf16 v[60:63], v[252:255], v[116:119], v[60:63]
  ds_read_b128 v[244:247], v8 offset:7808
  ds_read_b128 v[248:251], v7 offset:7936
  v_cvt_pk_bf16_f32 v161, v206, v207
  v_mfma_f32_16x16x32_bf16 v[60:63], v[216:219], v[120:123], v[60:63]
  ds_read_b128 v[252:255], v8 offset:7936
  ds_read_b128 v[216:219], v7 offset:0
  v_cvt_pk_bf16_f32 v158, v208, v209
  v_mfma_f32_16x16x32_bf16 v[60:63], v[220:223], v[124:127], v[60:63]
  v_cvt_pk_bf16_f32 v159, v210, v211
  s_waitcnt lgkmcnt(5)
  v_mfma_f32_16x16x32_bf16 v[60:63], v[224:227], v[128:131], v[60:63]
  v_exp_f32 v196, v44
  v_mfma_f32_16x16x32_bf16 v[60:63], v[228:231], v[132:135], v[60:63]
  v_exp_f32 v197, v45
  v_mfma_f32_16x16x32_bf16 v[36:39], v[220:223], v[100:103], v[36:39]
  ds_read_b128 v[220:223], v8 offset:0
  v_cvt_pk_bf16_f32 v156, v212, v213
  v_mfma_f32_16x16x32_bf16 v[36:39], v[224:227], v[104:107], v[36:39]
  ds_read_b128 v[224:227], v7 offset:128
  v_cvt_pk_bf16_f32 v157, v214, v215
  v_mfma_f32_16x16x32_bf16 v[36:39], v[228:231], v[108:111], v[36:39]
  v_exp_f32 v198, v46
  v_mfma_f32_16x16x32_bf16 v[32:35], v[232:235], v[88:91], v[32:35]
  v_exp_f32 v204, v60
  v_mfma_f32_16x16x32_bf16 v[32:35], v[236:239], v[92:95], v[32:35]
  ds_read_b128 v[228:231], v8 offset:128
  v_cvt_pk_bf16_f32 v148, v200, v201
  s_waitcnt lgkmcnt(4)
  v_mfma_f32_16x16x32_bf16 v[32:35], v[240:243], v[96:99], v[32:35]
  v_exp_f32 v205, v61
  v_mfma_f32_16x16x32_bf16 v[56:59], v[232:235], v[112:115], v[56:59]
  v_exp_f32 v206, v62
  v_mfma_f32_16x16x32_bf16 v[56:59], v[236:239], v[116:119], v[56:59]
  v_exp_f32 v207, v63
  v_mfma_f32_16x16x32_bf16 v[56:59], v[240:243], v[120:123], v[56:59]
  v_exp_f32 v199, v47
  v_mfma_f32_16x16x32_bf16 v[56:59], v[244:247], v[124:127], v[56:59]
  ds_read_b128 v[232:235], v7 offset:256
  ds_read_b128 v[236:239], v8 offset:256
  v_cvt_pk_bf16_f32 v154, v204, v205
  v_mfma_f32_16x16x32_bf16 v[56:59], v[248:251], v[128:131], v[56:59]
  ds_read_b128 v[240:243], v20 offset:0
  v_cvt_pk_bf16_f32 v155, v206, v207
  v_mfma_f32_16x16x32_bf16 v[56:59], v[252:255], v[132:135], v[56:59]
  v_exp_f32 v200, v40
  v_mfma_f32_16x16x32_bf16 v[32:35], v[244:247], v[100:103], v[32:35]
  ds_read_b128 v[244:247], v0 offset:0
  v_cvt_pk_bf16_f32 v149, v202, v203
  v_mfma_f32_16x16x32_bf16 v[32:35], v[248:251], v[104:107], v[32:35]
  v_exp_f32 v201, v41
  v_mfma_f32_16x16x32_bf16 v[32:35], v[252:255], v[108:111], v[32:35]
  ds_read_b128 v[248:251], v20 offset:128
  s_waitcnt lgkmcnt(5)
  v_mfma_f32_16x16x32_bf16 v[28:31], v[216:219], v[88:91], v[28:31]
  v_exp_f32 v208, v56
  v_mfma_f32_16x16x32_bf16 v[28:31], v[220:223], v[92:95], v[28:31]
  v_exp_f32 v209, v57
  v_mfma_f32_16x16x32_bf16 v[28:31], v[224:227], v[96:99], v[28:31]
  v_exp_f32 v210, v58
  v_mfma_f32_16x16x32_bf16 v[28:31], v[228:231], v[100:103], v[28:31]
  ds_read_b128 v[252:255], v0 offset:128
  v_cvt_pk_bf16_f32 v152, v208, v209
  s_waitcnt lgkmcnt(4)
  v_mfma_f32_16x16x32_bf16 v[28:31], v[232:235], v[104:107], v[28:31]
  ds_read_b128 v[216:219], v20 offset:256
  ds_read_b128 v[220:223], v0 offset:256
  v_cvt_pk_bf16_f32 v146, v196, v197
  v_mfma_f32_16x16x32_bf16 v[28:31], v[236:239], v[108:111], v[28:31]
  ds_read_b64_tr_b16 v[224:225], v9 offset:38400
  ds_read_b64_tr_b16 v[226:227], v9 offset:46080
  v_cvt_pk_bf16_f32 v147, v198, v199
  s_cbranch_vccnz SL46
  s_barrier
SL46:
  s_waitcnt lgkmcnt(4)
  v_mfma_f32_16x16x32_bf16 v[24:27], v[240:243], v[88:91], v[24:27]
  v_exp_f32 v211, v59
  v_mfma_f32_16x16x32_bf16 v[24:27], v[244:247], v[92:95], v[24:27]
  ds_read_b64_tr_b16 v[228:229], v10 offset:38400
  ds_read_b64_tr_b16 v[230:231], v10 offset:46080
  v_cvt_pk_bf16_f32 v153, v210, v211
  v_mfma_f32_16x16x32_bf16 v[24:27], v[248:251], v[96:99], v[24:27]
  ds_read_b64_tr_b16 v[232:233], v11 offset:38400
  ds_read_b64_tr_b16 v[234:235], v11 offset:46080
  v_cvt_pk_bf16_f32 v144, v200, v201
  v_mfma_f32_16x16x32_bf16 v[188:191], v[192:195], v[164:167], 0
  ds_read_b64_tr_b16 v[236:237], v12 offset:38400
  ds_read_b64_tr_b16 v[238:239], v12 offset:46080
  v_exp_f32 v202, v42
  v_mfma_f32_16x16x32_bf16 v[188:191], v[192:195], v[160:163], v[188:191]
  v_exp_f32 v203, v43
  v_mfma_f32_16x16x32_bf16 v[188:191], v[192:195], v[156:159], v[188:191]
  v_exp_f32 v196, v36
  v_mfma_f32_16x16x32_bf16 v[188:191], v[192:195], v[152:155], v[188:191]
  v_exp_f32 v197, v37
  v_mfma_f32_16x16x32_bf16 v[24:27], v[252:255], v[100:103], v[24:27]
  ds_read_b64_tr_b16 v[240:241], v9 offset:38528
  ds_read_b64_tr_b16 v[242:243], v9 offset:46208
  v_cvt_pk_bf16_f32 v145, v202, v203
  s_waitcnt lgkmcnt(8)
  v_mfma_f32_16x16x32_bf16 v[24:27], v[216:219], v[104:107], v[24:27]
  v_exp_f32 v198, v38
  v_mfma_f32_16x16x32_bf16 v[24:27], v[220:223], v[108:111], v[24:27]
  ds_read_b64_tr_b16 v[244:245], v10 offset:38528
  ds_read_b64_tr_b16 v[246:247], v10 offset:46208
  v_cvt_pk_bf16_f32 v142, v196, v197
  v_subrev_u32 v23, 813694976, v188
  s_mov_b32 s52, 503316480
  v_cmp_gt_u32 s[48:49], s52, v23
  s_or_b64 s[48:49], s[48:49], s[44:45]
  s_cmp_eq_u64 s[48:49], -1
  s_cbranch_scc0 FB1
FBR1:
  v_mfma_f32_16x16x32_bf16 v[88:91], v[224:227], v[160:163], 0
  ds_read_b64_tr_b16 v[248:249], v11 offset:38528
  ds_read_b64_tr_b16 v[250:251], v11 offset:46208
  v_exp_f32 v199, v39
  v_mfma_f32_16x16x32_bf16 v[56:59], v[224:227], v[148:151], 0
  ds_read_b64_tr_b16 v[252:253], v12 offset:38528
  ds_read_b64_tr_b16 v[254:255], v12 offset:46208
  v_cvt_pk_bf16_f32 v143, v198, v199
  s_waitcnt lgkmcnt(8)
  v_mfma_f32_16x16x32_bf16 v[92:95], v[228:231], v[160:163], 0
  v_exp_f32 v200, v32
  v_mfma_f32_16x16x32_bf16 v[60:63], v[228:231], v[148:151], 0
  v_exp_f32 v201, v33
  v_mfma_f32_16x16x32_bf16 v[96:99], v[232:235], v[160:163], 0
  ds_read_b64_tr_b16 v[216:217], v9 offset:38656
  ds_read_b64_tr_b16 v[218:219], v9 offset:46336
  v_cvt_pk_bf16_f32 v140, v200, v201
  v_mfma_f32_16x16x32_bf16 v[64:67], v[232:235], v[148:151], 0
  v_exp_f32 v202, v34
  v_mfma_f32_16x16x32_bf16 v[100:103], v[236:239], v[160:163], 0
  ds_read_b64_tr_b16 v[220:221], v10 offset:38656
  ds_read_b64_tr_b16 v[222:223], v10 offset:46336
  v_exp_f32 v203, v35
  v_mfma_f32_16x16x32_bf16 v[68:71], v[236:239], v[148:151], 0
  ds_read_b64_tr_b16 v[224:225], v11 offset:38656
  ds_read_b64_tr_b16 v[226:227], v11 offset:46336
  v_cvt_pk_bf16_f32 v141, v202, v203
  s_waitcnt lgkmcnt(8)
  v_mfma_f32_16x16x32_bf16 v[104:107], v[240:243], v[160:163], 0
  v_exp_f32 v196, v28
  v_mfma_f32_16x16x32_bf16 v[72:75], v[240:243], v[148:151], 0
  v_exp_f32 v197, v29
  v_mfma_f32_16x16x32_bf16 v[108:111], v[244:247], v[160:163], 0
  ds_read_b64_tr_b16 v[228:229], v12 offset:38656
  ds_read_b64_tr_b16 v[230:231], v12 offset:46336
  v_mfma_f32_16x16x32_bf16 v[76:79], v[244:247], v[148:151], 0
  v_exp_f32 v198, v30
  v_mfma_f32_16x16x32_bf16 v[112:115], v[248:251], v[160:163], 0
  ds_read_b64_tr_b16 v[232:233], v9 offset:53760
  ds_read_b64_tr_b16 v[234:235], v9 offset:61440
  v_mfma_f32_16x16x32_bf16 v[80:83], v[248:251], v[148:151], 0
  ds_read_b64_tr_b16 v[236:237], v10 offset:53760
  ds_read_b64_tr_b16 v[238:239], v10 offset:61440
  s_waitcnt lgkmcnt(8)
  v_mfma_f32_16x16x32_bf16 v[116:119], v[252:255], v[160:163], 0
  v_exp_f32 v199, v31
  v_mfma_f32_16x16x32_bf16 v[84:87], v[252:255], v[148:151], 0
  v_exp_f32 v200, v24
  v_mfma_f32_16x16x32_bf16 v[120:123], v[216:219], v[160:163], 0
  ds_read_b64_tr_b16 v[240:241], v11 offset:53760
  ds_read_b64_tr_b16 v[242:243], v11 offset:61440
  v_mfma_f32_16x16x32_bf16 v[168:171], v[216:219], v[148:151], 0
  v_exp_f32 v201, v25
  v_mfma_f32_16x16x32_bf16 v[124:127], v[220:223], v[160:163], 0
  ds_read_b64_tr_b16 v[244:245], v12 offset:53760
  ds_read_b64_tr_b16 v[246:247], v12 offset:61440
  v_mfma_f32_16x16x32_bf16 v[172:175], v[220:223], v[148:151], 0
  ds_read_b64_tr_b16 v[248:249], v9 offset:53888
  ds_read_b64_tr_b16 v[250:251], v9 offset:61568
  s_waitcnt lgkmcnt(8)
  v_mfma_f32_16x16x32_bf16 v[128:131], v[224:227], v[160:163], 0
  v_exp_f32 v202, v26
  v_mfma_f32_16x16x32_bf16 v[176:179], v[224:227], v[148:151], 0
  v_exp_f32 v203, v27
  v_mfma_f32_16x16x32_bf16 v[132:135], v[228:231], v[160:163], 0
  ds_read_b64_tr_b16 v[252:253], v10 offset:53888
  ds_read_b64_tr_b16 v[254:255], v10 offset:61568
  v_mfma_f32_16x16x32_bf16 v[180:183], v[228:231], v[148:151], 0
  ds_read_b64_tr_b16 v[216:217], v11 offset:53888
  ds_read_b64_tr_b16 v[218:219], v11 offset:61568
  v_cvt_pk_bf16_f32 v138, v196, v197
  v_cvt_pk_bf16_f32 v139, v198, v199
  v_cvt_pk_bf16_f32 v136, v200, v201
  v_cvt_pk_bf16_f32 v137, v202, v203
  v_mfma_f32_16x16x32_bf16 v[184:187], v[192:195], v[148:151], 0
  ds_read_b64_tr_b16 v[220:221], v12 offset:53888
  ds_read_b64_tr_b16 v[222:223], v12 offset:61568
  v_mfma_f32_16x16x32_bf16 v[184:187], v[192:195], v[144:147], v[184:187]
  v_mfma_f32_16x16x32_bf16 v[184:187], v[192:195], v[140:143], v[184:187]
  v_mfma_f32_16x16x32_bf16 v[184:187], v[192:195], v[136:139], v[184:187]
  s_cbranch_vccnz SL47
  s_barrier
SL47:
  v_mfma_f32_16x16x32_bf16 v[88:91], v[232:235], v[164:167], v[88:91]
  s_waitcnt lgkmcnt(8)
  v_mfma_f32_16x16x32_bf16 v[92:95], v[236:239], v[164:167], v[92:95]
  ds_read_b64_tr_b16 v[224:225], v9 offset:54016
  ds_read_b64_tr_b16 v[226:227], v9 offset:61696
  v_mfma_f32_16x16x32_bf16 v[96:99], v[240:243], v[164:167], v[96:99]
  ds_read_b64_tr_b16 v[228:229], v10 offset:54016
  ds_read_b64_tr_b16 v[230:231], v10 offset:61696
  v_subrev_u32 v23, 813694976, v184
  s_mov_b32 s52, 503316480
  v_cmp_gt_u32 s[48:49], s52, v23
  s_or_b64 s[48:49], s[48:49], s[42:43]
  s_cmp_eq_u64 s[48:49], -1
  s_cbranch_scc0 FB0
FBR0:
  v_mfma_f32_16x16x32_bf16 v[100:103], v[244:247], v[164:167], v[100:103]
  ds_read_b64_tr_b16 v[232:233], v11 offset:54016
  ds_read_b64_tr_b16 v[234:235], v11 offset:61696
  s_waitcnt lgkmcnt(8)
  v_mfma_f32_16x16x32_bf16 v[104:107], v[248:251], v[164:167], v[104:107]
  v_rcp_f32 v23, v188
  v_mfma_f32_16x16x32_bf16 v[108:111], v[252:255], v[164:167], v[108:111]
  ds_read_b64_tr_b16 v[236:237], v12 offset:54016
  ds_read_b64_tr_b16 v[238:239], v12 offset:61696
  v_mfma_f32_16x16x32_bf16 v[112:115], v[216:219], v[164:167], v[112:115]
  ds_read_b64_tr_b16 v[240:241], v9 offset:23040
  ds_read_b64_tr_b16 v[242:243], v9 offset:30720
  s_waitcnt lgkmcnt(8)
  v_mfma_f32_16x16x32_bf16 v[116:119], v[220:223], v[164:167], v[116:119]
  ds_read_b64_tr_b16 v[244:245], v10 offset:23040
  ds_read_b64_tr_b16 v[246:247], v10 offset:30720
  v_mfma_f32_16x16x32_bf16 v[120:123], v[224:227], v[164:167], v[120:123]
  ds_read_b64_tr_b16 v[248:249], v11 offset:23040
  ds_read_b64_tr_b16 v[250:251], v11 offset:30720
  s_waitcnt lgkmcnt(8)
  v_mfma_f32_16x16x32_bf16 v[124:127], v[228:231], v[164:167], v[124:127]
  ds_read_b64_tr_b16 v[252:253], v12 offset:23040
  ds_read_b64_tr_b16 v[254:255], v12 offset:30720
  v_mfma_f32_16x16x32_bf16 v[128:131], v[232:235], v[164:167], v[128:131]
  ds_read_b64_tr_b16 v[216:217], v9 offset:23168
  ds_read_b64_tr_b16 v[218:219], v9 offset:30848
  s_waitcnt lgkmcnt(8)
  v_mfma_f32_16x16x32_bf16 v[132:135], v[236:239], v[164:167], v[132:135]
  ds_read_b64_tr_b16 v[220:221], v10 offset:23168
  ds_read_b64_tr_b16 v[222:223], v10 offset:30848
  s_cbranch_vccz SL48
  s_barrier
SL48:
  v_mfma_f32_16x16x32_bf16 v[88:91], v[240:243], v[156:159], v[88:91]
  ds_read_b64_tr_b16 v[224:225], v11 offset:23168
  ds_read_b64_tr_b16 v[226:227], v11 offset:30848
  v_mfma_f32_16x16x32_bf16 v[56:59], v[240:243], v[144:147], v[56:59]
  ds_read_b64_tr_b16 v[228:229], v12 offset:23168
  ds_read_b64_tr_b16 v[230:231], v12 offset:30848
  s_waitcnt lgkmcnt(8)
  v_mfma_f32_16x16x32_bf16 v[92:95], v[244:247], v[156:159], v[92:95]
  v_rcp_f32 v22, v184
  v_mfma_f32_16x16x32_bf16 v[60:63], v[244:247], v[144:147], v[60:63]
  ds_read_b64_tr_b16 v[232:233], v9 offset:23296
  ds_read_b64_tr_b16 v[234:235], v9 offset:30976
  v_mfma_f32_16x16x32_bf16 v[96:99], v[248:251], v[156:159], v[96:99]
  ds_read_b64_tr_b16 v[236:237], v10 offset:23296
  ds_read_b64_tr_b16 v[238:239], v10 offset:30976
  v_mfma_f32_16x16x32_bf16 v[64:67], v[248:251], v[144:147], v[64:67]
  ds_read_b64_tr_b16 v[240:241], v11 offset:23296
  ds_read_b64_tr_b16 v[242:243], v11 offset:30976
  v_mfma_f32_16x16x32_bf16 v[100:103], v[252:255], v[156:159], v[100:103]
  v_mfma_f32_16x16x32_bf16 v[68:71], v[252:255], v[144:147], v[68:71]
  s_waitcnt lgkmcnt(8)
  v_mfma_f32_16x16x32_bf16 v[104:107], v[216:219], v[156:159], v[104:107]
  ds_read_b64_tr_b16 v[244:245], v12 offset:23296
  ds_read_b64_tr_b16 v[246:247], v12 offset:30976
  v_mfma_f32_16x16x32_bf16 v[72:75], v[216:219], v[144:147], v[72:75]
  ds_read_b64_tr_b16 v[248:249], v9 offset:7680
  ds_read_b64_tr_b16 v[250:251], v9 offset:15360
  v_mfma_f32_16x16x32_bf16 v[108:111], v[220:223], v[156:159], v[108:111]
  ds_read_b64_tr_b16 v[252:253], v10 offset:7680
  ds_read_b64_tr_b16 v[254:255], v10 offset:15360
  v_mfma_f32_16x16x32_bf16 v[76:79], v[220:223], v[144:147], v[76:79]
  v_mfma_f32_16x16x32_bf16 v[112:115], v[224:227], v[156:159], v[112:115]
  v_mfma_f32_16x16x32_bf16 v[80:83], v[224:227], v[144:147], v[80:83]
  s_waitcnt lgkmcnt(8)
  v_mfma_f32_16x16x32_bf16 v[116:119], v[228:231], v[156:159], v[116:119]
  ds_read_b64_tr_b16 v[216:217], v11 offset:7680
  ds_read_b64_tr_b16 v[218:219], v11 offset:15360
  v_mfma_f32_16x16x32_bf16 v[84:87], v[228:231], v[144:147], v[84:87]
  ds_read_b64_tr_b16 v[220:221], v12 offset:7680
  ds_read_b64_tr_b16 v[222:223], v12 offset:15360
  v_mfma_f32_16x16x32_bf16 v[120:123], v[232:235], v[156:159], v[120:123]
  ds_read_b64_tr_b16 v[224:225], v9 offset:7808
  ds_read_b64_tr_b16 v[226:227], v9 offset:15488
  v_mfma_f32_16x16x32_bf16 v[168:171], v[232:235], v[144:147], v[168:171]
  v_mfma_f32_16x16x32_bf16 v[124:127], v[236:239], v[156:159], v[124:127]
  v_mfma_f32_16x16x32_bf16 v[172:175], v[236:239], v[144:147], v[172:175]
  s_waitcnt lgkmcnt(8)
  v_mfma_f32_16x16x32_bf16 v[128:131], v[240:243], v[156:159], v[128:131]
  ds_read_b64_tr_b16 v[228:229], v10 offset:7808
  ds_read_b64_tr_b16 v[230:231], v10 offset:15488
  v_mfma_f32_16x16x32_bf16 v[176:179], v[240:243], v[144:147], v[176:179]
  ds_read_b64_tr_b16 v[232:233], v11 offset:7808
  ds_read_b64_tr_b16 v[234:235], v11 offset:15488
  v_mfma_f32_16x16x32_bf16 v[132:135], v[244:247], v[156:159], v[132:135]
  ds_read_b64_tr_b16 v[236:237], v12 offset:7808
  ds_read_b64_tr_b16 v[238:239], v12 offset:15488
  v_mfma_f32_16x16x32_bf16 v[180:183], v[244:247], v[144:147], v[180:183]
  v_mfma_f32_16x16x32_bf16 v[88:91], v[248:251], v[152:155], v[88:91]
  v_mfma_f32_16x16x32_bf16 v[56:59], v[248:251], v[140:143], v[56:59]
  s_waitcnt lgkmcnt(8)
  v_mfma_f32_16x16x32_bf16 v[92:95], v[252:255], v[152:155], v[92:95]
  ds_read_b64_tr_b16 v[240:241], v9 offset:7936
  ds_read_b64_tr_b16 v[242:243], v9 offset:15616
  v_mfma_f32_16x16x32_bf16 v[60:63], v[252:255], v[140:143], v[60:63]
  ds_read_b64_tr_b16 v[244:245], v10 offset:7936
  ds_read_b64_tr_b16 v[246:247], v10 offset:15616
  v_mfma_f32_16x16x32_bf16 v[96:99], v[216:219], v[152:155], v[96:99]
  ds_read_b64_tr_b16 v[248:249], v11 offset:7936
  ds_read_b64_tr_b16 v[250:251], v11 offset:15616
  v_mfma_f32_16x16x32_bf16 v[64:67], v[216:219], v[140:143], v[64:67]
  v_cvt_pk_bf16_f32 v156, v88, v89
  v_cvt_pk_bf16_f32 v157, v90, v91
  v_mfma_f32_16x16x32_bf16 v[100:103], v[220:223], v[152:155], v[100:103]
  v_cvt_pk_bf16_f32 v158, v92, v93
  v_cvt_pk_bf16_f32 v159, v94, v95
  v_mfma_f32_16x16x32_bf16 v[68:71], v[220:223], v[140:143], v[68:71]
  s_waitcnt lgkmcnt(8)
  v_mfma_f32_16x16x32_bf16 v[104:107], v[224:227], v[152:155], v[104:107]
  ds_read_b64_tr_b16 v[252:253], v12 offset:7936
  ds_read_b64_tr_b16 v[254:255], v12 offset:15616
  v_mfma_f32_16x16x32_bf16 v[72:75], v[224:227], v[140:143], v[72:75]
  ds_read_b64_tr_b16 v[216:217], v15 offset:0
  ds_read_b64_tr_b16 v[218:219], v9 offset:0
  v_mfma_f32_16x16x32_bf16 v[108:111], v[228:231], v[152:155], v[108:111]
  ds_read_b64_tr_b16 v[220:221], v16 offset:0
  ds_read_b64_tr_b16 v[222:223], v10 offset:0
  v_mfma_f32_16x16x32_bf16 v[76:79], v[228:231], v[140:143], v[76:79]
  v_cvt_pk_bf16_f32 v160, v96, v97
  v_cvt_pk_bf16_f32 v161, v98, v99
  v_mfma_f32_16x16x32_bf16 v[112:115], v[232:235], v[152:155], v[112:115]
  v_cvt_pk_bf16_f32 v162, v100, v101
  v_cvt_pk_bf16_f32 v163, v102, v103
  v_mfma_f32_16x16x32_bf16 v[80:83], v[232:235], v[140:143], v[80:83]
  v_cvt_pk_bf16_f32 v164, v104, v105
  s_waitcnt lgkmcnt(8)
  v_mfma_f32_16x16x32_bf16 v[116:119], v[236:239], v[152:155], v[116:119]
  ds_read_b64_tr_b16 v[224:225], v17 offset:0
  ds_read_b64_tr_b16 v[226:227], v11 offset:0
  v_mfma_f32_16x16x32_bf16 v[84:87], v[236:239], v[140:143], v[84:87]
  ds_read_b64_tr_b16 v[228:229], v18 offset:0
  ds_read_b64_tr_b16 v[230:231], v12 offset:0
  v_mfma_f32_16x16x32_bf16 v[120:123], v[240:243], v[152:155], v[120:123]
  ds_read_b64_tr_b16 v[232:233], v15 offset:128
  ds_read_b64_tr_b16 v[234:235], v9 offset:128
  v_mfma_f32_16x16x32_bf16 v[168:171], v[240:243], v[140:143], v[168:171]
  v_cvt_pk_bf16_f32 v165, v106, v107
  v_cvt_pk_bf16_f32 v166, v108, v109
  v_mfma_f32_16x16x32_bf16 v[124:127], v[244:247], v[152:155], v[124:127]
  v_cvt_pk_bf16_f32 v167, v110, v111
  v_cvt_pk_bf16_f32 v24, v112, v113
  v_mfma_f32_16x16x32_bf16 v[172:175], v[244:247], v[140:143], v[172:175]
  v_cvt_pk_bf16_f32 v25, v114, v115
  s_waitcnt lgkmcnt(8)
  v_mfma_f32_16x16x32_bf16 v[128:131], v[248:251], v[152:155], v[128:131]
  ds_read_b64_tr_b16 v[236:237], v16 offset:128
  ds_read_b64_tr_b16 v[238:239], v10 offset:128
  v_mfma_f32_16x16x32_bf16 v[176:179], v[248:251], v[140:143], v[176:179]
  ds_read_b64_tr_b16 v[240:241], v17 offset:128
  ds_read_b64_tr_b16 v[242:243], v11 offset:128
  v_mfma_f32_16x16x32_bf16 v[132:135], v[252:255], v[152:155], v[132:135]
  ds_read_b64_tr_b16 v[244:245], v18 offset:128
  ds_read_b64_tr_b16 v[246:247], v12 offset:128
  v_mfma_f32_16x16x32_bf16 v[180:183], v[252:255], v[140:143], v[180:183]
  v_cvt_pk_bf16_f32 v26, v116, v117
  v_cvt_pk_bf16_f32 v27, v118, v119
  v_mfma_f32_16x16x32_bf16 v[56:59], v[216:219], v[136:139], v[56:59]
  v_cvt_pk_bf16_f32 v28, v120, v121
  s_waitcnt lgkmcnt(8)
  v_mfma_f32_16x16x32_bf16 v[60:63], v[220:223], v[136:139], v[60:63]
  ds_read_b64_tr_b16 v[248:249], v15 offset:256
  ds_read_b64_tr_b16 v[250:251], v9 offset:256
  v_mfma_f32_16x16x32_bf16 v[64:67], v[224:227], v[136:139], v[64:67]
  ds_read_b64_tr_b16 v[252:253], v16 offset:256
  ds_read_b64_tr_b16 v[254:255], v10 offset:256
  v_mfma_f32_16x16x32_bf16 v[68:71], v[228:231], v[136:139], v[68:71]
  ds_read_b64_tr_b16 v[216:217], v17 offset:256
  ds_read_b64_tr_b16 v[218:219], v11 offset:256
  s_waitcnt lgkmcnt(8)
  v_mfma_f32_16x16x32_bf16 v[72:75], v[232:235], v[136:139], v[72:75]
  ds_read_b64_tr_b16 v[220:221], v18 offset:256
  ds_read_b64_tr_b16 v[222:223], v12 offset:256
  v_mfma_f32_16x16x32_bf16 v[76:79], v[236:239], v[136:139], v[76:79]
  v_cvt_pk_bf16_f32 v29, v122, v123
  v_cvt_pk_bf16_f32 v30, v124, v125
  s_waitcnt lgkmcnt(0)
  s_cbranch_vccz SL49
  s_barrier
SL49:
  ds_read_b128 v[224:227], v2 offset:30720
  ds_read_b128 v[228:231], v2 offset:31744
  ds_read_b128 v[232:235], v2 offset:32768
  ds_read_b128 v[236:239], v2 offset:33792
  v_mfma_f32_16x16x32_bf16 v[80:83], v[240:243], v[136:139], v[80:83]
  ds_read_b128 v[240:243], v2 offset:34816
  v_cvt_pk_bf16_f32 v31, v126, v127
  v_mfma_f32_16x16x32_bf16 v[84:87], v[244:247], v[136:139], v[84:87]
  ds_read_b128 v[244:247], v2 offset:35840
  v_cvt_pk_bf16_f32 v32, v128, v129
  v_mfma_f32_16x16x32_bf16 v[168:171], v[248:251], v[136:139], v[168:171]
  ds_read_b128 v[248:251], v2 offset:36864
  v_cvt_pk_bf16_f32 v33, v130, v131
  v_mfma_f32_16x16x32_bf16 v[172:175], v[252:255], v[136:139], v[172:175]
  ds_read_b128 v[252:255], v2 offset:37888
  v_cvt_pk_bf16_f32 v34, v132, v133
  v_mfma_f32_16x16x32_bf16 v[176:179], v[216:219], v[136:139], v[176:179]
  ds_read_b128 v[216:219], v2 offset:38912
  v_cvt_pk_bf16_f32 v35, v134, v135
  v_mfma_f32_16x16x32_bf16 v[180:183], v[220:223], v[136:139], v[180:183]
  ds_read_b128 v[220:223], v2 offset:39936
  s_waitcnt lgkmcnt(6)
  v_mfma_f32_16x16x32_bf16 v[192:195], v[224:227], v[156:159], 0
  v_cvt_pk_bf16_f32 v140, v56, v57
  v_cvt_pk_bf16_f32 v141, v58, v59
  v_mfma_f32_16x16x32_bf16 v[192:195], v[228:231], v[160:163], v[192:195]
  v_cvt_pk_bf16_f32 v142, v60, v61
  v_cvt_pk_bf16_f32 v143, v62, v63
  v_mfma_f32_16x16x32_bf16 v[192:195], v[232:235], v[164:167], v[192:195]
  v_cvt_pk_bf16_f32 v144, v64, v65
  v_cvt_pk_bf16_f32 v145, v66, v67
  v_mfma_f32_16x16x32_bf16 v[192:195], v[236:239], v[24:27], v[192:195]
  v_cvt_pk_bf16_f32 v146, v68, v69
  s_waitcnt lgkmcnt(4)
  v_mfma_f32_16x16x32_bf16 v[192:195], v[240:243], v[28:31], v[192:195]
  v_cvt_pk_bf16_f32 v147, v70, v71
  v_cvt_pk_bf16_f32 v148, v72, v73
  v_mfma_f32_16x16x32_bf16 v[192:195], v[244:247], v[32:35], v[192:195]
  v_cvt_pk_bf16_f32 v149, v74, v75
  v_cvt_pk_bf16_f32 v150, v76, v77
  v_mfma_f32_16x16x32_bf16 v[184:187], v[224:227], v[140:143], 0
  ds_read_b128 v[224:227], v2 offset:40960
  v_cvt_pk_bf16_f32 v151, v78, v79
  v_mfma_f32_16x16x32_bf16 v[184:187], v[228:231], v[144:147], v[184:187]
  ds_read_b128 v[228:231], v2 offset:41984
  v_cvt_pk_bf16_f32 v152, v80, v81
  v_mfma_f32_16x16x32_bf16 v[184:187], v[232:235], v[148:151], v[184:187]
  ds_read_b128 v[232:235], v2 offset:43008
  v_cvt_pk_bf16_f32 v153, v82, v83
  v_cvt_pk_bf16_f32 v154, v84, v85
  v_cvt_pk_bf16_f32 v155, v86, v87
  s_nop 1
  v_mfma_f32_16x16x32_bf16 v[184:187], v[236:239], v[152:155], v[184:187]
  ds_read_b128 v[236:239], v2 offset:44032
  v_cvt_pk_bf16_f32 v36, v168, v169
  v_cvt_pk_bf16_f32 v37, v170, v171
  v_cvt_pk_bf16_f32 v38, v172, v173
  v_cvt_pk_bf16_f32 v39, v174, v175
  s_nop 1
  v_mfma_f32_16x16x32_bf16 v[184:187], v[240:243], v[36:39], v[184:187]
  ds_read_b128 v[240:243], v2 offset:45056
  v_cvt_pk_bf16_f32 v40, v176, v177
  v_cvt_pk_bf16_f32 v41, v178, v179
  v_cvt_pk_bf16_f32 v42, v180, v181
  v_cvt_pk_bf16_f32 v43, v182, v183
  s_nop 1
  v_mfma_f32_16x16x32_bf16 v[184:187], v[244:247], v[40:43], v[184:187]
  ds_read_b128 v[244:247], v2 offset:46080
  s_waitcnt lgkmcnt(6)
  v_mfma_f32_16x16x32_bf16 v[188:191], v[248:251], v[140:143], 0
  v_mul_f32 v192, v192, v23
  v_mul_f32 v193, v193, v23
  v_mfma_f32_16x16x32_bf16 v[188:191], v[252:255], v[144:147], v[188:191]
  v_mul_f32 v194, v194, v23
  v_mul_f32 v195, v195, v23
  v_mfma_f32_16x16x32_bf16 v[188:191], v[216:219], v[148:151], v[188:191]
  v_cvt_pk_bf16_f32 v92, v192, v193
  v_cvt_pk_bf16_f32 v93, v194, v195
  v_mfma_f32_16x16x32_bf16 v[196:199], v[248:251], v[156:159], 0
  ds_read_b128 v[248:251], v2 offset:47104
  v_mul_f32 v184, v184, v22
  v_mfma_f32_16x16x32_bf16 v[196:199], v[252:255], v[160:163], v[196:199]
  ds_read_b128 v[252:255], v2 offset:48128
  v_mul_f32 v185, v185, v22
  v_mfma_f32_16x16x32_bf16 v[196:199], v[216:219], v[164:167], v[196:199]
  ds_read_b128 v[216:219], v2 offset:49152
  v_mul_f32 v186, v186, v22
  v_mfma_f32_16x16x32_bf16 v[196:199], v[220:223], v[24:27], v[196:199]
  v_mul_f32 v187, v187, v22
  s_waitcnt lgkmcnt(5)
  v_mfma_f32_16x16x32_bf16 v[196:199], v[224:227], v[28:31], v[196:199]
  v_cvt_pk_bf16_f32 v88, v184, v185
  v_cvt_pk_bf16_f32 v89, v186, v187
  v_mfma_f32_16x16x32_bf16 v[196:199], v[228:231], v[32:35], v[196:199]
  v_mfma_f32_16x16x32_bf16 v[188:191], v[220:223], v[152:155], v[188:191]
  ds_read_b128 v[220:223], v2 offset:50176
  v_mfma_f32_16x16x32_bf16 v[188:191], v[224:227], v[36:39], v[188:191]
  ds_read_b128 v[224:227], v2 offset:51200
  v_mfma_f32_16x16x32_bf16 v[188:191], v[228:231], v[40:43], v[188:191]
  ds_read_b128 v[228:231], v2 offset:52224
  s_mov_b32 s100, 71680
  buffer_load_dwordx4 v[104:107], v1, s[20:23], s100 offen offset:0 sc1
  buffer_load_dwordx4 v[108:111], v1, s[20:23], s100 offen offset:1024 sc1
  v_mfma_f32_16x16x32_bf16 v[200:203], v[232:235], v[140:143], 0
  v_mul_f32 v196, v196, v23
  v_mul_f32 v197, v197, v23
  v_mfma_f32_16x16x32_bf16 v[200:203], v[236:239], v[144:147], v[200:203]
  v_mul_f32 v198, v198, v23
  s_waitcnt lgkmcnt(4)
  v_mfma_f32_16x16x32_bf16 v[200:203], v[240:243], v[148:151], v[200:203]
  v_mul_f32 v199, v199, v23
  v_cvt_pk_bf16_f32 v94, v196, v197
  v_mfma_f32_16x16x32_bf16 v[208:211], v[232:235], v[156:159], 0
  ds_read_b128 v[232:235], v2 offset:53248
  v_cvt_pk_bf16_f32 v95, v198, v199
  v_mfma_f32_16x16x32_bf16 v[208:211], v[236:239], v[160:163], v[208:211]
  buffer_store_dwordx4 v[92:95], v6, s[16:19], 0 offen offset:0 nt sc1
  v_mul_f32 v188, v188, v22
  v_mfma_f32_16x16x32_bf16 v[208:211], v[240:243], v[164:167], v[208:211]
  ds_read_b128 v[236:239], v2 offset:54272
  v_mul_f32 v189, v189, v22
  v_mfma_f32_16x16x32_bf16 v[208:211], v[244:247], v[24:27], v[208:211]
  ds_read_b128 v[240:243], v2 offset:55296
  v_mul_f32 v190, v190, v22
  v_mfma_f32_16x16x32_bf16 v[208:211], v[248:251], v[28:31], v[208:211]
  v_mul_f32 v191, v191, v22
  v_cvt_pk_bf16_f32 v90, v188, v189
  v_mfma_f32_16x16x32_bf16 v[208:211], v[252:255], v[32:35], v[208:211]
  v_cvt_pk_bf16_f32 v91, v190, v191
  v_mfma_f32_16x16x32_bf16 v[200:203], v[244:247], v[152:155], v[200:203]
  buffer_store_dwordx4 v[88:91], v5, s[16:19], 0 offen offset:0 nt sc1
  v_mfma_f32_16x16x32_bf16 v[200:203], v[248:251], v[36:39], v[200:203]
  ds_read_b128 v[244:247], v2 offset:56320
  ds_read_b128 v[248:251], v2 offset:57344
  v_mfma_f32_16x16x32_bf16 v[200:203], v[252:255], v[40:43], v[200:203]
  ds_read_b128 v[252:255], v2 offset:58368
  s_waitcnt lgkmcnt(6)
  v_mfma_f32_16x16x32_bf16 v[204:207], v[216:219], v[140:143], 0
  v_mul_f32 v208, v208, v23
  v_mul_f32 v209, v209, v23
  v_mfma_f32_16x16x32_bf16 v[204:207], v[220:223], v[144:147], v[204:207]
  v_mul_f32 v210, v210, v23
  v_mul_f32 v211, v211, v23
  v_mfma_f32_16x16x32_bf16 v[204:207], v[224:227], v[148:151], v[204:207]
  v_cvt_pk_bf16_f32 v100, v208, v209
  v_cvt_pk_bf16_f32 v101, v210, v211
  v_mfma_f32_16x16x32_bf16 v[212:215], v[216:219], v[156:159], 0
  ds_read_b128 v[216:219], v2 offset:59392
  v_mul_f32 v200, v200, v22
  v_mfma_f32_16x16x32_bf16 v[212:215], v[220:223], v[160:163], v[212:215]
  ds_read_b128 v[220:223], v2 offset:60416
  v_mul_f32 v201, v201, v22
  v_mfma_f32_16x16x32_bf16 v[212:215], v[224:227], v[164:167], v[212:215]
  ds_read_b128 v[224:227], v1 offset:0
  v_mul_f32 v202, v202, v22
  v_mfma_f32_16x16x32_bf16 v[212:215], v[228:231], v[24:27], v[212:215]
  v_mul_f32 v203, v203, v22
  s_waitcnt lgkmcnt(5)
  v_mfma_f32_16x16x32_bf16 v[212:215], v[232:235], v[28:31], v[212:215]
  v_cvt_pk_bf16_f32 v96, v200, v201
  v_cvt_pk_bf16_f32 v97, v202, v203
  v_mfma_f32_16x16x32_bf16 v[212:215], v[236:239], v[32:35], v[212:215]
  v_mfma_f32_16x16x32_bf16 v[204:207], v[228:231], v[152:155], v[204:207]
  ds_read_b128 v[228:231], v1 offset:1024
  v_mfma_f32_16x16x32_bf16 v[204:207], v[232:235], v[36:39], v[204:207]
  ds_read_b128 v[232:235], v1 offset:2048
  v_mfma_f32_16x16x32_bf16 v[204:207], v[236:239], v[40:43], v[204:207]
  ds_read_b128 v[236:239], v1 offset:3072
  s_cbranch_vccz SL50
  s_barrier
SL50:
  v_mfma_f32_16x16x32_bf16 v[184:187], v[240:243], v[140:143], 0
  v_mul_f32 v212, v212, v23
  v_mul_f32 v213, v213, v23
  v_mfma_f32_16x16x32_bf16 v[184:187], v[244:247], v[144:147], v[184:187]
  v_mul_f32 v214, v214, v23
  s_waitcnt lgkmcnt(4)
  v_mfma_f32_16x16x32_bf16 v[184:187], v[248:251], v[148:151], v[184:187]
  v_mul_f32 v215, v215, v23
  v_cvt_pk_bf16_f32 v102, v212, v213
  v_mfma_f32_16x16x32_bf16 v[192:195], v[240:243], v[156:159], 0
  ds_read_b128 v[240:243], v1 offset:4096
  v_cvt_pk_bf16_f32 v103, v214, v215
  v_mfma_f32_16x16x32_bf16 v[192:195], v[244:247], v[160:163], v[192:195]
  buffer_store_dwordx4 v[100:103], v6, s[16:19], 0 offen offset:64 nt sc1
  v_mul_f32 v204, v204, v22
  v_mfma_f32_16x16x32_bf16 v[192:195], v[248:251], v[164:167], v[192:195]
  ds_read_b128 v[244:247], v1 offset:5120
  v_mul_f32 v205, v205, v22
  v_mfma_f32_16x16x32_bf16 v[192:195], v[252:255], v[24:27], v[192:195]
  ds_read_b128 v[248:251], v1 offset:6144
  v_mul_f32 v206, v206, v22
  v_mfma_f32_16x16x32_bf16 v[192:195], v[216:219], v[28:31], v[192:195]
  v_mul_f32 v207, v207, v22
  v_cvt_pk_bf16_f32 v98, v204, v205
  v_mfma_f32_16x16x32_bf16 v[192:195], v[220:223], v[32:35], v[192:195]
  v_cvt_pk_bf16_f32 v99, v206, v207
  v_mfma_f32_16x16x32_bf16 v[184:187], v[252:255], v[152:155], v[184:187]
  buffer_store_dwordx4 v[96:99], v5, s[16:19], 0 offen offset:64 nt sc1
  v_mfma_f32_16x16x32_bf16 v[184:187], v[216:219], v[36:39], v[184:187]
  ds_read_b128 v[252:255], v1 offset:7168
  ds_read_b128 v[216:219], v1 offset:8192
  v_mfma_f32_16x16x32_bf16 v[184:187], v[220:223], v[40:43], v[184:187]
  ds_read_b128 v[220:223], v1 offset:9216
  s_waitcnt lgkmcnt(6)
  v_mfma_f32_16x16x32_bf16 v[188:191], v[224:227], v[140:143], 0
  v_mul_f32 v192, v192, v23
  v_mul_f32 v193, v193, v23
  v_mfma_f32_16x16x32_bf16 v[188:191], v[228:231], v[144:147], v[188:191]
  v_mul_f32 v194, v194, v23
  v_mul_f32 v195, v195, v23
  v_mfma_f32_16x16x32_bf16 v[188:191], v[232:235], v[148:151], v[188:191]
  v_cvt_pk_bf16_f32 v92, v192, v193
  v_cvt_pk_bf16_f32 v93, v194, v195
  v_mfma_f32_16x16x32_bf16 v[196:199], v[224:227], v[156:159], 0
  ds_read_b128 v[224:227], v2 offset:0
  v_mul_f32 v184, v184, v22
  v_mfma_f32_16x16x32_bf16 v[196:199], v[228:231], v[160:163], v[196:199]
  ds_read_b128 v[228:231], v2 offset:1024
  v_mul_f32 v185, v185, v22
  v_mfma_f32_16x16x32_bf16 v[196:199], v[232:235], v[164:167], v[196:199]
  ds_read_b128 v[232:235], v2 offset:2048
  v_mul_f32 v186, v186, v22
  v_mfma_f32_16x16x32_bf16 v[196:199], v[236:239], v[24:27], v[196:199]
  v_mul_f32 v187, v187, v22
  s_waitcnt lgkmcnt(5)
  v_mfma_f32_16x16x32_bf16 v[196:199], v[240:243], v[28:31], v[196:199]
  v_cvt_pk_bf16_f32 v88, v184, v185
  v_cvt_pk_bf16_f32 v89, v186, v187
  v_mfma_f32_16x16x32_bf16 v[196:199], v[244:247], v[32:35], v[196:199]
  v_mfma_f32_16x16x32_bf16 v[188:191], v[236:239], v[152:155], v[188:191]
  ds_read_b128 v[236:239], v2 offset:3072
  v_mfma_f32_16x16x32_bf16 v[188:191], v[240:243], v[36:39], v[188:191]
  ds_read_b128 v[240:243], v2 offset:4096
  v_mfma_f32_16x16x32_bf16 v[188:191], v[244:247], v[40:43], v[188:191]
  ds_read_b128 v[244:247], v2 offset:5120
  v_mfma_f32_16x16x32_bf16 v[200:203], v[248:251], v[140:143], 0
  v_mfma_f32_16x16x32_bf16 v[200:203], v[252:255], v[144:147], v[200:203]
  v_mul_f32 v196, v196, v23
  s_waitcnt lgkmcnt(4)
  v_mfma_f32_16x16x32_bf16 v[200:203], v[216:219], v[148:151], v[200:203]
  v_mul_f32 v197, v197, v23
  v_mul_f32 v198, v198, v23
  v_mfma_f32_16x16x32_bf16 v[208:211], v[248:251], v[156:159], 0
  ds_read_b128 v[248:251], v2 offset:6144
  v_mul_f32 v199, v199, v23
  v_mfma_f32_16x16x32_bf16 v[208:211], v[252:255], v[160:163], v[208:211]
  ds_read_b128 v[252:255], v2 offset:7168
  v_cvt_pk_bf16_f32 v94, v196, v197
  v_mfma_f32_16x16x32_bf16 v[208:211], v[216:219], v[164:167], v[208:211]
  ds_read_b128 v[216:219], v2 offset:8192
  v_cvt_pk_bf16_f32 v95, v198, v199
  v_mfma_f32_16x16x32_bf16 v[208:211], v[220:223], v[24:27], v[208:211]
  buffer_store_dwordx4 v[92:95], v6, s[16:19], 0 offen offset:128 nt sc1
  v_mul_f32 v188, v188, v22
  v_mfma_f32_16x16x32_bf16 v[208:211], v[224:227], v[28:31], v[208:211]
  v_mul_f32 v189, v189, v22
  v_mul_f32 v190, v190, v22
  v_mfma_f32_16x16x32_bf16 v[208:211], v[228:231], v[32:35], v[208:211]
  v_mul_f32 v191, v191, v22
  v_cvt_pk_bf16_f32 v90, v188, v189
  v_mfma_f32_16x16x32_bf16 v[200:203], v[220:223], v[152:155], v[200:203]
  ds_read_b128 v[220:223], v2 offset:9216
  v_cvt_pk_bf16_f32 v91, v190, v191
  v_mfma_f32_16x16x32_bf16 v[200:203], v[224:227], v[36:39], v[200:203]
  buffer_store_dwordx4 v[88:91], v5, s[16:19], 0 offen offset:128 nt sc1
  v_mfma_f32_16x16x32_bf16 v[200:203], v[228:231], v[40:43], v[200:203]
  ds_read_b128 v[224:227], v2 offset:10240
  s_waitcnt lgkmcnt(5)
  v_mfma_f32_16x16x32_bf16 v[204:207], v[232:235], v[140:143], 0
  ds_read_b128 v[228:231], v2 offset:11264
  v_mul_f32 v208, v208, v23
  v_mfma_f32_16x16x32_bf16 v[204:207], v[236:239], v[144:147], v[204:207]
  v_mul_f32 v209, v209, v23
  v_mul_f32 v210, v210, v23
  v_mfma_f32_16x16x32_bf16 v[204:207], v[240:243], v[148:151], v[204:207]
  v_mul_f32 v211, v211, v23
  v_cvt_pk_bf16_f32 v100, v208, v209
  v_mfma_f32_16x16x32_bf16 v[212:215], v[232:235], v[156:159], 0
  ds_read_b128 v[232:235], v2 offset:12288
  v_cvt_pk_bf16_f32 v101, v210, v211
  v_mfma_f32_16x16x32_bf16 v[212:215], v[236:239], v[160:163], v[212:215]
  ds_read_b128 v[236:239], v2 offset:13312
  v_mul_f32 v200, v200, v22
  v_mfma_f32_16x16x32_bf16 v[212:215], v[240:243], v[164:167], v[212:215]
  ds_read_b128 v[240:243], v2 offset:14336
  v_mul_f32 v201, v201, v22
  v_mfma_f32_16x16x32_bf16 v[212:215], v[244:247], v[24:27], v[212:215]
  v_mul_f32 v202, v202, v22
  s_waitcnt lgkmcnt(5)
  v_mfma_f32_16x16x32_bf16 v[212:215], v[248:251], v[28:31], v[212:215]
  v_mul_f32 v203, v203, v22
  v_cvt_pk_bf16_f32 v96, v200, v201
  v_mfma_f32_16x16x32_bf16 v[212:215], v[252:255], v[32:35], v[212:215]
  v_cvt_pk_bf16_f32 v97, v202, v203
  v_mfma_f32_16x16x32_bf16 v[204:207], v[244:247], v[152:155], v[204:207]
  ds_read_b128 v[244:247], v2 offset:15360
  v_mfma_f32_16x16x32_bf16 v[204:207], v[248:251], v[36:39], v[204:207]
  ds_read_b128 v[248:251], v2 offset:16384
  v_mfma_f32_16x16x32_bf16 v[204:207], v[252:255], v[40:43], v[204:207]
  ds_read_b128 v[252:255], v2 offset:17408
  v_mfma_f32_16x16x32_bf16 v[184:187], v[216:219], v[140:143], 0
  v_mul_f32 v212, v212, v23
  v_mul_f32 v213, v213, v23
  v_mfma_f32_16x16x32_bf16 v[184:187], v[220:223], v[144:147], v[184:187]
  v_mul_f32 v214, v214, v23
  s_waitcnt lgkmcnt(4)
  v_mfma_f32_16x16x32_bf16 v[184:187], v[224:227], v[148:151], v[184:187]
  v_mul_f32 v215, v215, v23
  v_cvt_pk_bf16_f32 v102, v212, v213
  v_mfma_f32_16x16x32_bf16 v[192:195], v[216:219], v[156:159], 0
  ds_read_b128 v[216:219], v2 offset:18432
  v_cvt_pk_bf16_f32 v103, v214, v215
  v_mfma_f32_16x16x32_bf16 v[192:195], v[220:223], v[160:163], v[192:195]
  buffer_store_dwordx4 v[100:103], v6, s[16:19], 0 offen offset:192 nt sc1
  v_mul_f32 v204, v204, v22
  v_mfma_f32_16x16x32_bf16 v[192:195], v[224:227], v[164:167], v[192:195]
  ds_read_b128 v[220:223], v2 offset:19456
  v_mul_f32 v205, v205, v22
  v_mfma_f32_16x16x32_bf16 v[192:195], v[228:231], v[24:27], v[192:195]
  ds_read_b128 v[224:227], v2 offset:20480
  v_mul_f32 v206, v206, v22
  v_mfma_f32_16x16x32_bf16 v[192:195], v[232:235], v[28:31], v[192:195]
  v_mul_f32 v207, v207, v22
  v_cvt_pk_bf16_f32 v98, v204, v205
  v_mfma_f32_16x16x32_bf16 v[192:195], v[236:239], v[32:35], v[192:195]
  v_cvt_pk_bf16_f32 v99, v206, v207
  v_mfma_f32_16x16x32_bf16 v[184:187], v[228:231], v[152:155], v[184:187]
  buffer_store_dwordx4 v[96:99], v5, s[16:19], 0 offen offset:192 nt sc1
  v_mfma_f32_16x16x32_bf16 v[184:187], v[232:235], v[36:39], v[184:187]
  ds_read_b128 v[228:231], v2 offset:21504
  ds_read_b128 v[232:235], v2 offset:22528
  v_mfma_f32_16x16x32_bf16 v[184:187], v[236:239], v[40:43], v[184:187]
  ds_read_b128 v[236:239], v2 offset:23552
  s_waitcnt lgkmcnt(6)
  v_mfma_f32_16x16x32_bf16 v[188:191], v[240:243], v[140:143], 0
  v_mul_f32 v192, v192, v23
  v_mul_f32 v193, v193, v23
  v_mfma_f32_16x16x32_bf16 v[188:191], v[244:247], v[144:147], v[188:191]
  v_mul_f32 v194, v194, v23
  v_mul_f32 v195, v195, v23
  v_mfma_f32_16x16x32_bf16 v[188:191], v[248:251], v[148:151], v[188:191]
  v_cvt_pk_bf16_f32 v92, v192, v193
  v_cvt_pk_bf16_f32 v93, v194, v195
  v_mfma_f32_16x16x32_bf16 v[196:199], v[240:243], v[156:159], 0
  ds_read_b128 v[240:243], v2 offset:24576
  v_mul_f32 v184, v184, v22
  v_mfma_f32_16x16x32_bf16 v[196:199], v[244:247], v[160:163], v[196:199]
  ds_read_b128 v[244:247], v2 offset:25600
  v_mul_f32 v185, v185, v22
  v_mfma_f32_16x16x32_bf16 v[196:199], v[248:251], v[164:167], v[196:199]
  ds_read_b128 v[248:251], v2 offset:26624
  v_mul_f32 v186, v186, v22
  v_mfma_f32_16x16x32_bf16 v[196:199], v[252:255], v[24:27], v[196:199]
  v_mul_f32 v187, v187, v22
  s_waitcnt lgkmcnt(5)
  v_mfma_f32_16x16x32_bf16 v[196:199], v[216:219], v[28:31], v[196:199]
  v_cvt_pk_bf16_f32 v88, v184, v185
  v_cvt_pk_bf16_f32 v89, v186, v187
  v_mfma_f32_16x16x32_bf16 v[196:199], v[220:223], v[32:35], v[196:199]
  v_mfma_f32_16x16x32_bf16 v[188:191], v[252:255], v[152:155], v[188:191]
  ds_read_b128 v[252:255], v2 offset:27648
  v_mfma_f32_16x16x32_bf16 v[188:191], v[216:219], v[36:39], v[188:191]
  ds_read_b128 v[216:219], v2 offset:28672
  v_mfma_f32_16x16x32_bf16 v[188:191], v[220:223], v[40:43], v[188:191]
  ds_read_b128 v[220:223], v2 offset:29696
  s_waitcnt vmcnt(8)
  v_mfma_f32_16x16x32_bf16 v[200:203], v[224:227], v[140:143], 0
  v_mul_f32 v196, v196, v23
  v_mul_f32 v197, v197, v23
  v_mfma_f32_16x16x32_bf16 v[200:203], v[228:231], v[144:147], v[200:203]
  v_mul_f32 v198, v198, v23
  s_waitcnt lgkmcnt(4)
  v_mfma_f32_16x16x32_bf16 v[200:203], v[232:235], v[148:151], v[200:203]
  v_mul_f32 v199, v199, v23
  v_cvt_pk_bf16_f32 v94, v196, v197
  v_mfma_f32_16x16x32_bf16 v[208:211], v[224:227], v[156:159], 0
  v_cvt_pk_bf16_f32 v95, v198, v199
  v_mul_f32 v188, v188, v22
  v_mfma_f32_16x16x32_bf16 v[208:211], v[228:231], v[160:163], v[208:211]
  buffer_store_dwordx4 v[92:95], v6, s[16:19], 0 offen offset:256 nt sc1
  v_mul_f32 v189, v189, v22
  v_mfma_f32_16x16x32_bf16 v[208:211], v[232:235], v[164:167], v[208:211]
  v_mul_f32 v190, v190, v22
  v_mul_f32 v191, v191, v22
  v_mfma_f32_16x16x32_bf16 v[208:211], v[236:239], v[24:27], v[208:211]
  v_cvt_pk_bf16_f32 v90, v188, v189
  v_cvt_pk_bf16_f32 v91, v190, v191
  v_mfma_f32_16x16x32_bf16 v[208:211], v[240:243], v[28:31], v[208:211]
  buffer_store_dwordx4 v[88:91], v5, s[16:19], 0 offen offset:256 nt sc1
  v_mfma_f32_16x16x32_bf16 v[208:211], v[244:247], v[32:35], v[208:211]
  v_mfma_f32_16x16x32_bf16 v[200:203], v[236:239], v[152:155], v[200:203]
  v_mfma_f32_16x16x32_bf16 v[200:203], v[240:243], v[36:39], v[200:203]
  v_mfma_f32_16x16x32_bf16 v[200:203], v[244:247], v[40:43], v[200:203]
  s_waitcnt lgkmcnt(3)
  v_mfma_f32_16x16x32_bf16 v[204:207], v[248:251], v[140:143], 0
  s_waitcnt lgkmcnt(2)
  v_mfma_f32_16x16x32_bf16 v[204:207], v[252:255], v[144:147], v[204:207]
  s_waitcnt lgkmcnt(1)
  v_mfma_f32_16x16x32_bf16 v[204:207], v[216:219], v[148:151], v[204:207]
  v_mul_f32 v208, v208, v23
  v_mul_f32 v209, v209, v23
  v_mfma_f32_16x16x32_bf16 v[212:215], v[248:251], v[156:159], 0
  v_mul_f32 v210, v210, v23
  v_mul_f32 v211, v211, v23
  v_mfma_f32_16x16x32_bf16 v[212:215], v[252:255], v[160:163], v[212:215]
  v_cvt_pk_bf16_f32 v100, v208, v209
  v_cvt_pk_bf16_f32 v101, v210, v211
  v_mfma_f32_16x16x32_bf16 v[212:215], v[216:219], v[164:167], v[212:215]
  v_mul_f32 v200, v200, v22
  s_waitcnt lgkmcnt(0)
  v_mfma_f32_16x16x32_bf16 v[212:215], v[220:223], v[24:27], v[212:215]
  v_mul_f32 v201, v201, v22
  v_mfma_f32_16x16x32_bf16 v[212:215], v[104:107], v[28:31], v[212:215]
  v_mul_f32 v202, v202, v22
  v_mfma_f32_16x16x32_bf16 v[212:215], v[108:111], v[32:35], v[212:215]
  v_mul_f32 v203, v203, v22
  v_cvt_pk_bf16_f32 v96, v200, v201
  v_mfma_f32_16x16x32_bf16 v[204:207], v[220:223], v[152:155], v[204:207]
  v_cvt_pk_bf16_f32 v97, v202, v203
  v_mfma_f32_16x16x32_bf16 v[204:207], v[104:107], v[36:39], v[204:207]
  v_mfma_f32_16x16x32_bf16 v[204:207], v[108:111], v[40:43], v[204:207]
  s_nop 1
  v_mul_f32 v212, v212, v23
  v_mul_f32 v213, v213, v23
  v_mul_f32 v214, v214, v23
  v_mul_f32 v215, v215, v23
  v_cvt_pk_bf16_f32 v102, v212, v213
  v_cvt_pk_bf16_f32 v103, v214, v215
  buffer_store_dwordx4 v[100:103], v6, s[16:19], 0 offen offset:320 nt sc1
  v_mul_f32 v204, v204, v22
  v_mul_f32 v205, v205, v22
  v_mul_f32 v206, v206, v22
  v_mul_f32 v207, v207, v22
  v_cvt_pk_bf16_f32 v98, v204, v205
  v_cvt_pk_bf16_f32 v99, v206, v207
  buffer_store_dwordx4 v[96:99], v5, s[16:19], 0 offen offset:320 nt sc1
MK_fin:
MK_done:
  s_endpgm
MK_single:
  ds_read_b128 v[216:219], v2 offset:35840
  ds_read_b128 v[220:223], v2 offset:34816
  ds_read_b128 v[224:227], v2 offset:33792
  ds_read_b128 v[228:231], v2 offset:32768
  ds_read_b128 v[232:235], v2 offset:31744
  ds_read_b128 v[236:239], v2 offset:30720
  ds_read_b128 v[240:243], v2 offset:29696
  ds_read_b128 v[244:247], v2 offset:28672
  ds_read_b128 v[248:251], v2 offset:27648
  ds_read_b128 v[252:255], v2 offset:26624
  s_cmp_lg_u32 s3, 0
  s_cbranch_scc1 MK_np4
  s_waitcnt vmcnt(0)
MK_np4:
  s_waitcnt vmcnt(1)
  s_setprio 1
BODYS:
  s_waitcnt lgkmcnt(6)
  v_mfma_f32_16x16x32_bf16 v[192:195], v[216:219], v[160:163], 0
  ds_read_b128 v[216:219], v2 offset:25600
  v_mov_b32 v64, 0xff800000
  v_mfma_f32_16x16x32_bf16 v[192:195], v[220:223], v[164:167], v[192:195]
  ds_read_b128 v[220:223], v2 offset:24576
  v_add_u32 v65, 0, v19
  v_mfma_f32_16x16x32_bf16 v[192:195], v[224:227], v[168:171], v[192:195]
  ds_read_b128 v[224:227], v2 offset:23552
  v_add_u32 v66, 1, v19
  v_mfma_f32_16x16x32_bf16 v[192:195], v[228:231], v[172:175], v[192:195]
  ds_read_b128 v[228:231], v2 offset:22528
  s_waitcnt lgkmcnt(6)
  v_mfma_f32_16x16x32_bf16 v[192:195], v[232:235], v[176:179], v[192:195]
  ds_read_b128 v[232:235], v2 offset:21504
  v_add_u32 v67, 2, v19
  v_mfma_f32_16x16x32_bf16 v[192:195], v[236:239], v[180:183], v[192:195]
  ds_read_b128 v[236:239], v2 offset:20480
  v_add_u32 v68, 3, v19
  v_mfma_f32_16x16x32_bf16 v[196:199], v[240:243], v[160:163], 0
  ds_read_b128 v[240:243], v2 offset:19456
  v_cmp_gt_u32 s[48:49], 7, v65
  v_mfma_f32_16x16x32_bf16 v[196:199], v[244:247], v[164:167], v[196:199]
  ds_read_b128 v[244:247], v2 offset:18432
  s_waitcnt lgkmcnt(6)
  v_mfma_f32_16x16x32_bf16 v[196:199], v[248:251], v[168:171], v[196:199]
  ds_read_b128 v[248:251], v2 offset:17408
  v_cmp_gt_u32 s[50:51], 7, v66
  v_mfma_f32_16x16x32_bf16 v[196:199], v[252:255], v[172:175], v[196:199]
  ds_read_b128 v[252:255], v2 offset:16384
  v_cmp_gt_u32 s[52:53], 7, v67
  v_mfma_f32_16x16x32_bf16 v[196:199], v[216:219], v[176:179], v[196:199]
  ds_read_b128 v[216:219], v2 offset:15360
  v_cmp_gt_u32 s[54:55], 7, v68
  v_mfma_f32_16x16x32_bf16 v[196:199], v[220:223], v[180:183], v[196:199]
  ds_read_b128 v[220:223], v2 offset:14336
  s_waitcnt lgkmcnt(6)
  v_mfma_f32_16x16x32_bf16 v[208:211], v[224:227], v[160:163], 0
  ds_read_b128 v[224:227], v2 offset:13312
  s_add_i32 s46, s34, 8
  v_mfma_f32_16x16x32_bf16 v[208:211], v[228:231], v[164:167], v[208:211]
  ds_read_b128 v[228:231], v2 offset:12288
  v_sub_u32 v69, s46, v22
  v_mfma_f32_16x16x32_bf16 v[208:211], v[232:235], v[168:171], v[208:211]
  ds_read_b128 v[232:235], v2 offset:11264
  s_add_i32 s46, s34, 1
  v_mfma_f32_16x16x32_bf16 v[208:211], v[236:239], v[172:175], v[208:211]
  ds_read_b128 v[236:239], v2 offset:10240
  s_waitcnt lgkmcnt(6)
  v_mfma_f32_16x16x32_bf16 v[208:211], v[240:243], v[176:179], v[208:211]
  ds_read_b128 v[240:243], v2 offset:9216
  v_sub_u32 v70, s46, v22
  v_mfma_f32_16x16x32_bf16 v[208:211], v[244:247], v[180:183], v[208:211]
  ds_read_b128 v[244:247], v2 offset:8192
  v_cndmask_b32 v60, v64, 0, s[48:49]
  v_mfma_f32_16x16x32_bf16 v[212:215], v[248:251], v[160:163], 0
  ds_read_b128 v[248:251], v2 offset:7168
  v_cndmask_b32 v61, v64, 0, s[50:51]
  v_mfma_f32_16x16x32_bf16 v[212:215], v[252:255], v[164:167], v[212:215]
  ds_read_b128 v[252:255], v2 offset:6144
  s_waitcnt lgkmcnt(6)
  v_mfma_f32_16x16x32_bf16 v[212:215], v[216:219], v[168:171], v[212:215]
  ds_read_b128 v[216:219], v2 offset:5120
  v_cndmask_b32 v62, v64, 0, s[52:53]
  v_mfma_f32_16x16x32_bf16 v[212:215], v[220:223], v[172:175], v[212:215]
  ds_read_b128 v[220:223], v2 offset:4096
  v_cndmask_b32 v63, v64, 0, s[54:55]
  v_mfma_f32_16x16x32_bf16 v[212:215], v[224:227], v[176:179], v[212:215]
  ds_read_b128 v[224:227], v2 offset:3072
  v_cmp_gt_u32 s[46:47], 7, v69
  v_mfma_f32_16x16x32_bf16 v[212:215], v[228:231], v[180:183], v[212:215]
  ds_read_b128 v[228:231], v2 offset:2048
  v_cmp_gt_u32 s[48:49], 7, v70
  v_cndmask_b32 v84, v64, v60, s[46:47]
  v_cndmask_b32 v85, v64, v61, s[46:47]
  v_cndmask_b32 v86, v64, v62, s[46:47]
  v_cndmask_b32 v87, v64, v63, s[46:47]
  v_cndmask_b32 v56, v64, v60, s[48:49]
  v_cndmask_b32 v57, v64, v61, s[48:49]
  v_cndmask_b32 v58, v64, v62, s[48:49]
  v_cndmask_b32 v59, v64, v63, s[48:49]
  v_mul_f32 v192, s93, v192
  v_mul_f32 v193, s93, v193
  v_mul_f32 v194, s93, v194
  v_mul_f32 v195, s93, v195
  v_cvt_pk_bf16_f32 v112, v192, v193
  v_cvt_pk_bf16_f32 v113, v194, v195
  v_mul_f32 v196, s93, v196
  v_mul_f32 v197, s93, v197
  v_mul_f32 v198, s93, v198
  v_mul_f32 v199, s93, v199
  v_cvt_pk_bf16_f32 v114, v196, v197
  v_cvt_pk_bf16_f32 v115, v198, v199
  s_waitcnt lgkmcnt(6)
  v_mfma_f32_16x16x32_bf16 v[192:195], v[232:235], v[160:163], 0
  ds_read_b128 v[232:235], v2 offset:1024
  v_mul_f32 v208, s93, v208
  v_mfma_f32_16x16x32_bf16 v[192:195], v[236:239], v[164:167], v[192:195]
  ds_read_b128 v[236:239], v2 offset:0
  v_mul_f32 v209, s93, v209
  v_mfma_f32_16x16x32_bf16 v[192:195], v[240:243], v[168:171], v[192:195]
  ds_read_b128 v[240:243], v1 offset:35840
  v_mul_f32 v210, s93, v210
  v_mfma_f32_16x16x32_bf16 v[192:195], v[244:247], v[172:175], v[192:195]
  ds_read_b128 v[244:247], v1 offset:34816
  s_waitcnt lgkmcnt(6)
  v_mfma_f32_16x16x32_bf16 v[192:195], v[248:251], v[176:179], v[192:195]
  ds_read_b128 v[248:251], v1 offset:33792
  v_mul_f32 v211, s93, v211
  v_mfma_f32_16x16x32_bf16 v[192:195], v[252:255], v[180:183], v[192:195]
  ds_read_b128 v[252:255], v1 offset:32768
  v_cvt_pk_bf16_f32 v116, v208, v209
  v_mfma_f32_16x16x32_bf16 v[196:199], v[216:219], v[160:163], 0
  ds_read_b128 v[216:219], v1 offset:31744
  v_cvt_pk_bf16_f32 v117, v210, v211
  s_cmp_eq_u32 s3, 0
  s_cbranch_scc1 MK_np5
  s_waitcnt vmcnt(0)
  v_mov_b32 v23, 1
  s_mov_b64 exec, 1
  s_lshl_b32 s100, s26, 7
  buffer_atomic_add v23, off, s[8:11], s100 sc1
  s_mov_b64 exec, -1
  s_nop 3
MK_np5:
  v_mfma_f32_16x16x32_bf16 v[196:199], v[220:223], v[164:167], v[196:199]
  ds_read_b128 v[220:223], v1 offset:30720
  s_waitcnt lgkmcnt(6)
  v_mfma_f32_16x16x32_bf16 v[196:199], v[224:227], v[168:171], v[196:199]
  ds_read_b128 v[224:227], v1 offset:29696
  v_mul_f32 v212, s93, v212
  v_mfma_f32_16x16x32_bf16 v[196:199], v[228:231], v[172:175], v[196:199]
  ds_read_b128 v[228:231], v1 offset:28672
  v_mul_f32 v213, s93, v213
  v_mfma_f32_16x16x32_bf16 v[196:199], v[232:235], v[176:179], v[196:199]
  ds_read_b128 v[232:235], v1 offset:27648
  v_mul_f32 v214, s93, v214
  v_mfma_f32_16x16x32_bf16 v[196:199], v[236:239], v[180:183], v[196:199]
  ds_read_b128 v[236:239], v1 offset:26624
  v_mul_f32 v215, s93, v215
  v_cvt_pk_bf16_f32 v118, v212, v213
  v_cvt_pk_bf16_f32 v119, v214, v215
  s_waitcnt lgkmcnt(6)
  v_mfma_f32_16x16x32_bf16 v[208:211], v[240:243], v[160:163], 0
  ds_read_b128 v[240:243], v1 offset:25600
  v_mul_f32 v192, s93, v192
  v_mfma_f32_16x16x32_bf16 v[208:211], v[244:247], v[164:167], v[208:211]
  ds_read_b128 v[244:247], v1 offset:24576
  v_mul_f32 v193, s93, v193
  v_mfma_f32_16x16x32_bf16 v[208:211], v[248:251], v[168:171], v[208:211]
  ds_read_b128 v[248:251], v1 offset:23552
  v_mul_f32 v194, s93, v194
  v_mfma_f32_16x16x32_bf16 v[208:211], v[252:255], v[172:175], v[208:211]
  ds_read_b128 v[252:255], v1 offset:22528
  s_waitcnt lgkmcnt(6)
  v_mfma_f32_16x16x32_bf16 v[208:211], v[216:219], v[176:179], v[208:211]
  ds_read_b128 v[216:219], v1 offset:21504
  v_mul_f32 v195, s93, v195
  v_mfma_f32_16x16x32_bf16 v[208:211], v[220:223], v[180:183], v[208:211]
  ds_read_b128 v[220:223], v1 offset:20480
  v_cvt_pk_bf16_f32 v120, v192, v193
  v_mfma_f32_16x16x32_bf16 v[212:215], v[224:227], v[160:163], 0
  ds_read_b128 v[224:227], v1 offset:19456
  v_cvt_pk_bf16_f32 v121, v194, v195
  v_mfma_f32_16x16x32_bf16 v[212:215], v[228:231], v[164:167], v[212:215]
  ds_read_b128 v[228:231], v1 offset:18432
  s_waitcnt lgkmcnt(6)
  v_mfma_f32_16x16x32_bf16 v[212:215], v[232:235], v[168:171], v[212:215]
  ds_read_b128 v[232:235], v1 offset:17408
  v_mul_f32 v196, s93, v196
  v_mfma_f32_16x16x32_bf16 v[212:215], v[236:239], v[172:175], v[212:215]
  ds_read_b128 v[236:239], v1 offset:16384
  v_mul_f32 v197, s93, v197
  v_mfma_f32_16x16x32_bf16 v[212:215], v[240:243], v[176:179], v[212:215]
  ds_read_b128 v[240:243], v1 offset:15360
  v_mul_f32 v198, s93, v198
  v_mfma_f32_16x16x32_bf16 v[212:215], v[244:247], v[180:183], v[212:215]
  ds_read_b128 v[244:247], v1 offset:14336
  v_mul_f32 v199, s93, v199
  v_cvt_pk_bf16_f32 v122, v196, v197
  v_cvt_pk_bf16_f32 v123, v198, v199
  s_waitcnt lgkmcnt(6)
  v_mfma_f32_16x16x32_bf16 v[192:195], v[248:251], v[160:163], 0
  ds_read_b128 v[248:251], v1 offset:13312
  v_mul_f32 v208, s93, v208
  v_mfma_f32_16x16x32_bf16 v[192:195], v[252:255], v[164:167], v[192:195]
  ds_read_b128 v[252:255], v1 offset:12288
  v_mul_f32 v209, s93, v209
  v_mfma_f32_16x16x32_bf16 v[192:195], v[216:219], v[168:171], v[192:195]
  ds_read_b128 v[216:219], v1 offset:11264
  v_mul_f32 v210, s93, v210
  v_mfma_f32_16x16x32_bf16 v[192:195], v[220:223], v[172:175], v[192:195]
  ds_read_b128 v[220:223], v1 offset:10240
  s_waitcnt lgkmcnt(6)
  v_mfma_f32_16x16x32_bf16 v[192:195], v[224:227], v[176:179], v[192:195]
  ds_read_b128 v[224:227], v1 offset:9216
  v_mul_f32 v211, s93, v211
  v_mfma_f32_16x16x32_bf16 v[192:195], v[228:231], v[180:183], v[192:195]
  ds_read_b128 v[228:231], v1 offset:8192
  v_cvt_pk_bf16_f32 v124, v208, v209
  v_mfma_f32_16x16x32_bf16 v[196:199], v[232:235], v[160:163], 0
  ds_read_b128 v[232:235], v1 offset:7168
  v_cvt_pk_bf16_f32 v125, v210, v211
  v_mfma_f32_16x16x32_bf16 v[196:199], v[236:239], v[164:167], v[196:199]
  ds_read_b128 v[236:239], v1 offset:6144
  s_waitcnt lgkmcnt(6)
  v_mfma_f32_16x16x32_bf16 v[196:199], v[240:243], v[168:171], v[196:199]
  ds_read_b128 v[240:243], v1 offset:5120
  v_mul_f32 v212, s93, v212
  v_mfma_f32_16x16x32_bf16 v[196:199], v[244:247], v[172:175], v[196:199]
  ds_read_b128 v[244:247], v1 offset:4096
  v_mul_f32 v213, s93, v213
  s_barrier
  v_mfma_f32_16x16x32_bf16 v[196:199], v[248:251], v[176:179], v[196:199]
  ds_read_b128 v[248:251], v1 offset:3072
  v_mul_f32 v214, s93, v214
  v_mfma_f32_16x16x32_bf16 v[196:199], v[252:255], v[180:183], v[196:199]
  ds_read_b128 v[252:255], v1 offset:2048
  v_mul_f32 v215, s93, v215
  v_cvt_pk_bf16_f32 v126, v212, v213
  v_cvt_pk_bf16_f32 v127, v214, v215
  s_waitcnt lgkmcnt(6)
  v_mfma_f32_16x16x32_bf16 v[208:211], v[216:219], v[160:163], 0
  ds_read_b128 v[216:219], v1 offset:1024
  v_mul_f32 v192, s93, v192
  v_mfma_f32_16x16x32_bf16 v[208:211], v[220:223], v[164:167], v[208:211]
  ds_read_b128 v[220:223], v1 offset:0
  v_mul_f32 v193, s93, v193
  v_mfma_f32_16x16x32_bf16 v[208:211], v[224:227], v[168:171], v[208:211]
  v_mul_f32 v194, s93, v194
  v_mul_f32 v195, s93, v195
  v_mfma_f32_16x16x32_bf16 v[208:211], v[228:231], v[172:175], v[208:211]
  v_cvt_pk_bf16_f32 v128, v192, v193
  s_waitcnt lgkmcnt(4)
  v_mfma_f32_16x16x32_bf16 v[208:211], v[232:235], v[176:179], v[208:211]
  v_cvt_pk_bf16_f32 v129, v194, v195
  v_mul_f32 v196, s93, v196
  v_mfma_f32_16x16x32_bf16 v[208:211], v[236:239], v[180:183], v[208:211]
  v_mul_f32 v197, s93, v197
  v_mul_f32 v198, s93, v198
  v_mfma_f32_16x16x32_bf16 v[212:215], v[240:243], v[160:163], 0
  v_mul_f32 v199, s93, v199
  v_cvt_pk_bf16_f32 v130, v196, v197
  v_mfma_f32_16x16x32_bf16 v[212:215], v[244:247], v[164:167], v[212:215]
  v_cvt_pk_bf16_f32 v131, v198, v199
  s_waitcnt lgkmcnt(3)
  v_mfma_f32_16x16x32_bf16 v[212:215], v[248:251], v[168:171], v[212:215]
  v_mul_f32 v208, s93, v208
  s_waitcnt lgkmcnt(2)
  v_mfma_f32_16x16x32_bf16 v[212:215], v[252:255], v[172:175], v[212:215]
  v_mul_f32 v209, s93, v209
  s_waitcnt lgkmcnt(1)
  v_mfma_f32_16x16x32_bf16 v[212:215], v[216:219], v[176:179], v[212:215]
  v_mul_f32 v210, s93, v210
  s_waitcnt lgkmcnt(0)
  v_mfma_f32_16x16x32_bf16 v[212:215], v[220:223], v[180:183], v[212:215]
  v_mul_f32 v211, s93, v211
  s_setprio 0
  s_mul_i32 s100, s32, 7
  s_add_i32 s100, s100, s31
  s_add_u32 m0, s38, 107520
  s_nop 0
  buffer_load_dwordx4 v13, s[12:15], s100 offen lds
  s_add_u32 m0, s38, 108544
  s_nop 0
  buffer_load_dwordx4 v14, s[12:15], s100 offen lds
  s_add_u32 m0, s38, 109568
  s_nop 0
  buffer_load_dwordx4 v3, s[12:15], s100 offen lds
  s_add_u32 m0, s39, 107520
  s_nop 0
  buffer_load_dwordx4 v4, s[12:15], s100 offen lds
  s_mul_i32 s100, s32, 6
  s_add_i32 s100, s100, s31
  s_add_u32 m0, s38, 92160
  s_nop 0
  buffer_load_dwordx4 v13, s[12:15], s100 offen lds
  s_add_u32 m0, s38, 93184
  s_nop 0
  buffer_load_dwordx4 v14, s[12:15], s100 offen lds
  s_add_u32 m0, s38, 94208
  s_nop 0
  buffer_load_dwordx4 v3, s[12:15], s100 offen lds
  s_add_u32 m0, s39, 92160
  s_nop 0
  buffer_load_dwordx4 v4, s[12:15], s100 offen lds
  s_mul_i32 s100, s32, 5
  s_add_i32 s100, s100, s31
  s_add_u32 m0, s38, 76800
  s_nop 0
  buffer_load_dwordx4 v13, s[12:15], s100 offen lds
  s_add_u32 m0, s38, 77824
  s_nop 0
  buffer_load_dwordx4 v14, s[12:15], s100 offen lds
  s_add_u32 m0, s38, 78848
  s_nop 0
  buffer_load_dwordx4 v3, s[12:15], s100 offen lds
  s_add_u32 m0, s39, 76800
  s_nop 0
  buffer_load_dwordx4 v4, s[12:15], s100 offen lds
  s_barrier
  s_mul_i32 s100, s32, 4
  s_add_i32 s100, s100, s31
  s_add_u32 m0, s38, 61440
  s_nop 0
  buffer_load_dwordx4 v13, s[12:15], s100 offen lds
  s_add_u32 m0, s38, 62464
  s_nop 0
  buffer_load_dwordx4 v14, s[12:15], s100 offen lds
  s_add_u32 m0, s38, 63488
  s_nop 0
  buffer_load_dwordx4 v3, s[12:15], s100 offen lds
  s_add_u32 m0, s39, 61440
  s_nop 0
  buffer_load_dwordx4 v4, s[12:15], s100 offen lds
  s_mul_i32 s100, s32, 3
  s_add_i32 s100, s100, s31
  s_add_u32 m0, s38, 46080
  s_nop 0
  buffer_load_dwordx4 v13, s[12:15], s100 offen lds
  s_add_u32 m0, s38, 47104
  s_nop 0
  buffer_load_dwordx4 v14, s[12:15], s100 offen lds
  s_add_u32 m0, s38, 48128
  s_nop 0
  buffer_load_dwordx4 v3, s[12:15], s100 offen lds
  s_add_u32 m0, s39, 46080
  s_nop 0
  buffer_load_dwordx4 v4, s[12:15], s100 offen lds
  s_mul_i32 s100, s32, 2
  s_add_i32 s100, s100, s31
  s_add_u32 m0, s38, 30720
  s_nop 0
  buffer_load_dwordx4 v13, s[12:15], s100 offen lds
  s_add_u32 m0, s38, 31744
  s_nop 0
  buffer_load_dwordx4 v14, s[12:15], s100 offen lds
  s_add_u32 m0, s38, 32768
  s_nop 0
  buffer_load_dwordx4 v3, s[12:15], s100 offen lds
  s_add_u32 m0, s39, 30720
  s_nop 0
  buffer_load_dwordx4 v4, s[12:15], s100 offen lds
  s_waitcnt vmcnt(12)
  s_barrier
  s_max_u32 s100, s33, 1
  s_mul_i32 s100, s100, s32
  s_add_i32 s100, s100, s31
  s_add_u32 m0, s38, 15360
  s_nop 0
  buffer_load_dwordx4 v13, s[12:15], s100 offen lds
  s_add_u32 m0, s38, 16384
  s_nop 0
  buffer_load_dwordx4 v14, s[12:15], s100 offen lds
  s_add_u32 m0, s38, 17408
  s_nop 0
  buffer_load_dwordx4 v3, s[12:15], s100 offen lds
  s_add_u32 m0, s39, 15360
  s_nop 0
  buffer_load_dwordx4 v4, s[12:15], s100 offen lds
  s_max_u32 s100, s33, 0
  s_mul_i32 s100, s100, s32
  s_add_i32 s100, s100, s31
  s_add_u32 m0, s38, 0
  s_nop 0
  buffer_load_dwordx4 v13, s[12:15], s100 offen lds
  s_add_u32 m0, s38, 1024
  s_nop 0
  buffer_load_dwordx4 v14, s[12:15], s100 offen lds
  s_add_u32 m0, s38, 2048
  s_nop 0
  buffer_load_dwordx4 v3, s[12:15], s100 offen lds
  s_add_u32 m0, s39, 0
  s_nop 0
  buffer_load_dwordx4 v4, s[12:15], s100 offen lds
  s_waitcnt vmcnt(8)
  s_barrier
  ds_read_b128 v[224:227], v7 offset:61440
  ds_read_b128 v[228:231], v8 offset:61440
  ds_read_b128 v[232:235], v7 offset:61568
  ds_read_b128 v[236:239], v8 offset:61568
  ds_read_b128 v[240:243], v7 offset:61696
  ds_read_b128 v[244:247], v8 offset:61696
  ds_read_b128 v[248:251], v7 offset:53760
  ds_read_b128 v[252:255], v8 offset:53760
  ds_read_b128 v[216:219], v7 offset:53888
  ds_read_b128 v[220:223], v8 offset:53888
  s_waitcnt lgkmcnt(6)
  v_mfma_f32_16x16x32_bf16 v[84:87], v[224:227], v[112:115], v[84:87]
  ds_read_b128 v[224:227], v7 offset:54016
  v_cvt_pk_bf16_f32 v132, v208, v209
  v_mfma_f32_16x16x32_bf16 v[84:87], v[228:231], v[116:119], v[84:87]
  ds_read_b128 v[228:231], v8 offset:54016
  v_cvt_pk_bf16_f32 v133, v210, v211
  v_mfma_f32_16x16x32_bf16 v[84:87], v[232:235], v[120:123], v[84:87]
  ds_read_b128 v[232:235], v7 offset:46080
  v_mul_f32 v212, s93, v212
  v_mfma_f32_16x16x32_bf16 v[84:87], v[236:239], v[124:127], v[84:87]
  ds_read_b128 v[236:239], v8 offset:46080
  s_waitcnt lgkmcnt(6)
  v_mfma_f32_16x16x32_bf16 v[84:87], v[240:243], v[128:131], v[84:87]
  ds_read_b128 v[240:243], v7 offset:46208
  v_mul_f32 v213, s93, v213
  v_mul_f32 v214, s93, v214
  v_mul_f32 v215, s93, v215
  v_cvt_pk_bf16_f32 v134, v212, v213
  v_cvt_pk_bf16_f32 v135, v214, v215
  s_nop 1
  v_mfma_f32_16x16x32_bf16 v[84:87], v[244:247], v[132:135], v[84:87]
  ds_read_b128 v[244:247], v8 offset:46208
  v_add_u32 v2, 102400, v1
  v_mfma_f32_16x16x32_bf16 v[80:83], v[248:251], v[112:115], v[60:63]
  ds_read_b128 v[248:251], v7 offset:46336
  v_mov_b32 v192, 0x3f803f80
  v_mfma_f32_16x16x32_bf16 v[80:83], v[252:255], v[116:119], v[80:83]
  ds_read_b128 v[252:255], v8 offset:46336
  s_waitcnt lgkmcnt(6)
  v_mfma_f32_16x16x32_bf16 v[80:83], v[216:219], v[120:123], v[80:83]
  v_exp_f32 v204, v84
  v_mfma_f32_16x16x32_bf16 v[80:83], v[220:223], v[124:127], v[80:83]
  v_exp_f32 v205, v85
  v_mfma_f32_16x16x32_bf16 v[80:83], v[224:227], v[128:131], v[80:83]
  v_exp_f32 v206, v86
  v_mfma_f32_16x16x32_bf16 v[80:83], v[228:231], v[132:135], v[80:83]
  ds_read_b128 v[216:219], v7 offset:38400
  s_waitcnt vmcnt(0)
  s_barrier
  ds_read_b128 v[220:223], v8 offset:38400
  ds_read_b128 v[224:227], v7 offset:38528
  ds_read_b128 v[228:231], v8 offset:38528
  s_waitcnt lgkmcnt(6)
  v_mfma_f32_16x16x32_bf16 v[76:79], v[232:235], v[112:115], v[60:63]
  v_exp_f32 v207, v87
  v_mfma_f32_16x16x32_bf16 v[76:79], v[236:239], v[116:119], v[76:79]
  ds_read_b128 v[232:235], v7 offset:38656
  ds_read_b128 v[236:239], v8 offset:38656
  v_mfma_f32_16x16x32_bf16 v[76:79], v[240:243], v[120:123], v[76:79]
  ds_read_b128 v[240:243], v7 offset:30720
  v_mov_b32 v193, 0x3f803f80
  v_mfma_f32_16x16x32_bf16 v[76:79], v[244:247], v[124:127], v[76:79]
  ds_read_b128 v[244:247], v8 offset:30720
  s_waitcnt lgkmcnt(6)
  v_mfma_f32_16x16x32_bf16 v[76:79], v[248:251], v[128:131], v[76:79]
  v_exp_f32 v208, v80
  v_mfma_f32_16x16x32_bf16 v[76:79], v[252:255], v[132:135], v[76:79]
  v_exp_f32 v209, v81
  v_mfma_f32_16x16x32_bf16 v[72:75], v[216:219], v[112:115], v[60:63]
  v_exp_f32 v210, v82
  v_mfma_f32_16x16x32_bf16 v[72:75], v[220:223], v[116:119], v[72:75]
  ds_read_b128 v[248:251], v7 offset:30848
  s_waitcnt lgkmcnt(4)
  v_mfma_f32_16x16x32_bf16 v[72:75], v[224:227], v[120:123], v[72:75]
  v_exp_f32 v211, v83
  v_mfma_f32_16x16x32_bf16 v[72:75], v[228:231], v[124:127], v[72:75]
  ds_read_b128 v[252:255], v8 offset:30848
  ds_read_b128 v[216:219], v7 offset:30976
  v_mfma_f32_16x16x32_bf16 v[72:75], v[232:235], v[128:131], v[72:75]
  ds_read_b128 v[220:223], v8 offset:30976
  s_waitcnt lgkmcnt(4)
  v_mfma_f32_16x16x32_bf16 v[72:75], v[236:239], v[132:135], v[72:75]
  ds_read_b128 v[224:227], v7 offset:23040
  ds_read_b128 v[228:231], v8 offset:23040
  v_mfma_f32_16x16x32_bf16 v[68:71], v[240:243], v[112:115], v[60:63]
  ds_read_b128 v[232:235], v7 offset:23168
  ds_read_b128 v[236:239], v8 offset:23168
  v_mov_b32 v194, 0x3f803f80
  v_mfma_f32_16x16x32_bf16 v[68:71], v[244:247], v[116:119], v[68:71]
  ds_read_b128 v[240:243], v7 offset:23296
  v_mov_b32 v195, 0x3f803f80
  s_waitcnt lgkmcnt(5)
  v_mfma_f32_16x16x32_bf16 v[68:71], v[248:251], v[120:123], v[68:71]
  ds_read_b128 v[244:247], v8 offset:23296
  ds_read_b128 v[248:251], v7 offset:15360
  v_cvt_pk_bf16_f32 v166, v204, v205
  v_mfma_f32_16x16x32_bf16 v[68:71], v[252:255], v[124:127], v[68:71]
  v_exp_f32 v212, v76
  v_mfma_f32_16x16x32_bf16 v[68:71], v[216:219], v[128:131], v[68:71]
  v_exp_f32 v213, v77
  v_mfma_f32_16x16x32_bf16 v[68:71], v[220:223], v[132:135], v[68:71]
  ds_read_b128 v[252:255], v8 offset:15360
  v_and_b32 v14, 128, v1
  buffer_load_dword v13, v14, s[8:11], 0 offen
  s_waitcnt lgkmcnt(4)
  v_mfma_f32_16x16x32_bf16 v[64:67], v[224:227], v[112:115], v[60:63]
  v_exp_f32 v214, v78
  v_mfma_f32_16x16x32_bf16 v[64:67], v[228:231], v[116:119], v[64:67]
  v_exp_f32 v215, v79
  v_mfma_f32_16x16x32_bf16 v[64:67], v[232:235], v[120:123], v[64:67]
  ds_read_b128 v[216:219], v7 offset:15488
  ds_read_b128 v[220:223], v8 offset:15488
  v_cvt_pk_bf16_f32 v167, v206, v207
  v_mfma_f32_16x16x32_bf16 v[64:67], v[236:239], v[124:127], v[64:67]
  ds_read_b128 v[224:227], v7 offset:15616
  v_cvt_pk_bf16_f32 v164, v208, v209
  s_waitcnt lgkmcnt(4)
  v_mfma_f32_16x16x32_bf16 v[64:67], v[240:243], v[128:131], v[64:67]
  v_exp_f32 v204, v72
  v_mfma_f32_16x16x32_bf16 v[64:67], v[244:247], v[132:135], v[64:67]
  ds_read_b128 v[228:231], v8 offset:15616
  ds_read_b128 v[232:235], v7 offset:7680
  v_cvt_pk_bf16_f32 v165, v210, v211
  v_mfma_f32_16x16x32_bf16 v[60:63], v[248:251], v[112:115], v[60:63]
  ds_read_b128 v[236:239], v8 offset:7680
  v_cvt_pk_bf16_f32 v162, v212, v213
  s_waitcnt lgkmcnt(4)
  v_mfma_f32_16x16x32_bf16 v[60:63], v[252:255], v[116:119], v[60:63]
  v_exp_f32 v205, v73
  v_mfma_f32_16x16x32_bf16 v[60:63], v[216:219], v[120:123], v[60:63]
  ds_read_b128 v[240:243], v7 offset:7808
  ds_read_b128 v[244:247], v8 offset:7808
  v_cvt_pk_bf16_f32 v163, v214, v215
  v_mfma_f32_16x16x32_bf16 v[60:63], v[220:223], v[124:127], v[60:63]
  ds_read_b128 v[248:251], v7 offset:7936
  v_cvt_pk_bf16_f32 v160, v204, v205
  s_waitcnt lgkmcnt(4)
  v_mfma_f32_16x16x32_bf16 v[60:63], v[224:227], v[128:131], v[60:63]
  v_exp_f32 v206, v74
  v_mfma_f32_16x16x32_bf16 v[60:63], v[228:231], v[132:135], v[60:63]
  ds_read_b128 v[252:255], v8 offset:7936
  ds_read_b64_tr_b16 v[216:217], v9 offset:38400
  v_exp_f32 v207, v75
  s_mov_b32 s53, 0x40000
  s_mov_b32 s46, 72
NPOLL:
  s_waitcnt vmcnt(0)
  v_cmp_le_u32 s[48:49], s46, v13
  s_sub_u32 s53, s53, 1
  s_cbranch_scc1 NPOLLD
  s_cmp_eq_u64 s[48:49], -1
  s_cbranch_scc1 NPOLLD
  buffer_load_dword v13, v14, s[8:11], 0 offen sc1
  s_branch NPOLL
NPOLLD:
  s_add_u32 m0, s40, 0
  s_add_u32 s100, s40, 30720
  buffer_load_dwordx4 v1, s[20:23], s100 offen sc1 lds
  s_add_u32 m0, s40, 2048
  s_add_u32 s100, s40, 32768
  buffer_load_dwordx4 v1, s[20:23], s100 offen sc1 lds
  s_add_u32 m0, s40, 4096
  s_add_u32 s100, s40, 34816
  buffer_load_dwordx4 v1, s[20:23], s100 offen sc1 lds
  s_add_u32 m0, s40, 6144
  s_add_u32 s100, s40, 36864
  buffer_load_dwordx4 v1, s[20:23], s100 offen sc1 lds
  s_add_u32 m0, s40, 8192
  s_add_u32 s100, s40, 38912
  buffer_load_dwordx4 v1, s[20:23], s100 offen sc1 lds
  s_barrier
  s_add_u32 m0, s40, 133120
  s_add_u32 s100, s40, 0
  buffer_load_dwordx4 v1, s[20:23], s100 offen sc1 lds
  s_add_u32 m0, s40, 135168
  s_add_u32 s100, s40, 2048
  buffer_load_dwordx4 v1, s[20:23], s100 offen sc1 lds
  s_add_u32 m0, s40, 137216
  s_add_u32 s100, s40, 4096
  buffer_load_dwordx4 v1, s[20:23], s100 offen sc1 lds
  s_add_u32 m0, s40, 139264
  s_add_u32 s100, s40, 6144
  buffer_load_dwordx4 v1, s[20:23], s100 offen sc1 lds
  s_add_u32 m0, s40, 141312
  s_add_u32 s100, s40, 8192
  buffer_load_dwordx4 v1, s[20:23], s100 offen sc1 lds
  s_add_u32 m0, s40, 143360
  s_add_u32 s100, s40, 10240
  buffer_load_dwordx4 v1, s[20:23], s100 offen sc1 lds
  s_add_u32 m0, s40, 145408
  s_add_u32 s100, s40, 12288
  buffer_load_dwordx4 v1, s[20:23], s100 offen sc1 lds
  s_add_u32 m0, s40, 147456
  s_add_u32 s100, s40, 14336
  buffer_load_dwordx4 v1, s[20:23], s100 offen sc1 lds
  s_add_u32 m0, s40, 149504
  s_add_u32 s100, s40, 16384
  buffer_load_dwordx4 v1, s[20:23], s100 offen sc1 lds
  s_add_u32 m0, s40, 151552
  s_add_u32 s100, s40, 18432
  buffer_load_dwordx4 v1, s[20:23], s100 offen sc1 lds
  s_add_u32 m0, s40, 153600
  s_add_u32 s100, s40, 20480
  buffer_load_dwordx4 v1, s[20:23], s100 offen sc1 lds
  s_add_u32 m0, s40, 155648
  s_add_u32 s100, s40, 22528
  buffer_load_dwordx4 v1, s[20:23], s100 offen sc1 lds
  s_add_u32 m0, s40, 157696
  s_add_u32 s100, s40, 24576
  buffer_load_dwordx4 v1, s[20:23], s100 offen sc1 lds
  s_add_u32 m0, s40, 159744
  s_add_u32 s100, s40, 26624
  buffer_load_dwordx4 v1, s[20:23], s100 offen sc1 lds
  s_add_u32 m0, s40, 161792
  s_add_u32 s100, s40, 28672
  buffer_load_dwordx4 v1, s[20:23], s100 offen sc1 lds
  v_mfma_f32_16x16x32_bf16 v[56:59], v[232:235], v[112:115], v[56:59]
  ds_read_b64_tr_b16 v[218:219], v9 offset:46080
  v_cvt_pk_bf16_f32 v161, v206, v207
  s_waitcnt lgkmcnt(4)
  v_mfma_f32_16x16x32_bf16 v[56:59], v[236:239], v[116:119], v[56:59]
  ds_read_b64_tr_b16 v[220:221], v10 offset:38400
  ds_read_b64_tr_b16 v[222:223], v10 offset:46080
  v_exp_f32 v208, v68
  v_mfma_f32_16x16x32_bf16 v[56:59], v[240:243], v[120:123], v[56:59]
  ds_read_b64_tr_b16 v[224:225], v11 offset:38400
  ds_read_b64_tr_b16 v[226:227], v11 offset:46080
  v_exp_f32 v209, v69
  v_mfma_f32_16x16x32_bf16 v[56:59], v[244:247], v[124:127], v[56:59]
  ds_read_b64_tr_b16 v[228:229], v12 offset:38400
  ds_read_b64_tr_b16 v[230:231], v12 offset:46080
  v_cvt_pk_bf16_f32 v158, v208, v209
  s_waitcnt lgkmcnt(6)
  v_mfma_f32_16x16x32_bf16 v[56:59], v[248:251], v[128:131], v[56:59]
  ds_read_b64_tr_b16 v[232:233], v9 offset:38528
  ds_read_b64_tr_b16 v[234:235], v9 offset:46208
  v_exp_f32 v210, v70
  v_mfma_f32_16x16x32_bf16 v[56:59], v[252:255], v[132:135], v[56:59]
  ds_read_b64_tr_b16 v[236:237], v10 offset:38528
  ds_read_b64_tr_b16 v[238:239], v10 offset:46208
  v_exp_f32 v211, v71
  s_waitcnt vmcnt(0)
  s_barrier
  s_add_u32 m0, s40, 102400
  s_add_u32 s100, s40, 40960
  buffer_load_dwordx4 v1, s[20:23], s100 offen sc1 lds
  s_add_u32 m0, s40, 104448
  s_add_u32 s100, s40, 43008
  buffer_load_dwordx4 v1, s[20:23], s100 offen sc1 lds
  s_add_u32 m0, s40, 106496
  s_add_u32 s100, s40, 45056
  buffer_load_dwordx4 v1, s[20:23], s100 offen sc1 lds
  s_add_u32 m0, s40, 108544
  s_add_u32 s100, s40, 47104
  buffer_load_dwordx4 v1, s[20:23], s100 offen sc1 lds
  s_add_u32 m0, s40, 110592
  s_add_u32 s100, s40, 49152
  buffer_load_dwordx4 v1, s[20:23], s100 offen sc1 lds
  s_add_u32 m0, s40, 112640
  s_add_u32 s100, s40, 51200
  buffer_load_dwordx4 v1, s[20:23], s100 offen sc1 lds
  s_add_u32 m0, s40, 114688
  s_add_u32 s100, s40, 53248
  buffer_load_dwordx4 v1, s[20:23], s100 offen sc1 lds
  s_add_u32 m0, s40, 116736
  s_add_u32 s100, s40, 55296
  buffer_load_dwordx4 v1, s[20:23], s100 offen sc1 lds
  s_add_u32 m0, s40, 118784
  s_add_u32 s100, s40, 57344
  buffer_load_dwordx4 v1, s[20:23], s100 offen sc1 lds
  s_add_u32 m0, s40, 120832
  s_add_u32 s100, s40, 59392
  buffer_load_dwordx4 v1, s[20:23], s100 offen sc1 lds
  s_add_u32 m0, s40, 122880
  s_add_u32 s100, s40, 61440
  buffer_load_dwordx4 v1, s[20:23], s100 offen sc1 lds
  s_add_u32 m0, s40, 124928
  s_add_u32 s100, s40, 63488
  buffer_load_dwordx4 v1, s[20:23], s100 offen sc1 lds
  s_add_u32 m0, s40, 126976
  s_add_u32 s100, s40, 65536
  buffer_load_dwordx4 v1, s[20:23], s100 offen sc1 lds
  s_add_u32 m0, s40, 129024
  s_add_u32 s100, s40, 67584
  buffer_load_dwordx4 v1, s[20:23], s100 offen sc1 lds
  s_add_u32 m0, s40, 131072
  s_add_u32 s100, s40, 69632
  buffer_load_dwordx4 v1, s[20:23], s100 offen sc1 lds
  s_waitcnt vmcnt(0)
  s_barrier
  s_nop 0
  v_cvt_pk_bf16_f32 v159, v210, v211
  v_exp_f32 v212, v64
  v_exp_f32 v213, v65
  v_exp_f32 v214, v66
  v_exp_f32 v215, v67
  v_cvt_pk_bf16_f32 v156, v212, v213
  v_cvt_pk_bf16_f32 v157, v214, v215
  v_exp_f32 v204, v60
  v_exp_f32 v205, v61
  v_exp_f32 v206, v62
  v_exp_f32 v207, v63
  v_cvt_pk_bf16_f32 v154, v204, v205
  v_cvt_pk_bf16_f32 v155, v206, v207
  v_exp_f32 v208, v56
  v_exp_f32 v209, v57
  v_exp_f32 v210, v58
  v_exp_f32 v211, v59
  v_cvt_pk_bf16_f32 v152, v208, v209
  v_cvt_pk_bf16_f32 v153, v210, v211
  v_mfma_f32_16x16x32_bf16 v[188:191], v[192:195], v[164:167], 0
  ds_read_b64_tr_b16 v[240:241], v11 offset:38528
  ds_read_b64_tr_b16 v[242:243], v11 offset:46208
  v_mfma_f32_16x16x32_bf16 v[188:191], v[192:195], v[160:163], v[188:191]
  ds_read_b64_tr_b16 v[244:245], v12 offset:38528
  ds_read_b64_tr_b16 v[246:247], v12 offset:46208
  v_mfma_f32_16x16x32_bf16 v[188:191], v[192:195], v[156:159], v[188:191]
  v_mfma_f32_16x16x32_bf16 v[188:191], v[192:195], v[152:155], v[188:191]
  s_nop 7
  v_subrev_u32 v23, 813694976, v188
  s_mov_b32 s52, 503316480
  v_cmp_gt_u32 s[48:49], s52, v23
  s_or_b64 s[48:49], s[48:49], s[44:45]
  s_cmp_eq_u64 s[48:49], -1
  s_cbranch_scc0 FB1s
FBR1s:
  v_mfma_f32_16x16x32_bf16 v[88:91], v[216:219], v[160:163], 0
  s_waitcnt lgkmcnt(8)
  v_mfma_f32_16x16x32_bf16 v[92:95], v[220:223], v[160:163], 0
  ds_read_b64_tr_b16 v[248:249], v9 offset:38656
  ds_read_b64_tr_b16 v[250:251], v9 offset:46336
  v_mfma_f32_16x16x32_bf16 v[96:99], v[224:227], v[160:163], 0
  ds_read_b64_tr_b16 v[252:253], v10 offset:38656
  ds_read_b64_tr_b16 v[254:255], v10 offset:46336
  v_mfma_f32_16x16x32_bf16 v[100:103], v[228:231], v[160:163], 0
  ds_read_b64_tr_b16 v[216:217], v11 offset:38656
  ds_read_b64_tr_b16 v[218:219], v11 offset:46336
  s_waitcnt lgkmcnt(8)
  v_mfma_f32_16x16x32_bf16 v[104:107], v[232:235], v[160:163], 0
  ds_read_b64_tr_b16 v[220:221], v12 offset:38656
  ds_read_b64_tr_b16 v[222:223], v12 offset:46336
  v_mfma_f32_16x16x32_bf16 v[108:111], v[236:239], v[160:163], 0
  ds_read_b64_tr_b16 v[224:225], v9 offset:53760
  ds_read_b64_tr_b16 v[226:227], v9 offset:61440
  v_mfma_f32_16x16x32_bf16 v[112:115], v[240:243], v[160:163], 0
  ds_read_b64_tr_b16 v[228:229], v10 offset:53760
  ds_read_b64_tr_b16 v[230:231], v10 offset:61440
  s_waitcnt lgkmcnt(8)
  v_mfma_f32_16x16x32_bf16 v[116:119], v[244:247], v[160:163], 0
  ds_read_b64_tr_b16 v[232:233], v11 offset:53760
  ds_read_b64_tr_b16 v[234:235], v11 offset:61440
  v_mfma_f32_16x16x32_bf16 v[120:123], v[248:251], v[160:163], 0
  ds_read_b64_tr_b16 v[236:237], v12 offset:53760
  ds_read_b64_tr_b16 v[238:239], v12 offset:61440
  v_mfma_f32_16x16x32_bf16 v[124:127], v[252:255], v[160:163], 0
  ds_read_b64_tr_b16 v[240:241], v9 offset:53888
  ds_read_b64_tr_b16 v[242:243], v9 offset:61568
  s_waitcnt lgkmcnt(8)
  v_mfma_f32_16x16x32_bf16 v[128:131], v[216:219], v[160:163], 0
  ds_read_b64_tr_b16 v[244:245], v10 offset:53888
  ds_read_b64_tr_b16 v[246:247], v10 offset:61568
  v_mfma_f32_16x16x32_bf16 v[132:135], v[220:223], v[160:163], 0
  ds_read_b64_tr_b16 v[248:249], v11 offset:53888
  ds_read_b64_tr_b16 v[250:251], v11 offset:61568
  v_mfma_f32_16x16x32_bf16 v[88:91], v[224:227], v[164:167], v[88:91]
  ds_read_b64_tr_b16 v[252:253], v12 offset:53888
  ds_read_b64_tr_b16 v[254:255], v12 offset:61568
  s_waitcnt lgkmcnt(8)
  v_mfma_f32_16x16x32_bf16 v[92:95], v[228:231], v[164:167], v[92:95]
  v_rcp_f32 v23, v188
  v_mfma_f32_16x16x32_bf16 v[96:99], v[232:235], v[164:167], v[96:99]
  ds_read_b64_tr_b16 v[216:217], v9 offset:54016
  ds_read_b64_tr_b16 v[218:219], v9 offset:61696
  v_mfma_f32_16x16x32_bf16 v[100:103], v[236:239], v[164:167], v[100:103]
  ds_read_b64_tr_b16 v[220:221], v10 offset:54016
  ds_read_b64_tr_b16 v[222:223], v10 offset:61696
  s_waitcnt lgkmcnt(8)
  v_mfma_f32_16x16x32_bf16 v[104:107], v[240:243], v[164:167], v[104:107]
  ds_read_b64_tr_b16 v[224:225], v11 offset:54016
  ds_read_b64_tr_b16 v[226:227], v11 offset:61696
  v_mfma_f32_16x16x32_bf16 v[108:111], v[244:247], v[164:167], v[108:111]
  ds_read_b64_tr_b16 v[228:229], v12 offset:54016
  ds_read_b64_tr_b16 v[230:231], v12 offset:61696
  s_waitcnt lgkmcnt(8)
  v_mfma_f32_16x16x32_bf16 v[112:115], v[248:251], v[164:167], v[112:115]
  ds_read_b64_tr_b16 v[232:233], v9 offset:23040
  ds_read_b64_tr_b16 v[234:235], v9 offset:30720
  v_mfma_f32_16x16x32_bf16 v[116:119], v[252:255], v[164:167], v[116:119]
  ds_read_b64_tr_b16 v[236:237], v10 offset:23040
  ds_read_b64_tr_b16 v[238:239], v10 offset:30720
  s_waitcnt lgkmcnt(8)
  v_mfma_f32_16x16x32_bf16 v[120:123], v[216:219], v[164:167], v[120:123]
  ds_read_b64_tr_b16 v[240:241], v11 offset:23040
  ds_read_b64_tr_b16 v[242:243], v11 offset:30720
  v_mfma_f32_16x16x32_bf16 v[124:127], v[220:223], v[164:167], v[124:127]
  ds_read_b64_tr_b16 v[244:245], v12 offset:23040
  ds_read_b64_tr_b16 v[246:247], v12 offset:30720
  s_waitcnt lgkmcnt(8)
  v_mfma_f32_16x16x32_bf16 v[128:131], v[224:227], v[164:167], v[128:131]
  ds_read_b64_tr_b16 v[248:249], v9 offset:23168
  ds_read_b64_tr_b16 v[250:251], v9 offset:30848
  v_mfma_f32_16x16x32_bf16 v[132:135], v[228:231], v[164:167], v[132:135]
  ds_read_b64_tr_b16 v[252:253], v10 offset:23168
  ds_read_b64_tr_b16 v[254:255], v10 offset:30848
  s_waitcnt lgkmcnt(8)
  v_mfma_f32_16x16x32_bf16 v[88:91], v[232:235], v[156:159], v[88:91]
  ds_read_b64_tr_b16 v[216:217], v11 offset:23168
  ds_read_b64_tr_b16 v[218:219], v11 offset:30848
  v_mfma_f32_16x16x32_bf16 v[92:95], v[236:239], v[156:159], v[92:95]
  ds_read_b64_tr_b16 v[220:221], v12 offset:23168
  ds_read_b64_tr_b16 v[222:223], v12 offset:30848
  s_waitcnt lgkmcnt(8)
  v_mfma_f32_16x16x32_bf16 v[96:99], v[240:243], v[156:159], v[96:99]
  ds_read_b64_tr_b16 v[224:225], v9 offset:23296
  ds_read_b64_tr_b16 v[226:227], v9 offset:30976
  v_mfma_f32_16x16x32_bf16 v[100:103], v[244:247], v[156:159], v[100:103]
  ds_read_b64_tr_b16 v[228:229], v10 offset:23296
  ds_read_b64_tr_b16 v[230:231], v10 offset:30976
  s_waitcnt lgkmcnt(8)
  v_mfma_f32_16x16x32_bf16 v[104:107], v[248:251], v[156:159], v[104:107]
  ds_read_b64_tr_b16 v[232:233], v11 offset:23296
  ds_read_b64_tr_b16 v[234:235], v11 offset:30976
  v_mfma_f32_16x16x32_bf16 v[108:111], v[252:255], v[156:159], v[108:111]
  ds_read_b64_tr_b16 v[236:237], v12 offset:23296
  ds_read_b64_tr_b16 v[238:239], v12 offset:30976
  s_waitcnt lgkmcnt(8)
  v_mfma_f32_16x16x32_bf16 v[112:115], v[216:219], v[156:159], v[112:115]
  ds_read_b64_tr_b16 v[240:241], v9 offset:7680
  ds_read_b64_tr_b16 v[242:243], v9 offset:15360
  v_mfma_f32_16x16x32_bf16 v[116:119], v[220:223], v[156:159], v[116:119]
  ds_read_b64_tr_b16 v[244:245], v10 offset:7680
  ds_read_b64_tr_b16 v[246:247], v10 offset:15360
  s_waitcnt lgkmcnt(8)
  v_mfma_f32_16x16x32_bf16 v[120:123], v[224:227], v[156:159], v[120:123]
  ds_read_b64_tr_b16 v[248:249], v11 offset:7680
  ds_read_b64_tr_b16 v[250:251], v11 offset:15360
  v_mfma_f32_16x16x32_bf16 v[124:127], v[228:231], v[156:159], v[124:127]
  ds_read_b64_tr_b16 v[252:253], v12 offset:7680
  ds_read_b64_tr_b16 v[254:255], v12 offset:15360
  s_waitcnt lgkmcnt(8)
  v_mfma_f32_16x16x32_bf16 v[128:131], v[232:235], v[156:159], v[128:131]
  ds_read_b64_tr_b16 v[216:217], v9 offset:7808
  ds_read_b64_tr_b16 v[218:219], v9 offset:15488
  v_mfma_f32_16x16x32_bf16 v[132:135], v[236:239], v[156:159], v[132:135]
  ds_read_b64_tr_b16 v[220:221], v10 offset:7808
  ds_read_b64_tr_b16 v[222:223], v10 offset:15488
  s_waitcnt lgkmcnt(8)
  v_mfma_f32_16x16x32_bf16 v[88:91], v[240:243], v[152:155], v[88:91]
  ds_read_b64_tr_b16 v[224:225], v11 offset:7808
  ds_read_b64_tr_b16 v[226:227], v11 offset:15488
  v_mfma_f32_16x16x32_bf16 v[92:95], v[244:247], v[152:155], v[92:95]
  ds_read_b64_tr_b16 v[228:229], v12 offset:7808
  ds_read_b64_tr_b16 v[230:231], v12 offset:15488
  s_waitcnt lgkmcnt(8)
  v_mfma_f32_16x16x32_bf16 v[96:99], v[248:251], v[152:155], v[96:99]
  ds_read_b64_tr_b16 v[232:233], v9 offset:7936
  ds_read_b64_tr_b16 v[234:235], v9 offset:15616
  v_mfma_f32_16x16x32_bf16 v[100:103], v[252:255], v[152:155], v[100:103]
  ds_read_b64_tr_b16 v[236:237], v10 offset:7936
  ds_read_b64_tr_b16 v[238:239], v10 offset:15616
  s_waitcnt lgkmcnt(8)
  v_mfma_f32_16x16x32_bf16 v[104:107], v[216:219], v[152:155], v[104:107]
  ds_read_b64_tr_b16 v[240:241], v11 offset:7936
  ds_read_b64_tr_b16 v[242:243], v11 offset:15616
  v_mfma_f32_16x16x32_bf16 v[108:111], v[220:223], v[152:155], v[108:111]
  ds_read_b64_tr_b16 v[244:245], v12 offset:7936
  ds_read_b64_tr_b16 v[246:247], v12 offset:15616
  s_waitcnt lgkmcnt(8)
  v_mfma_f32_16x16x32_bf16 v[112:115], v[224:227], v[152:155], v[112:115]
  v_cvt_pk_bf16_f32 v156, v88, v89
  v_cvt_pk_bf16_f32 v157, v90, v91
  v_mfma_f32_16x16x32_bf16 v[116:119], v[228:231], v[152:155], v[116:119]
  v_cvt_pk_bf16_f32 v158, v92, v93
  s_waitcnt lgkmcnt(6)
  v_mfma_f32_16x16x32_bf16 v[120:123], v[232:235], v[152:155], v[120:123]
  v_cvt_pk_bf16_f32 v159, v94, v95
  s_waitcnt lgkmcnt(4)
  v_mfma_f32_16x16x32_bf16 v[124:127], v[236:239], v[152:155], v[124:127]
  v_cvt_pk_bf16_f32 v160, v96, v97
  s_waitcnt lgkmcnt(2)
  v_mfma_f32_16x16x32_bf16 v[128:131], v[240:243], v[152:155], v[128:131]
  v_cvt_pk_bf16_f32 v161, v98, v99
  s_waitcnt lgkmcnt(0)
  v_mfma_f32_16x16x32_bf16 v[132:135], v[244:247], v[152:155], v[132:135]
  v_cvt_pk_bf16_f32 v162, v100, v101
  ds_read_b128 v[248:251], v2 offset:30720
  ds_read_b128 v[252:255], v2 offset:31744
  ds_read_b128 v[216:219], v2 offset:32768
  ds_read_b128 v[220:223], v2 offset:33792
  ds_read_b128 v[224:227], v2 offset:34816
  ds_read_b128 v[228:231], v2 offset:35840
  ds_read_b128 v[232:235], v2 offset:36864
  ds_read_b128 v[236:239], v2 offset:37888
  ds_read_b128 v[240:243], v2 offset:38912
  ds_read_b128 v[244:247], v2 offset:39936
  s_waitcnt lgkmcnt(6)
  v_mfma_f32_16x16x32_bf16 v[192:195], v[248:251], v[156:159], 0
  ds_read_b128 v[248:251], v2 offset:40960
  v_cvt_pk_bf16_f32 v163, v102, v103
  s_nop 1
  v_mfma_f32_16x16x32_bf16 v[192:195], v[252:255], v[160:163], v[192:195]
  ds_read_b128 v[252:255], v2 offset:41984
  v_cvt_pk_bf16_f32 v164, v104, v105
  v_cvt_pk_bf16_f32 v165, v106, v107
  v_cvt_pk_bf16_f32 v166, v108, v109
  v_cvt_pk_bf16_f32 v167, v110, v111
  s_nop 1
  v_mfma_f32_16x16x32_bf16 v[192:195], v[216:219], v[164:167], v[192:195]
  ds_read_b128 v[216:219], v2 offset:43008
  v_cvt_pk_bf16_f32 v24, v112, v113
  v_cvt_pk_bf16_f32 v25, v114, v115
  v_cvt_pk_bf16_f32 v26, v116, v117
  v_cvt_pk_bf16_f32 v27, v118, v119
  s_nop 1
  v_mfma_f32_16x16x32_bf16 v[192:195], v[220:223], v[24:27], v[192:195]
  ds_read_b128 v[220:223], v2 offset:44032
  v_cvt_pk_bf16_f32 v28, v120, v121
  v_cvt_pk_bf16_f32 v29, v122, v123
  v_cvt_pk_bf16_f32 v30, v124, v125
  v_cvt_pk_bf16_f32 v31, v126, v127
  s_waitcnt lgkmcnt(6)
  s_nop 0
  v_mfma_f32_16x16x32_bf16 v[192:195], v[224:227], v[28:31], v[192:195]
  ds_read_b128 v[224:227], v2 offset:45056
  v_cvt_pk_bf16_f32 v32, v128, v129
  v_cvt_pk_bf16_f32 v33, v130, v131
  v_cvt_pk_bf16_f32 v34, v132, v133
  v_cvt_pk_bf16_f32 v35, v134, v135
  s_nop 1
  v_mfma_f32_16x16x32_bf16 v[192:195], v[228:231], v[32:35], v[192:195]
  ds_read_b128 v[228:231], v2 offset:46080
  v_mfma_f32_16x16x32_bf16 v[196:199], v[232:235], v[156:159], 0
  ds_read_b128 v[232:235], v2 offset:47104
  v_mfma_f32_16x16x32_bf16 v[196:199], v[236:239], v[160:163], v[196:199]
  ds_read_b128 v[236:239], v2 offset:48128
  s_waitcnt lgkmcnt(6)
  v_mfma_f32_16x16x32_bf16 v[196:199], v[240:243], v[164:167], v[196:199]
  ds_read_b128 v[240:243], v2 offset:49152
  v_mul_f32 v192, v192, v23
  v_mfma_f32_16x16x32_bf16 v[196:199], v[244:247], v[24:27], v[196:199]
  ds_read_b128 v[244:247], v2 offset:50176
  v_mul_f32 v193, v193, v23
  v_mfma_f32_16x16x32_bf16 v[196:199], v[248:251], v[28:31], v[196:199]
  ds_read_b128 v[248:251], v2 offset:51200
  v_mul_f32 v194, v194, v23
  v_mfma_f32_16x16x32_bf16 v[196:199], v[252:255], v[32:35], v[196:199]
  ds_read_b128 v[252:255], v2 offset:52224
  s_mov_b32 s100, 71680
  buffer_load_dwordx4 v[104:107], v1, s[20:23], s100 offen offset:0 sc1
  buffer_load_dwordx4 v[108:111], v1, s[20:23], s100 offen offset:1024 sc1
  s_waitcnt lgkmcnt(6)
  v_mfma_f32_16x16x32_bf16 v[208:211], v[216:219], v[156:159], 0
  ds_read_b128 v[216:219], v2 offset:53248
  v_mul_f32 v195, v195, v23
  v_mfma_f32_16x16x32_bf16 v[208:211], v[220:223], v[160:163], v[208:211]
  ds_read_b128 v[220:223], v2 offset:54272
  v_cvt_pk_bf16_f32 v92, v192, v193
  v_mfma_f32_16x16x32_bf16 v[208:211], v[224:227], v[164:167], v[208:211]
  ds_read_b128 v[224:227], v2 offset:55296
  v_cvt_pk_bf16_f32 v93, v194, v195
  v_mfma_f32_16x16x32_bf16 v[208:211], v[228:231], v[24:27], v[208:211]
  ds_read_b128 v[228:231], v2 offset:56320
  s_waitcnt lgkmcnt(6)
  v_mfma_f32_16x16x32_bf16 v[208:211], v[232:235], v[28:31], v[208:211]
  ds_read_b128 v[232:235], v2 offset:57344
  v_mul_f32 v196, v196, v23
  v_mfma_f32_16x16x32_bf16 v[208:211], v[236:239], v[32:35], v[208:211]
  ds_read_b128 v[236:239], v2 offset:58368
  v_mul_f32 v197, v197, v23
  v_mfma_f32_16x16x32_bf16 v[212:215], v[240:243], v[156:159], 0
  ds_read_b128 v[240:243], v2 offset:59392
  v_mul_f32 v198, v198, v23
  v_mfma_f32_16x16x32_bf16 v[212:215], v[244:247], v[160:163], v[212:215]
  ds_read_b128 v[244:247], v2 offset:60416
  s_waitcnt lgkmcnt(6)
  v_mfma_f32_16x16x32_bf16 v[212:215], v[248:251], v[164:167], v[212:215]
  ds_read_b128 v[248:251], v1 offset:0
  v_mul_f32 v199, v199, v23
  v_mfma_f32_16x16x32_bf16 v[212:215], v[252:255], v[24:27], v[212:215]
  ds_read_b128 v[252:255], v1 offset:1024
  v_cvt_pk_bf16_f32 v94, v196, v197
  v_mfma_f32_16x16x32_bf16 v[212:215], v[216:219], v[28:31], v[212:215]
  ds_read_b128 v[216:219], v1 offset:2048
  v_cvt_pk_bf16_f32 v95, v198, v199
  v_mfma_f32_16x16x32_bf16 v[212:215], v[220:223], v[32:35], v[212:215]
  buffer_store_dwordx4 v[92:95], v6, s[16:19], 0 offen offset:0 nt sc1
  v_mul_f32 v208, v208, v23
  ds_read_b128 v[220:223], v1 offset:3072
  s_waitcnt lgkmcnt(6)
  v_mfma_f32_16x16x32_bf16 v[192:195], v[224:227], v[156:159], 0
  ds_read_b128 v[224:227], v1 offset:4096
  v_mul_f32 v209, v209, v23
  v_mfma_f32_16x16x32_bf16 v[192:195], v[228:231], v[160:163], v[192:195]
  ds_read_b128 v[228:231], v1 offset:5120
  v_mul_f32 v210, v210, v23
  v_mfma_f32_16x16x32_bf16 v[192:195], v[232:235], v[164:167], v[192:195]
  ds_read_b128 v[232:235], v1 offset:6144
  v_mul_f32 v211, v211, v23
  v_mfma_f32_16x16x32_bf16 v[192:195], v[236:239], v[24:27], v[192:195]
  ds_read_b128 v[236:239], v1 offset:7168
  s_waitcnt lgkmcnt(6)
  v_mfma_f32_16x16x32_bf16 v[192:195], v[240:243], v[28:31], v[192:195]
  ds_read_b128 v[240:243], v1 offset:8192
  v_cvt_pk_bf16_f32 v100, v208, v209
  v_mfma_f32_16x16x32_bf16 v[192:195], v[244:247], v[32:35], v[192:195]
  ds_read_b128 v[244:247], v1 offset:9216
  v_cvt_pk_bf16_f32 v101, v210, v211
  v_mfma_f32_16x16x32_bf16 v[196:199], v[248:251], v[156:159], 0
  ds_read_b128 v[248:251], v2 offset:0
  v_mul_f32 v212, v212, v23
  v_mfma_f32_16x16x32_bf16 v[196:199], v[252:255], v[160:163], v[196:199]
  ds_read_b128 v[252:255], v2 offset:1024
  s_waitcnt lgkmcnt(6)
  v_mfma_f32_16x16x32_bf16 v[196:199], v[216:219], v[164:167], v[196:199]
  ds_read_b128 v[216:219], v2 offset:2048
  v_mul_f32 v213, v213, v23
  v_mfma_f32_16x16x32_bf16 v[196:199], v[220:223], v[24:27], v[196:199]
  ds_read_b128 v[220:223], v2 offset:3072
  v_mul_f32 v214, v214, v23
  v_mfma_f32_16x16x32_bf16 v[196:199], v[224:227], v[28:31], v[196:199]
  ds_read_b128 v[224:227], v2 offset:4096
  v_mul_f32 v215, v215, v23
  v_mfma_f32_16x16x32_bf16 v[196:199], v[228:231], v[32:35], v[196:199]
  ds_read_b128 v[228:231], v2 offset:5120
  v_cvt_pk_bf16_f32 v102, v212, v213
  v_cvt_pk_bf16_f32 v103, v214, v215
  buffer_store_dwordx4 v[100:103], v6, s[16:19], 0 offen offset:64 nt sc1
  s_waitcnt lgkmcnt(6)
  v_mfma_f32_16x16x32_bf16 v[208:211], v[232:235], v[156:159], 0
  ds_read_b128 v[232:235], v2 offset:6144
  v_mul_f32 v192, v192, v23
  v_mfma_f32_16x16x32_bf16 v[208:211], v[236:239], v[160:163], v[208:211]
  ds_read_b128 v[236:239], v2 offset:7168
  v_mul_f32 v193, v193, v23
  v_mfma_f32_16x16x32_bf16 v[208:211], v[240:243], v[164:167], v[208:211]
  ds_read_b128 v[240:243], v2 offset:8192
  v_mul_f32 v194, v194, v23
  v_mfma_f32_16x16x32_bf16 v[208:211], v[244:247], v[24:27], v[208:211]
  ds_read_b128 v[244:247], v2 offset:9216
  s_waitcnt lgkmcnt(6)
  v_mfma_f32_16x16x32_bf16 v[208:211], v[248:251], v[28:31], v[208:211]
  ds_read_b128 v[248:251], v2 offset:10240
  v_mul_f32 v195, v195, v23
  v_mfma_f32_16x16x32_bf16 v[208:211], v[252:255], v[32:35], v[208:211]
  ds_read_b128 v[252:255], v2 offset:11264
  v_cvt_pk_bf16_f32 v92, v192, v193
  v_mfma_f32_16x16x32_bf16 v[212:215], v[216:219], v[156:159], 0
  ds_read_b128 v[216:219], v2 offset:12288
  v_cvt_pk_bf16_f32 v93, v194, v195
  v_mfma_f32_16x16x32_bf16 v[212:215], v[220:223], v[160:163], v[212:215]
  ds_read_b128 v[220:223], v2 offset:13312
  s_waitcnt lgkmcnt(6)
  v_mfma_f32_16x16x32_bf16 v[212:215], v[224:227], v[164:167], v[212:215]
  ds_read_b128 v[224:227], v2 offset:14336
  v_mul_f32 v196, v196, v23
  v_mfma_f32_16x16x32_bf16 v[212:215], v[228:231], v[24:27], v[212:215]
  ds_read_b128 v[228:231], v2 offset:15360
  v_mul_f32 v197, v197, v23
  v_mfma_f32_16x16x32_bf16 v[212:215], v[232:235], v[28:31], v[212:215]
  ds_read_b128 v[232:235], v2 offset:16384
  v_mul_f32 v198, v198, v23
  v_mfma_f32_16x16x32_bf16 v[212:215], v[236:239], v[32:35], v[212:215]
  ds_read_b128 v[236:239], v2 offset:17408
  v_mul_f32 v199, v199, v23
  v_cvt_pk_bf16_f32 v94, v196, v197
  v_cvt_pk_bf16_f32 v95, v198, v199
  buffer_store_dwordx4 v[92:95], v6, s[16:19], 0 offen offset:128 nt sc1
  s_waitcnt lgkmcnt(6)
  v_mfma_f32_16x16x32_bf16 v[192:195], v[240:243], v[156:159], 0
  ds_read_b128 v[240:243], v2 offset:18432
  v_mul_f32 v208, v208, v23
  v_mfma_f32_16x16x32_bf16 v[192:195], v[244:247], v[160:163], v[192:195]
  ds_read_b128 v[244:247], v2 offset:19456
  v_mul_f32 v209, v209, v23
  v_mfma_f32_16x16x32_bf16 v[192:195], v[248:251], v[164:167], v[192:195]
  ds_read_b128 v[248:251], v2 offset:20480
  v_mul_f32 v210, v210, v23
  v_mfma_f32_16x16x32_bf16 v[192:195], v[252:255], v[24:27], v[192:195]
  ds_read_b128 v[252:255], v2 offset:21504
  s_waitcnt lgkmcnt(6)
  v_mfma_f32_16x16x32_bf16 v[192:195], v[216:219], v[28:31], v[192:195]
  ds_read_b128 v[216:219], v2 offset:22528
  v_mul_f32 v211, v211, v23
  v_mfma_f32_16x16x32_bf16 v[192:195], v[220:223], v[32:35], v[192:195]
  ds_read_b128 v[220:223], v2 offset:23552
  v_cvt_pk_bf16_f32 v100, v208, v209
  v_mfma_f32_16x16x32_bf16 v[196:199], v[224:227], v[156:159], 0
  ds_read_b128 v[224:227], v2 offset:24576
  v_cvt_pk_bf16_f32 v101, v210, v211
  v_mfma_f32_16x16x32_bf16 v[196:199], v[228:231], v[160:163], v[196:199]
  ds_read_b128 v[228:231], v2 offset:25600
  s_waitcnt lgkmcnt(6)
  v_mfma_f32_16x16x32_bf16 v[196:199], v[232:235], v[164:167], v[196:199]
  ds_read_b128 v[232:235], v2 offset:26624
  v_mul_f32 v212, v212, v23
  v_mfma_f32_16x16x32_bf16 v[196:199], v[236:239], v[24:27], v[196:199]
  ds_read_b128 v[236:239], v2 offset:27648
  v_mul_f32 v213, v213, v23
  v_mfma_f32_16x16x32_bf16 v[196:199], v[240:243], v[28:31], v[196:199]
  ds_read_b128 v[240:243], v2 offset:28672
  v_mul_f32 v214, v214, v23
  v_mfma_f32_16x16x32_bf16 v[196:199], v[244:247], v[32:35], v[196:199]
  ds_read_b128 v[244:247], v2 offset:29696
  v_mul_f32 v215, v215, v23
  v_cvt_pk_bf16_f32 v102, v212, v213
  v_cvt_pk_bf16_f32 v103, v214, v215
  buffer_store_dwordx4 v[100:103], v6, s[16:19], 0 offen offset:192 nt sc1
  s_waitcnt vmcnt(4)
  s_waitcnt lgkmcnt(6)
  v_mfma_f32_16x16x32_bf16 v[208:211], v[248:251], v[156:159], 0
  v_mul_f32 v192, v192, v23
  v_mul_f32 v193, v193, v23
  v_mfma_f32_16x16x32_bf16 v[208:211], v[252:255], v[160:163], v[208:211]
  v_mul_f32 v194, v194, v23
  v_mul_f32 v195, v195, v23
  v_mfma_f32_16x16x32_bf16 v[208:211], v[216:219], v[164:167], v[208:211]
  v_cvt_pk_bf16_f32 v92, v192, v193
  v_cvt_pk_bf16_f32 v93, v194, v195
  v_mfma_f32_16x16x32_bf16 v[208:211], v[220:223], v[24:27], v[208:211]
  v_mul_f32 v196, v196, v23
  s_waitcnt lgkmcnt(4)
  v_mfma_f32_16x16x32_bf16 v[208:211], v[224:227], v[28:31], v[208:211]
  v_mul_f32 v197, v197, v23
  v_mul_f32 v198, v198, v23
  v_mfma_f32_16x16x32_bf16 v[208:211], v[228:231], v[32:35], v[208:211]
  v_mul_f32 v199, v199, v23
  s_waitcnt lgkmcnt(3)
  v_mfma_f32_16x16x32_bf16 v[212:215], v[232:235], v[156:159], 0
  v_cvt_pk_bf16_f32 v94, v196, v197
  s_waitcnt lgkmcnt(2)
  v_mfma_f32_16x16x32_bf16 v[212:215], v[236:239], v[160:163], v[212:215]
  v_cvt_pk_bf16_f32 v95, v198, v199
  s_waitcnt lgkmcnt(1)
  v_mfma_f32_16x16x32_bf16 v[212:215], v[240:243], v[164:167], v[212:215]
  v_mul_f32 v208, v208, v23
  s_waitcnt lgkmcnt(0)
  v_mfma_f32_16x16x32_bf16 v[212:215], v[244:247], v[24:27], v[212:215]
  v_mul_f32 v209, v209, v23
  v_mfma_f32_16x16x32_bf16 v[212:215], v[104:107], v[28:31], v[212:215]
  v_mul_f32 v210, v210, v23
  v_mfma_f32_16x16x32_bf16 v[212:215], v[108:111], v[32:35], v[212:215]
  v_mul_f32 v211, v211, v23
  v_cvt_pk_bf16_f32 v100, v208, v209
  buffer_store_dwordx4 v[92:95], v6, s[16:19], 0 offen offset:256 nt sc1
  v_cvt_pk_bf16_f32 v101, v210, v211
  s_nop 3
  v_mul_f32 v212, v212, v23
  v_mul_f32 v213, v213, v23
  v_mul_f32 v214, v214, v23
  v_mul_f32 v215, v215, v23
  v_cvt_pk_bf16_f32 v102, v212, v213
  v_cvt_pk_bf16_f32 v103, v214, v215
  buffer_store_dwordx4 v[100:103], v6, s[16:19], 0 offen offset:320 nt sc1
  s_endpgm
FB0:
  s_nop 7
  v_max3_f32 v22, v24, v25, v26
  v_max3_f32 v22, v22, v27, v28
  v_max3_f32 v22, v22, v29, v30
  v_max3_f32 v22, v22, v31, v32
  v_max3_f32 v22, v22, v33, v34
  v_max3_f32 v22, v22, v35, v36
  v_max3_f32 v22, v22, v37, v38
  v_max3_f32 v22, v22, v39, v40
  v_max3_f32 v22, v22, v41, v42
  v_max3_f32 v22, v22, v43, v44
  v_max3_f32 v22, v22, v45, v46
  v_max3_f32 v22, v22, v47, v48
  v_max3_f32 v22, v22, v49, v50
  v_max3_f32 v22, v22, v51, v52
  v_max3_f32 v22, v22, v53, v54
  s_mov_b32 s52, 0xff7fffff
  v_max3_f32 v22, v22, v55, s52
  v_mov_b32 v23, v22
  s_nop 1
  v_permlane32_swap_b32 v22, v23
  s_nop 1
  v_max_f32 v22, v22, v23
  v_mov_b32 v23, v22
  s_nop 1
  v_permlane16_swap_b32 v22, v23
  s_nop 1
  v_max_f32 v22, v22, v23
  v_sub_f32 v24, v24, v22
  v_sub_f32 v25, v25, v22
  v_sub_f32 v26, v26, v22
  v_sub_f32 v27, v27, v22
  v_sub_f32 v28, v28, v22
  v_sub_f32 v29, v29, v22
  v_sub_f32 v30, v30, v22
  v_sub_f32 v31, v31, v22
  v_sub_f32 v32, v32, v22
  v_sub_f32 v33, v33, v22
  v_sub_f32 v34, v34, v22
  v_sub_f32 v35, v35, v22
  v_sub_f32 v36, v36, v22
  v_sub_f32 v37, v37, v22
  v_sub_f32 v38, v38, v22
  v_sub_f32 v39, v39, v22
  v_sub_f32 v40, v40, v22
  v_sub_f32 v41, v41, v22
  v_sub_f32 v42, v42, v22
  v_sub_f32 v43, v43, v22
  v_sub_f32 v44, v44, v22
  v_sub_f32 v45, v45, v22
  v_sub_f32 v46, v46, v22
  v_sub_f32 v47, v47, v22
  v_sub_f32 v48, v48, v22
  v_sub_f32 v49, v49, v22
  v_sub_f32 v50, v50, v22
  v_sub_f32 v51, v51, v22
  v_sub_f32 v52, v52, v22
  v_sub_f32 v53, v53, v22
  v_sub_f32 v54, v54, v22
  v_sub_f32 v55, v55, v22
  v_exp_f32 v24, v24
  v_exp_f32 v25, v25
  v_exp_f32 v26, v26
  v_exp_f32 v27, v27
  v_exp_f32 v28, v28
  v_exp_f32 v29, v29
  v_exp_f32 v30, v30
  v_exp_f32 v31, v31
  v_exp_f32 v32, v32
  v_exp_f32 v33, v33
  v_exp_f32 v34, v34
  v_exp_f32 v35, v35
  v_exp_f32 v36, v36
  v_exp_f32 v37, v37
  v_exp_f32 v38, v38
  v_exp_f32 v39, v39
  v_exp_f32 v40, v40
  v_exp_f32 v41, v41
  v_exp_f32 v42, v42
  v_exp_f32 v43, v43
  v_exp_f32 v44, v44
  v_exp_f32 v45, v45
  v_exp_f32 v46, v46
  v_exp_f32 v47, v47
  v_exp_f32 v48, v48
  v_exp_f32 v49, v49
  v_exp_f32 v50, v50
  v_exp_f32 v51, v51
  v_exp_f32 v52, v52
  v_exp_f32 v53, v53
  v_exp_f32 v54, v54
  v_exp_f32 v55, v55
  s_nop 0
  v_cvt_pk_bf16_f32 v136, v24, v25
  v_cvt_pk_bf16_f32 v137, v26, v27
  v_cvt_pk_bf16_f32 v138, v28, v29
  v_cvt_pk_bf16_f32 v139, v30, v31
  v_cvt_pk_bf16_f32 v140, v32, v33
  v_cvt_pk_bf16_f32 v141, v34, v35
  v_cvt_pk_bf16_f32 v142, v36, v37
  v_cvt_pk_bf16_f32 v143, v38, v39
  v_cvt_pk_bf16_f32 v144, v40, v41
  v_cvt_pk_bf16_f32 v145, v42, v43
  v_cvt_pk_bf16_f32 v146, v44, v45
  v_cvt_pk_bf16_f32 v147, v46, v47
  v_cvt_pk_bf16_f32 v148, v48, v49
  v_cvt_pk_bf16_f32 v149, v50, v51
  v_cvt_pk_bf16_f32 v150, v52, v53
  v_cvt_pk_bf16_f32 v151, v54, v55
  s_nop 1
  v_mfma_f32_16x16x32_bf16 v[184:187], v[192:195], v[136:139], 0
  v_mfma_f32_16x16x32_bf16 v[184:187], v[192:195], v[140:143], v[184:187]
  v_mfma_f32_16x16x32_bf16 v[184:187], v[192:195], v[144:147], v[184:187]
  v_mfma_f32_16x16x32_bf16 v[184:187], v[192:195], v[148:151], v[184:187]
  s_waitcnt lgkmcnt(0)
  ds_read_b64_tr_b16 v[24:25], v9 offset:38400
  ds_read_b64_tr_b16 v[26:27], v9 offset:46080
  ds_read_b64_tr_b16 v[28:29], v10 offset:38400
  ds_read_b64_tr_b16 v[30:31], v10 offset:46080
  ds_read_b64_tr_b16 v[32:33], v11 offset:38400
  ds_read_b64_tr_b16 v[34:35], v11 offset:46080
  ds_read_b64_tr_b16 v[36:37], v12 offset:38400
  ds_read_b64_tr_b16 v[38:39], v12 offset:46080
  ds_read_b64_tr_b16 v[40:41], v9 offset:38528
  ds_read_b64_tr_b16 v[42:43], v9 offset:46208
  ds_read_b64_tr_b16 v[44:45], v10 offset:38528
  ds_read_b64_tr_b16 v[46:47], v10 offset:46208
  s_waitcnt lgkmcnt(0)
  v_mfma_f32_16x16x32_bf16 v[56:59], v[24:27], v[148:151], 0
  v_mfma_f32_16x16x32_bf16 v[60:63], v[28:31], v[148:151], 0
  v_mfma_f32_16x16x32_bf16 v[64:67], v[32:35], v[148:151], 0
  v_mfma_f32_16x16x32_bf16 v[68:71], v[36:39], v[148:151], 0
  v_mfma_f32_16x16x32_bf16 v[72:75], v[40:43], v[148:151], 0
  v_mfma_f32_16x16x32_bf16 v[76:79], v[44:47], v[148:151], 0
  s_waitcnt lgkmcnt(0)
  ds_read_b64_tr_b16 v[24:25], v11 offset:38528
  ds_read_b64_tr_b16 v[26:27], v11 offset:46208
  ds_read_b64_tr_b16 v[28:29], v12 offset:38528
  ds_read_b64_tr_b16 v[30:31], v12 offset:46208
  ds_read_b64_tr_b16 v[32:33], v9 offset:38656
  ds_read_b64_tr_b16 v[34:35], v9 offset:46336
  ds_read_b64_tr_b16 v[36:37], v10 offset:38656
  ds_read_b64_tr_b16 v[38:39], v10 offset:46336
  ds_read_b64_tr_b16 v[40:41], v11 offset:38656
  ds_read_b64_tr_b16 v[42:43], v11 offset:46336
  ds_read_b64_tr_b16 v[44:45], v12 offset:38656
  ds_read_b64_tr_b16 v[46:47], v12 offset:46336
  s_waitcnt lgkmcnt(0)
  v_mfma_f32_16x16x32_bf16 v[80:83], v[24:27], v[148:151], 0
  v_mfma_f32_16x16x32_bf16 v[84:87], v[28:31], v[148:151], 0
  v_mfma_f32_16x16x32_bf16 v[168:171], v[32:35], v[148:151], 0
  v_mfma_f32_16x16x32_bf16 v[172:175], v[36:39], v[148:151], 0
  v_mfma_f32_16x16x32_bf16 v[176:179], v[40:43], v[148:151], 0
  v_mfma_f32_16x16x32_bf16 v[180:183], v[44:47], v[148:151], 0
  s_nop 7
  s_branch FBR0
FB1:
  s_nop 7
  v_max3_f32 v22, v56, v57, v58
  v_max3_f32 v22, v22, v59, v60
  v_max3_f32 v22, v22, v61, v62
  v_max3_f32 v22, v22, v63, v64
  v_max3_f32 v22, v22, v65, v66
  v_max3_f32 v22, v22, v67, v68
  v_max3_f32 v22, v22, v69, v70
  v_max3_f32 v22, v22, v71, v72
  v_max3_f32 v22, v22, v73, v74
  v_max3_f32 v22, v22, v75, v76
  v_max3_f32 v22, v22, v77, v78
  v_max3_f32 v22, v22, v79, v80
  v_max3_f32 v22, v22, v81, v82
  v_max3_f32 v22, v22, v83, v84
  v_max3_f32 v22, v22, v85, v86
  s_mov_b32 s52, 0xff7fffff
  v_max3_f32 v22, v22, v87, s52
  v_mov_b32 v23, v22
  s_nop 1
  v_permlane32_swap_b32 v22, v23
  s_nop 1
  v_max_f32 v22, v22, v23
  v_mov_b32 v23, v22
  s_nop 1
  v_permlane16_swap_b32 v22, v23
  s_nop 1
  v_max_f32 v22, v22, v23
  v_sub_f32 v56, v56, v22
  v_sub_f32 v57, v57, v22
  v_sub_f32 v58, v58, v22
  v_sub_f32 v59, v59, v22
  v_sub_f32 v60, v60, v22
  v_sub_f32 v61, v61, v22
  v_sub_f32 v62, v62, v22
  v_sub_f32 v63, v63, v22
  v_sub_f32 v64, v64, v22
  v_sub_f32 v65, v65, v22
  v_sub_f32 v66, v66, v22
  v_sub_f32 v67, v67, v22
  v_sub_f32 v68, v68, v22
  v_sub_f32 v69, v69, v22
  v_sub_f32 v70, v70, v22
  v_sub_f32 v71, v71, v22
  v_sub_f32 v72, v72, v22
  v_sub_f32 v73, v73, v22
  v_sub_f32 v74, v74, v22
  v_sub_f32 v75, v75, v22
  v_sub_f32 v76, v76, v22
  v_sub_f32 v77, v77, v22
  v_sub_f32 v78, v78, v22
  v_sub_f32 v79, v79, v22
  v_sub_f32 v80, v80, v22
  v_sub_f32 v81, v81, v22
  v_sub_f32 v82, v82, v22
  v_sub_f32 v83, v83, v22
  v_sub_f32 v84, v84, v22
  v_sub_f32 v85, v85, v22
  v_sub_f32 v86, v86, v22
  v_sub_f32 v87, v87, v22
  v_exp_f32 v56, v56
  v_exp_f32 v57, v57
  v_exp_f32 v58, v58
  v_exp_f32 v59, v59
  v_exp_f32 v60, v60
  v_exp_f32 v61, v61
  v_exp_f32 v62, v62
  v_exp_f32 v63, v63
  v_exp_f32 v64, v64
  v_exp_f32 v65, v65
  v_exp_f32 v66, v66
  v_exp_f32 v67, v67
  v_exp_f32 v68, v68
  v_exp_f32 v69, v69
  v_exp_f32 v70, v70
  v_exp_f32 v71, v71
  v_exp_f32 v72, v72
  v_exp_f32 v73, v73
  v_exp_f32 v74, v74
  v_exp_f32 v75, v75
  v_exp_f32 v76, v76
  v_exp_f32 v77, v77
  v_exp_f32 v78, v78
  v_exp_f32 v79, v79
  v_exp_f32 v80, v80
  v_exp_f32 v81, v81
  v_exp_f32 v82, v82
  v_exp_f32 v83, v83
  v_exp_f32 v84, v84
  v_exp_f32 v85, v85
  v_exp_f32 v86, v86
  v_exp_f32 v87, v87
  s_nop 0
  v_cvt_pk_bf16_f32 v152, v56, v57
  v_cvt_pk_bf16_f32 v153, v58, v59
  v_cvt_pk_bf16_f32 v154, v60, v61
  v_cvt_pk_bf16_f32 v155, v62, v63
  v_cvt_pk_bf16_f32 v156, v64, v65
  v_cvt_pk_bf16_f32 v157, v66, v67
  v_cvt_pk_bf16_f32 v158, v68, v69
  v_cvt_pk_bf16_f32 v159, v70, v71
  v_cvt_pk_bf16_f32 v160, v72, v73
  v_cvt_pk_bf16_f32 v161, v74, v75
  v_cvt_pk_bf16_f32 v162, v76, v77
  v_cvt_pk_bf16_f32 v163, v78, v79
  v_cvt_pk_bf16_f32 v164, v80, v81
  v_cvt_pk_bf16_f32 v165, v82, v83
  v_cvt_pk_bf16_f32 v166, v84, v85
  v_cvt_pk_bf16_f32 v167, v86, v87
  s_nop 1
  v_mfma_f32_16x16x32_bf16 v[188:191], v[192:195], v[152:155], 0
  v_mfma_f32_16x16x32_bf16 v[188:191], v[192:195], v[156:159], v[188:191]
  v_mfma_f32_16x16x32_bf16 v[188:191], v[192:195], v[160:163], v[188:191]
  v_mfma_f32_16x16x32_bf16 v[188:191], v[192:195], v[164:167], v[188:191]
  s_nop 7
  s_branch FBR1
FB1s:
  s_nop 7
  v_max3_f32 v22, v56, v57, v58
  v_max3_f32 v22, v22, v59, v60
  v_max3_f32 v22, v22, v61, v62
  v_max3_f32 v22, v22, v63, v64
  v_max3_f32 v22, v22, v65, v66
  v_max3_f32 v22, v22, v67, v68
  v_max3_f32 v22, v22, v69, v70
  v_max3_f32 v22, v22, v71, v72
  v_max3_f32 v22, v22, v73, v74
  v_max3_f32 v22, v22, v75, v76
  v_max3_f32 v22, v22, v77, v78
  v_max3_f32 v22, v22, v79, v80
  v_max3_f32 v22, v22, v81, v82
  v_max3_f32 v22, v22, v83, v84
  v_max3_f32 v22, v22, v85, v86
  s_mov_b32 s52, 0xff7fffff
  v_max3_f32 v22, v22, v87, s52
  v_mov_b32 v23, v22
  s_nop 1
  v_permlane32_swap_b32 v22, v23
  s_nop 1
  v_max_f32 v22, v22, v23
  v_mov_b32 v23, v22
  s_nop 1
  v_permlane16_swap_b32 v22, v23
  s_nop 1
  v_max_f32 v22, v22, v23
  v_sub_f32 v56, v56, v22
  v_sub_f32 v57, v57, v22
  v_sub_f32 v58, v58, v22
  v_sub_f32 v59, v59, v22
  v_sub_f32 v60, v60, v22
  v_sub_f32 v61, v61, v22
  v_sub_f32 v62, v62, v22
  v_sub_f32 v63, v63, v22
  v_sub_f32 v64, v64, v22
  v_sub_f32 v65, v65, v22
  v_sub_f32 v66, v66, v22
  v_sub_f32 v67, v67, v22
  v_sub_f32 v68, v68, v22
  v_sub_f32 v69, v69, v22
  v_sub_f32 v70, v70, v22
  v_sub_f32 v71, v71, v22
  v_sub_f32 v72, v72, v22
  v_sub_f32 v73, v73, v22
  v_sub_f32 v74, v74, v22
  v_sub_f32 v75, v75, v22
  v_sub_f32 v76, v76, v22
  v_sub_f32 v77, v77, v22
  v_sub_f32 v78, v78, v22
  v_sub_f32 v79, v79, v22
  v_sub_f32 v80, v80, v22
  v_sub_f32 v81, v81, v22
  v_sub_f32 v82, v82, v22
  v_sub_f32 v83, v83, v22
  v_sub_f32 v84, v84, v22
  v_sub_f32 v85, v85, v22
  v_sub_f32 v86, v86, v22
  v_sub_f32 v87, v87, v22
  v_exp_f32 v56, v56
  v_exp_f32 v57, v57
  v_exp_f32 v58, v58
  v_exp_f32 v59, v59
  v_exp_f32 v60, v60
  v_exp_f32 v61, v61
  v_exp_f32 v62, v62
  v_exp_f32 v63, v63
  v_exp_f32 v64, v64
  v_exp_f32 v65, v65
  v_exp_f32 v66, v66
  v_exp_f32 v67, v67
  v_exp_f32 v68, v68
  v_exp_f32 v69, v69
  v_exp_f32 v70, v70
  v_exp_f32 v71, v71
  v_exp_f32 v72, v72
  v_exp_f32 v73, v73
  v_exp_f32 v74, v74
  v_exp_f32 v75, v75
  v_exp_f32 v76, v76
  v_exp_f32 v77, v77
  v_exp_f32 v78, v78
  v_exp_f32 v79, v79
  v_exp_f32 v80, v80
  v_exp_f32 v81, v81
  v_exp_f32 v82, v82
  v_exp_f32 v83, v83
  v_exp_f32 v84, v84
  v_exp_f32 v85, v85
  v_exp_f32 v86, v86
  v_exp_f32 v87, v87
  s_nop 0
  v_cvt_pk_bf16_f32 v152, v56, v57
  v_cvt_pk_bf16_f32 v153, v58, v59
  v_cvt_pk_bf16_f32 v154, v60, v61
  v_cvt_pk_bf16_f32 v155, v62, v63
  v_cvt_pk_bf16_f32 v156, v64, v65
  v_cvt_pk_bf16_f32 v157, v66, v67
  v_cvt_pk_bf16_f32 v158, v68, v69
  v_cvt_pk_bf16_f32 v159, v70, v71
  v_cvt_pk_bf16_f32 v160, v72, v73
  v_cvt_pk_bf16_f32 v161, v74, v75
  v_cvt_pk_bf16_f32 v162, v76, v77
  v_cvt_pk_bf16_f32 v163, v78, v79
  v_cvt_pk_bf16_f32 v164, v80, v81
  v_cvt_pk_bf16_f32 v165, v82, v83
  v_cvt_pk_bf16_f32 v166, v84, v85
  v_cvt_pk_bf16_f32 v167, v86, v87
  s_nop 1
  v_mfma_f32_16x16x32_bf16 v[188:191], v[192:195], v[152:155], 0
  v_mfma_f32_16x16x32_bf16 v[188:191], v[192:195], v[156:159], v[188:191]
  v_mfma_f32_16x16x32_bf16 v[188:191], v[192:195], v[160:163], v[188:191]
  v_mfma_f32_16x16x32_bf16 v[188:191], v[192:195], v[164:167], v[188:191]
  s_nop 7
  s_branch FBR1s
MK_end:
.section .rodata,"a"
.p2align 6
.amdhsa_kernel standalone__neighborhood_nat__vision_kernel
  .amdhsa_next_free_vgpr 256
  .amdhsa_next_free_sgpr 102
  .amdhsa_accum_offset 256
  .amdhsa_group_segment_fixed_size 0
  .amdhsa_kernarg_size 48
  .amdhsa_user_sgpr_count 2
  .amdhsa_user_sgpr_kernarg_segment_ptr 1
  .amdhsa_system_sgpr_workgroup_id_x 1
.end_amdhsa_kernel
```

```asm
; @launch grid=(256,1,1) block=(512,1,1) lds=163840
.amdgcn_target "amdgcn-amd-amdhsa--gfx950"
.text
.globl standalone__neighborhood_nat__vision_kernel
.p2align 8
.type standalone__neighborhood_nat__vision_kernel,@function
standalone__neighborhood_nat__vision_kernel:
  s_cmp_ge_u32 s2, 256
  s_cbranch_scc1 MK_done
  s_load_dwordx8 s[4:11], s[0:1], 0
  s_load_dwordx4 s[84:87], s[0:1], 32
  s_getpc_b64 s[12:13]
MK_pc:
  s_and_b32 s13, s13, 0xffff
  s_mov_b32 s14, MK_end-MK_pc
  s_mov_b32 s15, 0x00020000
  v_lshlrev_b32 v23, 12, v0
  s_bfe_u32 s3, s2, 327683
  s_lshl_b32 s3, s3, 7
  buffer_load_dword v255, v23, s[12:15], s3 offen
  v_lshrrev_b32 v130, 6, v0
  v_and_b32 v0, 63, v0
  v_readfirstlane_b32 s24, v130
  v_and_b32 v128, 15, v0
  v_lshrrev_b32 v129, 4, v0
  v_lshrrev_b32 v130, 5, v0
  v_bfe_u32 v131, v0, 3, 2
  v_lshl_add_u32 v130, v130, 3, v131
  v_mul_u32_u24 v130, 1152, v130
  s_and_b32 s26, s24, 1
  s_lshl_b32 s46, s26, 2
  v_add_u32 v131, s46, v129
  v_and_b32 v132, 7, v0
  v_xor_b32 v131, v131, v132
  v_lshl_add_u32 v96, v131, 4, v130
  s_lshr_b32 s46, s24, 2
  s_lshl_b32 s46, s46, 5
  s_lshl_b32 s47, s26, 4
  s_add_u32 s46, s46, s47
  s_and_b32 s47, s24, 2
  s_lshl_b32 s47, s47, 1
  s_add_u32 s46, s46, s47
  s_mul_i32 s92, s46, 1152
  s_lshl_b32 s41, s24, 10
  s_cmp_lt_u32 s24, 4
  s_cselect_b64 vcc, -1, 0
  s_cbranch_vccz SL1
  s_waitcnt lgkmcnt(0)
  s_lshr_b32 s46, s24, 1
  s_cmp_lg_u32 s46, 1
  s_cbranch_scc1 MK_nwpf
  s_cmp_eq_u32 s24, 2
  s_cselect_b32 s46, 54, 18
  s_cselect_b32 s12, s6, s8
  s_cselect_b32 s13, s7, s9
  s_and_b32 s13, s13, 0xffff
  s_lshr_b32 s47, s2, 3
  s_mul_i32 s47, s47, s46
  s_lshl_b32 s100, s47, 7
  s_lshl_b32 s46, s46, 7
  s_add_u32 s14, s100, s46
  s_mov_b32 s15, 0x00020000
  v_lshlrev_b32 v23, 7, v0
  buffer_load_dword v254, v23, s[12:15], s100 offen
MK_nwpf:
  s_mov_b32 s88, s6
  s_and_b32 s89, s7, 0xffff
  s_mov_b32 s90, 221184
  s_mov_b32 s91, 0x00020000
  s_add_i32 m0, s41, 0
  s_add_i32 s100, s92, 0
  buffer_load_dwordx4 v96, s[88:91], s100 offen lds
  s_add_i32 m0, s41, 8192
  s_add_i32 s100, s92, 73728
  buffer_load_dwordx4 v96, s[88:91], s100 offen lds
  s_add_i32 m0, s41, 16384
  s_add_i32 s100, s92, 147456
  buffer_load_dwordx4 v96, s[88:91], s100 offen lds
  s_add_i32 m0, s41, 24576
  s_add_i32 s100, s92, 384
  buffer_load_dwordx4 v96, s[88:91], s100 offen lds
  s_add_i32 m0, s41, 32768
  s_add_i32 s100, s92, 74112
  buffer_load_dwordx4 v96, s[88:91], s100 offen lds
  s_add_i32 m0, s41, 40960
  s_add_i32 s100, s92, 147840
  buffer_load_dwordx4 v96, s[88:91], s100 offen lds
  s_add_i32 m0, s41, 4096
  s_add_i32 s100, s92, 36864
  buffer_load_dwordx4 v96, s[88:91], s100 offen lds
  s_add_i32 m0, s41, 12288
  s_add_i32 s100, s92, 110592
  buffer_load_dwordx4 v96, s[88:91], s100 offen lds
  s_add_i32 m0, s41, 20480
  s_add_i32 s100, s92, 184320
  buffer_load_dwordx4 v96, s[88:91], s100 offen lds
  s_add_i32 m0, s41, 28672
  s_add_i32 s100, s92, 37248
  buffer_load_dwordx4 v96, s[88:91], s100 offen lds
  s_add_i32 m0, s41, 36864
  s_add_i32 s100, s92, 110976
  buffer_load_dwordx4 v96, s[88:91], s100 offen lds
  s_add_i32 m0, s41, 45056
  s_add_i32 s100, s92, 184704
  buffer_load_dwordx4 v96, s[88:91], s100 offen lds
SL1:
  s_bfe_u32 s27, s2, 0x10002
  s_bfe_u32 s28, s2, 0x10001
  s_and_b32 s29, s2, 1
  s_lshl_b32 s29, s29, 2
  s_lshr_b32 s46, s2, 6
  s_add_u32 s29, s29, s46
  s_bfe_u32 s30, s2, 0x30003
  s_mul_i32 s37, s29, 14
  s_add_i32 s37, s37, -6
  s_max_i32 s29, s37, -4
  s_mul_i32 s30, s30, 14
  s_add_i32 s30, s30, -6
  s_lshr_b32 s25, s24, 1
  s_add_u32 s25, s25, 2
  s_and_b32 s25, s25, 3
  s_sub_u32 s56, 0, s27
  s_mul_i32 s57, s27, 224
  s_sub_u32 s58, 0, s28
  s_mul_i32 s59, s28, 224
  v_and_b32 v130, 7, v128
  s_mul_i32 s46, s26, 7
  s_add_i32 s46, s46, s30
  v_cmp_lt_u32 s[48:49], 6, v130
  v_add_u32 v130, s46, v130
  v_max_i32 v19, 0, v130
  v_add3_u32 v130, v130, v19, 6
  v_xor_b32 v130, s58, v130
  v_add_u32 v130, s59, v130
  v_subrev_u32 v19, s30, v19
  v_mul_u32_u24 v130, 384, v130
  v_lshl_add_u32 v130, v129, 4, v130
  s_lshl_b32 s46, s25, 2
  s_add_i32 s46, s46, -2
  s_mov_b32 s47, 86016
  v_lshrrev_b32 v131, 3, v128
  v_add_u32 v131, s46, v131
  v_mov_b32 v132, 0x80000000
  v_cmp_gt_i32 s[42:43], 0, v131
  v_add_u32 v5, s37, v131
  v_max_i32 v21, 0, v5
  v_add3_u32 v5, v5, v21, 6
  s_or_b64 s[42:43], s[42:43], s[48:49]
  v_xor_b32 v5, s56, v5
  v_add_u32 v5, s57, v5
  v_subrev_u32 v21, s29, v21
  v_mad_u32_u24 v5, v5, s47, v130
  v_cndmask_b32 v21, v21, v132, s[42:43]
  v_cndmask_b32 v5, v5, v132, s[42:43]
  v_add_u32 v131, 2, v131
  v_cmp_gt_i32 s[44:45], 0, v131
  v_add_u32 v6, s37, v131
  v_max_i32 v22, 0, v6
  v_add3_u32 v6, v6, v22, 6
  s_or_b64 s[44:45], s[44:45], s[48:49]
  v_xor_b32 v6, s56, v6
  v_add_u32 v6, s57, v6
  v_subrev_u32 v22, s29, v22
  v_mad_u32_u24 v6, v6, s47, v130
  v_cndmask_b32 v22, v22, v132, s[44:45]
  v_cndmask_b32 v6, v6, v132, s[44:45]
  s_waitcnt lgkmcnt(0)
  s_mov_b32 s88, s6
  s_and_b32 s89, s7, 0xffff
  s_mov_b32 s90, 221184
  s_mov_b32 s91, 0x00020000
  s_cmp_lg_u32 s24, 5
  s_cbranch_scc1 MK_ntlb
  s_max_i32 s46, s37, 0
  s_lshl_b32 s46, s46, 1
  s_sub_u32 s47, 184, s46
  s_cmp_eq_u32 s27, 0
  s_cselect_b32 s46, s46, s47
  s_mul_i32 s46, s46, 86016
  s_load_dword s94, s[4:5], s46
  s_load_dword s95, s[10:11], s46
  s_add_u32 s46, s46, 1720256
  s_load_dword s94, s[4:5], s46
  s_load_dword s95, s[10:11], s46
  s_add_u32 s46, s46, 1720256
  s_load_dword s94, s[4:5], s46
  s_load_dword s95, s[10:11], s46
  s_load_dword s94, s[84:85], 128
  s_load_dword s95, s[86:87], 0x20000
MK_ntlb:
  s_mov_b32 s12, s4
  s_and_b32 s13, s5, 0xffff
  s_mov_b32 s14, 19267584
  s_mov_b32 s15, 0x00020000
  s_movk_i32 s54, 112
  s_mov_b32 s16, s10
  s_and_b32 s17, s11, 0xffff
  s_mov_b32 s18, 19267584
  s_mov_b32 s19, 0x00020000
  s_mov_b32 s4, s8
  s_and_b32 s5, s9, 0xffff
  s_mov_b32 s6, 73728
  s_mov_b32 s7, 0x00020000
  s_mov_b32 s8, s84
  s_and_b32 s9, s85, 0xffff
  s_mov_b32 s10, 256
  s_mov_b32 s11, 0x00020000
  s_mov_b32 s20, s86
  s_and_b32 s21, s87, 0xffff
  s_mov_b32 s22, 73728
  s_mov_b32 s23, 0x00020000
  v_lshlrev_b32 v1, 4, v0
  v_add_u32 v2, 36864, v1
  s_and_b32 s40, s24, 3
  s_lshl_b32 s40, s40, 10
  v_bfe_u32 v130, v128, 1, 3
  v_xor_b32 v130, v130, v129
  v_lshlrev_b32 v131, 7, v128
  v_lshl_add_u32 v131, v130, 4, v131
  s_lshr_b32 s46, s24, 2
  s_mul_i32 s47, s46, 12288
  s_add_u32 s47, s47, 0
  v_add_u32 v97, s47, v131
  v_xor_b32 v98, 64, v97
  s_mul_i32 s47, s40, 6
  s_add_u32 s47, s47, 24576
  v_add_u32 v99, s47, v131
  v_xor_b32 v100, 64, v99
  v_mov_b32 v135, 0
  v_mov_b32 v134, 0
  s_lshr_b32 s46, s24, 2
  s_mul_i32 s46, s46, 3072
  s_mul_i32 s47, s40, 18
  s_add_u32 s46, s46, s47
  s_sub_u32 s46, 58368, s46
  v_add_u32 v101, s46, v1
  s_cbranch_vccz SL2
  v_mov_b32 v13, 0
  v_mov_b32 v14, 0
  v_mov_b32 v3, 0
  v_mov_b32 v4, 0
  s_branch SM2
SL2:
  s_lshl_b32 s46, s29, 1
  s_xor_b32 s46, s46, s56
  s_mul_i32 s47, s27, 222
  s_add_i32 s31, s46, s47
  s_mul_i32 s31, s31, 86016
  s_mul_i32 s32, s27, -688128
  s_add_i32 s32, s32, 344064
  s_lshr_b32 s33, s29, 31
  s_lshl_b32 s33, s33, 1
  s_lshl_b32 s38, s40, 2
  s_add_u32 s39, s38, 3072
  s_min_u32 s39, s39, 14336
  s_mul_i32 s48, s27, 172032
  s_sub_u32 s49, 172032, s48
  v_mov_b32 v132, s48
  v_mov_b32 v133, s49
  s_lshr_b32 s46, s38, 4
  s_add_u32 s46, s46, 0
  v_add_u32 v130, s46, v0
  v_mul_u32_u24 v13, 2731, v130
  v_lshrrev_b32 v13, 16, v13
  v_cmp_le_u32 s[52:53], 20, v13
  v_mul_u32_u24 v131, 24, v13
  v_sub_u32 v130, v130, v131
  v_subrev_u32 v131, 20, v13
  v_cndmask_b32 v13, v13, v131, s[52:53]
  v_bfe_u32 v131, v13, 1, 3
  v_xor_b32 v130, v130, v131
  v_cndmask_b32 v131, v132, v133, s[52:53]
  v_lshl_add_u32 v130, v130, 4, v131
  v_add_u32 v13, s30, v13
  v_max_i32 v13, 0, v13
  v_lshlrev_b32 v13, 1, v13
  v_xor_b32 v13, s58, v13
  v_add_u32 v13, s59, v13
  v_mul_u32_u24 v13, 384, v13
  v_add_u32 v13, v13, v130
  s_lshr_b32 s46, s38, 4
  s_add_u32 s46, s46, 64
  v_add_u32 v130, s46, v0
  v_mul_u32_u24 v14, 2731, v130
  v_lshrrev_b32 v14, 16, v14
  v_cmp_le_u32 s[52:53], 20, v14
  v_mul_u32_u24 v131, 24, v14
  v_sub_u32 v130, v130, v131
  v_subrev_u32 v131, 20, v14
  v_cndmask_b32 v14, v14, v131, s[52:53]
  v_bfe_u32 v131, v14, 1, 3
  v_xor_b32 v130, v130, v131
  v_cndmask_b32 v131, v132, v133, s[52:53]
  v_lshl_add_u32 v130, v130, 4, v131
  v_add_u32 v14, s30, v14
  v_max_i32 v14, 0, v14
  v_lshlrev_b32 v14, 1, v14
  v_xor_b32 v14, s58, v14
  v_add_u32 v14, s59, v14
  v_mul_u32_u24 v14, 384, v14
  v_add_u32 v14, v14, v130
  s_lshr_b32 s46, s38, 4
  s_add_u32 s46, s46, 128
  v_add_u32 v130, s46, v0
  v_mul_u32_u24 v3, 2731, v130
  v_lshrrev_b32 v3, 16, v3
  v_cmp_le_u32 s[52:53], 20, v3
  v_mul_u32_u24 v131, 24, v3
  v_sub_u32 v130, v130, v131
  v_subrev_u32 v131, 20, v3
  v_cndmask_b32 v3, v3, v131, s[52:53]
  v_bfe_u32 v131, v3, 1, 3
  v_xor_b32 v130, v130, v131
  v_cndmask_b32 v131, v132, v133, s[52:53]
  v_lshl_add_u32 v130, v130, 4, v131
  v_add_u32 v3, s30, v3
  v_max_i32 v3, 0, v3
  v_lshlrev_b32 v3, 1, v3
  v_xor_b32 v3, s58, v3
  v_add_u32 v3, s59, v3
  v_mul_u32_u24 v3, 384, v3
  v_add_u32 v3, v3, v130
  s_lshr_b32 s46, s39, 4
  v_add_u32 v130, s46, v0
  v_mul_u32_u24 v4, 2731, v130
  v_lshrrev_b32 v4, 16, v4
  v_cmp_le_u32 s[52:53], 20, v4
  v_mul_u32_u24 v131, 24, v4
  v_sub_u32 v130, v130, v131
  v_subrev_u32 v131, 20, v4
  v_cndmask_b32 v4, v4, v131, s[52:53]
  v_bfe_u32 v131, v4, 1, 3
  v_xor_b32 v130, v130, v131
  v_cndmask_b32 v131, v132, v133, s[52:53]
  v_lshl_add_u32 v130, v130, 4, v131
  v_add_u32 v4, s30, v4
  v_max_i32 v4, 0, v4
  v_lshlrev_b32 v4, 1, v4
  v_xor_b32 v4, s58, v4
  v_add_u32 v4, s59, v4
  v_mul_u32_u24 v4, 384, v4
  v_add_u32 v4, v4, v130
  s_add_u32 s38, s38, 10240
  s_add_u32 s39, s39, 10240
  s_lshl_b32 s46, s25, 2
  s_add_i32 s46, s46, -2
  s_max_i32 s46, s46, 0
  s_add_i32 s46, s46, s37
  s_max_i32 s46, s46, 0
  s_sub_i32 s46, s46, s29
  s_lshl_b32 s34, s25, 2
  s_add_i32 s34, s34, s37
  s_max_i32 s34, s34, 0
  s_sub_i32 s34, s34, s29
  s_sub_u32 s46, s34, s46
  s_lshr_b32 s46, s46, 1
  s_mul_i32 s36, s46, -8
  s_add_i32 s36, s36, 7
  s_add_i32 s34, s34, -1
  s_add_i32 s35, s34, s36
  s_mul_i32 s36, s36, 7680
  s_lshl_b32 s47, s26, 2
  s_mul_i32 s46, s34, 7680
  s_add_i32 s46, s46, 10240
  v_add_u32 v130, s47, v128
  v_bfe_u32 v131, v130, 1, 3
  v_xor_b32 v131, v131, v129
  v_mul_u32_u24 v130, 384, v130
  v_lshl_add_u32 v130, v131, 4, v130
  v_add_u32 v7, s46, v130
  v_xor_b32 v8, 64, v7
  v_lshrrev_b32 v130, 2, v128
  v_lshl_add_u32 v130, v129, 2, v130
  v_add_u32 v130, s47, v130
  v_bfe_u32 v131, v130, 1, 3
  v_and_b32 v132, 2, v128
  v_lshlrev_b32 v132, 1, v132
  v_xor_b32 v131, v131, v132
  v_mul_u32_u24 v130, 384, v130
  v_lshl_add_u32 v130, v131, 4, v130
  v_and_b32 v131, 1, v128
  v_lshl_add_u32 v130, v131, 3, v130
  v_add_u32 v9, s46, v130
  v_xor_b32 v10, 16, v9
  v_xor_b32 v11, 32, v9
  v_xor_b32 v12, 48, v9
  v_lshl_add_u32 v130, v129, 2, s47
  v_sub_u32 v19, v130, v19
  v_cndmask_b32 v19, v19, 64, s[44:45]
  v_add_u32 v20, s36, v7
  v_add_u32 v0, s36, v8
  v_add_u32 v15, s36, v9
  v_add_u32 v16, s36, v10
  v_add_u32 v17, s36, v11
  v_add_u32 v18, s36, v12
  s_mov_b32 s93, 1037384597
SM2:
  s_cbranch_vccnz SL3
  s_add_i32 m0, s41, 49152
  s_add_i32 s100, s92, 128
  buffer_load_dwordx4 v96, s[88:91], s100 offen lds
  s_add_i32 m0, s41, 57344
  s_add_i32 s100, s92, 73856
  buffer_load_dwordx4 v96, s[88:91], s100 offen lds
  s_add_i32 m0, s41, 65536
  s_add_i32 s100, s92, 147584
  buffer_load_dwordx4 v96, s[88:91], s100 offen lds
  s_add_i32 m0, s41, 73728
  s_add_i32 s100, s92, 512
  buffer_load_dwordx4 v96, s[88:91], s100 offen lds
  s_add_i32 m0, s41, 81920
  s_add_i32 s100, s92, 74240
  buffer_load_dwordx4 v96, s[88:91], s100 offen lds
  s_add_i32 m0, s41, 90112
  s_add_i32 s100, s92, 147968
  buffer_load_dwordx4 v96, s[88:91], s100 offen lds
  s_add_i32 m0, s41, 45056
  s_add_i32 s100, s92, -36736
  buffer_load_dwordx4 v96, s[88:91], s100 offen lds
  s_add_i32 m0, s41, 53248
  s_add_i32 s100, s92, 36992
  buffer_load_dwordx4 v96, s[88:91], s100 offen lds
  s_add_i32 m0, s41, 61440
  s_add_i32 s100, s92, 110720
  buffer_load_dwordx4 v96, s[88:91], s100 offen lds
  s_add_i32 m0, s41, 69632
  s_add_i32 s100, s92, -36352
  buffer_load_dwordx4 v96, s[88:91], s100 offen lds
  s_add_i32 m0, s41, 77824
  s_add_i32 s100, s92, 37376
  buffer_load_dwordx4 v96, s[88:91], s100 offen lds
  s_add_i32 m0, s41, 86016
  s_add_i32 s100, s92, 111104
  buffer_load_dwordx4 v96, s[88:91], s100 offen lds
SL3:
  s_cbranch_vccz SL4
  s_waitcnt vmcnt(0)
  s_branch SM4
SL4:
  s_waitcnt vmcnt(12)
SM4:
  s_barrier
  ds_read_b128 v[208:211], v99 offset:0
  ds_read_b128 v[212:215], v99 offset:2048
  ds_read_b128 v[216:219], v99 offset:4096
  ds_read_b128 v[184:187], v97 offset:0
  ds_read_b128 v[188:191], v97 offset:2048
  ds_read_b128 v[192:195], v97 offset:4096
  ds_read_b128 v[196:199], v97 offset:6144
  ds_read_b128 v[200:203], v97 offset:8192
  ds_read_b128 v[204:207], v97 offset:10240
  s_waitcnt lgkmcnt(5)
  v_mfma_f32_16x16x32_bf16 v[24:27], v[184:187], v[208:211], 0
  s_cbranch_vccz SL5
  s_add_i32 m0, s41, 98304
  s_add_i32 s100, s92, 256
  buffer_load_dwordx4 v96, s[88:91], s100 offen lds
SL5:
  v_mfma_f32_16x16x32_bf16 v[28:31], v[184:187], v[212:215], 0
  s_cbranch_vccz SL6
  s_add_i32 m0, s41, 106496
  s_add_i32 s100, s92, 73984
  buffer_load_dwordx4 v96, s[88:91], s100 offen lds
SL6:
  v_mfma_f32_16x16x32_bf16 v[32:35], v[184:187], v[216:219], 0
  s_waitcnt lgkmcnt(4)
  v_mfma_f32_16x16x32_bf16 v[36:39], v[188:191], v[208:211], 0
  ds_read_b128 v[244:247], v100 offset:0
  s_cbranch_vccz SL7
  s_add_i32 m0, s41, 114688
  s_add_i32 s100, s92, 147712
  buffer_load_dwordx4 v96, s[88:91], s100 offen lds
SL7:
  v_mfma_f32_16x16x32_bf16 v[40:43], v[188:191], v[212:215], 0
  ds_read_b128 v[248:251], v100 offset:2048
  s_cbranch_vccz SL8
  s_add_i32 m0, s41, 122880
  s_add_i32 s100, s92, 640
  buffer_load_dwordx4 v96, s[88:91], s100 offen lds
SL8:
  v_mfma_f32_16x16x32_bf16 v[44:47], v[188:191], v[216:219], 0
  s_waitcnt lgkmcnt(5)
  v_mfma_f32_16x16x32_bf16 v[48:51], v[192:195], v[208:211], 0
  ds_read_b128 v[252:255], v100 offset:4096
  s_cbranch_vccz SL9
  s_add_i32 m0, s41, 131072
  s_add_i32 s100, s92, 74368
  buffer_load_dwordx4 v96, s[88:91], s100 offen lds
SL9:
  v_mfma_f32_16x16x32_bf16 v[52:55], v[192:195], v[212:215], 0
  ds_read_b128 v[220:223], v98 offset:0
  s_cbranch_vccz SL10
  s_add_i32 m0, s41, 139264
  s_add_i32 s100, s92, 148096
  buffer_load_dwordx4 v96, s[88:91], s100 offen lds
SL10:
  v_mfma_f32_16x16x32_bf16 v[56:59], v[192:195], v[216:219], 0
  s_waitcnt lgkmcnt(6)
  v_mfma_f32_16x16x32_bf16 v[60:63], v[196:199], v[208:211], 0
  ds_read_b128 v[224:227], v98 offset:2048
  s_cbranch_vccz SL11
  s_add_i32 m0, s41, 102400
  s_add_i32 s100, s92, 37120
  buffer_load_dwordx4 v96, s[88:91], s100 offen lds
SL11:
  v_mfma_f32_16x16x32_bf16 v[64:67], v[196:199], v[212:215], 0
  ds_read_b128 v[228:231], v98 offset:4096
  s_cbranch_vccz SL12
  s_add_i32 m0, s41, 110592
  s_add_i32 s100, s92, 110848
  buffer_load_dwordx4 v96, s[88:91], s100 offen lds
SL12:
  v_mfma_f32_16x16x32_bf16 v[68:71], v[196:199], v[216:219], 0
  s_waitcnt lgkmcnt(7)
  v_mfma_f32_16x16x32_bf16 v[72:75], v[200:203], v[208:211], 0
  ds_read_b128 v[232:235], v98 offset:6144
  s_cbranch_vccz SL13
  s_add_i32 m0, s41, 118784
  s_add_i32 s100, s92, 184576
  buffer_load_dwordx4 v96, s[88:91], s100 offen lds
SL13:
  v_mfma_f32_16x16x32_bf16 v[76:79], v[200:203], v[212:215], 0
  ds_read_b128 v[236:239], v98 offset:8192
  s_cbranch_vccz SL14
  s_add_i32 m0, s41, 126976
  s_add_i32 s100, s92, 37504
  buffer_load_dwordx4 v96, s[88:91], s100 offen lds
SL14:
  v_mfma_f32_16x16x32_bf16 v[80:83], v[200:203], v[216:219], 0
  s_waitcnt lgkmcnt(8)
  v_mfma_f32_16x16x32_bf16 v[84:87], v[204:207], v[208:211], 0
  ds_read_b128 v[240:243], v98 offset:10240
  s_cbranch_vccz SL15
  s_add_i32 m0, s41, 135168
  s_add_i32 s100, s92, 111232
  buffer_load_dwordx4 v96, s[88:91], s100 offen lds
SL15:
  v_mfma_f32_16x16x32_bf16 v[88:91], v[204:207], v[212:215], 0
  s_cbranch_vccz SL16
  s_add_i32 m0, s41, 143360
  s_add_i32 s100, s92, 184960
  buffer_load_dwordx4 v96, s[88:91], s100 offen lds
SL16:
  v_mfma_f32_16x16x32_bf16 v[92:95], v[204:207], v[216:219], 0
  v_lshrrev_b32 v107, 4, v1
  s_cmp_lt_u32 s2, 72
  s_cbranch_scc0 MK_np1
  s_mul_hi_u32 s54, s2, 0x15555556
  s_lshl_b32 s54, s54, 6
  s_mul_i32 s55, s24, 6144
  s_add_u32 s100, s54, s55
  v_lshrrev_b32 v104, 2, v107
  v_mul_u32_u24 v104, 384, v104
  v_and_b32 v105, 3, v107
  v_lshl_add_u32 v104, v105, 4, v104
  s_add_u32 m0, s41, 147456
  s_nop 0
  buffer_load_dwordx4 v104, s[4:7], s100 offen lds
  s_mul_i32 s55, s40, 6
  s_add_u32 s100, s54, s55
  s_add_u32 m0, s40, 155648
  s_add_u32 s100, s100, 49152
  buffer_load_dwordx4 v104, s[4:7], s100 offen lds
MK_np1:
  s_sub_u32 s3, s2, 72
  s_lshr_b32 s3, s3, 31
  s_lshr_b32 s3, s3, s25
  s_cmp_eq_u32 s3, 0
  s_cbranch_scc1 MK_np3
  s_mul_hi_u32 s54, s2, 0x15555556
  s_mul_i32 s55, s54, 12
  s_sub_u32 s55, s2, s55
  s_cmp_ge_u32 s55, 6
  s_cselect_b32 s51, 1, 0
  s_mul_i32 s100, s51, 6
  s_sub_u32 s55, s55, s100
  v_lshrrev_b32 v106, 2, v128
  v_and_b32 v105, 3, v128
  v_lshl_add_u32 v134, v129, 3, v106
  v_lshlrev_b32 v134, 6, v134
  v_lshl_add_u32 v134, v105, 4, v134
  s_lshl_b32 s51, s51, 3
  s_add_u32 s51, s51, 147456
  v_add_u32 v134, s51, v134
  s_lshr_b32 s54, s55, 1
  s_lshl_b32 s54, s54, 6
  s_and_b32 s55, s55, 1
  s_lshl_b32 s55, s55, 4
  s_add_u32 s54, s54, s55
  v_lshrrev_b32 v104, 1, v106
  v_lshlrev_b32 v104, 5, v104
  v_and_b32 v106, 1, v106
  v_lshl_add_u32 v104, v106, 2, v104
  v_add3_u32 v104, v104, v105, s54
  v_mul_u32_u24 v104, 1152, v104
  v_lshl_add_u32 v135, v129, 4, v104
  s_mul_i32 s100, s26, 9216
  buffer_load_dwordx4 v[136:139], v135, s[88:91], s100 offen offset:768
  buffer_load_dwordx4 v[140:143], v135, s[88:91], s100 offen offset:832
  buffer_load_dwordx4 v[144:147], v135, s[88:91], s100 offen offset:896
  buffer_load_dwordx4 v[148:151], v135, s[88:91], s100 offen offset:960
  buffer_load_dwordx4 v[152:155], v135, s[88:91], s100 offen offset:1024
  buffer_load_dwordx4 v[156:159], v135, s[88:91], s100 offen offset:1088
MK_np3:
  s_cbranch_vccz SL18
  s_waitcnt vmcnt(63) lgkmcnt(0)
  s_branch SM18
SL18:
  s_cmp_lg_u32 s3, 0
  s_cbranch_scc1 CA17
  s_cmp_lt_u32 s2, 72
  s_cbranch_scc1 CB17
  s_waitcnt vmcnt(0)
CB17:
  s_waitcnt vmcnt(2)
CA17:
  s_waitcnt vmcnt(8) lgkmcnt(0)
SM18:
  s_barrier
  v_add_u32 v97, 49152, v97
  v_add_u32 v98, 49152, v98
  v_add_u32 v99, 49152, v99
  v_add_u32 v100, 49152, v100
  v_mfma_f32_16x16x32_bf16 v[24:27], v[220:223], v[244:247], v[24:27]
  ds_read_b128 v[208:211], v99 offset:0
  s_cbranch_vccnz SL19
  buffer_load_dwordx4 v[160:163], v6, s[12:15], 0 offen offset:0
SL19:
  v_mfma_f32_16x16x32_bf16 v[28:31], v[220:223], v[248:251], v[28:31]
  ds_read_b128 v[212:215], v99 offset:2048
  v_mfma_f32_16x16x32_bf16 v[32:35], v[220:223], v[252:255], v[32:35]
  v_mfma_f32_16x16x32_bf16 v[36:39], v[224:227], v[244:247], v[36:39]
  ds_read_b128 v[216:219], v99 offset:4096
  v_mfma_f32_16x16x32_bf16 v[40:43], v[224:227], v[248:251], v[40:43]
  ds_read_b128 v[184:187], v97 offset:0
  s_cbranch_vccnz SL20
  buffer_load_dwordx4 v[164:167], v6, s[12:15], 0 offen offset:64
SL20:
  v_mfma_f32_16x16x32_bf16 v[44:47], v[224:227], v[252:255], v[44:47]
  v_mfma_f32_16x16x32_bf16 v[48:51], v[228:231], v[244:247], v[48:51]
  ds_read_b128 v[188:191], v97 offset:2048
  v_mfma_f32_16x16x32_bf16 v[52:55], v[228:231], v[248:251], v[52:55]
  ds_read_b128 v[192:195], v97 offset:4096
  v_mfma_f32_16x16x32_bf16 v[56:59], v[228:231], v[252:255], v[56:59]
  v_mfma_f32_16x16x32_bf16 v[60:63], v[232:235], v[244:247], v[60:63]
  ds_read_b128 v[196:199], v97 offset:6144
  s_cbranch_vccnz SL21
  buffer_load_dwordx4 v[168:171], v6, s[12:15], 0 offen offset:128
SL21:
  v_mfma_f32_16x16x32_bf16 v[64:67], v[232:235], v[248:251], v[64:67]
  ds_read_b128 v[200:203], v97 offset:8192
  v_mfma_f32_16x16x32_bf16 v[68:71], v[232:235], v[252:255], v[68:71]
  v_mfma_f32_16x16x32_bf16 v[72:75], v[236:239], v[244:247], v[72:75]
  ds_read_b128 v[204:207], v97 offset:10240
  v_mfma_f32_16x16x32_bf16 v[76:79], v[236:239], v[248:251], v[76:79]
  s_cbranch_vccnz SL22
  buffer_load_dwordx4 v[172:175], v6, s[12:15], 0 offen offset:192
SL22:
  v_mfma_f32_16x16x32_bf16 v[80:83], v[236:239], v[252:255], v[80:83]
  v_mfma_f32_16x16x32_bf16 v[84:87], v[240:243], v[244:247], v[84:87]
  v_mfma_f32_16x16x32_bf16 v[88:91], v[240:243], v[248:251], v[88:91]
  v_mfma_f32_16x16x32_bf16 v[92:95], v[240:243], v[252:255], v[92:95]
  s_cbranch_vccz SL23
  s_lshl_b32 s46, s29, 1
  s_xor_b32 s46, s46, s56
  s_mul_i32 s47, s27, 222
  s_add_i32 s31, s46, s47
  s_mul_i32 s31, s31, 86016
  s_mul_i32 s32, s27, -688128
  s_add_i32 s32, s32, 344064
  s_lshr_b32 s33, s29, 31
  s_lshl_b32 s33, s33, 1
  s_lshl_b32 s38, s40, 2
  s_add_u32 s39, s38, 3072
  s_min_u32 s39, s39, 14336
  s_mul_i32 s48, s27, 172032
  s_sub_u32 s49, 172032, s48
  v_mov_b32 v132, s48
  v_mov_b32 v133, s49
  s_lshr_b32 s46, s38, 4
  s_add_u32 s46, s46, 0
  v_add_u32 v130, s46, v0
  v_mul_u32_u24 v13, 2731, v130
  v_lshrrev_b32 v13, 16, v13
  v_cmp_le_u32 s[52:53], 20, v13
  v_mul_u32_u24 v131, 24, v13
  v_sub_u32 v130, v130, v131
  v_subrev_u32 v131, 20, v13
  v_cndmask_b32 v13, v13, v131, s[52:53]
  v_bfe_u32 v131, v13, 1, 3
  v_xor_b32 v130, v130, v131
  v_cndmask_b32 v131, v132, v133, s[52:53]
  v_lshl_add_u32 v130, v130, 4, v131
  v_add_u32 v13, s30, v13
  v_max_i32 v13, 0, v13
  v_lshlrev_b32 v13, 1, v13
  v_xor_b32 v13, s58, v13
  v_add_u32 v13, s59, v13
  v_mul_u32_u24 v13, 384, v13
  v_add_u32 v13, v13, v130
  s_lshr_b32 s46, s38, 4
  s_add_u32 s46, s46, 64
  v_add_u32 v130, s46, v0
  v_mul_u32_u24 v14, 2731, v130
  v_lshrrev_b32 v14, 16, v14
  v_cmp_le_u32 s[52:53], 20, v14
  v_mul_u32_u24 v131, 24, v14
  v_sub_u32 v130, v130, v131
  v_subrev_u32 v131, 20, v14
  v_cndmask_b32 v14, v14, v131, s[52:53]
  v_bfe_u32 v131, v14, 1, 3
  v_xor_b32 v130, v130, v131
  v_cndmask_b32 v131, v132, v133, s[52:53]
  v_lshl_add_u32 v130, v130, 4, v131
  v_add_u32 v14, s30, v14
  v_max_i32 v14, 0, v14
  v_lshlrev_b32 v14, 1, v14
  v_xor_b32 v14, s58, v14
  v_add_u32 v14, s59, v14
  v_mul_u32_u24 v14, 384, v14
  v_add_u32 v14, v14, v130
  s_lshr_b32 s46, s38, 4
  s_add_u32 s46, s46, 128
  v_add_u32 v130, s46, v0
  v_mul_u32_u24 v3, 2731, v130
  v_lshrrev_b32 v3, 16, v3
  v_cmp_le_u32 s[52:53], 20, v3
  v_mul_u32_u24 v131, 24, v3
  v_sub_u32 v130, v130, v131
  v_subrev_u32 v131, 20, v3
  v_cndmask_b32 v3, v3, v131, s[52:53]
  v_bfe_u32 v131, v3, 1, 3
  v_xor_b32 v130, v130, v131
  v_cndmask_b32 v131, v132, v133, s[52:53]
  v_lshl_add_u32 v130, v130, 4, v131
  v_add_u32 v3, s30, v3
  v_max_i32 v3, 0, v3
  v_lshlrev_b32 v3, 1, v3
  v_xor_b32 v3, s58, v3
  v_add_u32 v3, s59, v3
  v_mul_u32_u24 v3, 384, v3
  v_add_u32 v3, v3, v130
  s_lshr_b32 s46, s39, 4
  v_add_u32 v130, s46, v0
  v_mul_u32_u24 v4, 2731, v130
  v_lshrrev_b32 v4, 16, v4
  v_cmp_le_u32 s[52:53], 20, v4
  v_mul_u32_u24 v131, 24, v4
  v_sub_u32 v130, v130, v131
  v_subrev_u32 v131, 20, v4
  v_cndmask_b32 v4, v4, v131, s[52:53]
  v_bfe_u32 v131, v4, 1, 3
  v_xor_b32 v130, v130, v131
  v_cndmask_b32 v131, v132, v133, s[52:53]
  v_lshl_add_u32 v130, v130, 4, v131
  v_add_u32 v4, s30, v4
  v_max_i32 v4, 0, v4
  v_lshlrev_b32 v4, 1, v4
  v_xor_b32 v4, s58, v4
  v_add_u32 v4, s59, v4
  v_mul_u32_u24 v4, 384, v4
  v_add_u32 v4, v4, v130
  s_add_u32 s38, s38, 10240
  s_add_u32 s39, s39, 10240
  s_lshl_b32 s46, s25, 2
  s_add_i32 s46, s46, -2
  s_max_i32 s46, s46, 0
  s_add_i32 s46, s46, s37
  s_max_i32 s46, s46, 0
  s_sub_i32 s46, s46, s29
  s_lshl_b32 s34, s25, 2
  s_add_i32 s34, s34, s37
  s_max_i32 s34, s34, 0
  s_sub_i32 s34, s34, s29
  s_sub_u32 s46, s34, s46
  s_lshr_b32 s46, s46, 1
  s_mul_i32 s36, s46, -8
  s_add_i32 s36, s36, 7
  s_add_i32 s34, s34, -1
  s_add_i32 s35, s34, s36
  s_mul_i32 s36, s36, 7680
  s_lshl_b32 s47, s26, 2
  s_mul_i32 s46, s34, 7680
  s_add_i32 s46, s46, 10240
  v_add_u32 v130, s47, v128
  v_bfe_u32 v131, v130, 1, 3
  v_xor_b32 v131, v131, v129
  v_mul_u32_u24 v130, 384, v130
  v_lshl_add_u32 v130, v131, 4, v130
  v_add_u32 v7, s46, v130
  v_xor_b32 v8, 64, v7
  v_lshrrev_b32 v130, 2, v128
  v_lshl_add_u32 v130, v129, 2, v130
  v_add_u32 v130, s47, v130
  v_bfe_u32 v131, v130, 1, 3
  v_and_b32 v132, 2, v128
  v_lshlrev_b32 v132, 1, v132
  v_xor_b32 v131, v131, v132
  v_mul_u32_u24 v130, 384, v130
  v_lshl_add_u32 v130, v131, 4, v130
  v_and_b32 v131, 1, v128
  v_lshl_add_u32 v130, v131, 3, v130
  v_add_u32 v9, s46, v130
  v_xor_b32 v10, 16, v9
  v_xor_b32 v11, 32, v9
  v_xor_b32 v12, 48, v9
  v_lshl_add_u32 v130, v129, 2, s47
  v_sub_u32 v19, v130, v19
  v_cndmask_b32 v19, v19, 64, s[44:45]
  v_add_u32 v20, s36, v7
  v_add_u32 v0, s36, v8
  v_add_u32 v15, s36, v9
  v_add_u32 v16, s36, v10
  v_add_u32 v17, s36, v11
  v_add_u32 v18, s36, v12
  s_mov_b32 s93, 1037384597
  v_lshrrev_b32 v133, 4, v1
  v_lshrrev_b32 v130, 3, v133
  s_mul_i32 s50, s26, 7
  s_add_i32 s50, s50, s30
  v_cmp_lt_u32 s[52:53], 6, v130
  v_add_u32 v130, s50, v130
  v_max_i32 v131, 0, v130
  v_add3_u32 v130, v130, v131, 6
  v_xor_b32 v130, s58, v130
  v_add_u32 v130, s59, v130
  v_mul_u32_u24 v130, 384, v130
  v_and_b32 v131, 7, v133
  v_xor_b32 v131, v131, v129
  v_lshl_add_u32 v130, v131, 4, v130
  v_mov_b32 v131, 0x80000000
  v_cndmask_b32 v134, v130, v131, s[52:53]
  v_xor_b32 v135, 64, v134
  s_lshl_b32 s46, s25, 2
  s_add_i32 s46, s46, s37
  s_lshl_b32 s84, s46, 1
  s_add_i32 s84, s84, 2
  s_xor_b32 s84, s84, s56
  s_add_i32 s84, s84, s57
  s_mul_i32 s84, s84, 86016
  s_lshl_b32 s85, s46, 1
  s_add_i32 s85, s85, 4
  s_xor_b32 s85, s85, s56
  s_add_i32 s85, s85, s57
  s_mul_i32 s85, s85, 86016
  s_lshl_b32 s86, s46, 1
  s_add_i32 s86, s86, 6
  s_xor_b32 s86, s86, s56
  s_add_i32 s86, s86, s57
  s_mul_i32 s86, s86, 86016
  s_lshl_b32 s87, s46, 1
  s_add_i32 s87, s87, 8
  s_xor_b32 s87, s87, s56
  s_add_i32 s87, s87, s57
  s_mul_i32 s87, s87, 86016
  s_mul_i32 s101, s40, 6
  s_add_u32 s101, s101, 73728
  v_bfe_u32 v130, v128, 1, 3
  v_xor_b32 v130, v130, v129
  v_lshlrev_b32 v131, 7, v128
  v_lshl_add_u32 v131, v130, 4, v131
  v_lshrrev_b32 v130, 3, v128
  v_lshl_add_u32 v130, v130, 11, v131
  v_add_u32 v23, s101, v130
SL23:
  s_waitcnt lgkmcnt(5)
  v_mfma_f32_16x16x32_bf16 v[24:27], v[184:187], v[208:211], v[24:27]
  s_cbranch_vccnz SL24
  buffer_load_dwordx4 v[176:179], v6, s[12:15], 0 offen offset:256
SL24:
  v_mfma_f32_16x16x32_bf16 v[28:31], v[184:187], v[212:215], v[28:31]
  v_mfma_f32_16x16x32_bf16 v[32:35], v[184:187], v[216:219], v[32:35]
  s_waitcnt lgkmcnt(4)
  v_mfma_f32_16x16x32_bf16 v[36:39], v[188:191], v[208:211], v[36:39]
  ds_read_b128 v[244:247], v100 offset:0
  v_mfma_f32_16x16x32_bf16 v[40:43], v[188:191], v[212:215], v[40:43]
  ds_read_b128 v[248:251], v100 offset:2048
  s_cbranch_vccnz SL25
  buffer_load_dwordx4 v[180:183], v6, s[12:15], 0 offen offset:320
SL25:
  v_mfma_f32_16x16x32_bf16 v[44:47], v[188:191], v[216:219], v[44:47]
  s_waitcnt lgkmcnt(5)
  v_mfma_f32_16x16x32_bf16 v[48:51], v[192:195], v[208:211], v[48:51]
  ds_read_b128 v[252:255], v100 offset:4096
  v_mfma_f32_16x16x32_bf16 v[52:55], v[192:195], v[212:215], v[52:55]
  ds_read_b128 v[220:223], v98 offset:0
  v_mfma_f32_16x16x32_bf16 v[56:59], v[192:195], v[216:219], v[56:59]
  s_waitcnt lgkmcnt(6)
  v_mfma_f32_16x16x32_bf16 v[60:63], v[196:199], v[208:211], v[60:63]
  ds_read_b128 v[224:227], v98 offset:2048
  s_cbranch_vccnz SL26
  s_cmp_eq_u32 s25, 0
  s_cbranch_scc1 QB6
  buffer_load_dwordx4 v[136:139], v5, s[12:15], 0 offen offset:0
QB6:
SL26:
  v_mfma_f32_16x16x32_bf16 v[64:67], v[196:199], v[212:215], v[64:67]
  ds_read_b128 v[228:231], v98 offset:4096
  v_mfma_f32_16x16x32_bf16 v[68:71], v[196:199], v[216:219], v[68:71]
  s_waitcnt lgkmcnt(7)
  v_mfma_f32_16x16x32_bf16 v[72:75], v[200:203], v[208:211], v[72:75]
  ds_read_b128 v[232:235], v98 offset:6144
  v_mfma_f32_16x16x32_bf16 v[76:79], v[200:203], v[212:215], v[76:79]
  ds_read_b128 v[236:239], v98 offset:8192
  s_cbranch_vccnz SL27
  s_cmp_eq_u32 s25, 0
  s_cbranch_scc1 QB7
  buffer_load_dwordx4 v[140:143], v5, s[12:15], 0 offen offset:64
QB7:
SL27:
  v_mfma_f32_16x16x32_bf16 v[80:83], v[200:203], v[216:219], v[80:83]
  s_waitcnt lgkmcnt(8)
  v_mfma_f32_16x16x32_bf16 v[84:87], v[204:207], v[208:211], v[84:87]
  ds_read_b128 v[240:243], v98 offset:10240
  v_mfma_f32_16x16x32_bf16 v[88:91], v[204:207], v[212:215], v[88:91]
  v_mfma_f32_16x16x32_bf16 v[92:95], v[204:207], v[216:219], v[92:95]
  s_cbranch_vccz SL28
  s_waitcnt vmcnt(0) lgkmcnt(0)
  s_branch SM28
SL28:
  s_cmp_lg_u32 s25, 0
  s_cbranch_scc1 MK_c2
  s_waitcnt vmcnt(6)
MK_c2:
  s_waitcnt vmcnt(8) lgkmcnt(0)
SM28:
  s_barrier
  v_add_u32 v97, 49152, v97
  v_add_u32 v98, 49152, v98
  v_add_u32 v99, 49152, v99
  v_add_u32 v100, 49152, v100
  v_mfma_f32_16x16x32_bf16 v[24:27], v[220:223], v[244:247], v[24:27]
  ds_read_b128 v[208:211], v99 offset:0
  s_cbranch_vccnz SL29
  s_cmp_eq_u32 s25, 0
  s_cbranch_scc1 QB8
  buffer_load_dwordx4 v[144:147], v5, s[12:15], 0 offen offset:128
QB8:
SL29:
  v_mfma_f32_16x16x32_bf16 v[28:31], v[220:223], v[248:251], v[28:31]
  ds_read_b128 v[212:215], v99 offset:2048
  v_mfma_f32_16x16x32_bf16 v[32:35], v[220:223], v[252:255], v[32:35]
  v_mfma_f32_16x16x32_bf16 v[36:39], v[224:227], v[244:247], v[36:39]
  ds_read_b128 v[216:219], v99 offset:4096
  v_mfma_f32_16x16x32_bf16 v[40:43], v[224:227], v[248:251], v[40:43]
  ds_read_b128 v[184:187], v97 offset:0
  s_cbranch_vccnz SL30
  s_cmp_eq_u32 s25, 0
  s_cbranch_scc1 QB9
  buffer_load_dwordx4 v[148:151], v5, s[12:15], 0 offen offset:192
QB9:
SL30:
  v_mfma_f32_16x16x32_bf16 v[44:47], v[224:227], v[252:255], v[44:47]
  v_mfma_f32_16x16x32_bf16 v[48:51], v[228:231], v[244:247], v[48:51]
  ds_read_b128 v[188:191], v97 offset:2048
  v_mfma_f32_16x16x32_bf16 v[52:55], v[228:231], v[248:251], v[52:55]
  ds_read_b128 v[192:195], v97 offset:4096
  v_mfma_f32_16x16x32_bf16 v[56:59], v[228:231], v[252:255], v[56:59]
  v_mfma_f32_16x16x32_bf16 v[60:63], v[232:235], v[244:247], v[60:63]
  ds_read_b128 v[196:199], v97 offset:6144
  s_cbranch_vccnz SL31
  s_cmp_eq_u32 s25, 0
  s_cbranch_scc1 QB10
  buffer_load_dwordx4 v[152:155], v5, s[12:15], 0 offen offset:256
QB10:
SL31:
  v_mfma_f32_16x16x32_bf16 v[64:67], v[232:235], v[248:251], v[64:67]
  ds_read_b128 v[200:203], v97 offset:8192
  v_mfma_f32_16x16x32_bf16 v[68:71], v[232:235], v[252:255], v[68:71]
  v_mfma_f32_16x16x32_bf16 v[72:75], v[236:239], v[244:247], v[72:75]
  ds_read_b128 v[204:207], v97 offset:10240
  v_mfma_f32_16x16x32_bf16 v[76:79], v[236:239], v[248:251], v[76:79]
  s_cbranch_vccnz SL32
  s_cmp_eq_u32 s25, 0
  s_cbranch_scc1 QB11
  buffer_load_dwordx4 v[156:159], v5, s[12:15], 0 offen offset:320
QB11:
SL32:
  v_mfma_f32_16x16x32_bf16 v[80:83], v[236:239], v[252:255], v[80:83]
  v_mfma_f32_16x16x32_bf16 v[84:87], v[240:243], v[244:247], v[84:87]
  v_mfma_f32_16x16x32_bf16 v[88:91], v[240:243], v[248:251], v[88:91]
  v_mfma_f32_16x16x32_bf16 v[92:95], v[240:243], v[252:255], v[92:95]
  s_cmp_eq_u32 s3, 0
  s_cbranch_scc1 MK_np2
  s_waitcnt lgkmcnt(0)
  ds_read_b64_tr_b16 v[104:105], v134 offset:0
  ds_read_b64_tr_b16 v[106:107], v134 offset:256
  ds_read_b64_tr_b16 v[108:109], v134 offset:2048
  ds_read_b64_tr_b16 v[110:111], v134 offset:2304
  ds_read_b64_tr_b16 v[112:113], v134 offset:4096
  ds_read_b64_tr_b16 v[114:115], v134 offset:4352
  ds_read_b64_tr_b16 v[116:117], v134 offset:6144
  ds_read_b64_tr_b16 v[118:119], v134 offset:6400
  ds_read_b64_tr_b16 v[120:121], v134 offset:8192
  ds_read_b64_tr_b16 v[122:123], v134 offset:8448
  ds_read_b64_tr_b16 v[124:125], v134 offset:10240
  ds_read_b64_tr_b16 v[126:127], v134 offset:10496
  s_setprio 3
  s_waitcnt lgkmcnt(0)
  v_mfma_f32_16x16x32_bf16 v[128:131], v[136:139], v[104:107], 0
  v_mfma_f32_16x16x32_bf16 v[128:131], v[140:143], v[108:111], v[128:131]
  v_mfma_f32_16x16x32_bf16 v[128:131], v[144:147], v[112:115], v[128:131]
  v_mfma_f32_16x16x32_bf16 v[128:131], v[148:151], v[116:119], v[128:131]
  v_mfma_f32_16x16x32_bf16 v[128:131], v[152:155], v[120:123], v[128:131]
  v_mfma_f32_16x16x32_bf16 v[128:131], v[156:159], v[124:127], v[128:131]
  s_lshl_b32 s100, s2, 10
  s_lshl_b32 s54, s26, 3
  s_add_u32 s100, s100, s54
  s_nop 5
  v_cvt_pk_bf16_f32 v132, v128, v129
  v_cvt_pk_bf16_f32 v133, v130, v131
  buffer_store_dwordx2 v[132:133], v1, s[20:23], s100 offen sc1
  s_setprio 0
MK_np2:
  ds_read_b128 v[244:247], v100 offset:0
  ds_read_b128 v[248:251], v100 offset:2048
  ds_read_b128 v[252:255], v100 offset:4096
  ds_read_b128 v[220:223], v98 offset:0
  ds_read_b128 v[224:227], v98 offset:2048
  s_waitcnt lgkmcnt(5)
  v_mfma_f32_16x16x32_bf16 v[24:27], v[184:187], v[208:211], v[24:27]
  ds_read_b128 v[228:231], v98 offset:4096
  s_cbranch_vccz SL33
  s_add_u32 m0, s101, 0
  s_nop 0
  buffer_load_dwordx4 v134, s[12:15], s86 offen offset:0 lds
SL33:
  v_mfma_f32_16x16x32_bf16 v[36:39], v[188:191], v[208:211], v[36:39]
  ds_read_b128 v[232:235], v98 offset:6144
  s_waitcnt lgkmcnt(2)
  v_mfma_f32_16x16x32_bf16 v[36:39], v[224:227], v[244:247], v[36:39]
  ds_read_b128 v[236:239], v98 offset:8192
  v_mfma_f32_16x16x32_bf16 v[24:27], v[220:223], v[244:247], v[24:27]
  ds_read_b128 v[240:243], v98 offset:10240
  v_mfma_f32_16x16x32_bf16 v[28:31], v[184:187], v[212:215], v[28:31]
  v_mfma_f32_16x16x32_bf16 v[28:31], v[220:223], v[248:251], v[28:31]
  v_mfma_f32_16x16x32_bf16 v[40:43], v[188:191], v[212:215], v[40:43]
  s_cbranch_vccz SL34
  s_add_u32 m0, s101, 896
  s_nop 0
  buffer_load_dwordx4 v134, s[12:15], s86 offen offset:128 lds
SL34:
  v_mfma_f32_16x16x32_bf16 v[40:43], v[224:227], v[248:251], v[40:43]
  s_waitcnt lgkmcnt(0)
  v_mfma_f32_16x16x32_bf16 v[32:35], v[184:187], v[216:219], v[32:35]
  v_mfma_f32_16x16x32_bf16 v[32:35], v[220:223], v[252:255], v[32:35]
  v_cvt_pk_bf16_f32 v104, v24, v25
  v_cvt_pk_bf16_f32 v105, v26, v27
  v_mfma_f32_16x16x32_bf16 v[44:47], v[188:191], v[216:219], v[44:47]
  v_cvt_pk_bf16_f32 v106, v36, v37
  v_cvt_pk_bf16_f32 v107, v38, v39
  v_mfma_f32_16x16x32_bf16 v[44:47], v[224:227], v[252:255], v[44:47]
  ds_write_b128 v101, v[104:107] offset:14336
  v_mfma_f32_16x16x32_bf16 v[48:51], v[192:195], v[208:211], v[48:51]
  s_cbranch_vccz SL35
  s_add_u32 m0, s101, 1792
  s_nop 0
  buffer_load_dwordx4 v134, s[12:15], s86 offen offset:256 lds
SL35:
  v_mfma_f32_16x16x32_bf16 v[48:51], v[228:231], v[244:247], v[48:51]
  v_cvt_pk_bf16_f32 v108, v28, v29
  v_cvt_pk_bf16_f32 v109, v30, v31
  v_mfma_f32_16x16x32_bf16 v[60:63], v[196:199], v[208:211], v[60:63]
  v_cvt_pk_bf16_f32 v110, v40, v41
  v_cvt_pk_bf16_f32 v111, v42, v43
  v_mfma_f32_16x16x32_bf16 v[60:63], v[232:235], v[244:247], v[60:63]
  ds_write_b128 v101, v[108:111] offset:8192
  v_mfma_f32_16x16x32_bf16 v[52:55], v[192:195], v[212:215], v[52:55]
  v_mfma_f32_16x16x32_bf16 v[52:55], v[228:231], v[248:251], v[52:55]
  v_cvt_pk_bf16_f32 v112, v32, v33
  v_cvt_pk_bf16_f32 v113, v34, v35
  v_mfma_f32_16x16x32_bf16 v[64:67], v[196:199], v[212:215], v[64:67]
  v_cvt_pk_bf16_f32 v114, v44, v45
  v_cvt_pk_bf16_f32 v115, v46, v47
  s_cbranch_vccz SL36
  s_add_u32 m0, s101, 3072
  s_nop 0
  buffer_load_dwordx4 v135, s[12:15], s87 offen offset:0 lds
SL36:
  v_mfma_f32_16x16x32_bf16 v[64:67], v[232:235], v[248:251], v[64:67]
  ds_write_b128 v101, v[112:115] offset:2048
  v_mfma_f32_16x16x32_bf16 v[56:59], v[192:195], v[216:219], v[56:59]
  v_mfma_f32_16x16x32_bf16 v[56:59], v[228:231], v[252:255], v[56:59]
  v_cvt_pk_bf16_f32 v116, v48, v49
  v_cvt_pk_bf16_f32 v117, v50, v51
  v_mfma_f32_16x16x32_bf16 v[68:71], v[196:199], v[216:219], v[68:71]
  v_cvt_pk_bf16_f32 v118, v60, v61
  v_cvt_pk_bf16_f32 v119, v62, v63
  v_mfma_f32_16x16x32_bf16 v[68:71], v[232:235], v[252:255], v[68:71]
  ds_write_b128 v101, v[116:119] offset:13312
  v_mfma_f32_16x16x32_bf16 v[72:75], v[200:203], v[208:211], v[72:75]
  s_cbranch_vccz SL37
  s_add_u32 m0, s101, 3968
  s_nop 0
  buffer_load_dwordx4 v135, s[12:15], s87 offen offset:128 lds
SL37:
  v_mfma_f32_16x16x32_bf16 v[72:75], v[236:239], v[244:247], v[72:75]
  v_cvt_pk_bf16_f32 v120, v52, v53
  v_cvt_pk_bf16_f32 v121, v54, v55
  v_mfma_f32_16x16x32_bf16 v[84:87], v[204:207], v[208:211], v[84:87]
  v_cvt_pk_bf16_f32 v122, v64, v65
  v_cvt_pk_bf16_f32 v123, v66, v67
  v_mfma_f32_16x16x32_bf16 v[84:87], v[240:243], v[244:247], v[84:87]
  ds_write_b128 v101, v[120:123] offset:7168
  v_mfma_f32_16x16x32_bf16 v[76:79], v[200:203], v[212:215], v[76:79]
  v_mfma_f32_16x16x32_bf16 v[76:79], v[236:239], v[248:251], v[76:79]
  v_cvt_pk_bf16_f32 v124, v56, v57
  v_cvt_pk_bf16_f32 v125, v58, v59
  v_mfma_f32_16x16x32_bf16 v[88:91], v[204:207], v[212:215], v[88:91]
  v_cvt_pk_bf16_f32 v126, v68, v69
  v_cvt_pk_bf16_f32 v127, v70, v71
  s_cbranch_vccz SL38
  s_add_u32 m0, s101, 4864
  s_nop 0
  buffer_load_dwordx4 v135, s[12:15], s87 offen offset:256 lds
SL38:
  v_mfma_f32_16x16x32_bf16 v[88:91], v[240:243], v[248:251], v[88:91]
  ds_write_b128 v101, v[124:127] offset:1024
  v_mfma_f32_16x16x32_bf16 v[80:83], v[200:203], v[216:219], v[80:83]
  v_mfma_f32_16x16x32_bf16 v[80:83], v[236:239], v[252:255], v[80:83]
  v_cvt_pk_bf16_f32 v104, v72, v73
  v_cvt_pk_bf16_f32 v105, v74, v75
  v_mfma_f32_16x16x32_bf16 v[92:95], v[204:207], v[216:219], v[92:95]
  v_cvt_pk_bf16_f32 v106, v84, v85
  v_cvt_pk_bf16_f32 v107, v86, v87
  v_mfma_f32_16x16x32_bf16 v[92:95], v[240:243], v[252:255], v[92:95]
  ds_write_b128 v101, v[104:107] offset:12288
  v_cvt_pk_bf16_f32 v108, v76, v77
  v_cvt_pk_bf16_f32 v109, v78, v79
  v_cvt_pk_bf16_f32 v110, v88, v89
  v_cvt_pk_bf16_f32 v111, v90, v91
  ds_write_b128 v101, v[108:111] offset:6144
  s_nop 3
  v_cvt_pk_bf16_f32 v112, v80, v81
  v_cvt_pk_bf16_f32 v113, v82, v83
  v_cvt_pk_bf16_f32 v114, v92, v93
  v_cvt_pk_bf16_f32 v115, v94, v95
  ds_write_b128 v101, v[112:115] offset:0
  s_waitcnt lgkmcnt(0)
  s_barrier
  s_cmp_eq_u32 s25, 0
  s_cbranch_scc1 MK_single
  ds_read_b128 v[216:219], v2 offset:35840
  ds_read_b128 v[220:223], v2 offset:34816
  ds_read_b128 v[224:227], v2 offset:33792
  ds_read_b128 v[228:231], v2 offset:32768
  ds_read_b128 v[232:235], v2 offset:31744
  ds_read_b128 v[236:239], v2 offset:30720
  ds_read_b128 v[240:243], v2 offset:29696
  ds_read_b128 v[244:247], v2 offset:28672
  ds_read_b128 v[248:251], v2 offset:27648
  ds_read_b128 v[252:255], v2 offset:26624
  s_cbranch_vccz SL39
  s_add_u32 m0, s101, 24576
  s_nop 0
  buffer_load_dwordx4 v134, s[12:15], s84 offen offset:0 lds
  s_add_u32 m0, s101, 25472
  s_nop 0
  buffer_load_dwordx4 v134, s[12:15], s84 offen offset:128 lds
  s_add_u32 m0, s101, 26368
  s_nop 0
  buffer_load_dwordx4 v134, s[12:15], s84 offen offset:256 lds
  s_add_u32 m0, s101, 27648
  s_nop 0
  buffer_load_dwordx4 v135, s[12:15], s85 offen offset:0 lds
  s_add_u32 m0, s101, 28544
  s_nop 0
  buffer_load_dwordx4 v135, s[12:15], s85 offen offset:128 lds
  s_add_u32 m0, s101, 29440
  s_nop 0
  buffer_load_dwordx4 v135, s[12:15], s85 offen offset:256 lds
  s_mul_i32 s100, s32, 9
  s_add_i32 s100, s100, s31
  s_add_u32 m0, s38, 138240
  s_nop 0
  buffer_load_dwordx4 v13, s[12:15], s100 offen lds
  s_add_u32 m0, s38, 139264
  s_nop 0
  buffer_load_dwordx4 v14, s[12:15], s100 offen lds
  s_add_u32 m0, s38, 140288
  s_nop 0
  buffer_load_dwordx4 v3, s[12:15], s100 offen lds
  s_add_u32 m0, s39, 138240
  s_nop 0
  buffer_load_dwordx4 v4, s[12:15], s100 offen lds
  s_mul_i32 s100, s32, 8
  s_add_i32 s100, s100, s31
  s_add_u32 m0, s38, 122880
  s_nop 0
  buffer_load_dwordx4 v13, s[12:15], s100 offen lds
  s_add_u32 m0, s38, 123904
  s_nop 0
  buffer_load_dwordx4 v14, s[12:15], s100 offen lds
  s_add_u32 m0, s38, 124928
  s_nop 0
  buffer_load_dwordx4 v3, s[12:15], s100 offen lds
  s_add_u32 m0, s39, 122880
  s_nop 0
  buffer_load_dwordx4 v4, s[12:15], s100 offen lds
  s_waitcnt vmcnt(8) lgkmcnt(0)
  v_xor_b32 v130, 64, v23
  ds_read_b128 v[136:139], v23 offset:24576
  ds_read_b128 v[140:143], v130 offset:24576
  ds_read_b128 v[144:147], v23 offset:25600
  ds_read_b128 v[148:151], v130 offset:25600
  ds_read_b128 v[152:155], v23 offset:26624
  ds_read_b128 v[156:159], v130 offset:26624
  ds_read_b128 v[160:163], v23 offset:0
  ds_read_b128 v[164:167], v130 offset:0
  ds_read_b128 v[168:171], v23 offset:1024
  ds_read_b128 v[172:175], v130 offset:1024
  ds_read_b128 v[176:179], v23 offset:2048
  ds_read_b128 v[180:183], v130 offset:2048
  s_waitcnt lgkmcnt(0)
  s_barrier
  s_branch SM39
SL39:
  s_waitcnt vmcnt(0)
  s_setprio 1
SM39:
BODY:
  s_waitcnt lgkmcnt(6)
  v_mfma_f32_16x16x32_bf16 v[184:187], v[216:219], v[136:139], 0
  v_mov_b32 v64, 0xff800000
  v_add_u32 v65, 0, v19
  v_mfma_f32_16x16x32_bf16 v[184:187], v[220:223], v[140:143], v[184:187]
  v_add_u32 v66, 1, v19
  v_add_u32 v67, 2, v19
  v_mfma_f32_16x16x32_bf16 v[184:187], v[224:227], v[144:147], v[184:187]
  v_add_u32 v68, 3, v19
  v_cmp_gt_u32 s[48:49], 7, v65
  v_mfma_f32_16x16x32_bf16 v[192:195], v[216:219], v[160:163], 0
  ds_read_b128 v[216:219], v2 offset:25600
  v_cmp_gt_u32 s[50:51], 7, v66
  v_mfma_f32_16x16x32_bf16 v[192:195], v[220:223], v[164:167], v[192:195]
  ds_read_b128 v[220:223], v2 offset:24576
  v_cmp_gt_u32 s[52:53], 7, v67
  v_mfma_f32_16x16x32_bf16 v[192:195], v[224:227], v[168:171], v[192:195]
  ds_read_b128 v[224:227], v2 offset:23552
  v_cmp_gt_u32 s[54:55], 7, v68
  v_mfma_f32_16x16x32_bf16 v[192:195], v[228:231], v[172:175], v[192:195]
  s_add_i32 s46, s34, 8
  s_waitcnt lgkmcnt(5)
  v_mfma_f32_16x16x32_bf16 v[192:195], v[232:235], v[176:179], v[192:195]
  v_sub_u32 v69, s46, v22
  s_add_i32 s46, s34, 1
  v_mfma_f32_16x16x32_bf16 v[192:195], v[236:239], v[180:183], v[192:195]
  v_sub_u32 v70, s46, v22
  s_add_i32 s46, s34, 6
  v_mfma_f32_16x16x32_bf16 v[184:187], v[228:231], v[148:151], v[184:187]
  ds_read_b128 v[228:231], v2 offset:22528
  v_sub_u32 v71, s46, v21
  v_mfma_f32_16x16x32_bf16 v[184:187], v[232:235], v[152:155], v[184:187]
  ds_read_b128 v[232:235], v2 offset:21504
  s_add_i32 s46, s34, 0
  v_mfma_f32_16x16x32_bf16 v[184:187], v[236:239], v[156:159], v[184:187]
  ds_read_b128 v[236:239], v2 offset:20480
  v_sub_u32 v72, s46, v21
  v_mfma_f32_16x16x32_bf16 v[188:191], v[240:243], v[136:139], 0
  v_sub_u32 v73, s35, v21
  v_cndmask_b32 v32, v64, 0, s[48:49]
  v_mfma_f32_16x16x32_bf16 v[188:191], v[244:247], v[140:143], v[188:191]
  v_cndmask_b32 v33, v64, 0, s[50:51]
  s_waitcnt lgkmcnt(4)
  v_mfma_f32_16x16x32_bf16 v[188:191], v[248:251], v[144:147], v[188:191]
  v_cndmask_b32 v34, v64, 0, s[52:53]
  v_cndmask_b32 v35, v64, 0, s[54:55]
  v_mfma_f32_16x16x32_bf16 v[196:199], v[240:243], v[160:163], 0
  ds_read_b128 v[240:243], v2 offset:19456
  v_cmp_gt_u32 s[46:47], 7, v69
  v_mfma_f32_16x16x32_bf16 v[196:199], v[244:247], v[164:167], v[196:199]
  ds_read_b128 v[244:247], v2 offset:18432
  v_cmp_gt_u32 s[48:49], 7, v70
  v_mfma_f32_16x16x32_bf16 v[196:199], v[248:251], v[168:171], v[196:199]
  ds_read_b128 v[248:251], v2 offset:17408
  v_cmp_gt_u32 s[50:51], 7, v71
  v_mfma_f32_16x16x32_bf16 v[196:199], v[252:255], v[172:175], v[196:199]
  v_cmp_gt_u32 s[52:53], 7, v72
  v_cmp_gt_u32 s[54:55], 7, v73
  v_mfma_f32_16x16x32_bf16 v[196:199], v[216:219], v[176:179], v[196:199]
  v_cndmask_b32 v84, v64, v32, s[46:47]
  v_cndmask_b32 v85, v64, v33, s[46:47]
  v_mfma_f32_16x16x32_bf16 v[196:199], v[220:223], v[180:183], v[196:199]
  v_cndmask_b32 v86, v64, v34, s[46:47]
  v_mul_f32 v192, s93, v192
  v_mfma_f32_16x16x32_bf16 v[188:191], v[252:255], v[148:151], v[188:191]
  ds_read_b128 v[252:255], v2 offset:16384
  v_mul_f32 v193, s93, v193
  v_mfma_f32_16x16x32_bf16 v[188:191], v[216:219], v[152:155], v[188:191]
  ds_read_b128 v[216:219], v2 offset:15360
  v_mul_f32 v194, s93, v194
  v_mfma_f32_16x16x32_bf16 v[188:191], v[220:223], v[156:159], v[188:191]
  ds_read_b128 v[220:223], v2 offset:14336
  s_waitcnt lgkmcnt(6)
  v_mfma_f32_16x16x32_bf16 v[200:203], v[224:227], v[136:139], 0
  v_mul_f32 v195, s93, v195
  v_cvt_pk_bf16_f32 v112, v192, v193
  v_mfma_f32_16x16x32_bf16 v[200:203], v[228:231], v[140:143], v[200:203]
  v_cvt_pk_bf16_f32 v113, v194, v195
  v_mul_f32 v184, s93, v184
  v_mfma_f32_16x16x32_bf16 v[200:203], v[232:235], v[144:147], v[200:203]
  v_mul_f32 v185, s93, v185
  v_mul_f32 v186, s93, v186
  v_mfma_f32_16x16x32_bf16 v[208:211], v[224:227], v[160:163], 0
  ds_read_b128 v[224:227], v2 offset:13312
  v_mul_f32 v187, s93, v187
  v_mfma_f32_16x16x32_bf16 v[208:211], v[228:231], v[164:167], v[208:211]
  ds_read_b128 v[228:231], v2 offset:12288
  v_cvt_pk_bf16_f32 v88, v184, v185
  v_mfma_f32_16x16x32_bf16 v[208:211], v[232:235], v[168:171], v[208:211]
  ds_read_b128 v[232:235], v2 offset:11264
  v_cvt_pk_bf16_f32 v89, v186, v187
  v_mfma_f32_16x16x32_bf16 v[208:211], v[236:239], v[172:175], v[208:211]
  v_mul_f32 v196, s93, v196
  s_waitcnt lgkmcnt(5)
  v_mfma_f32_16x16x32_bf16 v[208:211], v[240:243], v[176:179], v[208:211]
  v_mul_f32 v197, s93, v197
  v_mul_f32 v198, s93, v198
  v_mfma_f32_16x16x32_bf16 v[208:211], v[244:247], v[180:183], v[208:211]
  v_mul_f32 v199, s93, v199
  v_cvt_pk_bf16_f32 v114, v196, v197
  v_mfma_f32_16x16x32_bf16 v[200:203], v[236:239], v[148:151], v[200:203]
  ds_read_b128 v[236:239], v2 offset:10240
  v_cvt_pk_bf16_f32 v115, v198, v199
  v_mfma_f32_16x16x32_bf16 v[200:203], v[240:243], v[152:155], v[200:203]
  ds_read_b128 v[240:243], v2 offset:9216
  v_mul_f32 v188, s93, v188
  v_mfma_f32_16x16x32_bf16 v[200:203], v[244:247], v[156:159], v[200:203]
  ds_read_b128 v[244:247], v2 offset:8192
  v_mul_f32 v189, s93, v189
  v_mfma_f32_16x16x32_bf16 v[204:207], v[248:251], v[136:139], 0
  v_mul_f32 v190, s93, v190
  v_mul_f32 v191, s93, v191
  v_mfma_f32_16x16x32_bf16 v[204:207], v[252:255], v[140:143], v[204:207]
  v_cvt_pk_bf16_f32 v90, v188, v189
  s_waitcnt lgkmcnt(4)
  v_mfma_f32_16x16x32_bf16 v[204:207], v[216:219], v[144:147], v[204:207]
  v_cvt_pk_bf16_f32 v91, v190, v191
  v_cndmask_b32 v87, v64, v35, s[46:47]
  v_mfma_f32_16x16x32_bf16 v[212:215], v[248:251], v[160:163], 0
  ds_read_b128 v[248:251], v2 offset:7168
  v_cndmask_b32 v56, v64, v32, s[48:49]
  v_mfma_f32_16x16x32_bf16 v[212:215], v[252:255], v[164:167], v[212:215]
  ds_read_b128 v[252:255], v2 offset:6144
  v_cndmask_b32 v57, v64, v33, s[48:49]
  v_mfma_f32_16x16x32_bf16 v[212:215], v[216:219], v[168:171], v[212:215]
  ds_read_b128 v[216:219], v2 offset:5120
  v_cndmask_b32 v58, v64, v34, s[48:49]
  v_mfma_f32_16x16x32_bf16 v[212:215], v[220:223], v[172:175], v[212:215]
  v_cndmask_b32 v59, v64, v35, s[48:49]
  v_mul_f32 v208, s93, v208
  v_mfma_f32_16x16x32_bf16 v[212:215], v[224:227], v[176:179], v[212:215]
  v_mul_f32 v209, s93, v209
  v_mul_f32 v210, s93, v210
  v_mfma_f32_16x16x32_bf16 v[212:215], v[228:231], v[180:183], v[212:215]
  v_mul_f32 v211, s93, v211
  v_cvt_pk_bf16_f32 v116, v208, v209
  v_mfma_f32_16x16x32_bf16 v[204:207], v[220:223], v[148:151], v[204:207]
  ds_read_b128 v[220:223], v2 offset:4096
  v_cvt_pk_bf16_f32 v117, v210, v211
  v_mfma_f32_16x16x32_bf16 v[204:207], v[224:227], v[152:155], v[204:207]
  ds_read_b128 v[224:227], v2 offset:3072
  v_mul_f32 v200, s93, v200
  v_mfma_f32_16x16x32_bf16 v[204:207], v[228:231], v[156:159], v[204:207]
  ds_read_b128 v[228:231], v2 offset:2048
  s_waitcnt lgkmcnt(6)
  v_mfma_f32_16x16x32_bf16 v[184:187], v[232:235], v[136:139], 0
  v_mul_f32 v201, s93, v201
  v_mul_f32 v202, s93, v202
  v_mfma_f32_16x16x32_bf16 v[184:187], v[236:239], v[140:143], v[184:187]
  v_mul_f32 v203, s93, v203
  v_cvt_pk_bf16_f32 v92, v200, v201
  v_mfma_f32_16x16x32_bf16 v[184:187], v[240:243], v[144:147], v[184:187]
  v_cvt_pk_bf16_f32 v93, v202, v203
  v_mul_f32 v212, s93, v212
  v_mfma_f32_16x16x32_bf16 v[192:195], v[232:235], v[160:163], 0
  ds_read_b128 v[232:235], v2 offset:1024
  v_mul_f32 v213, s93, v213
  v_mfma_f32_16x16x32_bf16 v[192:195], v[236:239], v[164:167], v[192:195]
  ds_read_b128 v[236:239], v2 offset:0
  v_mul_f32 v214, s93, v214
  v_mfma_f32_16x16x32_bf16 v[192:195], v[240:243], v[168:171], v[192:195]
  ds_read_b128 v[240:243], v1 offset:35840
  v_mul_f32 v215, s93, v215
  v_mfma_f32_16x16x32_bf16 v[192:195], v[244:247], v[172:175], v[192:195]
  v_cvt_pk_bf16_f32 v118, v212, v213
  s_waitcnt lgkmcnt(5)
  v_mfma_f32_16x16x32_bf16 v[192:195], v[248:251], v[176:179], v[192:195]
  v_cvt_pk_bf16_f32 v119, v214, v215
  v_mul_f32 v204, s93, v204
  v_mfma_f32_16x16x32_bf16 v[192:195], v[252:255], v[180:183], v[192:195]
  v_mul_f32 v205, s93, v205
  v_mul_f32 v206, s93, v206
  v_mfma_f32_16x16x32_bf16 v[184:187], v[244:247], v[148:151], v[184:187]
  ds_read_b128 v[244:247], v1 offset:34816
  v_mul_f32 v207, s93, v207
  v_mfma_f32_16x16x32_bf16 v[184:187], v[248:251], v[152:155], v[184:187]
  ds_read_b128 v[248:251], v1 offset:33792
  v_cvt_pk_bf16_f32 v94, v204, v205
  v_mfma_f32_16x16x32_bf16 v[184:187], v[252:255], v[156:159], v[184:187]
  ds_read_b128 v[252:255], v1 offset:32768
  v_cvt_pk_bf16_f32 v95, v206, v207
  v_mfma_f32_16x16x32_bf16 v[188:191], v[216:219], v[136:139], 0
  v_cndmask_b32 v52, v64, v32, s[50:51]
  v_cndmask_b32 v53, v64, v33, s[50:51]
  s_cbranch_vccz SL40
  s_barrier
SL40:
  v_mfma_f32_16x16x32_bf16 v[188:191], v[220:223], v[140:143], v[188:191]
  v_cndmask_b32 v54, v64, v34, s[50:51]
  s_waitcnt lgkmcnt(4)
  v_mfma_f32_16x16x32_bf16 v[188:191], v[224:227], v[144:147], v[188:191]
  v_cndmask_b32 v55, v64, v35, s[50:51]
  v_mul_f32 v192, s93, v192
  v_mfma_f32_16x16x32_bf16 v[196:199], v[216:219], v[160:163], 0
  ds_read_b128 v[216:219], v1 offset:31744
  v_mul_f32 v193, s93, v193
  v_mfma_f32_16x16x32_bf16 v[196:199], v[220:223], v[164:167], v[196:199]
  ds_read_b128 v[220:223], v1 offset:30720
  v_mul_f32 v194, s93, v194
  v_mfma_f32_16x16x32_bf16 v[196:199], v[224:227], v[168:171], v[196:199]
  ds_read_b128 v[224:227], v1 offset:29696
  v_mul_f32 v195, s93, v195
  v_mfma_f32_16x16x32_bf16 v[196:199], v[228:231], v[172:175], v[196:199]
  v_cvt_pk_bf16_f32 v120, v192, v193
  v_cvt_pk_bf16_f32 v121, v194, v195
  v_mfma_f32_16x16x32_bf16 v[196:199], v[232:235], v[176:179], v[196:199]
  v_mul_f32 v184, s93, v184
  v_mul_f32 v185, s93, v185
  v_mfma_f32_16x16x32_bf16 v[196:199], v[236:239], v[180:183], v[196:199]
  v_mul_f32 v186, s93, v186
  v_mul_f32 v187, s93, v187
  v_mfma_f32_16x16x32_bf16 v[188:191], v[228:231], v[148:151], v[188:191]
  ds_read_b128 v[228:231], v1 offset:28672
  v_cvt_pk_bf16_f32 v96, v184, v185
  v_mfma_f32_16x16x32_bf16 v[188:191], v[232:235], v[152:155], v[188:191]
  ds_read_b128 v[232:235], v1 offset:27648
  v_cvt_pk_bf16_f32 v97, v186, v187
  v_mfma_f32_16x16x32_bf16 v[188:191], v[236:239], v[156:159], v[188:191]
  ds_read_b128 v[236:239], v1 offset:26624
  s_waitcnt lgkmcnt(6)
  v_mfma_f32_16x16x32_bf16 v[200:203], v[240:243], v[136:139], 0
  v_mul_f32 v196, s93, v196
  v_mul_f32 v197, s93, v197
  v_mfma_f32_16x16x32_bf16 v[200:203], v[244:247], v[140:143], v[200:203]
  v_mul_f32 v198, s93, v198
  v_mul_f32 v199, s93, v199
  v_mfma_f32_16x16x32_bf16 v[200:203], v[248:251], v[144:147], v[200:203]
  v_cvt_pk_bf16_f32 v122, v196, v197
  v_cvt_pk_bf16_f32 v123, v198, v199
  v_mfma_f32_16x16x32_bf16 v[208:211], v[240:243], v[160:163], 0
  ds_read_b128 v[240:243], v1 offset:25600
  v_mul_f32 v188, s93, v188
  v_mfma_f32_16x16x32_bf16 v[208:211], v[244:247], v[164:167], v[208:211]
  ds_read_b128 v[244:247], v1 offset:24576
  v_mul_f32 v189, s93, v189
  v_mfma_f32_16x16x32_bf16 v[208:211], v[248:251], v[168:171], v[208:211]
  ds_read_b128 v[248:251], v1 offset:23552
  v_mul_f32 v190, s93, v190
  v_mfma_f32_16x16x32_bf16 v[208:211], v[252:255], v[172:175], v[208:211]
  v_mul_f32 v191, s93, v191
  s_waitcnt lgkmcnt(5)
  v_mfma_f32_16x16x32_bf16 v[208:211], v[216:219], v[176:179], v[208:211]
  v_cvt_pk_bf16_f32 v98, v188, v189
  v_cvt_pk_bf16_f32 v99, v190, v191
  v_mfma_f32_16x16x32_bf16 v[208:211], v[220:223], v[180:183], v[208:211]
  v_cndmask_b32 v28, v64, v32, s[52:53]
  v_cndmask_b32 v29, v64, v33, s[52:53]
  v_mfma_f32_16x16x32_bf16 v[200:203], v[252:255], v[148:151], v[200:203]
  ds_read_b128 v[252:255], v1 offset:22528
  v_cndmask_b32 v30, v64, v34, s[52:53]
  v_mfma_f32_16x16x32_bf16 v[200:203], v[216:219], v[152:155], v[200:203]
  ds_read_b128 v[216:219], v1 offset:21504
  v_cndmask_b32 v31, v64, v35, s[52:53]
  v_mfma_f32_16x16x32_bf16 v[200:203], v[220:223], v[156:159], v[200:203]
  ds_read_b128 v[220:223], v1 offset:20480
  v_cndmask_b32 v24, v64, v32, s[54:55]
  v_mfma_f32_16x16x32_bf16 v[204:207], v[224:227], v[136:139], 0
  v_mul_f32 v208, s93, v208
  v_mul_f32 v209, s93, v209
  v_mfma_f32_16x16x32_bf16 v[204:207], v[228:231], v[140:143], v[204:207]
  v_mul_f32 v210, s93, v210
  s_waitcnt lgkmcnt(4)
  v_mfma_f32_16x16x32_bf16 v[204:207], v[232:235], v[144:147], v[204:207]
  v_mul_f32 v211, s93, v211
  v_cvt_pk_bf16_f32 v124, v208, v209
  v_mfma_f32_16x16x32_bf16 v[212:215], v[224:227], v[160:163], 0
  ds_read_b128 v[224:227], v1 offset:19456
  v_cvt_pk_bf16_f32 v125, v210, v211
  v_mfma_f32_16x16x32_bf16 v[212:215], v[228:231], v[164:167], v[212:215]
  ds_read_b128 v[228:231], v1 offset:18432
  v_mul_f32 v200, s93, v200
  v_mfma_f32_16x16x32_bf16 v[212:215], v[232:235], v[168:171], v[212:215]
  ds_read_b128 v[232:235], v1 offset:17408
  v_mul_f32 v201, s93, v201
  v_mfma_f32_16x16x32_bf16 v[212:215], v[236:239], v[172:175], v[212:215]
  v_mul_f32 v202, s93, v202
  v_mul_f32 v203, s93, v203
  v_mfma_f32_16x16x32_bf16 v[212:215], v[240:243], v[176:179], v[212:215]
  v_cvt_pk_bf16_f32 v100, v200, v201
  v_cvt_pk_bf16_f32 v101, v202, v203
  v_mfma_f32_16x16x32_bf16 v[212:215], v[244:247], v[180:183], v[212:215]
  v_mfma_f32_16x16x32_bf16 v[204:207], v[236:239], v[148:151], v[204:207]
  ds_read_b128 v[236:239], v1 offset:16384
  v_mfma_f32_16x16x32_bf16 v[204:207], v[240:243], v[152:155], v[204:207]
  ds_read_b128 v[240:243], v1 offset:15360
  v_mfma_f32_16x16x32_bf16 v[204:207], v[244:247], v[156:159], v[204:207]
  ds_read_b128 v[244:247], v1 offset:14336
  s_waitcnt lgkmcnt(6)
  v_mfma_f32_16x16x32_bf16 v[184:187], v[248:251], v[136:139], 0
  v_mul_f32 v212, s93, v212
  v_mul_f32 v213, s93, v213
  v_mfma_f32_16x16x32_bf16 v[184:187], v[252:255], v[140:143], v[184:187]
  v_mul_f32 v214, s93, v214
  v_mul_f32 v215, s93, v215
  v_mfma_f32_16x16x32_bf16 v[184:187], v[216:219], v[144:147], v[184:187]
  v_cvt_pk_bf16_f32 v126, v212, v213
  v_cvt_pk_bf16_f32 v127, v214, v215
  v_mfma_f32_16x16x32_bf16 v[192:195], v[248:251], v[160:163], 0
  ds_read_b128 v[248:251], v1 offset:13312
  v_mul_f32 v204, s93, v204
  v_mfma_f32_16x16x32_bf16 v[192:195], v[252:255], v[164:167], v[192:195]
  ds_read_b128 v[252:255], v1 offset:12288
  v_mul_f32 v205, s93, v205
  v_mfma_f32_16x16x32_bf16 v[192:195], v[216:219], v[168:171], v[192:195]
  ds_read_b128 v[216:219], v1 offset:11264
  v_mul_f32 v206, s93, v206
  v_mfma_f32_16x16x32_bf16 v[192:195], v[220:223], v[172:175], v[192:195]
  v_mul_f32 v207, s93, v207
  s_waitcnt lgkmcnt(5)
  v_mfma_f32_16x16x32_bf16 v[192:195], v[224:227], v[176:179], v[192:195]
  v_cvt_pk_bf16_f32 v102, v204, v205
  v_cvt_pk_bf16_f32 v103, v206, v207
  v_mfma_f32_16x16x32_bf16 v[192:195], v[228:231], v[180:183], v[192:195]
  v_cndmask_b32 v25, v64, v33, s[54:55]
  v_cndmask_b32 v26, v64, v34, s[54:55]
  v_mfma_f32_16x16x32_bf16 v[184:187], v[220:223], v[148:151], v[184:187]
  ds_read_b128 v[220:223], v1 offset:10240
  v_cndmask_b32 v27, v64, v35, s[54:55]
  v_mfma_f32_16x16x32_bf16 v[184:187], v[224:227], v[152:155], v[184:187]
  ds_read_b128 v[224:227], v1 offset:9216
  v_mfma_f32_16x16x32_bf16 v[184:187], v[228:231], v[156:159], v[184:187]
  ds_read_b128 v[228:231], v1 offset:8192
  v_mfma_f32_16x16x32_bf16 v[188:191], v[232:235], v[136:139], 0
  v_mul_f32 v192, s93, v192
  v_mul_f32 v193, s93, v193
  v_mfma_f32_16x16x32_bf16 v[188:191], v[236:239], v[140:143], v[188:191]
  v_mul_f32 v194, s93, v194
  s_waitcnt lgkmcnt(4)
  v_mfma_f32_16x16x32_bf16 v[188:191], v[240:243], v[144:147], v[188:191]
  v_mul_f32 v195, s93, v195
  v_cvt_pk_bf16_f32 v128, v192, v193
  v_mfma_f32_16x16x32_bf16 v[196:199], v[232:235], v[160:163], 0
  ds_read_b128 v[232:235], v1 offset:7168
  v_cvt_pk_bf16_f32 v129, v194, v195
  v_mfma_f32_16x16x32_bf16 v[196:199], v[236:239], v[164:167], v[196:199]
  ds_read_b128 v[236:239], v1 offset:6144
  v_mul_f32 v184, s93, v184
  v_mfma_f32_16x16x32_bf16 v[196:199], v[240:243], v[168:171], v[196:199]
  ds_read_b128 v[240:243], v1 offset:5120
  v_mul_f32 v185, s93, v185
  v_mfma_f32_16x16x32_bf16 v[196:199], v[244:247], v[172:175], v[196:199]
  v_mul_f32 v186, s93, v186
  v_mul_f32 v187, s93, v187
  v_mfma_f32_16x16x32_bf16 v[196:199], v[248:251], v[176:179], v[196:199]
  v_cvt_pk_bf16_f32 v104, v184, v185
  v_cvt_pk_bf16_f32 v105, v186, v187
  v_mfma_f32_16x16x32_bf16 v[196:199], v[252:255], v[180:183], v[196:199]
  v_mfma_f32_16x16x32_bf16 v[188:191], v[244:247], v[148:151], v[188:191]
  ds_read_b128 v[244:247], v1 offset:4096
  v_mfma_f32_16x16x32_bf16 v[188:191], v[248:251], v[152:155], v[188:191]
  ds_read_b128 v[248:251], v1 offset:3072
  v_mfma_f32_16x16x32_bf16 v[188:191], v[252:255], v[156:159], v[188:191]
  ds_read_b128 v[252:255], v1 offset:2048
  s_waitcnt lgkmcnt(6)
  v_mfma_f32_16x16x32_bf16 v[200:203], v[216:219], v[136:139], 0
  v_mul_f32 v196, s93, v196
  v_mul_f32 v197, s93, v197
  s_cbranch_vccz SL41
  s_waitcnt vmcnt(0)
  s_barrier
SL41:
  v_mfma_f32_16x16x32_bf16 v[200:203], v[220:223], v[140:143], v[200:203]
  v_mul_f32 v198, s93, v198
  v_mul_f32 v199, s93, v199
  v_mfma_f32_16x16x32_bf16 v[200:203], v[224:227], v[144:147], v[200:203]
  v_cvt_pk_bf16_f32 v130, v196, v197
  v_cvt_pk_bf16_f32 v131, v198, v199
  v_mfma_f32_16x16x32_bf16 v[208:211], v[216:219], v[160:163], 0
  ds_read_b128 v[216:219], v1 offset:1024
  v_mul_f32 v188, s93, v188
  v_mfma_f32_16x16x32_bf16 v[208:211], v[220:223], v[164:167], v[208:211]
  ds_read_b128 v[220:223], v1 offset:0
  v_mul_f32 v189, s93, v189
  v_mfma_f32_16x16x32_bf16 v[208:211], v[224:227], v[168:171], v[208:211]
  v_mul_f32 v190, s93, v190
  v_mul_f32 v191, s93, v191
  v_mfma_f32_16x16x32_bf16 v[208:211], v[228:231], v[172:175], v[208:211]
  v_cvt_pk_bf16_f32 v106, v188, v189
  s_cbranch_vccnz SL42
  s_barrier
SL42:
  s_waitcnt lgkmcnt(4)
  v_mfma_f32_16x16x32_bf16 v[208:211], v[232:235], v[176:179], v[208:211]
  v_cvt_pk_bf16_f32 v107, v190, v191
  v_mfma_f32_16x16x32_bf16 v[208:211], v[236:239], v[180:183], v[208:211]
  v_mfma_f32_16x16x32_bf16 v[200:203], v[228:231], v[148:151], v[200:203]
  v_mfma_f32_16x16x32_bf16 v[200:203], v[232:235], v[152:155], v[200:203]
  v_mfma_f32_16x16x32_bf16 v[200:203], v[236:239], v[156:159], v[200:203]
  v_mfma_f32_16x16x32_bf16 v[204:207], v[240:243], v[136:139], 0
  v_mfma_f32_16x16x32_bf16 v[204:207], v[244:247], v[140:143], v[204:207]
  s_waitcnt lgkmcnt(3)
  v_mfma_f32_16x16x32_bf16 v[204:207], v[248:251], v[144:147], v[204:207]
  v_mfma_f32_16x16x32_bf16 v[212:215], v[240:243], v[160:163], 0
  v_mul_f32 v208, s93, v208
  v_mul_f32 v209, s93, v209
  v_mfma_f32_16x16x32_bf16 v[212:215], v[244:247], v[164:167], v[212:215]
  v_mul_f32 v210, s93, v210
  v_mul_f32 v211, s93, v211
  v_mfma_f32_16x16x32_bf16 v[212:215], v[248:251], v[168:171], v[212:215]
  v_cvt_pk_bf16_f32 v132, v208, v209
  s_waitcnt lgkmcnt(2)
  v_mfma_f32_16x16x32_bf16 v[212:215], v[252:255], v[172:175], v[212:215]
  v_cvt_pk_bf16_f32 v133, v210, v211
  s_waitcnt lgkmcnt(1)
  v_mfma_f32_16x16x32_bf16 v[212:215], v[216:219], v[176:179], v[212:215]
  v_mul_f32 v200, s93, v200
  s_waitcnt lgkmcnt(0)
  v_mfma_f32_16x16x32_bf16 v[212:215], v[220:223], v[180:183], v[212:215]
  v_mul_f32 v201, s93, v201
  v_mul_f32 v202, s93, v202
  v_mfma_f32_16x16x32_bf16 v[204:207], v[252:255], v[148:151], v[204:207]
  v_mul_f32 v203, s93, v203
  v_cvt_pk_bf16_f32 v108, v200, v201
  v_mfma_f32_16x16x32_bf16 v[204:207], v[216:219], v[152:155], v[204:207]
  v_cvt_pk_bf16_f32 v109, v202, v203
  v_mfma_f32_16x16x32_bf16 v[204:207], v[220:223], v[156:159], v[204:207]
  s_cbranch_vccnz SL43
  s_setprio 0
  s_mul_i32 s100, s32, 7
  s_add_i32 s100, s100, s31
  s_add_u32 m0, s38, 107520
  s_nop 0
  buffer_load_dwordx4 v13, s[12:15], s100 offen lds
  s_add_u32 m0, s38, 108544
  s_nop 0
  buffer_load_dwordx4 v14, s[12:15], s100 offen lds
  s_add_u32 m0, s38, 109568
  s_nop 0
  buffer_load_dwordx4 v3, s[12:15], s100 offen lds
  s_add_u32 m0, s39, 107520
  s_nop 0
  buffer_load_dwordx4 v4, s[12:15], s100 offen lds
  s_mul_i32 s100, s32, 6
  s_add_i32 s100, s100, s31
  s_add_u32 m0, s38, 92160
  s_nop 0
  buffer_load_dwordx4 v13, s[12:15], s100 offen lds
  s_add_u32 m0, s38, 93184
  s_nop 0
  buffer_load_dwordx4 v14, s[12:15], s100 offen lds
  s_add_u32 m0, s38, 94208
  s_nop 0
  buffer_load_dwordx4 v3, s[12:15], s100 offen lds
  s_add_u32 m0, s39, 92160
  s_nop 0
  buffer_load_dwordx4 v4, s[12:15], s100 offen lds
  s_mul_i32 s100, s32, 5
  s_add_i32 s100, s100, s31
  s_add_u32 m0, s38, 76800
  s_nop 0
  buffer_load_dwordx4 v13, s[12:15], s100 offen lds
  s_add_u32 m0, s38, 77824
  s_nop 0
  buffer_load_dwordx4 v14, s[12:15], s100 offen lds
  s_add_u32 m0, s38, 78848
  s_nop 0
  buffer_load_dwordx4 v3, s[12:15], s100 offen lds
  s_add_u32 m0, s39, 76800
  s_nop 0
  buffer_load_dwordx4 v4, s[12:15], s100 offen lds
  s_barrier
  s_mul_i32 s100, s32, 4
  s_add_i32 s100, s100, s31
  s_add_u32 m0, s38, 61440
  s_nop 0
  buffer_load_dwordx4 v13, s[12:15], s100 offen lds
  s_add_u32 m0, s38, 62464
  s_nop 0
  buffer_load_dwordx4 v14, s[12:15], s100 offen lds
  s_add_u32 m0, s38, 63488
  s_nop 0
  buffer_load_dwordx4 v3, s[12:15], s100 offen lds
  s_add_u32 m0, s39, 61440
  s_nop 0
  buffer_load_dwordx4 v4, s[12:15], s100 offen lds
  s_mul_i32 s100, s32, 3
  s_add_i32 s100, s100, s31
  s_add_u32 m0, s38, 46080
  s_nop 0
  buffer_load_dwordx4 v13, s[12:15], s100 offen lds
  s_add_u32 m0, s38, 47104
  s_nop 0
  buffer_load_dwordx4 v14, s[12:15], s100 offen lds
  s_add_u32 m0, s38, 48128
  s_nop 0
  buffer_load_dwordx4 v3, s[12:15], s100 offen lds
  s_add_u32 m0, s39, 46080
  s_nop 0
  buffer_load_dwordx4 v4, s[12:15], s100 offen lds
  s_mul_i32 s100, s32, 2
  s_add_i32 s100, s100, s31
  s_add_u32 m0, s38, 30720
  s_nop 0
  buffer_load_dwordx4 v13, s[12:15], s100 offen lds
  s_add_u32 m0, s38, 31744
  s_nop 0
  buffer_load_dwordx4 v14, s[12:15], s100 offen lds
  s_add_u32 m0, s38, 32768
  s_nop 0
  buffer_load_dwordx4 v3, s[12:15], s100 offen lds
  s_add_u32 m0, s39, 30720
  s_nop 0
  buffer_load_dwordx4 v4, s[12:15], s100 offen lds
  s_waitcnt vmcnt(12)
  s_barrier
  s_max_u32 s100, s33, 1
  s_mul_i32 s100, s100, s32
  s_add_i32 s100, s100, s31
  s_add_u32 m0, s38, 15360
  s_nop 0
  buffer_load_dwordx4 v13, s[12:15], s100 offen lds
  s_add_u32 m0, s38, 16384
  s_nop 0
  buffer_load_dwordx4 v14, s[12:15], s100 offen lds
  s_add_u32 m0, s38, 17408
  s_nop 0
  buffer_load_dwordx4 v3, s[12:15], s100 offen lds
  s_add_u32 m0, s39, 15360
  s_nop 0
  buffer_load_dwordx4 v4, s[12:15], s100 offen lds
  s_max_u32 s100, s33, 0
  s_mul_i32 s100, s100, s32
  s_add_i32 s100, s100, s31
  s_add_u32 m0, s38, 0
  s_nop 0
  buffer_load_dwordx4 v13, s[12:15], s100 offen lds
  s_add_u32 m0, s38, 1024
  s_nop 0
  buffer_load_dwordx4 v14, s[12:15], s100 offen lds
  s_add_u32 m0, s38, 2048
  s_nop 0
  buffer_load_dwordx4 v3, s[12:15], s100 offen lds
  s_add_u32 m0, s39, 0
  s_nop 0
  buffer_load_dwordx4 v4, s[12:15], s100 offen lds
  s_waitcnt vmcnt(8)
  s_barrier
SL43:
  ds_read_b128 v[224:227], v7 offset:61440
  ds_read_b128 v[228:231], v8 offset:61440
  ds_read_b128 v[232:235], v7 offset:61568
  ds_read_b128 v[236:239], v8 offset:61568
  ds_read_b128 v[240:243], v7 offset:61696
  ds_read_b128 v[244:247], v8 offset:61696
  ds_read_b128 v[248:251], v7 offset:53760
  ds_read_b128 v[252:255], v8 offset:53760
  ds_read_b128 v[216:219], v7 offset:53888
  ds_read_b128 v[220:223], v8 offset:53888
  s_waitcnt lgkmcnt(6)
  v_mfma_f32_16x16x32_bf16 v[84:87], v[224:227], v[112:115], v[84:87]
  ds_read_b128 v[224:227], v7 offset:54016
  v_mul_f32 v212, s93, v212
  v_mfma_f32_16x16x32_bf16 v[84:87], v[228:231], v[116:119], v[84:87]
  ds_read_b128 v[228:231], v8 offset:54016
  v_mul_f32 v213, s93, v213
  v_mfma_f32_16x16x32_bf16 v[84:87], v[232:235], v[120:123], v[84:87]
  ds_read_b128 v[232:235], v7 offset:46080
  v_mul_f32 v214, s93, v214
  v_mfma_f32_16x16x32_bf16 v[84:87], v[236:239], v[124:127], v[84:87]
  ds_read_b128 v[236:239], v8 offset:46080
  s_waitcnt lgkmcnt(6)
  v_mfma_f32_16x16x32_bf16 v[84:87], v[240:243], v[128:131], v[84:87]
  ds_read_b128 v[240:243], v7 offset:46208
  v_mul_f32 v215, s93, v215
  v_cvt_pk_bf16_f32 v134, v212, v213
  v_cvt_pk_bf16_f32 v135, v214, v215
  s_nop 1
  v_mfma_f32_16x16x32_bf16 v[84:87], v[244:247], v[132:135], v[84:87]
  ds_read_b128 v[244:247], v8 offset:46208
  v_mul_f32 v204, s93, v204
  v_mfma_f32_16x16x32_bf16 v[80:83], v[248:251], v[112:115], v[32:35]
  ds_read_b128 v[248:251], v7 offset:46336
  v_mul_f32 v205, s93, v205
  v_mfma_f32_16x16x32_bf16 v[80:83], v[252:255], v[116:119], v[80:83]
  ds_read_b128 v[252:255], v8 offset:46336
  s_waitcnt lgkmcnt(6)
  v_mfma_f32_16x16x32_bf16 v[80:83], v[216:219], v[120:123], v[80:83]
  ds_read_b128 v[216:219], v7 offset:38400
  v_mul_f32 v206, s93, v206
  v_mfma_f32_16x16x32_bf16 v[80:83], v[220:223], v[124:127], v[80:83]
  ds_read_b128 v[220:223], v8 offset:38400
  v_mul_f32 v207, s93, v207
  v_mfma_f32_16x16x32_bf16 v[80:83], v[224:227], v[128:131], v[80:83]
  ds_read_b128 v[224:227], v7 offset:38528
  v_cvt_pk_bf16_f32 v110, v204, v205
  v_mfma_f32_16x16x32_bf16 v[80:83], v[228:231], v[132:135], v[80:83]
  ds_read_b128 v[228:231], v8 offset:38528
  s_waitcnt vmcnt(0)
  s_barrier
  s_waitcnt lgkmcnt(6)
  v_mfma_f32_16x16x32_bf16 v[52:55], v[232:235], v[88:91], v[52:55]
  v_exp_f32 v204, v84
  v_mfma_f32_16x16x32_bf16 v[52:55], v[236:239], v[92:95], v[52:55]
  v_exp_f32 v205, v85
  v_mfma_f32_16x16x32_bf16 v[52:55], v[240:243], v[96:99], v[52:55]
  v_exp_f32 v208, v80
  v_mfma_f32_16x16x32_bf16 v[76:79], v[232:235], v[112:115], v[32:35]
  ds_read_b128 v[232:235], v7 offset:38656
  v_cvt_pk_bf16_f32 v111, v206, v207
  v_mfma_f32_16x16x32_bf16 v[76:79], v[236:239], v[116:119], v[76:79]
  v_exp_f32 v206, v86
  v_mfma_f32_16x16x32_bf16 v[76:79], v[240:243], v[120:123], v[76:79]
  v_exp_f32 v207, v87
  v_mfma_f32_16x16x32_bf16 v[76:79], v[244:247], v[124:127], v[76:79]
  ds_read_b128 v[236:239], v8 offset:38656
  s_waitcnt lgkmcnt(4)
  v_mfma_f32_16x16x32_bf16 v[76:79], v[248:251], v[128:131], v[76:79]
  ds_read_b128 v[240:243], v7 offset:30720
  v_add_u32 v2, 102400, v1
  v_mfma_f32_16x16x32_bf16 v[76:79], v[252:255], v[132:135], v[76:79]
  v_exp_f32 v209, v81
  v_mfma_f32_16x16x32_bf16 v[52:55], v[244:247], v[100:103], v[52:55]
  ds_read_b128 v[244:247], v8 offset:30720
  v_mov_b32 v192, 0x3f803f80
  v_mfma_f32_16x16x32_bf16 v[52:55], v[248:251], v[104:107], v[52:55]
  ds_read_b128 v[248:251], v7 offset:30848
  v_mov_b32 v193, 0x3f803f80
  v_mfma_f32_16x16x32_bf16 v[52:55], v[252:255], v[108:111], v[52:55]
  v_exp_f32 v210, v82
  v_mfma_f32_16x16x32_bf16 v[48:51], v[216:219], v[88:91], v[32:35]
  v_exp_f32 v211, v83
  v_mfma_f32_16x16x32_bf16 v[48:51], v[220:223], v[92:95], v[48:51]
  ds_read_b128 v[252:255], v8 offset:30848
  v_mov_b32 v194, 0x3f803f80
  s_waitcnt lgkmcnt(4)
  v_mfma_f32_16x16x32_bf16 v[48:51], v[224:227], v[96:99], v[48:51]
  v_exp_f32 v212, v76
  v_mfma_f32_16x16x32_bf16 v[72:75], v[216:219], v[112:115], v[32:35]
  ds_read_b128 v[216:219], v7 offset:30976
  v_mov_b32 v195, 0x3f803f80
  v_mfma_f32_16x16x32_bf16 v[72:75], v[220:223], v[116:119], v[72:75]
  ds_read_b128 v[220:223], v8 offset:30976
  v_cvt_pk_bf16_f32 v166, v204, v205
  v_mfma_f32_16x16x32_bf16 v[72:75], v[224:227], v[120:123], v[72:75]
  v_exp_f32 v213, v77
  v_mfma_f32_16x16x32_bf16 v[72:75], v[228:231], v[124:127], v[72:75]
  v_exp_f32 v214, v78
  v_mfma_f32_16x16x32_bf16 v[72:75], v[232:235], v[128:131], v[72:75]
  v_exp_f32 v215, v79
  v_mfma_f32_16x16x32_bf16 v[72:75], v[236:239], v[132:135], v[72:75]
  ds_read_b128 v[224:227], v7 offset:23040
  v_cvt_pk_bf16_f32 v167, v206, v207
  v_mfma_f32_16x16x32_bf16 v[48:51], v[228:231], v[100:103], v[48:51]
  ds_read_b128 v[228:231], v8 offset:23040
  v_cvt_pk_bf16_f32 v164, v208, v209
  v_mfma_f32_16x16x32_bf16 v[48:51], v[232:235], v[104:107], v[48:51]
  v_exp_f32 v196, v52
  v_mfma_f32_16x16x32_bf16 v[48:51], v[236:239], v[108:111], v[48:51]
  ds_read_b128 v[232:235], v7 offset:23168
  s_waitcnt lgkmcnt(5)
  v_mfma_f32_16x16x32_bf16 v[44:47], v[240:243], v[88:91], v[32:35]
  v_exp_f32 v197, v53
  v_mfma_f32_16x16x32_bf16 v[44:47], v[244:247], v[92:95], v[44:47]
  v_exp_f32 v198, v54
  v_mfma_f32_16x16x32_bf16 v[44:47], v[248:251], v[96:99], v[44:47]
  v_exp_f32 v199, v55
  v_mfma_f32_16x16x32_bf16 v[68:71], v[240:243], v[112:115], v[32:35]
  ds_read_b128 v[236:239], v8 offset:23168
  ds_read_b128 v[240:243], v7 offset:23296
  v_cvt_pk_bf16_f32 v165, v210, v211
  v_mfma_f32_16x16x32_bf16 v[68:71], v[244:247], v[116:119], v[68:71]
  ds_read_b128 v[244:247], v8 offset:23296
  v_cvt_pk_bf16_f32 v162, v212, v213
  v_mfma_f32_16x16x32_bf16 v[68:71], v[248:251], v[120:123], v[68:71]
  v_exp_f32 v204, v72
  v_mfma_f32_16x16x32_bf16 v[68:71], v[252:255], v[124:127], v[68:71]
  ds_read_b128 v[248:251], v7 offset:15360
  v_cvt_pk_bf16_f32 v163, v214, v215
  s_waitcnt lgkmcnt(5)
  v_mfma_f32_16x16x32_bf16 v[68:71], v[216:219], v[128:131], v[68:71]
  v_exp_f32 v205, v73
  v_mfma_f32_16x16x32_bf16 v[68:71], v[220:223], v[132:135], v[68:71]
  v_exp_f32 v206, v74
  v_mfma_f32_16x16x32_bf16 v[44:47], v[252:255], v[100:103], v[44:47]
  v_exp_f32 v207, v75
  v_mfma_f32_16x16x32_bf16 v[44:47], v[216:219], v[104:107], v[44:47]
  ds_read_b128 v[252:255], v8 offset:15360
  ds_read_b128 v[216:219], v7 offset:15488
  v_mfma_f32_16x16x32_bf16 v[44:47], v[220:223], v[108:111], v[44:47]
  ds_read_b128 v[220:223], v8 offset:15488
  v_cvt_pk_bf16_f32 v150, v196, v197
  v_mfma_f32_16x16x32_bf16 v[40:43], v[224:227], v[88:91], v[32:35]
  v_exp_f32 v200, v48
  v_mfma_f32_16x16x32_bf16 v[40:43], v[228:231], v[92:95], v[40:43]
  v_cvt_pk_bf16_f32 v151, v198, v199
  s_waitcnt lgkmcnt(4)
  v_mfma_f32_16x16x32_bf16 v[40:43], v[232:235], v[96:99], v[40:43]
  v_exp_f32 v201, v49
  v_mfma_f32_16x16x32_bf16 v[64:67], v[224:227], v[112:115], v[32:35]
  v_exp_f32 v202, v50
  v_mfma_f32_16x16x32_bf16 v[64:67], v[228:231], v[116:119], v[64:67]
  v_exp_f32 v203, v51
  v_mfma_f32_16x16x32_bf16 v[64:67], v[232:235], v[120:123], v[64:67]
  ds_read_b128 v[224:227], v7 offset:15616
  ds_read_b128 v[228:231], v8 offset:15616
  v_cvt_pk_bf16_f32 v160, v204, v205
  v_mfma_f32_16x16x32_bf16 v[64:67], v[236:239], v[124:127], v[64:67]
  v_exp_f32 v208, v68
  v_mfma_f32_16x16x32_bf16 v[64:67], v[240:243], v[128:131], v[64:67]
  v_exp_f32 v209, v69
  v_mfma_f32_16x16x32_bf16 v[64:67], v[244:247], v[132:135], v[64:67]
  v_exp_f32 v210, v70
  v_mfma_f32_16x16x32_bf16 v[40:43], v[236:239], v[100:103], v[40:43]
  v_exp_f32 v211, v71
  v_mfma_f32_16x16x32_bf16 v[40:43], v[240:243], v[104:107], v[40:43]
  ds_read_b128 v[232:235], v7 offset:7680
  ds_read_b128 v[236:239], v8 offset:7680
  v_mfma_f32_16x16x32_bf16 v[40:43], v[244:247], v[108:111], v[40:43]
  ds_read_b128 v[240:243], v7 offset:7808
  s_barrier
  s_waitcnt lgkmcnt(5)
  v_mfma_f32_16x16x32_bf16 v[36:39], v[248:251], v[88:91], v[32:35]
  v_exp_f32 v212, v64
  v_mfma_f32_16x16x32_bf16 v[36:39], v[252:255], v[92:95], v[36:39]
  v_exp_f32 v213, v65
  v_mfma_f32_16x16x32_bf16 v[36:39], v[216:219], v[96:99], v[36:39]
  v_exp_f32 v214, v66
  v_mfma_f32_16x16x32_bf16 v[60:63], v[248:251], v[112:115], v[32:35]
  v_exp_f32 v215, v67
  v_mfma_f32_16x16x32_bf16 v[60:63], v[252:255], v[116:119], v[60:63]
  ds_read_b128 v[244:247], v8 offset:7808
  ds_read_b128 v[248:251], v7 offset:7936
  v_cvt_pk_bf16_f32 v161, v206, v207
  v_mfma_f32_16x16x32_bf16 v[60:63], v[216:219], v[120:123], v[60:63]
  ds_read_b128 v[252:255], v8 offset:7936
  ds_read_b128 v[216:219], v7 offset:0
  v_cvt_pk_bf16_f32 v158, v208, v209
  v_mfma_f32_16x16x32_bf16 v[60:63], v[220:223], v[124:127], v[60:63]
  v_cvt_pk_bf16_f32 v159, v210, v211
  s_waitcnt lgkmcnt(5)
  v_mfma_f32_16x16x32_bf16 v[60:63], v[224:227], v[128:131], v[60:63]
  v_exp_f32 v196, v44
  v_mfma_f32_16x16x32_bf16 v[60:63], v[228:231], v[132:135], v[60:63]
  v_exp_f32 v197, v45
  v_mfma_f32_16x16x32_bf16 v[36:39], v[220:223], v[100:103], v[36:39]
  ds_read_b128 v[220:223], v8 offset:0
  v_cvt_pk_bf16_f32 v156, v212, v213
  v_mfma_f32_16x16x32_bf16 v[36:39], v[224:227], v[104:107], v[36:39]
  ds_read_b128 v[224:227], v7 offset:128
  v_cvt_pk_bf16_f32 v157, v214, v215
  v_mfma_f32_16x16x32_bf16 v[36:39], v[228:231], v[108:111], v[36:39]
  v_exp_f32 v198, v46
  v_mfma_f32_16x16x32_bf16 v[32:35], v[232:235], v[88:91], v[32:35]
  v_exp_f32 v204, v60
  v_mfma_f32_16x16x32_bf16 v[32:35], v[236:239], v[92:95], v[32:35]
  ds_read_b128 v[228:231], v8 offset:128
  v_cvt_pk_bf16_f32 v148, v200, v201
  s_waitcnt lgkmcnt(4)
  v_mfma_f32_16x16x32_bf16 v[32:35], v[240:243], v[96:99], v[32:35]
  v_exp_f32 v205, v61
  v_mfma_f32_16x16x32_bf16 v[56:59], v[232:235], v[112:115], v[56:59]
  v_exp_f32 v206, v62
  v_mfma_f32_16x16x32_bf16 v[56:59], v[236:239], v[116:119], v[56:59]
  v_exp_f32 v207, v63
  v_mfma_f32_16x16x32_bf16 v[56:59], v[240:243], v[120:123], v[56:59]
  v_exp_f32 v199, v47
  v_mfma_f32_16x16x32_bf16 v[56:59], v[244:247], v[124:127], v[56:59]
  ds_read_b128 v[232:235], v7 offset:256
  ds_read_b128 v[236:239], v8 offset:256
  v_cvt_pk_bf16_f32 v154, v204, v205
  v_mfma_f32_16x16x32_bf16 v[56:59], v[248:251], v[128:131], v[56:59]
  ds_read_b128 v[240:243], v20 offset:0
  v_cvt_pk_bf16_f32 v155, v206, v207
  v_mfma_f32_16x16x32_bf16 v[56:59], v[252:255], v[132:135], v[56:59]
  v_exp_f32 v200, v40
  v_mfma_f32_16x16x32_bf16 v[32:35], v[244:247], v[100:103], v[32:35]
  ds_read_b128 v[244:247], v0 offset:0
  v_cvt_pk_bf16_f32 v149, v202, v203
  v_mfma_f32_16x16x32_bf16 v[32:35], v[248:251], v[104:107], v[32:35]
  v_exp_f32 v201, v41
  v_mfma_f32_16x16x32_bf16 v[32:35], v[252:255], v[108:111], v[32:35]
  ds_read_b128 v[248:251], v20 offset:128
  s_waitcnt lgkmcnt(5)
  v_mfma_f32_16x16x32_bf16 v[28:31], v[216:219], v[88:91], v[28:31]
  v_exp_f32 v208, v56
  v_mfma_f32_16x16x32_bf16 v[28:31], v[220:223], v[92:95], v[28:31]
  v_exp_f32 v209, v57
  v_mfma_f32_16x16x32_bf16 v[28:31], v[224:227], v[96:99], v[28:31]
  v_exp_f32 v210, v58
  v_mfma_f32_16x16x32_bf16 v[28:31], v[228:231], v[100:103], v[28:31]
  ds_read_b128 v[252:255], v0 offset:128
  v_cvt_pk_bf16_f32 v152, v208, v209
  s_waitcnt lgkmcnt(4)
  v_mfma_f32_16x16x32_bf16 v[28:31], v[232:235], v[104:107], v[28:31]
  ds_read_b128 v[216:219], v20 offset:256
  ds_read_b128 v[220:223], v0 offset:256
  v_cvt_pk_bf16_f32 v146, v196, v197
  v_mfma_f32_16x16x32_bf16 v[28:31], v[236:239], v[108:111], v[28:31]
  ds_read_b64_tr_b16 v[224:225], v9 offset:38400
  ds_read_b64_tr_b16 v[226:227], v9 offset:46080
  v_cvt_pk_bf16_f32 v147, v198, v199
  s_cbranch_vccnz SL46
  s_barrier
SL46:
  s_waitcnt lgkmcnt(4)
  v_mfma_f32_16x16x32_bf16 v[24:27], v[240:243], v[88:91], v[24:27]
  v_exp_f32 v211, v59
  v_mfma_f32_16x16x32_bf16 v[24:27], v[244:247], v[92:95], v[24:27]
  ds_read_b64_tr_b16 v[228:229], v10 offset:38400
  ds_read_b64_tr_b16 v[230:231], v10 offset:46080
  v_cvt_pk_bf16_f32 v153, v210, v211
  v_mfma_f32_16x16x32_bf16 v[24:27], v[248:251], v[96:99], v[24:27]
  ds_read_b64_tr_b16 v[232:233], v11 offset:38400
  ds_read_b64_tr_b16 v[234:235], v11 offset:46080
  v_cvt_pk_bf16_f32 v144, v200, v201
  v_mfma_f32_16x16x32_bf16 v[188:191], v[192:195], v[164:167], 0
  ds_read_b64_tr_b16 v[236:237], v12 offset:38400
  ds_read_b64_tr_b16 v[238:239], v12 offset:46080
  v_exp_f32 v202, v42
  v_mfma_f32_16x16x32_bf16 v[188:191], v[192:195], v[160:163], v[188:191]
  v_exp_f32 v203, v43
  v_mfma_f32_16x16x32_bf16 v[188:191], v[192:195], v[156:159], v[188:191]
  v_exp_f32 v196, v36
  v_mfma_f32_16x16x32_bf16 v[188:191], v[192:195], v[152:155], v[188:191]
  v_exp_f32 v197, v37
  v_mfma_f32_16x16x32_bf16 v[24:27], v[252:255], v[100:103], v[24:27]
  ds_read_b64_tr_b16 v[240:241], v9 offset:38528
  ds_read_b64_tr_b16 v[242:243], v9 offset:46208
  v_cvt_pk_bf16_f32 v145, v202, v203
  s_waitcnt lgkmcnt(8)
  v_mfma_f32_16x16x32_bf16 v[24:27], v[216:219], v[104:107], v[24:27]
  v_exp_f32 v198, v38
  v_mfma_f32_16x16x32_bf16 v[24:27], v[220:223], v[108:111], v[24:27]
  ds_read_b64_tr_b16 v[244:245], v10 offset:38528
  ds_read_b64_tr_b16 v[246:247], v10 offset:46208
  v_cvt_pk_bf16_f32 v142, v196, v197
  v_subrev_u32 v23, 813694976, v188
  s_mov_b32 s52, 503316480
  v_cmp_gt_u32 s[48:49], s52, v23
  s_or_b64 s[48:49], s[48:49], s[44:45]
  s_cmp_eq_u64 s[48:49], -1
  s_cbranch_scc0 FB1
FBR1:
  v_mfma_f32_16x16x32_bf16 v[88:91], v[224:227], v[160:163], 0
  ds_read_b64_tr_b16 v[248:249], v11 offset:38528
  ds_read_b64_tr_b16 v[250:251], v11 offset:46208
  v_exp_f32 v199, v39
  v_mfma_f32_16x16x32_bf16 v[56:59], v[224:227], v[148:151], 0
  ds_read_b64_tr_b16 v[252:253], v12 offset:38528
  ds_read_b64_tr_b16 v[254:255], v12 offset:46208
  v_cvt_pk_bf16_f32 v143, v198, v199
  s_waitcnt lgkmcnt(8)
  v_mfma_f32_16x16x32_bf16 v[92:95], v[228:231], v[160:163], 0
  v_exp_f32 v200, v32
  v_mfma_f32_16x16x32_bf16 v[60:63], v[228:231], v[148:151], 0
  v_exp_f32 v201, v33
  v_mfma_f32_16x16x32_bf16 v[96:99], v[232:235], v[160:163], 0
  ds_read_b64_tr_b16 v[216:217], v9 offset:38656
  ds_read_b64_tr_b16 v[218:219], v9 offset:46336
  v_cvt_pk_bf16_f32 v140, v200, v201
  v_mfma_f32_16x16x32_bf16 v[64:67], v[232:235], v[148:151], 0
  v_exp_f32 v202, v34
  v_mfma_f32_16x16x32_bf16 v[100:103], v[236:239], v[160:163], 0
  ds_read_b64_tr_b16 v[220:221], v10 offset:38656
  ds_read_b64_tr_b16 v[222:223], v10 offset:46336
  v_exp_f32 v203, v35
  v_mfma_f32_16x16x32_bf16 v[68:71], v[236:239], v[148:151], 0
  ds_read_b64_tr_b16 v[224:225], v11 offset:38656
  ds_read_b64_tr_b16 v[226:227], v11 offset:46336
  v_cvt_pk_bf16_f32 v141, v202, v203
  s_waitcnt lgkmcnt(8)
  v_mfma_f32_16x16x32_bf16 v[104:107], v[240:243], v[160:163], 0
  v_exp_f32 v196, v28
  v_mfma_f32_16x16x32_bf16 v[72:75], v[240:243], v[148:151], 0
  v_exp_f32 v197, v29
  v_mfma_f32_16x16x32_bf16 v[108:111], v[244:247], v[160:163], 0
  ds_read_b64_tr_b16 v[228:229], v12 offset:38656
  ds_read_b64_tr_b16 v[230:231], v12 offset:46336
  v_mfma_f32_16x16x32_bf16 v[76:79], v[244:247], v[148:151], 0
  v_exp_f32 v198, v30
  v_mfma_f32_16x16x32_bf16 v[112:115], v[248:251], v[160:163], 0
  ds_read_b64_tr_b16 v[232:233], v9 offset:53760
  ds_read_b64_tr_b16 v[234:235], v9 offset:61440
  v_mfma_f32_16x16x32_bf16 v[80:83], v[248:251], v[148:151], 0
  ds_read_b64_tr_b16 v[236:237], v10 offset:53760
  ds_read_b64_tr_b16 v[238:239], v10 offset:61440
  s_waitcnt lgkmcnt(8)
  v_mfma_f32_16x16x32_bf16 v[116:119], v[252:255], v[160:163], 0
  v_exp_f32 v199, v31
  v_mfma_f32_16x16x32_bf16 v[84:87], v[252:255], v[148:151], 0
  v_exp_f32 v200, v24
  v_mfma_f32_16x16x32_bf16 v[120:123], v[216:219], v[160:163], 0
  ds_read_b64_tr_b16 v[240:241], v11 offset:53760
  ds_read_b64_tr_b16 v[242:243], v11 offset:61440
  v_mfma_f32_16x16x32_bf16 v[168:171], v[216:219], v[148:151], 0
  v_exp_f32 v201, v25
  v_mfma_f32_16x16x32_bf16 v[124:127], v[220:223], v[160:163], 0
  ds_read_b64_tr_b16 v[244:245], v12 offset:53760
  ds_read_b64_tr_b16 v[246:247], v12 offset:61440
  v_mfma_f32_16x16x32_bf16 v[172:175], v[220:223], v[148:151], 0
  ds_read_b64_tr_b16 v[248:249], v9 offset:53888
  ds_read_b64_tr_b16 v[250:251], v9 offset:61568
  s_waitcnt lgkmcnt(8)
  v_mfma_f32_16x16x32_bf16 v[128:131], v[224:227], v[160:163], 0
  v_exp_f32 v202, v26
  v_mfma_f32_16x16x32_bf16 v[176:179], v[224:227], v[148:151], 0
  v_exp_f32 v203, v27
  v_mfma_f32_16x16x32_bf16 v[132:135], v[228:231], v[160:163], 0
  ds_read_b64_tr_b16 v[252:253], v10 offset:53888
  ds_read_b64_tr_b16 v[254:255], v10 offset:61568
  v_mfma_f32_16x16x32_bf16 v[180:183], v[228:231], v[148:151], 0
  ds_read_b64_tr_b16 v[216:217], v11 offset:53888
  ds_read_b64_tr_b16 v[218:219], v11 offset:61568
  v_cvt_pk_bf16_f32 v138, v196, v197
  v_cvt_pk_bf16_f32 v139, v198, v199
  v_cvt_pk_bf16_f32 v136, v200, v201
  v_cvt_pk_bf16_f32 v137, v202, v203
  v_mfma_f32_16x16x32_bf16 v[184:187], v[192:195], v[148:151], 0
  ds_read_b64_tr_b16 v[220:221], v12 offset:53888
  ds_read_b64_tr_b16 v[222:223], v12 offset:61568
  v_mfma_f32_16x16x32_bf16 v[184:187], v[192:195], v[144:147], v[184:187]
  v_mfma_f32_16x16x32_bf16 v[184:187], v[192:195], v[140:143], v[184:187]
  v_mfma_f32_16x16x32_bf16 v[184:187], v[192:195], v[136:139], v[184:187]
  s_cbranch_vccnz SL47
  s_barrier
SL47:
  v_mfma_f32_16x16x32_bf16 v[88:91], v[232:235], v[164:167], v[88:91]
  s_waitcnt lgkmcnt(8)
  v_mfma_f32_16x16x32_bf16 v[92:95], v[236:239], v[164:167], v[92:95]
  ds_read_b64_tr_b16 v[224:225], v9 offset:54016
  ds_read_b64_tr_b16 v[226:227], v9 offset:61696
  v_mfma_f32_16x16x32_bf16 v[96:99], v[240:243], v[164:167], v[96:99]
  ds_read_b64_tr_b16 v[228:229], v10 offset:54016
  ds_read_b64_tr_b16 v[230:231], v10 offset:61696
  v_subrev_u32 v23, 813694976, v184
  s_mov_b32 s52, 503316480
  v_cmp_gt_u32 s[48:49], s52, v23
  s_or_b64 s[48:49], s[48:49], s[42:43]
  s_cmp_eq_u64 s[48:49], -1
  s_cbranch_scc0 FB0
FBR0:
  v_mfma_f32_16x16x32_bf16 v[100:103], v[244:247], v[164:167], v[100:103]
  ds_read_b64_tr_b16 v[232:233], v11 offset:54016
  ds_read_b64_tr_b16 v[234:235], v11 offset:61696
  s_waitcnt lgkmcnt(8)
  v_mfma_f32_16x16x32_bf16 v[104:107], v[248:251], v[164:167], v[104:107]
  v_rcp_f32 v23, v188
  v_mfma_f32_16x16x32_bf16 v[108:111], v[252:255], v[164:167], v[108:111]
  ds_read_b64_tr_b16 v[236:237], v12 offset:54016
  ds_read_b64_tr_b16 v[238:239], v12 offset:61696
  v_mfma_f32_16x16x32_bf16 v[112:115], v[216:219], v[164:167], v[112:115]
  ds_read_b64_tr_b16 v[240:241], v9 offset:23040
  ds_read_b64_tr_b16 v[242:243], v9 offset:30720
  s_waitcnt lgkmcnt(8)
  v_mfma_f32_16x16x32_bf16 v[116:119], v[220:223], v[164:167], v[116:119]
  ds_read_b64_tr_b16 v[244:245], v10 offset:23040
  ds_read_b64_tr_b16 v[246:247], v10 offset:30720
  v_mfma_f32_16x16x32_bf16 v[120:123], v[224:227], v[164:167], v[120:123]
  ds_read_b64_tr_b16 v[248:249], v11 offset:23040
  ds_read_b64_tr_b16 v[250:251], v11 offset:30720
  s_waitcnt lgkmcnt(8)
  v_mfma_f32_16x16x32_bf16 v[124:127], v[228:231], v[164:167], v[124:127]
  ds_read_b64_tr_b16 v[252:253], v12 offset:23040
  ds_read_b64_tr_b16 v[254:255], v12 offset:30720
  v_mfma_f32_16x16x32_bf16 v[128:131], v[232:235], v[164:167], v[128:131]
  ds_read_b64_tr_b16 v[216:217], v9 offset:23168
  ds_read_b64_tr_b16 v[218:219], v9 offset:30848
  s_waitcnt lgkmcnt(8)
  v_mfma_f32_16x16x32_bf16 v[132:135], v[236:239], v[164:167], v[132:135]
  ds_read_b64_tr_b16 v[220:221], v10 offset:23168
  ds_read_b64_tr_b16 v[222:223], v10 offset:30848
  s_cbranch_vccz SL48
  s_barrier
SL48:
  v_mfma_f32_16x16x32_bf16 v[88:91], v[240:243], v[156:159], v[88:91]
  ds_read_b64_tr_b16 v[224:225], v11 offset:23168
  ds_read_b64_tr_b16 v[226:227], v11 offset:30848
  v_mfma_f32_16x16x32_bf16 v[56:59], v[240:243], v[144:147], v[56:59]
  ds_read_b64_tr_b16 v[228:229], v12 offset:23168
  ds_read_b64_tr_b16 v[230:231], v12 offset:30848
  s_waitcnt lgkmcnt(8)
  v_mfma_f32_16x16x32_bf16 v[92:95], v[244:247], v[156:159], v[92:95]
  v_rcp_f32 v22, v184
  v_mfma_f32_16x16x32_bf16 v[60:63], v[244:247], v[144:147], v[60:63]
  ds_read_b64_tr_b16 v[232:233], v9 offset:23296
  ds_read_b64_tr_b16 v[234:235], v9 offset:30976
  v_mfma_f32_16x16x32_bf16 v[96:99], v[248:251], v[156:159], v[96:99]
  ds_read_b64_tr_b16 v[236:237], v10 offset:23296
  ds_read_b64_tr_b16 v[238:239], v10 offset:30976
  v_mfma_f32_16x16x32_bf16 v[64:67], v[248:251], v[144:147], v[64:67]
  ds_read_b64_tr_b16 v[240:241], v11 offset:23296
  ds_read_b64_tr_b16 v[242:243], v11 offset:30976
  v_mfma_f32_16x16x32_bf16 v[100:103], v[252:255], v[156:159], v[100:103]
  v_mfma_f32_16x16x32_bf16 v[68:71], v[252:255], v[144:147], v[68:71]
  s_waitcnt lgkmcnt(8)
  v_mfma_f32_16x16x32_bf16 v[104:107], v[216:219], v[156:159], v[104:107]
  ds_read_b64_tr_b16 v[244:245], v12 offset:23296
  ds_read_b64_tr_b16 v[246:247], v12 offset:30976
  v_mfma_f32_16x16x32_bf16 v[72:75], v[216:219], v[144:147], v[72:75]
  ds_read_b64_tr_b16 v[248:249], v9 offset:7680
  ds_read_b64_tr_b16 v[250:251], v9 offset:15360
  v_mfma_f32_16x16x32_bf16 v[108:111], v[220:223], v[156:159], v[108:111]
  ds_read_b64_tr_b16 v[252:253], v10 offset:7680
  ds_read_b64_tr_b16 v[254:255], v10 offset:15360
  v_mfma_f32_16x16x32_bf16 v[76:79], v[220:223], v[144:147], v[76:79]
  v_mfma_f32_16x16x32_bf16 v[112:115], v[224:227], v[156:159], v[112:115]
  v_mfma_f32_16x16x32_bf16 v[80:83], v[224:227], v[144:147], v[80:83]
  s_waitcnt lgkmcnt(8)
  v_mfma_f32_16x16x32_bf16 v[116:119], v[228:231], v[156:159], v[116:119]
  ds_read_b64_tr_b16 v[216:217], v11 offset:7680
  ds_read_b64_tr_b16 v[218:219], v11 offset:15360
  v_mfma_f32_16x16x32_bf16 v[84:87], v[228:231], v[144:147], v[84:87]
  ds_read_b64_tr_b16 v[220:221], v12 offset:7680
  ds_read_b64_tr_b16 v[222:223], v12 offset:15360
  v_mfma_f32_16x16x32_bf16 v[120:123], v[232:235], v[156:159], v[120:123]
  ds_read_b64_tr_b16 v[224:225], v9 offset:7808
  ds_read_b64_tr_b16 v[226:227], v9 offset:15488
  v_mfma_f32_16x16x32_bf16 v[168:171], v[232:235], v[144:147], v[168:171]
  v_mfma_f32_16x16x32_bf16 v[124:127], v[236:239], v[156:159], v[124:127]
  v_mfma_f32_16x16x32_bf16 v[172:175], v[236:239], v[144:147], v[172:175]
  s_waitcnt lgkmcnt(8)
  v_mfma_f32_16x16x32_bf16 v[128:131], v[240:243], v[156:159], v[128:131]
  ds_read_b64_tr_b16 v[228:229], v10 offset:7808
  ds_read_b64_tr_b16 v[230:231], v10 offset:15488
  v_mfma_f32_16x16x32_bf16 v[176:179], v[240:243], v[144:147], v[176:179]
  ds_read_b64_tr_b16 v[232:233], v11 offset:7808
  ds_read_b64_tr_b16 v[234:235], v11 offset:15488
  v_mfma_f32_16x16x32_bf16 v[132:135], v[244:247], v[156:159], v[132:135]
  ds_read_b64_tr_b16 v[236:237], v12 offset:7808
  ds_read_b64_tr_b16 v[238:239], v12 offset:15488
  v_mfma_f32_16x16x32_bf16 v[180:183], v[244:247], v[144:147], v[180:183]
  v_mfma_f32_16x16x32_bf16 v[88:91], v[248:251], v[152:155], v[88:91]
  v_mfma_f32_16x16x32_bf16 v[56:59], v[248:251], v[140:143], v[56:59]
  s_waitcnt lgkmcnt(8)
  v_mfma_f32_16x16x32_bf16 v[92:95], v[252:255], v[152:155], v[92:95]
  ds_read_b64_tr_b16 v[240:241], v9 offset:7936
  ds_read_b64_tr_b16 v[242:243], v9 offset:15616
  v_mfma_f32_16x16x32_bf16 v[60:63], v[252:255], v[140:143], v[60:63]
  ds_read_b64_tr_b16 v[244:245], v10 offset:7936
  ds_read_b64_tr_b16 v[246:247], v10 offset:15616
  v_mfma_f32_16x16x32_bf16 v[96:99], v[216:219], v[152:155], v[96:99]
  ds_read_b64_tr_b16 v[248:249], v11 offset:7936
  ds_read_b64_tr_b16 v[250:251], v11 offset:15616
  v_mfma_f32_16x16x32_bf16 v[64:67], v[216:219], v[140:143], v[64:67]
  v_cvt_pk_bf16_f32 v156, v88, v89
  v_cvt_pk_bf16_f32 v157, v90, v91
  v_mfma_f32_16x16x32_bf16 v[100:103], v[220:223], v[152:155], v[100:103]
  v_cvt_pk_bf16_f32 v158, v92, v93
  v_cvt_pk_bf16_f32 v159, v94, v95
  v_mfma_f32_16x16x32_bf16 v[68:71], v[220:223], v[140:143], v[68:71]
  s_waitcnt lgkmcnt(8)
  v_mfma_f32_16x16x32_bf16 v[104:107], v[224:227], v[152:155], v[104:107]
  ds_read_b64_tr_b16 v[252:253], v12 offset:7936
  ds_read_b64_tr_b16 v[254:255], v12 offset:15616
  v_mfma_f32_16x16x32_bf16 v[72:75], v[224:227], v[140:143], v[72:75]
  ds_read_b64_tr_b16 v[216:217], v15 offset:0
  ds_read_b64_tr_b16 v[218:219], v9 offset:0
  v_mfma_f32_16x16x32_bf16 v[108:111], v[228:231], v[152:155], v[108:111]
  ds_read_b64_tr_b16 v[220:221], v16 offset:0
  ds_read_b64_tr_b16 v[222:223], v10 offset:0
  v_mfma_f32_16x16x32_bf16 v[76:79], v[228:231], v[140:143], v[76:79]
  v_cvt_pk_bf16_f32 v160, v96, v97
  v_cvt_pk_bf16_f32 v161, v98, v99
  v_mfma_f32_16x16x32_bf16 v[112:115], v[232:235], v[152:155], v[112:115]
  v_cvt_pk_bf16_f32 v162, v100, v101
  v_cvt_pk_bf16_f32 v163, v102, v103
  v_mfma_f32_16x16x32_bf16 v[80:83], v[232:235], v[140:143], v[80:83]
  v_cvt_pk_bf16_f32 v164, v104, v105
  s_waitcnt lgkmcnt(8)
  v_mfma_f32_16x16x32_bf16 v[116:119], v[236:239], v[152:155], v[116:119]
  ds_read_b64_tr_b16 v[224:225], v17 offset:0
  ds_read_b64_tr_b16 v[226:227], v11 offset:0
  v_mfma_f32_16x16x32_bf16 v[84:87], v[236:239], v[140:143], v[84:87]
  ds_read_b64_tr_b16 v[228:229], v18 offset:0
  ds_read_b64_tr_b16 v[230:231], v12 offset:0
  v_mfma_f32_16x16x32_bf16 v[120:123], v[240:243], v[152:155], v[120:123]
  ds_read_b64_tr_b16 v[232:233], v15 offset:128
  ds_read_b64_tr_b16 v[234:235], v9 offset:128
  v_mfma_f32_16x16x32_bf16 v[168:171], v[240:243], v[140:143], v[168:171]
  v_cvt_pk_bf16_f32 v165, v106, v107
  v_cvt_pk_bf16_f32 v166, v108, v109
  v_mfma_f32_16x16x32_bf16 v[124:127], v[244:247], v[152:155], v[124:127]
  v_cvt_pk_bf16_f32 v167, v110, v111
  v_cvt_pk_bf16_f32 v24, v112, v113
  v_mfma_f32_16x16x32_bf16 v[172:175], v[244:247], v[140:143], v[172:175]
  v_cvt_pk_bf16_f32 v25, v114, v115
  s_waitcnt lgkmcnt(8)
  v_mfma_f32_16x16x32_bf16 v[128:131], v[248:251], v[152:155], v[128:131]
  ds_read_b64_tr_b16 v[236:237], v16 offset:128
  ds_read_b64_tr_b16 v[238:239], v10 offset:128
  v_mfma_f32_16x16x32_bf16 v[176:179], v[248:251], v[140:143], v[176:179]
  ds_read_b64_tr_b16 v[240:241], v17 offset:128
  ds_read_b64_tr_b16 v[242:243], v11 offset:128
  v_mfma_f32_16x16x32_bf16 v[132:135], v[252:255], v[152:155], v[132:135]
  ds_read_b64_tr_b16 v[244:245], v18 offset:128
  ds_read_b64_tr_b16 v[246:247], v12 offset:128
  v_mfma_f32_16x16x32_bf16 v[180:183], v[252:255], v[140:143], v[180:183]
  v_cvt_pk_bf16_f32 v26, v116, v117
  v_cvt_pk_bf16_f32 v27, v118, v119
  v_mfma_f32_16x16x32_bf16 v[56:59], v[216:219], v[136:139], v[56:59]
  v_cvt_pk_bf16_f32 v28, v120, v121
  s_waitcnt lgkmcnt(8)
  v_mfma_f32_16x16x32_bf16 v[60:63], v[220:223], v[136:139], v[60:63]
  ds_read_b64_tr_b16 v[248:249], v15 offset:256
  ds_read_b64_tr_b16 v[250:251], v9 offset:256
  v_mfma_f32_16x16x32_bf16 v[64:67], v[224:227], v[136:139], v[64:67]
  ds_read_b64_tr_b16 v[252:253], v16 offset:256
  ds_read_b64_tr_b16 v[254:255], v10 offset:256
  v_mfma_f32_16x16x32_bf16 v[68:71], v[228:231], v[136:139], v[68:71]
  ds_read_b64_tr_b16 v[216:217], v17 offset:256
  ds_read_b64_tr_b16 v[218:219], v11 offset:256
  s_waitcnt lgkmcnt(8)
  v_mfma_f32_16x16x32_bf16 v[72:75], v[232:235], v[136:139], v[72:75]
  ds_read_b64_tr_b16 v[220:221], v18 offset:256
  ds_read_b64_tr_b16 v[222:223], v12 offset:256
  v_mfma_f32_16x16x32_bf16 v[76:79], v[236:239], v[136:139], v[76:79]
  v_cvt_pk_bf16_f32 v29, v122, v123
  v_cvt_pk_bf16_f32 v30, v124, v125
  s_waitcnt lgkmcnt(0)
  s_cbranch_vccz SL49
  s_barrier
SL49:
  ds_read_b128 v[224:227], v2 offset:30720
  ds_read_b128 v[228:231], v2 offset:31744
  ds_read_b128 v[232:235], v2 offset:32768
  ds_read_b128 v[236:239], v2 offset:33792
  v_mfma_f32_16x16x32_bf16 v[80:83], v[240:243], v[136:139], v[80:83]
  ds_read_b128 v[240:243], v2 offset:34816
  v_cvt_pk_bf16_f32 v31, v126, v127
  v_mfma_f32_16x16x32_bf16 v[84:87], v[244:247], v[136:139], v[84:87]
  ds_read_b128 v[244:247], v2 offset:35840
  v_cvt_pk_bf16_f32 v32, v128, v129
  v_mfma_f32_16x16x32_bf16 v[168:171], v[248:251], v[136:139], v[168:171]
  ds_read_b128 v[248:251], v2 offset:36864
  v_cvt_pk_bf16_f32 v33, v130, v131
  v_mfma_f32_16x16x32_bf16 v[172:175], v[252:255], v[136:139], v[172:175]
  ds_read_b128 v[252:255], v2 offset:37888
  v_cvt_pk_bf16_f32 v34, v132, v133
  v_mfma_f32_16x16x32_bf16 v[176:179], v[216:219], v[136:139], v[176:179]
  ds_read_b128 v[216:219], v2 offset:38912
  v_cvt_pk_bf16_f32 v35, v134, v135
  v_mfma_f32_16x16x32_bf16 v[180:183], v[220:223], v[136:139], v[180:183]
  ds_read_b128 v[220:223], v2 offset:39936
  s_waitcnt lgkmcnt(6)
  v_mfma_f32_16x16x32_bf16 v[192:195], v[224:227], v[156:159], 0
  v_cvt_pk_bf16_f32 v140, v56, v57
  v_cvt_pk_bf16_f32 v141, v58, v59
  v_mfma_f32_16x16x32_bf16 v[192:195], v[228:231], v[160:163], v[192:195]
  v_cvt_pk_bf16_f32 v142, v60, v61
  v_cvt_pk_bf16_f32 v143, v62, v63
  v_mfma_f32_16x16x32_bf16 v[192:195], v[232:235], v[164:167], v[192:195]
  v_cvt_pk_bf16_f32 v144, v64, v65
  v_cvt_pk_bf16_f32 v145, v66, v67
  v_mfma_f32_16x16x32_bf16 v[192:195], v[236:239], v[24:27], v[192:195]
  v_cvt_pk_bf16_f32 v146, v68, v69
  s_waitcnt lgkmcnt(4)
  v_mfma_f32_16x16x32_bf16 v[192:195], v[240:243], v[28:31], v[192:195]
  v_cvt_pk_bf16_f32 v147, v70, v71
  v_cvt_pk_bf16_f32 v148, v72, v73
  v_mfma_f32_16x16x32_bf16 v[192:195], v[244:247], v[32:35], v[192:195]
  v_cvt_pk_bf16_f32 v149, v74, v75
  v_cvt_pk_bf16_f32 v150, v76, v77
  v_mfma_f32_16x16x32_bf16 v[184:187], v[224:227], v[140:143], 0
  ds_read_b128 v[224:227], v2 offset:40960
  v_cvt_pk_bf16_f32 v151, v78, v79
  v_mfma_f32_16x16x32_bf16 v[184:187], v[228:231], v[144:147], v[184:187]
  ds_read_b128 v[228:231], v2 offset:41984
  v_cvt_pk_bf16_f32 v152, v80, v81
  v_mfma_f32_16x16x32_bf16 v[184:187], v[232:235], v[148:151], v[184:187]
  ds_read_b128 v[232:235], v2 offset:43008
  v_cvt_pk_bf16_f32 v153, v82, v83
  v_cvt_pk_bf16_f32 v154, v84, v85
  v_cvt_pk_bf16_f32 v155, v86, v87
  s_nop 1
  v_mfma_f32_16x16x32_bf16 v[184:187], v[236:239], v[152:155], v[184:187]
  ds_read_b128 v[236:239], v2 offset:44032
  v_cvt_pk_bf16_f32 v36, v168, v169
  v_cvt_pk_bf16_f32 v37, v170, v171
  v_cvt_pk_bf16_f32 v38, v172, v173
  v_cvt_pk_bf16_f32 v39, v174, v175
  s_nop 1
  v_mfma_f32_16x16x32_bf16 v[184:187], v[240:243], v[36:39], v[184:187]
  ds_read_b128 v[240:243], v2 offset:45056
  v_cvt_pk_bf16_f32 v40, v176, v177
  v_cvt_pk_bf16_f32 v41, v178, v179
  v_cvt_pk_bf16_f32 v42, v180, v181
  v_cvt_pk_bf16_f32 v43, v182, v183
  s_nop 1
  v_mfma_f32_16x16x32_bf16 v[184:187], v[244:247], v[40:43], v[184:187]
  ds_read_b128 v[244:247], v2 offset:46080
  s_waitcnt lgkmcnt(6)
  v_mfma_f32_16x16x32_bf16 v[188:191], v[248:251], v[140:143], 0
  v_mul_f32 v192, v192, v23
  v_mul_f32 v193, v193, v23
  v_mfma_f32_16x16x32_bf16 v[188:191], v[252:255], v[144:147], v[188:191]
  v_mul_f32 v194, v194, v23
  v_mul_f32 v195, v195, v23
  v_mfma_f32_16x16x32_bf16 v[188:191], v[216:219], v[148:151], v[188:191]
  v_cvt_pk_bf16_f32 v92, v192, v193
  v_cvt_pk_bf16_f32 v93, v194, v195
  v_mfma_f32_16x16x32_bf16 v[196:199], v[248:251], v[156:159], 0
  ds_read_b128 v[248:251], v2 offset:47104
  v_mul_f32 v184, v184, v22
  v_mfma_f32_16x16x32_bf16 v[196:199], v[252:255], v[160:163], v[196:199]
  ds_read_b128 v[252:255], v2 offset:48128
  v_mul_f32 v185, v185, v22
  v_mfma_f32_16x16x32_bf16 v[196:199], v[216:219], v[164:167], v[196:199]
  ds_read_b128 v[216:219], v2 offset:49152
  v_mul_f32 v186, v186, v22
  v_mfma_f32_16x16x32_bf16 v[196:199], v[220:223], v[24:27], v[196:199]
  v_mul_f32 v187, v187, v22
  s_waitcnt lgkmcnt(5)
  v_mfma_f32_16x16x32_bf16 v[196:199], v[224:227], v[28:31], v[196:199]
  v_cvt_pk_bf16_f32 v88, v184, v185
  v_cvt_pk_bf16_f32 v89, v186, v187
  v_mfma_f32_16x16x32_bf16 v[196:199], v[228:231], v[32:35], v[196:199]
  v_mfma_f32_16x16x32_bf16 v[188:191], v[220:223], v[152:155], v[188:191]
  ds_read_b128 v[220:223], v2 offset:50176
  v_mfma_f32_16x16x32_bf16 v[188:191], v[224:227], v[36:39], v[188:191]
  ds_read_b128 v[224:227], v2 offset:51200
  v_mfma_f32_16x16x32_bf16 v[188:191], v[228:231], v[40:43], v[188:191]
  ds_read_b128 v[228:231], v2 offset:52224
  s_mov_b32 s100, 71680
  buffer_load_dwordx4 v[104:107], v1, s[20:23], s100 offen offset:0 sc1
  buffer_load_dwordx4 v[108:111], v1, s[20:23], s100 offen offset:1024 sc1
  v_mfma_f32_16x16x32_bf16 v[200:203], v[232:235], v[140:143], 0
  v_mul_f32 v196, v196, v23
  v_mul_f32 v197, v197, v23
  v_mfma_f32_16x16x32_bf16 v[200:203], v[236:239], v[144:147], v[200:203]
  v_mul_f32 v198, v198, v23
  s_waitcnt lgkmcnt(4)
  v_mfma_f32_16x16x32_bf16 v[200:203], v[240:243], v[148:151], v[200:203]
  v_mul_f32 v199, v199, v23
  v_cvt_pk_bf16_f32 v94, v196, v197
  v_mfma_f32_16x16x32_bf16 v[208:211], v[232:235], v[156:159], 0
  ds_read_b128 v[232:235], v2 offset:53248
  v_cvt_pk_bf16_f32 v95, v198, v199
  v_mfma_f32_16x16x32_bf16 v[208:211], v[236:239], v[160:163], v[208:211]
  buffer_store_dwordx4 v[92:95], v6, s[16:19], 0 offen offset:0 nt sc1
  v_mul_f32 v188, v188, v22
  v_mfma_f32_16x16x32_bf16 v[208:211], v[240:243], v[164:167], v[208:211]
  ds_read_b128 v[236:239], v2 offset:54272
  v_mul_f32 v189, v189, v22
  v_mfma_f32_16x16x32_bf16 v[208:211], v[244:247], v[24:27], v[208:211]
  ds_read_b128 v[240:243], v2 offset:55296
  v_mul_f32 v190, v190, v22
  v_mfma_f32_16x16x32_bf16 v[208:211], v[248:251], v[28:31], v[208:211]
  v_mul_f32 v191, v191, v22
  v_cvt_pk_bf16_f32 v90, v188, v189
  v_mfma_f32_16x16x32_bf16 v[208:211], v[252:255], v[32:35], v[208:211]
  v_cvt_pk_bf16_f32 v91, v190, v191
  v_mfma_f32_16x16x32_bf16 v[200:203], v[244:247], v[152:155], v[200:203]
  buffer_store_dwordx4 v[88:91], v5, s[16:19], 0 offen offset:0 nt sc1
  v_mfma_f32_16x16x32_bf16 v[200:203], v[248:251], v[36:39], v[200:203]
  ds_read_b128 v[244:247], v2 offset:56320
  ds_read_b128 v[248:251], v2 offset:57344
  v_mfma_f32_16x16x32_bf16 v[200:203], v[252:255], v[40:43], v[200:203]
  ds_read_b128 v[252:255], v2 offset:58368
  s_waitcnt lgkmcnt(6)
  v_mfma_f32_16x16x32_bf16 v[204:207], v[216:219], v[140:143], 0
  v_mul_f32 v208, v208, v23
  v_mul_f32 v209, v209, v23
  v_mfma_f32_16x16x32_bf16 v[204:207], v[220:223], v[144:147], v[204:207]
  v_mul_f32 v210, v210, v23
  v_mul_f32 v211, v211, v23
  v_mfma_f32_16x16x32_bf16 v[204:207], v[224:227], v[148:151], v[204:207]
  v_cvt_pk_bf16_f32 v100, v208, v209
  v_cvt_pk_bf16_f32 v101, v210, v211
  v_mfma_f32_16x16x32_bf16 v[212:215], v[216:219], v[156:159], 0
  ds_read_b128 v[216:219], v2 offset:59392
  v_mul_f32 v200, v200, v22
  v_mfma_f32_16x16x32_bf16 v[212:215], v[220:223], v[160:163], v[212:215]
  ds_read_b128 v[220:223], v2 offset:60416
  v_mul_f32 v201, v201, v22
  v_mfma_f32_16x16x32_bf16 v[212:215], v[224:227], v[164:167], v[212:215]
  ds_read_b128 v[224:227], v1 offset:0
  v_mul_f32 v202, v202, v22
  v_mfma_f32_16x16x32_bf16 v[212:215], v[228:231], v[24:27], v[212:215]
  v_mul_f32 v203, v203, v22
  s_waitcnt lgkmcnt(5)
  v_mfma_f32_16x16x32_bf16 v[212:215], v[232:235], v[28:31], v[212:215]
  v_cvt_pk_bf16_f32 v96, v200, v201
  v_cvt_pk_bf16_f32 v97, v202, v203
  v_mfma_f32_16x16x32_bf16 v[212:215], v[236:239], v[32:35], v[212:215]
  v_mfma_f32_16x16x32_bf16 v[204:207], v[228:231], v[152:155], v[204:207]
  ds_read_b128 v[228:231], v1 offset:1024
  v_mfma_f32_16x16x32_bf16 v[204:207], v[232:235], v[36:39], v[204:207]
  ds_read_b128 v[232:235], v1 offset:2048
  v_mfma_f32_16x16x32_bf16 v[204:207], v[236:239], v[40:43], v[204:207]
  ds_read_b128 v[236:239], v1 offset:3072
  s_cbranch_vccz SL50
  s_barrier
SL50:
  v_mfma_f32_16x16x32_bf16 v[184:187], v[240:243], v[140:143], 0
  v_mul_f32 v212, v212, v23
  v_mul_f32 v213, v213, v23
  v_mfma_f32_16x16x32_bf16 v[184:187], v[244:247], v[144:147], v[184:187]
  v_mul_f32 v214, v214, v23
  s_waitcnt lgkmcnt(4)
  v_mfma_f32_16x16x32_bf16 v[184:187], v[248:251], v[148:151], v[184:187]
  v_mul_f32 v215, v215, v23
  v_cvt_pk_bf16_f32 v102, v212, v213
  v_mfma_f32_16x16x32_bf16 v[192:195], v[240:243], v[156:159], 0
  ds_read_b128 v[240:243], v1 offset:4096
  v_cvt_pk_bf16_f32 v103, v214, v215
  v_mfma_f32_16x16x32_bf16 v[192:195], v[244:247], v[160:163], v[192:195]
  buffer_store_dwordx4 v[100:103], v6, s[16:19], 0 offen offset:64 nt sc1
  v_mul_f32 v204, v204, v22
  v_mfma_f32_16x16x32_bf16 v[192:195], v[248:251], v[164:167], v[192:195]
  ds_read_b128 v[244:247], v1 offset:5120
  v_mul_f32 v205, v205, v22
  v_mfma_f32_16x16x32_bf16 v[192:195], v[252:255], v[24:27], v[192:195]
  ds_read_b128 v[248:251], v1 offset:6144
  v_mul_f32 v206, v206, v22
  v_mfma_f32_16x16x32_bf16 v[192:195], v[216:219], v[28:31], v[192:195]
  v_mul_f32 v207, v207, v22
  v_cvt_pk_bf16_f32 v98, v204, v205
  v_mfma_f32_16x16x32_bf16 v[192:195], v[220:223], v[32:35], v[192:195]
  v_cvt_pk_bf16_f32 v99, v206, v207
  v_mfma_f32_16x16x32_bf16 v[184:187], v[252:255], v[152:155], v[184:187]
  buffer_store_dwordx4 v[96:99], v5, s[16:19], 0 offen offset:64 nt sc1
  v_mfma_f32_16x16x32_bf16 v[184:187], v[216:219], v[36:39], v[184:187]
  ds_read_b128 v[252:255], v1 offset:7168
  ds_read_b128 v[216:219], v1 offset:8192
  v_mfma_f32_16x16x32_bf16 v[184:187], v[220:223], v[40:43], v[184:187]
  ds_read_b128 v[220:223], v1 offset:9216
  s_waitcnt lgkmcnt(6)
  v_mfma_f32_16x16x32_bf16 v[188:191], v[224:227], v[140:143], 0
  v_mul_f32 v192, v192, v23
  v_mul_f32 v193, v193, v23
  v_mfma_f32_16x16x32_bf16 v[188:191], v[228:231], v[144:147], v[188:191]
  v_mul_f32 v194, v194, v23
  v_mul_f32 v195, v195, v23
  v_mfma_f32_16x16x32_bf16 v[188:191], v[232:235], v[148:151], v[188:191]
  v_cvt_pk_bf16_f32 v92, v192, v193
  v_cvt_pk_bf16_f32 v93, v194, v195
  v_mfma_f32_16x16x32_bf16 v[196:199], v[224:227], v[156:159], 0
  ds_read_b128 v[224:227], v2 offset:0
  v_mul_f32 v184, v184, v22
  v_mfma_f32_16x16x32_bf16 v[196:199], v[228:231], v[160:163], v[196:199]
  ds_read_b128 v[228:231], v2 offset:1024
  v_mul_f32 v185, v185, v22
  v_mfma_f32_16x16x32_bf16 v[196:199], v[232:235], v[164:167], v[196:199]
  ds_read_b128 v[232:235], v2 offset:2048
  v_mul_f32 v186, v186, v22
  v_mfma_f32_16x16x32_bf16 v[196:199], v[236:239], v[24:27], v[196:199]
  v_mul_f32 v187, v187, v22
  s_waitcnt lgkmcnt(5)
  v_mfma_f32_16x16x32_bf16 v[196:199], v[240:243], v[28:31], v[196:199]
  v_cvt_pk_bf16_f32 v88, v184, v185
  v_cvt_pk_bf16_f32 v89, v186, v187
  v_mfma_f32_16x16x32_bf16 v[196:199], v[244:247], v[32:35], v[196:199]
  v_mfma_f32_16x16x32_bf16 v[188:191], v[236:239], v[152:155], v[188:191]
  ds_read_b128 v[236:239], v2 offset:3072
  v_mfma_f32_16x16x32_bf16 v[188:191], v[240:243], v[36:39], v[188:191]
  ds_read_b128 v[240:243], v2 offset:4096
  v_mfma_f32_16x16x32_bf16 v[188:191], v[244:247], v[40:43], v[188:191]
  ds_read_b128 v[244:247], v2 offset:5120
  v_mfma_f32_16x16x32_bf16 v[200:203], v[248:251], v[140:143], 0
  v_mfma_f32_16x16x32_bf16 v[200:203], v[252:255], v[144:147], v[200:203]
  v_mul_f32 v196, v196, v23
  s_waitcnt lgkmcnt(4)
  v_mfma_f32_16x16x32_bf16 v[200:203], v[216:219], v[148:151], v[200:203]
  v_mul_f32 v197, v197, v23
  v_mul_f32 v198, v198, v23
  v_mfma_f32_16x16x32_bf16 v[208:211], v[248:251], v[156:159], 0
  ds_read_b128 v[248:251], v2 offset:6144
  v_mul_f32 v199, v199, v23
  v_mfma_f32_16x16x32_bf16 v[208:211], v[252:255], v[160:163], v[208:211]
  ds_read_b128 v[252:255], v2 offset:7168
  v_cvt_pk_bf16_f32 v94, v196, v197
  v_mfma_f32_16x16x32_bf16 v[208:211], v[216:219], v[164:167], v[208:211]
  ds_read_b128 v[216:219], v2 offset:8192
  v_cvt_pk_bf16_f32 v95, v198, v199
  v_mfma_f32_16x16x32_bf16 v[208:211], v[220:223], v[24:27], v[208:211]
  buffer_store_dwordx4 v[92:95], v6, s[16:19], 0 offen offset:128 nt sc1
  v_mul_f32 v188, v188, v22
  v_mfma_f32_16x16x32_bf16 v[208:211], v[224:227], v[28:31], v[208:211]
  v_mul_f32 v189, v189, v22
  v_mul_f32 v190, v190, v22
  v_mfma_f32_16x16x32_bf16 v[208:211], v[228:231], v[32:35], v[208:211]
  v_mul_f32 v191, v191, v22
  v_cvt_pk_bf16_f32 v90, v188, v189
  v_mfma_f32_16x16x32_bf16 v[200:203], v[220:223], v[152:155], v[200:203]
  ds_read_b128 v[220:223], v2 offset:9216
  v_cvt_pk_bf16_f32 v91, v190, v191
  v_mfma_f32_16x16x32_bf16 v[200:203], v[224:227], v[36:39], v[200:203]
  buffer_store_dwordx4 v[88:91], v5, s[16:19], 0 offen offset:128 nt sc1
  v_mfma_f32_16x16x32_bf16 v[200:203], v[228:231], v[40:43], v[200:203]
  ds_read_b128 v[224:227], v2 offset:10240
  s_waitcnt lgkmcnt(5)
  v_mfma_f32_16x16x32_bf16 v[204:207], v[232:235], v[140:143], 0
  ds_read_b128 v[228:231], v2 offset:11264
  v_mul_f32 v208, v208, v23
  v_mfma_f32_16x16x32_bf16 v[204:207], v[236:239], v[144:147], v[204:207]
  v_mul_f32 v209, v209, v23
  v_mul_f32 v210, v210, v23
  v_mfma_f32_16x16x32_bf16 v[204:207], v[240:243], v[148:151], v[204:207]
  v_mul_f32 v211, v211, v23
  v_cvt_pk_bf16_f32 v100, v208, v209
  v_mfma_f32_16x16x32_bf16 v[212:215], v[232:235], v[156:159], 0
  ds_read_b128 v[232:235], v2 offset:12288
  v_cvt_pk_bf16_f32 v101, v210, v211
  v_mfma_f32_16x16x32_bf16 v[212:215], v[236:239], v[160:163], v[212:215]
  ds_read_b128 v[236:239], v2 offset:13312
  v_mul_f32 v200, v200, v22
  v_mfma_f32_16x16x32_bf16 v[212:215], v[240:243], v[164:167], v[212:215]
  ds_read_b128 v[240:243], v2 offset:14336
  v_mul_f32 v201, v201, v22
  v_mfma_f32_16x16x32_bf16 v[212:215], v[244:247], v[24:27], v[212:215]
  v_mul_f32 v202, v202, v22
  s_waitcnt lgkmcnt(5)
  v_mfma_f32_16x16x32_bf16 v[212:215], v[248:251], v[28:31], v[212:215]
  v_mul_f32 v203, v203, v22
  v_cvt_pk_bf16_f32 v96, v200, v201
  v_mfma_f32_16x16x32_bf16 v[212:215], v[252:255], v[32:35], v[212:215]
  v_cvt_pk_bf16_f32 v97, v202, v203
  v_mfma_f32_16x16x32_bf16 v[204:207], v[244:247], v[152:155], v[204:207]
  ds_read_b128 v[244:247], v2 offset:15360
  v_mfma_f32_16x16x32_bf16 v[204:207], v[248:251], v[36:39], v[204:207]
  ds_read_b128 v[248:251], v2 offset:16384
  v_mfma_f32_16x16x32_bf16 v[204:207], v[252:255], v[40:43], v[204:207]
  ds_read_b128 v[252:255], v2 offset:17408
  v_mfma_f32_16x16x32_bf16 v[184:187], v[216:219], v[140:143], 0
  v_mul_f32 v212, v212, v23
  v_mul_f32 v213, v213, v23
  v_mfma_f32_16x16x32_bf16 v[184:187], v[220:223], v[144:147], v[184:187]
  v_mul_f32 v214, v214, v23
  s_waitcnt lgkmcnt(4)
  v_mfma_f32_16x16x32_bf16 v[184:187], v[224:227], v[148:151], v[184:187]
  v_mul_f32 v215, v215, v23
  v_cvt_pk_bf16_f32 v102, v212, v213
  v_mfma_f32_16x16x32_bf16 v[192:195], v[216:219], v[156:159], 0
  ds_read_b128 v[216:219], v2 offset:18432
  v_cvt_pk_bf16_f32 v103, v214, v215
  v_mfma_f32_16x16x32_bf16 v[192:195], v[220:223], v[160:163], v[192:195]
  buffer_store_dwordx4 v[100:103], v6, s[16:19], 0 offen offset:192 nt sc1
  v_mul_f32 v204, v204, v22
  v_mfma_f32_16x16x32_bf16 v[192:195], v[224:227], v[164:167], v[192:195]
  ds_read_b128 v[220:223], v2 offset:19456
  v_mul_f32 v205, v205, v22
  v_mfma_f32_16x16x32_bf16 v[192:195], v[228:231], v[24:27], v[192:195]
  ds_read_b128 v[224:227], v2 offset:20480
  v_mul_f32 v206, v206, v22
  v_mfma_f32_16x16x32_bf16 v[192:195], v[232:235], v[28:31], v[192:195]
  v_mul_f32 v207, v207, v22
  v_cvt_pk_bf16_f32 v98, v204, v205
  v_mfma_f32_16x16x32_bf16 v[192:195], v[236:239], v[32:35], v[192:195]
  v_cvt_pk_bf16_f32 v99, v206, v207
  v_mfma_f32_16x16x32_bf16 v[184:187], v[228:231], v[152:155], v[184:187]
  buffer_store_dwordx4 v[96:99], v5, s[16:19], 0 offen offset:192 nt sc1
  v_mfma_f32_16x16x32_bf16 v[184:187], v[232:235], v[36:39], v[184:187]
  ds_read_b128 v[228:231], v2 offset:21504
  ds_read_b128 v[232:235], v2 offset:22528
  v_mfma_f32_16x16x32_bf16 v[184:187], v[236:239], v[40:43], v[184:187]
  ds_read_b128 v[236:239], v2 offset:23552
  s_waitcnt lgkmcnt(6)
  v_mfma_f32_16x16x32_bf16 v[188:191], v[240:243], v[140:143], 0
  v_mul_f32 v192, v192, v23
  v_mul_f32 v193, v193, v23
  v_mfma_f32_16x16x32_bf16 v[188:191], v[244:247], v[144:147], v[188:191]
  v_mul_f32 v194, v194, v23
  v_mul_f32 v195, v195, v23
  v_mfma_f32_16x16x32_bf16 v[188:191], v[248:251], v[148:151], v[188:191]
  v_cvt_pk_bf16_f32 v92, v192, v193
  v_cvt_pk_bf16_f32 v93, v194, v195
  v_mfma_f32_16x16x32_bf16 v[196:199], v[240:243], v[156:159], 0
  ds_read_b128 v[240:243], v2 offset:24576
  v_mul_f32 v184, v184, v22
  v_mfma_f32_16x16x32_bf16 v[196:199], v[244:247], v[160:163], v[196:199]
  ds_read_b128 v[244:247], v2 offset:25600
  v_mul_f32 v185, v185, v22
  v_mfma_f32_16x16x32_bf16 v[196:199], v[248:251], v[164:167], v[196:199]
  ds_read_b128 v[248:251], v2 offset:26624
  v_mul_f32 v186, v186, v22
  v_mfma_f32_16x16x32_bf16 v[196:199], v[252:255], v[24:27], v[196:199]
  v_mul_f32 v187, v187, v22
  s_waitcnt lgkmcnt(5)
  v_mfma_f32_16x16x32_bf16 v[196:199], v[216:219], v[28:31], v[196:199]
  v_cvt_pk_bf16_f32 v88, v184, v185
  v_cvt_pk_bf16_f32 v89, v186, v187
  v_mfma_f32_16x16x32_bf16 v[196:199], v[220:223], v[32:35], v[196:199]
  v_mfma_f32_16x16x32_bf16 v[188:191], v[252:255], v[152:155], v[188:191]
  ds_read_b128 v[252:255], v2 offset:27648
  v_mfma_f32_16x16x32_bf16 v[188:191], v[216:219], v[36:39], v[188:191]
  ds_read_b128 v[216:219], v2 offset:28672
  v_mfma_f32_16x16x32_bf16 v[188:191], v[220:223], v[40:43], v[188:191]
  ds_read_b128 v[220:223], v2 offset:29696
  s_waitcnt vmcnt(8)
  v_mfma_f32_16x16x32_bf16 v[200:203], v[224:227], v[140:143], 0
  v_mul_f32 v196, v196, v23
  v_mul_f32 v197, v197, v23
  v_mfma_f32_16x16x32_bf16 v[200:203], v[228:231], v[144:147], v[200:203]
  v_mul_f32 v198, v198, v23
  s_waitcnt lgkmcnt(4)
  v_mfma_f32_16x16x32_bf16 v[200:203], v[232:235], v[148:151], v[200:203]
  v_mul_f32 v199, v199, v23
  v_cvt_pk_bf16_f32 v94, v196, v197
  v_mfma_f32_16x16x32_bf16 v[208:211], v[224:227], v[156:159], 0
  v_cvt_pk_bf16_f32 v95, v198, v199
  v_mul_f32 v188, v188, v22
  v_mfma_f32_16x16x32_bf16 v[208:211], v[228:231], v[160:163], v[208:211]
  buffer_store_dwordx4 v[92:95], v6, s[16:19], 0 offen offset:256 nt sc1
  v_mul_f32 v189, v189, v22
  v_mfma_f32_16x16x32_bf16 v[208:211], v[232:235], v[164:167], v[208:211]
  v_mul_f32 v190, v190, v22
  v_mul_f32 v191, v191, v22
  v_mfma_f32_16x16x32_bf16 v[208:211], v[236:239], v[24:27], v[208:211]
  v_cvt_pk_bf16_f32 v90, v188, v189
  v_cvt_pk_bf16_f32 v91, v190, v191
  v_mfma_f32_16x16x32_bf16 v[208:211], v[240:243], v[28:31], v[208:211]
  buffer_store_dwordx4 v[88:91], v5, s[16:19], 0 offen offset:256 nt sc1
  v_mfma_f32_16x16x32_bf16 v[208:211], v[244:247], v[32:35], v[208:211]
  v_mfma_f32_16x16x32_bf16 v[200:203], v[236:239], v[152:155], v[200:203]
  v_mfma_f32_16x16x32_bf16 v[200:203], v[240:243], v[36:39], v[200:203]
  v_mfma_f32_16x16x32_bf16 v[200:203], v[244:247], v[40:43], v[200:203]
  s_waitcnt lgkmcnt(3)
  v_mfma_f32_16x16x32_bf16 v[204:207], v[248:251], v[140:143], 0
  s_waitcnt lgkmcnt(2)
  v_mfma_f32_16x16x32_bf16 v[204:207], v[252:255], v[144:147], v[204:207]
  s_waitcnt lgkmcnt(1)
  v_mfma_f32_16x16x32_bf16 v[204:207], v[216:219], v[148:151], v[204:207]
  v_mul_f32 v208, v208, v23
  v_mul_f32 v209, v209, v23
  v_mfma_f32_16x16x32_bf16 v[212:215], v[248:251], v[156:159], 0
  v_mul_f32 v210, v210, v23
  v_mul_f32 v211, v211, v23
  v_mfma_f32_16x16x32_bf16 v[212:215], v[252:255], v[160:163], v[212:215]
  v_cvt_pk_bf16_f32 v100, v208, v209
  v_cvt_pk_bf16_f32 v101, v210, v211
  v_mfma_f32_16x16x32_bf16 v[212:215], v[216:219], v[164:167], v[212:215]
  v_mul_f32 v200, v200, v22
  s_waitcnt lgkmcnt(0)
  v_mfma_f32_16x16x32_bf16 v[212:215], v[220:223], v[24:27], v[212:215]
  v_mul_f32 v201, v201, v22
  v_mfma_f32_16x16x32_bf16 v[212:215], v[104:107], v[28:31], v[212:215]
  v_mul_f32 v202, v202, v22
  v_mfma_f32_16x16x32_bf16 v[212:215], v[108:111], v[32:35], v[212:215]
  v_mul_f32 v203, v203, v22
  v_cvt_pk_bf16_f32 v96, v200, v201
  v_mfma_f32_16x16x32_bf16 v[204:207], v[220:223], v[152:155], v[204:207]
  v_cvt_pk_bf16_f32 v97, v202, v203
  v_mfma_f32_16x16x32_bf16 v[204:207], v[104:107], v[36:39], v[204:207]
  v_mfma_f32_16x16x32_bf16 v[204:207], v[108:111], v[40:43], v[204:207]
  s_nop 1
  v_mul_f32 v212, v212, v23
  v_mul_f32 v213, v213, v23
  v_mul_f32 v214, v214, v23
  v_mul_f32 v215, v215, v23
  v_cvt_pk_bf16_f32 v102, v212, v213
  v_cvt_pk_bf16_f32 v103, v214, v215
  buffer_store_dwordx4 v[100:103], v6, s[16:19], 0 offen offset:320 nt sc1
  v_mul_f32 v204, v204, v22
  v_mul_f32 v205, v205, v22
  v_mul_f32 v206, v206, v22
  v_mul_f32 v207, v207, v22
  v_cvt_pk_bf16_f32 v98, v204, v205
  v_cvt_pk_bf16_f32 v99, v206, v207
  buffer_store_dwordx4 v[96:99], v5, s[16:19], 0 offen offset:320 nt sc1
MK_fin:
MK_done:
  s_endpgm
MK_single:
  ds_read_b128 v[216:219], v2 offset:35840
  ds_read_b128 v[220:223], v2 offset:34816
  ds_read_b128 v[224:227], v2 offset:33792
  ds_read_b128 v[228:231], v2 offset:32768
  ds_read_b128 v[232:235], v2 offset:31744
  ds_read_b128 v[236:239], v2 offset:30720
  ds_read_b128 v[240:243], v2 offset:29696
  ds_read_b128 v[244:247], v2 offset:28672
  ds_read_b128 v[248:251], v2 offset:27648
  ds_read_b128 v[252:255], v2 offset:26624
  s_cmp_lg_u32 s3, 0
  s_cbranch_scc1 MK_np4
  s_waitcnt vmcnt(0)
MK_np4:
  s_waitcnt vmcnt(1)
  s_setprio 1
BODYS:
  s_waitcnt lgkmcnt(6)
  v_mfma_f32_16x16x32_bf16 v[192:195], v[216:219], v[160:163], 0
  ds_read_b128 v[216:219], v2 offset:25600
  v_mov_b32 v64, 0xff800000
  v_mfma_f32_16x16x32_bf16 v[192:195], v[220:223], v[164:167], v[192:195]
  ds_read_b128 v[220:223], v2 offset:24576
  v_add_u32 v65, 0, v19
  v_mfma_f32_16x16x32_bf16 v[192:195], v[224:227], v[168:171], v[192:195]
  ds_read_b128 v[224:227], v2 offset:23552
  v_add_u32 v66, 1, v19
  v_mfma_f32_16x16x32_bf16 v[192:195], v[228:231], v[172:175], v[192:195]
  ds_read_b128 v[228:231], v2 offset:22528
  s_waitcnt lgkmcnt(6)
  v_mfma_f32_16x16x32_bf16 v[192:195], v[232:235], v[176:179], v[192:195]
  ds_read_b128 v[232:235], v2 offset:21504
  v_add_u32 v67, 2, v19
  v_mfma_f32_16x16x32_bf16 v[192:195], v[236:239], v[180:183], v[192:195]
  ds_read_b128 v[236:239], v2 offset:20480
  v_add_u32 v68, 3, v19
  v_mfma_f32_16x16x32_bf16 v[196:199], v[240:243], v[160:163], 0
  ds_read_b128 v[240:243], v2 offset:19456
  v_cmp_gt_u32 s[48:49], 7, v65
  v_mfma_f32_16x16x32_bf16 v[196:199], v[244:247], v[164:167], v[196:199]
  ds_read_b128 v[244:247], v2 offset:18432
  s_waitcnt lgkmcnt(6)
  v_mfma_f32_16x16x32_bf16 v[196:199], v[248:251], v[168:171], v[196:199]
  ds_read_b128 v[248:251], v2 offset:17408
  v_cmp_gt_u32 s[50:51], 7, v66
  v_mfma_f32_16x16x32_bf16 v[196:199], v[252:255], v[172:175], v[196:199]
  ds_read_b128 v[252:255], v2 offset:16384
  v_cmp_gt_u32 s[52:53], 7, v67
  v_mfma_f32_16x16x32_bf16 v[196:199], v[216:219], v[176:179], v[196:199]
  ds_read_b128 v[216:219], v2 offset:15360
  v_cmp_gt_u32 s[54:55], 7, v68
  v_mfma_f32_16x16x32_bf16 v[196:199], v[220:223], v[180:183], v[196:199]
  ds_read_b128 v[220:223], v2 offset:14336
  s_waitcnt lgkmcnt(6)
  v_mfma_f32_16x16x32_bf16 v[208:211], v[224:227], v[160:163], 0
  ds_read_b128 v[224:227], v2 offset:13312
  s_add_i32 s46, s34, 8
  v_mfma_f32_16x16x32_bf16 v[208:211], v[228:231], v[164:167], v[208:211]
  ds_read_b128 v[228:231], v2 offset:12288
  v_sub_u32 v69, s46, v22
  v_mfma_f32_16x16x32_bf16 v[208:211], v[232:235], v[168:171], v[208:211]
  ds_read_b128 v[232:235], v2 offset:11264
  s_add_i32 s46, s34, 1
  v_mfma_f32_16x16x32_bf16 v[208:211], v[236:239], v[172:175], v[208:211]
  ds_read_b128 v[236:239], v2 offset:10240
  s_waitcnt lgkmcnt(6)
  v_mfma_f32_16x16x32_bf16 v[208:211], v[240:243], v[176:179], v[208:211]
  ds_read_b128 v[240:243], v2 offset:9216
  v_sub_u32 v70, s46, v22
  v_mfma_f32_16x16x32_bf16 v[208:211], v[244:247], v[180:183], v[208:211]
  ds_read_b128 v[244:247], v2 offset:8192
  v_cndmask_b32 v60, v64, 0, s[48:49]
  v_mfma_f32_16x16x32_bf16 v[212:215], v[248:251], v[160:163], 0
  ds_read_b128 v[248:251], v2 offset:7168
  v_cndmask_b32 v61, v64, 0, s[50:51]
  v_mfma_f32_16x16x32_bf16 v[212:215], v[252:255], v[164:167], v[212:215]
  ds_read_b128 v[252:255], v2 offset:6144
  s_waitcnt lgkmcnt(6)
  v_mfma_f32_16x16x32_bf16 v[212:215], v[216:219], v[168:171], v[212:215]
  ds_read_b128 v[216:219], v2 offset:5120
  v_cndmask_b32 v62, v64, 0, s[52:53]
  v_mfma_f32_16x16x32_bf16 v[212:215], v[220:223], v[172:175], v[212:215]
  ds_read_b128 v[220:223], v2 offset:4096
  v_cndmask_b32 v63, v64, 0, s[54:55]
  v_mfma_f32_16x16x32_bf16 v[212:215], v[224:227], v[176:179], v[212:215]
  ds_read_b128 v[224:227], v2 offset:3072
  v_cmp_gt_u32 s[46:47], 7, v69
  v_mfma_f32_16x16x32_bf16 v[212:215], v[228:231], v[180:183], v[212:215]
  ds_read_b128 v[228:231], v2 offset:2048
  v_cmp_gt_u32 s[48:49], 7, v70
  v_cndmask_b32 v84, v64, v60, s[46:47]
  v_cndmask_b32 v85, v64, v61, s[46:47]
  v_cndmask_b32 v86, v64, v62, s[46:47]
  v_cndmask_b32 v87, v64, v63, s[46:47]
  v_cndmask_b32 v56, v64, v60, s[48:49]
  v_cndmask_b32 v57, v64, v61, s[48:49]
  v_cndmask_b32 v58, v64, v62, s[48:49]
  v_cndmask_b32 v59, v64, v63, s[48:49]
  v_mul_f32 v192, s93, v192
  v_mul_f32 v193, s93, v193
  v_mul_f32 v194, s93, v194
  v_mul_f32 v195, s93, v195
  v_cvt_pk_bf16_f32 v112, v192, v193
  v_cvt_pk_bf16_f32 v113, v194, v195
  v_mul_f32 v196, s93, v196
  v_mul_f32 v197, s93, v197
  v_mul_f32 v198, s93, v198
  v_mul_f32 v199, s93, v199
  v_cvt_pk_bf16_f32 v114, v196, v197
  v_cvt_pk_bf16_f32 v115, v198, v199
  s_waitcnt lgkmcnt(6)
  v_mfma_f32_16x16x32_bf16 v[192:195], v[232:235], v[160:163], 0
  ds_read_b128 v[232:235], v2 offset:1024
  v_mul_f32 v208, s93, v208
  v_mfma_f32_16x16x32_bf16 v[192:195], v[236:239], v[164:167], v[192:195]
  ds_read_b128 v[236:239], v2 offset:0
  v_mul_f32 v209, s93, v209
  v_mfma_f32_16x16x32_bf16 v[192:195], v[240:243], v[168:171], v[192:195]
  ds_read_b128 v[240:243], v1 offset:35840
  v_mul_f32 v210, s93, v210
  v_mfma_f32_16x16x32_bf16 v[192:195], v[244:247], v[172:175], v[192:195]
  ds_read_b128 v[244:247], v1 offset:34816
  s_waitcnt lgkmcnt(6)
  v_mfma_f32_16x16x32_bf16 v[192:195], v[248:251], v[176:179], v[192:195]
  ds_read_b128 v[248:251], v1 offset:33792
  v_mul_f32 v211, s93, v211
  v_mfma_f32_16x16x32_bf16 v[192:195], v[252:255], v[180:183], v[192:195]
  ds_read_b128 v[252:255], v1 offset:32768
  v_cvt_pk_bf16_f32 v116, v208, v209
  v_mfma_f32_16x16x32_bf16 v[196:199], v[216:219], v[160:163], 0
  ds_read_b128 v[216:219], v1 offset:31744
  v_cvt_pk_bf16_f32 v117, v210, v211
  s_cmp_eq_u32 s3, 0
  s_cbranch_scc1 MK_np5
  s_waitcnt vmcnt(0)
  v_mov_b32 v23, 1
  s_mov_b64 exec, 1
  s_lshl_b32 s100, s26, 7
  buffer_atomic_add v23, off, s[8:11], s100 sc1
  s_mov_b64 exec, -1
  s_nop 3
MK_np5:
  v_mfma_f32_16x16x32_bf16 v[196:199], v[220:223], v[164:167], v[196:199]
  ds_read_b128 v[220:223], v1 offset:30720
  s_waitcnt lgkmcnt(6)
  v_mfma_f32_16x16x32_bf16 v[196:199], v[224:227], v[168:171], v[196:199]
  ds_read_b128 v[224:227], v1 offset:29696
  v_mul_f32 v212, s93, v212
  v_mfma_f32_16x16x32_bf16 v[196:199], v[228:231], v[172:175], v[196:199]
  ds_read_b128 v[228:231], v1 offset:28672
  v_mul_f32 v213, s93, v213
  v_mfma_f32_16x16x32_bf16 v[196:199], v[232:235], v[176:179], v[196:199]
  ds_read_b128 v[232:235], v1 offset:27648
  v_mul_f32 v214, s93, v214
  v_mfma_f32_16x16x32_bf16 v[196:199], v[236:239], v[180:183], v[196:199]
  ds_read_b128 v[236:239], v1 offset:26624
  v_mul_f32 v215, s93, v215
  v_cvt_pk_bf16_f32 v118, v212, v213
  v_cvt_pk_bf16_f32 v119, v214, v215
  s_waitcnt lgkmcnt(6)
  v_mfma_f32_16x16x32_bf16 v[208:211], v[240:243], v[160:163], 0
  ds_read_b128 v[240:243], v1 offset:25600
  v_mul_f32 v192, s93, v192
  v_mfma_f32_16x16x32_bf16 v[208:211], v[244:247], v[164:167], v[208:211]
  ds_read_b128 v[244:247], v1 offset:24576
  v_mul_f32 v193, s93, v193
  v_mfma_f32_16x16x32_bf16 v[208:211], v[248:251], v[168:171], v[208:211]
  ds_read_b128 v[248:251], v1 offset:23552
  v_mul_f32 v194, s93, v194
  v_mfma_f32_16x16x32_bf16 v[208:211], v[252:255], v[172:175], v[208:211]
  ds_read_b128 v[252:255], v1 offset:22528
  s_waitcnt lgkmcnt(6)
  v_mfma_f32_16x16x32_bf16 v[208:211], v[216:219], v[176:179], v[208:211]
  ds_read_b128 v[216:219], v1 offset:21504
  v_mul_f32 v195, s93, v195
  v_mfma_f32_16x16x32_bf16 v[208:211], v[220:223], v[180:183], v[208:211]
  ds_read_b128 v[220:223], v1 offset:20480
  v_cvt_pk_bf16_f32 v120, v192, v193
  v_mfma_f32_16x16x32_bf16 v[212:215], v[224:227], v[160:163], 0
  ds_read_b128 v[224:227], v1 offset:19456
  v_cvt_pk_bf16_f32 v121, v194, v195
  v_mfma_f32_16x16x32_bf16 v[212:215], v[228:231], v[164:167], v[212:215]
  ds_read_b128 v[228:231], v1 offset:18432
  s_waitcnt lgkmcnt(6)
  v_mfma_f32_16x16x32_bf16 v[212:215], v[232:235], v[168:171], v[212:215]
  ds_read_b128 v[232:235], v1 offset:17408
  v_mul_f32 v196, s93, v196
  v_mfma_f32_16x16x32_bf16 v[212:215], v[236:239], v[172:175], v[212:215]
  ds_read_b128 v[236:239], v1 offset:16384
  v_mul_f32 v197, s93, v197
  v_mfma_f32_16x16x32_bf16 v[212:215], v[240:243], v[176:179], v[212:215]
  ds_read_b128 v[240:243], v1 offset:15360
  v_mul_f32 v198, s93, v198
  v_mfma_f32_16x16x32_bf16 v[212:215], v[244:247], v[180:183], v[212:215]
  ds_read_b128 v[244:247], v1 offset:14336
  v_mul_f32 v199, s93, v199
  v_cvt_pk_bf16_f32 v122, v196, v197
  v_cvt_pk_bf16_f32 v123, v198, v199
  s_waitcnt lgkmcnt(6)
  v_mfma_f32_16x16x32_bf16 v[192:195], v[248:251], v[160:163], 0
  ds_read_b128 v[248:251], v1 offset:13312
  v_mul_f32 v208, s93, v208
  v_mfma_f32_16x16x32_bf16 v[192:195], v[252:255], v[164:167], v[192:195]
  ds_read_b128 v[252:255], v1 offset:12288
  v_mul_f32 v209, s93, v209
  v_mfma_f32_16x16x32_bf16 v[192:195], v[216:219], v[168:171], v[192:195]
  ds_read_b128 v[216:219], v1 offset:11264
  v_mul_f32 v210, s93, v210
  v_mfma_f32_16x16x32_bf16 v[192:195], v[220:223], v[172:175], v[192:195]
  ds_read_b128 v[220:223], v1 offset:10240
  s_waitcnt lgkmcnt(6)
  v_mfma_f32_16x16x32_bf16 v[192:195], v[224:227], v[176:179], v[192:195]
  ds_read_b128 v[224:227], v1 offset:9216
  v_mul_f32 v211, s93, v211
  v_mfma_f32_16x16x32_bf16 v[192:195], v[228:231], v[180:183], v[192:195]
  ds_read_b128 v[228:231], v1 offset:8192
  v_cvt_pk_bf16_f32 v124, v208, v209
  v_mfma_f32_16x16x32_bf16 v[196:199], v[232:235], v[160:163], 0
  ds_read_b128 v[232:235], v1 offset:7168
  v_cvt_pk_bf16_f32 v125, v210, v211
  v_mfma_f32_16x16x32_bf16 v[196:199], v[236:239], v[164:167], v[196:199]
  ds_read_b128 v[236:239], v1 offset:6144
  s_waitcnt lgkmcnt(6)
  v_mfma_f32_16x16x32_bf16 v[196:199], v[240:243], v[168:171], v[196:199]
  ds_read_b128 v[240:243], v1 offset:5120
  v_mul_f32 v212, s93, v212
  v_mfma_f32_16x16x32_bf16 v[196:199], v[244:247], v[172:175], v[196:199]
  ds_read_b128 v[244:247], v1 offset:4096
  v_mul_f32 v213, s93, v213
  v_mfma_f32_16x16x32_bf16 v[196:199], v[248:251], v[176:179], v[196:199]
  ds_read_b128 v[248:251], v1 offset:3072
  v_mul_f32 v214, s93, v214
  v_mfma_f32_16x16x32_bf16 v[196:199], v[252:255], v[180:183], v[196:199]
  ds_read_b128 v[252:255], v1 offset:2048
  v_mul_f32 v215, s93, v215
  v_cvt_pk_bf16_f32 v126, v212, v213
  v_cvt_pk_bf16_f32 v127, v214, v215
  s_waitcnt lgkmcnt(6)
  v_mfma_f32_16x16x32_bf16 v[208:211], v[216:219], v[160:163], 0
  ds_read_b128 v[216:219], v1 offset:1024
  v_mul_f32 v192, s93, v192
  v_mfma_f32_16x16x32_bf16 v[208:211], v[220:223], v[164:167], v[208:211]
  ds_read_b128 v[220:223], v1 offset:0
  v_mul_f32 v193, s93, v193
  v_mfma_f32_16x16x32_bf16 v[208:211], v[224:227], v[168:171], v[208:211]
  v_mul_f32 v194, s93, v194
  v_mul_f32 v195, s93, v195
  v_mfma_f32_16x16x32_bf16 v[208:211], v[228:231], v[172:175], v[208:211]
  v_cvt_pk_bf16_f32 v128, v192, v193
  s_barrier
  s_waitcnt lgkmcnt(4)
  v_mfma_f32_16x16x32_bf16 v[208:211], v[232:235], v[176:179], v[208:211]
  v_cvt_pk_bf16_f32 v129, v194, v195
  v_mul_f32 v196, s93, v196
  v_mfma_f32_16x16x32_bf16 v[208:211], v[236:239], v[180:183], v[208:211]
  v_mul_f32 v197, s93, v197
  v_mul_f32 v198, s93, v198
  v_mfma_f32_16x16x32_bf16 v[212:215], v[240:243], v[160:163], 0
  v_mul_f32 v199, s93, v199
  v_cvt_pk_bf16_f32 v130, v196, v197
  v_mfma_f32_16x16x32_bf16 v[212:215], v[244:247], v[164:167], v[212:215]
  v_cvt_pk_bf16_f32 v131, v198, v199
  s_waitcnt lgkmcnt(3)
  v_mfma_f32_16x16x32_bf16 v[212:215], v[248:251], v[168:171], v[212:215]
  v_mul_f32 v208, s93, v208
  s_waitcnt lgkmcnt(2)
  v_mfma_f32_16x16x32_bf16 v[212:215], v[252:255], v[172:175], v[212:215]
  v_mul_f32 v209, s93, v209
  s_waitcnt lgkmcnt(1)
  v_mfma_f32_16x16x32_bf16 v[212:215], v[216:219], v[176:179], v[212:215]
  v_mul_f32 v210, s93, v210
  s_waitcnt lgkmcnt(0)
  v_mfma_f32_16x16x32_bf16 v[212:215], v[220:223], v[180:183], v[212:215]
  v_mul_f32 v211, s93, v211
  s_setprio 0
  s_mul_i32 s100, s32, 7
  s_add_i32 s100, s100, s31
  s_add_u32 m0, s38, 107520
  s_nop 0
  buffer_load_dwordx4 v13, s[12:15], s100 offen lds
  s_add_u32 m0, s38, 108544
  s_nop 0
  buffer_load_dwordx4 v14, s[12:15], s100 offen lds
  s_add_u32 m0, s38, 109568
  s_nop 0
  buffer_load_dwordx4 v3, s[12:15], s100 offen lds
  s_add_u32 m0, s39, 107520
  s_nop 0
  buffer_load_dwordx4 v4, s[12:15], s100 offen lds
  s_mul_i32 s100, s32, 6
  s_add_i32 s100, s100, s31
  s_add_u32 m0, s38, 92160
  s_nop 0
  buffer_load_dwordx4 v13, s[12:15], s100 offen lds
  s_add_u32 m0, s38, 93184
  s_nop 0
  buffer_load_dwordx4 v14, s[12:15], s100 offen lds
  s_add_u32 m0, s38, 94208
  s_nop 0
  buffer_load_dwordx4 v3, s[12:15], s100 offen lds
  s_add_u32 m0, s39, 92160
  s_nop 0
  buffer_load_dwordx4 v4, s[12:15], s100 offen lds
  s_mul_i32 s100, s32, 5
  s_add_i32 s100, s100, s31
  s_add_u32 m0, s38, 76800
  s_nop 0
  buffer_load_dwordx4 v13, s[12:15], s100 offen lds
  s_add_u32 m0, s38, 77824
  s_nop 0
  buffer_load_dwordx4 v14, s[12:15], s100 offen lds
  s_add_u32 m0, s38, 78848
  s_nop 0
  buffer_load_dwordx4 v3, s[12:15], s100 offen lds
  s_add_u32 m0, s39, 76800
  s_nop 0
  buffer_load_dwordx4 v4, s[12:15], s100 offen lds
  s_barrier
  s_mul_i32 s100, s32, 4
  s_add_i32 s100, s100, s31
  s_add_u32 m0, s38, 61440
  s_nop 0
  buffer_load_dwordx4 v13, s[12:15], s100 offen lds
  s_add_u32 m0, s38, 62464
  s_nop 0
  buffer_load_dwordx4 v14, s[12:15], s100 offen lds
  s_add_u32 m0, s38, 63488
  s_nop 0
  buffer_load_dwordx4 v3, s[12:15], s100 offen lds
  s_add_u32 m0, s39, 61440
  s_nop 0
  buffer_load_dwordx4 v4, s[12:15], s100 offen lds
  s_mul_i32 s100, s32, 3
  s_add_i32 s100, s100, s31
  s_add_u32 m0, s38, 46080
  s_nop 0
  buffer_load_dwordx4 v13, s[12:15], s100 offen lds
  s_add_u32 m0, s38, 47104
  s_nop 0
  buffer_load_dwordx4 v14, s[12:15], s100 offen lds
  s_add_u32 m0, s38, 48128
  s_nop 0
  buffer_load_dwordx4 v3, s[12:15], s100 offen lds
  s_add_u32 m0, s39, 46080
  s_nop 0
  buffer_load_dwordx4 v4, s[12:15], s100 offen lds
  s_mul_i32 s100, s32, 2
  s_add_i32 s100, s100, s31
  s_add_u32 m0, s38, 30720
  s_nop 0
  buffer_load_dwordx4 v13, s[12:15], s100 offen lds
  s_add_u32 m0, s38, 31744
  s_nop 0
  buffer_load_dwordx4 v14, s[12:15], s100 offen lds
  s_add_u32 m0, s38, 32768
  s_nop 0
  buffer_load_dwordx4 v3, s[12:15], s100 offen lds
  s_add_u32 m0, s39, 30720
  s_nop 0
  buffer_load_dwordx4 v4, s[12:15], s100 offen lds
  s_waitcnt vmcnt(12)
  s_barrier
  s_max_u32 s100, s33, 1
  s_mul_i32 s100, s100, s32
  s_add_i32 s100, s100, s31
  s_add_u32 m0, s38, 15360
  s_nop 0
  buffer_load_dwordx4 v13, s[12:15], s100 offen lds
  s_add_u32 m0, s38, 16384
  s_nop 0
  buffer_load_dwordx4 v14, s[12:15], s100 offen lds
  s_add_u32 m0, s38, 17408
  s_nop 0
  buffer_load_dwordx4 v3, s[12:15], s100 offen lds
  s_add_u32 m0, s39, 15360
  s_nop 0
  buffer_load_dwordx4 v4, s[12:15], s100 offen lds
  s_max_u32 s100, s33, 0
  s_mul_i32 s100, s100, s32
  s_add_i32 s100, s100, s31
  s_add_u32 m0, s38, 0
  s_nop 0
  buffer_load_dwordx4 v13, s[12:15], s100 offen lds
  s_add_u32 m0, s38, 1024
  s_nop 0
  buffer_load_dwordx4 v14, s[12:15], s100 offen lds
  s_add_u32 m0, s38, 2048
  s_nop 0
  buffer_load_dwordx4 v3, s[12:15], s100 offen lds
  s_add_u32 m0, s39, 0
  s_nop 0
  buffer_load_dwordx4 v4, s[12:15], s100 offen lds
  s_waitcnt vmcnt(8)
  s_barrier
  ds_read_b128 v[224:227], v7 offset:61440
  ds_read_b128 v[228:231], v8 offset:61440
  ds_read_b128 v[232:235], v7 offset:61568
  ds_read_b128 v[236:239], v8 offset:61568
  ds_read_b128 v[240:243], v7 offset:61696
  ds_read_b128 v[244:247], v8 offset:61696
  ds_read_b128 v[248:251], v7 offset:53760
  ds_read_b128 v[252:255], v8 offset:53760
  ds_read_b128 v[216:219], v7 offset:53888
  ds_read_b128 v[220:223], v8 offset:53888
  s_waitcnt lgkmcnt(6)
  v_mfma_f32_16x16x32_bf16 v[84:87], v[224:227], v[112:115], v[84:87]
  ds_read_b128 v[224:227], v7 offset:54016
  v_cvt_pk_bf16_f32 v132, v208, v209
  v_mfma_f32_16x16x32_bf16 v[84:87], v[228:231], v[116:119], v[84:87]
  ds_read_b128 v[228:231], v8 offset:54016
  v_cvt_pk_bf16_f32 v133, v210, v211
  v_mfma_f32_16x16x32_bf16 v[84:87], v[232:235], v[120:123], v[84:87]
  ds_read_b128 v[232:235], v7 offset:46080
  v_mul_f32 v212, s93, v212
  v_mfma_f32_16x16x32_bf16 v[84:87], v[236:239], v[124:127], v[84:87]
  ds_read_b128 v[236:239], v8 offset:46080
  s_waitcnt lgkmcnt(6)
  v_mfma_f32_16x16x32_bf16 v[84:87], v[240:243], v[128:131], v[84:87]
  ds_read_b128 v[240:243], v7 offset:46208
  v_mul_f32 v213, s93, v213
  v_mul_f32 v214, s93, v214
  v_mul_f32 v215, s93, v215
  v_cvt_pk_bf16_f32 v134, v212, v213
  v_cvt_pk_bf16_f32 v135, v214, v215
  s_nop 1
  v_mfma_f32_16x16x32_bf16 v[84:87], v[244:247], v[132:135], v[84:87]
  ds_read_b128 v[244:247], v8 offset:46208
  v_add_u32 v2, 102400, v1
  v_mfma_f32_16x16x32_bf16 v[80:83], v[248:251], v[112:115], v[60:63]
  ds_read_b128 v[248:251], v7 offset:46336
  v_mov_b32 v192, 0x3f803f80
  v_mfma_f32_16x16x32_bf16 v[80:83], v[252:255], v[116:119], v[80:83]
  ds_read_b128 v[252:255], v8 offset:46336
  s_waitcnt lgkmcnt(6)
  v_mfma_f32_16x16x32_bf16 v[80:83], v[216:219], v[120:123], v[80:83]
  v_exp_f32 v204, v84
  v_mfma_f32_16x16x32_bf16 v[80:83], v[220:223], v[124:127], v[80:83]
  v_exp_f32 v205, v85
  v_mfma_f32_16x16x32_bf16 v[80:83], v[224:227], v[128:131], v[80:83]
  v_exp_f32 v206, v86
  v_mfma_f32_16x16x32_bf16 v[80:83], v[228:231], v[132:135], v[80:83]
  ds_read_b128 v[216:219], v7 offset:38400
  s_waitcnt vmcnt(0)
  s_barrier
  ds_read_b128 v[220:223], v8 offset:38400
  ds_read_b128 v[224:227], v7 offset:38528
  ds_read_b128 v[228:231], v8 offset:38528
  s_waitcnt lgkmcnt(6)
  v_mfma_f32_16x16x32_bf16 v[76:79], v[232:235], v[112:115], v[60:63]
  v_exp_f32 v207, v87
  v_mfma_f32_16x16x32_bf16 v[76:79], v[236:239], v[116:119], v[76:79]
  ds_read_b128 v[232:235], v7 offset:38656
  ds_read_b128 v[236:239], v8 offset:38656
  v_mfma_f32_16x16x32_bf16 v[76:79], v[240:243], v[120:123], v[76:79]
  ds_read_b128 v[240:243], v7 offset:30720
  v_mov_b32 v193, 0x3f803f80
  v_mfma_f32_16x16x32_bf16 v[76:79], v[244:247], v[124:127], v[76:79]
  ds_read_b128 v[244:247], v8 offset:30720
  s_waitcnt lgkmcnt(6)
  v_mfma_f32_16x16x32_bf16 v[76:79], v[248:251], v[128:131], v[76:79]
  v_exp_f32 v208, v80
  v_mfma_f32_16x16x32_bf16 v[76:79], v[252:255], v[132:135], v[76:79]
  v_exp_f32 v209, v81
  v_mfma_f32_16x16x32_bf16 v[72:75], v[216:219], v[112:115], v[60:63]
  v_exp_f32 v210, v82
  v_mfma_f32_16x16x32_bf16 v[72:75], v[220:223], v[116:119], v[72:75]
  ds_read_b128 v[248:251], v7 offset:30848
  s_waitcnt lgkmcnt(4)
  v_mfma_f32_16x16x32_bf16 v[72:75], v[224:227], v[120:123], v[72:75]
  v_exp_f32 v211, v83
  v_mfma_f32_16x16x32_bf16 v[72:75], v[228:231], v[124:127], v[72:75]
  ds_read_b128 v[252:255], v8 offset:30848
  ds_read_b128 v[216:219], v7 offset:30976
  v_mfma_f32_16x16x32_bf16 v[72:75], v[232:235], v[128:131], v[72:75]
  ds_read_b128 v[220:223], v8 offset:30976
  s_waitcnt lgkmcnt(4)
  v_mfma_f32_16x16x32_bf16 v[72:75], v[236:239], v[132:135], v[72:75]
  ds_read_b128 v[224:227], v7 offset:23040
  ds_read_b128 v[228:231], v8 offset:23040
  v_mfma_f32_16x16x32_bf16 v[68:71], v[240:243], v[112:115], v[60:63]
  ds_read_b128 v[232:235], v7 offset:23168
  ds_read_b128 v[236:239], v8 offset:23168
  v_mov_b32 v194, 0x3f803f80
  v_mfma_f32_16x16x32_bf16 v[68:71], v[244:247], v[116:119], v[68:71]
  ds_read_b128 v[240:243], v7 offset:23296
  v_mov_b32 v195, 0x3f803f80
  s_waitcnt lgkmcnt(5)
  v_mfma_f32_16x16x32_bf16 v[68:71], v[248:251], v[120:123], v[68:71]
  ds_read_b128 v[244:247], v8 offset:23296
  ds_read_b128 v[248:251], v7 offset:15360
  v_cvt_pk_bf16_f32 v166, v204, v205
  v_mfma_f32_16x16x32_bf16 v[68:71], v[252:255], v[124:127], v[68:71]
  v_exp_f32 v212, v76
  v_mfma_f32_16x16x32_bf16 v[68:71], v[216:219], v[128:131], v[68:71]
  v_exp_f32 v213, v77
  v_mfma_f32_16x16x32_bf16 v[68:71], v[220:223], v[132:135], v[68:71]
  ds_read_b128 v[252:255], v8 offset:15360
  v_and_b32 v14, 128, v1
  buffer_load_dword v13, v14, s[8:11], 0 offen
  s_waitcnt lgkmcnt(4)
  v_mfma_f32_16x16x32_bf16 v[64:67], v[224:227], v[112:115], v[60:63]
  v_exp_f32 v214, v78
  v_mfma_f32_16x16x32_bf16 v[64:67], v[228:231], v[116:119], v[64:67]
  v_exp_f32 v215, v79
  v_mfma_f32_16x16x32_bf16 v[64:67], v[232:235], v[120:123], v[64:67]
  ds_read_b128 v[216:219], v7 offset:15488
  ds_read_b128 v[220:223], v8 offset:15488
  v_cvt_pk_bf16_f32 v167, v206, v207
  v_mfma_f32_16x16x32_bf16 v[64:67], v[236:239], v[124:127], v[64:67]
  ds_read_b128 v[224:227], v7 offset:15616
  v_cvt_pk_bf16_f32 v164, v208, v209
  s_waitcnt lgkmcnt(4)
  v_mfma_f32_16x16x32_bf16 v[64:67], v[240:243], v[128:131], v[64:67]
  v_exp_f32 v204, v72
  v_mfma_f32_16x16x32_bf16 v[64:67], v[244:247], v[132:135], v[64:67]
  ds_read_b128 v[228:231], v8 offset:15616
  ds_read_b128 v[232:235], v7 offset:7680
  v_cvt_pk_bf16_f32 v165, v210, v211
  v_mfma_f32_16x16x32_bf16 v[60:63], v[248:251], v[112:115], v[60:63]
  ds_read_b128 v[236:239], v8 offset:7680
  v_cvt_pk_bf16_f32 v162, v212, v213
  s_waitcnt lgkmcnt(4)
  v_mfma_f32_16x16x32_bf16 v[60:63], v[252:255], v[116:119], v[60:63]
  v_exp_f32 v205, v73
  v_mfma_f32_16x16x32_bf16 v[60:63], v[216:219], v[120:123], v[60:63]
  ds_read_b128 v[240:243], v7 offset:7808
  ds_read_b128 v[244:247], v8 offset:7808
  v_cvt_pk_bf16_f32 v163, v214, v215
  v_mfma_f32_16x16x32_bf16 v[60:63], v[220:223], v[124:127], v[60:63]
  ds_read_b128 v[248:251], v7 offset:7936
  v_cvt_pk_bf16_f32 v160, v204, v205
  s_waitcnt lgkmcnt(4)
  v_mfma_f32_16x16x32_bf16 v[60:63], v[224:227], v[128:131], v[60:63]
  v_exp_f32 v206, v74
  v_mfma_f32_16x16x32_bf16 v[60:63], v[228:231], v[132:135], v[60:63]
  ds_read_b128 v[252:255], v8 offset:7936
  ds_read_b64_tr_b16 v[216:217], v9 offset:38400
  v_exp_f32 v207, v75
  s_mov_b32 s53, 0x40000
  s_mov_b32 s46, 72
NPOLL:
  s_waitcnt vmcnt(0)
  v_cmp_le_u32 s[48:49], s46, v13
  s_sub_u32 s53, s53, 1
  s_cbranch_scc1 NPOLLD
  s_cmp_eq_u64 s[48:49], -1
  s_cbranch_scc1 NPOLLD
  buffer_load_dword v13, v14, s[8:11], 0 offen sc1
  s_branch NPOLL
NPOLLD:
  s_add_u32 m0, s40, 0
  s_add_u32 s100, s40, 30720
  buffer_load_dwordx4 v1, s[20:23], s100 offen sc1 lds
  s_add_u32 m0, s40, 2048
  s_add_u32 s100, s40, 32768
  buffer_load_dwordx4 v1, s[20:23], s100 offen sc1 lds
  s_add_u32 m0, s40, 4096
  s_add_u32 s100, s40, 34816
  buffer_load_dwordx4 v1, s[20:23], s100 offen sc1 lds
  s_add_u32 m0, s40, 6144
  s_add_u32 s100, s40, 36864
  buffer_load_dwordx4 v1, s[20:23], s100 offen sc1 lds
  s_add_u32 m0, s40, 8192
  s_add_u32 s100, s40, 38912
  buffer_load_dwordx4 v1, s[20:23], s100 offen sc1 lds
  s_barrier
  s_add_u32 m0, s40, 133120
  s_add_u32 s100, s40, 0
  buffer_load_dwordx4 v1, s[20:23], s100 offen sc1 lds
  s_add_u32 m0, s40, 135168
  s_add_u32 s100, s40, 2048
  buffer_load_dwordx4 v1, s[20:23], s100 offen sc1 lds
  s_add_u32 m0, s40, 137216
  s_add_u32 s100, s40, 4096
  buffer_load_dwordx4 v1, s[20:23], s100 offen sc1 lds
  s_add_u32 m0, s40, 139264
  s_add_u32 s100, s40, 6144
  buffer_load_dwordx4 v1, s[20:23], s100 offen sc1 lds
  s_add_u32 m0, s40, 141312
  s_add_u32 s100, s40, 8192
  buffer_load_dwordx4 v1, s[20:23], s100 offen sc1 lds
  s_add_u32 m0, s40, 143360
  s_add_u32 s100, s40, 10240
  buffer_load_dwordx4 v1, s[20:23], s100 offen sc1 lds
  s_add_u32 m0, s40, 145408
  s_add_u32 s100, s40, 12288
  buffer_load_dwordx4 v1, s[20:23], s100 offen sc1 lds
  s_add_u32 m0, s40, 147456
  s_add_u32 s100, s40, 14336
  buffer_load_dwordx4 v1, s[20:23], s100 offen sc1 lds
  s_add_u32 m0, s40, 149504
  s_add_u32 s100, s40, 16384
  buffer_load_dwordx4 v1, s[20:23], s100 offen sc1 lds
  s_add_u32 m0, s40, 151552
  s_add_u32 s100, s40, 18432
  buffer_load_dwordx4 v1, s[20:23], s100 offen sc1 lds
  s_add_u32 m0, s40, 153600
  s_add_u32 s100, s40, 20480
  buffer_load_dwordx4 v1, s[20:23], s100 offen sc1 lds
  s_add_u32 m0, s40, 155648
  s_add_u32 s100, s40, 22528
  buffer_load_dwordx4 v1, s[20:23], s100 offen sc1 lds
  s_add_u32 m0, s40, 157696
  s_add_u32 s100, s40, 24576
  buffer_load_dwordx4 v1, s[20:23], s100 offen sc1 lds
  s_add_u32 m0, s40, 159744
  s_add_u32 s100, s40, 26624
  buffer_load_dwordx4 v1, s[20:23], s100 offen sc1 lds
  s_add_u32 m0, s40, 161792
  s_add_u32 s100, s40, 28672
  buffer_load_dwordx4 v1, s[20:23], s100 offen sc1 lds
  v_mfma_f32_16x16x32_bf16 v[56:59], v[232:235], v[112:115], v[56:59]
  ds_read_b64_tr_b16 v[218:219], v9 offset:46080
  v_cvt_pk_bf16_f32 v161, v206, v207
  s_waitcnt lgkmcnt(4)
  v_mfma_f32_16x16x32_bf16 v[56:59], v[236:239], v[116:119], v[56:59]
  ds_read_b64_tr_b16 v[220:221], v10 offset:38400
  ds_read_b64_tr_b16 v[222:223], v10 offset:46080
  v_exp_f32 v208, v68
  v_mfma_f32_16x16x32_bf16 v[56:59], v[240:243], v[120:123], v[56:59]
  ds_read_b64_tr_b16 v[224:225], v11 offset:38400
  ds_read_b64_tr_b16 v[226:227], v11 offset:46080
  v_exp_f32 v209, v69
  v_mfma_f32_16x16x32_bf16 v[56:59], v[244:247], v[124:127], v[56:59]
  ds_read_b64_tr_b16 v[228:229], v12 offset:38400
  ds_read_b64_tr_b16 v[230:231], v12 offset:46080
  v_cvt_pk_bf16_f32 v158, v208, v209
  s_waitcnt lgkmcnt(6)
  v_mfma_f32_16x16x32_bf16 v[56:59], v[248:251], v[128:131], v[56:59]
  ds_read_b64_tr_b16 v[232:233], v9 offset:38528
  ds_read_b64_tr_b16 v[234:235], v9 offset:46208
  v_exp_f32 v210, v70
  v_mfma_f32_16x16x32_bf16 v[56:59], v[252:255], v[132:135], v[56:59]
  ds_read_b64_tr_b16 v[236:237], v10 offset:38528
  ds_read_b64_tr_b16 v[238:239], v10 offset:46208
  v_exp_f32 v211, v71
  s_waitcnt vmcnt(0)
  s_barrier
  s_add_u32 m0, s40, 102400
  s_add_u32 s100, s40, 40960
  buffer_load_dwordx4 v1, s[20:23], s100 offen sc1 lds
  s_add_u32 m0, s40, 104448
  s_add_u32 s100, s40, 43008
  buffer_load_dwordx4 v1, s[20:23], s100 offen sc1 lds
  s_add_u32 m0, s40, 106496
  s_add_u32 s100, s40, 45056
  buffer_load_dwordx4 v1, s[20:23], s100 offen sc1 lds
  s_add_u32 m0, s40, 108544
  s_add_u32 s100, s40, 47104
  buffer_load_dwordx4 v1, s[20:23], s100 offen sc1 lds
  s_add_u32 m0, s40, 110592
  s_add_u32 s100, s40, 49152
  buffer_load_dwordx4 v1, s[20:23], s100 offen sc1 lds
  s_add_u32 m0, s40, 112640
  s_add_u32 s100, s40, 51200
  buffer_load_dwordx4 v1, s[20:23], s100 offen sc1 lds
  s_add_u32 m0, s40, 114688
  s_add_u32 s100, s40, 53248
  buffer_load_dwordx4 v1, s[20:23], s100 offen sc1 lds
  s_add_u32 m0, s40, 116736
  s_add_u32 s100, s40, 55296
  buffer_load_dwordx4 v1, s[20:23], s100 offen sc1 lds
  s_add_u32 m0, s40, 118784
  s_add_u32 s100, s40, 57344
  buffer_load_dwordx4 v1, s[20:23], s100 offen sc1 lds
  s_add_u32 m0, s40, 120832
  s_add_u32 s100, s40, 59392
  buffer_load_dwordx4 v1, s[20:23], s100 offen sc1 lds
  s_add_u32 m0, s40, 122880
  s_add_u32 s100, s40, 61440
  buffer_load_dwordx4 v1, s[20:23], s100 offen sc1 lds
  s_add_u32 m0, s40, 124928
  s_add_u32 s100, s40, 63488
  buffer_load_dwordx4 v1, s[20:23], s100 offen sc1 lds
  s_add_u32 m0, s40, 126976
  s_add_u32 s100, s40, 65536
  buffer_load_dwordx4 v1, s[20:23], s100 offen sc1 lds
  s_add_u32 m0, s40, 129024
  s_add_u32 s100, s40, 67584
  buffer_load_dwordx4 v1, s[20:23], s100 offen sc1 lds
  s_add_u32 m0, s40, 131072
  s_add_u32 s100, s40, 69632
  buffer_load_dwordx4 v1, s[20:23], s100 offen sc1 lds
  s_waitcnt vmcnt(0)
  s_barrier
  s_nop 0
  v_cvt_pk_bf16_f32 v159, v210, v211
  v_exp_f32 v212, v64
  v_exp_f32 v213, v65
  v_exp_f32 v214, v66
  v_exp_f32 v215, v67
  v_cvt_pk_bf16_f32 v156, v212, v213
  v_cvt_pk_bf16_f32 v157, v214, v215
  v_exp_f32 v204, v60
  v_exp_f32 v205, v61
  v_exp_f32 v206, v62
  v_exp_f32 v207, v63
  v_cvt_pk_bf16_f32 v154, v204, v205
  v_cvt_pk_bf16_f32 v155, v206, v207
  v_exp_f32 v208, v56
  v_exp_f32 v209, v57
  v_exp_f32 v210, v58
  v_exp_f32 v211, v59
  v_cvt_pk_bf16_f32 v152, v208, v209
  v_cvt_pk_bf16_f32 v153, v210, v211
  v_mfma_f32_16x16x32_bf16 v[188:191], v[192:195], v[164:167], 0
  ds_read_b64_tr_b16 v[240:241], v11 offset:38528
  ds_read_b64_tr_b16 v[242:243], v11 offset:46208
  v_mfma_f32_16x16x32_bf16 v[188:191], v[192:195], v[160:163], v[188:191]
  ds_read_b64_tr_b16 v[244:245], v12 offset:38528
  ds_read_b64_tr_b16 v[246:247], v12 offset:46208
  v_mfma_f32_16x16x32_bf16 v[188:191], v[192:195], v[156:159], v[188:191]
  v_mfma_f32_16x16x32_bf16 v[188:191], v[192:195], v[152:155], v[188:191]
  s_nop 7
  v_subrev_u32 v23, 813694976, v188
  s_mov_b32 s52, 503316480
  v_cmp_gt_u32 s[48:49], s52, v23
  s_or_b64 s[48:49], s[48:49], s[44:45]
  s_cmp_eq_u64 s[48:49], -1
  s_cbranch_scc0 FB1s
FBR1s:
  v_mfma_f32_16x16x32_bf16 v[88:91], v[216:219], v[160:163], 0
  s_waitcnt lgkmcnt(8)
  v_mfma_f32_16x16x32_bf16 v[92:95], v[220:223], v[160:163], 0
  ds_read_b64_tr_b16 v[248:249], v9 offset:38656
  ds_read_b64_tr_b16 v[250:251], v9 offset:46336
  v_mfma_f32_16x16x32_bf16 v[96:99], v[224:227], v[160:163], 0
  ds_read_b64_tr_b16 v[252:253], v10 offset:38656
  ds_read_b64_tr_b16 v[254:255], v10 offset:46336
  v_mfma_f32_16x16x32_bf16 v[100:103], v[228:231], v[160:163], 0
  ds_read_b64_tr_b16 v[216:217], v11 offset:38656
  ds_read_b64_tr_b16 v[218:219], v11 offset:46336
  s_waitcnt lgkmcnt(8)
  v_mfma_f32_16x16x32_bf16 v[104:107], v[232:235], v[160:163], 0
  ds_read_b64_tr_b16 v[220:221], v12 offset:38656
  ds_read_b64_tr_b16 v[222:223], v12 offset:46336
  v_mfma_f32_16x16x32_bf16 v[108:111], v[236:239], v[160:163], 0
  ds_read_b64_tr_b16 v[224:225], v9 offset:53760
  ds_read_b64_tr_b16 v[226:227], v9 offset:61440
  v_mfma_f32_16x16x32_bf16 v[112:115], v[240:243], v[160:163], 0
  ds_read_b64_tr_b16 v[228:229], v10 offset:53760
  ds_read_b64_tr_b16 v[230:231], v10 offset:61440
  s_waitcnt lgkmcnt(8)
  v_mfma_f32_16x16x32_bf16 v[116:119], v[244:247], v[160:163], 0
  ds_read_b64_tr_b16 v[232:233], v11 offset:53760
  ds_read_b64_tr_b16 v[234:235], v11 offset:61440
  v_mfma_f32_16x16x32_bf16 v[120:123], v[248:251], v[160:163], 0
  ds_read_b64_tr_b16 v[236:237], v12 offset:53760
  ds_read_b64_tr_b16 v[238:239], v12 offset:61440
  v_mfma_f32_16x16x32_bf16 v[124:127], v[252:255], v[160:163], 0
  ds_read_b64_tr_b16 v[240:241], v9 offset:53888
  ds_read_b64_tr_b16 v[242:243], v9 offset:61568
  s_waitcnt lgkmcnt(8)
  v_mfma_f32_16x16x32_bf16 v[128:131], v[216:219], v[160:163], 0
  ds_read_b64_tr_b16 v[244:245], v10 offset:53888
  ds_read_b64_tr_b16 v[246:247], v10 offset:61568
  v_mfma_f32_16x16x32_bf16 v[132:135], v[220:223], v[160:163], 0
  ds_read_b64_tr_b16 v[248:249], v11 offset:53888
  ds_read_b64_tr_b16 v[250:251], v11 offset:61568
  v_mfma_f32_16x16x32_bf16 v[88:91], v[224:227], v[164:167], v[88:91]
  ds_read_b64_tr_b16 v[252:253], v12 offset:53888
  ds_read_b64_tr_b16 v[254:255], v12 offset:61568
  s_waitcnt lgkmcnt(8)
  v_mfma_f32_16x16x32_bf16 v[92:95], v[228:231], v[164:167], v[92:95]
  v_rcp_f32 v23, v188
  v_mfma_f32_16x16x32_bf16 v[96:99], v[232:235], v[164:167], v[96:99]
  ds_read_b64_tr_b16 v[216:217], v9 offset:54016
  ds_read_b64_tr_b16 v[218:219], v9 offset:61696
  v_mfma_f32_16x16x32_bf16 v[100:103], v[236:239], v[164:167], v[100:103]
  ds_read_b64_tr_b16 v[220:221], v10 offset:54016
  ds_read_b64_tr_b16 v[222:223], v10 offset:61696
  s_waitcnt lgkmcnt(8)
  v_mfma_f32_16x16x32_bf16 v[104:107], v[240:243], v[164:167], v[104:107]
  ds_read_b64_tr_b16 v[224:225], v11 offset:54016
  ds_read_b64_tr_b16 v[226:227], v11 offset:61696
  v_mfma_f32_16x16x32_bf16 v[108:111], v[244:247], v[164:167], v[108:111]
  ds_read_b64_tr_b16 v[228:229], v12 offset:54016
  ds_read_b64_tr_b16 v[230:231], v12 offset:61696
  s_waitcnt lgkmcnt(8)
  v_mfma_f32_16x16x32_bf16 v[112:115], v[248:251], v[164:167], v[112:115]
  ds_read_b64_tr_b16 v[232:233], v9 offset:23040
  ds_read_b64_tr_b16 v[234:235], v9 offset:30720
  v_mfma_f32_16x16x32_bf16 v[116:119], v[252:255], v[164:167], v[116:119]
  ds_read_b64_tr_b16 v[236:237], v10 offset:23040
  ds_read_b64_tr_b16 v[238:239], v10 offset:30720
  s_waitcnt lgkmcnt(8)
  v_mfma_f32_16x16x32_bf16 v[120:123], v[216:219], v[164:167], v[120:123]
  ds_read_b64_tr_b16 v[240:241], v11 offset:23040
  ds_read_b64_tr_b16 v[242:243], v11 offset:30720
  v_mfma_f32_16x16x32_bf16 v[124:127], v[220:223], v[164:167], v[124:127]
  ds_read_b64_tr_b16 v[244:245], v12 offset:23040
  ds_read_b64_tr_b16 v[246:247], v12 offset:30720
  s_waitcnt lgkmcnt(8)
  v_mfma_f32_16x16x32_bf16 v[128:131], v[224:227], v[164:167], v[128:131]
  ds_read_b64_tr_b16 v[248:249], v9 offset:23168
  ds_read_b64_tr_b16 v[250:251], v9 offset:30848
  v_mfma_f32_16x16x32_bf16 v[132:135], v[228:231], v[164:167], v[132:135]
  ds_read_b64_tr_b16 v[252:253], v10 offset:23168
  ds_read_b64_tr_b16 v[254:255], v10 offset:30848
  s_waitcnt lgkmcnt(8)
  v_mfma_f32_16x16x32_bf16 v[88:91], v[232:235], v[156:159], v[88:91]
  ds_read_b64_tr_b16 v[216:217], v11 offset:23168
  ds_read_b64_tr_b16 v[218:219], v11 offset:30848
  v_mfma_f32_16x16x32_bf16 v[92:95], v[236:239], v[156:159], v[92:95]
  ds_read_b64_tr_b16 v[220:221], v12 offset:23168
  ds_read_b64_tr_b16 v[222:223], v12 offset:30848
  s_waitcnt lgkmcnt(8)
  v_mfma_f32_16x16x32_bf16 v[96:99], v[240:243], v[156:159], v[96:99]
  ds_read_b64_tr_b16 v[224:225], v9 offset:23296
  ds_read_b64_tr_b16 v[226:227], v9 offset:30976
  v_mfma_f32_16x16x32_bf16 v[100:103], v[244:247], v[156:159], v[100:103]
  ds_read_b64_tr_b16 v[228:229], v10 offset:23296
  ds_read_b64_tr_b16 v[230:231], v10 offset:30976
  s_waitcnt lgkmcnt(8)
  v_mfma_f32_16x16x32_bf16 v[104:107], v[248:251], v[156:159], v[104:107]
  ds_read_b64_tr_b16 v[232:233], v11 offset:23296
  ds_read_b64_tr_b16 v[234:235], v11 offset:30976
  v_mfma_f32_16x16x32_bf16 v[108:111], v[252:255], v[156:159], v[108:111]
  ds_read_b64_tr_b16 v[236:237], v12 offset:23296
  ds_read_b64_tr_b16 v[238:239], v12 offset:30976
  s_waitcnt lgkmcnt(8)
  v_mfma_f32_16x16x32_bf16 v[112:115], v[216:219], v[156:159], v[112:115]
  ds_read_b64_tr_b16 v[240:241], v9 offset:7680
  ds_read_b64_tr_b16 v[242:243], v9 offset:15360
  v_mfma_f32_16x16x32_bf16 v[116:119], v[220:223], v[156:159], v[116:119]
  ds_read_b64_tr_b16 v[244:245], v10 offset:7680
  ds_read_b64_tr_b16 v[246:247], v10 offset:15360
  s_waitcnt lgkmcnt(8)
  v_mfma_f32_16x16x32_bf16 v[120:123], v[224:227], v[156:159], v[120:123]
  ds_read_b64_tr_b16 v[248:249], v11 offset:7680
  ds_read_b64_tr_b16 v[250:251], v11 offset:15360
  v_mfma_f32_16x16x32_bf16 v[124:127], v[228:231], v[156:159], v[124:127]
  ds_read_b64_tr_b16 v[252:253], v12 offset:7680
  ds_read_b64_tr_b16 v[254:255], v12 offset:15360
  s_waitcnt lgkmcnt(8)
  v_mfma_f32_16x16x32_bf16 v[128:131], v[232:235], v[156:159], v[128:131]
  ds_read_b64_tr_b16 v[216:217], v9 offset:7808
  ds_read_b64_tr_b16 v[218:219], v9 offset:15488
  v_mfma_f32_16x16x32_bf16 v[132:135], v[236:239], v[156:159], v[132:135]
  ds_read_b64_tr_b16 v[220:221], v10 offset:7808
  ds_read_b64_tr_b16 v[222:223], v10 offset:15488
  s_waitcnt lgkmcnt(8)
  v_mfma_f32_16x16x32_bf16 v[88:91], v[240:243], v[152:155], v[88:91]
  ds_read_b64_tr_b16 v[224:225], v11 offset:7808
  ds_read_b64_tr_b16 v[226:227], v11 offset:15488
  v_mfma_f32_16x16x32_bf16 v[92:95], v[244:247], v[152:155], v[92:95]
  ds_read_b64_tr_b16 v[228:229], v12 offset:7808
  ds_read_b64_tr_b16 v[230:231], v12 offset:15488
  s_waitcnt lgkmcnt(8)
  v_mfma_f32_16x16x32_bf16 v[96:99], v[248:251], v[152:155], v[96:99]
  ds_read_b64_tr_b16 v[232:233], v9 offset:7936
  ds_read_b64_tr_b16 v[234:235], v9 offset:15616
  v_mfma_f32_16x16x32_bf16 v[100:103], v[252:255], v[152:155], v[100:103]
  ds_read_b64_tr_b16 v[236:237], v10 offset:7936
  ds_read_b64_tr_b16 v[238:239], v10 offset:15616
  s_waitcnt lgkmcnt(8)
  v_mfma_f32_16x16x32_bf16 v[104:107], v[216:219], v[152:155], v[104:107]
  ds_read_b64_tr_b16 v[240:241], v11 offset:7936
  ds_read_b64_tr_b16 v[242:243], v11 offset:15616
  v_mfma_f32_16x16x32_bf16 v[108:111], v[220:223], v[152:155], v[108:111]
  ds_read_b64_tr_b16 v[244:245], v12 offset:7936
  ds_read_b64_tr_b16 v[246:247], v12 offset:15616
  s_waitcnt lgkmcnt(8)
  v_mfma_f32_16x16x32_bf16 v[112:115], v[224:227], v[152:155], v[112:115]
  v_cvt_pk_bf16_f32 v156, v88, v89
  v_cvt_pk_bf16_f32 v157, v90, v91
  v_mfma_f32_16x16x32_bf16 v[116:119], v[228:231], v[152:155], v[116:119]
  v_cvt_pk_bf16_f32 v158, v92, v93
  s_waitcnt lgkmcnt(6)
  v_mfma_f32_16x16x32_bf16 v[120:123], v[232:235], v[152:155], v[120:123]
  v_cvt_pk_bf16_f32 v159, v94, v95
  s_waitcnt lgkmcnt(4)
  v_mfma_f32_16x16x32_bf16 v[124:127], v[236:239], v[152:155], v[124:127]
  v_cvt_pk_bf16_f32 v160, v96, v97
  s_waitcnt lgkmcnt(2)
  v_mfma_f32_16x16x32_bf16 v[128:131], v[240:243], v[152:155], v[128:131]
  v_cvt_pk_bf16_f32 v161, v98, v99
  s_waitcnt lgkmcnt(0)
  v_mfma_f32_16x16x32_bf16 v[132:135], v[244:247], v[152:155], v[132:135]
  v_cvt_pk_bf16_f32 v162, v100, v101
  ds_read_b128 v[248:251], v2 offset:30720
  ds_read_b128 v[252:255], v2 offset:31744
  ds_read_b128 v[216:219], v2 offset:32768
  ds_read_b128 v[220:223], v2 offset:33792
  ds_read_b128 v[224:227], v2 offset:34816
  ds_read_b128 v[228:231], v2 offset:35840
  ds_read_b128 v[232:235], v2 offset:36864
  ds_read_b128 v[236:239], v2 offset:37888
  ds_read_b128 v[240:243], v2 offset:38912
  ds_read_b128 v[244:247], v2 offset:39936
  s_waitcnt lgkmcnt(6)
  v_mfma_f32_16x16x32_bf16 v[192:195], v[248:251], v[156:159], 0
  ds_read_b128 v[248:251], v2 offset:40960
  v_cvt_pk_bf16_f32 v163, v102, v103
  s_nop 1
  v_mfma_f32_16x16x32_bf16 v[192:195], v[252:255], v[160:163], v[192:195]
  ds_read_b128 v[252:255], v2 offset:41984
  v_cvt_pk_bf16_f32 v164, v104, v105
  v_cvt_pk_bf16_f32 v165, v106, v107
  v_cvt_pk_bf16_f32 v166, v108, v109
  v_cvt_pk_bf16_f32 v167, v110, v111
  s_nop 1
  v_mfma_f32_16x16x32_bf16 v[192:195], v[216:219], v[164:167], v[192:195]
  ds_read_b128 v[216:219], v2 offset:43008
  v_cvt_pk_bf16_f32 v24, v112, v113
  v_cvt_pk_bf16_f32 v25, v114, v115
  v_cvt_pk_bf16_f32 v26, v116, v117
  v_cvt_pk_bf16_f32 v27, v118, v119
  s_nop 1
  v_mfma_f32_16x16x32_bf16 v[192:195], v[220:223], v[24:27], v[192:195]
  ds_read_b128 v[220:223], v2 offset:44032
  v_cvt_pk_bf16_f32 v28, v120, v121
  v_cvt_pk_bf16_f32 v29, v122, v123
  v_cvt_pk_bf16_f32 v30, v124, v125
  v_cvt_pk_bf16_f32 v31, v126, v127
  s_waitcnt lgkmcnt(6)
  s_nop 0
  v_mfma_f32_16x16x32_bf16 v[192:195], v[224:227], v[28:31], v[192:195]
  ds_read_b128 v[224:227], v2 offset:45056
  v_cvt_pk_bf16_f32 v32, v128, v129
  v_cvt_pk_bf16_f32 v33, v130, v131
  v_cvt_pk_bf16_f32 v34, v132, v133
  v_cvt_pk_bf16_f32 v35, v134, v135
  s_nop 1
  v_mfma_f32_16x16x32_bf16 v[192:195], v[228:231], v[32:35], v[192:195]
  ds_read_b128 v[228:231], v2 offset:46080
  v_mfma_f32_16x16x32_bf16 v[196:199], v[232:235], v[156:159], 0
  ds_read_b128 v[232:235], v2 offset:47104
  v_mfma_f32_16x16x32_bf16 v[196:199], v[236:239], v[160:163], v[196:199]
  ds_read_b128 v[236:239], v2 offset:48128
  s_waitcnt lgkmcnt(6)
  v_mfma_f32_16x16x32_bf16 v[196:199], v[240:243], v[164:167], v[196:199]
  ds_read_b128 v[240:243], v2 offset:49152
  v_mul_f32 v192, v192, v23
  v_mfma_f32_16x16x32_bf16 v[196:199], v[244:247], v[24:27], v[196:199]
  ds_read_b128 v[244:247], v2 offset:50176
  v_mul_f32 v193, v193, v23
  v_mfma_f32_16x16x32_bf16 v[196:199], v[248:251], v[28:31], v[196:199]
  ds_read_b128 v[248:251], v2 offset:51200
  v_mul_f32 v194, v194, v23
  v_mfma_f32_16x16x32_bf16 v[196:199], v[252:255], v[32:35], v[196:199]
  ds_read_b128 v[252:255], v2 offset:52224
  s_mov_b32 s100, 71680
  buffer_load_dwordx4 v[104:107], v1, s[20:23], s100 offen offset:0 sc1
  buffer_load_dwordx4 v[108:111], v1, s[20:23], s100 offen offset:1024 sc1
  s_waitcnt lgkmcnt(6)
  v_mfma_f32_16x16x32_bf16 v[208:211], v[216:219], v[156:159], 0
  ds_read_b128 v[216:219], v2 offset:53248
  v_mul_f32 v195, v195, v23
  v_mfma_f32_16x16x32_bf16 v[208:211], v[220:223], v[160:163], v[208:211]
  ds_read_b128 v[220:223], v2 offset:54272
  v_cvt_pk_bf16_f32 v92, v192, v193
  v_mfma_f32_16x16x32_bf16 v[208:211], v[224:227], v[164:167], v[208:211]
  ds_read_b128 v[224:227], v2 offset:55296
  v_cvt_pk_bf16_f32 v93, v194, v195
  v_mfma_f32_16x16x32_bf16 v[208:211], v[228:231], v[24:27], v[208:211]
  ds_read_b128 v[228:231], v2 offset:56320
  s_waitcnt lgkmcnt(6)
  v_mfma_f32_16x16x32_bf16 v[208:211], v[232:235], v[28:31], v[208:211]
  ds_read_b128 v[232:235], v2 offset:57344
  v_mul_f32 v196, v196, v23
  v_mfma_f32_16x16x32_bf16 v[208:211], v[236:239], v[32:35], v[208:211]
  ds_read_b128 v[236:239], v2 offset:58368
  v_mul_f32 v197, v197, v23
  v_mfma_f32_16x16x32_bf16 v[212:215], v[240:243], v[156:159], 0
  ds_read_b128 v[240:243], v2 offset:59392
  v_mul_f32 v198, v198, v23
  v_mfma_f32_16x16x32_bf16 v[212:215], v[244:247], v[160:163], v[212:215]
  ds_read_b128 v[244:247], v2 offset:60416
  s_waitcnt lgkmcnt(6)
  v_mfma_f32_16x16x32_bf16 v[212:215], v[248:251], v[164:167], v[212:215]
  ds_read_b128 v[248:251], v1 offset:0
  v_mul_f32 v199, v199, v23
  v_mfma_f32_16x16x32_bf16 v[212:215], v[252:255], v[24:27], v[212:215]
  ds_read_b128 v[252:255], v1 offset:1024
  v_cvt_pk_bf16_f32 v94, v196, v197
  v_mfma_f32_16x16x32_bf16 v[212:215], v[216:219], v[28:31], v[212:215]
  ds_read_b128 v[216:219], v1 offset:2048
  v_cvt_pk_bf16_f32 v95, v198, v199
  v_mfma_f32_16x16x32_bf16 v[212:215], v[220:223], v[32:35], v[212:215]
  buffer_store_dwordx4 v[92:95], v6, s[16:19], 0 offen offset:0 nt sc1
  v_mul_f32 v208, v208, v23
  ds_read_b128 v[220:223], v1 offset:3072
  s_waitcnt lgkmcnt(6)
  v_mfma_f32_16x16x32_bf16 v[192:195], v[224:227], v[156:159], 0
  ds_read_b128 v[224:227], v1 offset:4096
  v_mul_f32 v209, v209, v23
  v_mfma_f32_16x16x32_bf16 v[192:195], v[228:231], v[160:163], v[192:195]
  ds_read_b128 v[228:231], v1 offset:5120
  v_mul_f32 v210, v210, v23
  v_mfma_f32_16x16x32_bf16 v[192:195], v[232:235], v[164:167], v[192:195]
  ds_read_b128 v[232:235], v1 offset:6144
  v_mul_f32 v211, v211, v23
  v_mfma_f32_16x16x32_bf16 v[192:195], v[236:239], v[24:27], v[192:195]
  ds_read_b128 v[236:239], v1 offset:7168
  s_waitcnt lgkmcnt(6)
  v_mfma_f32_16x16x32_bf16 v[192:195], v[240:243], v[28:31], v[192:195]
  ds_read_b128 v[240:243], v1 offset:8192
  v_cvt_pk_bf16_f32 v100, v208, v209
  v_mfma_f32_16x16x32_bf16 v[192:195], v[244:247], v[32:35], v[192:195]
  ds_read_b128 v[244:247], v1 offset:9216
  v_cvt_pk_bf16_f32 v101, v210, v211
  v_mfma_f32_16x16x32_bf16 v[196:199], v[248:251], v[156:159], 0
  ds_read_b128 v[248:251], v2 offset:0
  v_mul_f32 v212, v212, v23
  v_mfma_f32_16x16x32_bf16 v[196:199], v[252:255], v[160:163], v[196:199]
  ds_read_b128 v[252:255], v2 offset:1024
  s_waitcnt lgkmcnt(6)
  v_mfma_f32_16x16x32_bf16 v[196:199], v[216:219], v[164:167], v[196:199]
  ds_read_b128 v[216:219], v2 offset:2048
  v_mul_f32 v213, v213, v23
  v_mfma_f32_16x16x32_bf16 v[196:199], v[220:223], v[24:27], v[196:199]
  ds_read_b128 v[220:223], v2 offset:3072
  v_mul_f32 v214, v214, v23
  v_mfma_f32_16x16x32_bf16 v[196:199], v[224:227], v[28:31], v[196:199]
  ds_read_b128 v[224:227], v2 offset:4096
  v_mul_f32 v215, v215, v23
  v_mfma_f32_16x16x32_bf16 v[196:199], v[228:231], v[32:35], v[196:199]
  ds_read_b128 v[228:231], v2 offset:5120
  v_cvt_pk_bf16_f32 v102, v212, v213
  v_cvt_pk_bf16_f32 v103, v214, v215
  buffer_store_dwordx4 v[100:103], v6, s[16:19], 0 offen offset:64 nt sc1
  s_waitcnt lgkmcnt(6)
  v_mfma_f32_16x16x32_bf16 v[208:211], v[232:235], v[156:159], 0
  ds_read_b128 v[232:235], v2 offset:6144
  v_mul_f32 v192, v192, v23
  v_mfma_f32_16x16x32_bf16 v[208:211], v[236:239], v[160:163], v[208:211]
  ds_read_b128 v[236:239], v2 offset:7168
  v_mul_f32 v193, v193, v23
  v_mfma_f32_16x16x32_bf16 v[208:211], v[240:243], v[164:167], v[208:211]
  ds_read_b128 v[240:243], v2 offset:8192
  v_mul_f32 v194, v194, v23
  v_mfma_f32_16x16x32_bf16 v[208:211], v[244:247], v[24:27], v[208:211]
  ds_read_b128 v[244:247], v2 offset:9216
  s_waitcnt lgkmcnt(6)
  v_mfma_f32_16x16x32_bf16 v[208:211], v[248:251], v[28:31], v[208:211]
  ds_read_b128 v[248:251], v2 offset:10240
  v_mul_f32 v195, v195, v23
  v_mfma_f32_16x16x32_bf16 v[208:211], v[252:255], v[32:35], v[208:211]
  ds_read_b128 v[252:255], v2 offset:11264
  v_cvt_pk_bf16_f32 v92, v192, v193
  v_mfma_f32_16x16x32_bf16 v[212:215], v[216:219], v[156:159], 0
  ds_read_b128 v[216:219], v2 offset:12288
  v_cvt_pk_bf16_f32 v93, v194, v195
  v_mfma_f32_16x16x32_bf16 v[212:215], v[220:223], v[160:163], v[212:215]
  ds_read_b128 v[220:223], v2 offset:13312
  s_waitcnt lgkmcnt(6)
  v_mfma_f32_16x16x32_bf16 v[212:215], v[224:227], v[164:167], v[212:215]
  ds_read_b128 v[224:227], v2 offset:14336
  v_mul_f32 v196, v196, v23
  v_mfma_f32_16x16x32_bf16 v[212:215], v[228:231], v[24:27], v[212:215]
  ds_read_b128 v[228:231], v2 offset:15360
  v_mul_f32 v197, v197, v23
  v_mfma_f32_16x16x32_bf16 v[212:215], v[232:235], v[28:31], v[212:215]
  ds_read_b128 v[232:235], v2 offset:16384
  v_mul_f32 v198, v198, v23
  v_mfma_f32_16x16x32_bf16 v[212:215], v[236:239], v[32:35], v[212:215]
  ds_read_b128 v[236:239], v2 offset:17408
  v_mul_f32 v199, v199, v23
  v_cvt_pk_bf16_f32 v94, v196, v197
  v_cvt_pk_bf16_f32 v95, v198, v199
  buffer_store_dwordx4 v[92:95], v6, s[16:19], 0 offen offset:128 nt sc1
  s_waitcnt lgkmcnt(6)
  v_mfma_f32_16x16x32_bf16 v[192:195], v[240:243], v[156:159], 0
  ds_read_b128 v[240:243], v2 offset:18432
  v_mul_f32 v208, v208, v23
  v_mfma_f32_16x16x32_bf16 v[192:195], v[244:247], v[160:163], v[192:195]
  ds_read_b128 v[244:247], v2 offset:19456
  v_mul_f32 v209, v209, v23
  v_mfma_f32_16x16x32_bf16 v[192:195], v[248:251], v[164:167], v[192:195]
  ds_read_b128 v[248:251], v2 offset:20480
  v_mul_f32 v210, v210, v23
  v_mfma_f32_16x16x32_bf16 v[192:195], v[252:255], v[24:27], v[192:195]
  ds_read_b128 v[252:255], v2 offset:21504
  s_waitcnt lgkmcnt(6)
  v_mfma_f32_16x16x32_bf16 v[192:195], v[216:219], v[28:31], v[192:195]
  ds_read_b128 v[216:219], v2 offset:22528
  v_mul_f32 v211, v211, v23
  v_mfma_f32_16x16x32_bf16 v[192:195], v[220:223], v[32:35], v[192:195]
  ds_read_b128 v[220:223], v2 offset:23552
  v_cvt_pk_bf16_f32 v100, v208, v209
  v_mfma_f32_16x16x32_bf16 v[196:199], v[224:227], v[156:159], 0
  ds_read_b128 v[224:227], v2 offset:24576
  v_cvt_pk_bf16_f32 v101, v210, v211
  v_mfma_f32_16x16x32_bf16 v[196:199], v[228:231], v[160:163], v[196:199]
  ds_read_b128 v[228:231], v2 offset:25600
  s_waitcnt lgkmcnt(6)
  v_mfma_f32_16x16x32_bf16 v[196:199], v[232:235], v[164:167], v[196:199]
  ds_read_b128 v[232:235], v2 offset:26624
  v_mul_f32 v212, v212, v23
  v_mfma_f32_16x16x32_bf16 v[196:199], v[236:239], v[24:27], v[196:199]
  ds_read_b128 v[236:239], v2 offset:27648
  v_mul_f32 v213, v213, v23
  v_mfma_f32_16x16x32_bf16 v[196:199], v[240:243], v[28:31], v[196:199]
  ds_read_b128 v[240:243], v2 offset:28672
  v_mul_f32 v214, v214, v23
  v_mfma_f32_16x16x32_bf16 v[196:199], v[244:247], v[32:35], v[196:199]
  ds_read_b128 v[244:247], v2 offset:29696
  v_mul_f32 v215, v215, v23
  v_cvt_pk_bf16_f32 v102, v212, v213
  v_cvt_pk_bf16_f32 v103, v214, v215
  buffer_store_dwordx4 v[100:103], v6, s[16:19], 0 offen offset:192 nt sc1
  s_waitcnt vmcnt(4)
  s_waitcnt lgkmcnt(6)
  v_mfma_f32_16x16x32_bf16 v[208:211], v[248:251], v[156:159], 0
  v_mul_f32 v192, v192, v23
  v_mul_f32 v193, v193, v23
  v_mfma_f32_16x16x32_bf16 v[208:211], v[252:255], v[160:163], v[208:211]
  v_mul_f32 v194, v194, v23
  v_mul_f32 v195, v195, v23
  v_mfma_f32_16x16x32_bf16 v[208:211], v[216:219], v[164:167], v[208:211]
  v_cvt_pk_bf16_f32 v92, v192, v193
  v_cvt_pk_bf16_f32 v93, v194, v195
  v_mfma_f32_16x16x32_bf16 v[208:211], v[220:223], v[24:27], v[208:211]
  v_mul_f32 v196, v196, v23
  s_waitcnt lgkmcnt(4)
  v_mfma_f32_16x16x32_bf16 v[208:211], v[224:227], v[28:31], v[208:211]
  v_mul_f32 v197, v197, v23
  v_mul_f32 v198, v198, v23
  v_mfma_f32_16x16x32_bf16 v[208:211], v[228:231], v[32:35], v[208:211]
  v_mul_f32 v199, v199, v23
  s_waitcnt lgkmcnt(3)
  v_mfma_f32_16x16x32_bf16 v[212:215], v[232:235], v[156:159], 0
  v_cvt_pk_bf16_f32 v94, v196, v197
  s_waitcnt lgkmcnt(2)
  v_mfma_f32_16x16x32_bf16 v[212:215], v[236:239], v[160:163], v[212:215]
  v_cvt_pk_bf16_f32 v95, v198, v199
  s_waitcnt lgkmcnt(1)
  v_mfma_f32_16x16x32_bf16 v[212:215], v[240:243], v[164:167], v[212:215]
  v_mul_f32 v208, v208, v23
  s_waitcnt lgkmcnt(0)
  v_mfma_f32_16x16x32_bf16 v[212:215], v[244:247], v[24:27], v[212:215]
  v_mul_f32 v209, v209, v23
  v_mfma_f32_16x16x32_bf16 v[212:215], v[104:107], v[28:31], v[212:215]
  v_mul_f32 v210, v210, v23
  v_mfma_f32_16x16x32_bf16 v[212:215], v[108:111], v[32:35], v[212:215]
  v_mul_f32 v211, v211, v23
  v_cvt_pk_bf16_f32 v100, v208, v209
  buffer_store_dwordx4 v[92:95], v6, s[16:19], 0 offen offset:256 nt sc1
  v_cvt_pk_bf16_f32 v101, v210, v211
  s_nop 3
  v_mul_f32 v212, v212, v23
  v_mul_f32 v213, v213, v23
  v_mul_f32 v214, v214, v23
  v_mul_f32 v215, v215, v23
  v_cvt_pk_bf16_f32 v102, v212, v213
  v_cvt_pk_bf16_f32 v103, v214, v215
  buffer_store_dwordx4 v[100:103], v6, s[16:19], 0 offen offset:320 nt sc1
  s_endpgm
FB0:
  s_nop 7
  v_max3_f32 v22, v24, v25, v26
  v_max3_f32 v22, v22, v27, v28
  v_max3_f32 v22, v22, v29, v30
  v_max3_f32 v22, v22, v31, v32
  v_max3_f32 v22, v22, v33, v34
  v_max3_f32 v22, v22, v35, v36
  v_max3_f32 v22, v22, v37, v38
  v_max3_f32 v22, v22, v39, v40
  v_max3_f32 v22, v22, v41, v42
  v_max3_f32 v22, v22, v43, v44
  v_max3_f32 v22, v22, v45, v46
  v_max3_f32 v22, v22, v47, v48
  v_max3_f32 v22, v22, v49, v50
  v_max3_f32 v22, v22, v51, v52
  v_max3_f32 v22, v22, v53, v54
  s_mov_b32 s52, 0xff7fffff
  v_max3_f32 v22, v22, v55, s52
  v_mov_b32 v23, v22
  s_nop 1
  v_permlane32_swap_b32 v22, v23
  s_nop 1
  v_max_f32 v22, v22, v23
  v_mov_b32 v23, v22
  s_nop 1
  v_permlane16_swap_b32 v22, v23
  s_nop 1
  v_max_f32 v22, v22, v23
  v_sub_f32 v24, v24, v22
  v_sub_f32 v25, v25, v22
  v_sub_f32 v26, v26, v22
  v_sub_f32 v27, v27, v22
  v_sub_f32 v28, v28, v22
  v_sub_f32 v29, v29, v22
  v_sub_f32 v30, v30, v22
  v_sub_f32 v31, v31, v22
  v_sub_f32 v32, v32, v22
  v_sub_f32 v33, v33, v22
  v_sub_f32 v34, v34, v22
  v_sub_f32 v35, v35, v22
  v_sub_f32 v36, v36, v22
  v_sub_f32 v37, v37, v22
  v_sub_f32 v38, v38, v22
  v_sub_f32 v39, v39, v22
  v_sub_f32 v40, v40, v22
  v_sub_f32 v41, v41, v22
  v_sub_f32 v42, v42, v22
  v_sub_f32 v43, v43, v22
  v_sub_f32 v44, v44, v22
  v_sub_f32 v45, v45, v22
  v_sub_f32 v46, v46, v22
  v_sub_f32 v47, v47, v22
  v_sub_f32 v48, v48, v22
  v_sub_f32 v49, v49, v22
  v_sub_f32 v50, v50, v22
  v_sub_f32 v51, v51, v22
  v_sub_f32 v52, v52, v22
  v_sub_f32 v53, v53, v22
  v_sub_f32 v54, v54, v22
  v_sub_f32 v55, v55, v22
  v_exp_f32 v24, v24
  v_exp_f32 v25, v25
  v_exp_f32 v26, v26
  v_exp_f32 v27, v27
  v_exp_f32 v28, v28
  v_exp_f32 v29, v29
  v_exp_f32 v30, v30
  v_exp_f32 v31, v31
  v_exp_f32 v32, v32
  v_exp_f32 v33, v33
  v_exp_f32 v34, v34
  v_exp_f32 v35, v35
  v_exp_f32 v36, v36
  v_exp_f32 v37, v37
  v_exp_f32 v38, v38
  v_exp_f32 v39, v39
  v_exp_f32 v40, v40
  v_exp_f32 v41, v41
  v_exp_f32 v42, v42
  v_exp_f32 v43, v43
  v_exp_f32 v44, v44
  v_exp_f32 v45, v45
  v_exp_f32 v46, v46
  v_exp_f32 v47, v47
  v_exp_f32 v48, v48
  v_exp_f32 v49, v49
  v_exp_f32 v50, v50
  v_exp_f32 v51, v51
  v_exp_f32 v52, v52
  v_exp_f32 v53, v53
  v_exp_f32 v54, v54
  v_exp_f32 v55, v55
  s_nop 0
  v_cvt_pk_bf16_f32 v136, v24, v25
  v_cvt_pk_bf16_f32 v137, v26, v27
  v_cvt_pk_bf16_f32 v138, v28, v29
  v_cvt_pk_bf16_f32 v139, v30, v31
  v_cvt_pk_bf16_f32 v140, v32, v33
  v_cvt_pk_bf16_f32 v141, v34, v35
  v_cvt_pk_bf16_f32 v142, v36, v37
  v_cvt_pk_bf16_f32 v143, v38, v39
  v_cvt_pk_bf16_f32 v144, v40, v41
  v_cvt_pk_bf16_f32 v145, v42, v43
  v_cvt_pk_bf16_f32 v146, v44, v45
  v_cvt_pk_bf16_f32 v147, v46, v47
  v_cvt_pk_bf16_f32 v148, v48, v49
  v_cvt_pk_bf16_f32 v149, v50, v51
  v_cvt_pk_bf16_f32 v150, v52, v53
  v_cvt_pk_bf16_f32 v151, v54, v55
  s_nop 1
  v_mfma_f32_16x16x32_bf16 v[184:187], v[192:195], v[136:139], 0
  v_mfma_f32_16x16x32_bf16 v[184:187], v[192:195], v[140:143], v[184:187]
  v_mfma_f32_16x16x32_bf16 v[184:187], v[192:195], v[144:147], v[184:187]
  v_mfma_f32_16x16x32_bf16 v[184:187], v[192:195], v[148:151], v[184:187]
  s_waitcnt lgkmcnt(0)
  ds_read_b64_tr_b16 v[24:25], v9 offset:38400
  ds_read_b64_tr_b16 v[26:27], v9 offset:46080
  ds_read_b64_tr_b16 v[28:29], v10 offset:38400
  ds_read_b64_tr_b16 v[30:31], v10 offset:46080
  ds_read_b64_tr_b16 v[32:33], v11 offset:38400
  ds_read_b64_tr_b16 v[34:35], v11 offset:46080
  ds_read_b64_tr_b16 v[36:37], v12 offset:38400
  ds_read_b64_tr_b16 v[38:39], v12 offset:46080
  ds_read_b64_tr_b16 v[40:41], v9 offset:38528
  ds_read_b64_tr_b16 v[42:43], v9 offset:46208
  ds_read_b64_tr_b16 v[44:45], v10 offset:38528
  ds_read_b64_tr_b16 v[46:47], v10 offset:46208
  s_waitcnt lgkmcnt(0)
  v_mfma_f32_16x16x32_bf16 v[56:59], v[24:27], v[148:151], 0
  v_mfma_f32_16x16x32_bf16 v[60:63], v[28:31], v[148:151], 0
  v_mfma_f32_16x16x32_bf16 v[64:67], v[32:35], v[148:151], 0
  v_mfma_f32_16x16x32_bf16 v[68:71], v[36:39], v[148:151], 0
  v_mfma_f32_16x16x32_bf16 v[72:75], v[40:43], v[148:151], 0
  v_mfma_f32_16x16x32_bf16 v[76:79], v[44:47], v[148:151], 0
  s_waitcnt lgkmcnt(0)
  ds_read_b64_tr_b16 v[24:25], v11 offset:38528
  ds_read_b64_tr_b16 v[26:27], v11 offset:46208
  ds_read_b64_tr_b16 v[28:29], v12 offset:38528
  ds_read_b64_tr_b16 v[30:31], v12 offset:46208
  ds_read_b64_tr_b16 v[32:33], v9 offset:38656
  ds_read_b64_tr_b16 v[34:35], v9 offset:46336
  ds_read_b64_tr_b16 v[36:37], v10 offset:38656
  ds_read_b64_tr_b16 v[38:39], v10 offset:46336
  ds_read_b64_tr_b16 v[40:41], v11 offset:38656
  ds_read_b64_tr_b16 v[42:43], v11 offset:46336
  ds_read_b64_tr_b16 v[44:45], v12 offset:38656
  ds_read_b64_tr_b16 v[46:47], v12 offset:46336
  s_waitcnt lgkmcnt(0)
  v_mfma_f32_16x16x32_bf16 v[80:83], v[24:27], v[148:151], 0
  v_mfma_f32_16x16x32_bf16 v[84:87], v[28:31], v[148:151], 0
  v_mfma_f32_16x16x32_bf16 v[168:171], v[32:35], v[148:151], 0
  v_mfma_f32_16x16x32_bf16 v[172:175], v[36:39], v[148:151], 0
  v_mfma_f32_16x16x32_bf16 v[176:179], v[40:43], v[148:151], 0
  v_mfma_f32_16x16x32_bf16 v[180:183], v[44:47], v[148:151], 0
  s_nop 7
  s_branch FBR0
FB1:
  s_nop 7
  v_max3_f32 v22, v56, v57, v58
  v_max3_f32 v22, v22, v59, v60
  v_max3_f32 v22, v22, v61, v62
  v_max3_f32 v22, v22, v63, v64
  v_max3_f32 v22, v22, v65, v66
  v_max3_f32 v22, v22, v67, v68
  v_max3_f32 v22, v22, v69, v70
  v_max3_f32 v22, v22, v71, v72
  v_max3_f32 v22, v22, v73, v74
  v_max3_f32 v22, v22, v75, v76
  v_max3_f32 v22, v22, v77, v78
  v_max3_f32 v22, v22, v79, v80
  v_max3_f32 v22, v22, v81, v82
  v_max3_f32 v22, v22, v83, v84
  v_max3_f32 v22, v22, v85, v86
  s_mov_b32 s52, 0xff7fffff
  v_max3_f32 v22, v22, v87, s52
  v_mov_b32 v23, v22
  s_nop 1
  v_permlane32_swap_b32 v22, v23
  s_nop 1
  v_max_f32 v22, v22, v23
  v_mov_b32 v23, v22
  s_nop 1
  v_permlane16_swap_b32 v22, v23
  s_nop 1
  v_max_f32 v22, v22, v23
  v_sub_f32 v56, v56, v22
  v_sub_f32 v57, v57, v22
  v_sub_f32 v58, v58, v22
  v_sub_f32 v59, v59, v22
  v_sub_f32 v60, v60, v22
  v_sub_f32 v61, v61, v22
  v_sub_f32 v62, v62, v22
  v_sub_f32 v63, v63, v22
  v_sub_f32 v64, v64, v22
  v_sub_f32 v65, v65, v22
  v_sub_f32 v66, v66, v22
  v_sub_f32 v67, v67, v22
  v_sub_f32 v68, v68, v22
  v_sub_f32 v69, v69, v22
  v_sub_f32 v70, v70, v22
  v_sub_f32 v71, v71, v22
  v_sub_f32 v72, v72, v22
  v_sub_f32 v73, v73, v22
  v_sub_f32 v74, v74, v22
  v_sub_f32 v75, v75, v22
  v_sub_f32 v76, v76, v22
  v_sub_f32 v77, v77, v22
  v_sub_f32 v78, v78, v22
  v_sub_f32 v79, v79, v22
  v_sub_f32 v80, v80, v22
  v_sub_f32 v81, v81, v22
  v_sub_f32 v82, v82, v22
  v_sub_f32 v83, v83, v22
  v_sub_f32 v84, v84, v22
  v_sub_f32 v85, v85, v22
  v_sub_f32 v86, v86, v22
  v_sub_f32 v87, v87, v22
  v_exp_f32 v56, v56
  v_exp_f32 v57, v57
  v_exp_f32 v58, v58
  v_exp_f32 v59, v59
  v_exp_f32 v60, v60
  v_exp_f32 v61, v61
  v_exp_f32 v62, v62
  v_exp_f32 v63, v63
  v_exp_f32 v64, v64
  v_exp_f32 v65, v65
  v_exp_f32 v66, v66
  v_exp_f32 v67, v67
  v_exp_f32 v68, v68
  v_exp_f32 v69, v69
  v_exp_f32 v70, v70
  v_exp_f32 v71, v71
  v_exp_f32 v72, v72
  v_exp_f32 v73, v73
  v_exp_f32 v74, v74
  v_exp_f32 v75, v75
  v_exp_f32 v76, v76
  v_exp_f32 v77, v77
  v_exp_f32 v78, v78
  v_exp_f32 v79, v79
  v_exp_f32 v80, v80
  v_exp_f32 v81, v81
  v_exp_f32 v82, v82
  v_exp_f32 v83, v83
  v_exp_f32 v84, v84
  v_exp_f32 v85, v85
  v_exp_f32 v86, v86
  v_exp_f32 v87, v87
  s_nop 0
  v_cvt_pk_bf16_f32 v152, v56, v57
  v_cvt_pk_bf16_f32 v153, v58, v59
  v_cvt_pk_bf16_f32 v154, v60, v61
  v_cvt_pk_bf16_f32 v155, v62, v63
  v_cvt_pk_bf16_f32 v156, v64, v65
  v_cvt_pk_bf16_f32 v157, v66, v67
  v_cvt_pk_bf16_f32 v158, v68, v69
  v_cvt_pk_bf16_f32 v159, v70, v71
  v_cvt_pk_bf16_f32 v160, v72, v73
  v_cvt_pk_bf16_f32 v161, v74, v75
  v_cvt_pk_bf16_f32 v162, v76, v77
  v_cvt_pk_bf16_f32 v163, v78, v79
  v_cvt_pk_bf16_f32 v164, v80, v81
  v_cvt_pk_bf16_f32 v165, v82, v83
  v_cvt_pk_bf16_f32 v166, v84, v85
  v_cvt_pk_bf16_f32 v167, v86, v87
  s_nop 1
  v_mfma_f32_16x16x32_bf16 v[188:191], v[192:195], v[152:155], 0
  v_mfma_f32_16x16x32_bf16 v[188:191], v[192:195], v[156:159], v[188:191]
  v_mfma_f32_16x16x32_bf16 v[188:191], v[192:195], v[160:163], v[188:191]
  v_mfma_f32_16x16x32_bf16 v[188:191], v[192:195], v[164:167], v[188:191]
  s_nop 7
  s_branch FBR1
FB1s:
  s_nop 7
  v_max3_f32 v22, v56, v57, v58
  v_max3_f32 v22, v22, v59, v60
  v_max3_f32 v22, v22, v61, v62
  v_max3_f32 v22, v22, v63, v64
  v_max3_f32 v22, v22, v65, v66
  v_max3_f32 v22, v22, v67, v68
  v_max3_f32 v22, v22, v69, v70
  v_max3_f32 v22, v22, v71, v72
  v_max3_f32 v22, v22, v73, v74
  v_max3_f32 v22, v22, v75, v76
  v_max3_f32 v22, v22, v77, v78
  v_max3_f32 v22, v22, v79, v80
  v_max3_f32 v22, v22, v81, v82
  v_max3_f32 v22, v22, v83, v84
  v_max3_f32 v22, v22, v85, v86
  s_mov_b32 s52, 0xff7fffff
  v_max3_f32 v22, v22, v87, s52
  v_mov_b32 v23, v22
  s_nop 1
  v_permlane32_swap_b32 v22, v23
  s_nop 1
  v_max_f32 v22, v22, v23
  v_mov_b32 v23, v22
  s_nop 1
  v_permlane16_swap_b32 v22, v23
  s_nop 1
  v_max_f32 v22, v22, v23
  v_sub_f32 v56, v56, v22
  v_sub_f32 v57, v57, v22
  v_sub_f32 v58, v58, v22
  v_sub_f32 v59, v59, v22
  v_sub_f32 v60, v60, v22
  v_sub_f32 v61, v61, v22
  v_sub_f32 v62, v62, v22
  v_sub_f32 v63, v63, v22
  v_sub_f32 v64, v64, v22
  v_sub_f32 v65, v65, v22
  v_sub_f32 v66, v66, v22
  v_sub_f32 v67, v67, v22
  v_sub_f32 v68, v68, v22
  v_sub_f32 v69, v69, v22
  v_sub_f32 v70, v70, v22
  v_sub_f32 v71, v71, v22
  v_sub_f32 v72, v72, v22
  v_sub_f32 v73, v73, v22
  v_sub_f32 v74, v74, v22
  v_sub_f32 v75, v75, v22
  v_sub_f32 v76, v76, v22
  v_sub_f32 v77, v77, v22
  v_sub_f32 v78, v78, v22
  v_sub_f32 v79, v79, v22
  v_sub_f32 v80, v80, v22
  v_sub_f32 v81, v81, v22
  v_sub_f32 v82, v82, v22
  v_sub_f32 v83, v83, v22
  v_sub_f32 v84, v84, v22
  v_sub_f32 v85, v85, v22
  v_sub_f32 v86, v86, v22
  v_sub_f32 v87, v87, v22
  v_exp_f32 v56, v56
  v_exp_f32 v57, v57
  v_exp_f32 v58, v58
  v_exp_f32 v59, v59
  v_exp_f32 v60, v60
  v_exp_f32 v61, v61
  v_exp_f32 v62, v62
  v_exp_f32 v63, v63
  v_exp_f32 v64, v64
  v_exp_f32 v65, v65
  v_exp_f32 v66, v66
  v_exp_f32 v67, v67
  v_exp_f32 v68, v68
  v_exp_f32 v69, v69
  v_exp_f32 v70, v70
  v_exp_f32 v71, v71
  v_exp_f32 v72, v72
  v_exp_f32 v73, v73
  v_exp_f32 v74, v74
  v_exp_f32 v75, v75
  v_exp_f32 v76, v76
  v_exp_f32 v77, v77
  v_exp_f32 v78, v78
  v_exp_f32 v79, v79
  v_exp_f32 v80, v80
  v_exp_f32 v81, v81
  v_exp_f32 v82, v82
  v_exp_f32 v83, v83
  v_exp_f32 v84, v84
  v_exp_f32 v85, v85
  v_exp_f32 v86, v86
  v_exp_f32 v87, v87
  s_nop 0
  v_cvt_pk_bf16_f32 v152, v56, v57
  v_cvt_pk_bf16_f32 v153, v58, v59
  v_cvt_pk_bf16_f32 v154, v60, v61
  v_cvt_pk_bf16_f32 v155, v62, v63
  v_cvt_pk_bf16_f32 v156, v64, v65
  v_cvt_pk_bf16_f32 v157, v66, v67
  v_cvt_pk_bf16_f32 v158, v68, v69
  v_cvt_pk_bf16_f32 v159, v70, v71
  v_cvt_pk_bf16_f32 v160, v72, v73
  v_cvt_pk_bf16_f32 v161, v74, v75
  v_cvt_pk_bf16_f32 v162, v76, v77
  v_cvt_pk_bf16_f32 v163, v78, v79
  v_cvt_pk_bf16_f32 v164, v80, v81
  v_cvt_pk_bf16_f32 v165, v82, v83
  v_cvt_pk_bf16_f32 v166, v84, v85
  v_cvt_pk_bf16_f32 v167, v86, v87
  s_nop 1
  v_mfma_f32_16x16x32_bf16 v[188:191], v[192:195], v[152:155], 0
  v_mfma_f32_16x16x32_bf16 v[188:191], v[192:195], v[156:159], v[188:191]
  v_mfma_f32_16x16x32_bf16 v[188:191], v[192:195], v[160:163], v[188:191]
  v_mfma_f32_16x16x32_bf16 v[188:191], v[192:195], v[164:167], v[188:191]
  s_nop 7
  s_branch FBR1s
MK_end:
.section .rodata,"a"
.p2align 6
.amdhsa_kernel standalone__neighborhood_nat__vision_kernel
  .amdhsa_next_free_vgpr 256
  .amdhsa_next_free_sgpr 102
  .amdhsa_accum_offset 256
  .amdhsa_group_segment_fixed_size 0
  .amdhsa_kernarg_size 48
  .amdhsa_user_sgpr_count 2
  .amdhsa_user_sgpr_kernarg_segment_ptr 1
  .amdhsa_system_sgpr_workgroup_id_x 1
.end_amdhsa_kernel
```

```asm
; @launch grid=(256,1,1) block=(512,1,1) lds=163840
.amdgcn_target "amdgcn-amd-amdhsa--gfx950"
.text
.globl standalone__neighborhood_nat__vision_kernel
.p2align 8
.type standalone__neighborhood_nat__vision_kernel,@function
standalone__neighborhood_nat__vision_kernel:
  s_cmp_ge_u32 s2, 256
  s_cbranch_scc1 MK_done
  s_load_dwordx8 s[4:11], s[0:1], 0
  s_load_dwordx4 s[84:87], s[0:1], 32
  s_getpc_b64 s[12:13]
MK_pc:
  s_and_b32 s13, s13, 0xffff
  s_mov_b32 s14, MK_end-MK_pc
  s_mov_b32 s15, 0x00020000
  v_lshlrev_b32 v23, 12, v0
  s_bfe_u32 s3, s2, 327683
  s_lshl_b32 s3, s3, 7
  buffer_load_dword v255, v23, s[12:15], s3 offen
  v_lshrrev_b32 v130, 6, v0
  v_and_b32 v0, 63, v0
  v_readfirstlane_b32 s24, v130
  v_and_b32 v128, 15, v0
  v_lshrrev_b32 v129, 4, v0
  v_lshrrev_b32 v130, 5, v0
  v_bfe_u32 v131, v0, 3, 2
  v_lshl_add_u32 v130, v130, 3, v131
  v_mul_u32_u24 v130, 1152, v130
  s_and_b32 s26, s24, 1
  s_lshl_b32 s46, s26, 2
  v_add_u32 v131, s46, v129
  v_and_b32 v132, 7, v0
  v_xor_b32 v131, v131, v132
  v_lshl_add_u32 v96, v131, 4, v130
  s_lshr_b32 s46, s24, 2
  s_lshl_b32 s46, s46, 5
  s_lshl_b32 s47, s26, 4
  s_add_u32 s46, s46, s47
  s_and_b32 s47, s24, 2
  s_lshl_b32 s47, s47, 1
  s_add_u32 s46, s46, s47
  s_mul_i32 s92, s46, 1152
  s_lshl_b32 s41, s24, 10
  s_cmp_lt_u32 s24, 4
  s_cselect_b64 vcc, -1, 0
  s_cbranch_vccz SL1
  s_waitcnt lgkmcnt(0)
  s_lshr_b32 s46, s24, 1
  s_cmp_lg_u32 s46, 1
  s_cbranch_scc1 MK_nwpf
  s_cmp_eq_u32 s24, 2
  s_cselect_b32 s46, 54, 18
  s_cselect_b32 s12, s6, s8
  s_cselect_b32 s13, s7, s9
  s_and_b32 s13, s13, 0xffff
  s_lshr_b32 s47, s2, 3
  s_mul_i32 s47, s47, s46
  s_lshl_b32 s100, s47, 7
  s_lshl_b32 s46, s46, 7
  s_add_u32 s14, s100, s46
  s_mov_b32 s15, 0x00020000
  v_lshlrev_b32 v23, 7, v0
  buffer_load_dword v254, v23, s[12:15], s100 offen
MK_nwpf:
  s_mov_b32 s88, s6
  s_and_b32 s89, s7, 0xffff
  s_mov_b32 s90, 221184
  s_mov_b32 s91, 0x00020000
  s_add_i32 m0, s41, 0
  s_add_i32 s100, s92, 0
  buffer_load_dwordx4 v96, s[88:91], s100 offen lds
  s_add_i32 m0, s41, 8192
  s_add_i32 s100, s92, 73728
  buffer_load_dwordx4 v96, s[88:91], s100 offen lds
  s_add_i32 m0, s41, 16384
  s_add_i32 s100, s92, 147456
  buffer_load_dwordx4 v96, s[88:91], s100 offen lds
  s_add_i32 m0, s41, 24576
  s_add_i32 s100, s92, 384
  buffer_load_dwordx4 v96, s[88:91], s100 offen lds
  s_add_i32 m0, s41, 32768
  s_add_i32 s100, s92, 74112
  buffer_load_dwordx4 v96, s[88:91], s100 offen lds
  s_add_i32 m0, s41, 40960
  s_add_i32 s100, s92, 147840
  buffer_load_dwordx4 v96, s[88:91], s100 offen lds
  s_add_i32 m0, s41, 4096
  s_add_i32 s100, s92, 36864
  buffer_load_dwordx4 v96, s[88:91], s100 offen lds
  s_add_i32 m0, s41, 12288
  s_add_i32 s100, s92, 110592
  buffer_load_dwordx4 v96, s[88:91], s100 offen lds
  s_add_i32 m0, s41, 20480
  s_add_i32 s100, s92, 184320
  buffer_load_dwordx4 v96, s[88:91], s100 offen lds
  s_add_i32 m0, s41, 28672
  s_add_i32 s100, s92, 37248
  buffer_load_dwordx4 v96, s[88:91], s100 offen lds
  s_add_i32 m0, s41, 36864
  s_add_i32 s100, s92, 110976
  buffer_load_dwordx4 v96, s[88:91], s100 offen lds
  s_add_i32 m0, s41, 45056
  s_add_i32 s100, s92, 184704
  buffer_load_dwordx4 v96, s[88:91], s100 offen lds
SL1:
  s_bfe_u32 s27, s2, 0x10002
  s_bfe_u32 s28, s2, 0x10001
  s_and_b32 s29, s2, 1
  s_lshl_b32 s29, s29, 2
  s_lshr_b32 s46, s2, 6
  s_add_u32 s29, s29, s46
  s_bfe_u32 s30, s2, 0x30003
  s_mul_i32 s37, s29, 14
  s_add_i32 s37, s37, -6
  s_max_i32 s29, s37, -4
  s_mul_i32 s30, s30, 14
  s_add_i32 s30, s30, -6
  s_lshr_b32 s25, s24, 1
  s_add_u32 s25, s25, 2
  s_and_b32 s25, s25, 3
  s_sub_u32 s56, 0, s27
  s_mul_i32 s57, s27, 224
  s_sub_u32 s58, 0, s28
  s_mul_i32 s59, s28, 224
  v_and_b32 v130, 7, v128
  s_mul_i32 s46, s26, 7
  s_add_i32 s46, s46, s30
  v_cmp_lt_u32 s[48:49], 6, v130
  v_add_u32 v130, s46, v130
  v_max_i32 v19, 0, v130
  v_add3_u32 v130, v130, v19, 6
  v_xor_b32 v130, s58, v130
  v_add_u32 v130, s59, v130
  v_subrev_u32 v19, s30, v19
  v_mul_u32_u24 v130, 384, v130
  v_lshl_add_u32 v130, v129, 4, v130
  s_lshl_b32 s46, s25, 2
  s_add_i32 s46, s46, -2
  s_mov_b32 s47, 86016
  v_lshrrev_b32 v131, 3, v128
  v_add_u32 v131, s46, v131
  v_mov_b32 v132, 0x80000000
  v_cmp_gt_i32 s[42:43], 0, v131
  v_add_u32 v5, s37, v131
  v_max_i32 v21, 0, v5
  v_add3_u32 v5, v5, v21, 6
  s_or_b64 s[42:43], s[42:43], s[48:49]
  v_xor_b32 v5, s56, v5
  v_add_u32 v5, s57, v5
  v_subrev_u32 v21, s29, v21
  v_mad_u32_u24 v5, v5, s47, v130
  v_cndmask_b32 v21, v21, v132, s[42:43]
  v_cndmask_b32 v5, v5, v132, s[42:43]
  v_add_u32 v131, 2, v131
  v_cmp_gt_i32 s[44:45], 0, v131
  v_add_u32 v6, s37, v131
  v_max_i32 v22, 0, v6
  v_add3_u32 v6, v6, v22, 6
  s_or_b64 s[44:45], s[44:45], s[48:49]
  v_xor_b32 v6, s56, v6
  v_add_u32 v6, s57, v6
  v_subrev_u32 v22, s29, v22
  v_mad_u32_u24 v6, v6, s47, v130
  v_cndmask_b32 v22, v22, v132, s[44:45]
  v_cndmask_b32 v6, v6, v132, s[44:45]
  s_waitcnt lgkmcnt(0)
  s_mov_b32 s88, s6
  s_and_b32 s89, s7, 0xffff
  s_mov_b32 s90, 221184
  s_mov_b32 s91, 0x00020000
  s_mov_b32 s12, s4
  s_and_b32 s13, s5, 0xffff
  s_mov_b32 s14, 19267584
  s_mov_b32 s15, 0x00020000
  s_movk_i32 s54, 112
  s_mov_b32 s16, s10
  s_and_b32 s17, s11, 0xffff
  s_mov_b32 s18, 19267584
  s_mov_b32 s19, 0x00020000
  s_mov_b32 s4, s8
  s_and_b32 s5, s9, 0xffff
  s_mov_b32 s6, 73728
  s_mov_b32 s7, 0x00020000
  s_mov_b32 s8, s84
  s_and_b32 s9, s85, 0xffff
  s_mov_b32 s10, 256
  s_mov_b32 s11, 0x00020000
  s_mov_b32 s20, s86
  s_and_b32 s21, s87, 0xffff
  s_mov_b32 s22, 73728
  s_mov_b32 s23, 0x00020000
  v_lshlrev_b32 v1, 4, v0
  v_add_u32 v2, 36864, v1
  s_and_b32 s40, s24, 3
  s_lshl_b32 s40, s40, 10
  v_bfe_u32 v130, v128, 1, 3
  v_xor_b32 v130, v130, v129
  v_lshlrev_b32 v131, 7, v128
  v_lshl_add_u32 v131, v130, 4, v131
  s_lshr_b32 s46, s24, 2
  s_mul_i32 s47, s46, 12288
  s_add_u32 s47, s47, 0
  v_add_u32 v97, s47, v131
  v_xor_b32 v98, 64, v97
  s_mul_i32 s47, s40, 6
  s_add_u32 s47, s47, 24576
  v_add_u32 v99, s47, v131
  v_xor_b32 v100, 64, v99
  v_mov_b32 v135, 0
  v_mov_b32 v134, 0
  s_lshr_b32 s46, s24, 2
  s_mul_i32 s46, s46, 3072
  s_mul_i32 s47, s40, 18
  s_add_u32 s46, s46, s47
  s_sub_u32 s46, 58368, s46
  v_add_u32 v101, s46, v1
  s_cbranch_vccz SL2
  v_mov_b32 v13, 0
  v_mov_b32 v14, 0
  v_mov_b32 v3, 0
  v_mov_b32 v4, 0
  s_branch SM2
SL2:
  s_lshl_b32 s46, s29, 1
  s_xor_b32 s46, s46, s56
  s_mul_i32 s47, s27, 222
  s_add_i32 s31, s46, s47
  s_mul_i32 s31, s31, 86016
  s_mul_i32 s32, s27, -688128
  s_add_i32 s32, s32, 344064
  s_lshr_b32 s33, s29, 31
  s_lshl_b32 s33, s33, 1
  s_lshl_b32 s38, s40, 2
  s_add_u32 s39, s38, 3072
  s_min_u32 s39, s39, 14336
  s_mul_i32 s48, s27, 172032
  s_sub_u32 s49, 172032, s48
  v_mov_b32 v132, s48
  v_mov_b32 v133, s49
  s_lshr_b32 s46, s38, 4
  s_add_u32 s46, s46, 0
  v_add_u32 v130, s46, v0
  v_mul_u32_u24 v13, 2731, v130
  v_lshrrev_b32 v13, 16, v13
  v_cmp_le_u32 s[52:53], 20, v13
  v_mul_u32_u24 v131, 24, v13
  v_sub_u32 v130, v130, v131
  v_subrev_u32 v131, 20, v13
  v_cndmask_b32 v13, v13, v131, s[52:53]
  v_bfe_u32 v131, v13, 1, 3
  v_xor_b32 v130, v130, v131
  v_cndmask_b32 v131, v132, v133, s[52:53]
  v_lshl_add_u32 v130, v130, 4, v131
  v_add_u32 v13, s30, v13
  v_max_i32 v13, 0, v13
  v_lshlrev_b32 v13, 1, v13
  v_xor_b32 v13, s58, v13
  v_add_u32 v13, s59, v13
  v_mul_u32_u24 v13, 384, v13
  v_add_u32 v13, v13, v130
  s_lshr_b32 s46, s38, 4
  s_add_u32 s46, s46, 64
  v_add_u32 v130, s46, v0
  v_mul_u32_u24 v14, 2731, v130
  v_lshrrev_b32 v14, 16, v14
  v_cmp_le_u32 s[52:53], 20, v14
  v_mul_u32_u24 v131, 24, v14
  v_sub_u32 v130, v130, v131
  v_subrev_u32 v131, 20, v14
  v_cndmask_b32 v14, v14, v131, s[52:53]
  v_bfe_u32 v131, v14, 1, 3
  v_xor_b32 v130, v130, v131
  v_cndmask_b32 v131, v132, v133, s[52:53]
  v_lshl_add_u32 v130, v130, 4, v131
  v_add_u32 v14, s30, v14
  v_max_i32 v14, 0, v14
  v_lshlrev_b32 v14, 1, v14
  v_xor_b32 v14, s58, v14
  v_add_u32 v14, s59, v14
  v_mul_u32_u24 v14, 384, v14
  v_add_u32 v14, v14, v130
  s_lshr_b32 s46, s38, 4
  s_add_u32 s46, s46, 128
  v_add_u32 v130, s46, v0
  v_mul_u32_u24 v3, 2731, v130
  v_lshrrev_b32 v3, 16, v3
  v_cmp_le_u32 s[52:53], 20, v3
  v_mul_u32_u24 v131, 24, v3
  v_sub_u32 v130, v130, v131
  v_subrev_u32 v131, 20, v3
  v_cndmask_b32 v3, v3, v131, s[52:53]
  v_bfe_u32 v131, v3, 1, 3
  v_xor_b32 v130, v130, v131
  v_cndmask_b32 v131, v132, v133, s[52:53]
  v_lshl_add_u32 v130, v130, 4, v131
  v_add_u32 v3, s30, v3
  v_max_i32 v3, 0, v3
  v_lshlrev_b32 v3, 1, v3
  v_xor_b32 v3, s58, v3
  v_add_u32 v3, s59, v3
  v_mul_u32_u24 v3, 384, v3
  v_add_u32 v3, v3, v130
  s_lshr_b32 s46, s39, 4
  v_add_u32 v130, s46, v0
  v_mul_u32_u24 v4, 2731, v130
  v_lshrrev_b32 v4, 16, v4
  v_cmp_le_u32 s[52:53], 20, v4
  v_mul_u32_u24 v131, 24, v4
  v_sub_u32 v130, v130, v131
  v_subrev_u32 v131, 20, v4
  v_cndmask_b32 v4, v4, v131, s[52:53]
  v_bfe_u32 v131, v4, 1, 3
  v_xor_b32 v130, v130, v131
  v_cndmask_b32 v131, v132, v133, s[52:53]
  v_lshl_add_u32 v130, v130, 4, v131
  v_add_u32 v4, s30, v4
  v_max_i32 v4, 0, v4
  v_lshlrev_b32 v4, 1, v4
  v_xor_b32 v4, s58, v4
  v_add_u32 v4, s59, v4
  v_mul_u32_u24 v4, 384, v4
  v_add_u32 v4, v4, v130
  s_add_u32 s38, s38, 10240
  s_add_u32 s39, s39, 10240
  s_lshl_b32 s46, s25, 2
  s_add_i32 s46, s46, -2
  s_max_i32 s46, s46, 0
  s_add_i32 s46, s46, s37
  s_max_i32 s46, s46, 0
  s_sub_i32 s46, s46, s29
  s_lshl_b32 s34, s25, 2
  s_add_i32 s34, s34, s37
  s_max_i32 s34, s34, 0
  s_sub_i32 s34, s34, s29
  s_sub_u32 s46, s34, s46
  s_lshr_b32 s46, s46, 1
  s_mul_i32 s36, s46, -8
  s_add_i32 s36, s36, 7
  s_add_i32 s34, s34, -1
  s_add_i32 s35, s34, s36
  s_mul_i32 s36, s36, 7680
  s_lshl_b32 s47, s26, 2
  s_mul_i32 s46, s34, 7680
  s_add_i32 s46, s46, 10240
  v_add_u32 v130, s47, v128
  v_bfe_u32 v131, v130, 1, 3
  v_xor_b32 v131, v131, v129
  v_mul_u32_u24 v130, 384, v130
  v_lshl_add_u32 v130, v131, 4, v130
  v_add_u32 v7, s46, v130
  v_xor_b32 v8, 64, v7
  v_lshrrev_b32 v130, 2, v128
  v_lshl_add_u32 v130, v129, 2, v130
  v_add_u32 v130, s47, v130
  v_bfe_u32 v131, v130, 1, 3
  v_and_b32 v132, 2, v128
  v_lshlrev_b32 v132, 1, v132
  v_xor_b32 v131, v131, v132
  v_mul_u32_u24 v130, 384, v130
  v_lshl_add_u32 v130, v131, 4, v130
  v_and_b32 v131, 1, v128
  v_lshl_add_u32 v130, v131, 3, v130
  v_add_u32 v9, s46, v130
  v_xor_b32 v10, 16, v9
  v_xor_b32 v11, 32, v9
  v_xor_b32 v12, 48, v9
  v_lshl_add_u32 v130, v129, 2, s47
  v_sub_u32 v19, v130, v19
  v_cndmask_b32 v19, v19, 64, s[44:45]
  v_add_u32 v20, s36, v7
  v_add_u32 v0, s36, v8
  v_add_u32 v15, s36, v9
  v_add_u32 v16, s36, v10
  v_add_u32 v17, s36, v11
  v_add_u32 v18, s36, v12
  s_mov_b32 s93, 1037384597
SM2:
  s_cbranch_vccnz SL3
  s_add_i32 m0, s41, 49152
  s_add_i32 s100, s92, 128
  buffer_load_dwordx4 v96, s[88:91], s100 offen lds
  s_add_i32 m0, s41, 57344
  s_add_i32 s100, s92, 73856
  buffer_load_dwordx4 v96, s[88:91], s100 offen lds
  s_add_i32 m0, s41, 65536
  s_add_i32 s100, s92, 147584
  buffer_load_dwordx4 v96, s[88:91], s100 offen lds
  s_add_i32 m0, s41, 73728
  s_add_i32 s100, s92, 512
  buffer_load_dwordx4 v96, s[88:91], s100 offen lds
  s_add_i32 m0, s41, 81920
  s_add_i32 s100, s92, 74240
  buffer_load_dwordx4 v96, s[88:91], s100 offen lds
  s_add_i32 m0, s41, 90112
  s_add_i32 s100, s92, 147968
  buffer_load_dwordx4 v96, s[88:91], s100 offen lds
  s_add_i32 m0, s41, 45056
  s_add_i32 s100, s92, -36736
  buffer_load_dwordx4 v96, s[88:91], s100 offen lds
  s_add_i32 m0, s41, 53248
  s_add_i32 s100, s92, 36992
  buffer_load_dwordx4 v96, s[88:91], s100 offen lds
  s_add_i32 m0, s41, 61440
  s_add_i32 s100, s92, 110720
  buffer_load_dwordx4 v96, s[88:91], s100 offen lds
  s_add_i32 m0, s41, 69632
  s_add_i32 s100, s92, -36352
  buffer_load_dwordx4 v96, s[88:91], s100 offen lds
  s_add_i32 m0, s41, 77824
  s_add_i32 s100, s92, 37376
  buffer_load_dwordx4 v96, s[88:91], s100 offen lds
  s_add_i32 m0, s41, 86016
  s_add_i32 s100, s92, 111104
  buffer_load_dwordx4 v96, s[88:91], s100 offen lds
SL3:
  s_cbranch_vccz SL4
  s_waitcnt vmcnt(0)
  s_branch SM4
SL4:
  s_waitcnt vmcnt(12)
SM4:
  s_barrier
  ds_read_b128 v[208:211], v99 offset:0
  ds_read_b128 v[212:215], v99 offset:2048
  ds_read_b128 v[216:219], v99 offset:4096
  ds_read_b128 v[184:187], v97 offset:0
  ds_read_b128 v[188:191], v97 offset:2048
  ds_read_b128 v[192:195], v97 offset:4096
  ds_read_b128 v[196:199], v97 offset:6144
  ds_read_b128 v[200:203], v97 offset:8192
  ds_read_b128 v[204:207], v97 offset:10240
  s_waitcnt lgkmcnt(5)
  v_mfma_f32_16x16x32_bf16 v[24:27], v[184:187], v[208:211], 0
  s_cbranch_vccz SL5
  s_add_i32 m0, s41, 98304
  s_add_i32 s100, s92, 256
  buffer_load_dwordx4 v96, s[88:91], s100 offen lds
SL5:
  v_mfma_f32_16x16x32_bf16 v[28:31], v[184:187], v[212:215], 0
  s_cbranch_vccz SL6
  s_add_i32 m0, s41, 106496
  s_add_i32 s100, s92, 73984
  buffer_load_dwordx4 v96, s[88:91], s100 offen lds
SL6:
  v_mfma_f32_16x16x32_bf16 v[32:35], v[184:187], v[216:219], 0
  s_waitcnt lgkmcnt(4)
  v_mfma_f32_16x16x32_bf16 v[36:39], v[188:191], v[208:211], 0
  ds_read_b128 v[244:247], v100 offset:0
  s_cbranch_vccz SL7
  s_add_i32 m0, s41, 114688
  s_add_i32 s100, s92, 147712
  buffer_load_dwordx4 v96, s[88:91], s100 offen lds
SL7:
  v_mfma_f32_16x16x32_bf16 v[40:43], v[188:191], v[212:215], 0
  ds_read_b128 v[248:251], v100 offset:2048
  s_cbranch_vccz SL8
  s_add_i32 m0, s41, 122880
  s_add_i32 s100, s92, 640
  buffer_load_dwordx4 v96, s[88:91], s100 offen lds
SL8:
  v_mfma_f32_16x16x32_bf16 v[44:47], v[188:191], v[216:219], 0
  s_waitcnt lgkmcnt(5)
  v_mfma_f32_16x16x32_bf16 v[48:51], v[192:195], v[208:211], 0
  ds_read_b128 v[252:255], v100 offset:4096
  s_cbranch_vccz SL9
  s_add_i32 m0, s41, 131072
  s_add_i32 s100, s92, 74368
  buffer_load_dwordx4 v96, s[88:91], s100 offen lds
SL9:
  v_mfma_f32_16x16x32_bf16 v[52:55], v[192:195], v[212:215], 0
  ds_read_b128 v[220:223], v98 offset:0
  s_cbranch_vccz SL10
  s_add_i32 m0, s41, 139264
  s_add_i32 s100, s92, 148096
  buffer_load_dwordx4 v96, s[88:91], s100 offen lds
SL10:
  v_mfma_f32_16x16x32_bf16 v[56:59], v[192:195], v[216:219], 0
  s_waitcnt lgkmcnt(6)
  v_mfma_f32_16x16x32_bf16 v[60:63], v[196:199], v[208:211], 0
  ds_read_b128 v[224:227], v98 offset:2048
  s_cbranch_vccz SL11
  s_add_i32 m0, s41, 102400
  s_add_i32 s100, s92, 37120
  buffer_load_dwordx4 v96, s[88:91], s100 offen lds
SL11:
  v_mfma_f32_16x16x32_bf16 v[64:67], v[196:199], v[212:215], 0
  ds_read_b128 v[228:231], v98 offset:4096
  s_cbranch_vccz SL12
  s_add_i32 m0, s41, 110592
  s_add_i32 s100, s92, 110848
  buffer_load_dwordx4 v96, s[88:91], s100 offen lds
SL12:
  v_mfma_f32_16x16x32_bf16 v[68:71], v[196:199], v[216:219], 0
  s_waitcnt lgkmcnt(7)
  v_mfma_f32_16x16x32_bf16 v[72:75], v[200:203], v[208:211], 0
  ds_read_b128 v[232:235], v98 offset:6144
  s_cbranch_vccz SL13
  s_add_i32 m0, s41, 118784
  s_add_i32 s100, s92, 184576
  buffer_load_dwordx4 v96, s[88:91], s100 offen lds
SL13:
  v_mfma_f32_16x16x32_bf16 v[76:79], v[200:203], v[212:215], 0
  ds_read_b128 v[236:239], v98 offset:8192
  s_cbranch_vccz SL14
  s_add_i32 m0, s41, 126976
  s_add_i32 s100, s92, 37504
  buffer_load_dwordx4 v96, s[88:91], s100 offen lds
SL14:
  v_mfma_f32_16x16x32_bf16 v[80:83], v[200:203], v[216:219], 0
  s_waitcnt lgkmcnt(8)
  v_mfma_f32_16x16x32_bf16 v[84:87], v[204:207], v[208:211], 0
  ds_read_b128 v[240:243], v98 offset:10240
  s_cbranch_vccz SL15
  s_add_i32 m0, s41, 135168
  s_add_i32 s100, s92, 111232
  buffer_load_dwordx4 v96, s[88:91], s100 offen lds
SL15:
  v_mfma_f32_16x16x32_bf16 v[88:91], v[204:207], v[212:215], 0
  s_cbranch_vccz SL16
  s_add_i32 m0, s41, 143360
  s_add_i32 s100, s92, 184960
  buffer_load_dwordx4 v96, s[88:91], s100 offen lds
SL16:
  v_mfma_f32_16x16x32_bf16 v[92:95], v[204:207], v[216:219], 0
  v_lshrrev_b32 v107, 4, v1
  s_cmp_lt_u32 s2, 72
  s_cbranch_scc0 MK_np1
  s_mul_hi_u32 s54, s2, 0x15555556
  s_lshl_b32 s54, s54, 6
  s_mul_i32 s55, s24, 6144
  s_add_u32 s100, s54, s55
  v_lshrrev_b32 v104, 2, v107
  v_mul_u32_u24 v104, 384, v104
  v_and_b32 v105, 3, v107
  v_lshl_add_u32 v104, v105, 4, v104
  s_add_u32 m0, s41, 147456
  s_nop 0
  buffer_load_dwordx4 v104, s[4:7], s100 offen lds
  s_mul_i32 s55, s40, 6
  s_add_u32 s100, s54, s55
  s_add_u32 m0, s40, 155648
  s_add_u32 s100, s100, 49152
  buffer_load_dwordx4 v104, s[4:7], s100 offen lds
MK_np1:
  s_sub_u32 s3, s2, 72
  s_lshr_b32 s3, s3, 31
  s_lshr_b32 s3, s3, s25
  s_cmp_eq_u32 s3, 0
  s_cbranch_scc1 MK_np3
  s_mul_hi_u32 s54, s2, 0x15555556
  s_mul_i32 s55, s54, 12
  s_sub_u32 s55, s2, s55
  s_cmp_ge_u32 s55, 6
  s_cselect_b32 s51, 1, 0
  s_mul_i32 s100, s51, 6
  s_sub_u32 s55, s55, s100
  v_lshrrev_b32 v106, 2, v128
  v_and_b32 v105, 3, v128
  v_lshl_add_u32 v134, v129, 3, v106
  v_lshlrev_b32 v134, 6, v134
  v_lshl_add_u32 v134, v105, 4, v134
  s_lshl_b32 s51, s51, 3
  s_add_u32 s51, s51, 147456
  v_add_u32 v134, s51, v134
  s_lshr_b32 s54, s55, 1
  s_lshl_b32 s54, s54, 6
  s_and_b32 s55, s55, 1
  s_lshl_b32 s55, s55, 4
  s_add_u32 s54, s54, s55
  v_lshrrev_b32 v104, 1, v106
  v_lshlrev_b32 v104, 5, v104
  v_and_b32 v106, 1, v106
  v_lshl_add_u32 v104, v106, 2, v104
  v_add3_u32 v104, v104, v105, s54
  v_mul_u32_u24 v104, 1152, v104
  v_lshl_add_u32 v135, v129, 4, v104
  s_mul_i32 s100, s26, 9216
  buffer_load_dwordx4 v[136:139], v135, s[88:91], s100 offen offset:768
  buffer_load_dwordx4 v[140:143], v135, s[88:91], s100 offen offset:832
  buffer_load_dwordx4 v[144:147], v135, s[88:91], s100 offen offset:896
  buffer_load_dwordx4 v[148:151], v135, s[88:91], s100 offen offset:960
  buffer_load_dwordx4 v[152:155], v135, s[88:91], s100 offen offset:1024
  buffer_load_dwordx4 v[156:159], v135, s[88:91], s100 offen offset:1088
MK_np3:
  s_cbranch_vccz SL18
  s_waitcnt vmcnt(63) lgkmcnt(0)
  s_branch SM18
SL18:
  s_cmp_lg_u32 s3, 0
  s_cbranch_scc1 CA17
  s_cmp_lt_u32 s2, 72
  s_cbranch_scc1 CB17
  s_waitcnt vmcnt(0)
CB17:
  s_waitcnt vmcnt(2)
CA17:
  s_waitcnt vmcnt(8) lgkmcnt(0)
SM18:
  s_barrier
  v_add_u32 v97, 49152, v97
  v_add_u32 v98, 49152, v98
  v_add_u32 v99, 49152, v99
  v_add_u32 v100, 49152, v100
  v_mfma_f32_16x16x32_bf16 v[24:27], v[220:223], v[244:247], v[24:27]
  ds_read_b128 v[208:211], v99 offset:0
  s_cbranch_vccnz SL19
  buffer_load_dwordx4 v[160:163], v6, s[12:15], 0 offen offset:0
SL19:
  v_mfma_f32_16x16x32_bf16 v[28:31], v[220:223], v[248:251], v[28:31]
  ds_read_b128 v[212:215], v99 offset:2048
  v_mfma_f32_16x16x32_bf16 v[32:35], v[220:223], v[252:255], v[32:35]
  v_mfma_f32_16x16x32_bf16 v[36:39], v[224:227], v[244:247], v[36:39]
  ds_read_b128 v[216:219], v99 offset:4096
  v_mfma_f32_16x16x32_bf16 v[40:43], v[224:227], v[248:251], v[40:43]
  ds_read_b128 v[184:187], v97 offset:0
  s_cbranch_vccnz SL20
  buffer_load_dwordx4 v[164:167], v6, s[12:15], 0 offen offset:64
SL20:
  v_mfma_f32_16x16x32_bf16 v[44:47], v[224:227], v[252:255], v[44:47]
  v_mfma_f32_16x16x32_bf16 v[48:51], v[228:231], v[244:247], v[48:51]
  ds_read_b128 v[188:191], v97 offset:2048
  v_mfma_f32_16x16x32_bf16 v[52:55], v[228:231], v[248:251], v[52:55]
  ds_read_b128 v[192:195], v97 offset:4096
  v_mfma_f32_16x16x32_bf16 v[56:59], v[228:231], v[252:255], v[56:59]
  v_mfma_f32_16x16x32_bf16 v[60:63], v[232:235], v[244:247], v[60:63]
  ds_read_b128 v[196:199], v97 offset:6144
  s_cbranch_vccnz SL21
  buffer_load_dwordx4 v[168:171], v6, s[12:15], 0 offen offset:128
SL21:
  v_mfma_f32_16x16x32_bf16 v[64:67], v[232:235], v[248:251], v[64:67]
  ds_read_b128 v[200:203], v97 offset:8192
  v_mfma_f32_16x16x32_bf16 v[68:71], v[232:235], v[252:255], v[68:71]
  v_mfma_f32_16x16x32_bf16 v[72:75], v[236:239], v[244:247], v[72:75]
  ds_read_b128 v[204:207], v97 offset:10240
  v_mfma_f32_16x16x32_bf16 v[76:79], v[236:239], v[248:251], v[76:79]
  s_cbranch_vccnz SL22
  buffer_load_dwordx4 v[172:175], v6, s[12:15], 0 offen offset:192
SL22:
  v_mfma_f32_16x16x32_bf16 v[80:83], v[236:239], v[252:255], v[80:83]
  v_mfma_f32_16x16x32_bf16 v[84:87], v[240:243], v[244:247], v[84:87]
  v_mfma_f32_16x16x32_bf16 v[88:91], v[240:243], v[248:251], v[88:91]
  v_mfma_f32_16x16x32_bf16 v[92:95], v[240:243], v[252:255], v[92:95]
  s_cbranch_vccz SL23
  s_lshl_b32 s46, s29, 1
  s_xor_b32 s46, s46, s56
  s_mul_i32 s47, s27, 222
  s_add_i32 s31, s46, s47
  s_mul_i32 s31, s31, 86016
  s_mul_i32 s32, s27, -688128
  s_add_i32 s32, s32, 344064
  s_lshr_b32 s33, s29, 31
  s_lshl_b32 s33, s33, 1
  s_lshl_b32 s38, s40, 2
  s_add_u32 s39, s38, 3072
  s_min_u32 s39, s39, 14336
  s_mul_i32 s48, s27, 172032
  s_sub_u32 s49, 172032, s48
  v_mov_b32 v132, s48
  v_mov_b32 v133, s49
  s_lshr_b32 s46, s38, 4
  s_add_u32 s46, s46, 0
  v_add_u32 v130, s46, v0
  v_mul_u32_u24 v13, 2731, v130
  v_lshrrev_b32 v13, 16, v13
  v_cmp_le_u32 s[52:53], 20, v13
  v_mul_u32_u24 v131, 24, v13
  v_sub_u32 v130, v130, v131
  v_subrev_u32 v131, 20, v13
  v_cndmask_b32 v13, v13, v131, s[52:53]
  v_bfe_u32 v131, v13, 1, 3
  v_xor_b32 v130, v130, v131
  v_cndmask_b32 v131, v132, v133, s[52:53]
  v_lshl_add_u32 v130, v130, 4, v131
  v_add_u32 v13, s30, v13
  v_max_i32 v13, 0, v13
  v_lshlrev_b32 v13, 1, v13
  v_xor_b32 v13, s58, v13
  v_add_u32 v13, s59, v13
  v_mul_u32_u24 v13, 384, v13
  v_add_u32 v13, v13, v130
  s_lshr_b32 s46, s38, 4
  s_add_u32 s46, s46, 64
  v_add_u32 v130, s46, v0
  v_mul_u32_u24 v14, 2731, v130
  v_lshrrev_b32 v14, 16, v14
  v_cmp_le_u32 s[52:53], 20, v14
  v_mul_u32_u24 v131, 24, v14
  v_sub_u32 v130, v130, v131
  v_subrev_u32 v131, 20, v14
  v_cndmask_b32 v14, v14, v131, s[52:53]
  v_bfe_u32 v131, v14, 1, 3
  v_xor_b32 v130, v130, v131
  v_cndmask_b32 v131, v132, v133, s[52:53]
  v_lshl_add_u32 v130, v130, 4, v131
  v_add_u32 v14, s30, v14
  v_max_i32 v14, 0, v14
  v_lshlrev_b32 v14, 1, v14
  v_xor_b32 v14, s58, v14
  v_add_u32 v14, s59, v14
  v_mul_u32_u24 v14, 384, v14
  v_add_u32 v14, v14, v130
  s_lshr_b32 s46, s38, 4
  s_add_u32 s46, s46, 128
  v_add_u32 v130, s46, v0
  v_mul_u32_u24 v3, 2731, v130
  v_lshrrev_b32 v3, 16, v3
  v_cmp_le_u32 s[52:53], 20, v3
  v_mul_u32_u24 v131, 24, v3
  v_sub_u32 v130, v130, v131
  v_subrev_u32 v131, 20, v3
  v_cndmask_b32 v3, v3, v131, s[52:53]
  v_bfe_u32 v131, v3, 1, 3
  v_xor_b32 v130, v130, v131
  v_cndmask_b32 v131, v132, v133, s[52:53]
  v_lshl_add_u32 v130, v130, 4, v131
  v_add_u32 v3, s30, v3
  v_max_i32 v3, 0, v3
  v_lshlrev_b32 v3, 1, v3
  v_xor_b32 v3, s58, v3
  v_add_u32 v3, s59, v3
  v_mul_u32_u24 v3, 384, v3
  v_add_u32 v3, v3, v130
  s_lshr_b32 s46, s39, 4
  v_add_u32 v130, s46, v0
  v_mul_u32_u24 v4, 2731, v130
  v_lshrrev_b32 v4, 16, v4
  v_cmp_le_u32 s[52:53], 20, v4
  v_mul_u32_u24 v131, 24, v4
  v_sub_u32 v130, v130, v131
  v_subrev_u32 v131, 20, v4
  v_cndmask_b32 v4, v4, v131, s[52:53]
  v_bfe_u32 v131, v4, 1, 3
  v_xor_b32 v130, v130, v131
  v_cndmask_b32 v131, v132, v133, s[52:53]
  v_lshl_add_u32 v130, v130, 4, v131
  v_add_u32 v4, s30, v4
  v_max_i32 v4, 0, v4
  v_lshlrev_b32 v4, 1, v4
  v_xor_b32 v4, s58, v4
  v_add_u32 v4, s59, v4
  v_mul_u32_u24 v4, 384, v4
  v_add_u32 v4, v4, v130
  s_add_u32 s38, s38, 10240
  s_add_u32 s39, s39, 10240
  s_lshl_b32 s46, s25, 2
  s_add_i32 s46, s46, -2
  s_max_i32 s46, s46, 0
  s_add_i32 s46, s46, s37
  s_max_i32 s46, s46, 0
  s_sub_i32 s46, s46, s29
  s_lshl_b32 s34, s25, 2
  s_add_i32 s34, s34, s37
  s_max_i32 s34, s34, 0
  s_sub_i32 s34, s34, s29
  s_sub_u32 s46, s34, s46
  s_lshr_b32 s46, s46, 1
  s_mul_i32 s36, s46, -8
  s_add_i32 s36, s36, 7
  s_add_i32 s34, s34, -1
  s_add_i32 s35, s34, s36
  s_mul_i32 s36, s36, 7680
  s_lshl_b32 s47, s26, 2
  s_mul_i32 s46, s34, 7680
  s_add_i32 s46, s46, 10240
  v_add_u32 v130, s47, v128
  v_bfe_u32 v131, v130, 1, 3
  v_xor_b32 v131, v131, v129
  v_mul_u32_u24 v130, 384, v130
  v_lshl_add_u32 v130, v131, 4, v130
  v_add_u32 v7, s46, v130
  v_xor_b32 v8, 64, v7
  v_lshrrev_b32 v130, 2, v128
  v_lshl_add_u32 v130, v129, 2, v130
  v_add_u32 v130, s47, v130
  v_bfe_u32 v131, v130, 1, 3
  v_and_b32 v132, 2, v128
  v_lshlrev_b32 v132, 1, v132
  v_xor_b32 v131, v131, v132
  v_mul_u32_u24 v130, 384, v130
  v_lshl_add_u32 v130, v131, 4, v130
  v_and_b32 v131, 1, v128
  v_lshl_add_u32 v130, v131, 3, v130
  v_add_u32 v9, s46, v130
  v_xor_b32 v10, 16, v9
  v_xor_b32 v11, 32, v9
  v_xor_b32 v12, 48, v9
  v_lshl_add_u32 v130, v129, 2, s47
  v_sub_u32 v19, v130, v19
  v_cndmask_b32 v19, v19, 64, s[44:45]
  v_add_u32 v20, s36, v7
  v_add_u32 v0, s36, v8
  v_add_u32 v15, s36, v9
  v_add_u32 v16, s36, v10
  v_add_u32 v17, s36, v11
  v_add_u32 v18, s36, v12
  s_mov_b32 s93, 1037384597
  v_lshrrev_b32 v133, 4, v1
  v_lshrrev_b32 v130, 3, v133
  s_mul_i32 s50, s26, 7
  s_add_i32 s50, s50, s30
  v_cmp_lt_u32 s[52:53], 6, v130
  v_add_u32 v130, s50, v130
  v_max_i32 v131, 0, v130
  v_add3_u32 v130, v130, v131, 6
  v_xor_b32 v130, s58, v130
  v_add_u32 v130, s59, v130
  v_mul_u32_u24 v130, 384, v130
  v_and_b32 v131, 7, v133
  v_xor_b32 v131, v131, v129
  v_lshl_add_u32 v130, v131, 4, v130
  v_mov_b32 v131, 0x80000000
  v_cndmask_b32 v134, v130, v131, s[52:53]
  v_xor_b32 v135, 64, v134
  s_lshl_b32 s46, s25, 2
  s_add_i32 s46, s46, s37
  s_lshl_b32 s84, s46, 1
  s_add_i32 s84, s84, 2
  s_xor_b32 s84, s84, s56
  s_add_i32 s84, s84, s57
  s_mul_i32 s84, s84, 86016
  s_lshl_b32 s85, s46, 1
  s_add_i32 s85, s85, 4
  s_xor_b32 s85, s85, s56
  s_add_i32 s85, s85, s57
  s_mul_i32 s85, s85, 86016
  s_lshl_b32 s86, s46, 1
  s_add_i32 s86, s86, 6
  s_xor_b32 s86, s86, s56
  s_add_i32 s86, s86, s57
  s_mul_i32 s86, s86, 86016
  s_lshl_b32 s87, s46, 1
  s_add_i32 s87, s87, 8
  s_xor_b32 s87, s87, s56
  s_add_i32 s87, s87, s57
  s_mul_i32 s87, s87, 86016
  s_mul_i32 s101, s40, 6
  s_add_u32 s101, s101, 73728
  v_bfe_u32 v130, v128, 1, 3
  v_xor_b32 v130, v130, v129
  v_lshlrev_b32 v131, 7, v128
  v_lshl_add_u32 v131, v130, 4, v131
  v_lshrrev_b32 v130, 3, v128
  v_lshl_add_u32 v130, v130, 11, v131
  v_add_u32 v23, s101, v130
SL23:
  s_waitcnt lgkmcnt(5)
  v_mfma_f32_16x16x32_bf16 v[24:27], v[184:187], v[208:211], v[24:27]
  s_cbranch_vccnz SL24
  buffer_load_dwordx4 v[176:179], v6, s[12:15], 0 offen offset:256
SL24:
  v_mfma_f32_16x16x32_bf16 v[28:31], v[184:187], v[212:215], v[28:31]
  v_mfma_f32_16x16x32_bf16 v[32:35], v[184:187], v[216:219], v[32:35]
  s_waitcnt lgkmcnt(4)
  v_mfma_f32_16x16x32_bf16 v[36:39], v[188:191], v[208:211], v[36:39]
  ds_read_b128 v[244:247], v100 offset:0
  v_mfma_f32_16x16x32_bf16 v[40:43], v[188:191], v[212:215], v[40:43]
  ds_read_b128 v[248:251], v100 offset:2048
  s_cbranch_vccnz SL25
  buffer_load_dwordx4 v[180:183], v6, s[12:15], 0 offen offset:320
SL25:
  v_mfma_f32_16x16x32_bf16 v[44:47], v[188:191], v[216:219], v[44:47]
  s_waitcnt lgkmcnt(5)
  v_mfma_f32_16x16x32_bf16 v[48:51], v[192:195], v[208:211], v[48:51]
  ds_read_b128 v[252:255], v100 offset:4096
  v_mfma_f32_16x16x32_bf16 v[52:55], v[192:195], v[212:215], v[52:55]
  ds_read_b128 v[220:223], v98 offset:0
  v_mfma_f32_16x16x32_bf16 v[56:59], v[192:195], v[216:219], v[56:59]
  s_waitcnt lgkmcnt(6)
  v_mfma_f32_16x16x32_bf16 v[60:63], v[196:199], v[208:211], v[60:63]
  ds_read_b128 v[224:227], v98 offset:2048
  s_cbranch_vccnz SL26
  s_cmp_eq_u32 s25, 0
  s_cbranch_scc1 QB6
  buffer_load_dwordx4 v[136:139], v5, s[12:15], 0 offen offset:0
QB6:
SL26:
  v_mfma_f32_16x16x32_bf16 v[64:67], v[196:199], v[212:215], v[64:67]
  ds_read_b128 v[228:231], v98 offset:4096
  v_mfma_f32_16x16x32_bf16 v[68:71], v[196:199], v[216:219], v[68:71]
  s_waitcnt lgkmcnt(7)
  v_mfma_f32_16x16x32_bf16 v[72:75], v[200:203], v[208:211], v[72:75]
  ds_read_b128 v[232:235], v98 offset:6144
  v_mfma_f32_16x16x32_bf16 v[76:79], v[200:203], v[212:215], v[76:79]
  ds_read_b128 v[236:239], v98 offset:8192
  s_cbranch_vccnz SL27
  s_cmp_eq_u32 s25, 0
  s_cbranch_scc1 QB7
  buffer_load_dwordx4 v[140:143], v5, s[12:15], 0 offen offset:64
QB7:
SL27:
  v_mfma_f32_16x16x32_bf16 v[80:83], v[200:203], v[216:219], v[80:83]
  s_waitcnt lgkmcnt(8)
  v_mfma_f32_16x16x32_bf16 v[84:87], v[204:207], v[208:211], v[84:87]
  ds_read_b128 v[240:243], v98 offset:10240
  v_mfma_f32_16x16x32_bf16 v[88:91], v[204:207], v[212:215], v[88:91]
  v_mfma_f32_16x16x32_bf16 v[92:95], v[204:207], v[216:219], v[92:95]
  s_cbranch_vccz SL28
  s_waitcnt vmcnt(0) lgkmcnt(0)
  s_branch SM28
SL28:
  s_cmp_lg_u32 s25, 0
  s_cbranch_scc1 MK_c2
  s_waitcnt vmcnt(6)
MK_c2:
  s_waitcnt vmcnt(8) lgkmcnt(0)
SM28:
  s_barrier
  v_add_u32 v97, 49152, v97
  v_add_u32 v98, 49152, v98
  v_add_u32 v99, 49152, v99
  v_add_u32 v100, 49152, v100
  v_mfma_f32_16x16x32_bf16 v[24:27], v[220:223], v[244:247], v[24:27]
  ds_read_b128 v[208:211], v99 offset:0
  s_cbranch_vccnz SL29
  s_cmp_eq_u32 s25, 0
  s_cbranch_scc1 QB8
  buffer_load_dwordx4 v[144:147], v5, s[12:15], 0 offen offset:128
QB8:
SL29:
  v_mfma_f32_16x16x32_bf16 v[28:31], v[220:223], v[248:251], v[28:31]
  ds_read_b128 v[212:215], v99 offset:2048
  v_mfma_f32_16x16x32_bf16 v[32:35], v[220:223], v[252:255], v[32:35]
  v_mfma_f32_16x16x32_bf16 v[36:39], v[224:227], v[244:247], v[36:39]
  ds_read_b128 v[216:219], v99 offset:4096
  v_mfma_f32_16x16x32_bf16 v[40:43], v[224:227], v[248:251], v[40:43]
  ds_read_b128 v[184:187], v97 offset:0
  s_cbranch_vccnz SL30
  s_cmp_eq_u32 s25, 0
  s_cbranch_scc1 QB9
  buffer_load_dwordx4 v[148:151], v5, s[12:15], 0 offen offset:192
QB9:
SL30:
  v_mfma_f32_16x16x32_bf16 v[44:47], v[224:227], v[252:255], v[44:47]
  v_mfma_f32_16x16x32_bf16 v[48:51], v[228:231], v[244:247], v[48:51]
  ds_read_b128 v[188:191], v97 offset:2048
  v_mfma_f32_16x16x32_bf16 v[52:55], v[228:231], v[248:251], v[52:55]
  ds_read_b128 v[192:195], v97 offset:4096
  v_mfma_f32_16x16x32_bf16 v[56:59], v[228:231], v[252:255], v[56:59]
  v_mfma_f32_16x16x32_bf16 v[60:63], v[232:235], v[244:247], v[60:63]
  ds_read_b128 v[196:199], v97 offset:6144
  s_cbranch_vccnz SL31
  s_cmp_eq_u32 s25, 0
  s_cbranch_scc1 QB10
  buffer_load_dwordx4 v[152:155], v5, s[12:15], 0 offen offset:256
QB10:
SL31:
  v_mfma_f32_16x16x32_bf16 v[64:67], v[232:235], v[248:251], v[64:67]
  ds_read_b128 v[200:203], v97 offset:8192
  v_mfma_f32_16x16x32_bf16 v[68:71], v[232:235], v[252:255], v[68:71]
  v_mfma_f32_16x16x32_bf16 v[72:75], v[236:239], v[244:247], v[72:75]
  ds_read_b128 v[204:207], v97 offset:10240
  v_mfma_f32_16x16x32_bf16 v[76:79], v[236:239], v[248:251], v[76:79]
  s_cbranch_vccnz SL32
  s_cmp_eq_u32 s25, 0
  s_cbranch_scc1 QB11
  buffer_load_dwordx4 v[156:159], v5, s[12:15], 0 offen offset:320
QB11:
SL32:
  v_mfma_f32_16x16x32_bf16 v[80:83], v[236:239], v[252:255], v[80:83]
  v_mfma_f32_16x16x32_bf16 v[84:87], v[240:243], v[244:247], v[84:87]
  v_mfma_f32_16x16x32_bf16 v[88:91], v[240:243], v[248:251], v[88:91]
  v_mfma_f32_16x16x32_bf16 v[92:95], v[240:243], v[252:255], v[92:95]
  s_cmp_eq_u32 s3, 0
  s_cbranch_scc1 MK_np2
  s_waitcnt lgkmcnt(0)
  ds_read_b64_tr_b16 v[104:105], v134 offset:0
  ds_read_b64_tr_b16 v[106:107], v134 offset:256
  ds_read_b64_tr_b16 v[108:109], v134 offset:2048
  ds_read_b64_tr_b16 v[110:111], v134 offset:2304
  ds_read_b64_tr_b16 v[112:113], v134 offset:4096
  ds_read_b64_tr_b16 v[114:115], v134 offset:4352
  ds_read_b64_tr_b16 v[116:117], v134 offset:6144
  ds_read_b64_tr_b16 v[118:119], v134 offset:6400
  ds_read_b64_tr_b16 v[120:121], v134 offset:8192
  ds_read_b64_tr_b16 v[122:123], v134 offset:8448
  ds_read_b64_tr_b16 v[124:125], v134 offset:10240
  ds_read_b64_tr_b16 v[126:127], v134 offset:10496
  s_setprio 3
  s_waitcnt lgkmcnt(0)
  v_mfma_f32_16x16x32_bf16 v[128:131], v[136:139], v[104:107], 0
  v_mfma_f32_16x16x32_bf16 v[128:131], v[140:143], v[108:111], v[128:131]
  v_mfma_f32_16x16x32_bf16 v[128:131], v[144:147], v[112:115], v[128:131]
  v_mfma_f32_16x16x32_bf16 v[128:131], v[148:151], v[116:119], v[128:131]
  v_mfma_f32_16x16x32_bf16 v[128:131], v[152:155], v[120:123], v[128:131]
  v_mfma_f32_16x16x32_bf16 v[128:131], v[156:159], v[124:127], v[128:131]
  s_lshl_b32 s100, s2, 10
  s_lshl_b32 s54, s26, 3
  s_add_u32 s100, s100, s54
  s_nop 5
  v_cvt_pk_bf16_f32 v132, v128, v129
  v_cvt_pk_bf16_f32 v133, v130, v131
  buffer_store_dwordx2 v[132:133], v1, s[20:23], s100 offen sc1
  s_setprio 0
MK_np2:
  ds_read_b128 v[244:247], v100 offset:0
  ds_read_b128 v[248:251], v100 offset:2048
  ds_read_b128 v[252:255], v100 offset:4096
  ds_read_b128 v[220:223], v98 offset:0
  ds_read_b128 v[224:227], v98 offset:2048
  s_waitcnt lgkmcnt(5)
  v_mfma_f32_16x16x32_bf16 v[24:27], v[184:187], v[208:211], v[24:27]
  ds_read_b128 v[228:231], v98 offset:4096
  s_cbranch_vccz SL33
  s_add_u32 m0, s101, 0
  s_nop 0
  buffer_load_dwordx4 v134, s[12:15], s86 offen offset:0 lds
SL33:
  v_mfma_f32_16x16x32_bf16 v[36:39], v[188:191], v[208:211], v[36:39]
  ds_read_b128 v[232:235], v98 offset:6144
  s_waitcnt lgkmcnt(2)
  v_mfma_f32_16x16x32_bf16 v[36:39], v[224:227], v[244:247], v[36:39]
  ds_read_b128 v[236:239], v98 offset:8192
  v_mfma_f32_16x16x32_bf16 v[24:27], v[220:223], v[244:247], v[24:27]
  ds_read_b128 v[240:243], v98 offset:10240
  v_mfma_f32_16x16x32_bf16 v[28:31], v[184:187], v[212:215], v[28:31]
  v_mfma_f32_16x16x32_bf16 v[28:31], v[220:223], v[248:251], v[28:31]
  v_mfma_f32_16x16x32_bf16 v[40:43], v[188:191], v[212:215], v[40:43]
  s_cbranch_vccz SL34
  s_add_u32 m0, s101, 896
  s_nop 0
  buffer_load_dwordx4 v134, s[12:15], s86 offen offset:128 lds
SL34:
  v_mfma_f32_16x16x32_bf16 v[40:43], v[224:227], v[248:251], v[40:43]
  s_waitcnt lgkmcnt(0)
  v_mfma_f32_16x16x32_bf16 v[32:35], v[184:187], v[216:219], v[32:35]
  v_mfma_f32_16x16x32_bf16 v[32:35], v[220:223], v[252:255], v[32:35]
  v_cvt_pk_bf16_f32 v104, v24, v25
  v_cvt_pk_bf16_f32 v105, v26, v27
  v_mfma_f32_16x16x32_bf16 v[44:47], v[188:191], v[216:219], v[44:47]
  v_cvt_pk_bf16_f32 v106, v36, v37
  v_cvt_pk_bf16_f32 v107, v38, v39
  v_mfma_f32_16x16x32_bf16 v[44:47], v[224:227], v[252:255], v[44:47]
  ds_write_b128 v101, v[104:107] offset:14336
  v_mfma_f32_16x16x32_bf16 v[48:51], v[192:195], v[208:211], v[48:51]
  s_cbranch_vccz SL35
  s_add_u32 m0, s101, 1792
  s_nop 0
  buffer_load_dwordx4 v134, s[12:15], s86 offen offset:256 lds
SL35:
  v_mfma_f32_16x16x32_bf16 v[48:51], v[228:231], v[244:247], v[48:51]
  v_cvt_pk_bf16_f32 v108, v28, v29
  v_cvt_pk_bf16_f32 v109, v30, v31
  v_mfma_f32_16x16x32_bf16 v[60:63], v[196:199], v[208:211], v[60:63]
  v_cvt_pk_bf16_f32 v110, v40, v41
  v_cvt_pk_bf16_f32 v111, v42, v43
  v_mfma_f32_16x16x32_bf16 v[60:63], v[232:235], v[244:247], v[60:63]
  ds_write_b128 v101, v[108:111] offset:8192
  v_mfma_f32_16x16x32_bf16 v[52:55], v[192:195], v[212:215], v[52:55]
  v_mfma_f32_16x16x32_bf16 v[52:55], v[228:231], v[248:251], v[52:55]
  v_cvt_pk_bf16_f32 v112, v32, v33
  v_cvt_pk_bf16_f32 v113, v34, v35
  v_mfma_f32_16x16x32_bf16 v[64:67], v[196:199], v[212:215], v[64:67]
  v_cvt_pk_bf16_f32 v114, v44, v45
  v_cvt_pk_bf16_f32 v115, v46, v47
  s_cbranch_vccz SL36
  s_add_u32 m0, s101, 3072
  s_nop 0
  buffer_load_dwordx4 v135, s[12:15], s87 offen offset:0 lds
SL36:
  v_mfma_f32_16x16x32_bf16 v[64:67], v[232:235], v[248:251], v[64:67]
  ds_write_b128 v101, v[112:115] offset:2048
  v_mfma_f32_16x16x32_bf16 v[56:59], v[192:195], v[216:219], v[56:59]
  v_mfma_f32_16x16x32_bf16 v[56:59], v[228:231], v[252:255], v[56:59]
  v_cvt_pk_bf16_f32 v116, v48, v49
  v_cvt_pk_bf16_f32 v117, v50, v51
  v_mfma_f32_16x16x32_bf16 v[68:71], v[196:199], v[216:219], v[68:71]
  v_cvt_pk_bf16_f32 v118, v60, v61
  v_cvt_pk_bf16_f32 v119, v62, v63
  v_mfma_f32_16x16x32_bf16 v[68:71], v[232:235], v[252:255], v[68:71]
  ds_write_b128 v101, v[116:119] offset:13312
  v_mfma_f32_16x16x32_bf16 v[72:75], v[200:203], v[208:211], v[72:75]
  s_cbranch_vccz SL37
  s_add_u32 m0, s101, 3968
  s_nop 0
  buffer_load_dwordx4 v135, s[12:15], s87 offen offset:128 lds
SL37:
  v_mfma_f32_16x16x32_bf16 v[72:75], v[236:239], v[244:247], v[72:75]
  v_cvt_pk_bf16_f32 v120, v52, v53
  v_cvt_pk_bf16_f32 v121, v54, v55
  v_mfma_f32_16x16x32_bf16 v[84:87], v[204:207], v[208:211], v[84:87]
  v_cvt_pk_bf16_f32 v122, v64, v65
  v_cvt_pk_bf16_f32 v123, v66, v67
  v_mfma_f32_16x16x32_bf16 v[84:87], v[240:243], v[244:247], v[84:87]
  ds_write_b128 v101, v[120:123] offset:7168
  v_mfma_f32_16x16x32_bf16 v[76:79], v[200:203], v[212:215], v[76:79]
  v_mfma_f32_16x16x32_bf16 v[76:79], v[236:239], v[248:251], v[76:79]
  v_cvt_pk_bf16_f32 v124, v56, v57
  v_cvt_pk_bf16_f32 v125, v58, v59
  v_mfma_f32_16x16x32_bf16 v[88:91], v[204:207], v[212:215], v[88:91]
  v_cvt_pk_bf16_f32 v126, v68, v69
  v_cvt_pk_bf16_f32 v127, v70, v71
  s_cbranch_vccz SL38
  s_add_u32 m0, s101, 4864
  s_nop 0
  buffer_load_dwordx4 v135, s[12:15], s87 offen offset:256 lds
SL38:
  v_mfma_f32_16x16x32_bf16 v[88:91], v[240:243], v[248:251], v[88:91]
  ds_write_b128 v101, v[124:127] offset:1024
  v_mfma_f32_16x16x32_bf16 v[80:83], v[200:203], v[216:219], v[80:83]
  v_mfma_f32_16x16x32_bf16 v[80:83], v[236:239], v[252:255], v[80:83]
  v_cvt_pk_bf16_f32 v104, v72, v73
  v_cvt_pk_bf16_f32 v105, v74, v75
  v_mfma_f32_16x16x32_bf16 v[92:95], v[204:207], v[216:219], v[92:95]
  v_cvt_pk_bf16_f32 v106, v84, v85
  v_cvt_pk_bf16_f32 v107, v86, v87
  v_mfma_f32_16x16x32_bf16 v[92:95], v[240:243], v[252:255], v[92:95]
  ds_write_b128 v101, v[104:107] offset:12288
  v_cvt_pk_bf16_f32 v108, v76, v77
  v_cvt_pk_bf16_f32 v109, v78, v79
  v_cvt_pk_bf16_f32 v110, v88, v89
  v_cvt_pk_bf16_f32 v111, v90, v91
  ds_write_b128 v101, v[108:111] offset:6144
  s_nop 3
  v_cvt_pk_bf16_f32 v112, v80, v81
  v_cvt_pk_bf16_f32 v113, v82, v83
  v_cvt_pk_bf16_f32 v114, v92, v93
  v_cvt_pk_bf16_f32 v115, v94, v95
  ds_write_b128 v101, v[112:115] offset:0
  s_waitcnt lgkmcnt(0)
  s_barrier
  s_cmp_eq_u32 s25, 0
  s_cbranch_scc1 MK_single
  ds_read_b128 v[216:219], v2 offset:35840
  ds_read_b128 v[220:223], v2 offset:34816
  ds_read_b128 v[224:227], v2 offset:33792
  ds_read_b128 v[228:231], v2 offset:32768
  ds_read_b128 v[232:235], v2 offset:31744
  ds_read_b128 v[236:239], v2 offset:30720
  ds_read_b128 v[240:243], v2 offset:29696
  ds_read_b128 v[244:247], v2 offset:28672
  ds_read_b128 v[248:251], v2 offset:27648
  ds_read_b128 v[252:255], v2 offset:26624
  s_cbranch_vccz SL39
  s_add_u32 m0, s101, 24576
  s_nop 0
  buffer_load_dwordx4 v134, s[12:15], s84 offen offset:0 lds
  s_add_u32 m0, s101, 25472
  s_nop 0
  buffer_load_dwordx4 v134, s[12:15], s84 offen offset:128 lds
  s_add_u32 m0, s101, 26368
  s_nop 0
  buffer_load_dwordx4 v134, s[12:15], s84 offen offset:256 lds
  s_add_u32 m0, s101, 27648
  s_nop 0
  buffer_load_dwordx4 v135, s[12:15], s85 offen offset:0 lds
  s_add_u32 m0, s101, 28544
  s_nop 0
  buffer_load_dwordx4 v135, s[12:15], s85 offen offset:128 lds
  s_add_u32 m0, s101, 29440
  s_nop 0
  buffer_load_dwordx4 v135, s[12:15], s85 offen offset:256 lds
  s_mul_i32 s100, s32, 9
  s_add_i32 s100, s100, s31
  s_add_u32 m0, s38, 138240
  s_nop 0
  buffer_load_dwordx4 v13, s[12:15], s100 offen lds
  s_add_u32 m0, s38, 139264
  s_nop 0
  buffer_load_dwordx4 v14, s[12:15], s100 offen lds
  s_add_u32 m0, s38, 140288
  s_nop 0
  buffer_load_dwordx4 v3, s[12:15], s100 offen lds
  s_add_u32 m0, s39, 138240
  s_nop 0
  buffer_load_dwordx4 v4, s[12:15], s100 offen lds
  s_mul_i32 s100, s32, 8
  s_add_i32 s100, s100, s31
  s_add_u32 m0, s38, 122880
  s_nop 0
  buffer_load_dwordx4 v13, s[12:15], s100 offen lds
  s_add_u32 m0, s38, 123904
  s_nop 0
  buffer_load_dwordx4 v14, s[12:15], s100 offen lds
  s_add_u32 m0, s38, 124928
  s_nop 0
  buffer_load_dwordx4 v3, s[12:15], s100 offen lds
  s_add_u32 m0, s39, 122880
  s_nop 0
  buffer_load_dwordx4 v4, s[12:15], s100 offen lds
  s_waitcnt vmcnt(8) lgkmcnt(0)
  v_xor_b32 v130, 64, v23
  ds_read_b128 v[136:139], v23 offset:24576
  ds_read_b128 v[140:143], v130 offset:24576
  ds_read_b128 v[144:147], v23 offset:25600
  ds_read_b128 v[148:151], v130 offset:25600
  ds_read_b128 v[152:155], v23 offset:26624
  ds_read_b128 v[156:159], v130 offset:26624
  ds_read_b128 v[160:163], v23 offset:0
  ds_read_b128 v[164:167], v130 offset:0
  ds_read_b128 v[168:171], v23 offset:1024
  ds_read_b128 v[172:175], v130 offset:1024
  ds_read_b128 v[176:179], v23 offset:2048
  ds_read_b128 v[180:183], v130 offset:2048
  s_waitcnt lgkmcnt(0)
  s_barrier
  s_branch SM39
SL39:
  s_waitcnt vmcnt(0)
  s_setprio 1
SM39:
BODY:
  s_waitcnt lgkmcnt(6)
  v_mfma_f32_16x16x32_bf16 v[184:187], v[216:219], v[136:139], 0
  v_mov_b32 v64, 0xff800000
  v_add_u32 v65, 0, v19
  v_mfma_f32_16x16x32_bf16 v[184:187], v[220:223], v[140:143], v[184:187]
  v_add_u32 v66, 1, v19
  v_add_u32 v67, 2, v19
  v_mfma_f32_16x16x32_bf16 v[184:187], v[224:227], v[144:147], v[184:187]
  v_add_u32 v68, 3, v19
  v_cmp_gt_u32 s[48:49], 7, v65
  v_mfma_f32_16x16x32_bf16 v[192:195], v[216:219], v[160:163], 0
  ds_read_b128 v[216:219], v2 offset:25600
  v_cmp_gt_u32 s[50:51], 7, v66
  v_mfma_f32_16x16x32_bf16 v[192:195], v[220:223], v[164:167], v[192:195]
  ds_read_b128 v[220:223], v2 offset:24576
  v_cmp_gt_u32 s[52:53], 7, v67
  v_mfma_f32_16x16x32_bf16 v[192:195], v[224:227], v[168:171], v[192:195]
  ds_read_b128 v[224:227], v2 offset:23552
  v_cmp_gt_u32 s[54:55], 7, v68
  v_mfma_f32_16x16x32_bf16 v[192:195], v[228:231], v[172:175], v[192:195]
  s_add_i32 s46, s34, 8
  s_waitcnt lgkmcnt(5)
  v_mfma_f32_16x16x32_bf16 v[192:195], v[232:235], v[176:179], v[192:195]
  v_sub_u32 v69, s46, v22
  s_add_i32 s46, s34, 1
  v_mfma_f32_16x16x32_bf16 v[192:195], v[236:239], v[180:183], v[192:195]
  v_sub_u32 v70, s46, v22
  s_add_i32 s46, s34, 6
  v_mfma_f32_16x16x32_bf16 v[184:187], v[228:231], v[148:151], v[184:187]
  ds_read_b128 v[228:231], v2 offset:22528
  v_sub_u32 v71, s46, v21
  v_mfma_f32_16x16x32_bf16 v[184:187], v[232:235], v[152:155], v[184:187]
  ds_read_b128 v[232:235], v2 offset:21504
  s_add_i32 s46, s34, 0
  v_mfma_f32_16x16x32_bf16 v[184:187], v[236:239], v[156:159], v[184:187]
  ds_read_b128 v[236:239], v2 offset:20480
  v_sub_u32 v72, s46, v21
  v_mfma_f32_16x16x32_bf16 v[188:191], v[240:243], v[136:139], 0
  v_sub_u32 v73, s35, v21
  v_cndmask_b32 v32, v64, 0, s[48:49]
  v_mfma_f32_16x16x32_bf16 v[188:191], v[244:247], v[140:143], v[188:191]
  v_cndmask_b32 v33, v64, 0, s[50:51]
  s_waitcnt lgkmcnt(4)
  v_mfma_f32_16x16x32_bf16 v[188:191], v[248:251], v[144:147], v[188:191]
  v_cndmask_b32 v34, v64, 0, s[52:53]
  v_cndmask_b32 v35, v64, 0, s[54:55]
  v_mfma_f32_16x16x32_bf16 v[196:199], v[240:243], v[160:163], 0
  ds_read_b128 v[240:243], v2 offset:19456
  v_cmp_gt_u32 s[46:47], 7, v69
  v_mfma_f32_16x16x32_bf16 v[196:199], v[244:247], v[164:167], v[196:199]
  ds_read_b128 v[244:247], v2 offset:18432
  v_cmp_gt_u32 s[48:49], 7, v70
  v_mfma_f32_16x16x32_bf16 v[196:199], v[248:251], v[168:171], v[196:199]
  ds_read_b128 v[248:251], v2 offset:17408
  v_cmp_gt_u32 s[50:51], 7, v71
  v_mfma_f32_16x16x32_bf16 v[196:199], v[252:255], v[172:175], v[196:199]
  v_cmp_gt_u32 s[52:53], 7, v72
  v_cmp_gt_u32 s[54:55], 7, v73
  v_mfma_f32_16x16x32_bf16 v[196:199], v[216:219], v[176:179], v[196:199]
  v_cndmask_b32 v84, v64, v32, s[46:47]
  v_cndmask_b32 v85, v64, v33, s[46:47]
  v_mfma_f32_16x16x32_bf16 v[196:199], v[220:223], v[180:183], v[196:199]
  v_cndmask_b32 v86, v64, v34, s[46:47]
  v_mul_f32 v192, s93, v192
  v_mfma_f32_16x16x32_bf16 v[188:191], v[252:255], v[148:151], v[188:191]
  ds_read_b128 v[252:255], v2 offset:16384
  v_mul_f32 v193, s93, v193
  v_mfma_f32_16x16x32_bf16 v[188:191], v[216:219], v[152:155], v[188:191]
  ds_read_b128 v[216:219], v2 offset:15360
  v_mul_f32 v194, s93, v194
  v_mfma_f32_16x16x32_bf16 v[188:191], v[220:223], v[156:159], v[188:191]
  ds_read_b128 v[220:223], v2 offset:14336
  s_waitcnt lgkmcnt(6)
  v_mfma_f32_16x16x32_bf16 v[200:203], v[224:227], v[136:139], 0
  v_mul_f32 v195, s93, v195
  v_cvt_pk_bf16_f32 v112, v192, v193
  v_mfma_f32_16x16x32_bf16 v[200:203], v[228:231], v[140:143], v[200:203]
  v_cvt_pk_bf16_f32 v113, v194, v195
  v_mul_f32 v184, s93, v184
  v_mfma_f32_16x16x32_bf16 v[200:203], v[232:235], v[144:147], v[200:203]
  v_mul_f32 v185, s93, v185
  v_mul_f32 v186, s93, v186
  v_mfma_f32_16x16x32_bf16 v[208:211], v[224:227], v[160:163], 0
  ds_read_b128 v[224:227], v2 offset:13312
  v_mul_f32 v187, s93, v187
  v_mfma_f32_16x16x32_bf16 v[208:211], v[228:231], v[164:167], v[208:211]
  ds_read_b128 v[228:231], v2 offset:12288
  v_cvt_pk_bf16_f32 v88, v184, v185
  v_mfma_f32_16x16x32_bf16 v[208:211], v[232:235], v[168:171], v[208:211]
  ds_read_b128 v[232:235], v2 offset:11264
  v_cvt_pk_bf16_f32 v89, v186, v187
  v_mfma_f32_16x16x32_bf16 v[208:211], v[236:239], v[172:175], v[208:211]
  v_mul_f32 v196, s93, v196
  s_waitcnt lgkmcnt(5)
  v_mfma_f32_16x16x32_bf16 v[208:211], v[240:243], v[176:179], v[208:211]
  v_mul_f32 v197, s93, v197
  v_mul_f32 v198, s93, v198
  v_mfma_f32_16x16x32_bf16 v[208:211], v[244:247], v[180:183], v[208:211]
  v_mul_f32 v199, s93, v199
  v_cvt_pk_bf16_f32 v114, v196, v197
  v_mfma_f32_16x16x32_bf16 v[200:203], v[236:239], v[148:151], v[200:203]
  ds_read_b128 v[236:239], v2 offset:10240
  v_cvt_pk_bf16_f32 v115, v198, v199
  v_mfma_f32_16x16x32_bf16 v[200:203], v[240:243], v[152:155], v[200:203]
  ds_read_b128 v[240:243], v2 offset:9216
  v_mul_f32 v188, s93, v188
  v_mfma_f32_16x16x32_bf16 v[200:203], v[244:247], v[156:159], v[200:203]
  ds_read_b128 v[244:247], v2 offset:8192
  v_mul_f32 v189, s93, v189
  v_mfma_f32_16x16x32_bf16 v[204:207], v[248:251], v[136:139], 0
  v_mul_f32 v190, s93, v190
  v_mul_f32 v191, s93, v191
  v_mfma_f32_16x16x32_bf16 v[204:207], v[252:255], v[140:143], v[204:207]
  v_cvt_pk_bf16_f32 v90, v188, v189
  s_waitcnt lgkmcnt(4)
  v_mfma_f32_16x16x32_bf16 v[204:207], v[216:219], v[144:147], v[204:207]
  v_cvt_pk_bf16_f32 v91, v190, v191
  v_cndmask_b32 v87, v64, v35, s[46:47]
  v_mfma_f32_16x16x32_bf16 v[212:215], v[248:251], v[160:163], 0
  ds_read_b128 v[248:251], v2 offset:7168
  v_cndmask_b32 v56, v64, v32, s[48:49]
  v_mfma_f32_16x16x32_bf16 v[212:215], v[252:255], v[164:167], v[212:215]
  ds_read_b128 v[252:255], v2 offset:6144
  v_cndmask_b32 v57, v64, v33, s[48:49]
  v_mfma_f32_16x16x32_bf16 v[212:215], v[216:219], v[168:171], v[212:215]
  ds_read_b128 v[216:219], v2 offset:5120
  v_cndmask_b32 v58, v64, v34, s[48:49]
  v_mfma_f32_16x16x32_bf16 v[212:215], v[220:223], v[172:175], v[212:215]
  v_cndmask_b32 v59, v64, v35, s[48:49]
  v_mul_f32 v208, s93, v208
  v_mfma_f32_16x16x32_bf16 v[212:215], v[224:227], v[176:179], v[212:215]
  v_mul_f32 v209, s93, v209
  v_mul_f32 v210, s93, v210
  v_mfma_f32_16x16x32_bf16 v[212:215], v[228:231], v[180:183], v[212:215]
  v_mul_f32 v211, s93, v211
  v_cvt_pk_bf16_f32 v116, v208, v209
  v_mfma_f32_16x16x32_bf16 v[204:207], v[220:223], v[148:151], v[204:207]
  ds_read_b128 v[220:223], v2 offset:4096
  v_cvt_pk_bf16_f32 v117, v210, v211
  v_mfma_f32_16x16x32_bf16 v[204:207], v[224:227], v[152:155], v[204:207]
  ds_read_b128 v[224:227], v2 offset:3072
  v_mul_f32 v200, s93, v200
  v_mfma_f32_16x16x32_bf16 v[204:207], v[228:231], v[156:159], v[204:207]
  ds_read_b128 v[228:231], v2 offset:2048
  s_waitcnt lgkmcnt(6)
  v_mfma_f32_16x16x32_bf16 v[184:187], v[232:235], v[136:139], 0
  v_mul_f32 v201, s93, v201
  v_mul_f32 v202, s93, v202
  v_mfma_f32_16x16x32_bf16 v[184:187], v[236:239], v[140:143], v[184:187]
  v_mul_f32 v203, s93, v203
  v_cvt_pk_bf16_f32 v92, v200, v201
  v_mfma_f32_16x16x32_bf16 v[184:187], v[240:243], v[144:147], v[184:187]
  v_cvt_pk_bf16_f32 v93, v202, v203
  v_mul_f32 v212, s93, v212
  v_mfma_f32_16x16x32_bf16 v[192:195], v[232:235], v[160:163], 0
  ds_read_b128 v[232:235], v2 offset:1024
  v_mul_f32 v213, s93, v213
  v_mfma_f32_16x16x32_bf16 v[192:195], v[236:239], v[164:167], v[192:195]
  ds_read_b128 v[236:239], v2 offset:0
  v_mul_f32 v214, s93, v214
  v_mfma_f32_16x16x32_bf16 v[192:195], v[240:243], v[168:171], v[192:195]
  ds_read_b128 v[240:243], v1 offset:35840
  v_mul_f32 v215, s93, v215
  v_mfma_f32_16x16x32_bf16 v[192:195], v[244:247], v[172:175], v[192:195]
  v_cvt_pk_bf16_f32 v118, v212, v213
  s_waitcnt lgkmcnt(5)
  v_mfma_f32_16x16x32_bf16 v[192:195], v[248:251], v[176:179], v[192:195]
  v_cvt_pk_bf16_f32 v119, v214, v215
  v_mul_f32 v204, s93, v204
  v_mfma_f32_16x16x32_bf16 v[192:195], v[252:255], v[180:183], v[192:195]
  v_mul_f32 v205, s93, v205
  v_mul_f32 v206, s93, v206
  v_mfma_f32_16x16x32_bf16 v[184:187], v[244:247], v[148:151], v[184:187]
  ds_read_b128 v[244:247], v1 offset:34816
  v_mul_f32 v207, s93, v207
  v_mfma_f32_16x16x32_bf16 v[184:187], v[248:251], v[152:155], v[184:187]
  ds_read_b128 v[248:251], v1 offset:33792
  v_cvt_pk_bf16_f32 v94, v204, v205
  v_mfma_f32_16x16x32_bf16 v[184:187], v[252:255], v[156:159], v[184:187]
  ds_read_b128 v[252:255], v1 offset:32768
  v_cvt_pk_bf16_f32 v95, v206, v207
  v_mfma_f32_16x16x32_bf16 v[188:191], v[216:219], v[136:139], 0
  v_cndmask_b32 v52, v64, v32, s[50:51]
  v_cndmask_b32 v53, v64, v33, s[50:51]
  s_cbranch_vccz SL40
  s_barrier
SL40:
  v_mfma_f32_16x16x32_bf16 v[188:191], v[220:223], v[140:143], v[188:191]
  v_cndmask_b32 v54, v64, v34, s[50:51]
  s_waitcnt lgkmcnt(4)
  v_mfma_f32_16x16x32_bf16 v[188:191], v[224:227], v[144:147], v[188:191]
  v_cndmask_b32 v55, v64, v35, s[50:51]
  v_mul_f32 v192, s93, v192
  v_mfma_f32_16x16x32_bf16 v[196:199], v[216:219], v[160:163], 0
  ds_read_b128 v[216:219], v1 offset:31744
  v_mul_f32 v193, s93, v193
  v_mfma_f32_16x16x32_bf16 v[196:199], v[220:223], v[164:167], v[196:199]
  ds_read_b128 v[220:223], v1 offset:30720
  v_mul_f32 v194, s93, v194
  v_mfma_f32_16x16x32_bf16 v[196:199], v[224:227], v[168:171], v[196:199]
  ds_read_b128 v[224:227], v1 offset:29696
  v_mul_f32 v195, s93, v195
  v_mfma_f32_16x16x32_bf16 v[196:199], v[228:231], v[172:175], v[196:199]
  v_cvt_pk_bf16_f32 v120, v192, v193
  v_cvt_pk_bf16_f32 v121, v194, v195
  v_mfma_f32_16x16x32_bf16 v[196:199], v[232:235], v[176:179], v[196:199]
  v_mul_f32 v184, s93, v184
  v_mul_f32 v185, s93, v185
  v_mfma_f32_16x16x32_bf16 v[196:199], v[236:239], v[180:183], v[196:199]
  v_mul_f32 v186, s93, v186
  v_mul_f32 v187, s93, v187
  v_mfma_f32_16x16x32_bf16 v[188:191], v[228:231], v[148:151], v[188:191]
  ds_read_b128 v[228:231], v1 offset:28672
  v_cvt_pk_bf16_f32 v96, v184, v185
  v_mfma_f32_16x16x32_bf16 v[188:191], v[232:235], v[152:155], v[188:191]
  ds_read_b128 v[232:235], v1 offset:27648
  v_cvt_pk_bf16_f32 v97, v186, v187
  v_mfma_f32_16x16x32_bf16 v[188:191], v[236:239], v[156:159], v[188:191]
  ds_read_b128 v[236:239], v1 offset:26624
  s_waitcnt lgkmcnt(6)
  v_mfma_f32_16x16x32_bf16 v[200:203], v[240:243], v[136:139], 0
  v_mul_f32 v196, s93, v196
  v_mul_f32 v197, s93, v197
  v_mfma_f32_16x16x32_bf16 v[200:203], v[244:247], v[140:143], v[200:203]
  v_mul_f32 v198, s93, v198
  v_mul_f32 v199, s93, v199
  v_mfma_f32_16x16x32_bf16 v[200:203], v[248:251], v[144:147], v[200:203]
  v_cvt_pk_bf16_f32 v122, v196, v197
  v_cvt_pk_bf16_f32 v123, v198, v199
  v_mfma_f32_16x16x32_bf16 v[208:211], v[240:243], v[160:163], 0
  ds_read_b128 v[240:243], v1 offset:25600
  v_mul_f32 v188, s93, v188
  v_mfma_f32_16x16x32_bf16 v[208:211], v[244:247], v[164:167], v[208:211]
  ds_read_b128 v[244:247], v1 offset:24576
  v_mul_f32 v189, s93, v189
  v_mfma_f32_16x16x32_bf16 v[208:211], v[248:251], v[168:171], v[208:211]
  ds_read_b128 v[248:251], v1 offset:23552
  v_mul_f32 v190, s93, v190
  v_mfma_f32_16x16x32_bf16 v[208:211], v[252:255], v[172:175], v[208:211]
  v_mul_f32 v191, s93, v191
  s_waitcnt lgkmcnt(5)
  v_mfma_f32_16x16x32_bf16 v[208:211], v[216:219], v[176:179], v[208:211]
  v_cvt_pk_bf16_f32 v98, v188, v189
  v_cvt_pk_bf16_f32 v99, v190, v191
  v_mfma_f32_16x16x32_bf16 v[208:211], v[220:223], v[180:183], v[208:211]
  v_cndmask_b32 v28, v64, v32, s[52:53]
  v_cndmask_b32 v29, v64, v33, s[52:53]
  v_mfma_f32_16x16x32_bf16 v[200:203], v[252:255], v[148:151], v[200:203]
  ds_read_b128 v[252:255], v1 offset:22528
  v_cndmask_b32 v30, v64, v34, s[52:53]
  v_mfma_f32_16x16x32_bf16 v[200:203], v[216:219], v[152:155], v[200:203]
  ds_read_b128 v[216:219], v1 offset:21504
  v_cndmask_b32 v31, v64, v35, s[52:53]
  v_mfma_f32_16x16x32_bf16 v[200:203], v[220:223], v[156:159], v[200:203]
  ds_read_b128 v[220:223], v1 offset:20480
  v_cndmask_b32 v24, v64, v32, s[54:55]
  v_mfma_f32_16x16x32_bf16 v[204:207], v[224:227], v[136:139], 0
  v_mul_f32 v208, s93, v208
  v_mul_f32 v209, s93, v209
  v_mfma_f32_16x16x32_bf16 v[204:207], v[228:231], v[140:143], v[204:207]
  v_mul_f32 v210, s93, v210
  s_waitcnt lgkmcnt(4)
  v_mfma_f32_16x16x32_bf16 v[204:207], v[232:235], v[144:147], v[204:207]
  v_mul_f32 v211, s93, v211
  v_cvt_pk_bf16_f32 v124, v208, v209
  v_mfma_f32_16x16x32_bf16 v[212:215], v[224:227], v[160:163], 0
  ds_read_b128 v[224:227], v1 offset:19456
  v_cvt_pk_bf16_f32 v125, v210, v211
  v_mfma_f32_16x16x32_bf16 v[212:215], v[228:231], v[164:167], v[212:215]
  ds_read_b128 v[228:231], v1 offset:18432
  v_mul_f32 v200, s93, v200
  v_mfma_f32_16x16x32_bf16 v[212:215], v[232:235], v[168:171], v[212:215]
  ds_read_b128 v[232:235], v1 offset:17408
  v_mul_f32 v201, s93, v201
  v_mfma_f32_16x16x32_bf16 v[212:215], v[236:239], v[172:175], v[212:215]
  v_mul_f32 v202, s93, v202
  v_mul_f32 v203, s93, v203
  v_mfma_f32_16x16x32_bf16 v[212:215], v[240:243], v[176:179], v[212:215]
  v_cvt_pk_bf16_f32 v100, v200, v201
  v_cvt_pk_bf16_f32 v101, v202, v203
  v_mfma_f32_16x16x32_bf16 v[212:215], v[244:247], v[180:183], v[212:215]
  v_mfma_f32_16x16x32_bf16 v[204:207], v[236:239], v[148:151], v[204:207]
  ds_read_b128 v[236:239], v1 offset:16384
  v_mfma_f32_16x16x32_bf16 v[204:207], v[240:243], v[152:155], v[204:207]
  ds_read_b128 v[240:243], v1 offset:15360
  v_mfma_f32_16x16x32_bf16 v[204:207], v[244:247], v[156:159], v[204:207]
  ds_read_b128 v[244:247], v1 offset:14336
  s_waitcnt lgkmcnt(6)
  v_mfma_f32_16x16x32_bf16 v[184:187], v[248:251], v[136:139], 0
  v_mul_f32 v212, s93, v212
  v_mul_f32 v213, s93, v213
  v_mfma_f32_16x16x32_bf16 v[184:187], v[252:255], v[140:143], v[184:187]
  v_mul_f32 v214, s93, v214
  v_mul_f32 v215, s93, v215
  v_mfma_f32_16x16x32_bf16 v[184:187], v[216:219], v[144:147], v[184:187]
  v_cvt_pk_bf16_f32 v126, v212, v213
  v_cvt_pk_bf16_f32 v127, v214, v215
  v_mfma_f32_16x16x32_bf16 v[192:195], v[248:251], v[160:163], 0
  ds_read_b128 v[248:251], v1 offset:13312
  v_mul_f32 v204, s93, v204
  v_mfma_f32_16x16x32_bf16 v[192:195], v[252:255], v[164:167], v[192:195]
  ds_read_b128 v[252:255], v1 offset:12288
  v_mul_f32 v205, s93, v205
  v_mfma_f32_16x16x32_bf16 v[192:195], v[216:219], v[168:171], v[192:195]
  ds_read_b128 v[216:219], v1 offset:11264
  v_mul_f32 v206, s93, v206
  v_mfma_f32_16x16x32_bf16 v[192:195], v[220:223], v[172:175], v[192:195]
  v_mul_f32 v207, s93, v207
  s_waitcnt lgkmcnt(5)
  v_mfma_f32_16x16x32_bf16 v[192:195], v[224:227], v[176:179], v[192:195]
  v_cvt_pk_bf16_f32 v102, v204, v205
  v_cvt_pk_bf16_f32 v103, v206, v207
  v_mfma_f32_16x16x32_bf16 v[192:195], v[228:231], v[180:183], v[192:195]
  v_cndmask_b32 v25, v64, v33, s[54:55]
  v_cndmask_b32 v26, v64, v34, s[54:55]
  v_mfma_f32_16x16x32_bf16 v[184:187], v[220:223], v[148:151], v[184:187]
  ds_read_b128 v[220:223], v1 offset:10240
  v_cndmask_b32 v27, v64, v35, s[54:55]
  v_mfma_f32_16x16x32_bf16 v[184:187], v[224:227], v[152:155], v[184:187]
  ds_read_b128 v[224:227], v1 offset:9216
  v_mfma_f32_16x16x32_bf16 v[184:187], v[228:231], v[156:159], v[184:187]
  ds_read_b128 v[228:231], v1 offset:8192
  v_mfma_f32_16x16x32_bf16 v[188:191], v[232:235], v[136:139], 0
  v_mul_f32 v192, s93, v192
  v_mul_f32 v193, s93, v193
  v_mfma_f32_16x16x32_bf16 v[188:191], v[236:239], v[140:143], v[188:191]
  v_mul_f32 v194, s93, v194
  s_waitcnt lgkmcnt(4)
  v_mfma_f32_16x16x32_bf16 v[188:191], v[240:243], v[144:147], v[188:191]
  v_mul_f32 v195, s93, v195
  v_cvt_pk_bf16_f32 v128, v192, v193
  v_mfma_f32_16x16x32_bf16 v[196:199], v[232:235], v[160:163], 0
  ds_read_b128 v[232:235], v1 offset:7168
  v_cvt_pk_bf16_f32 v129, v194, v195
  v_mfma_f32_16x16x32_bf16 v[196:199], v[236:239], v[164:167], v[196:199]
  ds_read_b128 v[236:239], v1 offset:6144
  v_mul_f32 v184, s93, v184
  v_mfma_f32_16x16x32_bf16 v[196:199], v[240:243], v[168:171], v[196:199]
  ds_read_b128 v[240:243], v1 offset:5120
  v_mul_f32 v185, s93, v185
  v_mfma_f32_16x16x32_bf16 v[196:199], v[244:247], v[172:175], v[196:199]
  v_mul_f32 v186, s93, v186
  v_mul_f32 v187, s93, v187
  v_mfma_f32_16x16x32_bf16 v[196:199], v[248:251], v[176:179], v[196:199]
  v_cvt_pk_bf16_f32 v104, v184, v185
  v_cvt_pk_bf16_f32 v105, v186, v187
  v_mfma_f32_16x16x32_bf16 v[196:199], v[252:255], v[180:183], v[196:199]
  v_mfma_f32_16x16x32_bf16 v[188:191], v[244:247], v[148:151], v[188:191]
  ds_read_b128 v[244:247], v1 offset:4096
  v_mfma_f32_16x16x32_bf16 v[188:191], v[248:251], v[152:155], v[188:191]
  ds_read_b128 v[248:251], v1 offset:3072
  v_mfma_f32_16x16x32_bf16 v[188:191], v[252:255], v[156:159], v[188:191]
  ds_read_b128 v[252:255], v1 offset:2048
  s_waitcnt lgkmcnt(6)
  v_mfma_f32_16x16x32_bf16 v[200:203], v[216:219], v[136:139], 0
  v_mul_f32 v196, s93, v196
  v_mul_f32 v197, s93, v197
  s_cbranch_vccz SL41
  s_waitcnt vmcnt(0)
  s_barrier
SL41:
  v_mfma_f32_16x16x32_bf16 v[200:203], v[220:223], v[140:143], v[200:203]
  v_mul_f32 v198, s93, v198
  v_mul_f32 v199, s93, v199
  v_mfma_f32_16x16x32_bf16 v[200:203], v[224:227], v[144:147], v[200:203]
  v_cvt_pk_bf16_f32 v130, v196, v197
  v_cvt_pk_bf16_f32 v131, v198, v199
  v_mfma_f32_16x16x32_bf16 v[208:211], v[216:219], v[160:163], 0
  ds_read_b128 v[216:219], v1 offset:1024
  v_mul_f32 v188, s93, v188
  v_mfma_f32_16x16x32_bf16 v[208:211], v[220:223], v[164:167], v[208:211]
  ds_read_b128 v[220:223], v1 offset:0
  v_mul_f32 v189, s93, v189
  v_mfma_f32_16x16x32_bf16 v[208:211], v[224:227], v[168:171], v[208:211]
  v_mul_f32 v190, s93, v190
  v_mul_f32 v191, s93, v191
  v_mfma_f32_16x16x32_bf16 v[208:211], v[228:231], v[172:175], v[208:211]
  v_cvt_pk_bf16_f32 v106, v188, v189
  s_cbranch_vccnz SL42
  s_barrier
SL42:
  s_waitcnt lgkmcnt(4)
  v_mfma_f32_16x16x32_bf16 v[208:211], v[232:235], v[176:179], v[208:211]
  v_cvt_pk_bf16_f32 v107, v190, v191
  v_mfma_f32_16x16x32_bf16 v[208:211], v[236:239], v[180:183], v[208:211]
  v_mfma_f32_16x16x32_bf16 v[200:203], v[228:231], v[148:151], v[200:203]
  v_mfma_f32_16x16x32_bf16 v[200:203], v[232:235], v[152:155], v[200:203]
  v_mfma_f32_16x16x32_bf16 v[200:203], v[236:239], v[156:159], v[200:203]
  v_mfma_f32_16x16x32_bf16 v[204:207], v[240:243], v[136:139], 0
  v_mfma_f32_16x16x32_bf16 v[204:207], v[244:247], v[140:143], v[204:207]
  s_waitcnt lgkmcnt(3)
  v_mfma_f32_16x16x32_bf16 v[204:207], v[248:251], v[144:147], v[204:207]
  v_mfma_f32_16x16x32_bf16 v[212:215], v[240:243], v[160:163], 0
  v_mul_f32 v208, s93, v208
  v_mul_f32 v209, s93, v209
  v_mfma_f32_16x16x32_bf16 v[212:215], v[244:247], v[164:167], v[212:215]
  v_mul_f32 v210, s93, v210
  v_mul_f32 v211, s93, v211
  v_mfma_f32_16x16x32_bf16 v[212:215], v[248:251], v[168:171], v[212:215]
  v_cvt_pk_bf16_f32 v132, v208, v209
  s_waitcnt lgkmcnt(2)
  v_mfma_f32_16x16x32_bf16 v[212:215], v[252:255], v[172:175], v[212:215]
  v_cvt_pk_bf16_f32 v133, v210, v211
  s_waitcnt lgkmcnt(1)
  v_mfma_f32_16x16x32_bf16 v[212:215], v[216:219], v[176:179], v[212:215]
  v_mul_f32 v200, s93, v200
  s_waitcnt lgkmcnt(0)
  v_mfma_f32_16x16x32_bf16 v[212:215], v[220:223], v[180:183], v[212:215]
  v_mul_f32 v201, s93, v201
  v_mul_f32 v202, s93, v202
  v_mfma_f32_16x16x32_bf16 v[204:207], v[252:255], v[148:151], v[204:207]
  v_mul_f32 v203, s93, v203
  v_cvt_pk_bf16_f32 v108, v200, v201
  v_mfma_f32_16x16x32_bf16 v[204:207], v[216:219], v[152:155], v[204:207]
  v_cvt_pk_bf16_f32 v109, v202, v203
  v_mfma_f32_16x16x32_bf16 v[204:207], v[220:223], v[156:159], v[204:207]
  s_cbranch_vccnz SL43
  s_setprio 0
  s_mul_i32 s100, s32, 7
  s_add_i32 s100, s100, s31
  s_add_u32 m0, s38, 107520
  s_nop 0
  buffer_load_dwordx4 v13, s[12:15], s100 offen lds
  s_add_u32 m0, s38, 108544
  s_nop 0
  buffer_load_dwordx4 v14, s[12:15], s100 offen lds
  s_add_u32 m0, s38, 109568
  s_nop 0
  buffer_load_dwordx4 v3, s[12:15], s100 offen lds
  s_add_u32 m0, s39, 107520
  s_nop 0
  buffer_load_dwordx4 v4, s[12:15], s100 offen lds
  s_mul_i32 s100, s32, 6
  s_add_i32 s100, s100, s31
  s_add_u32 m0, s38, 92160
  s_nop 0
  buffer_load_dwordx4 v13, s[12:15], s100 offen lds
  s_add_u32 m0, s38, 93184
  s_nop 0
  buffer_load_dwordx4 v14, s[12:15], s100 offen lds
  s_add_u32 m0, s38, 94208
  s_nop 0
  buffer_load_dwordx4 v3, s[12:15], s100 offen lds
  s_add_u32 m0, s39, 92160
  s_nop 0
  buffer_load_dwordx4 v4, s[12:15], s100 offen lds
  s_mul_i32 s100, s32, 5
  s_add_i32 s100, s100, s31
  s_add_u32 m0, s38, 76800
  s_nop 0
  buffer_load_dwordx4 v13, s[12:15], s100 offen lds
  s_add_u32 m0, s38, 77824
  s_nop 0
  buffer_load_dwordx4 v14, s[12:15], s100 offen lds
  s_add_u32 m0, s38, 78848
  s_nop 0
  buffer_load_dwordx4 v3, s[12:15], s100 offen lds
  s_add_u32 m0, s39, 76800
  s_nop 0
  buffer_load_dwordx4 v4, s[12:15], s100 offen lds
  s_barrier
  s_mul_i32 s100, s32, 4
  s_add_i32 s100, s100, s31
  s_add_u32 m0, s38, 61440
  s_nop 0
  buffer_load_dwordx4 v13, s[12:15], s100 offen lds
  s_add_u32 m0, s38, 62464
  s_nop 0
  buffer_load_dwordx4 v14, s[12:15], s100 offen lds
  s_add_u32 m0, s38, 63488
  s_nop 0
  buffer_load_dwordx4 v3, s[12:15], s100 offen lds
  s_add_u32 m0, s39, 61440
  s_nop 0
  buffer_load_dwordx4 v4, s[12:15], s100 offen lds
  s_mul_i32 s100, s32, 3
  s_add_i32 s100, s100, s31
  s_add_u32 m0, s38, 46080
  s_nop 0
  buffer_load_dwordx4 v13, s[12:15], s100 offen lds
  s_add_u32 m0, s38, 47104
  s_nop 0
  buffer_load_dwordx4 v14, s[12:15], s100 offen lds
  s_add_u32 m0, s38, 48128
  s_nop 0
  buffer_load_dwordx4 v3, s[12:15], s100 offen lds
  s_add_u32 m0, s39, 46080
  s_nop 0
  buffer_load_dwordx4 v4, s[12:15], s100 offen lds
  s_mul_i32 s100, s32, 2
  s_add_i32 s100, s100, s31
  s_add_u32 m0, s38, 30720
  s_nop 0
  buffer_load_dwordx4 v13, s[12:15], s100 offen lds
  s_add_u32 m0, s38, 31744
  s_nop 0
  buffer_load_dwordx4 v14, s[12:15], s100 offen lds
  s_add_u32 m0, s38, 32768
  s_nop 0
  buffer_load_dwordx4 v3, s[12:15], s100 offen lds
  s_add_u32 m0, s39, 30720
  s_nop 0
  buffer_load_dwordx4 v4, s[12:15], s100 offen lds
  s_waitcnt vmcnt(12)
  s_barrier
  s_max_u32 s100, s33, 1
  s_mul_i32 s100, s100, s32
  s_add_i32 s100, s100, s31
  s_add_u32 m0, s38, 15360
  s_nop 0
  buffer_load_dwordx4 v13, s[12:15], s100 offen lds
  s_add_u32 m0, s38, 16384
  s_nop 0
  buffer_load_dwordx4 v14, s[12:15], s100 offen lds
  s_add_u32 m0, s38, 17408
  s_nop 0
  buffer_load_dwordx4 v3, s[12:15], s100 offen lds
  s_add_u32 m0, s39, 15360
  s_nop 0
  buffer_load_dwordx4 v4, s[12:15], s100 offen lds
  s_max_u32 s100, s33, 0
  s_mul_i32 s100, s100, s32
  s_add_i32 s100, s100, s31
  s_add_u32 m0, s38, 0
  s_nop 0
  buffer_load_dwordx4 v13, s[12:15], s100 offen lds
  s_add_u32 m0, s38, 1024
  s_nop 0
  buffer_load_dwordx4 v14, s[12:15], s100 offen lds
  s_add_u32 m0, s38, 2048
  s_nop 0
  buffer_load_dwordx4 v3, s[12:15], s100 offen lds
  s_add_u32 m0, s39, 0
  s_nop 0
  buffer_load_dwordx4 v4, s[12:15], s100 offen lds
  s_waitcnt vmcnt(8)
  s_barrier
SL43:
  ds_read_b128 v[224:227], v7 offset:61440
  ds_read_b128 v[228:231], v8 offset:61440
  ds_read_b128 v[232:235], v7 offset:61568
  ds_read_b128 v[236:239], v8 offset:61568
  ds_read_b128 v[240:243], v7 offset:61696
  ds_read_b128 v[244:247], v8 offset:61696
  ds_read_b128 v[248:251], v7 offset:53760
  ds_read_b128 v[252:255], v8 offset:53760
  ds_read_b128 v[216:219], v7 offset:53888
  ds_read_b128 v[220:223], v8 offset:53888
  s_waitcnt lgkmcnt(6)
  v_mfma_f32_16x16x32_bf16 v[84:87], v[224:227], v[112:115], v[84:87]
  ds_read_b128 v[224:227], v7 offset:54016
  v_mul_f32 v212, s93, v212
  v_mfma_f32_16x16x32_bf16 v[84:87], v[228:231], v[116:119], v[84:87]
  ds_read_b128 v[228:231], v8 offset:54016
  v_mul_f32 v213, s93, v213
  v_mfma_f32_16x16x32_bf16 v[84:87], v[232:235], v[120:123], v[84:87]
  ds_read_b128 v[232:235], v7 offset:46080
  v_mul_f32 v214, s93, v214
  v_mfma_f32_16x16x32_bf16 v[84:87], v[236:239], v[124:127], v[84:87]
  ds_read_b128 v[236:239], v8 offset:46080
  s_waitcnt lgkmcnt(6)
  v_mfma_f32_16x16x32_bf16 v[84:87], v[240:243], v[128:131], v[84:87]
  ds_read_b128 v[240:243], v7 offset:46208
  v_mul_f32 v215, s93, v215
  v_cvt_pk_bf16_f32 v134, v212, v213
  v_cvt_pk_bf16_f32 v135, v214, v215
  s_nop 1
  v_mfma_f32_16x16x32_bf16 v[84:87], v[244:247], v[132:135], v[84:87]
  ds_read_b128 v[244:247], v8 offset:46208
  v_mul_f32 v204, s93, v204
  v_mfma_f32_16x16x32_bf16 v[80:83], v[248:251], v[112:115], v[32:35]
  ds_read_b128 v[248:251], v7 offset:46336
  v_mul_f32 v205, s93, v205
  v_mfma_f32_16x16x32_bf16 v[80:83], v[252:255], v[116:119], v[80:83]
  ds_read_b128 v[252:255], v8 offset:46336
  s_waitcnt lgkmcnt(6)
  v_mfma_f32_16x16x32_bf16 v[80:83], v[216:219], v[120:123], v[80:83]
  ds_read_b128 v[216:219], v7 offset:38400
  v_mul_f32 v206, s93, v206
  v_mfma_f32_16x16x32_bf16 v[80:83], v[220:223], v[124:127], v[80:83]
  ds_read_b128 v[220:223], v8 offset:38400
  v_mul_f32 v207, s93, v207
  v_mfma_f32_16x16x32_bf16 v[80:83], v[224:227], v[128:131], v[80:83]
  ds_read_b128 v[224:227], v7 offset:38528
  v_cvt_pk_bf16_f32 v110, v204, v205
  v_mfma_f32_16x16x32_bf16 v[80:83], v[228:231], v[132:135], v[80:83]
  ds_read_b128 v[228:231], v8 offset:38528
  s_waitcnt vmcnt(0)
  s_barrier
  s_waitcnt lgkmcnt(6)
  v_mfma_f32_16x16x32_bf16 v[52:55], v[232:235], v[88:91], v[52:55]
  v_exp_f32 v204, v84
  v_mfma_f32_16x16x32_bf16 v[52:55], v[236:239], v[92:95], v[52:55]
  v_exp_f32 v205, v85
  v_mfma_f32_16x16x32_bf16 v[52:55], v[240:243], v[96:99], v[52:55]
  v_exp_f32 v208, v80
  v_mfma_f32_16x16x32_bf16 v[76:79], v[232:235], v[112:115], v[32:35]
  ds_read_b128 v[232:235], v7 offset:38656
  v_cvt_pk_bf16_f32 v111, v206, v207
  v_mfma_f32_16x16x32_bf16 v[76:79], v[236:239], v[116:119], v[76:79]
  v_exp_f32 v206, v86
  v_mfma_f32_16x16x32_bf16 v[76:79], v[240:243], v[120:123], v[76:79]
  v_exp_f32 v207, v87
  v_mfma_f32_16x16x32_bf16 v[76:79], v[244:247], v[124:127], v[76:79]
  ds_read_b128 v[236:239], v8 offset:38656
  s_waitcnt lgkmcnt(4)
  v_mfma_f32_16x16x32_bf16 v[76:79], v[248:251], v[128:131], v[76:79]
  ds_read_b128 v[240:243], v7 offset:30720
  v_add_u32 v2, 102400, v1
  v_mfma_f32_16x16x32_bf16 v[76:79], v[252:255], v[132:135], v[76:79]
  v_exp_f32 v209, v81
  v_mfma_f32_16x16x32_bf16 v[52:55], v[244:247], v[100:103], v[52:55]
  ds_read_b128 v[244:247], v8 offset:30720
  v_mov_b32 v192, 0x3f803f80
  v_mfma_f32_16x16x32_bf16 v[52:55], v[248:251], v[104:107], v[52:55]
  ds_read_b128 v[248:251], v7 offset:30848
  v_mov_b32 v193, 0x3f803f80
  v_mfma_f32_16x16x32_bf16 v[52:55], v[252:255], v[108:111], v[52:55]
  v_exp_f32 v210, v82
  v_mfma_f32_16x16x32_bf16 v[48:51], v[216:219], v[88:91], v[32:35]
  v_exp_f32 v211, v83
  v_mfma_f32_16x16x32_bf16 v[48:51], v[220:223], v[92:95], v[48:51]
  ds_read_b128 v[252:255], v8 offset:30848
  v_mov_b32 v194, 0x3f803f80
  s_waitcnt lgkmcnt(4)
  v_mfma_f32_16x16x32_bf16 v[48:51], v[224:227], v[96:99], v[48:51]
  v_exp_f32 v212, v76
  v_mfma_f32_16x16x32_bf16 v[72:75], v[216:219], v[112:115], v[32:35]
  ds_read_b128 v[216:219], v7 offset:30976
  v_mov_b32 v195, 0x3f803f80
  v_mfma_f32_16x16x32_bf16 v[72:75], v[220:223], v[116:119], v[72:75]
  ds_read_b128 v[220:223], v8 offset:30976
  v_cvt_pk_bf16_f32 v166, v204, v205
  v_mfma_f32_16x16x32_bf16 v[72:75], v[224:227], v[120:123], v[72:75]
  v_exp_f32 v213, v77
  v_mfma_f32_16x16x32_bf16 v[72:75], v[228:231], v[124:127], v[72:75]
  v_exp_f32 v214, v78
  v_mfma_f32_16x16x32_bf16 v[72:75], v[232:235], v[128:131], v[72:75]
  v_exp_f32 v215, v79
  v_mfma_f32_16x16x32_bf16 v[72:75], v[236:239], v[132:135], v[72:75]
  ds_read_b128 v[224:227], v7 offset:23040
  v_cvt_pk_bf16_f32 v167, v206, v207
  v_mfma_f32_16x16x32_bf16 v[48:51], v[228:231], v[100:103], v[48:51]
  ds_read_b128 v[228:231], v8 offset:23040
  v_cvt_pk_bf16_f32 v164, v208, v209
  v_mfma_f32_16x16x32_bf16 v[48:51], v[232:235], v[104:107], v[48:51]
  v_exp_f32 v196, v52
  v_mfma_f32_16x16x32_bf16 v[48:51], v[236:239], v[108:111], v[48:51]
  ds_read_b128 v[232:235], v7 offset:23168
  s_waitcnt lgkmcnt(5)
  v_mfma_f32_16x16x32_bf16 v[44:47], v[240:243], v[88:91], v[32:35]
  v_exp_f32 v197, v53
  v_mfma_f32_16x16x32_bf16 v[44:47], v[244:247], v[92:95], v[44:47]
  v_exp_f32 v198, v54
  v_mfma_f32_16x16x32_bf16 v[44:47], v[248:251], v[96:99], v[44:47]
  v_exp_f32 v199, v55
  v_mfma_f32_16x16x32_bf16 v[68:71], v[240:243], v[112:115], v[32:35]
  ds_read_b128 v[236:239], v8 offset:23168
  ds_read_b128 v[240:243], v7 offset:23296
  v_cvt_pk_bf16_f32 v165, v210, v211
  v_mfma_f32_16x16x32_bf16 v[68:71], v[244:247], v[116:119], v[68:71]
  ds_read_b128 v[244:247], v8 offset:23296
  v_cvt_pk_bf16_f32 v162, v212, v213
  v_mfma_f32_16x16x32_bf16 v[68:71], v[248:251], v[120:123], v[68:71]
  v_exp_f32 v204, v72
  v_mfma_f32_16x16x32_bf16 v[68:71], v[252:255], v[124:127], v[68:71]
  ds_read_b128 v[248:251], v7 offset:15360
  v_cvt_pk_bf16_f32 v163, v214, v215
  s_waitcnt lgkmcnt(5)
  v_mfma_f32_16x16x32_bf16 v[68:71], v[216:219], v[128:131], v[68:71]
  v_exp_f32 v205, v73
  v_mfma_f32_16x16x32_bf16 v[68:71], v[220:223], v[132:135], v[68:71]
  v_exp_f32 v206, v74
  v_mfma_f32_16x16x32_bf16 v[44:47], v[252:255], v[100:103], v[44:47]
  v_exp_f32 v207, v75
  v_mfma_f32_16x16x32_bf16 v[44:47], v[216:219], v[104:107], v[44:47]
  ds_read_b128 v[252:255], v8 offset:15360
  ds_read_b128 v[216:219], v7 offset:15488
  v_mfma_f32_16x16x32_bf16 v[44:47], v[220:223], v[108:111], v[44:47]
  ds_read_b128 v[220:223], v8 offset:15488
  v_cvt_pk_bf16_f32 v150, v196, v197
  v_mfma_f32_16x16x32_bf16 v[40:43], v[224:227], v[88:91], v[32:35]
  v_exp_f32 v200, v48
  v_mfma_f32_16x16x32_bf16 v[40:43], v[228:231], v[92:95], v[40:43]
  v_cvt_pk_bf16_f32 v151, v198, v199
  s_waitcnt lgkmcnt(4)
  v_mfma_f32_16x16x32_bf16 v[40:43], v[232:235], v[96:99], v[40:43]
  v_exp_f32 v201, v49
  v_mfma_f32_16x16x32_bf16 v[64:67], v[224:227], v[112:115], v[32:35]
  v_exp_f32 v202, v50
  v_mfma_f32_16x16x32_bf16 v[64:67], v[228:231], v[116:119], v[64:67]
  v_exp_f32 v203, v51
  v_mfma_f32_16x16x32_bf16 v[64:67], v[232:235], v[120:123], v[64:67]
  ds_read_b128 v[224:227], v7 offset:15616
  ds_read_b128 v[228:231], v8 offset:15616
  v_cvt_pk_bf16_f32 v160, v204, v205
  v_mfma_f32_16x16x32_bf16 v[64:67], v[236:239], v[124:127], v[64:67]
  v_exp_f32 v208, v68
  v_mfma_f32_16x16x32_bf16 v[64:67], v[240:243], v[128:131], v[64:67]
  v_exp_f32 v209, v69
  v_mfma_f32_16x16x32_bf16 v[64:67], v[244:247], v[132:135], v[64:67]
  v_exp_f32 v210, v70
  v_mfma_f32_16x16x32_bf16 v[40:43], v[236:239], v[100:103], v[40:43]
  v_exp_f32 v211, v71
  v_mfma_f32_16x16x32_bf16 v[40:43], v[240:243], v[104:107], v[40:43]
  ds_read_b128 v[232:235], v7 offset:7680
  ds_read_b128 v[236:239], v8 offset:7680
  v_mfma_f32_16x16x32_bf16 v[40:43], v[244:247], v[108:111], v[40:43]
  ds_read_b128 v[240:243], v7 offset:7808
  s_barrier
  s_waitcnt lgkmcnt(5)
  v_mfma_f32_16x16x32_bf16 v[36:39], v[248:251], v[88:91], v[32:35]
  v_exp_f32 v212, v64
  v_mfma_f32_16x16x32_bf16 v[36:39], v[252:255], v[92:95], v[36:39]
  v_exp_f32 v213, v65
  v_mfma_f32_16x16x32_bf16 v[36:39], v[216:219], v[96:99], v[36:39]
  v_exp_f32 v214, v66
  v_mfma_f32_16x16x32_bf16 v[60:63], v[248:251], v[112:115], v[32:35]
  v_exp_f32 v215, v67
  v_mfma_f32_16x16x32_bf16 v[60:63], v[252:255], v[116:119], v[60:63]
  ds_read_b128 v[244:247], v8 offset:7808
  ds_read_b128 v[248:251], v7 offset:7936
  v_cvt_pk_bf16_f32 v161, v206, v207
  v_mfma_f32_16x16x32_bf16 v[60:63], v[216:219], v[120:123], v[60:63]
  ds_read_b128 v[252:255], v8 offset:7936
  ds_read_b128 v[216:219], v7 offset:0
  v_cvt_pk_bf16_f32 v158, v208, v209
  v_mfma_f32_16x16x32_bf16 v[60:63], v[220:223], v[124:127], v[60:63]
  v_cvt_pk_bf16_f32 v159, v210, v211
  s_waitcnt lgkmcnt(5)
  v_mfma_f32_16x16x32_bf16 v[60:63], v[224:227], v[128:131], v[60:63]
  v_exp_f32 v196, v44
  v_mfma_f32_16x16x32_bf16 v[60:63], v[228:231], v[132:135], v[60:63]
  v_exp_f32 v197, v45
  v_mfma_f32_16x16x32_bf16 v[36:39], v[220:223], v[100:103], v[36:39]
  ds_read_b128 v[220:223], v8 offset:0
  v_cvt_pk_bf16_f32 v156, v212, v213
  v_mfma_f32_16x16x32_bf16 v[36:39], v[224:227], v[104:107], v[36:39]
  ds_read_b128 v[224:227], v7 offset:128
  v_cvt_pk_bf16_f32 v157, v214, v215
  v_mfma_f32_16x16x32_bf16 v[36:39], v[228:231], v[108:111], v[36:39]
  v_exp_f32 v198, v46
  v_mfma_f32_16x16x32_bf16 v[32:35], v[232:235], v[88:91], v[32:35]
  v_exp_f32 v204, v60
  v_mfma_f32_16x16x32_bf16 v[32:35], v[236:239], v[92:95], v[32:35]
  ds_read_b128 v[228:231], v8 offset:128
  v_cvt_pk_bf16_f32 v148, v200, v201
  s_waitcnt lgkmcnt(4)
  v_mfma_f32_16x16x32_bf16 v[32:35], v[240:243], v[96:99], v[32:35]
  v_exp_f32 v205, v61
  v_mfma_f32_16x16x32_bf16 v[56:59], v[232:235], v[112:115], v[56:59]
  v_exp_f32 v206, v62
  v_mfma_f32_16x16x32_bf16 v[56:59], v[236:239], v[116:119], v[56:59]
  v_exp_f32 v207, v63
  v_mfma_f32_16x16x32_bf16 v[56:59], v[240:243], v[120:123], v[56:59]
  v_exp_f32 v199, v47
  v_mfma_f32_16x16x32_bf16 v[56:59], v[244:247], v[124:127], v[56:59]
  ds_read_b128 v[232:235], v7 offset:256
  ds_read_b128 v[236:239], v8 offset:256
  v_cvt_pk_bf16_f32 v154, v204, v205
  v_mfma_f32_16x16x32_bf16 v[56:59], v[248:251], v[128:131], v[56:59]
  ds_read_b128 v[240:243], v20 offset:0
  v_cvt_pk_bf16_f32 v155, v206, v207
  v_mfma_f32_16x16x32_bf16 v[56:59], v[252:255], v[132:135], v[56:59]
  v_exp_f32 v200, v40
  v_mfma_f32_16x16x32_bf16 v[32:35], v[244:247], v[100:103], v[32:35]
  ds_read_b128 v[244:247], v0 offset:0
  v_cvt_pk_bf16_f32 v149, v202, v203
  v_mfma_f32_16x16x32_bf16 v[32:35], v[248:251], v[104:107], v[32:35]
  v_exp_f32 v201, v41
  v_mfma_f32_16x16x32_bf16 v[32:35], v[252:255], v[108:111], v[32:35]
  ds_read_b128 v[248:251], v20 offset:128
  s_waitcnt lgkmcnt(5)
  v_mfma_f32_16x16x32_bf16 v[28:31], v[216:219], v[88:91], v[28:31]
  v_exp_f32 v208, v56
  v_mfma_f32_16x16x32_bf16 v[28:31], v[220:223], v[92:95], v[28:31]
  v_exp_f32 v209, v57
  v_mfma_f32_16x16x32_bf16 v[28:31], v[224:227], v[96:99], v[28:31]
  v_exp_f32 v210, v58
  v_mfma_f32_16x16x32_bf16 v[28:31], v[228:231], v[100:103], v[28:31]
  ds_read_b128 v[252:255], v0 offset:128
  v_cvt_pk_bf16_f32 v152, v208, v209
  s_waitcnt lgkmcnt(4)
  v_mfma_f32_16x16x32_bf16 v[28:31], v[232:235], v[104:107], v[28:31]
  ds_read_b128 v[216:219], v20 offset:256
  ds_read_b128 v[220:223], v0 offset:256
  v_cvt_pk_bf16_f32 v146, v196, v197
  v_mfma_f32_16x16x32_bf16 v[28:31], v[236:239], v[108:111], v[28:31]
  ds_read_b64_tr_b16 v[224:225], v9 offset:38400
  ds_read_b64_tr_b16 v[226:227], v9 offset:46080
  v_cvt_pk_bf16_f32 v147, v198, v199
  s_cbranch_vccnz SL46
  s_barrier
SL46:
  s_waitcnt lgkmcnt(4)
  v_mfma_f32_16x16x32_bf16 v[24:27], v[240:243], v[88:91], v[24:27]
  v_exp_f32 v211, v59
  v_mfma_f32_16x16x32_bf16 v[24:27], v[244:247], v[92:95], v[24:27]
  ds_read_b64_tr_b16 v[228:229], v10 offset:38400
  ds_read_b64_tr_b16 v[230:231], v10 offset:46080
  v_cvt_pk_bf16_f32 v153, v210, v211
  v_mfma_f32_16x16x32_bf16 v[24:27], v[248:251], v[96:99], v[24:27]
  ds_read_b64_tr_b16 v[232:233], v11 offset:38400
  ds_read_b64_tr_b16 v[234:235], v11 offset:46080
  v_cvt_pk_bf16_f32 v144, v200, v201
  v_mfma_f32_16x16x32_bf16 v[188:191], v[192:195], v[164:167], 0
  ds_read_b64_tr_b16 v[236:237], v12 offset:38400
  ds_read_b64_tr_b16 v[238:239], v12 offset:46080
  v_exp_f32 v202, v42
  v_mfma_f32_16x16x32_bf16 v[188:191], v[192:195], v[160:163], v[188:191]
  v_exp_f32 v203, v43
  v_mfma_f32_16x16x32_bf16 v[188:191], v[192:195], v[156:159], v[188:191]
  v_exp_f32 v196, v36
  v_mfma_f32_16x16x32_bf16 v[188:191], v[192:195], v[152:155], v[188:191]
  v_exp_f32 v197, v37
  v_mfma_f32_16x16x32_bf16 v[24:27], v[252:255], v[100:103], v[24:27]
  ds_read_b64_tr_b16 v[240:241], v9 offset:38528
  ds_read_b64_tr_b16 v[242:243], v9 offset:46208
  v_cvt_pk_bf16_f32 v145, v202, v203
  s_waitcnt lgkmcnt(8)
  v_mfma_f32_16x16x32_bf16 v[24:27], v[216:219], v[104:107], v[24:27]
  v_exp_f32 v198, v38
  v_mfma_f32_16x16x32_bf16 v[24:27], v[220:223], v[108:111], v[24:27]
  ds_read_b64_tr_b16 v[244:245], v10 offset:38528
  ds_read_b64_tr_b16 v[246:247], v10 offset:46208
  v_cvt_pk_bf16_f32 v142, v196, v197
  v_subrev_u32 v23, 897581056, v188
  s_mov_b32 s52, 335544320
  v_cmp_gt_u32 s[48:49], s52, v23
  s_or_b64 s[48:49], s[48:49], s[44:45]
  s_cmp_eq_u64 s[48:49], -1
  s_cbranch_scc0 FB1
FBR1:
  v_mfma_f32_16x16x32_bf16 v[88:91], v[224:227], v[160:163], 0
  ds_read_b64_tr_b16 v[248:249], v11 offset:38528
  ds_read_b64_tr_b16 v[250:251], v11 offset:46208
  v_exp_f32 v199, v39
  v_mfma_f32_16x16x32_bf16 v[56:59], v[224:227], v[148:151], 0
  ds_read_b64_tr_b16 v[252:253], v12 offset:38528
  ds_read_b64_tr_b16 v[254:255], v12 offset:46208
  v_cvt_pk_bf16_f32 v143, v198, v199
  s_waitcnt lgkmcnt(8)
  v_mfma_f32_16x16x32_bf16 v[92:95], v[228:231], v[160:163], 0
  v_exp_f32 v200, v32
  v_mfma_f32_16x16x32_bf16 v[60:63], v[228:231], v[148:151], 0
  v_exp_f32 v201, v33
  v_mfma_f32_16x16x32_bf16 v[96:99], v[232:235], v[160:163], 0
  ds_read_b64_tr_b16 v[216:217], v9 offset:38656
  ds_read_b64_tr_b16 v[218:219], v9 offset:46336
  v_cvt_pk_bf16_f32 v140, v200, v201
  v_mfma_f32_16x16x32_bf16 v[64:67], v[232:235], v[148:151], 0
  v_exp_f32 v202, v34
  v_mfma_f32_16x16x32_bf16 v[100:103], v[236:239], v[160:163], 0
  ds_read_b64_tr_b16 v[220:221], v10 offset:38656
  ds_read_b64_tr_b16 v[222:223], v10 offset:46336
  v_exp_f32 v203, v35
  v_mfma_f32_16x16x32_bf16 v[68:71], v[236:239], v[148:151], 0
  ds_read_b64_tr_b16 v[224:225], v11 offset:38656
  ds_read_b64_tr_b16 v[226:227], v11 offset:46336
  v_cvt_pk_bf16_f32 v141, v202, v203
  s_waitcnt lgkmcnt(8)
  v_mfma_f32_16x16x32_bf16 v[104:107], v[240:243], v[160:163], 0
  v_exp_f32 v196, v28
  v_mfma_f32_16x16x32_bf16 v[72:75], v[240:243], v[148:151], 0
  v_exp_f32 v197, v29
  v_mfma_f32_16x16x32_bf16 v[108:111], v[244:247], v[160:163], 0
  ds_read_b64_tr_b16 v[228:229], v12 offset:38656
  ds_read_b64_tr_b16 v[230:231], v12 offset:46336
  v_mfma_f32_16x16x32_bf16 v[76:79], v[244:247], v[148:151], 0
  v_exp_f32 v198, v30
  v_mfma_f32_16x16x32_bf16 v[112:115], v[248:251], v[160:163], 0
  ds_read_b64_tr_b16 v[232:233], v9 offset:53760
  ds_read_b64_tr_b16 v[234:235], v9 offset:61440
  v_mfma_f32_16x16x32_bf16 v[80:83], v[248:251], v[148:151], 0
  ds_read_b64_tr_b16 v[236:237], v10 offset:53760
  ds_read_b64_tr_b16 v[238:239], v10 offset:61440
  s_waitcnt lgkmcnt(8)
  v_mfma_f32_16x16x32_bf16 v[116:119], v[252:255], v[160:163], 0
  v_exp_f32 v199, v31
  v_mfma_f32_16x16x32_bf16 v[84:87], v[252:255], v[148:151], 0
  v_exp_f32 v200, v24
  v_mfma_f32_16x16x32_bf16 v[120:123], v[216:219], v[160:163], 0
  ds_read_b64_tr_b16 v[240:241], v11 offset:53760
  ds_read_b64_tr_b16 v[242:243], v11 offset:61440
  v_mfma_f32_16x16x32_bf16 v[168:171], v[216:219], v[148:151], 0
  v_exp_f32 v201, v25
  v_mfma_f32_16x16x32_bf16 v[124:127], v[220:223], v[160:163], 0
  ds_read_b64_tr_b16 v[244:245], v12 offset:53760
  ds_read_b64_tr_b16 v[246:247], v12 offset:61440
  v_mfma_f32_16x16x32_bf16 v[172:175], v[220:223], v[148:151], 0
  ds_read_b64_tr_b16 v[248:249], v9 offset:53888
  ds_read_b64_tr_b16 v[250:251], v9 offset:61568
  s_waitcnt lgkmcnt(8)
  v_mfma_f32_16x16x32_bf16 v[128:131], v[224:227], v[160:163], 0
  v_exp_f32 v202, v26
  v_mfma_f32_16x16x32_bf16 v[176:179], v[224:227], v[148:151], 0
  v_exp_f32 v203, v27
  v_mfma_f32_16x16x32_bf16 v[132:135], v[228:231], v[160:163], 0
  ds_read_b64_tr_b16 v[252:253], v10 offset:53888
  ds_read_b64_tr_b16 v[254:255], v10 offset:61568
  v_mfma_f32_16x16x32_bf16 v[180:183], v[228:231], v[148:151], 0
  ds_read_b64_tr_b16 v[216:217], v11 offset:53888
  ds_read_b64_tr_b16 v[218:219], v11 offset:61568
  v_cvt_pk_bf16_f32 v138, v196, v197
  v_cvt_pk_bf16_f32 v139, v198, v199
  v_cvt_pk_bf16_f32 v136, v200, v201
  v_cvt_pk_bf16_f32 v137, v202, v203
  v_mfma_f32_16x16x32_bf16 v[184:187], v[192:195], v[148:151], 0
  ds_read_b64_tr_b16 v[220:221], v12 offset:53888
  ds_read_b64_tr_b16 v[222:223], v12 offset:61568
  v_mfma_f32_16x16x32_bf16 v[184:187], v[192:195], v[144:147], v[184:187]
  v_mfma_f32_16x16x32_bf16 v[184:187], v[192:195], v[140:143], v[184:187]
  v_mfma_f32_16x16x32_bf16 v[184:187], v[192:195], v[136:139], v[184:187]
  s_cbranch_vccnz SL47
  s_barrier
SL47:
  v_mfma_f32_16x16x32_bf16 v[88:91], v[232:235], v[164:167], v[88:91]
  s_waitcnt lgkmcnt(8)
  v_mfma_f32_16x16x32_bf16 v[92:95], v[236:239], v[164:167], v[92:95]
  ds_read_b64_tr_b16 v[224:225], v9 offset:54016
  ds_read_b64_tr_b16 v[226:227], v9 offset:61696
  v_mfma_f32_16x16x32_bf16 v[96:99], v[240:243], v[164:167], v[96:99]
  ds_read_b64_tr_b16 v[228:229], v10 offset:54016
  ds_read_b64_tr_b16 v[230:231], v10 offset:61696
  v_subrev_u32 v23, 897581056, v184
  s_mov_b32 s52, 335544320
  v_cmp_gt_u32 s[48:49], s52, v23
  s_or_b64 s[48:49], s[48:49], s[42:43]
  s_cmp_eq_u64 s[48:49], -1
  s_cbranch_scc0 FB0
FBR0:
  v_mfma_f32_16x16x32_bf16 v[100:103], v[244:247], v[164:167], v[100:103]
  ds_read_b64_tr_b16 v[232:233], v11 offset:54016
  ds_read_b64_tr_b16 v[234:235], v11 offset:61696
  s_waitcnt lgkmcnt(8)
  v_mfma_f32_16x16x32_bf16 v[104:107], v[248:251], v[164:167], v[104:107]
  v_rcp_f32 v23, v188
  v_mfma_f32_16x16x32_bf16 v[108:111], v[252:255], v[164:167], v[108:111]
  ds_read_b64_tr_b16 v[236:237], v12 offset:54016
  ds_read_b64_tr_b16 v[238:239], v12 offset:61696
  v_mfma_f32_16x16x32_bf16 v[112:115], v[216:219], v[164:167], v[112:115]
  ds_read_b64_tr_b16 v[240:241], v9 offset:23040
  ds_read_b64_tr_b16 v[242:243], v9 offset:30720
  s_waitcnt lgkmcnt(8)
  v_mfma_f32_16x16x32_bf16 v[116:119], v[220:223], v[164:167], v[116:119]
  ds_read_b64_tr_b16 v[244:245], v10 offset:23040
  ds_read_b64_tr_b16 v[246:247], v10 offset:30720
  v_mfma_f32_16x16x32_bf16 v[120:123], v[224:227], v[164:167], v[120:123]
  ds_read_b64_tr_b16 v[248:249], v11 offset:23040
  ds_read_b64_tr_b16 v[250:251], v11 offset:30720
  s_waitcnt lgkmcnt(8)
  v_mfma_f32_16x16x32_bf16 v[124:127], v[228:231], v[164:167], v[124:127]
  ds_read_b64_tr_b16 v[252:253], v12 offset:23040
  ds_read_b64_tr_b16 v[254:255], v12 offset:30720
  v_mfma_f32_16x16x32_bf16 v[128:131], v[232:235], v[164:167], v[128:131]
  ds_read_b64_tr_b16 v[216:217], v9 offset:23168
  ds_read_b64_tr_b16 v[218:219], v9 offset:30848
  s_waitcnt lgkmcnt(8)
  v_mfma_f32_16x16x32_bf16 v[132:135], v[236:239], v[164:167], v[132:135]
  ds_read_b64_tr_b16 v[220:221], v10 offset:23168
  ds_read_b64_tr_b16 v[222:223], v10 offset:30848
  s_cbranch_vccz SL48
  s_barrier
SL48:
  v_mfma_f32_16x16x32_bf16 v[88:91], v[240:243], v[156:159], v[88:91]
  ds_read_b64_tr_b16 v[224:225], v11 offset:23168
  ds_read_b64_tr_b16 v[226:227], v11 offset:30848
  v_mfma_f32_16x16x32_bf16 v[56:59], v[240:243], v[144:147], v[56:59]
  ds_read_b64_tr_b16 v[228:229], v12 offset:23168
  ds_read_b64_tr_b16 v[230:231], v12 offset:30848
  s_waitcnt lgkmcnt(8)
  v_mfma_f32_16x16x32_bf16 v[92:95], v[244:247], v[156:159], v[92:95]
  v_rcp_f32 v22, v184
  v_mfma_f32_16x16x32_bf16 v[60:63], v[244:247], v[144:147], v[60:63]
  ds_read_b64_tr_b16 v[232:233], v9 offset:23296
  ds_read_b64_tr_b16 v[234:235], v9 offset:30976
  v_mfma_f32_16x16x32_bf16 v[96:99], v[248:251], v[156:159], v[96:99]
  ds_read_b64_tr_b16 v[236:237], v10 offset:23296
  ds_read_b64_tr_b16 v[238:239], v10 offset:30976
  v_mfma_f32_16x16x32_bf16 v[64:67], v[248:251], v[144:147], v[64:67]
  ds_read_b64_tr_b16 v[240:241], v11 offset:23296
  ds_read_b64_tr_b16 v[242:243], v11 offset:30976
  v_mfma_f32_16x16x32_bf16 v[100:103], v[252:255], v[156:159], v[100:103]
  v_mfma_f32_16x16x32_bf16 v[68:71], v[252:255], v[144:147], v[68:71]
  s_waitcnt lgkmcnt(8)
  v_mfma_f32_16x16x32_bf16 v[104:107], v[216:219], v[156:159], v[104:107]
  ds_read_b64_tr_b16 v[244:245], v12 offset:23296
  ds_read_b64_tr_b16 v[246:247], v12 offset:30976
  v_mfma_f32_16x16x32_bf16 v[72:75], v[216:219], v[144:147], v[72:75]
  ds_read_b64_tr_b16 v[248:249], v9 offset:7680
  ds_read_b64_tr_b16 v[250:251], v9 offset:15360
  v_mfma_f32_16x16x32_bf16 v[108:111], v[220:223], v[156:159], v[108:111]
  ds_read_b64_tr_b16 v[252:253], v10 offset:7680
  ds_read_b64_tr_b16 v[254:255], v10 offset:15360
  v_mfma_f32_16x16x32_bf16 v[76:79], v[220:223], v[144:147], v[76:79]
  v_mfma_f32_16x16x32_bf16 v[112:115], v[224:227], v[156:159], v[112:115]
  v_mfma_f32_16x16x32_bf16 v[80:83], v[224:227], v[144:147], v[80:83]
  s_waitcnt lgkmcnt(8)
  v_mfma_f32_16x16x32_bf16 v[116:119], v[228:231], v[156:159], v[116:119]
  ds_read_b64_tr_b16 v[216:217], v11 offset:7680
  ds_read_b64_tr_b16 v[218:219], v11 offset:15360
  v_mfma_f32_16x16x32_bf16 v[84:87], v[228:231], v[144:147], v[84:87]
  ds_read_b64_tr_b16 v[220:221], v12 offset:7680
  ds_read_b64_tr_b16 v[222:223], v12 offset:15360
  v_mfma_f32_16x16x32_bf16 v[120:123], v[232:235], v[156:159], v[120:123]
  ds_read_b64_tr_b16 v[224:225], v9 offset:7808
  ds_read_b64_tr_b16 v[226:227], v9 offset:15488
  v_mfma_f32_16x16x32_bf16 v[168:171], v[232:235], v[144:147], v[168:171]
  v_mfma_f32_16x16x32_bf16 v[124:127], v[236:239], v[156:159], v[124:127]
  v_mfma_f32_16x16x32_bf16 v[172:175], v[236:239], v[144:147], v[172:175]
  s_waitcnt lgkmcnt(8)
  v_mfma_f32_16x16x32_bf16 v[128:131], v[240:243], v[156:159], v[128:131]
  ds_read_b64_tr_b16 v[228:229], v10 offset:7808
  ds_read_b64_tr_b16 v[230:231], v10 offset:15488
  v_mfma_f32_16x16x32_bf16 v[176:179], v[240:243], v[144:147], v[176:179]
  ds_read_b64_tr_b16 v[232:233], v11 offset:7808
  ds_read_b64_tr_b16 v[234:235], v11 offset:15488
  v_mfma_f32_16x16x32_bf16 v[132:135], v[244:247], v[156:159], v[132:135]
  ds_read_b64_tr_b16 v[236:237], v12 offset:7808
  ds_read_b64_tr_b16 v[238:239], v12 offset:15488
  v_mfma_f32_16x16x32_bf16 v[180:183], v[244:247], v[144:147], v[180:183]
  v_mfma_f32_16x16x32_bf16 v[88:91], v[248:251], v[152:155], v[88:91]
  v_mfma_f32_16x16x32_bf16 v[56:59], v[248:251], v[140:143], v[56:59]
  s_waitcnt lgkmcnt(8)
  v_mfma_f32_16x16x32_bf16 v[92:95], v[252:255], v[152:155], v[92:95]
  ds_read_b64_tr_b16 v[240:241], v9 offset:7936
  ds_read_b64_tr_b16 v[242:243], v9 offset:15616
  v_mfma_f32_16x16x32_bf16 v[60:63], v[252:255], v[140:143], v[60:63]
  ds_read_b64_tr_b16 v[244:245], v10 offset:7936
  ds_read_b64_tr_b16 v[246:247], v10 offset:15616
  v_mfma_f32_16x16x32_bf16 v[96:99], v[216:219], v[152:155], v[96:99]
  ds_read_b64_tr_b16 v[248:249], v11 offset:7936
  ds_read_b64_tr_b16 v[250:251], v11 offset:15616
  v_mfma_f32_16x16x32_bf16 v[64:67], v[216:219], v[140:143], v[64:67]
  v_cvt_pk_bf16_f32 v156, v88, v89
  v_cvt_pk_bf16_f32 v157, v90, v91
  v_mfma_f32_16x16x32_bf16 v[100:103], v[220:223], v[152:155], v[100:103]
  v_cvt_pk_bf16_f32 v158, v92, v93
  v_cvt_pk_bf16_f32 v159, v94, v95
  v_mfma_f32_16x16x32_bf16 v[68:71], v[220:223], v[140:143], v[68:71]
  s_waitcnt lgkmcnt(8)
  v_mfma_f32_16x16x32_bf16 v[104:107], v[224:227], v[152:155], v[104:107]
  ds_read_b64_tr_b16 v[252:253], v12 offset:7936
  ds_read_b64_tr_b16 v[254:255], v12 offset:15616
  v_mfma_f32_16x16x32_bf16 v[72:75], v[224:227], v[140:143], v[72:75]
  ds_read_b64_tr_b16 v[216:217], v15 offset:0
  ds_read_b64_tr_b16 v[218:219], v9 offset:0
  v_mfma_f32_16x16x32_bf16 v[108:111], v[228:231], v[152:155], v[108:111]
  ds_read_b64_tr_b16 v[220:221], v16 offset:0
  ds_read_b64_tr_b16 v[222:223], v10 offset:0
  v_mfma_f32_16x16x32_bf16 v[76:79], v[228:231], v[140:143], v[76:79]
  v_cvt_pk_bf16_f32 v160, v96, v97
  v_cvt_pk_bf16_f32 v161, v98, v99
  v_mfma_f32_16x16x32_bf16 v[112:115], v[232:235], v[152:155], v[112:115]
  v_cvt_pk_bf16_f32 v162, v100, v101
  v_cvt_pk_bf16_f32 v163, v102, v103
  v_mfma_f32_16x16x32_bf16 v[80:83], v[232:235], v[140:143], v[80:83]
  v_cvt_pk_bf16_f32 v164, v104, v105
  s_waitcnt lgkmcnt(8)
  v_mfma_f32_16x16x32_bf16 v[116:119], v[236:239], v[152:155], v[116:119]
  ds_read_b64_tr_b16 v[224:225], v17 offset:0
  ds_read_b64_tr_b16 v[226:227], v11 offset:0
  v_mfma_f32_16x16x32_bf16 v[84:87], v[236:239], v[140:143], v[84:87]
  ds_read_b64_tr_b16 v[228:229], v18 offset:0
  ds_read_b64_tr_b16 v[230:231], v12 offset:0
  v_mfma_f32_16x16x32_bf16 v[120:123], v[240:243], v[152:155], v[120:123]
  ds_read_b64_tr_b16 v[232:233], v15 offset:128
  ds_read_b64_tr_b16 v[234:235], v9 offset:128
  v_mfma_f32_16x16x32_bf16 v[168:171], v[240:243], v[140:143], v[168:171]
  v_cvt_pk_bf16_f32 v165, v106, v107
  v_cvt_pk_bf16_f32 v166, v108, v109
  v_mfma_f32_16x16x32_bf16 v[124:127], v[244:247], v[152:155], v[124:127]
  v_cvt_pk_bf16_f32 v167, v110, v111
  v_cvt_pk_bf16_f32 v24, v112, v113
  v_mfma_f32_16x16x32_bf16 v[172:175], v[244:247], v[140:143], v[172:175]
  v_cvt_pk_bf16_f32 v25, v114, v115
  s_waitcnt lgkmcnt(8)
  v_mfma_f32_16x16x32_bf16 v[128:131], v[248:251], v[152:155], v[128:131]
  ds_read_b64_tr_b16 v[236:237], v16 offset:128
  ds_read_b64_tr_b16 v[238:239], v10 offset:128
  v_mfma_f32_16x16x32_bf16 v[176:179], v[248:251], v[140:143], v[176:179]
  ds_read_b64_tr_b16 v[240:241], v17 offset:128
  ds_read_b64_tr_b16 v[242:243], v11 offset:128
  v_mfma_f32_16x16x32_bf16 v[132:135], v[252:255], v[152:155], v[132:135]
  ds_read_b64_tr_b16 v[244:245], v18 offset:128
  ds_read_b64_tr_b16 v[246:247], v12 offset:128
  v_mfma_f32_16x16x32_bf16 v[180:183], v[252:255], v[140:143], v[180:183]
  v_cvt_pk_bf16_f32 v26, v116, v117
  v_cvt_pk_bf16_f32 v27, v118, v119
  v_mfma_f32_16x16x32_bf16 v[56:59], v[216:219], v[136:139], v[56:59]
  v_cvt_pk_bf16_f32 v28, v120, v121
  s_waitcnt lgkmcnt(8)
  v_mfma_f32_16x16x32_bf16 v[60:63], v[220:223], v[136:139], v[60:63]
  ds_read_b64_tr_b16 v[248:249], v15 offset:256
  ds_read_b64_tr_b16 v[250:251], v9 offset:256
  v_mfma_f32_16x16x32_bf16 v[64:67], v[224:227], v[136:139], v[64:67]
  ds_read_b64_tr_b16 v[252:253], v16 offset:256
  ds_read_b64_tr_b16 v[254:255], v10 offset:256
  v_mfma_f32_16x16x32_bf16 v[68:71], v[228:231], v[136:139], v[68:71]
  ds_read_b64_tr_b16 v[216:217], v17 offset:256
  ds_read_b64_tr_b16 v[218:219], v11 offset:256
  s_waitcnt lgkmcnt(8)
  v_mfma_f32_16x16x32_bf16 v[72:75], v[232:235], v[136:139], v[72:75]
  ds_read_b64_tr_b16 v[220:221], v18 offset:256
  ds_read_b64_tr_b16 v[222:223], v12 offset:256
  v_mfma_f32_16x16x32_bf16 v[76:79], v[236:239], v[136:139], v[76:79]
  v_cvt_pk_bf16_f32 v29, v122, v123
  v_cvt_pk_bf16_f32 v30, v124, v125
  s_waitcnt lgkmcnt(0)
  s_cbranch_vccz SL49
  s_barrier
SL49:
  ds_read_b128 v[224:227], v2 offset:30720
  ds_read_b128 v[228:231], v2 offset:31744
  ds_read_b128 v[232:235], v2 offset:32768
  ds_read_b128 v[236:239], v2 offset:33792
  v_mfma_f32_16x16x32_bf16 v[80:83], v[240:243], v[136:139], v[80:83]
  ds_read_b128 v[240:243], v2 offset:34816
  v_cvt_pk_bf16_f32 v31, v126, v127
  v_mfma_f32_16x16x32_bf16 v[84:87], v[244:247], v[136:139], v[84:87]
  ds_read_b128 v[244:247], v2 offset:35840
  v_cvt_pk_bf16_f32 v32, v128, v129
  v_mfma_f32_16x16x32_bf16 v[168:171], v[248:251], v[136:139], v[168:171]
  ds_read_b128 v[248:251], v2 offset:36864
  v_cvt_pk_bf16_f32 v33, v130, v131
  v_mfma_f32_16x16x32_bf16 v[172:175], v[252:255], v[136:139], v[172:175]
  ds_read_b128 v[252:255], v2 offset:37888
  v_cvt_pk_bf16_f32 v34, v132, v133
  v_mfma_f32_16x16x32_bf16 v[176:179], v[216:219], v[136:139], v[176:179]
  ds_read_b128 v[216:219], v2 offset:38912
  v_cvt_pk_bf16_f32 v35, v134, v135
  v_mfma_f32_16x16x32_bf16 v[180:183], v[220:223], v[136:139], v[180:183]
  ds_read_b128 v[220:223], v2 offset:39936
  s_waitcnt lgkmcnt(6)
  v_mfma_f32_16x16x32_bf16 v[192:195], v[224:227], v[156:159], 0
  v_cvt_pk_bf16_f32 v140, v56, v57
  v_cvt_pk_bf16_f32 v141, v58, v59
  v_mfma_f32_16x16x32_bf16 v[192:195], v[228:231], v[160:163], v[192:195]
  v_cvt_pk_bf16_f32 v142, v60, v61
  v_cvt_pk_bf16_f32 v143, v62, v63
  v_mfma_f32_16x16x32_bf16 v[192:195], v[232:235], v[164:167], v[192:195]
  v_cvt_pk_bf16_f32 v144, v64, v65
  v_cvt_pk_bf16_f32 v145, v66, v67
  v_mfma_f32_16x16x32_bf16 v[192:195], v[236:239], v[24:27], v[192:195]
  v_cvt_pk_bf16_f32 v146, v68, v69
  s_waitcnt lgkmcnt(4)
  v_mfma_f32_16x16x32_bf16 v[192:195], v[240:243], v[28:31], v[192:195]
  v_cvt_pk_bf16_f32 v147, v70, v71
  v_cvt_pk_bf16_f32 v148, v72, v73
  v_mfma_f32_16x16x32_bf16 v[192:195], v[244:247], v[32:35], v[192:195]
  v_cvt_pk_bf16_f32 v149, v74, v75
  v_cvt_pk_bf16_f32 v150, v76, v77
  v_mfma_f32_16x16x32_bf16 v[184:187], v[224:227], v[140:143], 0
  ds_read_b128 v[224:227], v2 offset:40960
  v_cvt_pk_bf16_f32 v151, v78, v79
  v_mfma_f32_16x16x32_bf16 v[184:187], v[228:231], v[144:147], v[184:187]
  ds_read_b128 v[228:231], v2 offset:41984
  v_cvt_pk_bf16_f32 v152, v80, v81
  v_mfma_f32_16x16x32_bf16 v[184:187], v[232:235], v[148:151], v[184:187]
  ds_read_b128 v[232:235], v2 offset:43008
  v_cvt_pk_bf16_f32 v153, v82, v83
  v_cvt_pk_bf16_f32 v154, v84, v85
  v_cvt_pk_bf16_f32 v155, v86, v87
  s_nop 1
  v_mfma_f32_16x16x32_bf16 v[184:187], v[236:239], v[152:155], v[184:187]
  ds_read_b128 v[236:239], v2 offset:44032
  v_cvt_pk_bf16_f32 v36, v168, v169
  v_cvt_pk_bf16_f32 v37, v170, v171
  v_cvt_pk_bf16_f32 v38, v172, v173
  v_cvt_pk_bf16_f32 v39, v174, v175
  s_nop 1
  v_mfma_f32_16x16x32_bf16 v[184:187], v[240:243], v[36:39], v[184:187]
  ds_read_b128 v[240:243], v2 offset:45056
  v_cvt_pk_bf16_f32 v40, v176, v177
  v_cvt_pk_bf16_f32 v41, v178, v179
  v_cvt_pk_bf16_f32 v42, v180, v181
  v_cvt_pk_bf16_f32 v43, v182, v183
  s_nop 1
  v_mfma_f32_16x16x32_bf16 v[184:187], v[244:247], v[40:43], v[184:187]
  ds_read_b128 v[244:247], v2 offset:46080
  s_waitcnt lgkmcnt(6)
  v_mfma_f32_16x16x32_bf16 v[188:191], v[248:251], v[140:143], 0
  v_mul_f32 v192, v192, v23
  v_mul_f32 v193, v193, v23
  v_mfma_f32_16x16x32_bf16 v[188:191], v[252:255], v[144:147], v[188:191]
  v_mul_f32 v194, v194, v23
  v_mul_f32 v195, v195, v23
  v_mfma_f32_16x16x32_bf16 v[188:191], v[216:219], v[148:151], v[188:191]
  v_cvt_pk_bf16_f32 v92, v192, v193
  v_cvt_pk_bf16_f32 v93, v194, v195
  v_mfma_f32_16x16x32_bf16 v[196:199], v[248:251], v[156:159], 0
  ds_read_b128 v[248:251], v2 offset:47104
  v_mul_f32 v184, v184, v22
  v_mfma_f32_16x16x32_bf16 v[196:199], v[252:255], v[160:163], v[196:199]
  ds_read_b128 v[252:255], v2 offset:48128
  v_mul_f32 v185, v185, v22
  v_mfma_f32_16x16x32_bf16 v[196:199], v[216:219], v[164:167], v[196:199]
  ds_read_b128 v[216:219], v2 offset:49152
  v_mul_f32 v186, v186, v22
  v_mfma_f32_16x16x32_bf16 v[196:199], v[220:223], v[24:27], v[196:199]
  v_mul_f32 v187, v187, v22
  s_waitcnt lgkmcnt(5)
  v_mfma_f32_16x16x32_bf16 v[196:199], v[224:227], v[28:31], v[196:199]
  v_cvt_pk_bf16_f32 v88, v184, v185
  v_cvt_pk_bf16_f32 v89, v186, v187
  v_mfma_f32_16x16x32_bf16 v[196:199], v[228:231], v[32:35], v[196:199]
  v_mfma_f32_16x16x32_bf16 v[188:191], v[220:223], v[152:155], v[188:191]
  ds_read_b128 v[220:223], v2 offset:50176
  v_mfma_f32_16x16x32_bf16 v[188:191], v[224:227], v[36:39], v[188:191]
  ds_read_b128 v[224:227], v2 offset:51200
  v_mfma_f32_16x16x32_bf16 v[188:191], v[228:231], v[40:43], v[188:191]
  ds_read_b128 v[228:231], v2 offset:52224
  s_mov_b32 s100, 71680
  buffer_load_dwordx4 v[104:107], v1, s[20:23], s100 offen offset:0 sc1
  buffer_load_dwordx4 v[108:111], v1, s[20:23], s100 offen offset:1024 sc1
  v_mfma_f32_16x16x32_bf16 v[200:203], v[232:235], v[140:143], 0
  v_mul_f32 v196, v196, v23
  v_mul_f32 v197, v197, v23
  v_mfma_f32_16x16x32_bf16 v[200:203], v[236:239], v[144:147], v[200:203]
  v_mul_f32 v198, v198, v23
  s_waitcnt lgkmcnt(4)
  v_mfma_f32_16x16x32_bf16 v[200:203], v[240:243], v[148:151], v[200:203]
  v_mul_f32 v199, v199, v23
  v_cvt_pk_bf16_f32 v94, v196, v197
  v_mfma_f32_16x16x32_bf16 v[208:211], v[232:235], v[156:159], 0
  ds_read_b128 v[232:235], v2 offset:53248
  v_cvt_pk_bf16_f32 v95, v198, v199
  v_mfma_f32_16x16x32_bf16 v[208:211], v[236:239], v[160:163], v[208:211]
  buffer_store_dwordx4 v[92:95], v6, s[16:19], 0 offen offset:0 nt sc1
  v_mul_f32 v188, v188, v22
  v_mfma_f32_16x16x32_bf16 v[208:211], v[240:243], v[164:167], v[208:211]
  ds_read_b128 v[236:239], v2 offset:54272
  v_mul_f32 v189, v189, v22
  v_mfma_f32_16x16x32_bf16 v[208:211], v[244:247], v[24:27], v[208:211]
  ds_read_b128 v[240:243], v2 offset:55296
  v_mul_f32 v190, v190, v22
  v_mfma_f32_16x16x32_bf16 v[208:211], v[248:251], v[28:31], v[208:211]
  v_mul_f32 v191, v191, v22
  v_cvt_pk_bf16_f32 v90, v188, v189
  v_mfma_f32_16x16x32_bf16 v[208:211], v[252:255], v[32:35], v[208:211]
  v_cvt_pk_bf16_f32 v91, v190, v191
  v_mfma_f32_16x16x32_bf16 v[200:203], v[244:247], v[152:155], v[200:203]
  buffer_store_dwordx4 v[88:91], v5, s[16:19], 0 offen offset:0 nt sc1
  v_mfma_f32_16x16x32_bf16 v[200:203], v[248:251], v[36:39], v[200:203]
  ds_read_b128 v[244:247], v2 offset:56320
  ds_read_b128 v[248:251], v2 offset:57344
  v_mfma_f32_16x16x32_bf16 v[200:203], v[252:255], v[40:43], v[200:203]
  ds_read_b128 v[252:255], v2 offset:58368
  s_waitcnt lgkmcnt(6)
  v_mfma_f32_16x16x32_bf16 v[204:207], v[216:219], v[140:143], 0
  v_mul_f32 v208, v208, v23
  v_mul_f32 v209, v209, v23
  v_mfma_f32_16x16x32_bf16 v[204:207], v[220:223], v[144:147], v[204:207]
  v_mul_f32 v210, v210, v23
  v_mul_f32 v211, v211, v23
  v_mfma_f32_16x16x32_bf16 v[204:207], v[224:227], v[148:151], v[204:207]
  v_cvt_pk_bf16_f32 v100, v208, v209
  v_cvt_pk_bf16_f32 v101, v210, v211
  v_mfma_f32_16x16x32_bf16 v[212:215], v[216:219], v[156:159], 0
  ds_read_b128 v[216:219], v2 offset:59392
  v_mul_f32 v200, v200, v22
  v_mfma_f32_16x16x32_bf16 v[212:215], v[220:223], v[160:163], v[212:215]
  ds_read_b128 v[220:223], v2 offset:60416
  v_mul_f32 v201, v201, v22
  v_mfma_f32_16x16x32_bf16 v[212:215], v[224:227], v[164:167], v[212:215]
  ds_read_b128 v[224:227], v1 offset:0
  v_mul_f32 v202, v202, v22
  v_mfma_f32_16x16x32_bf16 v[212:215], v[228:231], v[24:27], v[212:215]
  v_mul_f32 v203, v203, v22
  s_waitcnt lgkmcnt(5)
  v_mfma_f32_16x16x32_bf16 v[212:215], v[232:235], v[28:31], v[212:215]
  v_cvt_pk_bf16_f32 v96, v200, v201
  v_cvt_pk_bf16_f32 v97, v202, v203
  v_mfma_f32_16x16x32_bf16 v[212:215], v[236:239], v[32:35], v[212:215]
  v_mfma_f32_16x16x32_bf16 v[204:207], v[228:231], v[152:155], v[204:207]
  ds_read_b128 v[228:231], v1 offset:1024
  v_mfma_f32_16x16x32_bf16 v[204:207], v[232:235], v[36:39], v[204:207]
  ds_read_b128 v[232:235], v1 offset:2048
  v_mfma_f32_16x16x32_bf16 v[204:207], v[236:239], v[40:43], v[204:207]
  ds_read_b128 v[236:239], v1 offset:3072
  s_cbranch_vccz SL50
  s_barrier
SL50:
  v_mfma_f32_16x16x32_bf16 v[184:187], v[240:243], v[140:143], 0
  v_mul_f32 v212, v212, v23
  v_mul_f32 v213, v213, v23
  v_mfma_f32_16x16x32_bf16 v[184:187], v[244:247], v[144:147], v[184:187]
  v_mul_f32 v214, v214, v23
  s_waitcnt lgkmcnt(4)
  v_mfma_f32_16x16x32_bf16 v[184:187], v[248:251], v[148:151], v[184:187]
  v_mul_f32 v215, v215, v23
  v_cvt_pk_bf16_f32 v102, v212, v213
  v_mfma_f32_16x16x32_bf16 v[192:195], v[240:243], v[156:159], 0
  ds_read_b128 v[240:243], v1 offset:4096
  v_cvt_pk_bf16_f32 v103, v214, v215
  v_mfma_f32_16x16x32_bf16 v[192:195], v[244:247], v[160:163], v[192:195]
  buffer_store_dwordx4 v[100:103], v6, s[16:19], 0 offen offset:64 nt sc1
  v_mul_f32 v204, v204, v22
  v_mfma_f32_16x16x32_bf16 v[192:195], v[248:251], v[164:167], v[192:195]
  ds_read_b128 v[244:247], v1 offset:5120
  v_mul_f32 v205, v205, v22
  v_mfma_f32_16x16x32_bf16 v[192:195], v[252:255], v[24:27], v[192:195]
  ds_read_b128 v[248:251], v1 offset:6144
  v_mul_f32 v206, v206, v22
  v_mfma_f32_16x16x32_bf16 v[192:195], v[216:219], v[28:31], v[192:195]
  v_mul_f32 v207, v207, v22
  v_cvt_pk_bf16_f32 v98, v204, v205
  v_mfma_f32_16x16x32_bf16 v[192:195], v[220:223], v[32:35], v[192:195]
  v_cvt_pk_bf16_f32 v99, v206, v207
  v_mfma_f32_16x16x32_bf16 v[184:187], v[252:255], v[152:155], v[184:187]
  buffer_store_dwordx4 v[96:99], v5, s[16:19], 0 offen offset:64 nt sc1
  v_mfma_f32_16x16x32_bf16 v[184:187], v[216:219], v[36:39], v[184:187]
  ds_read_b128 v[252:255], v1 offset:7168
  ds_read_b128 v[216:219], v1 offset:8192
  v_mfma_f32_16x16x32_bf16 v[184:187], v[220:223], v[40:43], v[184:187]
  ds_read_b128 v[220:223], v1 offset:9216
  s_waitcnt lgkmcnt(6)
  v_mfma_f32_16x16x32_bf16 v[188:191], v[224:227], v[140:143], 0
  v_mul_f32 v192, v192, v23
  v_mul_f32 v193, v193, v23
  v_mfma_f32_16x16x32_bf16 v[188:191], v[228:231], v[144:147], v[188:191]
  v_mul_f32 v194, v194, v23
  v_mul_f32 v195, v195, v23
  v_mfma_f32_16x16x32_bf16 v[188:191], v[232:235], v[148:151], v[188:191]
  v_cvt_pk_bf16_f32 v92, v192, v193
  v_cvt_pk_bf16_f32 v93, v194, v195
  v_mfma_f32_16x16x32_bf16 v[196:199], v[224:227], v[156:159], 0
  ds_read_b128 v[224:227], v2 offset:0
  v_mul_f32 v184, v184, v22
  v_mfma_f32_16x16x32_bf16 v[196:199], v[228:231], v[160:163], v[196:199]
  ds_read_b128 v[228:231], v2 offset:1024
  v_mul_f32 v185, v185, v22
  v_mfma_f32_16x16x32_bf16 v[196:199], v[232:235], v[164:167], v[196:199]
  ds_read_b128 v[232:235], v2 offset:2048
  v_mul_f32 v186, v186, v22
  v_mfma_f32_16x16x32_bf16 v[196:199], v[236:239], v[24:27], v[196:199]
  v_mul_f32 v187, v187, v22
  s_waitcnt lgkmcnt(5)
  v_mfma_f32_16x16x32_bf16 v[196:199], v[240:243], v[28:31], v[196:199]
  v_cvt_pk_bf16_f32 v88, v184, v185
  v_cvt_pk_bf16_f32 v89, v186, v187
  v_mfma_f32_16x16x32_bf16 v[196:199], v[244:247], v[32:35], v[196:199]
  v_mfma_f32_16x16x32_bf16 v[188:191], v[236:239], v[152:155], v[188:191]
  ds_read_b128 v[236:239], v2 offset:3072
  v_mfma_f32_16x16x32_bf16 v[188:191], v[240:243], v[36:39], v[188:191]
  ds_read_b128 v[240:243], v2 offset:4096
  v_mfma_f32_16x16x32_bf16 v[188:191], v[244:247], v[40:43], v[188:191]
  ds_read_b128 v[244:247], v2 offset:5120
  v_mfma_f32_16x16x32_bf16 v[200:203], v[248:251], v[140:143], 0
  v_mfma_f32_16x16x32_bf16 v[200:203], v[252:255], v[144:147], v[200:203]
  v_mul_f32 v196, v196, v23
  s_waitcnt lgkmcnt(4)
  v_mfma_f32_16x16x32_bf16 v[200:203], v[216:219], v[148:151], v[200:203]
  v_mul_f32 v197, v197, v23
  v_mul_f32 v198, v198, v23
  v_mfma_f32_16x16x32_bf16 v[208:211], v[248:251], v[156:159], 0
  ds_read_b128 v[248:251], v2 offset:6144
  v_mul_f32 v199, v199, v23
  v_mfma_f32_16x16x32_bf16 v[208:211], v[252:255], v[160:163], v[208:211]
  ds_read_b128 v[252:255], v2 offset:7168
  v_cvt_pk_bf16_f32 v94, v196, v197
  v_mfma_f32_16x16x32_bf16 v[208:211], v[216:219], v[164:167], v[208:211]
  ds_read_b128 v[216:219], v2 offset:8192
  v_cvt_pk_bf16_f32 v95, v198, v199
  v_mfma_f32_16x16x32_bf16 v[208:211], v[220:223], v[24:27], v[208:211]
  buffer_store_dwordx4 v[92:95], v6, s[16:19], 0 offen offset:128 nt sc1
  v_mul_f32 v188, v188, v22
  v_mfma_f32_16x16x32_bf16 v[208:211], v[224:227], v[28:31], v[208:211]
  v_mul_f32 v189, v189, v22
  v_mul_f32 v190, v190, v22
  v_mfma_f32_16x16x32_bf16 v[208:211], v[228:231], v[32:35], v[208:211]
  v_mul_f32 v191, v191, v22
  v_cvt_pk_bf16_f32 v90, v188, v189
  v_mfma_f32_16x16x32_bf16 v[200:203], v[220:223], v[152:155], v[200:203]
  ds_read_b128 v[220:223], v2 offset:9216
  v_cvt_pk_bf16_f32 v91, v190, v191
  v_mfma_f32_16x16x32_bf16 v[200:203], v[224:227], v[36:39], v[200:203]
  buffer_store_dwordx4 v[88:91], v5, s[16:19], 0 offen offset:128 nt sc1
  v_mfma_f32_16x16x32_bf16 v[200:203], v[228:231], v[40:43], v[200:203]
  ds_read_b128 v[224:227], v2 offset:10240
  s_waitcnt lgkmcnt(5)
  v_mfma_f32_16x16x32_bf16 v[204:207], v[232:235], v[140:143], 0
  ds_read_b128 v[228:231], v2 offset:11264
  v_mul_f32 v208, v208, v23
  v_mfma_f32_16x16x32_bf16 v[204:207], v[236:239], v[144:147], v[204:207]
  v_mul_f32 v209, v209, v23
  v_mul_f32 v210, v210, v23
  v_mfma_f32_16x16x32_bf16 v[204:207], v[240:243], v[148:151], v[204:207]
  v_mul_f32 v211, v211, v23
  v_cvt_pk_bf16_f32 v100, v208, v209
  v_mfma_f32_16x16x32_bf16 v[212:215], v[232:235], v[156:159], 0
  ds_read_b128 v[232:235], v2 offset:12288
  v_cvt_pk_bf16_f32 v101, v210, v211
  v_mfma_f32_16x16x32_bf16 v[212:215], v[236:239], v[160:163], v[212:215]
  ds_read_b128 v[236:239], v2 offset:13312
  v_mul_f32 v200, v200, v22
  v_mfma_f32_16x16x32_bf16 v[212:215], v[240:243], v[164:167], v[212:215]
  ds_read_b128 v[240:243], v2 offset:14336
  v_mul_f32 v201, v201, v22
  v_mfma_f32_16x16x32_bf16 v[212:215], v[244:247], v[24:27], v[212:215]
  v_mul_f32 v202, v202, v22
  s_waitcnt lgkmcnt(5)
  v_mfma_f32_16x16x32_bf16 v[212:215], v[248:251], v[28:31], v[212:215]
  v_mul_f32 v203, v203, v22
  v_cvt_pk_bf16_f32 v96, v200, v201
  v_mfma_f32_16x16x32_bf16 v[212:215], v[252:255], v[32:35], v[212:215]
  v_cvt_pk_bf16_f32 v97, v202, v203
  v_mfma_f32_16x16x32_bf16 v[204:207], v[244:247], v[152:155], v[204:207]
  ds_read_b128 v[244:247], v2 offset:15360
  v_mfma_f32_16x16x32_bf16 v[204:207], v[248:251], v[36:39], v[204:207]
  ds_read_b128 v[248:251], v2 offset:16384
  v_mfma_f32_16x16x32_bf16 v[204:207], v[252:255], v[40:43], v[204:207]
  ds_read_b128 v[252:255], v2 offset:17408
  v_mfma_f32_16x16x32_bf16 v[184:187], v[216:219], v[140:143], 0
  v_mul_f32 v212, v212, v23
  v_mul_f32 v213, v213, v23
  v_mfma_f32_16x16x32_bf16 v[184:187], v[220:223], v[144:147], v[184:187]
  v_mul_f32 v214, v214, v23
  s_waitcnt lgkmcnt(4)
  v_mfma_f32_16x16x32_bf16 v[184:187], v[224:227], v[148:151], v[184:187]
  v_mul_f32 v215, v215, v23
  v_cvt_pk_bf16_f32 v102, v212, v213
  v_mfma_f32_16x16x32_bf16 v[192:195], v[216:219], v[156:159], 0
  ds_read_b128 v[216:219], v2 offset:18432
  v_cvt_pk_bf16_f32 v103, v214, v215
  v_mfma_f32_16x16x32_bf16 v[192:195], v[220:223], v[160:163], v[192:195]
  buffer_store_dwordx4 v[100:103], v6, s[16:19], 0 offen offset:192 nt sc1
  v_mul_f32 v204, v204, v22
  v_mfma_f32_16x16x32_bf16 v[192:195], v[224:227], v[164:167], v[192:195]
  ds_read_b128 v[220:223], v2 offset:19456
  v_mul_f32 v205, v205, v22
  v_mfma_f32_16x16x32_bf16 v[192:195], v[228:231], v[24:27], v[192:195]
  ds_read_b128 v[224:227], v2 offset:20480
  v_mul_f32 v206, v206, v22
  v_mfma_f32_16x16x32_bf16 v[192:195], v[232:235], v[28:31], v[192:195]
  v_mul_f32 v207, v207, v22
  v_cvt_pk_bf16_f32 v98, v204, v205
  v_mfma_f32_16x16x32_bf16 v[192:195], v[236:239], v[32:35], v[192:195]
  v_cvt_pk_bf16_f32 v99, v206, v207
  v_mfma_f32_16x16x32_bf16 v[184:187], v[228:231], v[152:155], v[184:187]
  buffer_store_dwordx4 v[96:99], v5, s[16:19], 0 offen offset:192 nt sc1
  v_mfma_f32_16x16x32_bf16 v[184:187], v[232:235], v[36:39], v[184:187]
  ds_read_b128 v[228:231], v2 offset:21504
  ds_read_b128 v[232:235], v2 offset:22528
  v_mfma_f32_16x16x32_bf16 v[184:187], v[236:239], v[40:43], v[184:187]
  ds_read_b128 v[236:239], v2 offset:23552
  s_waitcnt lgkmcnt(6)
  v_mfma_f32_16x16x32_bf16 v[188:191], v[240:243], v[140:143], 0
  v_mul_f32 v192, v192, v23
  v_mul_f32 v193, v193, v23
  v_mfma_f32_16x16x32_bf16 v[188:191], v[244:247], v[144:147], v[188:191]
  v_mul_f32 v194, v194, v23
  v_mul_f32 v195, v195, v23
  v_mfma_f32_16x16x32_bf16 v[188:191], v[248:251], v[148:151], v[188:191]
  v_cvt_pk_bf16_f32 v92, v192, v193
  v_cvt_pk_bf16_f32 v93, v194, v195
  v_mfma_f32_16x16x32_bf16 v[196:199], v[240:243], v[156:159], 0
  ds_read_b128 v[240:243], v2 offset:24576
  v_mul_f32 v184, v184, v22
  v_mfma_f32_16x16x32_bf16 v[196:199], v[244:247], v[160:163], v[196:199]
  ds_read_b128 v[244:247], v2 offset:25600
  v_mul_f32 v185, v185, v22
  v_mfma_f32_16x16x32_bf16 v[196:199], v[248:251], v[164:167], v[196:199]
  ds_read_b128 v[248:251], v2 offset:26624
  v_mul_f32 v186, v186, v22
  v_mfma_f32_16x16x32_bf16 v[196:199], v[252:255], v[24:27], v[196:199]
  v_mul_f32 v187, v187, v22
  s_waitcnt lgkmcnt(5)
  v_mfma_f32_16x16x32_bf16 v[196:199], v[216:219], v[28:31], v[196:199]
  v_cvt_pk_bf16_f32 v88, v184, v185
  v_cvt_pk_bf16_f32 v89, v186, v187
  v_mfma_f32_16x16x32_bf16 v[196:199], v[220:223], v[32:35], v[196:199]
  v_mfma_f32_16x16x32_bf16 v[188:191], v[252:255], v[152:155], v[188:191]
  ds_read_b128 v[252:255], v2 offset:27648
  v_mfma_f32_16x16x32_bf16 v[188:191], v[216:219], v[36:39], v[188:191]
  ds_read_b128 v[216:219], v2 offset:28672
  v_mfma_f32_16x16x32_bf16 v[188:191], v[220:223], v[40:43], v[188:191]
  ds_read_b128 v[220:223], v2 offset:29696
  s_waitcnt vmcnt(8)
  v_mfma_f32_16x16x32_bf16 v[200:203], v[224:227], v[140:143], 0
  v_mul_f32 v196, v196, v23
  v_mul_f32 v197, v197, v23
  v_mfma_f32_16x16x32_bf16 v[200:203], v[228:231], v[144:147], v[200:203]
  v_mul_f32 v198, v198, v23
  s_waitcnt lgkmcnt(4)
  v_mfma_f32_16x16x32_bf16 v[200:203], v[232:235], v[148:151], v[200:203]
  v_mul_f32 v199, v199, v23
  v_cvt_pk_bf16_f32 v94, v196, v197
  v_mfma_f32_16x16x32_bf16 v[208:211], v[224:227], v[156:159], 0
  v_cvt_pk_bf16_f32 v95, v198, v199
  v_mul_f32 v188, v188, v22
  v_mfma_f32_16x16x32_bf16 v[208:211], v[228:231], v[160:163], v[208:211]
  buffer_store_dwordx4 v[92:95], v6, s[16:19], 0 offen offset:256 nt sc1
  v_mul_f32 v189, v189, v22
  v_mfma_f32_16x16x32_bf16 v[208:211], v[232:235], v[164:167], v[208:211]
  v_mul_f32 v190, v190, v22
  v_mul_f32 v191, v191, v22
  v_mfma_f32_16x16x32_bf16 v[208:211], v[236:239], v[24:27], v[208:211]
  v_cvt_pk_bf16_f32 v90, v188, v189
  v_cvt_pk_bf16_f32 v91, v190, v191
  v_mfma_f32_16x16x32_bf16 v[208:211], v[240:243], v[28:31], v[208:211]
  buffer_store_dwordx4 v[88:91], v5, s[16:19], 0 offen offset:256 nt sc1
  v_mfma_f32_16x16x32_bf16 v[208:211], v[244:247], v[32:35], v[208:211]
  v_mfma_f32_16x16x32_bf16 v[200:203], v[236:239], v[152:155], v[200:203]
  v_mfma_f32_16x16x32_bf16 v[200:203], v[240:243], v[36:39], v[200:203]
  v_mfma_f32_16x16x32_bf16 v[200:203], v[244:247], v[40:43], v[200:203]
  s_waitcnt lgkmcnt(3)
  v_mfma_f32_16x16x32_bf16 v[204:207], v[248:251], v[140:143], 0
  s_waitcnt lgkmcnt(2)
  v_mfma_f32_16x16x32_bf16 v[204:207], v[252:255], v[144:147], v[204:207]
  s_waitcnt lgkmcnt(1)
  v_mfma_f32_16x16x32_bf16 v[204:207], v[216:219], v[148:151], v[204:207]
  v_mul_f32 v208, v208, v23
  v_mul_f32 v209, v209, v23
  v_mfma_f32_16x16x32_bf16 v[212:215], v[248:251], v[156:159], 0
  v_mul_f32 v210, v210, v23
  v_mul_f32 v211, v211, v23
  v_mfma_f32_16x16x32_bf16 v[212:215], v[252:255], v[160:163], v[212:215]
  v_cvt_pk_bf16_f32 v100, v208, v209
  v_cvt_pk_bf16_f32 v101, v210, v211
  v_mfma_f32_16x16x32_bf16 v[212:215], v[216:219], v[164:167], v[212:215]
  v_mul_f32 v200, v200, v22
  s_waitcnt lgkmcnt(0)
  v_mfma_f32_16x16x32_bf16 v[212:215], v[220:223], v[24:27], v[212:215]
  v_mul_f32 v201, v201, v22
  v_mfma_f32_16x16x32_bf16 v[212:215], v[104:107], v[28:31], v[212:215]
  v_mul_f32 v202, v202, v22
  v_mfma_f32_16x16x32_bf16 v[212:215], v[108:111], v[32:35], v[212:215]
  v_mul_f32 v203, v203, v22
  v_cvt_pk_bf16_f32 v96, v200, v201
  v_mfma_f32_16x16x32_bf16 v[204:207], v[220:223], v[152:155], v[204:207]
  v_cvt_pk_bf16_f32 v97, v202, v203
  v_mfma_f32_16x16x32_bf16 v[204:207], v[104:107], v[36:39], v[204:207]
  v_mfma_f32_16x16x32_bf16 v[204:207], v[108:111], v[40:43], v[204:207]
  s_nop 1
  v_mul_f32 v212, v212, v23
  v_mul_f32 v213, v213, v23
  v_mul_f32 v214, v214, v23
  v_mul_f32 v215, v215, v23
  v_cvt_pk_bf16_f32 v102, v212, v213
  v_cvt_pk_bf16_f32 v103, v214, v215
  buffer_store_dwordx4 v[100:103], v6, s[16:19], 0 offen offset:320 nt sc1
  v_mul_f32 v204, v204, v22
  v_mul_f32 v205, v205, v22
  v_mul_f32 v206, v206, v22
  v_mul_f32 v207, v207, v22
  v_cvt_pk_bf16_f32 v98, v204, v205
  v_cvt_pk_bf16_f32 v99, v206, v207
  buffer_store_dwordx4 v[96:99], v5, s[16:19], 0 offen offset:320 nt sc1
MK_fin:
MK_done:
  s_endpgm
MK_single:
  ds_read_b128 v[216:219], v2 offset:35840
  ds_read_b128 v[220:223], v2 offset:34816
  ds_read_b128 v[224:227], v2 offset:33792
  ds_read_b128 v[228:231], v2 offset:32768
  ds_read_b128 v[232:235], v2 offset:31744
  ds_read_b128 v[236:239], v2 offset:30720
  ds_read_b128 v[240:243], v2 offset:29696
  ds_read_b128 v[244:247], v2 offset:28672
  ds_read_b128 v[248:251], v2 offset:27648
  ds_read_b128 v[252:255], v2 offset:26624
  s_cmp_lg_u32 s3, 0
  s_cbranch_scc1 MK_np4
  s_waitcnt vmcnt(0)
MK_np4:
  s_waitcnt vmcnt(1)
  s_setprio 1
BODYS:
  s_waitcnt lgkmcnt(6)
  v_mfma_f32_16x16x32_bf16 v[192:195], v[216:219], v[160:163], 0
  ds_read_b128 v[216:219], v2 offset:25600
  v_mov_b32 v64, 0xff800000
  v_mfma_f32_16x16x32_bf16 v[192:195], v[220:223], v[164:167], v[192:195]
  ds_read_b128 v[220:223], v2 offset:24576
  v_add_u32 v65, 0, v19
  v_mfma_f32_16x16x32_bf16 v[192:195], v[224:227], v[168:171], v[192:195]
  ds_read_b128 v[224:227], v2 offset:23552
  v_add_u32 v66, 1, v19
  v_mfma_f32_16x16x32_bf16 v[192:195], v[228:231], v[172:175], v[192:195]
  ds_read_b128 v[228:231], v2 offset:22528
  s_waitcnt lgkmcnt(6)
  v_mfma_f32_16x16x32_bf16 v[192:195], v[232:235], v[176:179], v[192:195]
  ds_read_b128 v[232:235], v2 offset:21504
  v_add_u32 v67, 2, v19
  v_mfma_f32_16x16x32_bf16 v[192:195], v[236:239], v[180:183], v[192:195]
  ds_read_b128 v[236:239], v2 offset:20480
  v_add_u32 v68, 3, v19
  v_mfma_f32_16x16x32_bf16 v[196:199], v[240:243], v[160:163], 0
  ds_read_b128 v[240:243], v2 offset:19456
  v_cmp_gt_u32 s[48:49], 7, v65
  v_mfma_f32_16x16x32_bf16 v[196:199], v[244:247], v[164:167], v[196:199]
  ds_read_b128 v[244:247], v2 offset:18432
  s_waitcnt lgkmcnt(6)
  v_mfma_f32_16x16x32_bf16 v[196:199], v[248:251], v[168:171], v[196:199]
  ds_read_b128 v[248:251], v2 offset:17408
  v_cmp_gt_u32 s[50:51], 7, v66
  v_mfma_f32_16x16x32_bf16 v[196:199], v[252:255], v[172:175], v[196:199]
  ds_read_b128 v[252:255], v2 offset:16384
  v_cmp_gt_u32 s[52:53], 7, v67
  v_mfma_f32_16x16x32_bf16 v[196:199], v[216:219], v[176:179], v[196:199]
  ds_read_b128 v[216:219], v2 offset:15360
  v_cmp_gt_u32 s[54:55], 7, v68
  v_mfma_f32_16x16x32_bf16 v[196:199], v[220:223], v[180:183], v[196:199]
  ds_read_b128 v[220:223], v2 offset:14336
  s_waitcnt lgkmcnt(6)
  v_mfma_f32_16x16x32_bf16 v[208:211], v[224:227], v[160:163], 0
  ds_read_b128 v[224:227], v2 offset:13312
  s_add_i32 s46, s34, 8
  v_mfma_f32_16x16x32_bf16 v[208:211], v[228:231], v[164:167], v[208:211]
  ds_read_b128 v[228:231], v2 offset:12288
  v_sub_u32 v69, s46, v22
  v_mfma_f32_16x16x32_bf16 v[208:211], v[232:235], v[168:171], v[208:211]
  ds_read_b128 v[232:235], v2 offset:11264
  s_add_i32 s46, s34, 1
  v_mfma_f32_16x16x32_bf16 v[208:211], v[236:239], v[172:175], v[208:211]
  ds_read_b128 v[236:239], v2 offset:10240
  s_waitcnt lgkmcnt(6)
  v_mfma_f32_16x16x32_bf16 v[208:211], v[240:243], v[176:179], v[208:211]
  ds_read_b128 v[240:243], v2 offset:9216
  v_sub_u32 v70, s46, v22
  v_mfma_f32_16x16x32_bf16 v[208:211], v[244:247], v[180:183], v[208:211]
  ds_read_b128 v[244:247], v2 offset:8192
  v_cndmask_b32 v60, v64, 0, s[48:49]
  v_mfma_f32_16x16x32_bf16 v[212:215], v[248:251], v[160:163], 0
  ds_read_b128 v[248:251], v2 offset:7168
  v_cndmask_b32 v61, v64, 0, s[50:51]
  v_mfma_f32_16x16x32_bf16 v[212:215], v[252:255], v[164:167], v[212:215]
  ds_read_b128 v[252:255], v2 offset:6144
  s_waitcnt lgkmcnt(6)
  v_mfma_f32_16x16x32_bf16 v[212:215], v[216:219], v[168:171], v[212:215]
  ds_read_b128 v[216:219], v2 offset:5120
  v_cndmask_b32 v62, v64, 0, s[52:53]
  v_mfma_f32_16x16x32_bf16 v[212:215], v[220:223], v[172:175], v[212:215]
  ds_read_b128 v[220:223], v2 offset:4096
  v_cndmask_b32 v63, v64, 0, s[54:55]
  v_mfma_f32_16x16x32_bf16 v[212:215], v[224:227], v[176:179], v[212:215]
  ds_read_b128 v[224:227], v2 offset:3072
  v_cmp_gt_u32 s[46:47], 7, v69
  v_mfma_f32_16x16x32_bf16 v[212:215], v[228:231], v[180:183], v[212:215]
  ds_read_b128 v[228:231], v2 offset:2048
  v_cmp_gt_u32 s[48:49], 7, v70
  v_cndmask_b32 v84, v64, v60, s[46:47]
  v_cndmask_b32 v85, v64, v61, s[46:47]
  v_cndmask_b32 v86, v64, v62, s[46:47]
  v_cndmask_b32 v87, v64, v63, s[46:47]
  v_cndmask_b32 v56, v64, v60, s[48:49]
  v_cndmask_b32 v57, v64, v61, s[48:49]
  v_cndmask_b32 v58, v64, v62, s[48:49]
  v_cndmask_b32 v59, v64, v63, s[48:49]
  v_mul_f32 v192, s93, v192
  v_mul_f32 v193, s93, v193
  v_mul_f32 v194, s93, v194
  v_mul_f32 v195, s93, v195
  v_cvt_pk_bf16_f32 v112, v192, v193
  v_cvt_pk_bf16_f32 v113, v194, v195
  v_mul_f32 v196, s93, v196
  v_mul_f32 v197, s93, v197
  v_mul_f32 v198, s93, v198
  v_mul_f32 v199, s93, v199
  v_cvt_pk_bf16_f32 v114, v196, v197
  v_cvt_pk_bf16_f32 v115, v198, v199
  s_waitcnt lgkmcnt(6)
  v_mfma_f32_16x16x32_bf16 v[192:195], v[232:235], v[160:163], 0
  ds_read_b128 v[232:235], v2 offset:1024
  v_mul_f32 v208, s93, v208
  v_mfma_f32_16x16x32_bf16 v[192:195], v[236:239], v[164:167], v[192:195]
  ds_read_b128 v[236:239], v2 offset:0
  v_mul_f32 v209, s93, v209
  v_mfma_f32_16x16x32_bf16 v[192:195], v[240:243], v[168:171], v[192:195]
  ds_read_b128 v[240:243], v1 offset:35840
  v_mul_f32 v210, s93, v210
  v_mfma_f32_16x16x32_bf16 v[192:195], v[244:247], v[172:175], v[192:195]
  ds_read_b128 v[244:247], v1 offset:34816
  s_waitcnt lgkmcnt(6)
  v_mfma_f32_16x16x32_bf16 v[192:195], v[248:251], v[176:179], v[192:195]
  ds_read_b128 v[248:251], v1 offset:33792
  v_mul_f32 v211, s93, v211
  v_mfma_f32_16x16x32_bf16 v[192:195], v[252:255], v[180:183], v[192:195]
  ds_read_b128 v[252:255], v1 offset:32768
  v_cvt_pk_bf16_f32 v116, v208, v209
  v_mfma_f32_16x16x32_bf16 v[196:199], v[216:219], v[160:163], 0
  ds_read_b128 v[216:219], v1 offset:31744
  v_cvt_pk_bf16_f32 v117, v210, v211
  s_cmp_eq_u32 s3, 0
  s_cbranch_scc1 MK_np5
  s_waitcnt vmcnt(0)
  v_mov_b32 v23, 1
  s_mov_b64 exec, 1
  s_lshl_b32 s100, s26, 7
  buffer_atomic_add v23, off, s[8:11], s100 sc1
  s_mov_b64 exec, -1
  s_nop 3
MK_np5:
  v_mfma_f32_16x16x32_bf16 v[196:199], v[220:223], v[164:167], v[196:199]
  ds_read_b128 v[220:223], v1 offset:30720
  s_waitcnt lgkmcnt(6)
  v_mfma_f32_16x16x32_bf16 v[196:199], v[224:227], v[168:171], v[196:199]
  ds_read_b128 v[224:227], v1 offset:29696
  v_mul_f32 v212, s93, v212
  v_mfma_f32_16x16x32_bf16 v[196:199], v[228:231], v[172:175], v[196:199]
  ds_read_b128 v[228:231], v1 offset:28672
  v_mul_f32 v213, s93, v213
  v_mfma_f32_16x16x32_bf16 v[196:199], v[232:235], v[176:179], v[196:199]
  ds_read_b128 v[232:235], v1 offset:27648
  v_mul_f32 v214, s93, v214
  v_mfma_f32_16x16x32_bf16 v[196:199], v[236:239], v[180:183], v[196:199]
  ds_read_b128 v[236:239], v1 offset:26624
  v_mul_f32 v215, s93, v215
  v_cvt_pk_bf16_f32 v118, v212, v213
  v_cvt_pk_bf16_f32 v119, v214, v215
  s_waitcnt lgkmcnt(6)
  v_mfma_f32_16x16x32_bf16 v[208:211], v[240:243], v[160:163], 0
  ds_read_b128 v[240:243], v1 offset:25600
  v_mul_f32 v192, s93, v192
  v_mfma_f32_16x16x32_bf16 v[208:211], v[244:247], v[164:167], v[208:211]
  ds_read_b128 v[244:247], v1 offset:24576
  v_mul_f32 v193, s93, v193
  v_mfma_f32_16x16x32_bf16 v[208:211], v[248:251], v[168:171], v[208:211]
  ds_read_b128 v[248:251], v1 offset:23552
  v_mul_f32 v194, s93, v194
  v_mfma_f32_16x16x32_bf16 v[208:211], v[252:255], v[172:175], v[208:211]
  ds_read_b128 v[252:255], v1 offset:22528
  s_waitcnt lgkmcnt(6)
  v_mfma_f32_16x16x32_bf16 v[208:211], v[216:219], v[176:179], v[208:211]
  ds_read_b128 v[216:219], v1 offset:21504
  v_mul_f32 v195, s93, v195
  v_mfma_f32_16x16x32_bf16 v[208:211], v[220:223], v[180:183], v[208:211]
  ds_read_b128 v[220:223], v1 offset:20480
  v_cvt_pk_bf16_f32 v120, v192, v193
  v_mfma_f32_16x16x32_bf16 v[212:215], v[224:227], v[160:163], 0
  ds_read_b128 v[224:227], v1 offset:19456
  v_cvt_pk_bf16_f32 v121, v194, v195
  v_mfma_f32_16x16x32_bf16 v[212:215], v[228:231], v[164:167], v[212:215]
  ds_read_b128 v[228:231], v1 offset:18432
  s_waitcnt lgkmcnt(6)
  v_mfma_f32_16x16x32_bf16 v[212:215], v[232:235], v[168:171], v[212:215]
  ds_read_b128 v[232:235], v1 offset:17408
  v_mul_f32 v196, s93, v196
  v_mfma_f32_16x16x32_bf16 v[212:215], v[236:239], v[172:175], v[212:215]
  ds_read_b128 v[236:239], v1 offset:16384
  v_mul_f32 v197, s93, v197
  v_mfma_f32_16x16x32_bf16 v[212:215], v[240:243], v[176:179], v[212:215]
  ds_read_b128 v[240:243], v1 offset:15360
  v_mul_f32 v198, s93, v198
  v_mfma_f32_16x16x32_bf16 v[212:215], v[244:247], v[180:183], v[212:215]
  ds_read_b128 v[244:247], v1 offset:14336
  v_mul_f32 v199, s93, v199
  v_cvt_pk_bf16_f32 v122, v196, v197
  v_cvt_pk_bf16_f32 v123, v198, v199
  s_waitcnt lgkmcnt(6)
  v_mfma_f32_16x16x32_bf16 v[192:195], v[248:251], v[160:163], 0
  ds_read_b128 v[248:251], v1 offset:13312
  v_mul_f32 v208, s93, v208
  v_mfma_f32_16x16x32_bf16 v[192:195], v[252:255], v[164:167], v[192:195]
  ds_read_b128 v[252:255], v1 offset:12288
  v_mul_f32 v209, s93, v209
  v_mfma_f32_16x16x32_bf16 v[192:195], v[216:219], v[168:171], v[192:195]
  ds_read_b128 v[216:219], v1 offset:11264
  v_mul_f32 v210, s93, v210
  v_mfma_f32_16x16x32_bf16 v[192:195], v[220:223], v[172:175], v[192:195]
  ds_read_b128 v[220:223], v1 offset:10240
  s_waitcnt lgkmcnt(6)
  v_mfma_f32_16x16x32_bf16 v[192:195], v[224:227], v[176:179], v[192:195]
  ds_read_b128 v[224:227], v1 offset:9216
  v_mul_f32 v211, s93, v211
  v_mfma_f32_16x16x32_bf16 v[192:195], v[228:231], v[180:183], v[192:195]
  ds_read_b128 v[228:231], v1 offset:8192
  v_cvt_pk_bf16_f32 v124, v208, v209
  v_mfma_f32_16x16x32_bf16 v[196:199], v[232:235], v[160:163], 0
  ds_read_b128 v[232:235], v1 offset:7168
  v_cvt_pk_bf16_f32 v125, v210, v211
  v_mfma_f32_16x16x32_bf16 v[196:199], v[236:239], v[164:167], v[196:199]
  ds_read_b128 v[236:239], v1 offset:6144
  s_waitcnt lgkmcnt(6)
  v_mfma_f32_16x16x32_bf16 v[196:199], v[240:243], v[168:171], v[196:199]
  ds_read_b128 v[240:243], v1 offset:5120
  v_mul_f32 v212, s93, v212
  v_mfma_f32_16x16x32_bf16 v[196:199], v[244:247], v[172:175], v[196:199]
  ds_read_b128 v[244:247], v1 offset:4096
  v_mul_f32 v213, s93, v213
  v_mfma_f32_16x16x32_bf16 v[196:199], v[248:251], v[176:179], v[196:199]
  ds_read_b128 v[248:251], v1 offset:3072
  v_mul_f32 v214, s93, v214
  v_mfma_f32_16x16x32_bf16 v[196:199], v[252:255], v[180:183], v[196:199]
  ds_read_b128 v[252:255], v1 offset:2048
  v_mul_f32 v215, s93, v215
  v_cvt_pk_bf16_f32 v126, v212, v213
  v_cvt_pk_bf16_f32 v127, v214, v215
  s_waitcnt lgkmcnt(6)
  v_mfma_f32_16x16x32_bf16 v[208:211], v[216:219], v[160:163], 0
  ds_read_b128 v[216:219], v1 offset:1024
  v_mul_f32 v192, s93, v192
  v_mfma_f32_16x16x32_bf16 v[208:211], v[220:223], v[164:167], v[208:211]
  ds_read_b128 v[220:223], v1 offset:0
  v_mul_f32 v193, s93, v193
  v_mfma_f32_16x16x32_bf16 v[208:211], v[224:227], v[168:171], v[208:211]
  v_mul_f32 v194, s93, v194
  v_mul_f32 v195, s93, v195
  v_mfma_f32_16x16x32_bf16 v[208:211], v[228:231], v[172:175], v[208:211]
  v_cvt_pk_bf16_f32 v128, v192, v193
  s_barrier
  s_waitcnt lgkmcnt(4)
  v_mfma_f32_16x16x32_bf16 v[208:211], v[232:235], v[176:179], v[208:211]
  v_cvt_pk_bf16_f32 v129, v194, v195
  v_mul_f32 v196, s93, v196
  v_mfma_f32_16x16x32_bf16 v[208:211], v[236:239], v[180:183], v[208:211]
  v_mul_f32 v197, s93, v197
  v_mul_f32 v198, s93, v198
  v_mfma_f32_16x16x32_bf16 v[212:215], v[240:243], v[160:163], 0
  v_mul_f32 v199, s93, v199
  v_cvt_pk_bf16_f32 v130, v196, v197
  v_mfma_f32_16x16x32_bf16 v[212:215], v[244:247], v[164:167], v[212:215]
  v_cvt_pk_bf16_f32 v131, v198, v199
  s_waitcnt lgkmcnt(3)
  v_mfma_f32_16x16x32_bf16 v[212:215], v[248:251], v[168:171], v[212:215]
  v_mul_f32 v208, s93, v208
  s_waitcnt lgkmcnt(2)
  v_mfma_f32_16x16x32_bf16 v[212:215], v[252:255], v[172:175], v[212:215]
  v_mul_f32 v209, s93, v209
  s_waitcnt lgkmcnt(1)
  v_mfma_f32_16x16x32_bf16 v[212:215], v[216:219], v[176:179], v[212:215]
  v_mul_f32 v210, s93, v210
  s_waitcnt lgkmcnt(0)
  v_mfma_f32_16x16x32_bf16 v[212:215], v[220:223], v[180:183], v[212:215]
  v_mul_f32 v211, s93, v211
  s_setprio 0
  s_mul_i32 s100, s32, 7
  s_add_i32 s100, s100, s31
  s_add_u32 m0, s38, 107520
  s_nop 0
  buffer_load_dwordx4 v13, s[12:15], s100 offen lds
  s_add_u32 m0, s38, 108544
  s_nop 0
  buffer_load_dwordx4 v14, s[12:15], s100 offen lds
  s_add_u32 m0, s38, 109568
  s_nop 0
  buffer_load_dwordx4 v3, s[12:15], s100 offen lds
  s_add_u32 m0, s39, 107520
  s_nop 0
  buffer_load_dwordx4 v4, s[12:15], s100 offen lds
  s_mul_i32 s100, s32, 6
  s_add_i32 s100, s100, s31
  s_add_u32 m0, s38, 92160
  s_nop 0
  buffer_load_dwordx4 v13, s[12:15], s100 offen lds
  s_add_u32 m0, s38, 93184
  s_nop 0
  buffer_load_dwordx4 v14, s[12:15], s100 offen lds
  s_add_u32 m0, s38, 94208
  s_nop 0
  buffer_load_dwordx4 v3, s[12:15], s100 offen lds
  s_add_u32 m0, s39, 92160
  s_nop 0
  buffer_load_dwordx4 v4, s[12:15], s100 offen lds
  s_mul_i32 s100, s32, 5
  s_add_i32 s100, s100, s31
  s_add_u32 m0, s38, 76800
  s_nop 0
  buffer_load_dwordx4 v13, s[12:15], s100 offen lds
  s_add_u32 m0, s38, 77824
  s_nop 0
  buffer_load_dwordx4 v14, s[12:15], s100 offen lds
  s_add_u32 m0, s38, 78848
  s_nop 0
  buffer_load_dwordx4 v3, s[12:15], s100 offen lds
  s_add_u32 m0, s39, 76800
  s_nop 0
  buffer_load_dwordx4 v4, s[12:15], s100 offen lds
  s_barrier
  s_mul_i32 s100, s32, 4
  s_add_i32 s100, s100, s31
  s_add_u32 m0, s38, 61440
  s_nop 0
  buffer_load_dwordx4 v13, s[12:15], s100 offen lds
  s_add_u32 m0, s38, 62464
  s_nop 0
  buffer_load_dwordx4 v14, s[12:15], s100 offen lds
  s_add_u32 m0, s38, 63488
  s_nop 0
  buffer_load_dwordx4 v3, s[12:15], s100 offen lds
  s_add_u32 m0, s39, 61440
  s_nop 0
  buffer_load_dwordx4 v4, s[12:15], s100 offen lds
  s_mul_i32 s100, s32, 3
  s_add_i32 s100, s100, s31
  s_add_u32 m0, s38, 46080
  s_nop 0
  buffer_load_dwordx4 v13, s[12:15], s100 offen lds
  s_add_u32 m0, s38, 47104
  s_nop 0
  buffer_load_dwordx4 v14, s[12:15], s100 offen lds
  s_add_u32 m0, s38, 48128
  s_nop 0
  buffer_load_dwordx4 v3, s[12:15], s100 offen lds
  s_add_u32 m0, s39, 46080
  s_nop 0
  buffer_load_dwordx4 v4, s[12:15], s100 offen lds
  s_mul_i32 s100, s32, 2
  s_add_i32 s100, s100, s31
  s_add_u32 m0, s38, 30720
  s_nop 0
  buffer_load_dwordx4 v13, s[12:15], s100 offen lds
  s_add_u32 m0, s38, 31744
  s_nop 0
  buffer_load_dwordx4 v14, s[12:15], s100 offen lds
  s_add_u32 m0, s38, 32768
  s_nop 0
  buffer_load_dwordx4 v3, s[12:15], s100 offen lds
  s_add_u32 m0, s39, 30720
  s_nop 0
  buffer_load_dwordx4 v4, s[12:15], s100 offen lds
  s_waitcnt vmcnt(12)
  s_barrier
  s_max_u32 s100, s33, 1
  s_mul_i32 s100, s100, s32
  s_add_i32 s100, s100, s31
  s_add_u32 m0, s38, 15360
  s_nop 0
  buffer_load_dwordx4 v13, s[12:15], s100 offen lds
  s_add_u32 m0, s38, 16384
  s_nop 0
  buffer_load_dwordx4 v14, s[12:15], s100 offen lds
  s_add_u32 m0, s38, 17408
  s_nop 0
  buffer_load_dwordx4 v3, s[12:15], s100 offen lds
  s_add_u32 m0, s39, 15360
  s_nop 0
  buffer_load_dwordx4 v4, s[12:15], s100 offen lds
  s_max_u32 s100, s33, 0
  s_mul_i32 s100, s100, s32
  s_add_i32 s100, s100, s31
  s_add_u32 m0, s38, 0
  s_nop 0
  buffer_load_dwordx4 v13, s[12:15], s100 offen lds
  s_add_u32 m0, s38, 1024
  s_nop 0
  buffer_load_dwordx4 v14, s[12:15], s100 offen lds
  s_add_u32 m0, s38, 2048
  s_nop 0
  buffer_load_dwordx4 v3, s[12:15], s100 offen lds
  s_add_u32 m0, s39, 0
  s_nop 0
  buffer_load_dwordx4 v4, s[12:15], s100 offen lds
  s_waitcnt vmcnt(8)
  s_barrier
  ds_read_b128 v[224:227], v7 offset:61440
  ds_read_b128 v[228:231], v8 offset:61440
  ds_read_b128 v[232:235], v7 offset:61568
  ds_read_b128 v[236:239], v8 offset:61568
  ds_read_b128 v[240:243], v7 offset:61696
  ds_read_b128 v[244:247], v8 offset:61696
  ds_read_b128 v[248:251], v7 offset:53760
  ds_read_b128 v[252:255], v8 offset:53760
  ds_read_b128 v[216:219], v7 offset:53888
  ds_read_b128 v[220:223], v8 offset:53888
  s_waitcnt lgkmcnt(6)
  v_mfma_f32_16x16x32_bf16 v[84:87], v[224:227], v[112:115], v[84:87]
  ds_read_b128 v[224:227], v7 offset:54016
  v_cvt_pk_bf16_f32 v132, v208, v209
  v_mfma_f32_16x16x32_bf16 v[84:87], v[228:231], v[116:119], v[84:87]
  ds_read_b128 v[228:231], v8 offset:54016
  v_cvt_pk_bf16_f32 v133, v210, v211
  v_mfma_f32_16x16x32_bf16 v[84:87], v[232:235], v[120:123], v[84:87]
  ds_read_b128 v[232:235], v7 offset:46080
  v_mul_f32 v212, s93, v212
  v_mfma_f32_16x16x32_bf16 v[84:87], v[236:239], v[124:127], v[84:87]
  ds_read_b128 v[236:239], v8 offset:46080
  s_waitcnt lgkmcnt(6)
  v_mfma_f32_16x16x32_bf16 v[84:87], v[240:243], v[128:131], v[84:87]
  ds_read_b128 v[240:243], v7 offset:46208
  v_mul_f32 v213, s93, v213
  v_mul_f32 v214, s93, v214
  v_mul_f32 v215, s93, v215
  v_cvt_pk_bf16_f32 v134, v212, v213
  v_cvt_pk_bf16_f32 v135, v214, v215
  s_nop 1
  v_mfma_f32_16x16x32_bf16 v[84:87], v[244:247], v[132:135], v[84:87]
  ds_read_b128 v[244:247], v8 offset:46208
  v_add_u32 v2, 102400, v1
  v_mfma_f32_16x16x32_bf16 v[80:83], v[248:251], v[112:115], v[60:63]
  ds_read_b128 v[248:251], v7 offset:46336
  v_mov_b32 v192, 0x3f803f80
  v_mfma_f32_16x16x32_bf16 v[80:83], v[252:255], v[116:119], v[80:83]
  ds_read_b128 v[252:255], v8 offset:46336
  s_waitcnt lgkmcnt(6)
  v_mfma_f32_16x16x32_bf16 v[80:83], v[216:219], v[120:123], v[80:83]
  v_exp_f32 v204, v84
  v_mfma_f32_16x16x32_bf16 v[80:83], v[220:223], v[124:127], v[80:83]
  v_exp_f32 v205, v85
  v_mfma_f32_16x16x32_bf16 v[80:83], v[224:227], v[128:131], v[80:83]
  v_exp_f32 v206, v86
  v_mfma_f32_16x16x32_bf16 v[80:83], v[228:231], v[132:135], v[80:83]
  ds_read_b128 v[216:219], v7 offset:38400
  s_waitcnt vmcnt(0)
  s_barrier
  ds_read_b128 v[220:223], v8 offset:38400
  ds_read_b128 v[224:227], v7 offset:38528
  ds_read_b128 v[228:231], v8 offset:38528
  s_waitcnt lgkmcnt(6)
  v_mfma_f32_16x16x32_bf16 v[76:79], v[232:235], v[112:115], v[60:63]
  v_exp_f32 v207, v87
  v_mfma_f32_16x16x32_bf16 v[76:79], v[236:239], v[116:119], v[76:79]
  ds_read_b128 v[232:235], v7 offset:38656
  ds_read_b128 v[236:239], v8 offset:38656
  v_mfma_f32_16x16x32_bf16 v[76:79], v[240:243], v[120:123], v[76:79]
  ds_read_b128 v[240:243], v7 offset:30720
  v_mov_b32 v193, 0x3f803f80
  v_mfma_f32_16x16x32_bf16 v[76:79], v[244:247], v[124:127], v[76:79]
  ds_read_b128 v[244:247], v8 offset:30720
  s_waitcnt lgkmcnt(6)
  v_mfma_f32_16x16x32_bf16 v[76:79], v[248:251], v[128:131], v[76:79]
  v_exp_f32 v208, v80
  v_mfma_f32_16x16x32_bf16 v[76:79], v[252:255], v[132:135], v[76:79]
  v_exp_f32 v209, v81
  v_mfma_f32_16x16x32_bf16 v[72:75], v[216:219], v[112:115], v[60:63]
  v_exp_f32 v210, v82
  v_mfma_f32_16x16x32_bf16 v[72:75], v[220:223], v[116:119], v[72:75]
  ds_read_b128 v[248:251], v7 offset:30848
  s_waitcnt lgkmcnt(4)
  v_mfma_f32_16x16x32_bf16 v[72:75], v[224:227], v[120:123], v[72:75]
  v_exp_f32 v211, v83
  v_mfma_f32_16x16x32_bf16 v[72:75], v[228:231], v[124:127], v[72:75]
  ds_read_b128 v[252:255], v8 offset:30848
  ds_read_b128 v[216:219], v7 offset:30976
  v_mfma_f32_16x16x32_bf16 v[72:75], v[232:235], v[128:131], v[72:75]
  ds_read_b128 v[220:223], v8 offset:30976
  s_waitcnt lgkmcnt(4)
  v_mfma_f32_16x16x32_bf16 v[72:75], v[236:239], v[132:135], v[72:75]
  ds_read_b128 v[224:227], v7 offset:23040
  ds_read_b128 v[228:231], v8 offset:23040
  v_mfma_f32_16x16x32_bf16 v[68:71], v[240:243], v[112:115], v[60:63]
  ds_read_b128 v[232:235], v7 offset:23168
  ds_read_b128 v[236:239], v8 offset:23168
  v_mov_b32 v194, 0x3f803f80
  v_mfma_f32_16x16x32_bf16 v[68:71], v[244:247], v[116:119], v[68:71]
  ds_read_b128 v[240:243], v7 offset:23296
  v_mov_b32 v195, 0x3f803f80
  s_waitcnt lgkmcnt(5)
  v_mfma_f32_16x16x32_bf16 v[68:71], v[248:251], v[120:123], v[68:71]
  ds_read_b128 v[244:247], v8 offset:23296
  ds_read_b128 v[248:251], v7 offset:15360
  v_cvt_pk_bf16_f32 v166, v204, v205
  v_mfma_f32_16x16x32_bf16 v[68:71], v[252:255], v[124:127], v[68:71]
  v_exp_f32 v212, v76
  v_mfma_f32_16x16x32_bf16 v[68:71], v[216:219], v[128:131], v[68:71]
  v_exp_f32 v213, v77
  v_mfma_f32_16x16x32_bf16 v[68:71], v[220:223], v[132:135], v[68:71]
  ds_read_b128 v[252:255], v8 offset:15360
  v_and_b32 v14, 128, v1
  buffer_load_dword v13, v14, s[8:11], 0 offen
  s_waitcnt lgkmcnt(4)
  v_mfma_f32_16x16x32_bf16 v[64:67], v[224:227], v[112:115], v[60:63]
  v_exp_f32 v214, v78
  v_mfma_f32_16x16x32_bf16 v[64:67], v[228:231], v[116:119], v[64:67]
  v_exp_f32 v215, v79
  v_mfma_f32_16x16x32_bf16 v[64:67], v[232:235], v[120:123], v[64:67]
  ds_read_b128 v[216:219], v7 offset:15488
  ds_read_b128 v[220:223], v8 offset:15488
  v_cvt_pk_bf16_f32 v167, v206, v207
  v_mfma_f32_16x16x32_bf16 v[64:67], v[236:239], v[124:127], v[64:67]
  ds_read_b128 v[224:227], v7 offset:15616
  v_cvt_pk_bf16_f32 v164, v208, v209
  s_waitcnt lgkmcnt(4)
  v_mfma_f32_16x16x32_bf16 v[64:67], v[240:243], v[128:131], v[64:67]
  v_exp_f32 v204, v72
  v_mfma_f32_16x16x32_bf16 v[64:67], v[244:247], v[132:135], v[64:67]
  ds_read_b128 v[228:231], v8 offset:15616
  ds_read_b128 v[232:235], v7 offset:7680
  v_cvt_pk_bf16_f32 v165, v210, v211
  v_mfma_f32_16x16x32_bf16 v[60:63], v[248:251], v[112:115], v[60:63]
  ds_read_b128 v[236:239], v8 offset:7680
  v_cvt_pk_bf16_f32 v162, v212, v213
  s_waitcnt lgkmcnt(4)
  v_mfma_f32_16x16x32_bf16 v[60:63], v[252:255], v[116:119], v[60:63]
  v_exp_f32 v205, v73
  v_mfma_f32_16x16x32_bf16 v[60:63], v[216:219], v[120:123], v[60:63]
  ds_read_b128 v[240:243], v7 offset:7808
  ds_read_b128 v[244:247], v8 offset:7808
  v_cvt_pk_bf16_f32 v163, v214, v215
  v_mfma_f32_16x16x32_bf16 v[60:63], v[220:223], v[124:127], v[60:63]
  ds_read_b128 v[248:251], v7 offset:7936
  v_cvt_pk_bf16_f32 v160, v204, v205
  s_waitcnt lgkmcnt(4)
  v_mfma_f32_16x16x32_bf16 v[60:63], v[224:227], v[128:131], v[60:63]
  v_exp_f32 v206, v74
  v_mfma_f32_16x16x32_bf16 v[60:63], v[228:231], v[132:135], v[60:63]
  ds_read_b128 v[252:255], v8 offset:7936
  ds_read_b64_tr_b16 v[216:217], v9 offset:38400
  v_exp_f32 v207, v75
  s_mov_b32 s53, 0x40000
  s_mov_b32 s46, 72
NPOLL:
  s_waitcnt vmcnt(0)
  v_cmp_le_u32 s[48:49], s46, v13
  s_sub_u32 s53, s53, 1
  s_cbranch_scc1 NPOLLD
  s_cmp_eq_u64 s[48:49], -1
  s_cbranch_scc1 NPOLLD
  buffer_load_dword v13, v14, s[8:11], 0 offen sc1
  s_branch NPOLL
NPOLLD:
  s_add_u32 m0, s40, 0
  s_add_u32 s100, s40, 30720
  buffer_load_dwordx4 v1, s[20:23], s100 offen sc1 lds
  s_add_u32 m0, s40, 2048
  s_add_u32 s100, s40, 32768
  buffer_load_dwordx4 v1, s[20:23], s100 offen sc1 lds
  s_add_u32 m0, s40, 4096
  s_add_u32 s100, s40, 34816
  buffer_load_dwordx4 v1, s[20:23], s100 offen sc1 lds
  s_add_u32 m0, s40, 6144
  s_add_u32 s100, s40, 36864
  buffer_load_dwordx4 v1, s[20:23], s100 offen sc1 lds
  s_add_u32 m0, s40, 8192
  s_add_u32 s100, s40, 38912
  buffer_load_dwordx4 v1, s[20:23], s100 offen sc1 lds
  s_barrier
  s_add_u32 m0, s40, 133120
  s_add_u32 s100, s40, 0
  buffer_load_dwordx4 v1, s[20:23], s100 offen sc1 lds
  s_add_u32 m0, s40, 135168
  s_add_u32 s100, s40, 2048
  buffer_load_dwordx4 v1, s[20:23], s100 offen sc1 lds
  s_add_u32 m0, s40, 137216
  s_add_u32 s100, s40, 4096
  buffer_load_dwordx4 v1, s[20:23], s100 offen sc1 lds
  s_add_u32 m0, s40, 139264
  s_add_u32 s100, s40, 6144
  buffer_load_dwordx4 v1, s[20:23], s100 offen sc1 lds
  s_add_u32 m0, s40, 141312
  s_add_u32 s100, s40, 8192
  buffer_load_dwordx4 v1, s[20:23], s100 offen sc1 lds
  s_add_u32 m0, s40, 143360
  s_add_u32 s100, s40, 10240
  buffer_load_dwordx4 v1, s[20:23], s100 offen sc1 lds
  s_add_u32 m0, s40, 145408
  s_add_u32 s100, s40, 12288
  buffer_load_dwordx4 v1, s[20:23], s100 offen sc1 lds
  s_add_u32 m0, s40, 147456
  s_add_u32 s100, s40, 14336
  buffer_load_dwordx4 v1, s[20:23], s100 offen sc1 lds
  s_add_u32 m0, s40, 149504
  s_add_u32 s100, s40, 16384
  buffer_load_dwordx4 v1, s[20:23], s100 offen sc1 lds
  s_add_u32 m0, s40, 151552
  s_add_u32 s100, s40, 18432
  buffer_load_dwordx4 v1, s[20:23], s100 offen sc1 lds
  s_add_u32 m0, s40, 153600
  s_add_u32 s100, s40, 20480
  buffer_load_dwordx4 v1, s[20:23], s100 offen sc1 lds
  s_add_u32 m0, s40, 155648
  s_add_u32 s100, s40, 22528
  buffer_load_dwordx4 v1, s[20:23], s100 offen sc1 lds
  s_add_u32 m0, s40, 157696
  s_add_u32 s100, s40, 24576
  buffer_load_dwordx4 v1, s[20:23], s100 offen sc1 lds
  s_add_u32 m0, s40, 159744
  s_add_u32 s100, s40, 26624
  buffer_load_dwordx4 v1, s[20:23], s100 offen sc1 lds
  s_add_u32 m0, s40, 161792
  s_add_u32 s100, s40, 28672
  buffer_load_dwordx4 v1, s[20:23], s100 offen sc1 lds
  v_mfma_f32_16x16x32_bf16 v[56:59], v[232:235], v[112:115], v[56:59]
  ds_read_b64_tr_b16 v[218:219], v9 offset:46080
  v_cvt_pk_bf16_f32 v161, v206, v207
  s_waitcnt lgkmcnt(4)
  v_mfma_f32_16x16x32_bf16 v[56:59], v[236:239], v[116:119], v[56:59]
  ds_read_b64_tr_b16 v[220:221], v10 offset:38400
  ds_read_b64_tr_b16 v[222:223], v10 offset:46080
  v_exp_f32 v208, v68
  v_mfma_f32_16x16x32_bf16 v[56:59], v[240:243], v[120:123], v[56:59]
  ds_read_b64_tr_b16 v[224:225], v11 offset:38400
  ds_read_b64_tr_b16 v[226:227], v11 offset:46080
  v_exp_f32 v209, v69
  v_mfma_f32_16x16x32_bf16 v[56:59], v[244:247], v[124:127], v[56:59]
  ds_read_b64_tr_b16 v[228:229], v12 offset:38400
  ds_read_b64_tr_b16 v[230:231], v12 offset:46080
  v_cvt_pk_bf16_f32 v158, v208, v209
  s_waitcnt lgkmcnt(6)
  v_mfma_f32_16x16x32_bf16 v[56:59], v[248:251], v[128:131], v[56:59]
  ds_read_b64_tr_b16 v[232:233], v9 offset:38528
  ds_read_b64_tr_b16 v[234:235], v9 offset:46208
  v_exp_f32 v210, v70
  v_mfma_f32_16x16x32_bf16 v[56:59], v[252:255], v[132:135], v[56:59]
  ds_read_b64_tr_b16 v[236:237], v10 offset:38528
  ds_read_b64_tr_b16 v[238:239], v10 offset:46208
  v_exp_f32 v211, v71
  s_waitcnt vmcnt(0)
  s_barrier
  s_add_u32 m0, s40, 102400
  s_add_u32 s100, s40, 40960
  buffer_load_dwordx4 v1, s[20:23], s100 offen sc1 lds
  s_add_u32 m0, s40, 104448
  s_add_u32 s100, s40, 43008
  buffer_load_dwordx4 v1, s[20:23], s100 offen sc1 lds
  s_add_u32 m0, s40, 106496
  s_add_u32 s100, s40, 45056
  buffer_load_dwordx4 v1, s[20:23], s100 offen sc1 lds
  s_add_u32 m0, s40, 108544
  s_add_u32 s100, s40, 47104
  buffer_load_dwordx4 v1, s[20:23], s100 offen sc1 lds
  s_add_u32 m0, s40, 110592
  s_add_u32 s100, s40, 49152
  buffer_load_dwordx4 v1, s[20:23], s100 offen sc1 lds
  s_add_u32 m0, s40, 112640
  s_add_u32 s100, s40, 51200
  buffer_load_dwordx4 v1, s[20:23], s100 offen sc1 lds
  s_add_u32 m0, s40, 114688
  s_add_u32 s100, s40, 53248
  buffer_load_dwordx4 v1, s[20:23], s100 offen sc1 lds
  s_add_u32 m0, s40, 116736
  s_add_u32 s100, s40, 55296
  buffer_load_dwordx4 v1, s[20:23], s100 offen sc1 lds
  s_add_u32 m0, s40, 118784
  s_add_u32 s100, s40, 57344
  buffer_load_dwordx4 v1, s[20:23], s100 offen sc1 lds
  s_add_u32 m0, s40, 120832
  s_add_u32 s100, s40, 59392
  buffer_load_dwordx4 v1, s[20:23], s100 offen sc1 lds
  s_add_u32 m0, s40, 122880
  s_add_u32 s100, s40, 61440
  buffer_load_dwordx4 v1, s[20:23], s100 offen sc1 lds
  s_add_u32 m0, s40, 124928
  s_add_u32 s100, s40, 63488
  buffer_load_dwordx4 v1, s[20:23], s100 offen sc1 lds
  s_add_u32 m0, s40, 126976
  s_add_u32 s100, s40, 65536
  buffer_load_dwordx4 v1, s[20:23], s100 offen sc1 lds
  s_add_u32 m0, s40, 129024
  s_add_u32 s100, s40, 67584
  buffer_load_dwordx4 v1, s[20:23], s100 offen sc1 lds
  s_add_u32 m0, s40, 131072
  s_add_u32 s100, s40, 69632
  buffer_load_dwordx4 v1, s[20:23], s100 offen sc1 lds
  s_waitcnt vmcnt(0)
  s_barrier
  s_nop 0
  v_cvt_pk_bf16_f32 v159, v210, v211
  v_exp_f32 v212, v64
  v_exp_f32 v213, v65
  v_exp_f32 v214, v66
  v_exp_f32 v215, v67
  v_cvt_pk_bf16_f32 v156, v212, v213
  v_cvt_pk_bf16_f32 v157, v214, v215
  v_exp_f32 v204, v60
  v_exp_f32 v205, v61
  v_exp_f32 v206, v62
  v_exp_f32 v207, v63
  v_cvt_pk_bf16_f32 v154, v204, v205
  v_cvt_pk_bf16_f32 v155, v206, v207
  v_exp_f32 v208, v56
  v_exp_f32 v209, v57
  v_exp_f32 v210, v58
  v_exp_f32 v211, v59
  v_cvt_pk_bf16_f32 v152, v208, v209
  v_cvt_pk_bf16_f32 v153, v210, v211
  v_mfma_f32_16x16x32_bf16 v[188:191], v[192:195], v[164:167], 0
  ds_read_b64_tr_b16 v[240:241], v11 offset:38528
  ds_read_b64_tr_b16 v[242:243], v11 offset:46208
  v_mfma_f32_16x16x32_bf16 v[188:191], v[192:195], v[160:163], v[188:191]
  ds_read_b64_tr_b16 v[244:245], v12 offset:38528
  ds_read_b64_tr_b16 v[246:247], v12 offset:46208
  v_mfma_f32_16x16x32_bf16 v[188:191], v[192:195], v[156:159], v[188:191]
  v_mfma_f32_16x16x32_bf16 v[188:191], v[192:195], v[152:155], v[188:191]
  s_nop 7
  v_subrev_u32 v23, 897581056, v188
  s_mov_b32 s52, 335544320
  v_cmp_gt_u32 s[48:49], s52, v23
  s_or_b64 s[48:49], s[48:49], s[44:45]
  s_cmp_eq_u64 s[48:49], -1
  s_cbranch_scc0 FB1s
FBR1s:
  v_mfma_f32_16x16x32_bf16 v[88:91], v[216:219], v[160:163], 0
  s_waitcnt lgkmcnt(8)
  v_mfma_f32_16x16x32_bf16 v[92:95], v[220:223], v[160:163], 0
  ds_read_b64_tr_b16 v[248:249], v9 offset:38656
  ds_read_b64_tr_b16 v[250:251], v9 offset:46336
  v_mfma_f32_16x16x32_bf16 v[96:99], v[224:227], v[160:163], 0
  ds_read_b64_tr_b16 v[252:253], v10 offset:38656
  ds_read_b64_tr_b16 v[254:255], v10 offset:46336
  v_mfma_f32_16x16x32_bf16 v[100:103], v[228:231], v[160:163], 0
  ds_read_b64_tr_b16 v[216:217], v11 offset:38656
  ds_read_b64_tr_b16 v[218:219], v11 offset:46336
  s_waitcnt lgkmcnt(8)
  v_mfma_f32_16x16x32_bf16 v[104:107], v[232:235], v[160:163], 0
  ds_read_b64_tr_b16 v[220:221], v12 offset:38656
  ds_read_b64_tr_b16 v[222:223], v12 offset:46336
  v_mfma_f32_16x16x32_bf16 v[108:111], v[236:239], v[160:163], 0
  ds_read_b64_tr_b16 v[224:225], v9 offset:53760
  ds_read_b64_tr_b16 v[226:227], v9 offset:61440
  v_mfma_f32_16x16x32_bf16 v[112:115], v[240:243], v[160:163], 0
  ds_read_b64_tr_b16 v[228:229], v10 offset:53760
  ds_read_b64_tr_b16 v[230:231], v10 offset:61440
  s_waitcnt lgkmcnt(8)
  v_mfma_f32_16x16x32_bf16 v[116:119], v[244:247], v[160:163], 0
  ds_read_b64_tr_b16 v[232:233], v11 offset:53760
  ds_read_b64_tr_b16 v[234:235], v11 offset:61440
  v_mfma_f32_16x16x32_bf16 v[120:123], v[248:251], v[160:163], 0
  ds_read_b64_tr_b16 v[236:237], v12 offset:53760
  ds_read_b64_tr_b16 v[238:239], v12 offset:61440
  v_mfma_f32_16x16x32_bf16 v[124:127], v[252:255], v[160:163], 0
  ds_read_b64_tr_b16 v[240:241], v9 offset:53888
  ds_read_b64_tr_b16 v[242:243], v9 offset:61568
  s_waitcnt lgkmcnt(8)
  v_mfma_f32_16x16x32_bf16 v[128:131], v[216:219], v[160:163], 0
  ds_read_b64_tr_b16 v[244:245], v10 offset:53888
  ds_read_b64_tr_b16 v[246:247], v10 offset:61568
  v_mfma_f32_16x16x32_bf16 v[132:135], v[220:223], v[160:163], 0
  ds_read_b64_tr_b16 v[248:249], v11 offset:53888
  ds_read_b64_tr_b16 v[250:251], v11 offset:61568
  v_mfma_f32_16x16x32_bf16 v[88:91], v[224:227], v[164:167], v[88:91]
  ds_read_b64_tr_b16 v[252:253], v12 offset:53888
  ds_read_b64_tr_b16 v[254:255], v12 offset:61568
  s_waitcnt lgkmcnt(8)
  v_mfma_f32_16x16x32_bf16 v[92:95], v[228:231], v[164:167], v[92:95]
  v_rcp_f32 v23, v188
  v_mfma_f32_16x16x32_bf16 v[96:99], v[232:235], v[164:167], v[96:99]
  ds_read_b64_tr_b16 v[216:217], v9 offset:54016
  ds_read_b64_tr_b16 v[218:219], v9 offset:61696
  v_mfma_f32_16x16x32_bf16 v[100:103], v[236:239], v[164:167], v[100:103]
  ds_read_b64_tr_b16 v[220:221], v10 offset:54016
  ds_read_b64_tr_b16 v[222:223], v10 offset:61696
  s_waitcnt lgkmcnt(8)
  v_mfma_f32_16x16x32_bf16 v[104:107], v[240:243], v[164:167], v[104:107]
  ds_read_b64_tr_b16 v[224:225], v11 offset:54016
  ds_read_b64_tr_b16 v[226:227], v11 offset:61696
  v_mfma_f32_16x16x32_bf16 v[108:111], v[244:247], v[164:167], v[108:111]
  ds_read_b64_tr_b16 v[228:229], v12 offset:54016
  ds_read_b64_tr_b16 v[230:231], v12 offset:61696
  s_waitcnt lgkmcnt(8)
  v_mfma_f32_16x16x32_bf16 v[112:115], v[248:251], v[164:167], v[112:115]
  ds_read_b64_tr_b16 v[232:233], v9 offset:23040
  ds_read_b64_tr_b16 v[234:235], v9 offset:30720
  v_mfma_f32_16x16x32_bf16 v[116:119], v[252:255], v[164:167], v[116:119]
  ds_read_b64_tr_b16 v[236:237], v10 offset:23040
  ds_read_b64_tr_b16 v[238:239], v10 offset:30720
  s_waitcnt lgkmcnt(8)
  v_mfma_f32_16x16x32_bf16 v[120:123], v[216:219], v[164:167], v[120:123]
  ds_read_b64_tr_b16 v[240:241], v11 offset:23040
  ds_read_b64_tr_b16 v[242:243], v11 offset:30720
  v_mfma_f32_16x16x32_bf16 v[124:127], v[220:223], v[164:167], v[124:127]
  ds_read_b64_tr_b16 v[244:245], v12 offset:23040
  ds_read_b64_tr_b16 v[246:247], v12 offset:30720
  s_waitcnt lgkmcnt(8)
  v_mfma_f32_16x16x32_bf16 v[128:131], v[224:227], v[164:167], v[128:131]
  ds_read_b64_tr_b16 v[248:249], v9 offset:23168
  ds_read_b64_tr_b16 v[250:251], v9 offset:30848
  v_mfma_f32_16x16x32_bf16 v[132:135], v[228:231], v[164:167], v[132:135]
  ds_read_b64_tr_b16 v[252:253], v10 offset:23168
  ds_read_b64_tr_b16 v[254:255], v10 offset:30848
  s_waitcnt lgkmcnt(8)
  v_mfma_f32_16x16x32_bf16 v[88:91], v[232:235], v[156:159], v[88:91]
  ds_read_b64_tr_b16 v[216:217], v11 offset:23168
  ds_read_b64_tr_b16 v[218:219], v11 offset:30848
  v_mfma_f32_16x16x32_bf16 v[92:95], v[236:239], v[156:159], v[92:95]
  ds_read_b64_tr_b16 v[220:221], v12 offset:23168
  ds_read_b64_tr_b16 v[222:223], v12 offset:30848
  s_waitcnt lgkmcnt(8)
  v_mfma_f32_16x16x32_bf16 v[96:99], v[240:243], v[156:159], v[96:99]
  ds_read_b64_tr_b16 v[224:225], v9 offset:23296
  ds_read_b64_tr_b16 v[226:227], v9 offset:30976
  v_mfma_f32_16x16x32_bf16 v[100:103], v[244:247], v[156:159], v[100:103]
  ds_read_b64_tr_b16 v[228:229], v10 offset:23296
  ds_read_b64_tr_b16 v[230:231], v10 offset:30976
  s_waitcnt lgkmcnt(8)
  v_mfma_f32_16x16x32_bf16 v[104:107], v[248:251], v[156:159], v[104:107]
  ds_read_b64_tr_b16 v[232:233], v11 offset:23296
  ds_read_b64_tr_b16 v[234:235], v11 offset:30976
  v_mfma_f32_16x16x32_bf16 v[108:111], v[252:255], v[156:159], v[108:111]
  ds_read_b64_tr_b16 v[236:237], v12 offset:23296
  ds_read_b64_tr_b16 v[238:239], v12 offset:30976
  s_waitcnt lgkmcnt(8)
  v_mfma_f32_16x16x32_bf16 v[112:115], v[216:219], v[156:159], v[112:115]
  ds_read_b64_tr_b16 v[240:241], v9 offset:7680
  ds_read_b64_tr_b16 v[242:243], v9 offset:15360
  v_mfma_f32_16x16x32_bf16 v[116:119], v[220:223], v[156:159], v[116:119]
  ds_read_b64_tr_b16 v[244:245], v10 offset:7680
  ds_read_b64_tr_b16 v[246:247], v10 offset:15360
  s_waitcnt lgkmcnt(8)
  v_mfma_f32_16x16x32_bf16 v[120:123], v[224:227], v[156:159], v[120:123]
  ds_read_b64_tr_b16 v[248:249], v11 offset:7680
  ds_read_b64_tr_b16 v[250:251], v11 offset:15360
  v_mfma_f32_16x16x32_bf16 v[124:127], v[228:231], v[156:159], v[124:127]
  ds_read_b64_tr_b16 v[252:253], v12 offset:7680
  ds_read_b64_tr_b16 v[254:255], v12 offset:15360
  s_waitcnt lgkmcnt(8)
  v_mfma_f32_16x16x32_bf16 v[128:131], v[232:235], v[156:159], v[128:131]
  ds_read_b64_tr_b16 v[216:217], v9 offset:7808
  ds_read_b64_tr_b16 v[218:219], v9 offset:15488
  v_mfma_f32_16x16x32_bf16 v[132:135], v[236:239], v[156:159], v[132:135]
  ds_read_b64_tr_b16 v[220:221], v10 offset:7808
  ds_read_b64_tr_b16 v[222:223], v10 offset:15488
  s_waitcnt lgkmcnt(8)
  v_mfma_f32_16x16x32_bf16 v[88:91], v[240:243], v[152:155], v[88:91]
  ds_read_b64_tr_b16 v[224:225], v11 offset:7808
  ds_read_b64_tr_b16 v[226:227], v11 offset:15488
  v_mfma_f32_16x16x32_bf16 v[92:95], v[244:247], v[152:155], v[92:95]
  ds_read_b64_tr_b16 v[228:229], v12 offset:7808
  ds_read_b64_tr_b16 v[230:231], v12 offset:15488
  s_waitcnt lgkmcnt(8)
  v_mfma_f32_16x16x32_bf16 v[96:99], v[248:251], v[152:155], v[96:99]
  ds_read_b64_tr_b16 v[232:233], v9 offset:7936
  ds_read_b64_tr_b16 v[234:235], v9 offset:15616
  v_mfma_f32_16x16x32_bf16 v[100:103], v[252:255], v[152:155], v[100:103]
  ds_read_b64_tr_b16 v[236:237], v10 offset:7936
  ds_read_b64_tr_b16 v[238:239], v10 offset:15616
  s_waitcnt lgkmcnt(8)
  v_mfma_f32_16x16x32_bf16 v[104:107], v[216:219], v[152:155], v[104:107]
  ds_read_b64_tr_b16 v[240:241], v11 offset:7936
  ds_read_b64_tr_b16 v[242:243], v11 offset:15616
  v_mfma_f32_16x16x32_bf16 v[108:111], v[220:223], v[152:155], v[108:111]
  ds_read_b64_tr_b16 v[244:245], v12 offset:7936
  ds_read_b64_tr_b16 v[246:247], v12 offset:15616
  s_waitcnt lgkmcnt(8)
  v_mfma_f32_16x16x32_bf16 v[112:115], v[224:227], v[152:155], v[112:115]
  v_cvt_pk_bf16_f32 v156, v88, v89
  v_cvt_pk_bf16_f32 v157, v90, v91
  v_mfma_f32_16x16x32_bf16 v[116:119], v[228:231], v[152:155], v[116:119]
  v_cvt_pk_bf16_f32 v158, v92, v93
  s_waitcnt lgkmcnt(6)
  v_mfma_f32_16x16x32_bf16 v[120:123], v[232:235], v[152:155], v[120:123]
  v_cvt_pk_bf16_f32 v159, v94, v95
  s_waitcnt lgkmcnt(4)
  v_mfma_f32_16x16x32_bf16 v[124:127], v[236:239], v[152:155], v[124:127]
  v_cvt_pk_bf16_f32 v160, v96, v97
  s_waitcnt lgkmcnt(2)
  v_mfma_f32_16x16x32_bf16 v[128:131], v[240:243], v[152:155], v[128:131]
  v_cvt_pk_bf16_f32 v161, v98, v99
  s_waitcnt lgkmcnt(0)
  v_mfma_f32_16x16x32_bf16 v[132:135], v[244:247], v[152:155], v[132:135]
  v_cvt_pk_bf16_f32 v162, v100, v101
  ds_read_b128 v[248:251], v2 offset:30720
  ds_read_b128 v[252:255], v2 offset:31744
  ds_read_b128 v[216:219], v2 offset:32768
  ds_read_b128 v[220:223], v2 offset:33792
  ds_read_b128 v[224:227], v2 offset:34816
  ds_read_b128 v[228:231], v2 offset:35840
  ds_read_b128 v[232:235], v2 offset:36864
  ds_read_b128 v[236:239], v2 offset:37888
  ds_read_b128 v[240:243], v2 offset:38912
  ds_read_b128 v[244:247], v2 offset:39936
  s_waitcnt lgkmcnt(6)
  v_mfma_f32_16x16x32_bf16 v[192:195], v[248:251], v[156:159], 0
  ds_read_b128 v[248:251], v2 offset:40960
  v_cvt_pk_bf16_f32 v163, v102, v103
  s_nop 1
  v_mfma_f32_16x16x32_bf16 v[192:195], v[252:255], v[160:163], v[192:195]
  ds_read_b128 v[252:255], v2 offset:41984
  v_cvt_pk_bf16_f32 v164, v104, v105
  v_cvt_pk_bf16_f32 v165, v106, v107
  v_cvt_pk_bf16_f32 v166, v108, v109
  v_cvt_pk_bf16_f32 v167, v110, v111
  s_nop 1
  v_mfma_f32_16x16x32_bf16 v[192:195], v[216:219], v[164:167], v[192:195]
  ds_read_b128 v[216:219], v2 offset:43008
  v_cvt_pk_bf16_f32 v24, v112, v113
  v_cvt_pk_bf16_f32 v25, v114, v115
  v_cvt_pk_bf16_f32 v26, v116, v117
  v_cvt_pk_bf16_f32 v27, v118, v119
  s_nop 1
  v_mfma_f32_16x16x32_bf16 v[192:195], v[220:223], v[24:27], v[192:195]
  ds_read_b128 v[220:223], v2 offset:44032
  v_cvt_pk_bf16_f32 v28, v120, v121
  v_cvt_pk_bf16_f32 v29, v122, v123
  v_cvt_pk_bf16_f32 v30, v124, v125
  v_cvt_pk_bf16_f32 v31, v126, v127
  s_waitcnt lgkmcnt(6)
  s_nop 0
  v_mfma_f32_16x16x32_bf16 v[192:195], v[224:227], v[28:31], v[192:195]
  ds_read_b128 v[224:227], v2 offset:45056
  v_cvt_pk_bf16_f32 v32, v128, v129
  v_cvt_pk_bf16_f32 v33, v130, v131
  v_cvt_pk_bf16_f32 v34, v132, v133
  v_cvt_pk_bf16_f32 v35, v134, v135
  s_nop 1
  v_mfma_f32_16x16x32_bf16 v[192:195], v[228:231], v[32:35], v[192:195]
  ds_read_b128 v[228:231], v2 offset:46080
  v_mfma_f32_16x16x32_bf16 v[196:199], v[232:235], v[156:159], 0
  ds_read_b128 v[232:235], v2 offset:47104
  v_mfma_f32_16x16x32_bf16 v[196:199], v[236:239], v[160:163], v[196:199]
  ds_read_b128 v[236:239], v2 offset:48128
  s_waitcnt lgkmcnt(6)
  v_mfma_f32_16x16x32_bf16 v[196:199], v[240:243], v[164:167], v[196:199]
  ds_read_b128 v[240:243], v2 offset:49152
  v_mul_f32 v192, v192, v23
  v_mfma_f32_16x16x32_bf16 v[196:199], v[244:247], v[24:27], v[196:199]
  ds_read_b128 v[244:247], v2 offset:50176
  v_mul_f32 v193, v193, v23
  v_mfma_f32_16x16x32_bf16 v[196:199], v[248:251], v[28:31], v[196:199]
  ds_read_b128 v[248:251], v2 offset:51200
  v_mul_f32 v194, v194, v23
  v_mfma_f32_16x16x32_bf16 v[196:199], v[252:255], v[32:35], v[196:199]
  ds_read_b128 v[252:255], v2 offset:52224
  s_mov_b32 s100, 71680
  buffer_load_dwordx4 v[104:107], v1, s[20:23], s100 offen offset:0 sc1
  buffer_load_dwordx4 v[108:111], v1, s[20:23], s100 offen offset:1024 sc1
  s_waitcnt lgkmcnt(6)
  v_mfma_f32_16x16x32_bf16 v[208:211], v[216:219], v[156:159], 0
  ds_read_b128 v[216:219], v2 offset:53248
  v_mul_f32 v195, v195, v23
  v_mfma_f32_16x16x32_bf16 v[208:211], v[220:223], v[160:163], v[208:211]
  ds_read_b128 v[220:223], v2 offset:54272
  v_cvt_pk_bf16_f32 v92, v192, v193
  v_mfma_f32_16x16x32_bf16 v[208:211], v[224:227], v[164:167], v[208:211]
  ds_read_b128 v[224:227], v2 offset:55296
  v_cvt_pk_bf16_f32 v93, v194, v195
  v_mfma_f32_16x16x32_bf16 v[208:211], v[228:231], v[24:27], v[208:211]
  ds_read_b128 v[228:231], v2 offset:56320
  s_waitcnt lgkmcnt(6)
  v_mfma_f32_16x16x32_bf16 v[208:211], v[232:235], v[28:31], v[208:211]
  ds_read_b128 v[232:235], v2 offset:57344
  v_mul_f32 v196, v196, v23
  v_mfma_f32_16x16x32_bf16 v[208:211], v[236:239], v[32:35], v[208:211]
  ds_read_b128 v[236:239], v2 offset:58368
  v_mul_f32 v197, v197, v23
  v_mfma_f32_16x16x32_bf16 v[212:215], v[240:243], v[156:159], 0
  ds_read_b128 v[240:243], v2 offset:59392
  v_mul_f32 v198, v198, v23
  v_mfma_f32_16x16x32_bf16 v[212:215], v[244:247], v[160:163], v[212:215]
  ds_read_b128 v[244:247], v2 offset:60416
  s_waitcnt lgkmcnt(6)
  v_mfma_f32_16x16x32_bf16 v[212:215], v[248:251], v[164:167], v[212:215]
  ds_read_b128 v[248:251], v1 offset:0
  v_mul_f32 v199, v199, v23
  v_mfma_f32_16x16x32_bf16 v[212:215], v[252:255], v[24:27], v[212:215]
  ds_read_b128 v[252:255], v1 offset:1024
  v_cvt_pk_bf16_f32 v94, v196, v197
  v_mfma_f32_16x16x32_bf16 v[212:215], v[216:219], v[28:31], v[212:215]
  ds_read_b128 v[216:219], v1 offset:2048
  v_cvt_pk_bf16_f32 v95, v198, v199
  v_mfma_f32_16x16x32_bf16 v[212:215], v[220:223], v[32:35], v[212:215]
  buffer_store_dwordx4 v[92:95], v6, s[16:19], 0 offen offset:0 nt sc1
  v_mul_f32 v208, v208, v23
  ds_read_b128 v[220:223], v1 offset:3072
  s_waitcnt lgkmcnt(6)
  v_mfma_f32_16x16x32_bf16 v[192:195], v[224:227], v[156:159], 0
  ds_read_b128 v[224:227], v1 offset:4096
  v_mul_f32 v209, v209, v23
  v_mfma_f32_16x16x32_bf16 v[192:195], v[228:231], v[160:163], v[192:195]
  ds_read_b128 v[228:231], v1 offset:5120
  v_mul_f32 v210, v210, v23
  v_mfma_f32_16x16x32_bf16 v[192:195], v[232:235], v[164:167], v[192:195]
  ds_read_b128 v[232:235], v1 offset:6144
  v_mul_f32 v211, v211, v23
  v_mfma_f32_16x16x32_bf16 v[192:195], v[236:239], v[24:27], v[192:195]
  ds_read_b128 v[236:239], v1 offset:7168
  s_waitcnt lgkmcnt(6)
  v_mfma_f32_16x16x32_bf16 v[192:195], v[240:243], v[28:31], v[192:195]
  ds_read_b128 v[240:243], v1 offset:8192
  v_cvt_pk_bf16_f32 v100, v208, v209
  v_mfma_f32_16x16x32_bf16 v[192:195], v[244:247], v[32:35], v[192:195]
  ds_read_b128 v[244:247], v1 offset:9216
  v_cvt_pk_bf16_f32 v101, v210, v211
  v_mfma_f32_16x16x32_bf16 v[196:199], v[248:251], v[156:159], 0
  ds_read_b128 v[248:251], v2 offset:0
  v_mul_f32 v212, v212, v23
  v_mfma_f32_16x16x32_bf16 v[196:199], v[252:255], v[160:163], v[196:199]
  ds_read_b128 v[252:255], v2 offset:1024
  s_waitcnt lgkmcnt(6)
  v_mfma_f32_16x16x32_bf16 v[196:199], v[216:219], v[164:167], v[196:199]
  ds_read_b128 v[216:219], v2 offset:2048
  v_mul_f32 v213, v213, v23
  v_mfma_f32_16x16x32_bf16 v[196:199], v[220:223], v[24:27], v[196:199]
  ds_read_b128 v[220:223], v2 offset:3072
  v_mul_f32 v214, v214, v23
  v_mfma_f32_16x16x32_bf16 v[196:199], v[224:227], v[28:31], v[196:199]
  ds_read_b128 v[224:227], v2 offset:4096
  v_mul_f32 v215, v215, v23
  v_mfma_f32_16x16x32_bf16 v[196:199], v[228:231], v[32:35], v[196:199]
  ds_read_b128 v[228:231], v2 offset:5120
  v_cvt_pk_bf16_f32 v102, v212, v213
  v_cvt_pk_bf16_f32 v103, v214, v215
  buffer_store_dwordx4 v[100:103], v6, s[16:19], 0 offen offset:64 nt sc1
  s_waitcnt lgkmcnt(6)
  v_mfma_f32_16x16x32_bf16 v[208:211], v[232:235], v[156:159], 0
  ds_read_b128 v[232:235], v2 offset:6144
  v_mul_f32 v192, v192, v23
  v_mfma_f32_16x16x32_bf16 v[208:211], v[236:239], v[160:163], v[208:211]
  ds_read_b128 v[236:239], v2 offset:7168
  v_mul_f32 v193, v193, v23
  v_mfma_f32_16x16x32_bf16 v[208:211], v[240:243], v[164:167], v[208:211]
  ds_read_b128 v[240:243], v2 offset:8192
  v_mul_f32 v194, v194, v23
  v_mfma_f32_16x16x32_bf16 v[208:211], v[244:247], v[24:27], v[208:211]
  ds_read_b128 v[244:247], v2 offset:9216
  s_waitcnt lgkmcnt(6)
  v_mfma_f32_16x16x32_bf16 v[208:211], v[248:251], v[28:31], v[208:211]
  ds_read_b128 v[248:251], v2 offset:10240
  v_mul_f32 v195, v195, v23
  v_mfma_f32_16x16x32_bf16 v[208:211], v[252:255], v[32:35], v[208:211]
  ds_read_b128 v[252:255], v2 offset:11264
  v_cvt_pk_bf16_f32 v92, v192, v193
  v_mfma_f32_16x16x32_bf16 v[212:215], v[216:219], v[156:159], 0
  ds_read_b128 v[216:219], v2 offset:12288
  v_cvt_pk_bf16_f32 v93, v194, v195
  v_mfma_f32_16x16x32_bf16 v[212:215], v[220:223], v[160:163], v[212:215]
  ds_read_b128 v[220:223], v2 offset:13312
  s_waitcnt lgkmcnt(6)
  v_mfma_f32_16x16x32_bf16 v[212:215], v[224:227], v[164:167], v[212:215]
  ds_read_b128 v[224:227], v2 offset:14336
  v_mul_f32 v196, v196, v23
  v_mfma_f32_16x16x32_bf16 v[212:215], v[228:231], v[24:27], v[212:215]
  ds_read_b128 v[228:231], v2 offset:15360
  v_mul_f32 v197, v197, v23
  v_mfma_f32_16x16x32_bf16 v[212:215], v[232:235], v[28:31], v[212:215]
  ds_read_b128 v[232:235], v2 offset:16384
  v_mul_f32 v198, v198, v23
  v_mfma_f32_16x16x32_bf16 v[212:215], v[236:239], v[32:35], v[212:215]
  ds_read_b128 v[236:239], v2 offset:17408
  v_mul_f32 v199, v199, v23
  v_cvt_pk_bf16_f32 v94, v196, v197
  v_cvt_pk_bf16_f32 v95, v198, v199
  buffer_store_dwordx4 v[92:95], v6, s[16:19], 0 offen offset:128 nt sc1
  s_waitcnt lgkmcnt(6)
  v_mfma_f32_16x16x32_bf16 v[192:195], v[240:243], v[156:159], 0
  ds_read_b128 v[240:243], v2 offset:18432
  v_mul_f32 v208, v208, v23
  v_mfma_f32_16x16x32_bf16 v[192:195], v[244:247], v[160:163], v[192:195]
  ds_read_b128 v[244:247], v2 offset:19456
  v_mul_f32 v209, v209, v23
  v_mfma_f32_16x16x32_bf16 v[192:195], v[248:251], v[164:167], v[192:195]
  ds_read_b128 v[248:251], v2 offset:20480
  v_mul_f32 v210, v210, v23
  v_mfma_f32_16x16x32_bf16 v[192:195], v[252:255], v[24:27], v[192:195]
  ds_read_b128 v[252:255], v2 offset:21504
  s_waitcnt lgkmcnt(6)
  v_mfma_f32_16x16x32_bf16 v[192:195], v[216:219], v[28:31], v[192:195]
  ds_read_b128 v[216:219], v2 offset:22528
  v_mul_f32 v211, v211, v23
  v_mfma_f32_16x16x32_bf16 v[192:195], v[220:223], v[32:35], v[192:195]
  ds_read_b128 v[220:223], v2 offset:23552
  v_cvt_pk_bf16_f32 v100, v208, v209
  v_mfma_f32_16x16x32_bf16 v[196:199], v[224:227], v[156:159], 0
  ds_read_b128 v[224:227], v2 offset:24576
  v_cvt_pk_bf16_f32 v101, v210, v211
  v_mfma_f32_16x16x32_bf16 v[196:199], v[228:231], v[160:163], v[196:199]
  ds_read_b128 v[228:231], v2 offset:25600
  s_waitcnt lgkmcnt(6)
  v_mfma_f32_16x16x32_bf16 v[196:199], v[232:235], v[164:167], v[196:199]
  ds_read_b128 v[232:235], v2 offset:26624
  v_mul_f32 v212, v212, v23
  v_mfma_f32_16x16x32_bf16 v[196:199], v[236:239], v[24:27], v[196:199]
  ds_read_b128 v[236:239], v2 offset:27648
  v_mul_f32 v213, v213, v23
  v_mfma_f32_16x16x32_bf16 v[196:199], v[240:243], v[28:31], v[196:199]
  ds_read_b128 v[240:243], v2 offset:28672
  v_mul_f32 v214, v214, v23
  v_mfma_f32_16x16x32_bf16 v[196:199], v[244:247], v[32:35], v[196:199]
  ds_read_b128 v[244:247], v2 offset:29696
  v_mul_f32 v215, v215, v23
  v_cvt_pk_bf16_f32 v102, v212, v213
  v_cvt_pk_bf16_f32 v103, v214, v215
  buffer_store_dwordx4 v[100:103], v6, s[16:19], 0 offen offset:192 nt sc1
  s_waitcnt vmcnt(4)
  s_waitcnt lgkmcnt(6)
  v_mfma_f32_16x16x32_bf16 v[208:211], v[248:251], v[156:159], 0
  v_mul_f32 v192, v192, v23
  v_mul_f32 v193, v193, v23
  v_mfma_f32_16x16x32_bf16 v[208:211], v[252:255], v[160:163], v[208:211]
  v_mul_f32 v194, v194, v23
  v_mul_f32 v195, v195, v23
  v_mfma_f32_16x16x32_bf16 v[208:211], v[216:219], v[164:167], v[208:211]
  v_cvt_pk_bf16_f32 v92, v192, v193
  v_cvt_pk_bf16_f32 v93, v194, v195
  v_mfma_f32_16x16x32_bf16 v[208:211], v[220:223], v[24:27], v[208:211]
  v_mul_f32 v196, v196, v23
  s_waitcnt lgkmcnt(4)
  v_mfma_f32_16x16x32_bf16 v[208:211], v[224:227], v[28:31], v[208:211]
  v_mul_f32 v197, v197, v23
  v_mul_f32 v198, v198, v23
  v_mfma_f32_16x16x32_bf16 v[208:211], v[228:231], v[32:35], v[208:211]
  v_mul_f32 v199, v199, v23
  s_waitcnt lgkmcnt(3)
  v_mfma_f32_16x16x32_bf16 v[212:215], v[232:235], v[156:159], 0
  v_cvt_pk_bf16_f32 v94, v196, v197
  s_waitcnt lgkmcnt(2)
  v_mfma_f32_16x16x32_bf16 v[212:215], v[236:239], v[160:163], v[212:215]
  v_cvt_pk_bf16_f32 v95, v198, v199
  s_waitcnt lgkmcnt(1)
  v_mfma_f32_16x16x32_bf16 v[212:215], v[240:243], v[164:167], v[212:215]
  v_mul_f32 v208, v208, v23
  s_waitcnt lgkmcnt(0)
  v_mfma_f32_16x16x32_bf16 v[212:215], v[244:247], v[24:27], v[212:215]
  v_mul_f32 v209, v209, v23
  v_mfma_f32_16x16x32_bf16 v[212:215], v[104:107], v[28:31], v[212:215]
  v_mul_f32 v210, v210, v23
  v_mfma_f32_16x16x32_bf16 v[212:215], v[108:111], v[32:35], v[212:215]
  v_mul_f32 v211, v211, v23
  v_cvt_pk_bf16_f32 v100, v208, v209
  buffer_store_dwordx4 v[92:95], v6, s[16:19], 0 offen offset:256 nt sc1
  v_cvt_pk_bf16_f32 v101, v210, v211
  s_nop 3
  v_mul_f32 v212, v212, v23
  v_mul_f32 v213, v213, v23
  v_mul_f32 v214, v214, v23
  v_mul_f32 v215, v215, v23
  v_cvt_pk_bf16_f32 v102, v212, v213
  v_cvt_pk_bf16_f32 v103, v214, v215
  buffer_store_dwordx4 v[100:103], v6, s[16:19], 0 offen offset:320 nt sc1
  s_endpgm
FB0:
  s_nop 7
  v_max3_f32 v22, v24, v25, v26
  v_max3_f32 v22, v22, v27, v28
  v_max3_f32 v22, v22, v29, v30
  v_max3_f32 v22, v22, v31, v32
  v_max3_f32 v22, v22, v33, v34
  v_max3_f32 v22, v22, v35, v36
  v_max3_f32 v22, v22, v37, v38
  v_max3_f32 v22, v22, v39, v40
  v_max3_f32 v22, v22, v41, v42
  v_max3_f32 v22, v22, v43, v44
  v_max3_f32 v22, v22, v45, v46
  v_max3_f32 v22, v22, v47, v48
  v_max3_f32 v22, v22, v49, v50
  v_max3_f32 v22, v22, v51, v52
  v_max3_f32 v22, v22, v53, v54
  s_mov_b32 s52, 0xff7fffff
  v_max3_f32 v22, v22, v55, s52
  v_mov_b32 v23, v22
  s_nop 1
  v_permlane32_swap_b32 v22, v23
  s_nop 1
  v_max_f32 v22, v22, v23
  v_mov_b32 v23, v22
  s_nop 1
  v_permlane16_swap_b32 v22, v23
  s_nop 1
  v_max_f32 v22, v22, v23
  v_sub_f32 v24, v24, v22
  v_sub_f32 v25, v25, v22
  v_sub_f32 v26, v26, v22
  v_sub_f32 v27, v27, v22
  v_sub_f32 v28, v28, v22
  v_sub_f32 v29, v29, v22
  v_sub_f32 v30, v30, v22
  v_sub_f32 v31, v31, v22
  v_sub_f32 v32, v32, v22
  v_sub_f32 v33, v33, v22
  v_sub_f32 v34, v34, v22
  v_sub_f32 v35, v35, v22
  v_sub_f32 v36, v36, v22
  v_sub_f32 v37, v37, v22
  v_sub_f32 v38, v38, v22
  v_sub_f32 v39, v39, v22
  v_sub_f32 v40, v40, v22
  v_sub_f32 v41, v41, v22
  v_sub_f32 v42, v42, v22
  v_sub_f32 v43, v43, v22
  v_sub_f32 v44, v44, v22
  v_sub_f32 v45, v45, v22
  v_sub_f32 v46, v46, v22
  v_sub_f32 v47, v47, v22
  v_sub_f32 v48, v48, v22
  v_sub_f32 v49, v49, v22
  v_sub_f32 v50, v50, v22
  v_sub_f32 v51, v51, v22
  v_sub_f32 v52, v52, v22
  v_sub_f32 v53, v53, v22
  v_sub_f32 v54, v54, v22
  v_sub_f32 v55, v55, v22
  v_exp_f32 v24, v24
  v_exp_f32 v25, v25
  v_exp_f32 v26, v26
  v_exp_f32 v27, v27
  v_exp_f32 v28, v28
  v_exp_f32 v29, v29
  v_exp_f32 v30, v30
  v_exp_f32 v31, v31
  v_exp_f32 v32, v32
  v_exp_f32 v33, v33
  v_exp_f32 v34, v34
  v_exp_f32 v35, v35
  v_exp_f32 v36, v36
  v_exp_f32 v37, v37
  v_exp_f32 v38, v38
  v_exp_f32 v39, v39
  v_exp_f32 v40, v40
  v_exp_f32 v41, v41
  v_exp_f32 v42, v42
  v_exp_f32 v43, v43
  v_exp_f32 v44, v44
  v_exp_f32 v45, v45
  v_exp_f32 v46, v46
  v_exp_f32 v47, v47
  v_exp_f32 v48, v48
  v_exp_f32 v49, v49
  v_exp_f32 v50, v50
  v_exp_f32 v51, v51
  v_exp_f32 v52, v52
  v_exp_f32 v53, v53
  v_exp_f32 v54, v54
  v_exp_f32 v55, v55
  s_nop 0
  v_cvt_pk_bf16_f32 v136, v24, v25
  v_cvt_pk_bf16_f32 v137, v26, v27
  v_cvt_pk_bf16_f32 v138, v28, v29
  v_cvt_pk_bf16_f32 v139, v30, v31
  v_cvt_pk_bf16_f32 v140, v32, v33
  v_cvt_pk_bf16_f32 v141, v34, v35
  v_cvt_pk_bf16_f32 v142, v36, v37
  v_cvt_pk_bf16_f32 v143, v38, v39
  v_cvt_pk_bf16_f32 v144, v40, v41
  v_cvt_pk_bf16_f32 v145, v42, v43
  v_cvt_pk_bf16_f32 v146, v44, v45
  v_cvt_pk_bf16_f32 v147, v46, v47
  v_cvt_pk_bf16_f32 v148, v48, v49
  v_cvt_pk_bf16_f32 v149, v50, v51
  v_cvt_pk_bf16_f32 v150, v52, v53
  v_cvt_pk_bf16_f32 v151, v54, v55
  s_nop 1
  v_mfma_f32_16x16x32_bf16 v[184:187], v[192:195], v[136:139], 0
  v_mfma_f32_16x16x32_bf16 v[184:187], v[192:195], v[140:143], v[184:187]
  v_mfma_f32_16x16x32_bf16 v[184:187], v[192:195], v[144:147], v[184:187]
  v_mfma_f32_16x16x32_bf16 v[184:187], v[192:195], v[148:151], v[184:187]
  s_waitcnt lgkmcnt(0)
  ds_read_b64_tr_b16 v[24:25], v9 offset:38400
  ds_read_b64_tr_b16 v[26:27], v9 offset:46080
  ds_read_b64_tr_b16 v[28:29], v10 offset:38400
  ds_read_b64_tr_b16 v[30:31], v10 offset:46080
  ds_read_b64_tr_b16 v[32:33], v11 offset:38400
  ds_read_b64_tr_b16 v[34:35], v11 offset:46080
  ds_read_b64_tr_b16 v[36:37], v12 offset:38400
  ds_read_b64_tr_b16 v[38:39], v12 offset:46080
  ds_read_b64_tr_b16 v[40:41], v9 offset:38528
  ds_read_b64_tr_b16 v[42:43], v9 offset:46208
  ds_read_b64_tr_b16 v[44:45], v10 offset:38528
  ds_read_b64_tr_b16 v[46:47], v10 offset:46208
  s_waitcnt lgkmcnt(0)
  v_mfma_f32_16x16x32_bf16 v[56:59], v[24:27], v[148:151], 0
  v_mfma_f32_16x16x32_bf16 v[60:63], v[28:31], v[148:151], 0
  v_mfma_f32_16x16x32_bf16 v[64:67], v[32:35], v[148:151], 0
  v_mfma_f32_16x16x32_bf16 v[68:71], v[36:39], v[148:151], 0
  v_mfma_f32_16x16x32_bf16 v[72:75], v[40:43], v[148:151], 0
  v_mfma_f32_16x16x32_bf16 v[76:79], v[44:47], v[148:151], 0
  s_waitcnt lgkmcnt(0)
  ds_read_b64_tr_b16 v[24:25], v11 offset:38528
  ds_read_b64_tr_b16 v[26:27], v11 offset:46208
  ds_read_b64_tr_b16 v[28:29], v12 offset:38528
  ds_read_b64_tr_b16 v[30:31], v12 offset:46208
  ds_read_b64_tr_b16 v[32:33], v9 offset:38656
  ds_read_b64_tr_b16 v[34:35], v9 offset:46336
  ds_read_b64_tr_b16 v[36:37], v10 offset:38656
  ds_read_b64_tr_b16 v[38:39], v10 offset:46336
  ds_read_b64_tr_b16 v[40:41], v11 offset:38656
  ds_read_b64_tr_b16 v[42:43], v11 offset:46336
  ds_read_b64_tr_b16 v[44:45], v12 offset:38656
  ds_read_b64_tr_b16 v[46:47], v12 offset:46336
  s_waitcnt lgkmcnt(0)
  v_mfma_f32_16x16x32_bf16 v[80:83], v[24:27], v[148:151], 0
  v_mfma_f32_16x16x32_bf16 v[84:87], v[28:31], v[148:151], 0
  v_mfma_f32_16x16x32_bf16 v[168:171], v[32:35], v[148:151], 0
  v_mfma_f32_16x16x32_bf16 v[172:175], v[36:39], v[148:151], 0
  v_mfma_f32_16x16x32_bf16 v[176:179], v[40:43], v[148:151], 0
  v_mfma_f32_16x16x32_bf16 v[180:183], v[44:47], v[148:151], 0
  s_nop 7
  s_branch FBR0
FB1:
  s_nop 7
  v_max3_f32 v22, v56, v57, v58
  v_max3_f32 v22, v22, v59, v60
  v_max3_f32 v22, v22, v61, v62
  v_max3_f32 v22, v22, v63, v64
  v_max3_f32 v22, v22, v65, v66
  v_max3_f32 v22, v22, v67, v68
  v_max3_f32 v22, v22, v69, v70
  v_max3_f32 v22, v22, v71, v72
  v_max3_f32 v22, v22, v73, v74
  v_max3_f32 v22, v22, v75, v76
  v_max3_f32 v22, v22, v77, v78
  v_max3_f32 v22, v22, v79, v80
  v_max3_f32 v22, v22, v81, v82
  v_max3_f32 v22, v22, v83, v84
  v_max3_f32 v22, v22, v85, v86
  s_mov_b32 s52, 0xff7fffff
  v_max3_f32 v22, v22, v87, s52
  v_mov_b32 v23, v22
  s_nop 1
  v_permlane32_swap_b32 v22, v23
  s_nop 1
  v_max_f32 v22, v22, v23
  v_mov_b32 v23, v22
  s_nop 1
  v_permlane16_swap_b32 v22, v23
  s_nop 1
  v_max_f32 v22, v22, v23
  v_sub_f32 v56, v56, v22
  v_sub_f32 v57, v57, v22
  v_sub_f32 v58, v58, v22
  v_sub_f32 v59, v59, v22
  v_sub_f32 v60, v60, v22
  v_sub_f32 v61, v61, v22
  v_sub_f32 v62, v62, v22
  v_sub_f32 v63, v63, v22
  v_sub_f32 v64, v64, v22
  v_sub_f32 v65, v65, v22
  v_sub_f32 v66, v66, v22
  v_sub_f32 v67, v67, v22
  v_sub_f32 v68, v68, v22
  v_sub_f32 v69, v69, v22
  v_sub_f32 v70, v70, v22
  v_sub_f32 v71, v71, v22
  v_sub_f32 v72, v72, v22
  v_sub_f32 v73, v73, v22
  v_sub_f32 v74, v74, v22
  v_sub_f32 v75, v75, v22
  v_sub_f32 v76, v76, v22
  v_sub_f32 v77, v77, v22
  v_sub_f32 v78, v78, v22
  v_sub_f32 v79, v79, v22
  v_sub_f32 v80, v80, v22
  v_sub_f32 v81, v81, v22
  v_sub_f32 v82, v82, v22
  v_sub_f32 v83, v83, v22
  v_sub_f32 v84, v84, v22
  v_sub_f32 v85, v85, v22
  v_sub_f32 v86, v86, v22
  v_sub_f32 v87, v87, v22
  v_exp_f32 v56, v56
  v_exp_f32 v57, v57
  v_exp_f32 v58, v58
  v_exp_f32 v59, v59
  v_exp_f32 v60, v60
  v_exp_f32 v61, v61
  v_exp_f32 v62, v62
  v_exp_f32 v63, v63
  v_exp_f32 v64, v64
  v_exp_f32 v65, v65
  v_exp_f32 v66, v66
  v_exp_f32 v67, v67
  v_exp_f32 v68, v68
  v_exp_f32 v69, v69
  v_exp_f32 v70, v70
  v_exp_f32 v71, v71
  v_exp_f32 v72, v72
  v_exp_f32 v73, v73
  v_exp_f32 v74, v74
  v_exp_f32 v75, v75
  v_exp_f32 v76, v76
  v_exp_f32 v77, v77
  v_exp_f32 v78, v78
  v_exp_f32 v79, v79
  v_exp_f32 v80, v80
  v_exp_f32 v81, v81
  v_exp_f32 v82, v82
  v_exp_f32 v83, v83
  v_exp_f32 v84, v84
  v_exp_f32 v85, v85
  v_exp_f32 v86, v86
  v_exp_f32 v87, v87
  s_nop 0
  v_cvt_pk_bf16_f32 v152, v56, v57
  v_cvt_pk_bf16_f32 v153, v58, v59
  v_cvt_pk_bf16_f32 v154, v60, v61
  v_cvt_pk_bf16_f32 v155, v62, v63
  v_cvt_pk_bf16_f32 v156, v64, v65
  v_cvt_pk_bf16_f32 v157, v66, v67
  v_cvt_pk_bf16_f32 v158, v68, v69
  v_cvt_pk_bf16_f32 v159, v70, v71
  v_cvt_pk_bf16_f32 v160, v72, v73
  v_cvt_pk_bf16_f32 v161, v74, v75
  v_cvt_pk_bf16_f32 v162, v76, v77
  v_cvt_pk_bf16_f32 v163, v78, v79
  v_cvt_pk_bf16_f32 v164, v80, v81
  v_cvt_pk_bf16_f32 v165, v82, v83
  v_cvt_pk_bf16_f32 v166, v84, v85
  v_cvt_pk_bf16_f32 v167, v86, v87
  s_nop 1
  v_mfma_f32_16x16x32_bf16 v[188:191], v[192:195], v[152:155], 0
  v_mfma_f32_16x16x32_bf16 v[188:191], v[192:195], v[156:159], v[188:191]
  v_mfma_f32_16x16x32_bf16 v[188:191], v[192:195], v[160:163], v[188:191]
  v_mfma_f32_16x16x32_bf16 v[188:191], v[192:195], v[164:167], v[188:191]
  s_nop 7
  s_branch FBR1
FB1s:
  s_nop 7
  v_max3_f32 v22, v56, v57, v58
  v_max3_f32 v22, v22, v59, v60
  v_max3_f32 v22, v22, v61, v62
  v_max3_f32 v22, v22, v63, v64
  v_max3_f32 v22, v22, v65, v66
  v_max3_f32 v22, v22, v67, v68
  v_max3_f32 v22, v22, v69, v70
  v_max3_f32 v22, v22, v71, v72
  v_max3_f32 v22, v22, v73, v74
  v_max3_f32 v22, v22, v75, v76
  v_max3_f32 v22, v22, v77, v78
  v_max3_f32 v22, v22, v79, v80
  v_max3_f32 v22, v22, v81, v82
  v_max3_f32 v22, v22, v83, v84
  v_max3_f32 v22, v22, v85, v86
  s_mov_b32 s52, 0xff7fffff
  v_max3_f32 v22, v22, v87, s52
  v_mov_b32 v23, v22
  s_nop 1
  v_permlane32_swap_b32 v22, v23
  s_nop 1
  v_max_f32 v22, v22, v23
  v_mov_b32 v23, v22
  s_nop 1
  v_permlane16_swap_b32 v22, v23
  s_nop 1
  v_max_f32 v22, v22, v23
  v_sub_f32 v56, v56, v22
  v_sub_f32 v57, v57, v22
  v_sub_f32 v58, v58, v22
  v_sub_f32 v59, v59, v22
  v_sub_f32 v60, v60, v22
  v_sub_f32 v61, v61, v22
  v_sub_f32 v62, v62, v22
  v_sub_f32 v63, v63, v22
  v_sub_f32 v64, v64, v22
  v_sub_f32 v65, v65, v22
  v_sub_f32 v66, v66, v22
  v_sub_f32 v67, v67, v22
  v_sub_f32 v68, v68, v22
  v_sub_f32 v69, v69, v22
  v_sub_f32 v70, v70, v22
  v_sub_f32 v71, v71, v22
  v_sub_f32 v72, v72, v22
  v_sub_f32 v73, v73, v22
  v_sub_f32 v74, v74, v22
  v_sub_f32 v75, v75, v22
  v_sub_f32 v76, v76, v22
  v_sub_f32 v77, v77, v22
  v_sub_f32 v78, v78, v22
  v_sub_f32 v79, v79, v22
  v_sub_f32 v80, v80, v22
  v_sub_f32 v81, v81, v22
  v_sub_f32 v82, v82, v22
  v_sub_f32 v83, v83, v22
  v_sub_f32 v84, v84, v22
  v_sub_f32 v85, v85, v22
  v_sub_f32 v86, v86, v22
  v_sub_f32 v87, v87, v22
  v_exp_f32 v56, v56
  v_exp_f32 v57, v57
  v_exp_f32 v58, v58
  v_exp_f32 v59, v59
  v_exp_f32 v60, v60
  v_exp_f32 v61, v61
  v_exp_f32 v62, v62
  v_exp_f32 v63, v63
  v_exp_f32 v64, v64
  v_exp_f32 v65, v65
  v_exp_f32 v66, v66
  v_exp_f32 v67, v67
  v_exp_f32 v68, v68
  v_exp_f32 v69, v69
  v_exp_f32 v70, v70
  v_exp_f32 v71, v71
  v_exp_f32 v72, v72
  v_exp_f32 v73, v73
  v_exp_f32 v74, v74
  v_exp_f32 v75, v75
  v_exp_f32 v76, v76
  v_exp_f32 v77, v77
  v_exp_f32 v78, v78
  v_exp_f32 v79, v79
  v_exp_f32 v80, v80
  v_exp_f32 v81, v81
  v_exp_f32 v82, v82
  v_exp_f32 v83, v83
  v_exp_f32 v84, v84
  v_exp_f32 v85, v85
  v_exp_f32 v86, v86
  v_exp_f32 v87, v87
  s_nop 0
  v_cvt_pk_bf16_f32 v152, v56, v57
  v_cvt_pk_bf16_f32 v153, v58, v59
  v_cvt_pk_bf16_f32 v154, v60, v61
  v_cvt_pk_bf16_f32 v155, v62, v63
  v_cvt_pk_bf16_f32 v156, v64, v65
  v_cvt_pk_bf16_f32 v157, v66, v67
  v_cvt_pk_bf16_f32 v158, v68, v69
  v_cvt_pk_bf16_f32 v159, v70, v71
  v_cvt_pk_bf16_f32 v160, v72, v73
  v_cvt_pk_bf16_f32 v161, v74, v75
  v_cvt_pk_bf16_f32 v162, v76, v77
  v_cvt_pk_bf16_f32 v163, v78, v79
  v_cvt_pk_bf16_f32 v164, v80, v81
  v_cvt_pk_bf16_f32 v165, v82, v83
  v_cvt_pk_bf16_f32 v166, v84, v85
  v_cvt_pk_bf16_f32 v167, v86, v87
  s_nop 1
  v_mfma_f32_16x16x32_bf16 v[188:191], v[192:195], v[152:155], 0
  v_mfma_f32_16x16x32_bf16 v[188:191], v[192:195], v[156:159], v[188:191]
  v_mfma_f32_16x16x32_bf16 v[188:191], v[192:195], v[160:163], v[188:191]
  v_mfma_f32_16x16x32_bf16 v[188:191], v[192:195], v[164:167], v[188:191]
  s_nop 7
  s_branch FBR1s
MK_end:
.section .rodata,"a"
.p2align 6
.amdhsa_kernel standalone__neighborhood_nat__vision_kernel
  .amdhsa_next_free_vgpr 256
  .amdhsa_next_free_sgpr 102
  .amdhsa_accum_offset 256
  .amdhsa_group_segment_fixed_size 0
  .amdhsa_kernarg_size 48
  .amdhsa_user_sgpr_count 2
  .amdhsa_user_sgpr_kernarg_segment_ptr 1
  .amdhsa_system_sgpr_workgroup_id_x 1
.end_amdhsa_kernel
```
